```python
import torch

def _softmax(x, axis=-1):
    return torch.softmax(x, dim=axis)
def _gelu(x):
    return torch.nn.functional.gelu(x, approximate="tanh")
def _silu(x):
    return torch.nn.functional.silu(x)
def _sigmoid(x):
    return torch.sigmoid(x)
def _layernorm(x, axis=-1, eps=1e-5):
    m = x.mean(dim=axis, keepdim=True)
    v = x.var(dim=axis, keepdim=True, unbiased=False)
    return (x - m) / torch.sqrt(v + eps)
def _scatter_add(tgt, idx, src, axis=0):
    return tgt.clone().index_add_(axis, idx, src)
def _segment_sum(src, seg, n):
    out = torch.zeros((n,) + src.shape[1:], dtype=src.dtype)
    return out.index_add_(0, seg, src)
def _pad(x, pw):
    flat = tuple(v for pair in reversed(pw) for v in pair)
    return torch.nn.functional.pad(x, flat)

kernel_name = 'interleave_layers__sliding_local_dilated__mixer_token_mlp__prompt'

def setup_inputs():

    _w = (lambda a: (lambda t: t.to(torch.bfloat16) if t.is_floating_point() else t)(torch.as_tensor(a)))
    def _A_setup():
        B, S, D = 1, 2048, 1024
        return {
            "x": _w((lambda *s: torch.randn(*s, dtype=torch.bfloat16) * 0.05)(B, S, D)),
            "wqkv": _w((lambda *s: torch.randn(*s, dtype=torch.bfloat16) * 0.05)(D, 3 * D)),
            "wo": _w((lambda *s: torch.randn(*s, dtype=torch.bfloat16) * 0.05)(D, D)),
        }
    _A_in = _A_setup()

    def _B_setup():
        B, S, D, F = 1, 2048, 1024, 3584
        return {
            "x": _w((lambda *s: torch.randn(*s, dtype=torch.bfloat16) * 0.05)(B, S, D)),
            "w1": _w((lambda *s: torch.randn(*s, dtype=torch.bfloat16) * 1.6)(S, F) * (S ** -0.5)),
            "b1": _w((lambda *s: torch.randn(*s, dtype=torch.bfloat16) * 1.6)(F) * 0.02),
            "w2": _w((lambda *s: torch.randn(*s, dtype=torch.bfloat16) * 1.6)(F, S) * (F ** -0.5)),
            "b2": _w((lambda *s: torch.randn(*s, dtype=torch.bfloat16) * 1.6)(S) * 0.02),
        }
    _B_in = _B_setup()

    return {
        "A_x": _A_in["x"],
        "A_wqkv": _A_in["wqkv"],
        "A_wo": _A_in["wo"],
        "B_x": _B_in["x"],
        "B_w1": _B_in["w1"],
        "B_b1": _B_in["b1"],
        "B_w2": _B_in["w2"],
        "B_b2": _B_in["b2"],
    }

def reference(A_x, A_wqkv, A_wo, B_x, B_w1, B_b1, B_w2, B_b2):
    def _A_ref(x, wqkv, wo):
        B, S, D = x.shape
        H = 32; Dh = D // H
        W, dil = 8, 2
        qkv = (lambda x, *d: x.permute(*d))((x @ wqkv).reshape(B, S, 3, H, Dh), 2, 0, 3, 1, 4)
        q, k, v = qkv[0], qkv[1], qkv[2]
        scale = Dh ** -0.5
        pos = torch.arange(S)
        off = torch.arange(W) * dil
        idx = pos[:, None] - off[None, :]
        mask = idx >= 0
        idx_c = torch.where(mask, idx, 0).reshape(-1)
        kg = k[:, :, idx_c, :].reshape(B, H, S, W, Dh)
        vg = v[:, :, idx_c, :].reshape(B, H, S, W, Dh)
        logits = torch.einsum("bhsd,bhswd->bhsw", q, kg) * scale
        logits = torch.where(mask[None, None, :, :], logits, -1e9)
        attn = _softmax(logits, axis=-1)
        o = torch.einsum("bhsw,bhswd->bhsd", attn, vg)
        return (lambda x, *d: x.permute(*d))(o, 0, 2, 1, 3).reshape(B, S, D) @ wo

    def _B_ref(x, w1, b1, w2, b2):
        B, S, D = x.shape
        h = _layernorm(x, axis=-1)
        u = torch.einsum("bsd,sf->bdf", h, w1) + b1
        u = _gelu(u)
        y = torch.einsum("bdf,fs->bds", u, w2) + b2
        return (lambda x, *d: x.permute(*d))(y, 0, 2, 1)

    x = A_x
    x = x + _A_ref(_layernorm(x, axis=-1), A_wqkv, A_wo)
    x = x + _B_ref(_layernorm(x, axis=-1), B_w1, B_b1, B_w2, B_b2)
    x = x + _A_ref(_layernorm(x, axis=-1), A_wqkv, A_wo)
    x = x + _B_ref(_layernorm(x, axis=-1), B_w1, B_b1, B_w2, B_b2)
    return x
```

```asm
; @launch kernel=k1a_kernel grid=(256,1,1) block=(512,1,1) lds=130176
; @launch kernel=k2a_kernel grid=(256,1,1) block=(512,1,1) lds=150528
; @launch kernel=k3_kernel grid=(224,1,1) block=(512,1,1) lds=163840
; @launch kernel=k4a_kernel grid=(256,1,1) block=(512,1,1) lds=147456
; @launch kernel=k1b_kernel grid=(256,1,1) block=(512,1,1) lds=130176
; @launch kernel=k2b_kernel grid=(256,1,1) block=(512,1,1) lds=150528
; @launch kernel=k3_kernel grid=(224,1,1) block=(512,1,1) lds=163840
; @launch kernel=k4b_kernel grid=(256,1,1) block=(512,1,1) lds=147456
.amdgcn_target "amdgcn-amd-amdhsa--gfx950"
.text
.p2align 8
k1a_kernel:
  s_mov_b32 s3, 0
  s_branch k1_body
.p2align 8
k1b_kernel:
  s_mov_b32 s3, 1
k1_body:
  s_cmp_ge_u32 s2, 256
  s_cbranch_scc1 k1_end
  s_load_dwordx16 s[64:79], s[0:1], 0
  s_load_dwordx2 s[80:81], s[0:1], 64
  s_load_dwordx2 s[82:83], s[0:1], 80
  v_lshrrev_b32 v1, 6, v0
  v_and_b32 v0, 63, v0
  v_readfirstlane_b32 s4, v1
  s_lshr_b32 s32, s2, 3
  s_lshr_b32 s5, s32, 3
  s_and_b32 s6, s32, 7
  s_lshl_b32 s7, s5, 1
  s_add_u32 s7, s7, s6
  s_and_b32 s7, s7, 7
  s_and_b32 s32, s2, 7
  s_lshr_b32 s28, s32, 1
  s_lshl_b32 s28, s28, 2
  s_add_u32 s28, s28, s5
  s_and_b32 s29, s32, 1
  s_mul_i32 s29, s29, 8
  s_add_u32 s29, s29, s6
  s_cmp_ge_u32 s4, 4
  s_cbranch_scc1 k1_loader
  v_and_b32 v2, 31, v0
  v_lshrrev_b32 v3, 5, v0
  v_and_b32 v4, 15, v0
  v_lshrrev_b32 v5, 4, v0
  v_lshrrev_b32 v6, 2, v4
  v_and_b32 v7, 3, v0
  s_waitcnt lgkmcnt(0)
  s_add_u32 s16, s82, 25165824
  s_addc_u32 s17, s83, 0
  s_mov_b32 s18, 262144
  s_mov_b32 s19, 0x20000
  s_cmp_lg_u32 s4, 0
  s_cbranch_scc1 k1_norst
  v_mov_b32 v16, -1
  v_mov_b32 v17, -1
  v_mov_b32 v18, -1
  v_mov_b32 v19, -1
  v_lshlrev_b32 v20, 4, v0
  s_lshl_b32 s32, s2, 10
  buffer_store_dwordx4 v[16:19], v20, s[16:19], s32 offen sc0 sc1
k1_norst:
  v_lshlrev_b32 v21, 3, v5
  v_add_u32 v21, v21, v6
  v_lshlrev_b32 v21, 7, v21
  v_lshrrev_b32 v22, 1, v7
  s_lshl_b32 s32, s4, 1
  v_add_u32 v22, s32, v22
  v_lshrrev_b32 v23, 1, v6
  v_and_b32 v24, 1, v5
  v_lshl_or_b32 v23, v24, 1, v23
  v_lshlrev_b32 v23, 1, v23
  v_xor_b32 v22, v22, v23
  v_lshlrev_b32 v22, 4, v22
  v_and_b32 v23, 1, v7
  v_lshlrev_b32 v23, 3, v23
  v_add3_u32 v8, v21, v22, v23
  v_add_u32 v8, 18432, v8
  v_lshrrev_b32 v21, 1, v4
  v_xor_b32 v21, v21, v5
  v_lshlrev_b32 v21, 4, v21
  v_lshlrev_b32 v22, 7, v4
  v_add_u32 v9, v21, v22
  v_xor_b32 v10, 64, v9
  v_and_b32 v21, 1, v4
  v_mul_u32_u24 v21, 28800, v21
  v_lshrrev_b32 v22, 1, v4
  v_mul_u32_u24 v22, 400, v22
  v_lshlrev_b32 v23, 3, v5
  v_add3_u32 v11, v21, v22, v23
  s_lshl_b32 s32, s4, 5
  s_add_u32 s32, s32, 43008
  v_add_u32 v11, s32, v11
  v_lshlrev_b32 v12, 3, v4
  v_add_u32 v12, 129024, v12
  v_mov_b32 v112, 0
  v_mov_b32 v113, 0
  v_mov_b32 v114, 0
  v_mov_b32 v115, 0
  v_mov_b32 v116, 0
  v_mov_b32 v117, 0
  v_mov_b32 v118, 0
  v_mov_b32 v119, 0
  v_mov_b32 v120, 0
  v_mov_b32 v121, 0
  v_mov_b32 v122, 0
  v_mov_b32 v123, 0
  v_mov_b32 v124, 0
  v_mov_b32 v125, 0
  v_mov_b32 v126, 0
  v_mov_b32 v127, 0
  v_mov_b32 v128, 0
  v_mov_b32 v129, 0
  v_mov_b32 v130, 0
  v_mov_b32 v131, 0
  v_mov_b32 v132, 0
  v_mov_b32 v133, 0
  v_mov_b32 v134, 0
  v_mov_b32 v135, 0
  v_mov_b32 v136, 0
  v_mov_b32 v137, 0
  v_mov_b32 v138, 0
  v_mov_b32 v139, 0
  v_mov_b32 v140, 0
  v_mov_b32 v141, 0
  v_mov_b32 v142, 0
  v_mov_b32 v143, 0
  v_mov_b32 v144, 0
  v_mov_b32 v145, 0
  v_mov_b32 v146, 0
  v_mov_b32 v147, 0
  v_mov_b32 v148, 0
  v_mov_b32 v149, 0
  v_mov_b32 v150, 0
  v_mov_b32 v151, 0
  v_mov_b32 v152, 0
  v_mov_b32 v153, 0
  v_mov_b32 v154, 0
  v_mov_b32 v155, 0
  v_mov_b32 v156, 0
  v_mov_b32 v157, 0
  v_mov_b32 v158, 0
  v_mov_b32 v159, 0
  v_mov_b32 v160, 0
  v_mov_b32 v161, 0
  v_mov_b32 v162, 0
  v_mov_b32 v163, 0
  v_mov_b32 v164, 0
  v_mov_b32 v165, 0
  v_mov_b32 v166, 0
  v_mov_b32 v167, 0
  v_mov_b32 v168, 0
  v_mov_b32 v169, 0
  v_mov_b32 v170, 0
  v_mov_b32 v171, 0
  v_mov_b32 v172, 0
  v_mov_b32 v173, 0
  v_mov_b32 v174, 0
  v_mov_b32 v175, 0
  v_mov_b32 v176, 0
  v_mov_b32 v177, 0
  v_mov_b32 v178, 0
  v_mov_b32 v179, 0
  v_mov_b32 v180, 0
  v_mov_b32 v181, 0
  v_mov_b32 v182, 0
  v_mov_b32 v183, 0
  v_mov_b32 v184, 0
  v_mov_b32 v185, 0
  v_mov_b32 v186, 0
  v_mov_b32 v187, 0
  v_mov_b32 v188, 0
  v_mov_b32 v189, 0
  v_mov_b32 v190, 0
  v_mov_b32 v191, 0
  v_mov_b32 v192, 0
  v_mov_b32 v193, 0
  v_mov_b32 v194, 0
  v_mov_b32 v195, 0
  v_mov_b32 v196, 0
  v_mov_b32 v197, 0
  v_mov_b32 v198, 0
  v_mov_b32 v199, 0
  v_mov_b32 v200, 0
  v_mov_b32 v201, 0
  v_mov_b32 v202, 0
  v_mov_b32 v203, 0
  v_mov_b32 v204, 0
  v_mov_b32 v205, 0
  v_mov_b32 v206, 0
  v_mov_b32 v207, 0
  v_mov_b32 v208, 0
  v_mov_b32 v209, 0
  v_mov_b32 v210, 0
  v_mov_b32 v211, 0
  v_mov_b32 v212, 0
  v_mov_b32 v213, 0
  v_mov_b32 v214, 0
  v_mov_b32 v215, 0
  v_mov_b32 v216, 0
  v_mov_b32 v217, 0
  v_mov_b32 v218, 0
  v_mov_b32 v219, 0
  s_mov_b32 s43, 0
  s_mov_b32 s39, 15
  s_barrier
  ds_read_b64_tr_b16 v[16:17], v8 offset:0
  ds_read_b64_tr_b16 v[18:19], v8 offset:512
  ds_read_b128 v[28:31], v9 offset:0
  ds_read_b64_tr_b16 v[20:21], v8 offset:8192
  ds_read_b64_tr_b16 v[22:23], v8 offset:8704
  ds_read_b64_tr_b16 v[24:25], v8 offset:16384
  ds_read_b64_tr_b16 v[26:27], v8 offset:16896
  ds_read_b128 v[32:35], v9 offset:2048
  ds_read_b128 v[36:39], v9 offset:4096
  ds_read_b128 v[40:43], v9 offset:6144
  ds_read_b128 v[44:47], v9 offset:8192
  ds_read_b128 v[48:51], v9 offset:10240
  ds_read_b128 v[52:55], v9 offset:12288
  ds_read_b128 v[56:59], v9 offset:14336
  ds_read_b128 v[60:63], v9 offset:16384
  s_add_u32 s32, s43, 43008
  s_cmp_eq_u32 s32, 129024
  s_cselect_b32 s32, 0, s32
  s_sub_u32 s42, s32, s43
  s_mov_b32 s43, s32
k1_cloop:
  s_waitcnt lgkmcnt(0)
  v_mfma_f32_16x16x32_bf16 v[112:115], v[16:19], v[28:31], v[112:115]
  ds_read_b64_tr_b16 v[64:65], v8 offset:4096
  v_mfma_f32_16x16x32_bf16 v[148:151], v[20:23], v[28:31], v[148:151]
  ds_read_b64_tr_b16 v[66:67], v8 offset:4608
  v_mfma_f32_16x16x32_bf16 v[184:187], v[24:27], v[28:31], v[184:187]
  ds_read_b128 v[76:79], v10 offset:0
  v_mfma_f32_16x16x32_bf16 v[116:119], v[16:19], v[32:35], v[116:119]
  ds_read_b64_tr_b16 v[68:69], v8 offset:12288
  v_mfma_f32_16x16x32_bf16 v[152:155], v[20:23], v[32:35], v[152:155]
  ds_read_b64_tr_b16 v[70:71], v8 offset:12800
  v_mfma_f32_16x16x32_bf16 v[188:191], v[24:27], v[32:35], v[188:191]
  ds_read_b64_tr_b16 v[72:73], v8 offset:20480
  v_mfma_f32_16x16x32_bf16 v[120:123], v[16:19], v[36:39], v[120:123]
  ds_read_b64_tr_b16 v[74:75], v8 offset:20992
  v_mfma_f32_16x16x32_bf16 v[156:159], v[20:23], v[36:39], v[156:159]
  ds_read_b128 v[80:83], v10 offset:2048
  v_mfma_f32_16x16x32_bf16 v[192:195], v[24:27], v[36:39], v[192:195]
  ds_read_b128 v[84:87], v10 offset:4096
  v_mfma_f32_16x16x32_bf16 v[124:127], v[16:19], v[40:43], v[124:127]
  ds_read_b128 v[88:91], v10 offset:6144
  v_mfma_f32_16x16x32_bf16 v[160:163], v[20:23], v[40:43], v[160:163]
  ds_read_b128 v[92:95], v10 offset:8192
  v_mfma_f32_16x16x32_bf16 v[196:199], v[24:27], v[40:43], v[196:199]
  ds_read_b128 v[96:99], v10 offset:10240
  v_mfma_f32_16x16x32_bf16 v[128:131], v[16:19], v[44:47], v[128:131]
  ds_read_b128 v[100:103], v10 offset:12288
  v_mfma_f32_16x16x32_bf16 v[164:167], v[20:23], v[44:47], v[164:167]
  ds_read_b128 v[104:107], v10 offset:14336
  v_mfma_f32_16x16x32_bf16 v[200:203], v[24:27], v[44:47], v[200:203]
  ds_read_b128 v[108:111], v10 offset:16384
  v_mfma_f32_16x16x32_bf16 v[132:135], v[16:19], v[48:51], v[132:135]
  v_add_u32 v8, s42, v8
  v_mfma_f32_16x16x32_bf16 v[168:171], v[20:23], v[48:51], v[168:171]
  v_add_u32 v9, s42, v9
  v_mfma_f32_16x16x32_bf16 v[204:207], v[24:27], v[48:51], v[204:207]
  v_add_u32 v10, s42, v10
  v_mfma_f32_16x16x32_bf16 v[136:139], v[16:19], v[52:55], v[136:139]
  v_mfma_f32_16x16x32_bf16 v[172:175], v[20:23], v[52:55], v[172:175]
  v_mfma_f32_16x16x32_bf16 v[208:211], v[24:27], v[52:55], v[208:211]
  v_mfma_f32_16x16x32_bf16 v[140:143], v[16:19], v[56:59], v[140:143]
  v_mfma_f32_16x16x32_bf16 v[176:179], v[20:23], v[56:59], v[176:179]
  v_mfma_f32_16x16x32_bf16 v[212:215], v[24:27], v[56:59], v[212:215]
  v_mfma_f32_16x16x32_bf16 v[144:147], v[16:19], v[60:63], v[144:147]
  v_mfma_f32_16x16x32_bf16 v[180:183], v[20:23], v[60:63], v[180:183]
  v_mfma_f32_16x16x32_bf16 v[216:219], v[24:27], v[60:63], v[216:219]
  s_waitcnt lgkmcnt(0)
  s_barrier
  v_mfma_f32_16x16x32_bf16 v[112:115], v[64:67], v[76:79], v[112:115]
  ds_read_b64_tr_b16 v[16:17], v8 offset:0
  v_mfma_f32_16x16x32_bf16 v[148:151], v[68:71], v[76:79], v[148:151]
  ds_read_b64_tr_b16 v[18:19], v8 offset:512
  v_mfma_f32_16x16x32_bf16 v[184:187], v[72:75], v[76:79], v[184:187]
  ds_read_b128 v[28:31], v9 offset:0
  v_mfma_f32_16x16x32_bf16 v[116:119], v[64:67], v[80:83], v[116:119]
  ds_read_b64_tr_b16 v[20:21], v8 offset:8192
  v_mfma_f32_16x16x32_bf16 v[152:155], v[68:71], v[80:83], v[152:155]
  ds_read_b64_tr_b16 v[22:23], v8 offset:8704
  v_mfma_f32_16x16x32_bf16 v[188:191], v[72:75], v[80:83], v[188:191]
  ds_read_b64_tr_b16 v[24:25], v8 offset:16384
  v_mfma_f32_16x16x32_bf16 v[120:123], v[64:67], v[84:87], v[120:123]
  ds_read_b64_tr_b16 v[26:27], v8 offset:16896
  v_mfma_f32_16x16x32_bf16 v[156:159], v[68:71], v[84:87], v[156:159]
  ds_read_b128 v[32:35], v9 offset:2048
  v_mfma_f32_16x16x32_bf16 v[192:195], v[72:75], v[84:87], v[192:195]
  ds_read_b128 v[36:39], v9 offset:4096
  v_mfma_f32_16x16x32_bf16 v[124:127], v[64:67], v[88:91], v[124:127]
  ds_read_b128 v[40:43], v9 offset:6144
  v_mfma_f32_16x16x32_bf16 v[160:163], v[68:71], v[88:91], v[160:163]
  ds_read_b128 v[44:47], v9 offset:8192
  v_mfma_f32_16x16x32_bf16 v[196:199], v[72:75], v[88:91], v[196:199]
  ds_read_b128 v[48:51], v9 offset:10240
  v_mfma_f32_16x16x32_bf16 v[128:131], v[64:67], v[92:95], v[128:131]
  ds_read_b128 v[52:55], v9 offset:12288
  v_mfma_f32_16x16x32_bf16 v[164:167], v[68:71], v[92:95], v[164:167]
  ds_read_b128 v[56:59], v9 offset:14336
  v_mfma_f32_16x16x32_bf16 v[200:203], v[72:75], v[92:95], v[200:203]
  ds_read_b128 v[60:63], v9 offset:16384
  v_mfma_f32_16x16x32_bf16 v[132:135], v[64:67], v[96:99], v[132:135]
  s_add_u32 s32, s43, 43008
  v_mfma_f32_16x16x32_bf16 v[168:171], v[68:71], v[96:99], v[168:171]
  s_cmp_eq_u32 s32, 129024
  v_mfma_f32_16x16x32_bf16 v[204:207], v[72:75], v[96:99], v[204:207]
  s_cselect_b32 s32, 0, s32
  v_mfma_f32_16x16x32_bf16 v[136:139], v[64:67], v[100:103], v[136:139]
  s_sub_u32 s42, s32, s43
  v_mfma_f32_16x16x32_bf16 v[172:175], v[68:71], v[100:103], v[172:175]
  s_mov_b32 s43, s32
  v_mfma_f32_16x16x32_bf16 v[208:211], v[72:75], v[100:103], v[208:211]
  v_mfma_f32_16x16x32_bf16 v[140:143], v[64:67], v[104:107], v[140:143]
  v_mfma_f32_16x16x32_bf16 v[176:179], v[68:71], v[104:107], v[176:179]
  v_mfma_f32_16x16x32_bf16 v[212:215], v[72:75], v[104:107], v[212:215]
  v_mfma_f32_16x16x32_bf16 v[144:147], v[64:67], v[108:111], v[144:147]
  v_mfma_f32_16x16x32_bf16 v[180:183], v[68:71], v[108:111], v[180:183]
  v_mfma_f32_16x16x32_bf16 v[216:219], v[72:75], v[108:111], v[216:219]
  s_sub_u32 s39, s39, 1
  s_cmp_lg_u32 s39, 0
  s_cbranch_scc1 k1_cloop
  s_waitcnt lgkmcnt(0)
  v_mfma_f32_16x16x32_bf16 v[112:115], v[16:19], v[28:31], v[112:115]
  ds_read_b64_tr_b16 v[64:65], v8 offset:4096
  v_mfma_f32_16x16x32_bf16 v[148:151], v[20:23], v[28:31], v[148:151]
  ds_read_b64_tr_b16 v[66:67], v8 offset:4608
  v_mfma_f32_16x16x32_bf16 v[184:187], v[24:27], v[28:31], v[184:187]
  ds_read_b128 v[76:79], v10 offset:0
  v_mfma_f32_16x16x32_bf16 v[116:119], v[16:19], v[32:35], v[116:119]
  ds_read_b64_tr_b16 v[68:69], v8 offset:12288
  v_mfma_f32_16x16x32_bf16 v[152:155], v[20:23], v[32:35], v[152:155]
  ds_read_b64_tr_b16 v[70:71], v8 offset:12800
  v_mfma_f32_16x16x32_bf16 v[188:191], v[24:27], v[32:35], v[188:191]
  ds_read_b64_tr_b16 v[72:73], v8 offset:20480
  v_mfma_f32_16x16x32_bf16 v[120:123], v[16:19], v[36:39], v[120:123]
  ds_read_b64_tr_b16 v[74:75], v8 offset:20992
  v_mfma_f32_16x16x32_bf16 v[156:159], v[20:23], v[36:39], v[156:159]
  ds_read_b128 v[80:83], v10 offset:2048
  v_mfma_f32_16x16x32_bf16 v[192:195], v[24:27], v[36:39], v[192:195]
  ds_read_b128 v[84:87], v10 offset:4096
  v_mfma_f32_16x16x32_bf16 v[124:127], v[16:19], v[40:43], v[124:127]
  ds_read_b128 v[88:91], v10 offset:6144
  v_mfma_f32_16x16x32_bf16 v[160:163], v[20:23], v[40:43], v[160:163]
  ds_read_b128 v[92:95], v10 offset:8192
  v_mfma_f32_16x16x32_bf16 v[196:199], v[24:27], v[40:43], v[196:199]
  ds_read_b128 v[96:99], v10 offset:10240
  v_mfma_f32_16x16x32_bf16 v[128:131], v[16:19], v[44:47], v[128:131]
  ds_read_b128 v[100:103], v10 offset:12288
  v_mfma_f32_16x16x32_bf16 v[164:167], v[20:23], v[44:47], v[164:167]
  ds_read_b128 v[104:107], v10 offset:14336
  v_mfma_f32_16x16x32_bf16 v[200:203], v[24:27], v[44:47], v[200:203]
  ds_read_b128 v[108:111], v10 offset:16384
  v_mfma_f32_16x16x32_bf16 v[132:135], v[16:19], v[48:51], v[132:135]
  v_mfma_f32_16x16x32_bf16 v[168:171], v[20:23], v[48:51], v[168:171]
  v_mfma_f32_16x16x32_bf16 v[204:207], v[24:27], v[48:51], v[204:207]
  v_mfma_f32_16x16x32_bf16 v[136:139], v[16:19], v[52:55], v[136:139]
  v_mfma_f32_16x16x32_bf16 v[172:175], v[20:23], v[52:55], v[172:175]
  v_mfma_f32_16x16x32_bf16 v[208:211], v[24:27], v[52:55], v[208:211]
  v_mfma_f32_16x16x32_bf16 v[140:143], v[16:19], v[56:59], v[140:143]
  v_mfma_f32_16x16x32_bf16 v[176:179], v[20:23], v[56:59], v[176:179]
  v_mfma_f32_16x16x32_bf16 v[212:215], v[24:27], v[56:59], v[212:215]
  v_mfma_f32_16x16x32_bf16 v[144:147], v[16:19], v[60:63], v[144:147]
  v_mfma_f32_16x16x32_bf16 v[180:183], v[20:23], v[60:63], v[180:183]
  v_mfma_f32_16x16x32_bf16 v[216:219], v[24:27], v[60:63], v[216:219]
  s_waitcnt lgkmcnt(0)
  v_mfma_f32_16x16x32_bf16 v[112:115], v[64:67], v[76:79], v[112:115]
  v_mfma_f32_16x16x32_bf16 v[148:151], v[68:71], v[76:79], v[148:151]
  v_mfma_f32_16x16x32_bf16 v[184:187], v[72:75], v[76:79], v[184:187]
  v_mfma_f32_16x16x32_bf16 v[116:119], v[64:67], v[80:83], v[116:119]
  v_mfma_f32_16x16x32_bf16 v[152:155], v[68:71], v[80:83], v[152:155]
  v_mfma_f32_16x16x32_bf16 v[188:191], v[72:75], v[80:83], v[188:191]
  v_mfma_f32_16x16x32_bf16 v[120:123], v[64:67], v[84:87], v[120:123]
  v_mfma_f32_16x16x32_bf16 v[156:159], v[68:71], v[84:87], v[156:159]
  v_mfma_f32_16x16x32_bf16 v[192:195], v[72:75], v[84:87], v[192:195]
  v_mfma_f32_16x16x32_bf16 v[124:127], v[64:67], v[88:91], v[124:127]
  v_mfma_f32_16x16x32_bf16 v[160:163], v[68:71], v[88:91], v[160:163]
  v_mfma_f32_16x16x32_bf16 v[196:199], v[72:75], v[88:91], v[196:199]
  v_mfma_f32_16x16x32_bf16 v[128:131], v[64:67], v[92:95], v[128:131]
  v_mfma_f32_16x16x32_bf16 v[164:167], v[68:71], v[92:95], v[164:167]
  v_mfma_f32_16x16x32_bf16 v[200:203], v[72:75], v[92:95], v[200:203]
  v_mfma_f32_16x16x32_bf16 v[132:135], v[64:67], v[96:99], v[132:135]
  v_mfma_f32_16x16x32_bf16 v[168:171], v[68:71], v[96:99], v[168:171]
  v_mfma_f32_16x16x32_bf16 v[204:207], v[72:75], v[96:99], v[204:207]
  v_mfma_f32_16x16x32_bf16 v[136:139], v[64:67], v[100:103], v[136:139]
  v_mfma_f32_16x16x32_bf16 v[172:175], v[68:71], v[100:103], v[172:175]
  v_mfma_f32_16x16x32_bf16 v[208:211], v[72:75], v[100:103], v[208:211]
  v_mfma_f32_16x16x32_bf16 v[140:143], v[64:67], v[104:107], v[140:143]
  v_mfma_f32_16x16x32_bf16 v[176:179], v[68:71], v[104:107], v[176:179]
  v_mfma_f32_16x16x32_bf16 v[212:215], v[72:75], v[104:107], v[212:215]
  v_mfma_f32_16x16x32_bf16 v[144:147], v[64:67], v[108:111], v[144:147]
  v_mfma_f32_16x16x32_bf16 v[180:183], v[68:71], v[108:111], v[180:183]
  v_mfma_f32_16x16x32_bf16 v[216:219], v[72:75], v[108:111], v[216:219]
  v_mov_b32_dpp v16, v112 row_newbcast:0 row_mask:0xf bank_mask:0xf
  v_mov_b32_dpp v17, v113 row_newbcast:0 row_mask:0xf bank_mask:0xf
  v_mov_b32_dpp v18, v114 row_newbcast:0 row_mask:0xf bank_mask:0xf
  v_mov_b32_dpp v19, v115 row_newbcast:0 row_mask:0xf bank_mask:0xf
  v_mov_b32_dpp v20, v148 row_newbcast:0 row_mask:0xf bank_mask:0xf
  v_mov_b32_dpp v21, v149 row_newbcast:0 row_mask:0xf bank_mask:0xf
  v_mov_b32_dpp v22, v150 row_newbcast:0 row_mask:0xf bank_mask:0xf
  v_mov_b32_dpp v23, v151 row_newbcast:0 row_mask:0xf bank_mask:0xf
  v_mov_b32_dpp v24, v184 row_newbcast:0 row_mask:0xf bank_mask:0xf
  v_mov_b32_dpp v25, v185 row_newbcast:0 row_mask:0xf bank_mask:0xf
  v_mov_b32_dpp v26, v186 row_newbcast:0 row_mask:0xf bank_mask:0xf
  v_mov_b32_dpp v27, v187 row_newbcast:0 row_mask:0xf bank_mask:0xf
  s_barrier
  ds_read_b64 v[32:33], v12 offset:0
  ds_read_b64 v[34:35], v12 offset:128
  ds_read_b64 v[36:37], v12 offset:256
  ds_read_b64 v[38:39], v12 offset:384
  ds_read_b64 v[40:41], v12 offset:512
  ds_read_b64 v[42:43], v12 offset:640
  ds_read_b64 v[44:45], v12 offset:768
  ds_read_b64 v[46:47], v12 offset:896
  ds_read_b64 v[48:49], v12 offset:1024
  s_waitcnt lgkmcnt(0)
  v_pk_fma_f32 v[148:149], v[20:21], v[32:33], v[148:149] op_sel_hi:[1,0,1] neg_lo:[0,1,0] neg_hi:[0,1,0]
  v_pk_fma_f32 v[150:151], v[22:23], v[32:33], v[150:151] op_sel_hi:[1,0,1] neg_lo:[0,1,0] neg_hi:[0,1,0]
  v_pk_mul_f32 v[148:149], v[148:149], v[32:33] op_sel:[0,1] op_sel_hi:[1,1]
  v_pk_mul_f32 v[150:151], v[150:151], v[32:33] op_sel:[0,1] op_sel_hi:[1,1]
  v_cvt_pk_bf16_f32 v52, v148, v149
  v_cvt_pk_bf16_f32 v53, v150, v151
  ds_write_b64 v11, v[52:53] offset:128
  v_pk_fma_f32 v[184:185], v[24:25], v[32:33], v[184:185] op_sel_hi:[1,0,1] neg_lo:[0,1,0] neg_hi:[0,1,0]
  v_pk_fma_f32 v[186:187], v[26:27], v[32:33], v[186:187] op_sel_hi:[1,0,1] neg_lo:[0,1,0] neg_hi:[0,1,0]
  v_pk_mul_f32 v[184:185], v[184:185], v[32:33] op_sel:[0,1] op_sel_hi:[1,1]
  v_pk_mul_f32 v[186:187], v[186:187], v[32:33] op_sel:[0,1] op_sel_hi:[1,1]
  v_cvt_pk_bf16_f32 v54, v184, v185
  v_cvt_pk_bf16_f32 v55, v186, v187
  ds_write_b64 v11, v[54:55] offset:256
  v_pk_fma_f32 v[116:117], v[16:17], v[34:35], v[116:117] op_sel_hi:[1,0,1] neg_lo:[0,1,0] neg_hi:[0,1,0]
  v_pk_fma_f32 v[118:119], v[18:19], v[34:35], v[118:119] op_sel_hi:[1,0,1] neg_lo:[0,1,0] neg_hi:[0,1,0]
  v_pk_mul_f32 v[116:117], v[116:117], v[34:35] op_sel:[0,1] op_sel_hi:[1,1]
  v_pk_mul_f32 v[118:119], v[118:119], v[34:35] op_sel:[0,1] op_sel_hi:[1,1]
  v_cvt_pk_bf16_f32 v56, v116, v117
  v_cvt_pk_bf16_f32 v57, v118, v119
  ds_write_b64 v11, v[56:57] offset:3200
  v_pk_fma_f32 v[152:153], v[20:21], v[34:35], v[152:153] op_sel_hi:[1,0,1] neg_lo:[0,1,0] neg_hi:[0,1,0]
  v_pk_fma_f32 v[154:155], v[22:23], v[34:35], v[154:155] op_sel_hi:[1,0,1] neg_lo:[0,1,0] neg_hi:[0,1,0]
  v_pk_mul_f32 v[152:153], v[152:153], v[34:35] op_sel:[0,1] op_sel_hi:[1,1]
  v_pk_mul_f32 v[154:155], v[154:155], v[34:35] op_sel:[0,1] op_sel_hi:[1,1]
  v_cvt_pk_bf16_f32 v58, v152, v153
  v_cvt_pk_bf16_f32 v59, v154, v155
  ds_write_b64 v11, v[58:59] offset:3328
  v_pk_fma_f32 v[188:189], v[24:25], v[34:35], v[188:189] op_sel_hi:[1,0,1] neg_lo:[0,1,0] neg_hi:[0,1,0]
  v_pk_fma_f32 v[190:191], v[26:27], v[34:35], v[190:191] op_sel_hi:[1,0,1] neg_lo:[0,1,0] neg_hi:[0,1,0]
  v_pk_mul_f32 v[188:189], v[188:189], v[34:35] op_sel:[0,1] op_sel_hi:[1,1]
  v_pk_mul_f32 v[190:191], v[190:191], v[34:35] op_sel:[0,1] op_sel_hi:[1,1]
  v_cvt_pk_bf16_f32 v60, v188, v189
  v_cvt_pk_bf16_f32 v61, v190, v191
  ds_write_b64 v11, v[60:61] offset:3456
  v_pk_fma_f32 v[120:121], v[16:17], v[36:37], v[120:121] op_sel_hi:[1,0,1] neg_lo:[0,1,0] neg_hi:[0,1,0]
  v_pk_fma_f32 v[122:123], v[18:19], v[36:37], v[122:123] op_sel_hi:[1,0,1] neg_lo:[0,1,0] neg_hi:[0,1,0]
  v_pk_mul_f32 v[120:121], v[120:121], v[36:37] op_sel:[0,1] op_sel_hi:[1,1]
  v_pk_mul_f32 v[122:123], v[122:123], v[36:37] op_sel:[0,1] op_sel_hi:[1,1]
  v_cvt_pk_bf16_f32 v62, v120, v121
  v_cvt_pk_bf16_f32 v63, v122, v123
  ds_write_b64 v11, v[62:63] offset:6400
  v_pk_fma_f32 v[156:157], v[20:21], v[36:37], v[156:157] op_sel_hi:[1,0,1] neg_lo:[0,1,0] neg_hi:[0,1,0]
  v_pk_fma_f32 v[158:159], v[22:23], v[36:37], v[158:159] op_sel_hi:[1,0,1] neg_lo:[0,1,0] neg_hi:[0,1,0]
  v_pk_mul_f32 v[156:157], v[156:157], v[36:37] op_sel:[0,1] op_sel_hi:[1,1]
  v_pk_mul_f32 v[158:159], v[158:159], v[36:37] op_sel:[0,1] op_sel_hi:[1,1]
  v_cvt_pk_bf16_f32 v64, v156, v157
  v_cvt_pk_bf16_f32 v65, v158, v159
  ds_write_b64 v11, v[64:65] offset:6528
  v_pk_fma_f32 v[192:193], v[24:25], v[36:37], v[192:193] op_sel_hi:[1,0,1] neg_lo:[0,1,0] neg_hi:[0,1,0]
  v_pk_fma_f32 v[194:195], v[26:27], v[36:37], v[194:195] op_sel_hi:[1,0,1] neg_lo:[0,1,0] neg_hi:[0,1,0]
  v_pk_mul_f32 v[192:193], v[192:193], v[36:37] op_sel:[0,1] op_sel_hi:[1,1]
  v_pk_mul_f32 v[194:195], v[194:195], v[36:37] op_sel:[0,1] op_sel_hi:[1,1]
  v_cvt_pk_bf16_f32 v66, v192, v193
  v_cvt_pk_bf16_f32 v67, v194, v195
  ds_write_b64 v11, v[66:67] offset:6656
  v_pk_fma_f32 v[124:125], v[16:17], v[38:39], v[124:125] op_sel_hi:[1,0,1] neg_lo:[0,1,0] neg_hi:[0,1,0]
  v_pk_fma_f32 v[126:127], v[18:19], v[38:39], v[126:127] op_sel_hi:[1,0,1] neg_lo:[0,1,0] neg_hi:[0,1,0]
  v_pk_mul_f32 v[124:125], v[124:125], v[38:39] op_sel:[0,1] op_sel_hi:[1,1]
  v_pk_mul_f32 v[126:127], v[126:127], v[38:39] op_sel:[0,1] op_sel_hi:[1,1]
  v_cvt_pk_bf16_f32 v52, v124, v125
  v_cvt_pk_bf16_f32 v53, v126, v127
  ds_write_b64 v11, v[52:53] offset:9600
  v_pk_fma_f32 v[160:161], v[20:21], v[38:39], v[160:161] op_sel_hi:[1,0,1] neg_lo:[0,1,0] neg_hi:[0,1,0]
  v_pk_fma_f32 v[162:163], v[22:23], v[38:39], v[162:163] op_sel_hi:[1,0,1] neg_lo:[0,1,0] neg_hi:[0,1,0]
  v_pk_mul_f32 v[160:161], v[160:161], v[38:39] op_sel:[0,1] op_sel_hi:[1,1]
  v_pk_mul_f32 v[162:163], v[162:163], v[38:39] op_sel:[0,1] op_sel_hi:[1,1]
  v_cvt_pk_bf16_f32 v54, v160, v161
  v_cvt_pk_bf16_f32 v55, v162, v163
  ds_write_b64 v11, v[54:55] offset:9728
  v_pk_fma_f32 v[196:197], v[24:25], v[38:39], v[196:197] op_sel_hi:[1,0,1] neg_lo:[0,1,0] neg_hi:[0,1,0]
  v_pk_fma_f32 v[198:199], v[26:27], v[38:39], v[198:199] op_sel_hi:[1,0,1] neg_lo:[0,1,0] neg_hi:[0,1,0]
  v_pk_mul_f32 v[196:197], v[196:197], v[38:39] op_sel:[0,1] op_sel_hi:[1,1]
  v_pk_mul_f32 v[198:199], v[198:199], v[38:39] op_sel:[0,1] op_sel_hi:[1,1]
  v_cvt_pk_bf16_f32 v56, v196, v197
  v_cvt_pk_bf16_f32 v57, v198, v199
  ds_write_b64 v11, v[56:57] offset:9856
  v_pk_fma_f32 v[128:129], v[16:17], v[40:41], v[128:129] op_sel_hi:[1,0,1] neg_lo:[0,1,0] neg_hi:[0,1,0]
  v_pk_fma_f32 v[130:131], v[18:19], v[40:41], v[130:131] op_sel_hi:[1,0,1] neg_lo:[0,1,0] neg_hi:[0,1,0]
  v_pk_mul_f32 v[128:129], v[128:129], v[40:41] op_sel:[0,1] op_sel_hi:[1,1]
  v_pk_mul_f32 v[130:131], v[130:131], v[40:41] op_sel:[0,1] op_sel_hi:[1,1]
  v_cvt_pk_bf16_f32 v58, v128, v129
  v_cvt_pk_bf16_f32 v59, v130, v131
  ds_write_b64 v11, v[58:59] offset:12800
  v_pk_fma_f32 v[164:165], v[20:21], v[40:41], v[164:165] op_sel_hi:[1,0,1] neg_lo:[0,1,0] neg_hi:[0,1,0]
  v_pk_fma_f32 v[166:167], v[22:23], v[40:41], v[166:167] op_sel_hi:[1,0,1] neg_lo:[0,1,0] neg_hi:[0,1,0]
  v_pk_mul_f32 v[164:165], v[164:165], v[40:41] op_sel:[0,1] op_sel_hi:[1,1]
  v_pk_mul_f32 v[166:167], v[166:167], v[40:41] op_sel:[0,1] op_sel_hi:[1,1]
  v_cvt_pk_bf16_f32 v60, v164, v165
  v_cvt_pk_bf16_f32 v61, v166, v167
  ds_write_b64 v11, v[60:61] offset:12928
  v_pk_fma_f32 v[200:201], v[24:25], v[40:41], v[200:201] op_sel_hi:[1,0,1] neg_lo:[0,1,0] neg_hi:[0,1,0]
  v_pk_fma_f32 v[202:203], v[26:27], v[40:41], v[202:203] op_sel_hi:[1,0,1] neg_lo:[0,1,0] neg_hi:[0,1,0]
  v_pk_mul_f32 v[200:201], v[200:201], v[40:41] op_sel:[0,1] op_sel_hi:[1,1]
  v_pk_mul_f32 v[202:203], v[202:203], v[40:41] op_sel:[0,1] op_sel_hi:[1,1]
  v_cvt_pk_bf16_f32 v62, v200, v201
  v_cvt_pk_bf16_f32 v63, v202, v203
  ds_write_b64 v11, v[62:63] offset:13056
  v_pk_fma_f32 v[132:133], v[16:17], v[42:43], v[132:133] op_sel_hi:[1,0,1] neg_lo:[0,1,0] neg_hi:[0,1,0]
  v_pk_fma_f32 v[134:135], v[18:19], v[42:43], v[134:135] op_sel_hi:[1,0,1] neg_lo:[0,1,0] neg_hi:[0,1,0]
  v_pk_mul_f32 v[132:133], v[132:133], v[42:43] op_sel:[0,1] op_sel_hi:[1,1]
  v_pk_mul_f32 v[134:135], v[134:135], v[42:43] op_sel:[0,1] op_sel_hi:[1,1]
  v_cvt_pk_bf16_f32 v64, v132, v133
  v_cvt_pk_bf16_f32 v65, v134, v135
  ds_write_b64 v11, v[64:65] offset:16000
  v_pk_fma_f32 v[168:169], v[20:21], v[42:43], v[168:169] op_sel_hi:[1,0,1] neg_lo:[0,1,0] neg_hi:[0,1,0]
  v_pk_fma_f32 v[170:171], v[22:23], v[42:43], v[170:171] op_sel_hi:[1,0,1] neg_lo:[0,1,0] neg_hi:[0,1,0]
  v_pk_mul_f32 v[168:169], v[168:169], v[42:43] op_sel:[0,1] op_sel_hi:[1,1]
  v_pk_mul_f32 v[170:171], v[170:171], v[42:43] op_sel:[0,1] op_sel_hi:[1,1]
  v_cvt_pk_bf16_f32 v66, v168, v169
  v_cvt_pk_bf16_f32 v67, v170, v171
  ds_write_b64 v11, v[66:67] offset:16128
  v_pk_fma_f32 v[204:205], v[24:25], v[42:43], v[204:205] op_sel_hi:[1,0,1] neg_lo:[0,1,0] neg_hi:[0,1,0]
  v_pk_fma_f32 v[206:207], v[26:27], v[42:43], v[206:207] op_sel_hi:[1,0,1] neg_lo:[0,1,0] neg_hi:[0,1,0]
  v_pk_mul_f32 v[204:205], v[204:205], v[42:43] op_sel:[0,1] op_sel_hi:[1,1]
  v_pk_mul_f32 v[206:207], v[206:207], v[42:43] op_sel:[0,1] op_sel_hi:[1,1]
  v_cvt_pk_bf16_f32 v52, v204, v205
  v_cvt_pk_bf16_f32 v53, v206, v207
  ds_write_b64 v11, v[52:53] offset:16256
  v_pk_fma_f32 v[136:137], v[16:17], v[44:45], v[136:137] op_sel_hi:[1,0,1] neg_lo:[0,1,0] neg_hi:[0,1,0]
  v_pk_fma_f32 v[138:139], v[18:19], v[44:45], v[138:139] op_sel_hi:[1,0,1] neg_lo:[0,1,0] neg_hi:[0,1,0]
  v_pk_mul_f32 v[136:137], v[136:137], v[44:45] op_sel:[0,1] op_sel_hi:[1,1]
  v_pk_mul_f32 v[138:139], v[138:139], v[44:45] op_sel:[0,1] op_sel_hi:[1,1]
  v_cvt_pk_bf16_f32 v54, v136, v137
  v_cvt_pk_bf16_f32 v55, v138, v139
  ds_write_b64 v11, v[54:55] offset:19200
  v_pk_fma_f32 v[172:173], v[20:21], v[44:45], v[172:173] op_sel_hi:[1,0,1] neg_lo:[0,1,0] neg_hi:[0,1,0]
  v_pk_fma_f32 v[174:175], v[22:23], v[44:45], v[174:175] op_sel_hi:[1,0,1] neg_lo:[0,1,0] neg_hi:[0,1,0]
  v_pk_mul_f32 v[172:173], v[172:173], v[44:45] op_sel:[0,1] op_sel_hi:[1,1]
  v_pk_mul_f32 v[174:175], v[174:175], v[44:45] op_sel:[0,1] op_sel_hi:[1,1]
  v_cvt_pk_bf16_f32 v56, v172, v173
  v_cvt_pk_bf16_f32 v57, v174, v175
  ds_write_b64 v11, v[56:57] offset:19328
  v_pk_fma_f32 v[208:209], v[24:25], v[44:45], v[208:209] op_sel_hi:[1,0,1] neg_lo:[0,1,0] neg_hi:[0,1,0]
  v_pk_fma_f32 v[210:211], v[26:27], v[44:45], v[210:211] op_sel_hi:[1,0,1] neg_lo:[0,1,0] neg_hi:[0,1,0]
  v_pk_mul_f32 v[208:209], v[208:209], v[44:45] op_sel:[0,1] op_sel_hi:[1,1]
  v_pk_mul_f32 v[210:211], v[210:211], v[44:45] op_sel:[0,1] op_sel_hi:[1,1]
  v_cvt_pk_bf16_f32 v58, v208, v209
  v_cvt_pk_bf16_f32 v59, v210, v211
  ds_write_b64 v11, v[58:59] offset:19456
  v_pk_fma_f32 v[140:141], v[16:17], v[46:47], v[140:141] op_sel_hi:[1,0,1] neg_lo:[0,1,0] neg_hi:[0,1,0]
  v_pk_fma_f32 v[142:143], v[18:19], v[46:47], v[142:143] op_sel_hi:[1,0,1] neg_lo:[0,1,0] neg_hi:[0,1,0]
  v_pk_mul_f32 v[140:141], v[140:141], v[46:47] op_sel:[0,1] op_sel_hi:[1,1]
  v_pk_mul_f32 v[142:143], v[142:143], v[46:47] op_sel:[0,1] op_sel_hi:[1,1]
  v_cvt_pk_bf16_f32 v60, v140, v141
  v_cvt_pk_bf16_f32 v61, v142, v143
  ds_write_b64 v11, v[60:61] offset:22400
  v_pk_fma_f32 v[176:177], v[20:21], v[46:47], v[176:177] op_sel_hi:[1,0,1] neg_lo:[0,1,0] neg_hi:[0,1,0]
  v_pk_fma_f32 v[178:179], v[22:23], v[46:47], v[178:179] op_sel_hi:[1,0,1] neg_lo:[0,1,0] neg_hi:[0,1,0]
  v_pk_mul_f32 v[176:177], v[176:177], v[46:47] op_sel:[0,1] op_sel_hi:[1,1]
  v_pk_mul_f32 v[178:179], v[178:179], v[46:47] op_sel:[0,1] op_sel_hi:[1,1]
  v_cvt_pk_bf16_f32 v62, v176, v177
  v_cvt_pk_bf16_f32 v63, v178, v179
  ds_write_b64 v11, v[62:63] offset:22528
  v_pk_fma_f32 v[212:213], v[24:25], v[46:47], v[212:213] op_sel_hi:[1,0,1] neg_lo:[0,1,0] neg_hi:[0,1,0]
  v_pk_fma_f32 v[214:215], v[26:27], v[46:47], v[214:215] op_sel_hi:[1,0,1] neg_lo:[0,1,0] neg_hi:[0,1,0]
  v_pk_mul_f32 v[212:213], v[212:213], v[46:47] op_sel:[0,1] op_sel_hi:[1,1]
  v_pk_mul_f32 v[214:215], v[214:215], v[46:47] op_sel:[0,1] op_sel_hi:[1,1]
  v_cvt_pk_bf16_f32 v64, v212, v213
  v_cvt_pk_bf16_f32 v65, v214, v215
  ds_write_b64 v11, v[64:65] offset:22656
  v_pk_fma_f32 v[144:145], v[16:17], v[48:49], v[144:145] op_sel_hi:[1,0,1] neg_lo:[0,1,0] neg_hi:[0,1,0]
  v_pk_fma_f32 v[146:147], v[18:19], v[48:49], v[146:147] op_sel_hi:[1,0,1] neg_lo:[0,1,0] neg_hi:[0,1,0]
  v_pk_mul_f32 v[144:145], v[144:145], v[48:49] op_sel:[0,1] op_sel_hi:[1,1]
  v_pk_mul_f32 v[146:147], v[146:147], v[48:49] op_sel:[0,1] op_sel_hi:[1,1]
  v_cvt_pk_bf16_f32 v66, v144, v145
  v_cvt_pk_bf16_f32 v67, v146, v147
  ds_write_b64 v11, v[66:67] offset:25600
  v_pk_fma_f32 v[180:181], v[20:21], v[48:49], v[180:181] op_sel_hi:[1,0,1] neg_lo:[0,1,0] neg_hi:[0,1,0]
  v_pk_fma_f32 v[182:183], v[22:23], v[48:49], v[182:183] op_sel_hi:[1,0,1] neg_lo:[0,1,0] neg_hi:[0,1,0]
  v_pk_mul_f32 v[180:181], v[180:181], v[48:49] op_sel:[0,1] op_sel_hi:[1,1]
  v_pk_mul_f32 v[182:183], v[182:183], v[48:49] op_sel:[0,1] op_sel_hi:[1,1]
  v_cvt_pk_bf16_f32 v52, v180, v181
  v_cvt_pk_bf16_f32 v53, v182, v183
  ds_write_b64 v11, v[52:53] offset:25728
  v_pk_fma_f32 v[216:217], v[24:25], v[48:49], v[216:217] op_sel_hi:[1,0,1] neg_lo:[0,1,0] neg_hi:[0,1,0]
  v_pk_fma_f32 v[218:219], v[26:27], v[48:49], v[218:219] op_sel_hi:[1,0,1] neg_lo:[0,1,0] neg_hi:[0,1,0]
  v_pk_mul_f32 v[216:217], v[216:217], v[48:49] op_sel:[0,1] op_sel_hi:[1,1]
  v_pk_mul_f32 v[218:219], v[218:219], v[48:49] op_sel:[0,1] op_sel_hi:[1,1]
  v_cvt_pk_bf16_f32 v54, v216, v217
  v_cvt_pk_bf16_f32 v55, v218, v219
  ds_write_b64 v11, v[54:55] offset:25856
  s_waitcnt lgkmcnt(0)
  s_branch k1_attn
k1_loader:
  s_nop 7
  s_nop 7
  s_sub_u32 s41, s4, 4
  v_mov_b32 v16, 0x3f803f80
  v_mov_b32 v17, v16
  v_mov_b32 v18, v16
  v_mov_b32 v19, v16
  v_lshlrev_b32 v20, 4, v0
  v_add_u32 v21, 86016, v20
  s_cmp_lg_u32 s41, 0
  s_cbranch_scc1 k1_noones
  s_mov_b64 exec, 0xff
  ds_write_b128 v20, v[16:19]
  ds_write_b128 v20, v[16:19] offset:43008
  ds_write_b128 v21, v[16:19]
  s_mov_b64 exec, -1
k1_noones:
  s_lshl_b32 s32, s41, 5
  s_add_u32 s32, s32, 16
  v_lshrrev_b32 v2, 3, v0
  v_add_u32 v2, s32, v2
  v_bfe_u32 v3, v2, 1, 3
  v_and_b32 v4, 7, v0
  v_xor_b32 v3, v3, v4
  v_lshlrev_b32 v3, 4, v3
  s_lshl_b32 s40, s28, 7
  s_sub_u32 s40, s40, 16
  v_add_u32 v2, s40, v2
  v_max_i32 v2, 0, v2
  v_lshlrev_b32 v2, 11, v2
  v_add_u32 v8, v2, v3
  s_lshl_b32 s32, s41, 5
  s_add_u32 s32, s32, 24
  v_lshrrev_b32 v2, 3, v0
  v_add_u32 v2, s32, v2
  v_bfe_u32 v3, v2, 1, 3
  v_and_b32 v4, 7, v0
  v_xor_b32 v3, v3, v4
  v_lshlrev_b32 v3, 4, v3
  s_lshl_b32 s40, s28, 7
  s_sub_u32 s40, s40, 16
  v_add_u32 v2, s40, v2
  v_max_i32 v2, 0, v2
  v_lshlrev_b32 v2, 11, v2
  v_add_u32 v9, v2, v3
  v_subrev_u32 v9, 1024, v9
  s_lshl_b32 s32, s41, 5
  s_add_u32 s32, s32, 32
  v_lshrrev_b32 v2, 3, v0
  v_add_u32 v2, s32, v2
  v_bfe_u32 v3, v2, 1, 3
  v_and_b32 v4, 7, v0
  v_xor_b32 v3, v3, v4
  v_lshlrev_b32 v3, 4, v3
  s_lshl_b32 s40, s28, 7
  s_sub_u32 s40, s40, 16
  v_add_u32 v2, s40, v2
  v_max_i32 v2, 0, v2
  v_lshlrev_b32 v2, 11, v2
  v_add_u32 v10, v2, v3
  v_subrev_u32 v10, 2048, v10
  s_lshl_b32 s32, s41, 5
  s_add_u32 s32, s32, 40
  v_lshrrev_b32 v2, 3, v0
  v_add_u32 v2, s32, v2
  v_bfe_u32 v3, v2, 1, 3
  v_and_b32 v4, 7, v0
  v_xor_b32 v3, v3, v4
  v_lshlrev_b32 v3, 4, v3
  s_lshl_b32 s40, s28, 7
  s_sub_u32 s40, s40, 16
  v_add_u32 v2, s40, v2
  v_max_i32 v2, 0, v2
  v_lshlrev_b32 v2, 11, v2
  v_add_u32 v11, v2, v3
  v_subrev_u32 v11, 3072, v11
  s_lshl_b32 s32, s41, 3
  v_lshrrev_b32 v2, 3, v0
  v_add_u32 v2, s32, v2
  v_bfe_u32 v3, v2, 1, 3
  v_and_b32 v4, 7, v0
  v_xor_b32 v3, v3, v4
  v_lshlrev_b32 v3, 4, v3
  s_lshl_b32 s40, s28, 7
  s_sub_u32 s40, s40, 16
  v_add_u32 v2, s40, v2
  v_max_i32 v2, 0, v2
  v_lshlrev_b32 v2, 11, v2
  v_add_u32 v12, v2, v3
  s_mul_i32 s32, s41, 16
  s_add_u32 s32, s32, 0
  v_lshrrev_b32 v2, 3, v0
  v_add_u32 v2, s32, v2
  v_bfe_u32 v3, v2, 1, 1
  v_bfe_u32 v4, v2, 3, 1
  v_lshl_or_b32 v3, v4, 1, v3
  v_lshlrev_b32 v3, 1, v3
  v_and_b32 v4, 7, v0
  v_xor_b32 v3, v3, v4
  v_lshlrev_b32 v3, 4, v3
  s_mov_b32 s32, 6144
  v_mul_lo_u32 v2, v2, s32
  v_add_u32 v13, v2, v3
  s_mul_i32 s32, s41, 16
  s_add_u32 s32, s32, 8
  v_lshrrev_b32 v2, 3, v0
  v_add_u32 v2, s32, v2
  v_bfe_u32 v3, v2, 1, 1
  v_bfe_u32 v4, v2, 3, 1
  v_lshl_or_b32 v3, v4, 1, v3
  v_lshlrev_b32 v3, 1, v3
  v_and_b32 v4, 7, v0
  v_xor_b32 v3, v3, v4
  v_lshlrev_b32 v3, 4, v3
  s_mov_b32 s32, 6144
  v_mul_lo_u32 v2, v2, s32
  v_add_u32 v14, v2, v3
  v_subrev_u32 v14, 1024, v14
  v_add_u32 v15, 2048, v13
  v_add_u32 v16, 2048, v14
  v_add_u32 v17, 4096, v13
  v_add_u32 v18, 4096, v14
  s_lshl_b32 s44, s41, 12
  s_add_u32 s44, s44, 2048
  s_lshl_b32 s45, s41, 10
  s_lshl_b32 s46, s41, 11
  s_add_u32 s46, s46, 18432
  s_add_u32 s47, s46, 8192
  s_add_u32 s48, s46, 16384
  s_mov_b32 s34, 0
  s_lshl_b32 s35, s29, 7
  v_lshrrev_b32 v2, 1, v0
  s_lshl_b32 s32, s41, 5
  s_add_u32 s32, s32, 16
  v_add_u32 v2, s32, v2
  v_bfe_u32 v3, v2, 1, 3
  v_and_b32 v4, 1, v0
  v_lshlrev_b32 v4, 2, v4
  v_xor_b32 v3, v3, v4
  v_lshlrev_b32 v3, 4, v3
  v_lshlrev_b32 v4, 7, v2
  v_add_u32 v20, v3, v4
  v_xor_b32 v21, 16, v20
  v_xor_b32 v22, 32, v20
  v_xor_b32 v23, 48, v20
  v_lshlrev_b32 v25, 3, v2
  v_add_u32 v25, 129024, v25
  s_and_b32 s32, s41, 1
  s_lshl_b32 s32, s32, 10
  v_lshlrev_b32 v24, 4, v0
  v_add_u32 v24, s32, v24
  v_lshrrev_b32 v26, 7, v24
  v_lshlrev_b32 v26, 3, v26
  v_add_u32 v26, 129024, v26
  v_mov_b32 v28, 0
  v_mov_b32 v29, 0
  v_mov_b32 v30, 0
  v_mov_b32 v31, 0
  v_mov_b32 v27, 0x3f803f80
  s_mov_b32 s43, 0
  s_waitcnt lgkmcnt(0)
  s_cmp_eq_u32 s3, 0
  s_cselect_b32 s8, s64, s82
  s_cselect_b32 s9, s65, s83
  s_cselect_b32 s10, 0, 20971520
  s_add_u32 s8, s8, s10
  s_addc_u32 s9, s9, 0
  s_mov_b32 s10, 4194304
  s_mov_b32 s11, 0x20000
  s_mov_b32 s12, s66
  s_mov_b32 s13, s67
  s_mov_b32 s14, 6291456
  s_mov_b32 s15, 0x20000
  s_cmp_ge_u32 s41, 2
  s_cbranch_scc1 k1_ldB
  s_cmp_eq_u32 s41, 0
  s_cselect_b32 s52, 0xffffff00, -1
  s_mov_b32 s53, -1
  s_mov_b32 s30, 7
  s_mov_b32 s31, -2
  s_mov_b32 s38, 0
k1A_nk1:
  s_add_u32 s30, s30, 1
  s_and_b32 s30, s30, 7
  s_cselect_b32 s32, 0, 1
  s_add_u32 s31, s31, s32
  s_sub_u32 s32, s30, s7
  s_and_b32 s32, s32, 7
  s_cmp_lt_u32 s32, 2
  s_cselect_b32 s32, 1, 0
  s_add_u32 s32, s32, s31
  s_cmp_ge_u32 s32, 2
  s_cbranch_scc1 k1A_nk1
  s_lshl_b32 s33, s32, 3
  s_add_u32 s33, s33, s30
  s_mul_i32 s36, s33, 128
  s_add_u32 s36, s36, s34
  s_mul_i32 s37, s33, 393216
  s_add_u32 s37, s37, s35
  s_add_u32 m0, s38, s45
  s_mov_b64 exec, s[52:53]
  buffer_load_dwordx4 v12, s[8:11], s36 offen offset:0 lds
  s_mov_b64 exec, -1
  s_add_u32 m0, s38, s44
  s_nop 0
  buffer_load_dwordx4 v8, s[8:11], s36 offen offset:0 lds
  buffer_load_dwordx4 v9, s[8:11], s36 offen offset:1024 lds
  buffer_load_dwordx4 v10, s[8:11], s36 offen offset:2048 lds
  buffer_load_dwordx4 v11, s[8:11], s36 offen offset:3072 lds
  s_add_u32 m0, s38, s46
  s_nop 0
  buffer_load_dwordx4 v13, s[12:15], s37 offen offset:0 lds
  buffer_load_dwordx4 v14, s[12:15], s37 offen offset:1024 lds
  s_add_u32 m0, s38, s47
  s_nop 0
  buffer_load_dwordx4 v15, s[12:15], s37 offen offset:0 lds
  buffer_load_dwordx4 v16, s[12:15], s37 offen offset:1024 lds
  s_add_u32 m0, s38, s48
  s_nop 0
  buffer_load_dwordx4 v17, s[12:15], s37 offen offset:0 lds
  buffer_load_dwordx4 v18, s[12:15], s37 offen offset:1024 lds
  s_add_u32 s38, s38, 43008
  s_cmp_eq_u32 s38, 129024
  s_cselect_b32 s38, 0, s38
k1A_nk2:
  s_add_u32 s30, s30, 1
  s_and_b32 s30, s30, 7
  s_cselect_b32 s32, 0, 1
  s_add_u32 s31, s31, s32
  s_sub_u32 s32, s30, s7
  s_and_b32 s32, s32, 7
  s_cmp_lt_u32 s32, 2
  s_cselect_b32 s32, 1, 0
  s_add_u32 s32, s32, s31
  s_cmp_ge_u32 s32, 2
  s_cbranch_scc1 k1A_nk2
  s_lshl_b32 s33, s32, 3
  s_add_u32 s33, s33, s30
  s_mul_i32 s36, s33, 128
  s_add_u32 s36, s36, s34
  s_mul_i32 s37, s33, 393216
  s_add_u32 s37, s37, s35
  s_add_u32 m0, s38, s45
  s_mov_b64 exec, s[52:53]
  buffer_load_dwordx4 v12, s[8:11], s36 offen offset:0 lds
  s_mov_b64 exec, -1
  s_add_u32 m0, s38, s44
  s_nop 0
  buffer_load_dwordx4 v8, s[8:11], s36 offen offset:0 lds
  buffer_load_dwordx4 v9, s[8:11], s36 offen offset:1024 lds
  buffer_load_dwordx4 v10, s[8:11], s36 offen offset:2048 lds
  buffer_load_dwordx4 v11, s[8:11], s36 offen offset:3072 lds
  s_add_u32 m0, s38, s46
  s_nop 0
  buffer_load_dwordx4 v13, s[12:15], s37 offen offset:0 lds
  buffer_load_dwordx4 v14, s[12:15], s37 offen offset:1024 lds
  s_add_u32 m0, s38, s47
  s_nop 0
  buffer_load_dwordx4 v15, s[12:15], s37 offen offset:0 lds
  buffer_load_dwordx4 v16, s[12:15], s37 offen offset:1024 lds
  s_add_u32 m0, s38, s48
  s_nop 0
  buffer_load_dwordx4 v17, s[12:15], s37 offen offset:0 lds
  buffer_load_dwordx4 v18, s[12:15], s37 offen offset:1024 lds
  s_add_u32 s38, s38, 43008
  s_cmp_eq_u32 s38, 129024
  s_cselect_b32 s38, 0, s38
  s_mov_b32 s39, 14
k1A_lloop:
  s_waitcnt vmcnt(11)
  s_barrier
k1A_nk3:
  s_add_u32 s30, s30, 1
  s_and_b32 s30, s30, 7
  s_cselect_b32 s32, 0, 1
  s_add_u32 s31, s31, s32
  s_sub_u32 s32, s30, s7
  s_and_b32 s32, s32, 7
  s_cmp_lt_u32 s32, 2
  s_cselect_b32 s32, 1, 0
  s_add_u32 s32, s32, s31
  s_cmp_ge_u32 s32, 2
  s_cbranch_scc1 k1A_nk3
  s_lshl_b32 s33, s32, 3
  s_add_u32 s33, s33, s30
  s_mul_i32 s36, s33, 128
  s_add_u32 s36, s36, s34
  s_mul_i32 s37, s33, 393216
  s_add_u32 s37, s37, s35
  s_add_u32 m0, s38, s45
  s_mov_b64 exec, s[52:53]
  buffer_load_dwordx4 v12, s[8:11], s36 offen offset:0 lds
  s_mov_b64 exec, -1
  s_add_u32 m0, s38, s44
  s_nop 0
  buffer_load_dwordx4 v8, s[8:11], s36 offen offset:0 lds
  buffer_load_dwordx4 v9, s[8:11], s36 offen offset:1024 lds
  buffer_load_dwordx4 v10, s[8:11], s36 offen offset:2048 lds
  buffer_load_dwordx4 v11, s[8:11], s36 offen offset:3072 lds
  s_add_u32 m0, s38, s46
  s_nop 0
  buffer_load_dwordx4 v13, s[12:15], s37 offen offset:0 lds
  buffer_load_dwordx4 v14, s[12:15], s37 offen offset:1024 lds
  s_add_u32 m0, s38, s47
  s_nop 0
  buffer_load_dwordx4 v15, s[12:15], s37 offen offset:0 lds
  buffer_load_dwordx4 v16, s[12:15], s37 offen offset:1024 lds
  s_add_u32 m0, s38, s48
  s_nop 0
  buffer_load_dwordx4 v17, s[12:15], s37 offen offset:0 lds
  buffer_load_dwordx4 v18, s[12:15], s37 offen offset:1024 lds
  s_add_u32 s38, s38, 43008
  s_cmp_eq_u32 s38, 129024
  s_cselect_b32 s38, 0, s38
  ds_read_b128 v[32:35], v20
  ds_read_b128 v[36:39], v21
  ds_read_b128 v[40:43], v22
  ds_read_b128 v[44:47], v23
  ds_read_b128 v[48:51], v24
  s_add_u32 s32, s43, 43008
  s_cmp_eq_u32 s32, 129024
  s_cselect_b32 s32, 0, s32
  s_sub_u32 s42, s32, s43
  s_mov_b32 s43, s32
  v_add_u32 v20, s42, v20
  v_add_u32 v21, s42, v21
  v_add_u32 v22, s42, v22
  v_add_u32 v23, s42, v23
  v_add_u32 v24, s42, v24
  s_waitcnt lgkmcnt(4)
  v_dot2c_f32_bf16 v28, v27, v32
  v_dot2c_f32_bf16 v29, v32, v32
  v_dot2c_f32_bf16 v28, v27, v33
  v_dot2c_f32_bf16 v29, v33, v33
  v_dot2c_f32_bf16 v28, v27, v34
  v_dot2c_f32_bf16 v29, v34, v34
  v_dot2c_f32_bf16 v28, v27, v35
  v_dot2c_f32_bf16 v29, v35, v35
  s_waitcnt lgkmcnt(3)
  v_dot2c_f32_bf16 v28, v27, v36
  v_dot2c_f32_bf16 v29, v36, v36
  v_dot2c_f32_bf16 v28, v27, v37
  v_dot2c_f32_bf16 v29, v37, v37
  v_dot2c_f32_bf16 v28, v27, v38
  v_dot2c_f32_bf16 v29, v38, v38
  v_dot2c_f32_bf16 v28, v27, v39
  v_dot2c_f32_bf16 v29, v39, v39
  s_waitcnt lgkmcnt(2)
  v_dot2c_f32_bf16 v28, v27, v40
  v_dot2c_f32_bf16 v29, v40, v40
  v_dot2c_f32_bf16 v28, v27, v41
  v_dot2c_f32_bf16 v29, v41, v41
  v_dot2c_f32_bf16 v28, v27, v42
  v_dot2c_f32_bf16 v29, v42, v42
  v_dot2c_f32_bf16 v28, v27, v43
  v_dot2c_f32_bf16 v29, v43, v43
  s_waitcnt lgkmcnt(1)
  v_dot2c_f32_bf16 v28, v27, v44
  v_dot2c_f32_bf16 v29, v44, v44
  v_dot2c_f32_bf16 v28, v27, v45
  v_dot2c_f32_bf16 v29, v45, v45
  v_dot2c_f32_bf16 v28, v27, v46
  v_dot2c_f32_bf16 v29, v46, v46
  v_dot2c_f32_bf16 v28, v27, v47
  v_dot2c_f32_bf16 v29, v47, v47
  s_waitcnt lgkmcnt(0)
  v_dot2c_f32_bf16 v30, v27, v48
  v_dot2c_f32_bf16 v31, v48, v48
  v_dot2c_f32_bf16 v30, v27, v49
  v_dot2c_f32_bf16 v31, v49, v49
  v_dot2c_f32_bf16 v30, v27, v50
  v_dot2c_f32_bf16 v31, v50, v50
  v_dot2c_f32_bf16 v30, v27, v51
  v_dot2c_f32_bf16 v31, v51, v51
  s_sub_u32 s39, s39, 1
  s_cmp_lg_u32 s39, 0
  s_cbranch_scc1 k1A_lloop
  s_waitcnt vmcnt(11)
  s_barrier
  ds_read_b128 v[32:35], v20
  ds_read_b128 v[36:39], v21
  ds_read_b128 v[40:43], v22
  ds_read_b128 v[44:47], v23
  ds_read_b128 v[48:51], v24
  s_add_u32 s32, s43, 43008
  s_cmp_eq_u32 s32, 129024
  s_cselect_b32 s32, 0, s32
  s_sub_u32 s42, s32, s43
  s_mov_b32 s43, s32
  v_add_u32 v20, s42, v20
  v_add_u32 v21, s42, v21
  v_add_u32 v22, s42, v22
  v_add_u32 v23, s42, v23
  v_add_u32 v24, s42, v24
  s_waitcnt lgkmcnt(4)
  v_dot2c_f32_bf16 v28, v27, v32
  v_dot2c_f32_bf16 v29, v32, v32
  v_dot2c_f32_bf16 v28, v27, v33
  v_dot2c_f32_bf16 v29, v33, v33
  v_dot2c_f32_bf16 v28, v27, v34
  v_dot2c_f32_bf16 v29, v34, v34
  v_dot2c_f32_bf16 v28, v27, v35
  v_dot2c_f32_bf16 v29, v35, v35
  s_waitcnt lgkmcnt(3)
  v_dot2c_f32_bf16 v28, v27, v36
  v_dot2c_f32_bf16 v29, v36, v36
  v_dot2c_f32_bf16 v28, v27, v37
  v_dot2c_f32_bf16 v29, v37, v37
  v_dot2c_f32_bf16 v28, v27, v38
  v_dot2c_f32_bf16 v29, v38, v38
  v_dot2c_f32_bf16 v28, v27, v39
  v_dot2c_f32_bf16 v29, v39, v39
  s_waitcnt lgkmcnt(2)
  v_dot2c_f32_bf16 v28, v27, v40
  v_dot2c_f32_bf16 v29, v40, v40
  v_dot2c_f32_bf16 v28, v27, v41
  v_dot2c_f32_bf16 v29, v41, v41
  v_dot2c_f32_bf16 v28, v27, v42
  v_dot2c_f32_bf16 v29, v42, v42
  v_dot2c_f32_bf16 v28, v27, v43
  v_dot2c_f32_bf16 v29, v43, v43
  s_waitcnt lgkmcnt(1)
  v_dot2c_f32_bf16 v28, v27, v44
  v_dot2c_f32_bf16 v29, v44, v44
  v_dot2c_f32_bf16 v28, v27, v45
  v_dot2c_f32_bf16 v29, v45, v45
  v_dot2c_f32_bf16 v28, v27, v46
  v_dot2c_f32_bf16 v29, v46, v46
  v_dot2c_f32_bf16 v28, v27, v47
  v_dot2c_f32_bf16 v29, v47, v47
  s_waitcnt lgkmcnt(0)
  v_dot2c_f32_bf16 v30, v27, v48
  v_dot2c_f32_bf16 v31, v48, v48
  v_dot2c_f32_bf16 v30, v27, v49
  v_dot2c_f32_bf16 v31, v49, v49
  v_dot2c_f32_bf16 v30, v27, v50
  v_dot2c_f32_bf16 v31, v50, v50
  v_dot2c_f32_bf16 v30, v27, v51
  v_dot2c_f32_bf16 v31, v51, v51
  s_waitcnt vmcnt(0)
  s_barrier
  ds_read_b128 v[32:35], v20
  ds_read_b128 v[36:39], v21
  ds_read_b128 v[40:43], v22
  ds_read_b128 v[44:47], v23
  ds_read_b128 v[48:51], v24
  s_add_u32 s32, s43, 43008
  s_cmp_eq_u32 s32, 129024
  s_cselect_b32 s32, 0, s32
  s_sub_u32 s42, s32, s43
  s_mov_b32 s43, s32
  v_add_u32 v20, s42, v20
  v_add_u32 v21, s42, v21
  v_add_u32 v22, s42, v22
  v_add_u32 v23, s42, v23
  v_add_u32 v24, s42, v24
  s_waitcnt lgkmcnt(4)
  v_dot2c_f32_bf16 v28, v27, v32
  v_dot2c_f32_bf16 v29, v32, v32
  v_dot2c_f32_bf16 v28, v27, v33
  v_dot2c_f32_bf16 v29, v33, v33
  v_dot2c_f32_bf16 v28, v27, v34
  v_dot2c_f32_bf16 v29, v34, v34
  v_dot2c_f32_bf16 v28, v27, v35
  v_dot2c_f32_bf16 v29, v35, v35
  s_waitcnt lgkmcnt(3)
  v_dot2c_f32_bf16 v28, v27, v36
  v_dot2c_f32_bf16 v29, v36, v36
  v_dot2c_f32_bf16 v28, v27, v37
  v_dot2c_f32_bf16 v29, v37, v37
  v_dot2c_f32_bf16 v28, v27, v38
  v_dot2c_f32_bf16 v29, v38, v38
  v_dot2c_f32_bf16 v28, v27, v39
  v_dot2c_f32_bf16 v29, v39, v39
  s_waitcnt lgkmcnt(2)
  v_dot2c_f32_bf16 v28, v27, v40
  v_dot2c_f32_bf16 v29, v40, v40
  v_dot2c_f32_bf16 v28, v27, v41
  v_dot2c_f32_bf16 v29, v41, v41
  v_dot2c_f32_bf16 v28, v27, v42
  v_dot2c_f32_bf16 v29, v42, v42
  v_dot2c_f32_bf16 v28, v27, v43
  v_dot2c_f32_bf16 v29, v43, v43
  s_waitcnt lgkmcnt(1)
  v_dot2c_f32_bf16 v28, v27, v44
  v_dot2c_f32_bf16 v29, v44, v44
  v_dot2c_f32_bf16 v28, v27, v45
  v_dot2c_f32_bf16 v29, v45, v45
  v_dot2c_f32_bf16 v28, v27, v46
  v_dot2c_f32_bf16 v29, v46, v46
  v_dot2c_f32_bf16 v28, v27, v47
  v_dot2c_f32_bf16 v29, v47, v47
  s_waitcnt lgkmcnt(0)
  v_dot2c_f32_bf16 v30, v27, v48
  v_dot2c_f32_bf16 v31, v48, v48
  v_dot2c_f32_bf16 v30, v27, v49
  v_dot2c_f32_bf16 v31, v49, v49
  v_dot2c_f32_bf16 v30, v27, v50
  v_dot2c_f32_bf16 v31, v50, v50
  v_dot2c_f32_bf16 v30, v27, v51
  v_dot2c_f32_bf16 v31, v51, v51
  s_branch k1_ldone
k1_ldB:
  s_nop 7
  s_nop 7
  s_mov_b32 s30, 7
  s_mov_b32 s31, -2
  s_mov_b32 s38, 0
k1B_nk4:
  s_add_u32 s30, s30, 1
  s_and_b32 s30, s30, 7
  s_cselect_b32 s32, 0, 1
  s_add_u32 s31, s31, s32
  s_sub_u32 s32, s30, s7
  s_and_b32 s32, s32, 7
  s_cmp_lt_u32 s32, 2
  s_cselect_b32 s32, 1, 0
  s_add_u32 s32, s32, s31
  s_cmp_ge_u32 s32, 2
  s_cbranch_scc1 k1B_nk4
  s_lshl_b32 s33, s32, 3
  s_add_u32 s33, s33, s30
  s_mul_i32 s36, s33, 128
  s_add_u32 s36, s36, s34
  s_mul_i32 s37, s33, 393216
  s_add_u32 s37, s37, s35
  s_add_u32 m0, s38, s44
  s_nop 0
  buffer_load_dwordx4 v8, s[8:11], s36 offen offset:0 lds
  buffer_load_dwordx4 v9, s[8:11], s36 offen offset:1024 lds
  buffer_load_dwordx4 v10, s[8:11], s36 offen offset:2048 lds
  buffer_load_dwordx4 v11, s[8:11], s36 offen offset:3072 lds
  s_add_u32 m0, s38, s46
  s_nop 0
  buffer_load_dwordx4 v13, s[12:15], s37 offen offset:0 lds
  buffer_load_dwordx4 v14, s[12:15], s37 offen offset:1024 lds
  s_add_u32 m0, s38, s47
  s_nop 0
  buffer_load_dwordx4 v15, s[12:15], s37 offen offset:0 lds
  buffer_load_dwordx4 v16, s[12:15], s37 offen offset:1024 lds
  s_add_u32 m0, s38, s48
  s_nop 0
  buffer_load_dwordx4 v17, s[12:15], s37 offen offset:0 lds
  buffer_load_dwordx4 v18, s[12:15], s37 offen offset:1024 lds
  s_add_u32 s38, s38, 43008
  s_cmp_eq_u32 s38, 129024
  s_cselect_b32 s38, 0, s38
k1B_nk5:
  s_add_u32 s30, s30, 1
  s_and_b32 s30, s30, 7
  s_cselect_b32 s32, 0, 1
  s_add_u32 s31, s31, s32
  s_sub_u32 s32, s30, s7
  s_and_b32 s32, s32, 7
  s_cmp_lt_u32 s32, 2
  s_cselect_b32 s32, 1, 0
  s_add_u32 s32, s32, s31
  s_cmp_ge_u32 s32, 2
  s_cbranch_scc1 k1B_nk5
  s_lshl_b32 s33, s32, 3
  s_add_u32 s33, s33, s30
  s_mul_i32 s36, s33, 128
  s_add_u32 s36, s36, s34
  s_mul_i32 s37, s33, 393216
  s_add_u32 s37, s37, s35
  s_add_u32 m0, s38, s44
  s_nop 0
  buffer_load_dwordx4 v8, s[8:11], s36 offen offset:0 lds
  buffer_load_dwordx4 v9, s[8:11], s36 offen offset:1024 lds
  buffer_load_dwordx4 v10, s[8:11], s36 offen offset:2048 lds
  buffer_load_dwordx4 v11, s[8:11], s36 offen offset:3072 lds
  s_add_u32 m0, s38, s46
  s_nop 0
  buffer_load_dwordx4 v13, s[12:15], s37 offen offset:0 lds
  buffer_load_dwordx4 v14, s[12:15], s37 offen offset:1024 lds
  s_add_u32 m0, s38, s47
  s_nop 0
  buffer_load_dwordx4 v15, s[12:15], s37 offen offset:0 lds
  buffer_load_dwordx4 v16, s[12:15], s37 offen offset:1024 lds
  s_add_u32 m0, s38, s48
  s_nop 0
  buffer_load_dwordx4 v17, s[12:15], s37 offen offset:0 lds
  buffer_load_dwordx4 v18, s[12:15], s37 offen offset:1024 lds
  s_add_u32 s38, s38, 43008
  s_cmp_eq_u32 s38, 129024
  s_cselect_b32 s38, 0, s38
  s_mov_b32 s39, 14
k1B_lloop:
  s_waitcnt vmcnt(10)
  s_barrier
k1B_nk6:
  s_add_u32 s30, s30, 1
  s_and_b32 s30, s30, 7
  s_cselect_b32 s32, 0, 1
  s_add_u32 s31, s31, s32
  s_sub_u32 s32, s30, s7
  s_and_b32 s32, s32, 7
  s_cmp_lt_u32 s32, 2
  s_cselect_b32 s32, 1, 0
  s_add_u32 s32, s32, s31
  s_cmp_ge_u32 s32, 2
  s_cbranch_scc1 k1B_nk6
  s_lshl_b32 s33, s32, 3
  s_add_u32 s33, s33, s30
  s_mul_i32 s36, s33, 128
  s_add_u32 s36, s36, s34
  s_mul_i32 s37, s33, 393216
  s_add_u32 s37, s37, s35
  s_add_u32 m0, s38, s44
  s_nop 0
  buffer_load_dwordx4 v8, s[8:11], s36 offen offset:0 lds
  buffer_load_dwordx4 v9, s[8:11], s36 offen offset:1024 lds
  buffer_load_dwordx4 v10, s[8:11], s36 offen offset:2048 lds
  buffer_load_dwordx4 v11, s[8:11], s36 offen offset:3072 lds
  s_add_u32 m0, s38, s46
  s_nop 0
  buffer_load_dwordx4 v13, s[12:15], s37 offen offset:0 lds
  buffer_load_dwordx4 v14, s[12:15], s37 offen offset:1024 lds
  s_add_u32 m0, s38, s47
  s_nop 0
  buffer_load_dwordx4 v15, s[12:15], s37 offen offset:0 lds
  buffer_load_dwordx4 v16, s[12:15], s37 offen offset:1024 lds
  s_add_u32 m0, s38, s48
  s_nop 0
  buffer_load_dwordx4 v17, s[12:15], s37 offen offset:0 lds
  buffer_load_dwordx4 v18, s[12:15], s37 offen offset:1024 lds
  s_add_u32 s38, s38, 43008
  s_cmp_eq_u32 s38, 129024
  s_cselect_b32 s38, 0, s38
  ds_read_b128 v[32:35], v20
  ds_read_b128 v[36:39], v21
  ds_read_b128 v[40:43], v22
  ds_read_b128 v[44:47], v23
  ds_read_b128 v[48:51], v24
  s_add_u32 s32, s43, 43008
  s_cmp_eq_u32 s32, 129024
  s_cselect_b32 s32, 0, s32
  s_sub_u32 s42, s32, s43
  s_mov_b32 s43, s32
  v_add_u32 v20, s42, v20
  v_add_u32 v21, s42, v21
  v_add_u32 v22, s42, v22
  v_add_u32 v23, s42, v23
  v_add_u32 v24, s42, v24
  s_waitcnt lgkmcnt(4)
  v_dot2c_f32_bf16 v28, v27, v32
  v_dot2c_f32_bf16 v29, v32, v32
  v_dot2c_f32_bf16 v28, v27, v33
  v_dot2c_f32_bf16 v29, v33, v33
  v_dot2c_f32_bf16 v28, v27, v34
  v_dot2c_f32_bf16 v29, v34, v34
  v_dot2c_f32_bf16 v28, v27, v35
  v_dot2c_f32_bf16 v29, v35, v35
  s_waitcnt lgkmcnt(3)
  v_dot2c_f32_bf16 v28, v27, v36
  v_dot2c_f32_bf16 v29, v36, v36
  v_dot2c_f32_bf16 v28, v27, v37
  v_dot2c_f32_bf16 v29, v37, v37
  v_dot2c_f32_bf16 v28, v27, v38
  v_dot2c_f32_bf16 v29, v38, v38
  v_dot2c_f32_bf16 v28, v27, v39
  v_dot2c_f32_bf16 v29, v39, v39
  s_waitcnt lgkmcnt(2)
  v_dot2c_f32_bf16 v28, v27, v40
  v_dot2c_f32_bf16 v29, v40, v40
  v_dot2c_f32_bf16 v28, v27, v41
  v_dot2c_f32_bf16 v29, v41, v41
  v_dot2c_f32_bf16 v28, v27, v42
  v_dot2c_f32_bf16 v29, v42, v42
  v_dot2c_f32_bf16 v28, v27, v43
  v_dot2c_f32_bf16 v29, v43, v43
  s_waitcnt lgkmcnt(1)
  v_dot2c_f32_bf16 v28, v27, v44
  v_dot2c_f32_bf16 v29, v44, v44
  v_dot2c_f32_bf16 v28, v27, v45
  v_dot2c_f32_bf16 v29, v45, v45
  v_dot2c_f32_bf16 v28, v27, v46
  v_dot2c_f32_bf16 v29, v46, v46
  v_dot2c_f32_bf16 v28, v27, v47
  v_dot2c_f32_bf16 v29, v47, v47
  s_waitcnt lgkmcnt(0)
  v_dot2c_f32_bf16 v30, v27, v48
  v_dot2c_f32_bf16 v31, v48, v48
  v_dot2c_f32_bf16 v30, v27, v49
  v_dot2c_f32_bf16 v31, v49, v49
  v_dot2c_f32_bf16 v30, v27, v50
  v_dot2c_f32_bf16 v31, v50, v50
  v_dot2c_f32_bf16 v30, v27, v51
  v_dot2c_f32_bf16 v31, v51, v51
  s_sub_u32 s39, s39, 1
  s_cmp_lg_u32 s39, 0
  s_cbranch_scc1 k1B_lloop
  s_waitcnt vmcnt(10)
  s_barrier
  ds_read_b128 v[32:35], v20
  ds_read_b128 v[36:39], v21
  ds_read_b128 v[40:43], v22
  ds_read_b128 v[44:47], v23
  ds_read_b128 v[48:51], v24
  s_add_u32 s32, s43, 43008
  s_cmp_eq_u32 s32, 129024
  s_cselect_b32 s32, 0, s32
  s_sub_u32 s42, s32, s43
  s_mov_b32 s43, s32
  v_add_u32 v20, s42, v20
  v_add_u32 v21, s42, v21
  v_add_u32 v22, s42, v22
  v_add_u32 v23, s42, v23
  v_add_u32 v24, s42, v24
  s_waitcnt lgkmcnt(4)
  v_dot2c_f32_bf16 v28, v27, v32
  v_dot2c_f32_bf16 v29, v32, v32
  v_dot2c_f32_bf16 v28, v27, v33
  v_dot2c_f32_bf16 v29, v33, v33
  v_dot2c_f32_bf16 v28, v27, v34
  v_dot2c_f32_bf16 v29, v34, v34
  v_dot2c_f32_bf16 v28, v27, v35
  v_dot2c_f32_bf16 v29, v35, v35
  s_waitcnt lgkmcnt(3)
  v_dot2c_f32_bf16 v28, v27, v36
  v_dot2c_f32_bf16 v29, v36, v36
  v_dot2c_f32_bf16 v28, v27, v37
  v_dot2c_f32_bf16 v29, v37, v37
  v_dot2c_f32_bf16 v28, v27, v38
  v_dot2c_f32_bf16 v29, v38, v38
  v_dot2c_f32_bf16 v28, v27, v39
  v_dot2c_f32_bf16 v29, v39, v39
  s_waitcnt lgkmcnt(2)
  v_dot2c_f32_bf16 v28, v27, v40
  v_dot2c_f32_bf16 v29, v40, v40
  v_dot2c_f32_bf16 v28, v27, v41
  v_dot2c_f32_bf16 v29, v41, v41
  v_dot2c_f32_bf16 v28, v27, v42
  v_dot2c_f32_bf16 v29, v42, v42
  v_dot2c_f32_bf16 v28, v27, v43
  v_dot2c_f32_bf16 v29, v43, v43
  s_waitcnt lgkmcnt(1)
  v_dot2c_f32_bf16 v28, v27, v44
  v_dot2c_f32_bf16 v29, v44, v44
  v_dot2c_f32_bf16 v28, v27, v45
  v_dot2c_f32_bf16 v29, v45, v45
  v_dot2c_f32_bf16 v28, v27, v46
  v_dot2c_f32_bf16 v29, v46, v46
  v_dot2c_f32_bf16 v28, v27, v47
  v_dot2c_f32_bf16 v29, v47, v47
  s_waitcnt lgkmcnt(0)
  v_dot2c_f32_bf16 v30, v27, v48
  v_dot2c_f32_bf16 v31, v48, v48
  v_dot2c_f32_bf16 v30, v27, v49
  v_dot2c_f32_bf16 v31, v49, v49
  v_dot2c_f32_bf16 v30, v27, v50
  v_dot2c_f32_bf16 v31, v50, v50
  v_dot2c_f32_bf16 v30, v27, v51
  v_dot2c_f32_bf16 v31, v51, v51
  s_waitcnt vmcnt(0)
  s_barrier
  ds_read_b128 v[32:35], v20
  ds_read_b128 v[36:39], v21
  ds_read_b128 v[40:43], v22
  ds_read_b128 v[44:47], v23
  ds_read_b128 v[48:51], v24
  s_add_u32 s32, s43, 43008
  s_cmp_eq_u32 s32, 129024
  s_cselect_b32 s32, 0, s32
  s_sub_u32 s42, s32, s43
  s_mov_b32 s43, s32
  v_add_u32 v20, s42, v20
  v_add_u32 v21, s42, v21
  v_add_u32 v22, s42, v22
  v_add_u32 v23, s42, v23
  v_add_u32 v24, s42, v24
  s_waitcnt lgkmcnt(4)
  v_dot2c_f32_bf16 v28, v27, v32
  v_dot2c_f32_bf16 v29, v32, v32
  v_dot2c_f32_bf16 v28, v27, v33
  v_dot2c_f32_bf16 v29, v33, v33
  v_dot2c_f32_bf16 v28, v27, v34
  v_dot2c_f32_bf16 v29, v34, v34
  v_dot2c_f32_bf16 v28, v27, v35
  v_dot2c_f32_bf16 v29, v35, v35
  s_waitcnt lgkmcnt(3)
  v_dot2c_f32_bf16 v28, v27, v36
  v_dot2c_f32_bf16 v29, v36, v36
  v_dot2c_f32_bf16 v28, v27, v37
  v_dot2c_f32_bf16 v29, v37, v37
  v_dot2c_f32_bf16 v28, v27, v38
  v_dot2c_f32_bf16 v29, v38, v38
  v_dot2c_f32_bf16 v28, v27, v39
  v_dot2c_f32_bf16 v29, v39, v39
  s_waitcnt lgkmcnt(2)
  v_dot2c_f32_bf16 v28, v27, v40
  v_dot2c_f32_bf16 v29, v40, v40
  v_dot2c_f32_bf16 v28, v27, v41
  v_dot2c_f32_bf16 v29, v41, v41
  v_dot2c_f32_bf16 v28, v27, v42
  v_dot2c_f32_bf16 v29, v42, v42
  v_dot2c_f32_bf16 v28, v27, v43
  v_dot2c_f32_bf16 v29, v43, v43
  s_waitcnt lgkmcnt(1)
  v_dot2c_f32_bf16 v28, v27, v44
  v_dot2c_f32_bf16 v29, v44, v44
  v_dot2c_f32_bf16 v28, v27, v45
  v_dot2c_f32_bf16 v29, v45, v45
  v_dot2c_f32_bf16 v28, v27, v46
  v_dot2c_f32_bf16 v29, v46, v46
  v_dot2c_f32_bf16 v28, v27, v47
  v_dot2c_f32_bf16 v29, v47, v47
  s_waitcnt lgkmcnt(0)
  v_dot2c_f32_bf16 v30, v27, v48
  v_dot2c_f32_bf16 v31, v48, v48
  v_dot2c_f32_bf16 v30, v27, v49
  v_dot2c_f32_bf16 v31, v49, v49
  v_dot2c_f32_bf16 v30, v27, v50
  v_dot2c_f32_bf16 v31, v50, v50
  v_dot2c_f32_bf16 v30, v27, v51
  v_dot2c_f32_bf16 v31, v51, v51
k1_ldone:
  s_nop 7
  s_nop 7
  v_add_f32_dpp v32, v28, v28 quad_perm:[1,0,3,2] row_mask:0xf bank_mask:0xf
  v_mov_b32 v28, v32
  v_add_f32_dpp v32, v29, v29 quad_perm:[1,0,3,2] row_mask:0xf bank_mask:0xf
  v_mov_b32 v29, v32
  v_add_f32_dpp v32, v30, v30 quad_perm:[1,0,3,2] row_mask:0xf bank_mask:0xf
  v_mov_b32 v30, v32
  s_nop 1
  v_add_f32_dpp v32, v30, v30 quad_perm:[2,3,0,1] row_mask:0xf bank_mask:0xf
  v_mov_b32 v30, v32
  s_nop 1
  v_add_f32_dpp v32, v30, v30 row_half_mirror row_mask:0xf bank_mask:0xf
  v_mov_b32 v30, v32
  v_add_f32_dpp v32, v31, v31 quad_perm:[1,0,3,2] row_mask:0xf bank_mask:0xf
  v_mov_b32 v31, v32
  s_nop 1
  v_add_f32_dpp v32, v31, v31 quad_perm:[2,3,0,1] row_mask:0xf bank_mask:0xf
  v_mov_b32 v31, v32
  s_nop 1
  v_add_f32_dpp v32, v31, v31 row_half_mirror row_mask:0xf bank_mask:0xf
  v_mov_b32 v31, v32
  v_mul_f32 v28, 0x3a800000, v28
  v_mul_f32 v29, 0x3a800000, v29
  v_fma_f32 v29, -v28, v28, v29
  v_max_f32 v29, 0, v29
  v_mov_b32 v32, v29
  v_cvt_pk_bf16_f32 v32, v32, v32
  v_lshlrev_b32 v32, 16, v32
  v_add_f32 v32, 0x3727c5ac, v32
  v_cvt_pk_bf16_f32 v32, v32, v32
  v_lshlrev_b32 v32, 16, v32
  v_sqrt_f32 v32, v32
  s_nop 0
  v_cvt_pk_bf16_f32 v32, v32, v32
  v_lshlrev_b32 v32, 16, v32
  v_rcp_f32 v32, v32
  v_cvt_pk_bf16_f32 v28, v28, v28
  v_lshlrev_b32 v28, 16, v28
  v_mov_b32 v29, v32
  v_mul_f32 v30, 0x3a800000, v30
  v_mul_f32 v31, 0x3a800000, v31
  v_fma_f32 v31, -v30, v30, v31
  v_max_f32 v31, 0, v31
  v_mov_b32 v32, v31
  v_cvt_pk_bf16_f32 v32, v32, v32
  v_lshlrev_b32 v32, 16, v32
  v_add_f32 v32, 0x3727c5ac, v32
  v_cvt_pk_bf16_f32 v32, v32, v32
  v_lshlrev_b32 v32, 16, v32
  v_sqrt_f32 v32, v32
  s_nop 0
  v_cvt_pk_bf16_f32 v32, v32, v32
  v_lshlrev_b32 v32, 16, v32
  v_rcp_f32 v32, v32
  v_cvt_pk_bf16_f32 v30, v30, v30
  v_lshlrev_b32 v30, 16, v30
  v_mov_b32 v31, v32
  ds_write_b64 v25, v[28:29]
  ds_write_b64 v26, v[30:31]
  s_waitcnt lgkmcnt(0)
  s_barrier
  v_and_b32 v2, 31, v0
  v_lshrrev_b32 v3, 5, v0
  v_and_b32 v4, 15, v0
  v_lshrrev_b32 v5, 4, v0
  v_lshrrev_b32 v6, 2, v4
  v_and_b32 v7, 3, v0
k1_attn:
  s_nop 7
  s_nop 7
  s_mov_b32 s20, s82
  s_mov_b32 s21, s83
  s_mov_b32 s22, 4194304
  s_mov_b32 s23, 0x20000
  s_lshr_b32 s40, s4, 1
  s_and_b32 s41, s4, 1
  s_mul_i32 s32, s41, 28800
  s_add_u32 s32, s32, 43008
  s_lshl_b32 s44, s40, 4
  v_add_u32 v16, s44, v4
  v_lshlrev_b32 v17, 4, v5
  v_add_u32 v17, s32, v17
  v_mul_u32_u24 v18, 400, v16
  v_add_u32 v8, v18, v17
  v_add_u32 v10, 3200, v8
  v_add_u32 v8, 128, v8
  v_add_u32 v16, 16, v16
  v_min_u32 v16, 71, v16
  v_mul_u32_u24 v18, 400, v16
  v_add3_u32 v9, v18, v17, 64
  v_add_u32 v9, 64, v9
  v_lshl_add_u32 v16, v5, 2, v6
  v_add_u32 v16, s44, v16
  v_lshlrev_b32 v17, 4, v7
  v_add_u32 v17, s32, v17
  v_add_u32 v17, 256, v17
  v_mul_u32_u24 v18, 400, v16
  v_add_u32 v11, v18, v17
  v_add_u32 v16, 16, v16
  v_min_u32 v16, 71, v16
  v_mul_u32_u24 v18, 400, v16
  v_add_u32 v12, v18, v17
  s_lshl_b32 s45, s40, 5
  s_add_u32 s45, s45, s41
  v_lshlrev_b32 v16, 1, v4
  v_add_u32 v16, s45, v16
  v_bfe_u32 v17, v16, 1, 3
  v_xor_b32 v17, v17, v5
  v_lshlrev_b32 v17, 4, v17
  v_lshlrev_b32 v16, 7, v16
  v_add_u32 v13, v16, v17
  v_xor_b32 v14, 64, v13
  s_lshl_b32 s46, s28, 4
  s_add_u32 s46, s46, s29
  s_lshl_b32 s46, s46, 14
  v_lshlrev_b32 v16, 2, v5
  v_sub_u32 v16, v16, v4
  s_or_b32 s47, s28, s40
  s_cmp_eq_u32 s47, 0
  s_cselect_b32 s48, 0, -1
  v_add_u32 v17, -1, v16
  v_cmp_gt_u32 s[52:53], 8, v17
  v_add_u32 v17, 0, v16
  v_cmp_gt_u32 s[54:55], 8, v17
  v_add_u32 v17, 1, v16
  v_cmp_gt_u32 s[56:57], 8, v17
  v_add_u32 v17, 2, v16
  v_cmp_gt_u32 s[58:59], 8, v17
  v_add_u32 v17, 15, v16
  v_cmp_gt_u32 s[60:61], 8, v17
  v_add_u32 v17, 16, v16
  v_cmp_gt_u32 s[62:63], 8, v17
  v_add_u32 v17, 17, v16
  v_cmp_gt_u32 s[64:65], 8, v17
  v_add_u32 v17, 18, v16
  v_cmp_gt_u32 s[66:67], 8, v17
  s_and_b32 s52, s52, s48
  s_and_b32 s54, s54, s48
  s_and_b32 s56, s56, s48
  s_and_b32 s58, s58, s48
  s_barrier
  v_mov_b32 v15, 0x3e8293ee
  v_mov_b32 v7, 0xff800000
  ds_read_b128 v[32:35], v10 offset:0
  ds_read_b128 v[36:39], v8 offset:0
  ds_read_b128 v[40:43], v9 offset:0
  ds_read_b64_tr_b16 v[44:45], v11 offset:0
  ds_read_b64_tr_b16 v[46:47], v12 offset:0
  ds_read_b64_tr_b16 v[48:49], v11 offset:8
  ds_read_b64_tr_b16 v[50:51], v12 offset:8
  ds_read_b128 v[80:83], v10 offset:64
  ds_read_b128 v[84:87], v8 offset:64
  ds_read_b128 v[88:91], v9 offset:64
  ds_read_b64_tr_b16 v[92:93], v11 offset:64
  ds_read_b64_tr_b16 v[94:95], v12 offset:64
  ds_read_b64_tr_b16 v[96:97], v11 offset:72
  ds_read_b64_tr_b16 v[98:99], v12 offset:72
  s_waitcnt lgkmcnt(11)
  v_mfma_f32_16x16x32_bf16 v[52:55], v[36:39], v[32:35], 0
  v_mfma_f32_16x16x32_bf16 v[56:59], v[40:43], v[32:35], 0
  s_waitcnt lgkmcnt(4)
  v_mfma_f32_16x16x32_bf16 v[100:103], v[84:87], v[80:83], 0
  v_mfma_f32_16x16x32_bf16 v[104:107], v[88:91], v[80:83], 0
  s_nop 3
  v_cndmask_b32 v52, v7, v52, s[52:53]
  s_nop 1
  v_cndmask_b32 v100, v7, v100, s[52:53]
  v_cndmask_b32 v53, v7, v53, s[54:55]
  v_cndmask_b32 v101, v7, v101, s[54:55]
  v_cndmask_b32 v54, v7, v54, s[56:57]
  v_cndmask_b32 v102, v7, v102, s[56:57]
  v_cndmask_b32 v55, v7, v55, s[58:59]
  v_cndmask_b32 v103, v7, v103, s[58:59]
  v_cndmask_b32 v56, v7, v56, s[60:61]
  v_cndmask_b32 v104, v7, v104, s[60:61]
  v_cndmask_b32 v57, v7, v57, s[62:63]
  v_cndmask_b32 v105, v7, v105, s[62:63]
  v_cndmask_b32 v58, v7, v58, s[64:65]
  v_cndmask_b32 v106, v7, v106, s[64:65]
  v_cndmask_b32 v59, v7, v59, s[66:67]
  v_cndmask_b32 v107, v7, v107, s[66:67]
  v_max3_f32 v60, v52, v53, v54
  v_max3_f32 v108, v100, v101, v102
  v_max3_f32 v61, v55, v56, v57
  v_max3_f32 v109, v103, v104, v105
  v_max3_f32 v60, v60, v58, v59
  v_max3_f32 v108, v108, v106, v107
  v_max_f32 v60, v60, v61
  v_max_f32 v108, v108, v109
  v_mov_b32 v61, v60
  v_mov_b32 v109, v108
  s_nop 0
  v_permlane16_swap_b32 v60, v61
  v_permlane16_swap_b32 v108, v109
  v_max_f32 v60, v60, v61
  v_max_f32 v108, v108, v109
  v_mov_b32 v61, v60
  v_mov_b32 v109, v108
  s_nop 0
  v_permlane32_swap_b32 v60, v61
  v_permlane32_swap_b32 v108, v109
  v_max_f32 v60, v60, v61
  v_max_f32 v108, v108, v109
  v_mul_f32 v60, v15, v60
  v_mul_f32 v108, v15, v108
  v_fma_f32 v52, v52, v15, -v60
  v_fma_f32 v100, v100, v15, -v108
  v_fma_f32 v53, v53, v15, -v60
  v_fma_f32 v101, v101, v15, -v108
  v_fma_f32 v54, v54, v15, -v60
  v_fma_f32 v102, v102, v15, -v108
  v_fma_f32 v55, v55, v15, -v60
  v_fma_f32 v103, v103, v15, -v108
  v_fma_f32 v56, v56, v15, -v60
  v_fma_f32 v104, v104, v15, -v108
  v_fma_f32 v57, v57, v15, -v60
  v_fma_f32 v105, v105, v15, -v108
  v_fma_f32 v58, v58, v15, -v60
  v_fma_f32 v106, v106, v15, -v108
  v_fma_f32 v59, v59, v15, -v60
  v_fma_f32 v107, v107, v15, -v108
  v_exp_f32 v52, v52
  v_exp_f32 v100, v100
  v_exp_f32 v53, v53
  v_exp_f32 v101, v101
  v_exp_f32 v54, v54
  v_exp_f32 v102, v102
  v_exp_f32 v55, v55
  v_exp_f32 v103, v103
  v_exp_f32 v56, v56
  v_exp_f32 v104, v104
  v_exp_f32 v57, v57
  v_exp_f32 v105, v105
  v_exp_f32 v58, v58
  v_exp_f32 v106, v106
  v_exp_f32 v59, v59
  v_exp_f32 v107, v107
  v_pk_add_f32 v[60:61], v[52:53], v[54:55]
  v_pk_add_f32 v[108:109], v[100:101], v[102:103]
  v_pk_add_f32 v[62:63], v[56:57], v[58:59]
  v_pk_add_f32 v[110:111], v[104:105], v[106:107]
  v_pk_add_f32 v[60:61], v[60:61], v[62:63]
  v_pk_add_f32 v[108:109], v[108:109], v[110:111]
  v_add_f32 v60, v60, v61
  v_add_f32 v108, v108, v109
  v_mov_b32 v61, v60
  v_mov_b32 v109, v108
  s_nop 0
  v_permlane16_swap_b32 v60, v61
  v_permlane16_swap_b32 v108, v109
  v_add_f32 v60, v60, v61
  v_add_f32 v108, v108, v109
  v_mov_b32 v61, v60
  v_mov_b32 v109, v108
  s_nop 0
  v_permlane32_swap_b32 v60, v61
  v_permlane32_swap_b32 v108, v109
  v_add_f32 v60, v60, v61
  v_add_f32 v108, v108, v109
  v_rcp_f32 v60, v60
  v_rcp_f32 v108, v108
  v_pk_mul_f32 v[52:53], v[52:53], v[60:61] op_sel_hi:[1,0]
  v_pk_mul_f32 v[100:101], v[100:101], v[108:109] op_sel_hi:[1,0]
  v_pk_mul_f32 v[54:55], v[54:55], v[60:61] op_sel_hi:[1,0]
  v_pk_mul_f32 v[102:103], v[102:103], v[108:109] op_sel_hi:[1,0]
  v_pk_mul_f32 v[56:57], v[56:57], v[60:61] op_sel_hi:[1,0]
  v_pk_mul_f32 v[104:105], v[104:105], v[108:109] op_sel_hi:[1,0]
  v_pk_mul_f32 v[58:59], v[58:59], v[60:61] op_sel_hi:[1,0]
  v_pk_mul_f32 v[106:107], v[106:107], v[108:109] op_sel_hi:[1,0]
  v_cvt_pk_bf16_f32 v64, v52, v53
  v_cvt_pk_bf16_f32 v112, v100, v101
  v_cvt_pk_bf16_f32 v65, v54, v55
  v_cvt_pk_bf16_f32 v113, v102, v103
  v_cvt_pk_bf16_f32 v66, v56, v57
  v_cvt_pk_bf16_f32 v114, v104, v105
  v_cvt_pk_bf16_f32 v67, v58, v59
  v_cvt_pk_bf16_f32 v115, v106, v107
  s_waitcnt lgkmcnt(0)
  v_mfma_f32_16x16x32_bf16 v[68:71], v[44:47], v[64:67], 0
  v_mfma_f32_16x16x32_bf16 v[116:119], v[92:95], v[112:115], 0
  v_mfma_f32_16x16x32_bf16 v[72:75], v[48:51], v[64:67], 0
  v_mfma_f32_16x16x32_bf16 v[120:123], v[96:99], v[112:115], 0
  s_nop 4
  v_cvt_pk_bf16_f32 v32, v68, v69
  v_cvt_pk_bf16_f32 v80, v116, v117
  v_cvt_pk_bf16_f32 v33, v70, v71
  v_cvt_pk_bf16_f32 v81, v118, v119
  v_cvt_pk_bf16_f32 v34, v72, v73
  v_cvt_pk_bf16_f32 v82, v120, v121
  v_cvt_pk_bf16_f32 v35, v74, v75
  v_cvt_pk_bf16_f32 v83, v122, v123
  buffer_store_dwordx4 v[32:35], v13, s[20:23], s46 offen
  buffer_store_dwordx4 v[80:83], v14, s[20:23], s46 offen
k1_end:
  s_endpgm
  s_nop 7
  s_nop 7
.p2align 8
k2a_kernel:
  s_mov_b32 s3, 0
  s_branch k2_body
.p2align 8
k2b_kernel:
  s_mov_b32 s3, 1
k2_body:
  s_cmp_ge_u32 s2, 256
  s_cbranch_scc1 k2_end
  s_load_dwordx16 s[64:79], s[0:1], 0
  s_load_dwordx2 s[80:81], s[0:1], 64
  s_load_dwordx2 s[82:83], s[0:1], 80
  v_lshrrev_b32 v1, 6, v0
  v_and_b32 v0, 63, v0
  v_readfirstlane_b32 s4, v1
  s_lshr_b32 s32, s2, 3
  s_lshr_b32 s5, s32, 3
  s_and_b32 s6, s32, 7
  s_lshl_b32 s7, s5, 1
  s_add_u32 s7, s7, s6
  s_and_b32 s7, s7, 7
  s_and_b32 s32, s2, 7
  s_lshr_b32 s28, s32, 1
  s_lshl_b32 s28, s28, 2
  s_add_u32 s28, s28, s5
  s_and_b32 s29, s32, 1
  s_mul_i32 s29, s29, 8
  s_add_u32 s29, s29, s6
  s_cmp_ge_u32 s4, 4
  s_cbranch_scc1 k2_loader
  v_and_b32 v2, 31, v0
  v_lshrrev_b32 v3, 5, v0
  v_and_b32 v4, 15, v0
  v_lshrrev_b32 v5, 4, v0
  v_lshrrev_b32 v6, 2, v4
  v_and_b32 v7, 3, v0
  s_and_b32 s40, s4, 1
  s_lshr_b32 s41, s4, 1
  s_lshl_b32 s32, s28, 7
  s_lshl_b32 s44, s41, 6
  s_add_u32 s32, s32, s44
  v_add_u32 v13, s32, v2
  v_lshlrev_b32 v14, 11, v13
  v_lshlrev_b32 v15, 4, v3
  v_add_u32 v14, v14, v15
  s_lshl_b32 s32, s29, 7
  s_lshl_b32 s44, s40, 6
  s_add_u32 s32, s32, s44
  v_add_u32 v14, s32, v14
  s_mov_b32 s47, 65536
  s_waitcnt lgkmcnt(0)
  s_cmp_eq_u32 s3, 0
  s_cselect_b32 s16, s64, s82
  s_cselect_b32 s17, s65, s83
  s_cselect_b32 s18, 0, 20971520
  s_add_u32 s16, s16, s18
  s_addc_u32 s17, s17, 0
  s_mov_b32 s18, 4194304
  s_mov_b32 s19, 0x20000
  s_add_u32 s20, s82, 4194304
  s_addc_u32 s21, s83, 0
  s_mov_b32 s22, 4194304
  s_mov_b32 s23, 0x20000
  s_add_u32 s24, s82, 8388608
  s_addc_u32 s25, s83, 0
  s_mov_b32 s26, 4194304
  s_mov_b32 s27, 0x20000
  buffer_load_dwordx4 v[96:99], v14, s[16:19], 0 offen offset:0
  buffer_load_dwordx4 v[100:103], v14, s[16:19], 0 offen offset:32
  buffer_load_dwordx4 v[104:107], v14, s[16:19], s47 offen offset:0
  buffer_load_dwordx4 v[108:111], v14, s[16:19], s47 offen offset:32
  s_lshl_b32 s32, s41, 6
  v_add_u32 v17, s32, v2
  v_bfe_u32 v18, v17, 1, 3
  v_xor_b32 v18, v18, v3
  v_lshlrev_b32 v18, 4, v18
  v_lshlrev_b32 v19, 7, v17
  v_add_u32 v18, v18, v19
  v_xor_b32 v8, 0, v18
  v_xor_b32 v9, 32, v18
  v_xor_b32 v10, 64, v18
  v_xor_b32 v11, 96, v18
  v_lshrrev_b32 v16, 1, v5
  v_lshlrev_b32 v16, 3, v16
  v_add_u32 v16, v16, v6
  v_lshlrev_b32 v16, 7, v16
  v_and_b32 v17, 1, v5
  v_lshlrev_b32 v17, 2, v17
  v_add_u32 v17, v17, v7
  v_and_b32 v19, 1, v17
  v_lshlrev_b32 v19, 1, v19
  v_and_b32 v18, 4, v17
  v_or_b32 v19, v19, v18
  v_bfe_u32 v18, v17, 1, 1
  v_or_b32 v18, v18, v19
  v_lshlrev_b32 v18, 3, v18
  s_lshl_b32 s32, s40, 6
  v_add_u32 v18, s32, v18
  v_lshrrev_b32 v19, 1, v6
  v_lshlrev_b32 v19, 6, v19
  v_xor_b32 v18, v18, v19
  v_add_u32 v12, v16, v18
  s_and_b32 s32, s29, 1
  s_lshl_b32 s32, s32, 3
  s_lshl_b32 s44, s40, 2
  s_add_u32 s32, s32, s44
  v_add_u32 v16, s32, v3
  v_lshlrev_b32 v17, 2, v7
  v_xor_b32 v16, v16, v17
  v_lshlrev_b32 v16, 4, v16
  v_lshlrev_b32 v17, 8, v2
  v_add_u32 v15, v16, v17
  s_lshr_b32 s32, s29, 1
  s_lshl_b32 s32, s32, 5
  s_lshl_b32 s44, s28, 1
  s_add_u32 s32, s32, s44
  s_add_u32 s32, s32, s41
  s_lshl_b32 s46, s32, 14
  s_add_u32 s48, s46, 8192
  s_lshl_b32 s32, s40, 7
  s_lshl_b32 s44, s41, 6
  s_add_u32 s32, s32, s44
  v_add_u32 v113, s32, v0
  v_lshlrev_b32 v113, 3, v113
  v_add_u32 v113, 147456, v113
  v_add_u32 v114, s44, v2
  v_lshlrev_b32 v114, 3, v114
  v_add_u32 v114, 149504, v114
  s_waitcnt vmcnt(0)
  v_lshlrev_b32 v64, 16, v96
  v_and_b32 v65, 0xffff0000, v96
  v_lshlrev_b32 v66, 16, v97
  v_and_b32 v67, 0xffff0000, v97
  v_lshlrev_b32 v68, 16, v98
  v_and_b32 v69, 0xffff0000, v98
  v_lshlrev_b32 v70, 16, v99
  v_and_b32 v71, 0xffff0000, v99
  v_lshlrev_b32 v72, 16, v100
  v_and_b32 v73, 0xffff0000, v100
  v_lshlrev_b32 v74, 16, v101
  v_and_b32 v75, 0xffff0000, v101
  v_lshlrev_b32 v76, 16, v102
  v_and_b32 v77, 0xffff0000, v102
  v_lshlrev_b32 v78, 16, v103
  v_and_b32 v79, 0xffff0000, v103
  v_lshlrev_b32 v80, 16, v104
  v_and_b32 v81, 0xffff0000, v104
  v_lshlrev_b32 v82, 16, v105
  v_and_b32 v83, 0xffff0000, v105
  v_lshlrev_b32 v84, 16, v106
  v_and_b32 v85, 0xffff0000, v106
  v_lshlrev_b32 v86, 16, v107
  v_and_b32 v87, 0xffff0000, v107
  v_lshlrev_b32 v88, 16, v108
  v_and_b32 v89, 0xffff0000, v108
  v_lshlrev_b32 v90, 16, v109
  v_and_b32 v91, 0xffff0000, v109
  v_lshlrev_b32 v92, 16, v110
  v_and_b32 v93, 0xffff0000, v110
  v_lshlrev_b32 v94, 16, v111
  v_and_b32 v95, 0xffff0000, v111
  s_mov_b32 s43, 0
  s_mov_b32 s39, 15
  s_barrier
  ds_read_b128 v[16:19], v8
  ds_read_b64_tr_b16 v[24:25], v12 offset:16384
  ds_read_b64_tr_b16 v[26:27], v12 offset:16896
  ds_read_b128 v[20:23], v8 offset:4096
  ds_read_b128 v[28:31], v9
  ds_read_b64_tr_b16 v[36:37], v12 offset:18432
  ds_read_b64_tr_b16 v[38:39], v12 offset:18944
  ds_read_b128 v[32:35], v9 offset:4096
  s_add_u32 s32, s43, 24576
  s_cmp_eq_u32 s32, 147456
  s_cselect_b32 s32, 0, s32
  s_sub_u32 s42, s32, s43
  s_mov_b32 s43, s32
k2_cloop:
  s_waitcnt lgkmcnt(0)
  v_mfma_f32_32x32x16_bf16 v[64:79], v[24:27], v[16:19], v[64:79]
  ds_read_b128 v[40:43], v10
  ds_read_b64_tr_b16 v[48:49], v12 offset:20480
  ds_read_b64_tr_b16 v[50:51], v12 offset:20992
  ds_read_b128 v[44:47], v10 offset:4096
  v_mfma_f32_32x32x16_bf16 v[80:95], v[24:27], v[20:23], v[80:95]
  ds_read_b128 v[52:55], v11
  ds_read_b64_tr_b16 v[60:61], v12 offset:22528
  ds_read_b64_tr_b16 v[62:63], v12 offset:23040
  ds_read_b128 v[56:59], v11 offset:4096
  v_mfma_f32_32x32x16_bf16 v[64:79], v[36:39], v[28:31], v[64:79]
  v_add_u32 v8, s42, v8
  v_add_u32 v9, s42, v9
  v_add_u32 v10, s42, v10
  v_add_u32 v11, s42, v11
  v_mfma_f32_32x32x16_bf16 v[80:95], v[36:39], v[32:35], v[80:95]
  v_add_u32 v12, s42, v12
  s_waitcnt lgkmcnt(0)
  s_barrier
  v_mfma_f32_32x32x16_bf16 v[64:79], v[48:51], v[40:43], v[64:79]
  ds_read_b128 v[16:19], v8
  ds_read_b64_tr_b16 v[24:25], v12 offset:16384
  ds_read_b64_tr_b16 v[26:27], v12 offset:16896
  ds_read_b128 v[20:23], v8 offset:4096
  v_mfma_f32_32x32x16_bf16 v[80:95], v[48:51], v[44:47], v[80:95]
  ds_read_b128 v[28:31], v9
  ds_read_b64_tr_b16 v[36:37], v12 offset:18432
  ds_read_b64_tr_b16 v[38:39], v12 offset:18944
  ds_read_b128 v[32:35], v9 offset:4096
  v_mfma_f32_32x32x16_bf16 v[64:79], v[60:63], v[52:55], v[64:79]
  s_add_u32 s32, s43, 24576
  s_cmp_eq_u32 s32, 147456
  s_cselect_b32 s32, 0, s32
  s_sub_u32 s42, s32, s43
  v_mfma_f32_32x32x16_bf16 v[80:95], v[60:63], v[56:59], v[80:95]
  s_mov_b32 s43, s32
  s_sub_u32 s39, s39, 1
  s_cmp_lg_u32 s39, 0
  s_cbranch_scc1 k2_cloop
  s_waitcnt lgkmcnt(0)
  v_mfma_f32_32x32x16_bf16 v[64:79], v[24:27], v[16:19], v[64:79]
  ds_read_b128 v[40:43], v10
  ds_read_b64_tr_b16 v[48:49], v12 offset:20480
  ds_read_b64_tr_b16 v[50:51], v12 offset:20992
  ds_read_b128 v[44:47], v10 offset:4096
  v_mfma_f32_32x32x16_bf16 v[80:95], v[24:27], v[20:23], v[80:95]
  ds_read_b128 v[52:55], v11
  ds_read_b64_tr_b16 v[60:61], v12 offset:22528
  ds_read_b64_tr_b16 v[62:63], v12 offset:23040
  ds_read_b128 v[56:59], v11 offset:4096
  v_mfma_f32_32x32x16_bf16 v[64:79], v[36:39], v[28:31], v[64:79]
  v_mfma_f32_32x32x16_bf16 v[80:95], v[36:39], v[32:35], v[80:95]
  s_waitcnt lgkmcnt(0)
  v_mfma_f32_32x32x16_bf16 v[64:79], v[48:51], v[40:43], v[64:79]
  v_mfma_f32_32x32x16_bf16 v[80:95], v[48:51], v[44:47], v[80:95]
  v_mfma_f32_32x32x16_bf16 v[64:79], v[60:63], v[52:55], v[64:79]
  v_mfma_f32_32x32x16_bf16 v[80:95], v[60:63], v[56:59], v[80:95]
  s_nop 10
  v_cvt_pk_bf16_f32 v96, v64, v65
  v_cvt_pk_bf16_f32 v97, v66, v67
  v_cvt_pk_bf16_f32 v98, v68, v69
  v_cvt_pk_bf16_f32 v99, v70, v71
  v_lshlrev_b32 v64, 16, v96
  v_and_b32 v65, 0xffff0000, v96
  v_lshlrev_b32 v66, 16, v97
  v_and_b32 v67, 0xffff0000, v97
  v_lshlrev_b32 v68, 16, v98
  v_and_b32 v69, 0xffff0000, v98
  v_lshlrev_b32 v70, 16, v99
  v_and_b32 v71, 0xffff0000, v99
  v_cvt_pk_bf16_f32 v100, v72, v73
  v_cvt_pk_bf16_f32 v101, v74, v75
  v_cvt_pk_bf16_f32 v102, v76, v77
  v_cvt_pk_bf16_f32 v103, v78, v79
  v_lshlrev_b32 v72, 16, v100
  v_and_b32 v73, 0xffff0000, v100
  v_lshlrev_b32 v74, 16, v101
  v_and_b32 v75, 0xffff0000, v101
  v_lshlrev_b32 v76, 16, v102
  v_and_b32 v77, 0xffff0000, v102
  v_lshlrev_b32 v78, 16, v103
  v_and_b32 v79, 0xffff0000, v103
  v_cvt_pk_bf16_f32 v104, v80, v81
  v_cvt_pk_bf16_f32 v105, v82, v83
  v_cvt_pk_bf16_f32 v106, v84, v85
  v_cvt_pk_bf16_f32 v107, v86, v87
  v_lshlrev_b32 v80, 16, v104
  v_and_b32 v81, 0xffff0000, v104
  v_lshlrev_b32 v82, 16, v105
  v_and_b32 v83, 0xffff0000, v105
  v_lshlrev_b32 v84, 16, v106
  v_and_b32 v85, 0xffff0000, v106
  v_lshlrev_b32 v86, 16, v107
  v_and_b32 v87, 0xffff0000, v107
  v_cvt_pk_bf16_f32 v108, v88, v89
  v_cvt_pk_bf16_f32 v109, v90, v91
  v_cvt_pk_bf16_f32 v110, v92, v93
  v_cvt_pk_bf16_f32 v111, v94, v95
  v_lshlrev_b32 v88, 16, v108
  v_and_b32 v89, 0xffff0000, v108
  v_lshlrev_b32 v90, 16, v109
  v_and_b32 v91, 0xffff0000, v109
  v_lshlrev_b32 v92, 16, v110
  v_and_b32 v93, 0xffff0000, v110
  v_lshlrev_b32 v94, 16, v111
  v_and_b32 v95, 0xffff0000, v111
  v_pk_add_f32 v[20:21], v[64:65], v[66:67]
  v_pk_mul_f32 v[22:23], v[64:65], v[64:65]
  v_pk_fma_f32 v[22:23], v[66:67], v[66:67], v[22:23]
  v_pk_add_f32 v[20:21], v[20:21], v[68:69]
  v_pk_fma_f32 v[22:23], v[68:69], v[68:69], v[22:23]
  v_pk_add_f32 v[20:21], v[20:21], v[70:71]
  v_pk_fma_f32 v[22:23], v[70:71], v[70:71], v[22:23]
  v_pk_add_f32 v[20:21], v[20:21], v[72:73]
  v_pk_fma_f32 v[22:23], v[72:73], v[72:73], v[22:23]
  v_pk_add_f32 v[20:21], v[20:21], v[74:75]
  v_pk_fma_f32 v[22:23], v[74:75], v[74:75], v[22:23]
  v_pk_add_f32 v[20:21], v[20:21], v[76:77]
  v_pk_fma_f32 v[22:23], v[76:77], v[76:77], v[22:23]
  v_pk_add_f32 v[20:21], v[20:21], v[78:79]
  v_pk_fma_f32 v[22:23], v[78:79], v[78:79], v[22:23]
  v_add_f32 v16, v20, v21
  v_add_f32 v18, v22, v23
  v_pk_add_f32 v[24:25], v[80:81], v[82:83]
  v_pk_mul_f32 v[26:27], v[80:81], v[80:81]
  v_pk_fma_f32 v[26:27], v[82:83], v[82:83], v[26:27]
  v_pk_add_f32 v[24:25], v[24:25], v[84:85]
  v_pk_fma_f32 v[26:27], v[84:85], v[84:85], v[26:27]
  v_pk_add_f32 v[24:25], v[24:25], v[86:87]
  v_pk_fma_f32 v[26:27], v[86:87], v[86:87], v[26:27]
  v_pk_add_f32 v[24:25], v[24:25], v[88:89]
  v_pk_fma_f32 v[26:27], v[88:89], v[88:89], v[26:27]
  v_pk_add_f32 v[24:25], v[24:25], v[90:91]
  v_pk_fma_f32 v[26:27], v[90:91], v[90:91], v[26:27]
  v_pk_add_f32 v[24:25], v[24:25], v[92:93]
  v_pk_fma_f32 v[26:27], v[92:93], v[92:93], v[26:27]
  v_pk_add_f32 v[24:25], v[24:25], v[94:95]
  v_pk_fma_f32 v[26:27], v[94:95], v[94:95], v[26:27]
  v_add_f32 v17, v24, v25
  v_add_f32 v19, v26, v27
  s_nop 0
  v_permlane32_swap_b32 v16, v17
  v_permlane32_swap_b32 v18, v19
  v_add_f32 v28, v16, v17
  v_add_f32 v29, v18, v19
  ds_write_b64 v113, v[28:29]
  buffer_store_dwordx4 v[96:99], v14, s[20:23], 0 offen offset:0
  buffer_store_dwordx4 v[100:103], v14, s[20:23], 0 offen offset:32
  buffer_store_dwordx4 v[104:107], v14, s[20:23], s47 offen offset:0
  buffer_store_dwordx4 v[108:111], v14, s[20:23], s47 offen offset:32
  s_waitcnt lgkmcnt(0)
  s_barrier
  s_barrier
  ds_read_b64 v[16:17], v114
  ds_read_b64 v[18:19], v114 offset:256
  s_waitcnt lgkmcnt(0)
  v_pk_add_f32 v[64:65], v[64:65], v[16:17] op_sel_hi:[1,0] neg_lo:[0,1] neg_hi:[0,1]
  v_pk_add_f32 v[66:67], v[66:67], v[16:17] op_sel_hi:[1,0] neg_lo:[0,1] neg_hi:[0,1]
  v_pk_add_f32 v[68:69], v[68:69], v[16:17] op_sel_hi:[1,0] neg_lo:[0,1] neg_hi:[0,1]
  v_pk_add_f32 v[70:71], v[70:71], v[16:17] op_sel_hi:[1,0] neg_lo:[0,1] neg_hi:[0,1]
  v_pk_mul_f32 v[64:65], v[64:65], v[16:17] op_sel:[0,1] op_sel_hi:[1,1]
  v_pk_mul_f32 v[66:67], v[66:67], v[16:17] op_sel:[0,1] op_sel_hi:[1,1]
  v_pk_mul_f32 v[68:69], v[68:69], v[16:17] op_sel:[0,1] op_sel_hi:[1,1]
  v_pk_mul_f32 v[70:71], v[70:71], v[16:17] op_sel:[0,1] op_sel_hi:[1,1]
  v_cvt_pk_bf16_f32 v32, v64, v65
  v_cvt_pk_bf16_f32 v33, v66, v67
  v_cvt_pk_bf16_f32 v34, v68, v69
  v_cvt_pk_bf16_f32 v35, v70, v71
  v_xor_b32 v48, 0, v15
  buffer_store_dwordx4 v[32:35], v48, s[24:27], s46 offen
  v_pk_add_f32 v[72:73], v[72:73], v[16:17] op_sel_hi:[1,0] neg_lo:[0,1] neg_hi:[0,1]
  v_pk_add_f32 v[74:75], v[74:75], v[16:17] op_sel_hi:[1,0] neg_lo:[0,1] neg_hi:[0,1]
  v_pk_add_f32 v[76:77], v[76:77], v[16:17] op_sel_hi:[1,0] neg_lo:[0,1] neg_hi:[0,1]
  v_pk_add_f32 v[78:79], v[78:79], v[16:17] op_sel_hi:[1,0] neg_lo:[0,1] neg_hi:[0,1]
  v_pk_mul_f32 v[72:73], v[72:73], v[16:17] op_sel:[0,1] op_sel_hi:[1,1]
  v_pk_mul_f32 v[74:75], v[74:75], v[16:17] op_sel:[0,1] op_sel_hi:[1,1]
  v_pk_mul_f32 v[76:77], v[76:77], v[16:17] op_sel:[0,1] op_sel_hi:[1,1]
  v_pk_mul_f32 v[78:79], v[78:79], v[16:17] op_sel:[0,1] op_sel_hi:[1,1]
  v_cvt_pk_bf16_f32 v36, v72, v73
  v_cvt_pk_bf16_f32 v37, v74, v75
  v_cvt_pk_bf16_f32 v38, v76, v77
  v_cvt_pk_bf16_f32 v39, v78, v79
  v_xor_b32 v49, 32, v15
  buffer_store_dwordx4 v[36:39], v49, s[24:27], s46 offen
  v_pk_add_f32 v[80:81], v[80:81], v[18:19] op_sel_hi:[1,0] neg_lo:[0,1] neg_hi:[0,1]
  v_pk_add_f32 v[82:83], v[82:83], v[18:19] op_sel_hi:[1,0] neg_lo:[0,1] neg_hi:[0,1]
  v_pk_add_f32 v[84:85], v[84:85], v[18:19] op_sel_hi:[1,0] neg_lo:[0,1] neg_hi:[0,1]
  v_pk_add_f32 v[86:87], v[86:87], v[18:19] op_sel_hi:[1,0] neg_lo:[0,1] neg_hi:[0,1]
  v_pk_mul_f32 v[80:81], v[80:81], v[18:19] op_sel:[0,1] op_sel_hi:[1,1]
  v_pk_mul_f32 v[82:83], v[82:83], v[18:19] op_sel:[0,1] op_sel_hi:[1,1]
  v_pk_mul_f32 v[84:85], v[84:85], v[18:19] op_sel:[0,1] op_sel_hi:[1,1]
  v_pk_mul_f32 v[86:87], v[86:87], v[18:19] op_sel:[0,1] op_sel_hi:[1,1]
  v_cvt_pk_bf16_f32 v40, v80, v81
  v_cvt_pk_bf16_f32 v41, v82, v83
  v_cvt_pk_bf16_f32 v42, v84, v85
  v_cvt_pk_bf16_f32 v43, v86, v87
  v_xor_b32 v50, 0, v15
  buffer_store_dwordx4 v[40:43], v50, s[24:27], s48 offen
  v_pk_add_f32 v[88:89], v[88:89], v[18:19] op_sel_hi:[1,0] neg_lo:[0,1] neg_hi:[0,1]
  v_pk_add_f32 v[90:91], v[90:91], v[18:19] op_sel_hi:[1,0] neg_lo:[0,1] neg_hi:[0,1]
  v_pk_add_f32 v[92:93], v[92:93], v[18:19] op_sel_hi:[1,0] neg_lo:[0,1] neg_hi:[0,1]
  v_pk_add_f32 v[94:95], v[94:95], v[18:19] op_sel_hi:[1,0] neg_lo:[0,1] neg_hi:[0,1]
  v_pk_mul_f32 v[88:89], v[88:89], v[18:19] op_sel:[0,1] op_sel_hi:[1,1]
  v_pk_mul_f32 v[90:91], v[90:91], v[18:19] op_sel:[0,1] op_sel_hi:[1,1]
  v_pk_mul_f32 v[92:93], v[92:93], v[18:19] op_sel:[0,1] op_sel_hi:[1,1]
  v_pk_mul_f32 v[94:95], v[94:95], v[18:19] op_sel:[0,1] op_sel_hi:[1,1]
  v_cvt_pk_bf16_f32 v44, v88, v89
  v_cvt_pk_bf16_f32 v45, v90, v91
  v_cvt_pk_bf16_f32 v46, v92, v93
  v_cvt_pk_bf16_f32 v47, v94, v95
  v_xor_b32 v51, 32, v15
  buffer_store_dwordx4 v[44:47], v51, s[24:27], s48 offen
  s_endpgm
k2_loader:
  s_nop 7
  s_nop 7
  s_sub_u32 s41, s4, 4
  s_lshl_b32 s44, s41, 12
  s_lshl_b32 s45, s41, 11
  s_add_u32 s45, s45, 16384
  v_lshlrev_b32 v8, 4, v0
  v_add_u32 v8, s44, v8
  s_mul_i32 s32, s41, 16
  s_add_u32 s32, s32, 0
  v_lshrrev_b32 v2, 3, v0
  v_add_u32 v2, s32, v2
  v_bfe_u32 v3, v2, 1, 1
  v_lshlrev_b32 v3, 2, v3
  v_and_b32 v4, 7, v0
  v_xor_b32 v3, v3, v4
  v_lshlrev_b32 v3, 4, v3
  s_mov_b32 s32, 2048
  v_mul_lo_u32 v2, v2, s32
  v_add_u32 v9, v2, v3
  s_mul_i32 s32, s41, 16
  s_add_u32 s32, s32, 8
  v_lshrrev_b32 v2, 3, v0
  v_add_u32 v2, s32, v2
  v_bfe_u32 v3, v2, 1, 1
  v_lshlrev_b32 v3, 2, v3
  v_and_b32 v4, 7, v0
  v_xor_b32 v3, v3, v4
  v_lshlrev_b32 v3, 4, v3
  s_mov_b32 s32, 2048
  v_mul_lo_u32 v2, v2, s32
  v_add_u32 v10, v2, v3
  v_subrev_u32 v10, 1024, v10
  s_mul_i32 s34, s28, 262144
  s_lshl_b32 s35, s29, 7
  s_waitcnt lgkmcnt(0)
  s_mov_b32 s8, s82
  s_mov_b32 s9, s83
  s_mov_b32 s10, 4194304
  s_mov_b32 s11, 0x20000
  s_mov_b32 s12, s68
  s_mov_b32 s13, s69
  s_mov_b32 s14, 2097152
  s_mov_b32 s15, 0x20000
  s_add_u32 s16, s82, 25165824
  s_addc_u32 s17, s83, 0
  s_mov_b32 s18, 262144
  s_mov_b32 s19, 0x20000
  v_and_b32 v2, 31, v0
  v_lshrrev_b32 v3, 5, v0
  s_lshl_b32 s32, s41, 5
  v_add_u32 v12, s32, v2
  v_lshlrev_b32 v12, 3, v12
  s_lshl_b32 s32, s28, 10
  v_add_u32 v14, s32, v12
  s_lshl_b32 s32, s29, 14
  v_add_u32 v13, s32, v14
  v_lshlrev_b32 v15, 17, v3
  v_add_u32 v14, v14, v15
  v_add_u32 v12, 147456, v12
  s_mov_b32 s53, 16384
  s_mov_b32 s54, 32768
  s_mov_b32 s55, 49152
  s_mov_b32 s56, 65536
  s_mov_b32 s57, 81920
  s_mov_b32 s58, 98304
  s_mov_b32 s59, 114688
  s_mov_b32 s30, 7
  s_mov_b32 s31, -2
  s_mov_b32 s38, 0
k2_nk7:
  s_add_u32 s30, s30, 1
  s_and_b32 s30, s30, 7
  s_cselect_b32 s32, 0, 1
  s_add_u32 s31, s31, s32
  s_sub_u32 s32, s30, s7
  s_and_b32 s32, s32, 7
  s_cmp_lt_u32 s32, 2
  s_cselect_b32 s32, 1, 0
  s_add_u32 s32, s32, s31
  s_cmp_ge_u32 s32, 2
  s_cbranch_scc1 k2_nk7
  s_lshl_b32 s33, s32, 3
  s_add_u32 s33, s33, s30
  s_mul_i32 s36, s33, 16384
  s_add_u32 s36, s36, s34
  s_mul_i32 s37, s33, 131072
  s_add_u32 s37, s37, s35
  s_add_u32 m0, s38, s44
  s_nop 0
  buffer_load_dwordx4 v8, s[8:11], s36 offen offset:0 lds
  buffer_load_dwordx4 v8, s[8:11], s36 offen offset:1024 lds
  buffer_load_dwordx4 v8, s[8:11], s36 offen offset:2048 lds
  buffer_load_dwordx4 v8, s[8:11], s36 offen offset:3072 lds
  s_add_u32 m0, s38, s45
  s_nop 0
  buffer_load_dwordx4 v9, s[12:15], s37 offen offset:0 lds
  buffer_load_dwordx4 v10, s[12:15], s37 offen offset:1024 lds
  s_add_u32 s38, s38, 24576
  s_cmp_eq_u32 s38, 147456
  s_cselect_b32 s38, 0, s38
k2_nk8:
  s_add_u32 s30, s30, 1
  s_and_b32 s30, s30, 7
  s_cselect_b32 s32, 0, 1
  s_add_u32 s31, s31, s32
  s_sub_u32 s32, s30, s7
  s_and_b32 s32, s32, 7
  s_cmp_lt_u32 s32, 2
  s_cselect_b32 s32, 1, 0
  s_add_u32 s32, s32, s31
  s_cmp_ge_u32 s32, 2
  s_cbranch_scc1 k2_nk8
  s_lshl_b32 s33, s32, 3
  s_add_u32 s33, s33, s30
  s_mul_i32 s36, s33, 16384
  s_add_u32 s36, s36, s34
  s_mul_i32 s37, s33, 131072
  s_add_u32 s37, s37, s35
  s_add_u32 m0, s38, s44
  s_nop 0
  buffer_load_dwordx4 v8, s[8:11], s36 offen offset:0 lds
  buffer_load_dwordx4 v8, s[8:11], s36 offen offset:1024 lds
  buffer_load_dwordx4 v8, s[8:11], s36 offen offset:2048 lds
  buffer_load_dwordx4 v8, s[8:11], s36 offen offset:3072 lds
  s_add_u32 m0, s38, s45
  s_nop 0
  buffer_load_dwordx4 v9, s[12:15], s37 offen offset:0 lds
  buffer_load_dwordx4 v10, s[12:15], s37 offen offset:1024 lds
  s_add_u32 s38, s38, 24576
  s_cmp_eq_u32 s38, 147456
  s_cselect_b32 s38, 0, s38
k2_nk9:
  s_add_u32 s30, s30, 1
  s_and_b32 s30, s30, 7
  s_cselect_b32 s32, 0, 1
  s_add_u32 s31, s31, s32
  s_sub_u32 s32, s30, s7
  s_and_b32 s32, s32, 7
  s_cmp_lt_u32 s32, 2
  s_cselect_b32 s32, 1, 0
  s_add_u32 s32, s32, s31
  s_cmp_ge_u32 s32, 2
  s_cbranch_scc1 k2_nk9
  s_lshl_b32 s33, s32, 3
  s_add_u32 s33, s33, s30
  s_mul_i32 s36, s33, 16384
  s_add_u32 s36, s36, s34
  s_mul_i32 s37, s33, 131072
  s_add_u32 s37, s37, s35
  s_add_u32 m0, s38, s44
  s_nop 0
  buffer_load_dwordx4 v8, s[8:11], s36 offen offset:0 lds
  buffer_load_dwordx4 v8, s[8:11], s36 offen offset:1024 lds
  buffer_load_dwordx4 v8, s[8:11], s36 offen offset:2048 lds
  buffer_load_dwordx4 v8, s[8:11], s36 offen offset:3072 lds
  s_add_u32 m0, s38, s45
  s_nop 0
  buffer_load_dwordx4 v9, s[12:15], s37 offen offset:0 lds
  buffer_load_dwordx4 v10, s[12:15], s37 offen offset:1024 lds
  s_add_u32 s38, s38, 24576
  s_cmp_eq_u32 s38, 147456
  s_cselect_b32 s38, 0, s38
k2_nk10:
  s_add_u32 s30, s30, 1
  s_and_b32 s30, s30, 7
  s_cselect_b32 s32, 0, 1
  s_add_u32 s31, s31, s32
  s_sub_u32 s32, s30, s7
  s_and_b32 s32, s32, 7
  s_cmp_lt_u32 s32, 2
  s_cselect_b32 s32, 1, 0
  s_add_u32 s32, s32, s31
  s_cmp_ge_u32 s32, 2
  s_cbranch_scc1 k2_nk10
  s_lshl_b32 s33, s32, 3
  s_add_u32 s33, s33, s30
  s_mul_i32 s36, s33, 16384
  s_add_u32 s36, s36, s34
  s_mul_i32 s37, s33, 131072
  s_add_u32 s37, s37, s35
  s_add_u32 m0, s38, s44
  s_nop 0
  buffer_load_dwordx4 v8, s[8:11], s36 offen offset:0 lds
  buffer_load_dwordx4 v8, s[8:11], s36 offen offset:1024 lds
  buffer_load_dwordx4 v8, s[8:11], s36 offen offset:2048 lds
  buffer_load_dwordx4 v8, s[8:11], s36 offen offset:3072 lds
  s_add_u32 m0, s38, s45
  s_nop 0
  buffer_load_dwordx4 v9, s[12:15], s37 offen offset:0 lds
  buffer_load_dwordx4 v10, s[12:15], s37 offen offset:1024 lds
  s_add_u32 s38, s38, 24576
  s_cmp_eq_u32 s38, 147456
  s_cselect_b32 s38, 0, s38
k2_nk11:
  s_add_u32 s30, s30, 1
  s_and_b32 s30, s30, 7
  s_cselect_b32 s32, 0, 1
  s_add_u32 s31, s31, s32
  s_sub_u32 s32, s30, s7
  s_and_b32 s32, s32, 7
  s_cmp_lt_u32 s32, 2
  s_cselect_b32 s32, 1, 0
  s_add_u32 s32, s32, s31
  s_cmp_ge_u32 s32, 2
  s_cbranch_scc1 k2_nk11
  s_lshl_b32 s33, s32, 3
  s_add_u32 s33, s33, s30
  s_mul_i32 s36, s33, 16384
  s_add_u32 s36, s36, s34
  s_mul_i32 s37, s33, 131072
  s_add_u32 s37, s37, s35
  s_add_u32 m0, s38, s44
  s_nop 0
  buffer_load_dwordx4 v8, s[8:11], s36 offen offset:0 lds
  buffer_load_dwordx4 v8, s[8:11], s36 offen offset:1024 lds
  buffer_load_dwordx4 v8, s[8:11], s36 offen offset:2048 lds
  buffer_load_dwordx4 v8, s[8:11], s36 offen offset:3072 lds
  s_add_u32 m0, s38, s45
  s_nop 0
  buffer_load_dwordx4 v9, s[12:15], s37 offen offset:0 lds
  buffer_load_dwordx4 v10, s[12:15], s37 offen offset:1024 lds
  s_add_u32 s38, s38, 24576
  s_cmp_eq_u32 s38, 147456
  s_cselect_b32 s38, 0, s38
  s_mov_b32 s39, 11
k2_lloop:
  s_waitcnt vmcnt(24)
  s_barrier
k2_nk12:
  s_add_u32 s30, s30, 1
  s_and_b32 s30, s30, 7
  s_cselect_b32 s32, 0, 1
  s_add_u32 s31, s31, s32
  s_sub_u32 s32, s30, s7
  s_and_b32 s32, s32, 7
  s_cmp_lt_u32 s32, 2
  s_cselect_b32 s32, 1, 0
  s_add_u32 s32, s32, s31
  s_cmp_ge_u32 s32, 2
  s_cbranch_scc1 k2_nk12
  s_lshl_b32 s33, s32, 3
  s_add_u32 s33, s33, s30
  s_mul_i32 s36, s33, 16384
  s_add_u32 s36, s36, s34
  s_mul_i32 s37, s33, 131072
  s_add_u32 s37, s37, s35
  s_add_u32 m0, s38, s44
  s_nop 0
  buffer_load_dwordx4 v8, s[8:11], s36 offen offset:0 lds
  buffer_load_dwordx4 v8, s[8:11], s36 offen offset:1024 lds
  buffer_load_dwordx4 v8, s[8:11], s36 offen offset:2048 lds
  buffer_load_dwordx4 v8, s[8:11], s36 offen offset:3072 lds
  s_add_u32 m0, s38, s45
  s_nop 0
  buffer_load_dwordx4 v9, s[12:15], s37 offen offset:0 lds
  buffer_load_dwordx4 v10, s[12:15], s37 offen offset:1024 lds
  s_add_u32 s38, s38, 24576
  s_cmp_eq_u32 s38, 147456
  s_cselect_b32 s38, 0, s38
  s_sub_u32 s39, s39, 1
  s_cmp_lg_u32 s39, 0
  s_cbranch_scc1 k2_lloop
  s_waitcnt vmcnt(24)
  s_barrier
  s_waitcnt vmcnt(18)
  s_barrier
  s_waitcnt vmcnt(12)
  s_barrier
  s_waitcnt vmcnt(6)
  s_barrier
  s_waitcnt vmcnt(0)
  s_barrier
  s_barrier
  ds_read_b64 v[16:17], v12
  ds_read_b64 v[18:19], v12 offset:1024
  s_waitcnt lgkmcnt(0)
  v_add_f32 v16, v16, v18
  v_add_f32 v17, v17, v19
  v_and_b32 v17, 0x7fffffff, v17
  s_mov_b32 exec_hi, 0
  buffer_store_dwordx2 v[16:17], v13, s[16:19], 0 offen sc0 sc1
  s_mov_b64 exec, -1
  s_mov_b32 s39, 0
k2_poll:
  buffer_load_dwordx2 v[20:21], v14, s[16:19], 0 offen sc0 sc1
  buffer_load_dwordx2 v[22:23], v14, s[16:19], s53 offen sc0 sc1
  buffer_load_dwordx2 v[24:25], v14, s[16:19], s54 offen sc0 sc1
  buffer_load_dwordx2 v[26:27], v14, s[16:19], s55 offen sc0 sc1
  buffer_load_dwordx2 v[28:29], v14, s[16:19], s56 offen sc0 sc1
  buffer_load_dwordx2 v[30:31], v14, s[16:19], s57 offen sc0 sc1
  buffer_load_dwordx2 v[32:33], v14, s[16:19], s58 offen sc0 sc1
  buffer_load_dwordx2 v[34:35], v14, s[16:19], s59 offen sc0 sc1
  s_waitcnt vmcnt(0)
  v_min3_i32 v36, v21, v23, v25
  v_min3_i32 v37, v27, v29, v31
  v_min3_i32 v36, v36, v33, v35
  v_min_i32 v36, v36, v37
  v_cmp_gt_i32 vcc, 0, v36
  s_add_u32 s39, s39, 1
  s_cmp_gt_u32 s39, 200000
  s_cbranch_scc1 k2_pdone
  s_cbranch_vccnz k2_poll
k2_pdone:
  v_pk_add_f32 v[20:21], v[20:21], v[22:23]
  v_pk_add_f32 v[24:25], v[24:25], v[26:27]
  v_pk_add_f32 v[28:29], v[28:29], v[30:31]
  v_pk_add_f32 v[32:33], v[32:33], v[34:35]
  v_pk_add_f32 v[20:21], v[20:21], v[24:25]
  v_pk_add_f32 v[28:29], v[28:29], v[32:33]
  v_pk_add_f32 v[20:21], v[20:21], v[28:29]
  v_mov_b32 v22, v20
  v_mov_b32 v23, v21
  s_nop 0
  v_permlane32_swap_b32 v20, v22
  v_permlane32_swap_b32 v21, v23
  v_add_f32 v20, v20, v22
  v_add_f32 v21, v21, v23
  v_mul_f32 v20, 0x3a800000, v20
  v_mul_f32 v21, 0x3a800000, v21
  v_fma_f32 v21, -v20, v20, v21
  v_max_f32 v21, 0, v21
  v_mov_b32 v24, v21
  v_cvt_pk_bf16_f32 v24, v24, v24
  v_lshlrev_b32 v24, 16, v24
  v_add_f32 v24, 0x3727c5ac, v24
  v_cvt_pk_bf16_f32 v24, v24, v24
  v_lshlrev_b32 v24, 16, v24
  v_sqrt_f32 v24, v24
  s_nop 0
  v_cvt_pk_bf16_f32 v24, v24, v24
  v_lshlrev_b32 v24, 16, v24
  v_rcp_f32 v24, v24
  s_nop 0
  v_mul_f32 v21, v21, v24
  v_mul_f32 v21, v21, v24
  v_cvt_pk_bf16_f32 v21, v21, v21
  v_lshlrev_b32 v21, 16, v21
  v_add_f32 v21, 0x3727c5ac, v21
  v_cvt_pk_bf16_f32 v21, v21, v21
  v_lshlrev_b32 v21, 16, v21
  v_sqrt_f32 v21, v21
  s_nop 0
  v_cvt_pk_bf16_f32 v21, v21, v21
  v_lshlrev_b32 v21, 16, v21
  v_rcp_f32 v21, v21
  s_nop 0
  v_mul_f32 v21, v21, v24
  ds_write_b64 v12, v[20:21] offset:2048
  s_waitcnt lgkmcnt(0)
  s_barrier
k2_end:
  s_endpgm
  s_nop 7
  s_nop 7
.p2align 8
k3_kernel:
  s_cmp_ge_u32 s2, 224
  s_cbranch_scc1 k3_end
  s_load_dwordx16 s[64:79], s[0:1], 0
  s_load_dwordx2 s[80:81], s[0:1], 64
  s_load_dwordx2 s[82:83], s[0:1], 80
  v_lshrrev_b32 v1, 6, v0
  v_and_b32 v0, 63, v0
  v_readfirstlane_b32 s4, v1
  s_lshr_b32 s32, s2, 3
  s_mul_i32 s5, s32, 9363
  s_lshr_b32 s5, s5, 16
  s_mul_i32 s6, s5, 7
  s_sub_u32 s6, s32, s6
  s_lshl_b32 s7, s5, 1
  s_add_u32 s7, s7, s6
  s_and_b32 s7, s7, 7
  s_and_b32 s32, s2, 7
  s_lshr_b32 s28, s32, 2
  s_lshl_b32 s28, s28, 2
  s_add_u32 s28, s28, s5
  s_and_b32 s29, s32, 3
  s_mul_i32 s29, s29, 7
  s_add_u32 s29, s29, s6
  s_cmp_ge_u32 s4, 4
  s_cbranch_scc1 k3_loader
  v_and_b32 v2, 31, v0
  v_lshrrev_b32 v3, 5, v0
  v_and_b32 v4, 15, v0
  v_lshrrev_b32 v5, 4, v0
  v_lshrrev_b32 v6, 2, v4
  v_and_b32 v7, 3, v0
  s_and_b32 s40, s4, 1
  s_lshr_b32 s41, s4, 1
  s_lshl_b32 s32, s29, 8
  s_lshl_b32 s44, s40, 7
  s_add_u32 s32, s32, s44
  v_lshlrev_b32 v13, 4, v3
  v_add_u32 v13, s32, v13
  s_waitcnt lgkmcnt(0)
  s_mov_b32 s16, s74
  s_mov_b32 s17, s75
  s_mov_b32 s18, 7168
  s_mov_b32 s19, 0x20000
  s_add_u32 s24, s82, 12582912
  s_addc_u32 s25, s83, 0
  s_mov_b32 s26, 7340032
  s_mov_b32 s27, 0x20000
  buffer_load_dwordx4 v[144:147], v13, s[16:19], 0 offen offset:0
  buffer_load_dwordx4 v[148:151], v13, s[16:19], 0 offen offset:32
  buffer_load_dwordx4 v[152:155], v13, s[16:19], 0 offen offset:64
  buffer_load_dwordx4 v[156:159], v13, s[16:19], 0 offen offset:96
  v_lshrrev_b32 v16, 1, v5
  v_lshlrev_b32 v16, 3, v16
  v_add_u32 v16, v16, v6
  v_lshlrev_b32 v16, 8, v16
  v_and_b32 v17, 1, v5
  v_lshlrev_b32 v17, 2, v17
  v_add_u32 v17, v17, v7
  v_lshlrev_b32 v20, 6, v6
  v_and_b32 v19, 1, v17
  v_lshlrev_b32 v19, 1, v19
  v_and_b32 v18, 4, v17
  v_or_b32 v19, v19, v18
  v_bfe_u32 v18, v17, 1, 1
  v_or_b32 v18, v18, v19
  v_lshlrev_b32 v18, 3, v18
  s_lshl_b32 s32, s40, 7
  v_add_u32 v18, s32, v18
  v_xor_b32 v18, v18, v20
  v_add_u32 v8, v16, v18
  v_add_u32 v8, 16384, v8
  v_xor_b32 v9, 64, v8
  v_lshlrev_b32 v17, 3, v17
  s_lshl_b32 s32, s41, 7
  v_add_u32 v17, s32, v17
  v_xor_b32 v17, v17, v20
  v_add_u32 v10, v16, v17
  v_xor_b32 v11, 64, v10
  s_lshl_b32 s32, s41, 6
  v_add_u32 v16, s32, v2
  v_bfe_u32 v17, v16, 1, 3
  v_xor_b32 v17, v17, v3
  v_lshlrev_b32 v17, 4, v17
  v_lshlrev_b32 v16, 7, v16
  v_add_u32 v14, v16, v17
  s_mul_i32 s32, s28, 56
  s_lshl_b32 s44, s29, 1
  s_add_u32 s32, s32, s44
  s_add_u32 s32, s32, s40
  s_lshl_b32 s46, s32, 14
  s_waitcnt vmcnt(0)
  v_lshlrev_b32 v80, 16, v144
  v_and_b32 v81, 0xffff0000, v144
  v_lshlrev_b32 v82, 16, v145
  v_and_b32 v83, 0xffff0000, v145
  v_lshlrev_b32 v84, 16, v146
  v_and_b32 v85, 0xffff0000, v146
  v_lshlrev_b32 v86, 16, v147
  v_and_b32 v87, 0xffff0000, v147
  v_mov_b32 v96, v80
  v_mov_b32 v97, v81
  v_mov_b32 v98, v82
  v_mov_b32 v99, v83
  v_mov_b32 v100, v84
  v_mov_b32 v101, v85
  v_mov_b32 v102, v86
  v_mov_b32 v103, v87
  v_lshlrev_b32 v88, 16, v148
  v_and_b32 v89, 0xffff0000, v148
  v_lshlrev_b32 v90, 16, v149
  v_and_b32 v91, 0xffff0000, v149
  v_lshlrev_b32 v92, 16, v150
  v_and_b32 v93, 0xffff0000, v150
  v_lshlrev_b32 v94, 16, v151
  v_and_b32 v95, 0xffff0000, v151
  v_mov_b32 v104, v88
  v_mov_b32 v105, v89
  v_mov_b32 v106, v90
  v_mov_b32 v107, v91
  v_mov_b32 v108, v92
  v_mov_b32 v109, v93
  v_mov_b32 v110, v94
  v_mov_b32 v111, v95
  v_lshlrev_b32 v112, 16, v152
  v_and_b32 v113, 0xffff0000, v152
  v_lshlrev_b32 v114, 16, v153
  v_and_b32 v115, 0xffff0000, v153
  v_lshlrev_b32 v116, 16, v154
  v_and_b32 v117, 0xffff0000, v154
  v_lshlrev_b32 v118, 16, v155
  v_and_b32 v119, 0xffff0000, v155
  v_mov_b32 v128, v112
  v_mov_b32 v129, v113
  v_mov_b32 v130, v114
  v_mov_b32 v131, v115
  v_mov_b32 v132, v116
  v_mov_b32 v133, v117
  v_mov_b32 v134, v118
  v_mov_b32 v135, v119
  v_lshlrev_b32 v120, 16, v156
  v_and_b32 v121, 0xffff0000, v156
  v_lshlrev_b32 v122, 16, v157
  v_and_b32 v123, 0xffff0000, v157
  v_lshlrev_b32 v124, 16, v158
  v_and_b32 v125, 0xffff0000, v158
  v_lshlrev_b32 v126, 16, v159
  v_and_b32 v127, 0xffff0000, v159
  v_mov_b32 v136, v120
  v_mov_b32 v137, v121
  v_mov_b32 v138, v122
  v_mov_b32 v139, v123
  v_mov_b32 v140, v124
  v_mov_b32 v141, v125
  v_mov_b32 v142, v126
  v_mov_b32 v143, v127
  s_mov_b32 s43, 0
  s_mov_b32 s39, 31
  s_barrier
  ds_read_b64_tr_b16 v[16:17], v8 offset:0
  ds_read_b64_tr_b16 v[18:19], v8 offset:1024
  ds_read_b64_tr_b16 v[24:25], v10 offset:0
  ds_read_b64_tr_b16 v[26:27], v10 offset:1024
  ds_read_b64_tr_b16 v[28:29], v11 offset:0
  ds_read_b64_tr_b16 v[30:31], v11 offset:1024
  ds_read_b64_tr_b16 v[20:21], v9 offset:0
  ds_read_b64_tr_b16 v[22:23], v9 offset:1024
  ds_read_b64_tr_b16 v[32:33], v8 offset:4096
  ds_read_b64_tr_b16 v[34:35], v8 offset:5120
  ds_read_b64_tr_b16 v[40:41], v10 offset:4096
  ds_read_b64_tr_b16 v[42:43], v10 offset:5120
  ds_read_b64_tr_b16 v[44:45], v11 offset:4096
  ds_read_b64_tr_b16 v[46:47], v11 offset:5120
  ds_read_b64_tr_b16 v[36:37], v9 offset:4096
  ds_read_b64_tr_b16 v[38:39], v9 offset:5120
  s_add_u32 s32, s43, 32768
  s_cmp_eq_u32 s32, 163840
  s_cselect_b32 s32, 0, s32
  s_sub_u32 s42, s32, s43
  s_mov_b32 s43, s32
k3_cloop:
  s_waitcnt lgkmcnt(0)
  v_mfma_f32_32x32x16_bf16 v[80:95], v[16:19], v[24:27], v[80:95]
  ds_read_b64_tr_b16 v[48:49], v8 offset:8192
  ds_read_b64_tr_b16 v[50:51], v8 offset:9216
  ds_read_b64_tr_b16 v[56:57], v10 offset:8192
  v_mfma_f32_32x32x16_bf16 v[96:111], v[16:19], v[28:31], v[96:111]
  ds_read_b64_tr_b16 v[58:59], v10 offset:9216
  ds_read_b64_tr_b16 v[60:61], v11 offset:8192
  ds_read_b64_tr_b16 v[62:63], v11 offset:9216
  v_mfma_f32_32x32x16_bf16 v[128:143], v[20:23], v[28:31], v[128:143]
  ds_read_b64_tr_b16 v[52:53], v9 offset:8192
  ds_read_b64_tr_b16 v[54:55], v9 offset:9216
  ds_read_b64_tr_b16 v[64:65], v8 offset:12288
  v_mfma_f32_32x32x16_bf16 v[112:127], v[20:23], v[24:27], v[112:127]
  ds_read_b64_tr_b16 v[66:67], v8 offset:13312
  ds_read_b64_tr_b16 v[72:73], v10 offset:12288
  ds_read_b64_tr_b16 v[74:75], v10 offset:13312
  v_mfma_f32_32x32x16_bf16 v[80:95], v[32:35], v[40:43], v[80:95]
  ds_read_b64_tr_b16 v[76:77], v11 offset:12288
  ds_read_b64_tr_b16 v[78:79], v11 offset:13312
  ds_read_b64_tr_b16 v[68:69], v9 offset:12288
  v_mfma_f32_32x32x16_bf16 v[96:111], v[32:35], v[44:47], v[96:111]
  ds_read_b64_tr_b16 v[70:71], v9 offset:13312
  v_add_u32 v8, s42, v8
  v_add_u32 v9, s42, v9
  v_mfma_f32_32x32x16_bf16 v[128:143], v[36:39], v[44:47], v[128:143]
  v_add_u32 v10, s42, v10
  v_add_u32 v11, s42, v11
  v_mfma_f32_32x32x16_bf16 v[112:127], v[36:39], v[40:43], v[112:127]
  s_waitcnt lgkmcnt(0)
  s_barrier
  v_mfma_f32_32x32x16_bf16 v[80:95], v[48:51], v[56:59], v[80:95]
  ds_read_b64_tr_b16 v[16:17], v8 offset:0
  ds_read_b64_tr_b16 v[18:19], v8 offset:1024
  ds_read_b64_tr_b16 v[24:25], v10 offset:0
  v_mfma_f32_32x32x16_bf16 v[96:111], v[48:51], v[60:63], v[96:111]
  ds_read_b64_tr_b16 v[26:27], v10 offset:1024
  ds_read_b64_tr_b16 v[28:29], v11 offset:0
  ds_read_b64_tr_b16 v[30:31], v11 offset:1024
  v_mfma_f32_32x32x16_bf16 v[128:143], v[52:55], v[60:63], v[128:143]
  ds_read_b64_tr_b16 v[20:21], v9 offset:0
  ds_read_b64_tr_b16 v[22:23], v9 offset:1024
  ds_read_b64_tr_b16 v[32:33], v8 offset:4096
  v_mfma_f32_32x32x16_bf16 v[112:127], v[52:55], v[56:59], v[112:127]
  ds_read_b64_tr_b16 v[34:35], v8 offset:5120
  ds_read_b64_tr_b16 v[40:41], v10 offset:4096
  ds_read_b64_tr_b16 v[42:43], v10 offset:5120
  v_mfma_f32_32x32x16_bf16 v[80:95], v[64:67], v[72:75], v[80:95]
  ds_read_b64_tr_b16 v[44:45], v11 offset:4096
  ds_read_b64_tr_b16 v[46:47], v11 offset:5120
  ds_read_b64_tr_b16 v[36:37], v9 offset:4096
  v_mfma_f32_32x32x16_bf16 v[96:111], v[64:67], v[76:79], v[96:111]
  ds_read_b64_tr_b16 v[38:39], v9 offset:5120
  s_add_u32 s32, s43, 32768
  s_cmp_eq_u32 s32, 163840
  v_mfma_f32_32x32x16_bf16 v[128:143], v[68:71], v[76:79], v[128:143]
  s_cselect_b32 s32, 0, s32
  s_sub_u32 s42, s32, s43
  s_mov_b32 s43, s32
  v_mfma_f32_32x32x16_bf16 v[112:127], v[68:71], v[72:75], v[112:127]
  s_sub_u32 s39, s39, 1
  s_cmp_lg_u32 s39, 0
  s_cbranch_scc1 k3_cloop
  s_waitcnt lgkmcnt(0)
  v_mfma_f32_32x32x16_bf16 v[80:95], v[16:19], v[24:27], v[80:95]
  ds_read_b64_tr_b16 v[48:49], v8 offset:8192
  ds_read_b64_tr_b16 v[50:51], v8 offset:9216
  ds_read_b64_tr_b16 v[56:57], v10 offset:8192
  v_mfma_f32_32x32x16_bf16 v[96:111], v[16:19], v[28:31], v[96:111]
  ds_read_b64_tr_b16 v[58:59], v10 offset:9216
  ds_read_b64_tr_b16 v[60:61], v11 offset:8192
  ds_read_b64_tr_b16 v[62:63], v11 offset:9216
  v_mfma_f32_32x32x16_bf16 v[128:143], v[20:23], v[28:31], v[128:143]
  ds_read_b64_tr_b16 v[52:53], v9 offset:8192
  ds_read_b64_tr_b16 v[54:55], v9 offset:9216
  ds_read_b64_tr_b16 v[64:65], v8 offset:12288
  v_mfma_f32_32x32x16_bf16 v[112:127], v[20:23], v[24:27], v[112:127]
  ds_read_b64_tr_b16 v[66:67], v8 offset:13312
  ds_read_b64_tr_b16 v[72:73], v10 offset:12288
  ds_read_b64_tr_b16 v[74:75], v10 offset:13312
  v_mfma_f32_32x32x16_bf16 v[80:95], v[32:35], v[40:43], v[80:95]
  ds_read_b64_tr_b16 v[76:77], v11 offset:12288
  ds_read_b64_tr_b16 v[78:79], v11 offset:13312
  ds_read_b64_tr_b16 v[68:69], v9 offset:12288
  v_mfma_f32_32x32x16_bf16 v[96:111], v[32:35], v[44:47], v[96:111]
  ds_read_b64_tr_b16 v[70:71], v9 offset:13312
  v_mfma_f32_32x32x16_bf16 v[128:143], v[36:39], v[44:47], v[128:143]
  v_mfma_f32_32x32x16_bf16 v[112:127], v[36:39], v[40:43], v[112:127]
  s_waitcnt lgkmcnt(0)
  v_mfma_f32_32x32x16_bf16 v[80:95], v[48:51], v[56:59], v[80:95]
  v_mfma_f32_32x32x16_bf16 v[96:111], v[48:51], v[60:63], v[96:111]
  v_mfma_f32_32x32x16_bf16 v[128:143], v[52:55], v[60:63], v[128:143]
  v_mfma_f32_32x32x16_bf16 v[112:127], v[52:55], v[56:59], v[112:127]
  v_mfma_f32_32x32x16_bf16 v[80:95], v[64:67], v[72:75], v[80:95]
  v_mfma_f32_32x32x16_bf16 v[96:111], v[64:67], v[76:79], v[96:111]
  v_mfma_f32_32x32x16_bf16 v[128:143], v[68:71], v[76:79], v[128:143]
  v_mfma_f32_32x32x16_bf16 v[112:127], v[68:71], v[72:75], v[112:127]
  v_mov_b32 v16, 0xc0135761
  v_mov_b32 v17, 0xbdd2d3e8
  v_mov_b32 v18, 1.0
  s_nop 5
  v_pk_mul_f32 v[24:25], v[80:81], v[80:81]
  v_pk_mul_f32 v[26:27], v[82:83], v[82:83]
  v_pk_mul_f32 v[28:29], v[84:85], v[84:85]
  v_pk_mul_f32 v[30:31], v[86:87], v[86:87]
  v_pk_fma_f32 v[24:25], v[24:25], v[16:17], v[16:17] op_sel:[0,1,0] op_sel_hi:[1,1,0]
  v_pk_fma_f32 v[26:27], v[26:27], v[16:17], v[16:17] op_sel:[0,1,0] op_sel_hi:[1,1,0]
  v_pk_fma_f32 v[28:29], v[28:29], v[16:17], v[16:17] op_sel:[0,1,0] op_sel_hi:[1,1,0]
  v_pk_fma_f32 v[30:31], v[30:31], v[16:17], v[16:17] op_sel:[0,1,0] op_sel_hi:[1,1,0]
  v_pk_mul_f32 v[24:25], v[24:25], v[80:81]
  v_pk_mul_f32 v[26:27], v[26:27], v[82:83]
  v_pk_mul_f32 v[28:29], v[28:29], v[84:85]
  v_pk_mul_f32 v[30:31], v[30:31], v[86:87]
  v_exp_f32 v24, v24
  v_exp_f32 v25, v25
  v_exp_f32 v26, v26
  v_exp_f32 v27, v27
  v_exp_f32 v28, v28
  v_exp_f32 v29, v29
  v_exp_f32 v30, v30
  v_exp_f32 v31, v31
  v_pk_add_f32 v[24:25], v[24:25], v[18:19] op_sel_hi:[1,0]
  v_pk_add_f32 v[26:27], v[26:27], v[18:19] op_sel_hi:[1,0]
  v_pk_add_f32 v[28:29], v[28:29], v[18:19] op_sel_hi:[1,0]
  v_pk_add_f32 v[30:31], v[30:31], v[18:19] op_sel_hi:[1,0]
  v_rcp_f32 v24, v24
  v_rcp_f32 v25, v25
  v_rcp_f32 v26, v26
  v_rcp_f32 v27, v27
  v_rcp_f32 v28, v28
  v_rcp_f32 v29, v29
  v_rcp_f32 v30, v30
  v_rcp_f32 v31, v31
  v_pk_mul_f32 v[24:25], v[24:25], v[80:81]
  v_pk_mul_f32 v[26:27], v[26:27], v[82:83]
  v_pk_mul_f32 v[28:29], v[28:29], v[84:85]
  v_pk_mul_f32 v[30:31], v[30:31], v[86:87]
  v_cvt_pk_bf16_f32 v32, v24, v25
  v_cvt_pk_bf16_f32 v33, v26, v27
  v_cvt_pk_bf16_f32 v34, v28, v29
  v_cvt_pk_bf16_f32 v35, v30, v31
  v_xor_b32 v36, 0, v14
  buffer_store_dwordx4 v[32:35], v36, s[24:27], s46 offen offset:0
  v_pk_mul_f32 v[40:41], v[88:89], v[88:89]
  v_pk_mul_f32 v[42:43], v[90:91], v[90:91]
  v_pk_mul_f32 v[44:45], v[92:93], v[92:93]
  v_pk_mul_f32 v[46:47], v[94:95], v[94:95]
  v_pk_fma_f32 v[40:41], v[40:41], v[16:17], v[16:17] op_sel:[0,1,0] op_sel_hi:[1,1,0]
  v_pk_fma_f32 v[42:43], v[42:43], v[16:17], v[16:17] op_sel:[0,1,0] op_sel_hi:[1,1,0]
  v_pk_fma_f32 v[44:45], v[44:45], v[16:17], v[16:17] op_sel:[0,1,0] op_sel_hi:[1,1,0]
  v_pk_fma_f32 v[46:47], v[46:47], v[16:17], v[16:17] op_sel:[0,1,0] op_sel_hi:[1,1,0]
  v_pk_mul_f32 v[40:41], v[40:41], v[88:89]
  v_pk_mul_f32 v[42:43], v[42:43], v[90:91]
  v_pk_mul_f32 v[44:45], v[44:45], v[92:93]
  v_pk_mul_f32 v[46:47], v[46:47], v[94:95]
  v_exp_f32 v40, v40
  v_exp_f32 v41, v41
  v_exp_f32 v42, v42
  v_exp_f32 v43, v43
  v_exp_f32 v44, v44
  v_exp_f32 v45, v45
  v_exp_f32 v46, v46
  v_exp_f32 v47, v47
  v_pk_add_f32 v[40:41], v[40:41], v[18:19] op_sel_hi:[1,0]
  v_pk_add_f32 v[42:43], v[42:43], v[18:19] op_sel_hi:[1,0]
  v_pk_add_f32 v[44:45], v[44:45], v[18:19] op_sel_hi:[1,0]
  v_pk_add_f32 v[46:47], v[46:47], v[18:19] op_sel_hi:[1,0]
  v_rcp_f32 v40, v40
  v_rcp_f32 v41, v41
  v_rcp_f32 v42, v42
  v_rcp_f32 v43, v43
  v_rcp_f32 v44, v44
  v_rcp_f32 v45, v45
  v_rcp_f32 v46, v46
  v_rcp_f32 v47, v47
  v_pk_mul_f32 v[40:41], v[40:41], v[88:89]
  v_pk_mul_f32 v[42:43], v[42:43], v[90:91]
  v_pk_mul_f32 v[44:45], v[44:45], v[92:93]
  v_pk_mul_f32 v[46:47], v[46:47], v[94:95]
  v_cvt_pk_bf16_f32 v48, v40, v41
  v_cvt_pk_bf16_f32 v49, v42, v43
  v_cvt_pk_bf16_f32 v50, v44, v45
  v_cvt_pk_bf16_f32 v51, v46, v47
  v_xor_b32 v52, 32, v14
  buffer_store_dwordx4 v[48:51], v52, s[24:27], s46 offen offset:0
  v_pk_mul_f32 v[24:25], v[96:97], v[96:97]
  v_pk_mul_f32 v[26:27], v[98:99], v[98:99]
  v_pk_mul_f32 v[28:29], v[100:101], v[100:101]
  v_pk_mul_f32 v[30:31], v[102:103], v[102:103]
  v_pk_fma_f32 v[24:25], v[24:25], v[16:17], v[16:17] op_sel:[0,1,0] op_sel_hi:[1,1,0]
  v_pk_fma_f32 v[26:27], v[26:27], v[16:17], v[16:17] op_sel:[0,1,0] op_sel_hi:[1,1,0]
  v_pk_fma_f32 v[28:29], v[28:29], v[16:17], v[16:17] op_sel:[0,1,0] op_sel_hi:[1,1,0]
  v_pk_fma_f32 v[30:31], v[30:31], v[16:17], v[16:17] op_sel:[0,1,0] op_sel_hi:[1,1,0]
  v_pk_mul_f32 v[24:25], v[24:25], v[96:97]
  v_pk_mul_f32 v[26:27], v[26:27], v[98:99]
  v_pk_mul_f32 v[28:29], v[28:29], v[100:101]
  v_pk_mul_f32 v[30:31], v[30:31], v[102:103]
  v_exp_f32 v24, v24
  v_exp_f32 v25, v25
  v_exp_f32 v26, v26
  v_exp_f32 v27, v27
  v_exp_f32 v28, v28
  v_exp_f32 v29, v29
  v_exp_f32 v30, v30
  v_exp_f32 v31, v31
  v_pk_add_f32 v[24:25], v[24:25], v[18:19] op_sel_hi:[1,0]
  v_pk_add_f32 v[26:27], v[26:27], v[18:19] op_sel_hi:[1,0]
  v_pk_add_f32 v[28:29], v[28:29], v[18:19] op_sel_hi:[1,0]
  v_pk_add_f32 v[30:31], v[30:31], v[18:19] op_sel_hi:[1,0]
  v_rcp_f32 v24, v24
  v_rcp_f32 v25, v25
  v_rcp_f32 v26, v26
  v_rcp_f32 v27, v27
  v_rcp_f32 v28, v28
  v_rcp_f32 v29, v29
  v_rcp_f32 v30, v30
  v_rcp_f32 v31, v31
  v_pk_mul_f32 v[24:25], v[24:25], v[96:97]
  v_pk_mul_f32 v[26:27], v[26:27], v[98:99]
  v_pk_mul_f32 v[28:29], v[28:29], v[100:101]
  v_pk_mul_f32 v[30:31], v[30:31], v[102:103]
  v_cvt_pk_bf16_f32 v32, v24, v25
  v_cvt_pk_bf16_f32 v33, v26, v27
  v_cvt_pk_bf16_f32 v34, v28, v29
  v_cvt_pk_bf16_f32 v35, v30, v31
  v_xor_b32 v36, 0, v14
  v_add_u32 v36, 4096, v36
  buffer_store_dwordx4 v[32:35], v36, s[24:27], s46 offen
  v_pk_mul_f32 v[40:41], v[104:105], v[104:105]
  v_pk_mul_f32 v[42:43], v[106:107], v[106:107]
  v_pk_mul_f32 v[44:45], v[108:109], v[108:109]
  v_pk_mul_f32 v[46:47], v[110:111], v[110:111]
  v_pk_fma_f32 v[40:41], v[40:41], v[16:17], v[16:17] op_sel:[0,1,0] op_sel_hi:[1,1,0]
  v_pk_fma_f32 v[42:43], v[42:43], v[16:17], v[16:17] op_sel:[0,1,0] op_sel_hi:[1,1,0]
  v_pk_fma_f32 v[44:45], v[44:45], v[16:17], v[16:17] op_sel:[0,1,0] op_sel_hi:[1,1,0]
  v_pk_fma_f32 v[46:47], v[46:47], v[16:17], v[16:17] op_sel:[0,1,0] op_sel_hi:[1,1,0]
  v_pk_mul_f32 v[40:41], v[40:41], v[104:105]
  v_pk_mul_f32 v[42:43], v[42:43], v[106:107]
  v_pk_mul_f32 v[44:45], v[44:45], v[108:109]
  v_pk_mul_f32 v[46:47], v[46:47], v[110:111]
  v_exp_f32 v40, v40
  v_exp_f32 v41, v41
  v_exp_f32 v42, v42
  v_exp_f32 v43, v43
  v_exp_f32 v44, v44
  v_exp_f32 v45, v45
  v_exp_f32 v46, v46
  v_exp_f32 v47, v47
  v_pk_add_f32 v[40:41], v[40:41], v[18:19] op_sel_hi:[1,0]
  v_pk_add_f32 v[42:43], v[42:43], v[18:19] op_sel_hi:[1,0]
  v_pk_add_f32 v[44:45], v[44:45], v[18:19] op_sel_hi:[1,0]
  v_pk_add_f32 v[46:47], v[46:47], v[18:19] op_sel_hi:[1,0]
  v_rcp_f32 v40, v40
  v_rcp_f32 v41, v41
  v_rcp_f32 v42, v42
  v_rcp_f32 v43, v43
  v_rcp_f32 v44, v44
  v_rcp_f32 v45, v45
  v_rcp_f32 v46, v46
  v_rcp_f32 v47, v47
  v_pk_mul_f32 v[40:41], v[40:41], v[104:105]
  v_pk_mul_f32 v[42:43], v[42:43], v[106:107]
  v_pk_mul_f32 v[44:45], v[44:45], v[108:109]
  v_pk_mul_f32 v[46:47], v[46:47], v[110:111]
  v_cvt_pk_bf16_f32 v48, v40, v41
  v_cvt_pk_bf16_f32 v49, v42, v43
  v_cvt_pk_bf16_f32 v50, v44, v45
  v_cvt_pk_bf16_f32 v51, v46, v47
  v_xor_b32 v52, 32, v14
  v_add_u32 v52, 4096, v52
  buffer_store_dwordx4 v[48:51], v52, s[24:27], s46 offen
  v_pk_mul_f32 v[24:25], v[112:113], v[112:113]
  v_pk_mul_f32 v[26:27], v[114:115], v[114:115]
  v_pk_mul_f32 v[28:29], v[116:117], v[116:117]
  v_pk_mul_f32 v[30:31], v[118:119], v[118:119]
  v_pk_fma_f32 v[24:25], v[24:25], v[16:17], v[16:17] op_sel:[0,1,0] op_sel_hi:[1,1,0]
  v_pk_fma_f32 v[26:27], v[26:27], v[16:17], v[16:17] op_sel:[0,1,0] op_sel_hi:[1,1,0]
  v_pk_fma_f32 v[28:29], v[28:29], v[16:17], v[16:17] op_sel:[0,1,0] op_sel_hi:[1,1,0]
  v_pk_fma_f32 v[30:31], v[30:31], v[16:17], v[16:17] op_sel:[0,1,0] op_sel_hi:[1,1,0]
  v_pk_mul_f32 v[24:25], v[24:25], v[112:113]
  v_pk_mul_f32 v[26:27], v[26:27], v[114:115]
  v_pk_mul_f32 v[28:29], v[28:29], v[116:117]
  v_pk_mul_f32 v[30:31], v[30:31], v[118:119]
  v_exp_f32 v24, v24
  v_exp_f32 v25, v25
  v_exp_f32 v26, v26
  v_exp_f32 v27, v27
  v_exp_f32 v28, v28
  v_exp_f32 v29, v29
  v_exp_f32 v30, v30
  v_exp_f32 v31, v31
  v_pk_add_f32 v[24:25], v[24:25], v[18:19] op_sel_hi:[1,0]
  v_pk_add_f32 v[26:27], v[26:27], v[18:19] op_sel_hi:[1,0]
  v_pk_add_f32 v[28:29], v[28:29], v[18:19] op_sel_hi:[1,0]
  v_pk_add_f32 v[30:31], v[30:31], v[18:19] op_sel_hi:[1,0]
  v_rcp_f32 v24, v24
  v_rcp_f32 v25, v25
  v_rcp_f32 v26, v26
  v_rcp_f32 v27, v27
  v_rcp_f32 v28, v28
  v_rcp_f32 v29, v29
  v_rcp_f32 v30, v30
  v_rcp_f32 v31, v31
  v_pk_mul_f32 v[24:25], v[24:25], v[112:113]
  v_pk_mul_f32 v[26:27], v[26:27], v[114:115]
  v_pk_mul_f32 v[28:29], v[28:29], v[116:117]
  v_pk_mul_f32 v[30:31], v[30:31], v[118:119]
  v_cvt_pk_bf16_f32 v32, v24, v25
  v_cvt_pk_bf16_f32 v33, v26, v27
  v_cvt_pk_bf16_f32 v34, v28, v29
  v_cvt_pk_bf16_f32 v35, v30, v31
  v_xor_b32 v36, 64, v14
  buffer_store_dwordx4 v[32:35], v36, s[24:27], s46 offen offset:0
  v_pk_mul_f32 v[40:41], v[120:121], v[120:121]
  v_pk_mul_f32 v[42:43], v[122:123], v[122:123]
  v_pk_mul_f32 v[44:45], v[124:125], v[124:125]
  v_pk_mul_f32 v[46:47], v[126:127], v[126:127]
  v_pk_fma_f32 v[40:41], v[40:41], v[16:17], v[16:17] op_sel:[0,1,0] op_sel_hi:[1,1,0]
  v_pk_fma_f32 v[42:43], v[42:43], v[16:17], v[16:17] op_sel:[0,1,0] op_sel_hi:[1,1,0]
  v_pk_fma_f32 v[44:45], v[44:45], v[16:17], v[16:17] op_sel:[0,1,0] op_sel_hi:[1,1,0]
  v_pk_fma_f32 v[46:47], v[46:47], v[16:17], v[16:17] op_sel:[0,1,0] op_sel_hi:[1,1,0]
  v_pk_mul_f32 v[40:41], v[40:41], v[120:121]
  v_pk_mul_f32 v[42:43], v[42:43], v[122:123]
  v_pk_mul_f32 v[44:45], v[44:45], v[124:125]
  v_pk_mul_f32 v[46:47], v[46:47], v[126:127]
  v_exp_f32 v40, v40
  v_exp_f32 v41, v41
  v_exp_f32 v42, v42
  v_exp_f32 v43, v43
  v_exp_f32 v44, v44
  v_exp_f32 v45, v45
  v_exp_f32 v46, v46
  v_exp_f32 v47, v47
  v_pk_add_f32 v[40:41], v[40:41], v[18:19] op_sel_hi:[1,0]
  v_pk_add_f32 v[42:43], v[42:43], v[18:19] op_sel_hi:[1,0]
  v_pk_add_f32 v[44:45], v[44:45], v[18:19] op_sel_hi:[1,0]
  v_pk_add_f32 v[46:47], v[46:47], v[18:19] op_sel_hi:[1,0]
  v_rcp_f32 v40, v40
  v_rcp_f32 v41, v41
  v_rcp_f32 v42, v42
  v_rcp_f32 v43, v43
  v_rcp_f32 v44, v44
  v_rcp_f32 v45, v45
  v_rcp_f32 v46, v46
  v_rcp_f32 v47, v47
  v_pk_mul_f32 v[40:41], v[40:41], v[120:121]
  v_pk_mul_f32 v[42:43], v[42:43], v[122:123]
  v_pk_mul_f32 v[44:45], v[44:45], v[124:125]
  v_pk_mul_f32 v[46:47], v[46:47], v[126:127]
  v_cvt_pk_bf16_f32 v48, v40, v41
  v_cvt_pk_bf16_f32 v49, v42, v43
  v_cvt_pk_bf16_f32 v50, v44, v45
  v_cvt_pk_bf16_f32 v51, v46, v47
  v_xor_b32 v52, 96, v14
  buffer_store_dwordx4 v[48:51], v52, s[24:27], s46 offen offset:0
  v_pk_mul_f32 v[24:25], v[128:129], v[128:129]
  v_pk_mul_f32 v[26:27], v[130:131], v[130:131]
  v_pk_mul_f32 v[28:29], v[132:133], v[132:133]
  v_pk_mul_f32 v[30:31], v[134:135], v[134:135]
  v_pk_fma_f32 v[24:25], v[24:25], v[16:17], v[16:17] op_sel:[0,1,0] op_sel_hi:[1,1,0]
  v_pk_fma_f32 v[26:27], v[26:27], v[16:17], v[16:17] op_sel:[0,1,0] op_sel_hi:[1,1,0]
  v_pk_fma_f32 v[28:29], v[28:29], v[16:17], v[16:17] op_sel:[0,1,0] op_sel_hi:[1,1,0]
  v_pk_fma_f32 v[30:31], v[30:31], v[16:17], v[16:17] op_sel:[0,1,0] op_sel_hi:[1,1,0]
  v_pk_mul_f32 v[24:25], v[24:25], v[128:129]
  v_pk_mul_f32 v[26:27], v[26:27], v[130:131]
  v_pk_mul_f32 v[28:29], v[28:29], v[132:133]
  v_pk_mul_f32 v[30:31], v[30:31], v[134:135]
  v_exp_f32 v24, v24
  v_exp_f32 v25, v25
  v_exp_f32 v26, v26
  v_exp_f32 v27, v27
  v_exp_f32 v28, v28
  v_exp_f32 v29, v29
  v_exp_f32 v30, v30
  v_exp_f32 v31, v31
  v_pk_add_f32 v[24:25], v[24:25], v[18:19] op_sel_hi:[1,0]
  v_pk_add_f32 v[26:27], v[26:27], v[18:19] op_sel_hi:[1,0]
  v_pk_add_f32 v[28:29], v[28:29], v[18:19] op_sel_hi:[1,0]
  v_pk_add_f32 v[30:31], v[30:31], v[18:19] op_sel_hi:[1,0]
  v_rcp_f32 v24, v24
  v_rcp_f32 v25, v25
  v_rcp_f32 v26, v26
  v_rcp_f32 v27, v27
  v_rcp_f32 v28, v28
  v_rcp_f32 v29, v29
  v_rcp_f32 v30, v30
  v_rcp_f32 v31, v31
  v_pk_mul_f32 v[24:25], v[24:25], v[128:129]
  v_pk_mul_f32 v[26:27], v[26:27], v[130:131]
  v_pk_mul_f32 v[28:29], v[28:29], v[132:133]
  v_pk_mul_f32 v[30:31], v[30:31], v[134:135]
  v_cvt_pk_bf16_f32 v32, v24, v25
  v_cvt_pk_bf16_f32 v33, v26, v27
  v_cvt_pk_bf16_f32 v34, v28, v29
  v_cvt_pk_bf16_f32 v35, v30, v31
  v_xor_b32 v36, 64, v14
  v_add_u32 v36, 4096, v36
  buffer_store_dwordx4 v[32:35], v36, s[24:27], s46 offen
  v_pk_mul_f32 v[40:41], v[136:137], v[136:137]
  v_pk_mul_f32 v[42:43], v[138:139], v[138:139]
  v_pk_mul_f32 v[44:45], v[140:141], v[140:141]
  v_pk_mul_f32 v[46:47], v[142:143], v[142:143]
  v_pk_fma_f32 v[40:41], v[40:41], v[16:17], v[16:17] op_sel:[0,1,0] op_sel_hi:[1,1,0]
  v_pk_fma_f32 v[42:43], v[42:43], v[16:17], v[16:17] op_sel:[0,1,0] op_sel_hi:[1,1,0]
  v_pk_fma_f32 v[44:45], v[44:45], v[16:17], v[16:17] op_sel:[0,1,0] op_sel_hi:[1,1,0]
  v_pk_fma_f32 v[46:47], v[46:47], v[16:17], v[16:17] op_sel:[0,1,0] op_sel_hi:[1,1,0]
  v_pk_mul_f32 v[40:41], v[40:41], v[136:137]
  v_pk_mul_f32 v[42:43], v[42:43], v[138:139]
  v_pk_mul_f32 v[44:45], v[44:45], v[140:141]
  v_pk_mul_f32 v[46:47], v[46:47], v[142:143]
  v_exp_f32 v40, v40
  v_exp_f32 v41, v41
  v_exp_f32 v42, v42
  v_exp_f32 v43, v43
  v_exp_f32 v44, v44
  v_exp_f32 v45, v45
  v_exp_f32 v46, v46
  v_exp_f32 v47, v47
  v_pk_add_f32 v[40:41], v[40:41], v[18:19] op_sel_hi:[1,0]
  v_pk_add_f32 v[42:43], v[42:43], v[18:19] op_sel_hi:[1,0]
  v_pk_add_f32 v[44:45], v[44:45], v[18:19] op_sel_hi:[1,0]
  v_pk_add_f32 v[46:47], v[46:47], v[18:19] op_sel_hi:[1,0]
  v_rcp_f32 v40, v40
  v_rcp_f32 v41, v41
  v_rcp_f32 v42, v42
  v_rcp_f32 v43, v43
  v_rcp_f32 v44, v44
  v_rcp_f32 v45, v45
  v_rcp_f32 v46, v46
  v_rcp_f32 v47, v47
  v_pk_mul_f32 v[40:41], v[40:41], v[136:137]
  v_pk_mul_f32 v[42:43], v[42:43], v[138:139]
  v_pk_mul_f32 v[44:45], v[44:45], v[140:141]
  v_pk_mul_f32 v[46:47], v[46:47], v[142:143]
  v_cvt_pk_bf16_f32 v48, v40, v41
  v_cvt_pk_bf16_f32 v49, v42, v43
  v_cvt_pk_bf16_f32 v50, v44, v45
  v_cvt_pk_bf16_f32 v51, v46, v47
  v_xor_b32 v52, 96, v14
  v_add_u32 v52, 4096, v52
  buffer_store_dwordx4 v[48:51], v52, s[24:27], s46 offen
  s_endpgm
k3_loader:
  s_nop 7
  s_nop 7
  s_sub_u32 s41, s4, 4
  s_lshl_b32 s44, s41, 12
  s_add_u32 s45, s44, 16384
  v_lshlrev_b32 v8, 4, v0
  v_add_u32 v8, s44, v8
  v_lshrrev_b32 v2, 4, v0
  v_lshlrev_b32 v3, 2, v2
  v_and_b32 v4, 15, v0
  v_xor_b32 v3, v3, v4
  v_lshlrev_b32 v3, 4, v3
  s_lshl_b32 s32, s41, 4
  v_add_u32 v2, s32, v2
  s_mov_b32 s32, 7168
  v_mul_lo_u32 v2, v2, s32
  v_add_u32 v9, v2, v3
  v_add_u32 v10, 27648, v9
  v_add_u32 v11, 55296, v9
  v_add_u32 v12, 82944, v9
  s_mul_i32 s34, s28, 524288
  s_lshl_b32 s35, s29, 8
  s_waitcnt lgkmcnt(0)
  s_add_u32 s8, s82, 8388608
  s_addc_u32 s9, s83, 0
  s_mov_b32 s10, 4194304
  s_mov_b32 s11, 0x20000
  s_mov_b32 s12, s72
  s_mov_b32 s13, s73
  s_mov_b32 s14, 14680064
  s_mov_b32 s15, 0x20000
  s_mov_b32 s30, 7
  s_mov_b32 s31, -2
  s_mov_b32 s38, 0
k3_nk13:
  s_add_u32 s30, s30, 1
  s_and_b32 s30, s30, 7
  s_cselect_b32 s32, 0, 1
  s_add_u32 s31, s31, s32
  s_sub_u32 s32, s30, s7
  s_and_b32 s32, s32, 7
  s_cmp_lt_u32 s32, 2
  s_cselect_b32 s32, 1, 0
  s_add_u32 s32, s32, s31
  s_cmp_ge_u32 s32, 4
  s_cbranch_scc1 k3_nk13
  s_lshl_b32 s33, s32, 3
  s_add_u32 s33, s33, s30
  s_mul_i32 s36, s33, 16384
  s_add_u32 s36, s36, s34
  s_mul_i32 s37, s33, 458752
  s_add_u32 s37, s37, s35
  s_add_u32 m0, s38, s44
  s_nop 0
  buffer_load_dwordx4 v8, s[8:11], s36 offen offset:0 lds
  buffer_load_dwordx4 v8, s[8:11], s36 offen offset:1024 lds
  buffer_load_dwordx4 v8, s[8:11], s36 offen offset:2048 lds
  buffer_load_dwordx4 v8, s[8:11], s36 offen offset:3072 lds
  s_add_u32 m0, s38, s45
  s_nop 0
  buffer_load_dwordx4 v9, s[12:15], s37 offen offset:0 lds
  buffer_load_dwordx4 v10, s[12:15], s37 offen offset:1024 lds
  buffer_load_dwordx4 v11, s[12:15], s37 offen offset:2048 lds
  buffer_load_dwordx4 v12, s[12:15], s37 offen offset:3072 lds
  s_add_u32 s38, s38, 32768
  s_cmp_eq_u32 s38, 163840
  s_cselect_b32 s38, 0, s38
k3_nk14:
  s_add_u32 s30, s30, 1
  s_and_b32 s30, s30, 7
  s_cselect_b32 s32, 0, 1
  s_add_u32 s31, s31, s32
  s_sub_u32 s32, s30, s7
  s_and_b32 s32, s32, 7
  s_cmp_lt_u32 s32, 2
  s_cselect_b32 s32, 1, 0
  s_add_u32 s32, s32, s31
  s_cmp_ge_u32 s32, 4
  s_cbranch_scc1 k3_nk14
  s_lshl_b32 s33, s32, 3
  s_add_u32 s33, s33, s30
  s_mul_i32 s36, s33, 16384
  s_add_u32 s36, s36, s34
  s_mul_i32 s37, s33, 458752
  s_add_u32 s37, s37, s35
  s_add_u32 m0, s38, s44
  s_nop 0
  buffer_load_dwordx4 v8, s[8:11], s36 offen offset:0 lds
  buffer_load_dwordx4 v8, s[8:11], s36 offen offset:1024 lds
  buffer_load_dwordx4 v8, s[8:11], s36 offen offset:2048 lds
  buffer_load_dwordx4 v8, s[8:11], s36 offen offset:3072 lds
  s_add_u32 m0, s38, s45
  s_nop 0
  buffer_load_dwordx4 v9, s[12:15], s37 offen offset:0 lds
  buffer_load_dwordx4 v10, s[12:15], s37 offen offset:1024 lds
  buffer_load_dwordx4 v11, s[12:15], s37 offen offset:2048 lds
  buffer_load_dwordx4 v12, s[12:15], s37 offen offset:3072 lds
  s_add_u32 s38, s38, 32768
  s_cmp_eq_u32 s38, 163840
  s_cselect_b32 s38, 0, s38
k3_nk15:
  s_add_u32 s30, s30, 1
  s_and_b32 s30, s30, 7
  s_cselect_b32 s32, 0, 1
  s_add_u32 s31, s31, s32
  s_sub_u32 s32, s30, s7
  s_and_b32 s32, s32, 7
  s_cmp_lt_u32 s32, 2
  s_cselect_b32 s32, 1, 0
  s_add_u32 s32, s32, s31
  s_cmp_ge_u32 s32, 4
  s_cbranch_scc1 k3_nk15
  s_lshl_b32 s33, s32, 3
  s_add_u32 s33, s33, s30
  s_mul_i32 s36, s33, 16384
  s_add_u32 s36, s36, s34
  s_mul_i32 s37, s33, 458752
  s_add_u32 s37, s37, s35
  s_add_u32 m0, s38, s44
  s_nop 0
  buffer_load_dwordx4 v8, s[8:11], s36 offen offset:0 lds
  buffer_load_dwordx4 v8, s[8:11], s36 offen offset:1024 lds
  buffer_load_dwordx4 v8, s[8:11], s36 offen offset:2048 lds
  buffer_load_dwordx4 v8, s[8:11], s36 offen offset:3072 lds
  s_add_u32 m0, s38, s45
  s_nop 0
  buffer_load_dwordx4 v9, s[12:15], s37 offen offset:0 lds
  buffer_load_dwordx4 v10, s[12:15], s37 offen offset:1024 lds
  buffer_load_dwordx4 v11, s[12:15], s37 offen offset:2048 lds
  buffer_load_dwordx4 v12, s[12:15], s37 offen offset:3072 lds
  s_add_u32 s38, s38, 32768
  s_cmp_eq_u32 s38, 163840
  s_cselect_b32 s38, 0, s38
k3_nk16:
  s_add_u32 s30, s30, 1
  s_and_b32 s30, s30, 7
  s_cselect_b32 s32, 0, 1
  s_add_u32 s31, s31, s32
  s_sub_u32 s32, s30, s7
  s_and_b32 s32, s32, 7
  s_cmp_lt_u32 s32, 2
  s_cselect_b32 s32, 1, 0
  s_add_u32 s32, s32, s31
  s_cmp_ge_u32 s32, 4
  s_cbranch_scc1 k3_nk16
  s_lshl_b32 s33, s32, 3
  s_add_u32 s33, s33, s30
  s_mul_i32 s36, s33, 16384
  s_add_u32 s36, s36, s34
  s_mul_i32 s37, s33, 458752
  s_add_u32 s37, s37, s35
  s_add_u32 m0, s38, s44
  s_nop 0
  buffer_load_dwordx4 v8, s[8:11], s36 offen offset:0 lds
  buffer_load_dwordx4 v8, s[8:11], s36 offen offset:1024 lds
  buffer_load_dwordx4 v8, s[8:11], s36 offen offset:2048 lds
  buffer_load_dwordx4 v8, s[8:11], s36 offen offset:3072 lds
  s_add_u32 m0, s38, s45
  s_nop 0
  buffer_load_dwordx4 v9, s[12:15], s37 offen offset:0 lds
  buffer_load_dwordx4 v10, s[12:15], s37 offen offset:1024 lds
  buffer_load_dwordx4 v11, s[12:15], s37 offen offset:2048 lds
  buffer_load_dwordx4 v12, s[12:15], s37 offen offset:3072 lds
  s_add_u32 s38, s38, 32768
  s_cmp_eq_u32 s38, 163840
  s_cselect_b32 s38, 0, s38
  s_mov_b32 s39, 28
k3_lloop:
  s_waitcnt vmcnt(24)
  s_barrier
k3_nk17:
  s_add_u32 s30, s30, 1
  s_and_b32 s30, s30, 7
  s_cselect_b32 s32, 0, 1
  s_add_u32 s31, s31, s32
  s_sub_u32 s32, s30, s7
  s_and_b32 s32, s32, 7
  s_cmp_lt_u32 s32, 2
  s_cselect_b32 s32, 1, 0
  s_add_u32 s32, s32, s31
  s_cmp_ge_u32 s32, 4
  s_cbranch_scc1 k3_nk17
  s_lshl_b32 s33, s32, 3
  s_add_u32 s33, s33, s30
  s_mul_i32 s36, s33, 16384
  s_add_u32 s36, s36, s34
  s_mul_i32 s37, s33, 458752
  s_add_u32 s37, s37, s35
  s_add_u32 m0, s38, s44
  s_nop 0
  buffer_load_dwordx4 v8, s[8:11], s36 offen offset:0 lds
  buffer_load_dwordx4 v8, s[8:11], s36 offen offset:1024 lds
  buffer_load_dwordx4 v8, s[8:11], s36 offen offset:2048 lds
  buffer_load_dwordx4 v8, s[8:11], s36 offen offset:3072 lds
  s_add_u32 m0, s38, s45
  s_nop 0
  buffer_load_dwordx4 v9, s[12:15], s37 offen offset:0 lds
  buffer_load_dwordx4 v10, s[12:15], s37 offen offset:1024 lds
  buffer_load_dwordx4 v11, s[12:15], s37 offen offset:2048 lds
  buffer_load_dwordx4 v12, s[12:15], s37 offen offset:3072 lds
  s_add_u32 s38, s38, 32768
  s_cmp_eq_u32 s38, 163840
  s_cselect_b32 s38, 0, s38
  s_sub_u32 s39, s39, 1
  s_cmp_lg_u32 s39, 0
  s_cbranch_scc1 k3_lloop
  s_waitcnt vmcnt(24)
  s_barrier
  s_waitcnt vmcnt(16)
  s_barrier
  s_waitcnt vmcnt(8)
  s_barrier
  s_waitcnt vmcnt(0)
  s_barrier
k3_end:
  s_endpgm
  s_nop 7
  s_nop 7
.p2align 8
k4a_kernel:
  s_mov_b32 s3, 0
  s_branch k4_body
.p2align 8
k4b_kernel:
  s_mov_b32 s3, 1
k4_body:
  s_cmp_ge_u32 s2, 256
  s_cbranch_scc1 k4_end
  s_load_dwordx16 s[64:79], s[0:1], 0
  s_load_dwordx2 s[80:81], s[0:1], 64
  s_load_dwordx2 s[82:83], s[0:1], 80
  v_lshrrev_b32 v1, 6, v0
  v_and_b32 v0, 63, v0
  v_readfirstlane_b32 s4, v1
  s_lshr_b32 s32, s2, 3
  s_lshr_b32 s5, s32, 3
  s_and_b32 s6, s32, 7
  s_lshl_b32 s7, s5, 1
  s_add_u32 s7, s7, s6
  s_and_b32 s7, s7, 7
  s_and_b32 s32, s2, 7
  s_lshr_b32 s28, s32, 2
  s_lshl_b32 s28, s28, 2
  s_add_u32 s28, s28, s5
  s_and_b32 s29, s32, 3
  s_mul_i32 s29, s29, 8
  s_add_u32 s29, s29, s6
  s_cmp_ge_u32 s4, 4
  s_cbranch_scc1 k4_loader
  v_and_b32 v2, 31, v0
  v_lshrrev_b32 v3, 5, v0
  v_and_b32 v4, 15, v0
  v_lshrrev_b32 v5, 4, v0
  v_lshrrev_b32 v6, 2, v4
  v_and_b32 v7, 3, v0
  s_and_b32 s40, s4, 1
  s_lshr_b32 s41, s4, 1
  s_lshl_b32 s32, s29, 6
  s_lshl_b32 s44, s41, 5
  s_add_u32 s32, s32, s44
  v_add_u32 v13, s32, v2
  v_lshlrev_b32 v14, 11, v13
  v_lshlrev_b32 v15, 4, v3
  v_add_u32 v14, v14, v15
  s_lshl_b32 s32, s28, 8
  s_lshl_b32 s44, s40, 7
  s_add_u32 s32, s32, s44
  v_add_u32 v14, s32, v14
  v_lshlrev_b32 v13, 1, v13
  s_waitcnt lgkmcnt(0)
  s_add_u32 s16, s82, 4194304
  s_addc_u32 s17, s83, 0
  s_mov_b32 s18, 4194304
  s_mov_b32 s19, 0x20000
  s_mov_b32 s20, s78
  s_mov_b32 s21, s79
  s_mov_b32 s22, 4096
  s_mov_b32 s23, 0x20000
  s_cmp_eq_u32 s3, 0
  s_cselect_b32 s24, s82, s80
  s_cselect_b32 s25, s83, s81
  s_cselect_b32 s26, 20971520, 0
  s_add_u32 s24, s24, s26
  s_addc_u32 s25, s25, 0
  s_mov_b32 s26, 4194304
  s_mov_b32 s27, 0x20000
  buffer_load_dwordx4 v[96:99], v14, s[16:19], 0 offen offset:0
  buffer_load_dwordx4 v[100:103], v14, s[16:19], 0 offen offset:32
  buffer_load_dwordx4 v[104:107], v14, s[16:19], 0 offen offset:64
  buffer_load_dwordx4 v[108:111], v14, s[16:19], 0 offen offset:96
  buffer_load_ushort v112, v13, s[20:23], 0 offen
  v_lshrrev_b32 v16, 2, v2
  v_and_b32 v18, 1, v16
  v_lshlrev_b32 v18, 1, v18
  v_and_b32 v17, 4, v16
  v_or_b32 v18, v18, v17
  v_bfe_u32 v17, v16, 1, 1
  v_or_b32 v17, v17, v18
  v_lshlrev_b32 v17, 2, v17
  v_add_u32 v17, v17, v7
  s_lshl_b32 s32, s40, 6
  v_add_u32 v17, s32, v17
  v_bfe_u32 v18, v17, 1, 3
  v_xor_b32 v18, v18, v3
  v_lshlrev_b32 v18, 4, v18
  v_lshlrev_b32 v19, 7, v17
  v_add_u32 v18, v18, v19
  v_xor_b32 v8, 0, v18
  v_xor_b32 v9, 32, v18
  v_xor_b32 v10, 64, v18
  v_xor_b32 v11, 96, v18
  v_lshrrev_b32 v16, 1, v5
  v_lshlrev_b32 v16, 3, v16
  v_add_u32 v16, v16, v6
  v_lshlrev_b32 v16, 7, v16
  v_and_b32 v17, 1, v5
  v_lshlrev_b32 v17, 1, v17
  v_lshrrev_b32 v18, 1, v7
  v_add_u32 v17, v17, v18
  s_lshl_b32 s32, s41, 2
  v_add_u32 v17, s32, v17
  v_lshrrev_b32 v18, 1, v6
  v_lshlrev_b32 v18, 2, v18
  v_xor_b32 v17, v17, v18
  v_lshlrev_b32 v17, 4, v17
  v_and_b32 v18, 1, v7
  v_lshlrev_b32 v18, 3, v18
  v_add3_u32 v12, v16, v17, v18
  s_waitcnt vmcnt(0)
  v_lshlrev_b32 v112, 16, v112
  v_lshlrev_b32 v64, 16, v96
  v_and_b32 v65, 0xffff0000, v96
  v_lshlrev_b32 v66, 16, v97
  v_and_b32 v67, 0xffff0000, v97
  v_lshlrev_b32 v68, 16, v98
  v_and_b32 v69, 0xffff0000, v98
  v_lshlrev_b32 v70, 16, v99
  v_and_b32 v71, 0xffff0000, v99
  v_pk_add_f32 v[64:65], v[64:65], v[112:113] op_sel_hi:[1,0]
  v_pk_add_f32 v[66:67], v[66:67], v[112:113] op_sel_hi:[1,0]
  v_pk_add_f32 v[68:69], v[68:69], v[112:113] op_sel_hi:[1,0]
  v_pk_add_f32 v[70:71], v[70:71], v[112:113] op_sel_hi:[1,0]
  v_lshlrev_b32 v72, 16, v100
  v_and_b32 v73, 0xffff0000, v100
  v_lshlrev_b32 v74, 16, v101
  v_and_b32 v75, 0xffff0000, v101
  v_lshlrev_b32 v76, 16, v102
  v_and_b32 v77, 0xffff0000, v102
  v_lshlrev_b32 v78, 16, v103
  v_and_b32 v79, 0xffff0000, v103
  v_pk_add_f32 v[72:73], v[72:73], v[112:113] op_sel_hi:[1,0]
  v_pk_add_f32 v[74:75], v[74:75], v[112:113] op_sel_hi:[1,0]
  v_pk_add_f32 v[76:77], v[76:77], v[112:113] op_sel_hi:[1,0]
  v_pk_add_f32 v[78:79], v[78:79], v[112:113] op_sel_hi:[1,0]
  v_lshlrev_b32 v80, 16, v104
  v_and_b32 v81, 0xffff0000, v104
  v_lshlrev_b32 v82, 16, v105
  v_and_b32 v83, 0xffff0000, v105
  v_lshlrev_b32 v84, 16, v106
  v_and_b32 v85, 0xffff0000, v106
  v_lshlrev_b32 v86, 16, v107
  v_and_b32 v87, 0xffff0000, v107
  v_pk_add_f32 v[80:81], v[80:81], v[112:113] op_sel_hi:[1,0]
  v_pk_add_f32 v[82:83], v[82:83], v[112:113] op_sel_hi:[1,0]
  v_pk_add_f32 v[84:85], v[84:85], v[112:113] op_sel_hi:[1,0]
  v_pk_add_f32 v[86:87], v[86:87], v[112:113] op_sel_hi:[1,0]
  v_lshlrev_b32 v88, 16, v108
  v_and_b32 v89, 0xffff0000, v108
  v_lshlrev_b32 v90, 16, v109
  v_and_b32 v91, 0xffff0000, v109
  v_lshlrev_b32 v92, 16, v110
  v_and_b32 v93, 0xffff0000, v110
  v_lshlrev_b32 v94, 16, v111
  v_and_b32 v95, 0xffff0000, v111
  v_pk_add_f32 v[88:89], v[88:89], v[112:113] op_sel_hi:[1,0]
  v_pk_add_f32 v[90:91], v[90:91], v[112:113] op_sel_hi:[1,0]
  v_pk_add_f32 v[92:93], v[92:93], v[112:113] op_sel_hi:[1,0]
  v_pk_add_f32 v[94:95], v[94:95], v[112:113] op_sel_hi:[1,0]
  s_mov_b32 s43, 0
  s_mov_b32 s39, 55
  s_barrier
  ds_read_b128 v[16:19], v8
  ds_read_b64_tr_b16 v[24:25], v12 offset:16384
  ds_read_b64_tr_b16 v[26:27], v12 offset:16896
  ds_read_b128 v[20:23], v8 offset:4096
  ds_read_b128 v[28:31], v9
  ds_read_b64_tr_b16 v[36:37], v12 offset:18432
  ds_read_b64_tr_b16 v[38:39], v12 offset:18944
  ds_read_b128 v[32:35], v9 offset:4096
  s_add_u32 s32, s43, 24576
  s_cmp_eq_u32 s32, 147456
  s_cselect_b32 s32, 0, s32
  s_sub_u32 s42, s32, s43
  s_mov_b32 s43, s32
k4_cloop:
  s_waitcnt lgkmcnt(0)
  v_mfma_f32_32x32x16_bf16 v[64:79], v[16:19], v[24:27], v[64:79]
  ds_read_b128 v[40:43], v10
  ds_read_b64_tr_b16 v[48:49], v12 offset:20480
  ds_read_b64_tr_b16 v[50:51], v12 offset:20992
  ds_read_b128 v[44:47], v10 offset:4096
  v_mfma_f32_32x32x16_bf16 v[80:95], v[20:23], v[24:27], v[80:95]
  ds_read_b128 v[52:55], v11
  ds_read_b64_tr_b16 v[60:61], v12 offset:22528
  ds_read_b64_tr_b16 v[62:63], v12 offset:23040
  ds_read_b128 v[56:59], v11 offset:4096
  v_mfma_f32_32x32x16_bf16 v[64:79], v[28:31], v[36:39], v[64:79]
  v_add_u32 v8, s42, v8
  v_add_u32 v9, s42, v9
  v_add_u32 v10, s42, v10
  v_add_u32 v11, s42, v11
  v_mfma_f32_32x32x16_bf16 v[80:95], v[32:35], v[36:39], v[80:95]
  v_add_u32 v12, s42, v12
  s_waitcnt lgkmcnt(0)
  s_barrier
  v_mfma_f32_32x32x16_bf16 v[64:79], v[40:43], v[48:51], v[64:79]
  ds_read_b128 v[16:19], v8
  ds_read_b64_tr_b16 v[24:25], v12 offset:16384
  ds_read_b64_tr_b16 v[26:27], v12 offset:16896
  ds_read_b128 v[20:23], v8 offset:4096
  v_mfma_f32_32x32x16_bf16 v[80:95], v[44:47], v[48:51], v[80:95]
  ds_read_b128 v[28:31], v9
  ds_read_b64_tr_b16 v[36:37], v12 offset:18432
  ds_read_b64_tr_b16 v[38:39], v12 offset:18944
  ds_read_b128 v[32:35], v9 offset:4096
  v_mfma_f32_32x32x16_bf16 v[64:79], v[52:55], v[60:63], v[64:79]
  s_add_u32 s32, s43, 24576
  s_cmp_eq_u32 s32, 147456
  s_cselect_b32 s32, 0, s32
  s_sub_u32 s42, s32, s43
  v_mfma_f32_32x32x16_bf16 v[80:95], v[56:59], v[60:63], v[80:95]
  s_mov_b32 s43, s32
  s_sub_u32 s39, s39, 1
  s_cmp_lg_u32 s39, 0
  s_cbranch_scc1 k4_cloop
  s_waitcnt lgkmcnt(0)
  v_mfma_f32_32x32x16_bf16 v[64:79], v[16:19], v[24:27], v[64:79]
  ds_read_b128 v[40:43], v10
  ds_read_b64_tr_b16 v[48:49], v12 offset:20480
  ds_read_b64_tr_b16 v[50:51], v12 offset:20992
  ds_read_b128 v[44:47], v10 offset:4096
  v_mfma_f32_32x32x16_bf16 v[80:95], v[20:23], v[24:27], v[80:95]
  ds_read_b128 v[52:55], v11
  ds_read_b64_tr_b16 v[60:61], v12 offset:22528
  ds_read_b64_tr_b16 v[62:63], v12 offset:23040
  ds_read_b128 v[56:59], v11 offset:4096
  v_mfma_f32_32x32x16_bf16 v[64:79], v[28:31], v[36:39], v[64:79]
  v_mfma_f32_32x32x16_bf16 v[80:95], v[32:35], v[36:39], v[80:95]
  s_waitcnt lgkmcnt(0)
  v_mfma_f32_32x32x16_bf16 v[64:79], v[40:43], v[48:51], v[64:79]
  v_mfma_f32_32x32x16_bf16 v[80:95], v[44:47], v[48:51], v[80:95]
  v_mfma_f32_32x32x16_bf16 v[64:79], v[52:55], v[60:63], v[64:79]
  v_mfma_f32_32x32x16_bf16 v[80:95], v[56:59], v[60:63], v[80:95]
  s_nop 10
  v_cvt_pk_bf16_f32 v96, v64, v65
  v_cvt_pk_bf16_f32 v97, v66, v67
  v_cvt_pk_bf16_f32 v98, v68, v69
  v_cvt_pk_bf16_f32 v99, v70, v71
  buffer_store_dwordx4 v[96:99], v14, s[24:27], 0 offen offset:0
  v_cvt_pk_bf16_f32 v100, v72, v73
  v_cvt_pk_bf16_f32 v101, v74, v75
  v_cvt_pk_bf16_f32 v102, v76, v77
  v_cvt_pk_bf16_f32 v103, v78, v79
  buffer_store_dwordx4 v[100:103], v14, s[24:27], 0 offen offset:32
  v_cvt_pk_bf16_f32 v104, v80, v81
  v_cvt_pk_bf16_f32 v105, v82, v83
  v_cvt_pk_bf16_f32 v106, v84, v85
  v_cvt_pk_bf16_f32 v107, v86, v87
  buffer_store_dwordx4 v[104:107], v14, s[24:27], 0 offen offset:64
  v_cvt_pk_bf16_f32 v108, v88, v89
  v_cvt_pk_bf16_f32 v109, v90, v91
  v_cvt_pk_bf16_f32 v110, v92, v93
  v_cvt_pk_bf16_f32 v111, v94, v95
  buffer_store_dwordx4 v[108:111], v14, s[24:27], 0 offen offset:96
  s_endpgm
k4_loader:
  s_nop 7
  s_nop 7
  s_sub_u32 s41, s4, 4
  s_lshl_b32 s44, s41, 12
  s_lshl_b32 s45, s41, 11
  s_add_u32 s45, s45, 16384
  v_lshlrev_b32 v8, 4, v0
  v_add_u32 v8, s44, v8
  s_mul_i32 s32, s41, 16
  s_add_u32 s32, s32, 0
  v_lshrrev_b32 v2, 3, v0
  v_add_u32 v2, s32, v2
  v_bfe_u32 v3, v2, 1, 1
  v_lshlrev_b32 v3, 2, v3
  v_and_b32 v4, 7, v0
  v_xor_b32 v3, v3, v4
  v_lshlrev_b32 v3, 4, v3
  s_mov_b32 s32, 4096
  v_mul_lo_u32 v2, v2, s32
  v_add_u32 v9, v2, v3
  s_mul_i32 s32, s41, 16
  s_add_u32 s32, s32, 8
  v_lshrrev_b32 v2, 3, v0
  v_add_u32 v2, s32, v2
  v_bfe_u32 v3, v2, 1, 1
  v_lshlrev_b32 v3, 2, v3
  v_and_b32 v4, 7, v0
  v_xor_b32 v3, v3, v4
  v_lshlrev_b32 v3, 4, v3
  s_mov_b32 s32, 4096
  v_mul_lo_u32 v2, v2, s32
  v_add_u32 v10, v2, v3
  v_subrev_u32 v10, 1024, v10
  s_mul_i32 s34, s28, 917504
  s_lshl_b32 s35, s29, 7
  s_waitcnt lgkmcnt(0)
  s_add_u32 s8, s82, 12582912
  s_addc_u32 s9, s83, 0
  s_mov_b32 s10, 7340032
  s_mov_b32 s11, 0x20000
  s_mov_b32 s12, s76
  s_mov_b32 s13, s77
  s_mov_b32 s14, 14680064
  s_mov_b32 s15, 0x20000
  s_mov_b32 s30, 7
  s_mov_b32 s31, -2
  s_mov_b32 s38, 0
k4_nk18:
  s_add_u32 s30, s30, 1
  s_and_b32 s30, s30, 7
  s_cselect_b32 s32, 0, 1
  s_add_u32 s31, s31, s32
  s_sub_u32 s32, s30, s7
  s_and_b32 s32, s32, 7
  s_cmp_lt_u32 s32, 2
  s_cselect_b32 s32, 1, 0
  s_add_u32 s32, s32, s31
  s_cmp_ge_u32 s32, 7
  s_cbranch_scc1 k4_nk18
  s_lshl_b32 s33, s32, 3
  s_add_u32 s33, s33, s30
  s_mul_i32 s36, s33, 16384
  s_add_u32 s36, s36, s34
  s_mul_i32 s37, s33, 262144
  s_add_u32 s37, s37, s35
  s_add_u32 m0, s38, s44
  s_nop 0
  buffer_load_dwordx4 v8, s[8:11], s36 offen offset:0 lds
  buffer_load_dwordx4 v8, s[8:11], s36 offen offset:1024 lds
  buffer_load_dwordx4 v8, s[8:11], s36 offen offset:2048 lds
  buffer_load_dwordx4 v8, s[8:11], s36 offen offset:3072 lds
  s_add_u32 m0, s38, s45
  s_nop 0
  buffer_load_dwordx4 v9, s[12:15], s37 offen offset:0 lds
  buffer_load_dwordx4 v10, s[12:15], s37 offen offset:1024 lds
  s_add_u32 s38, s38, 24576
  s_cmp_eq_u32 s38, 147456
  s_cselect_b32 s38, 0, s38
k4_nk19:
  s_add_u32 s30, s30, 1
  s_and_b32 s30, s30, 7
  s_cselect_b32 s32, 0, 1
  s_add_u32 s31, s31, s32
  s_sub_u32 s32, s30, s7
  s_and_b32 s32, s32, 7
  s_cmp_lt_u32 s32, 2
  s_cselect_b32 s32, 1, 0
  s_add_u32 s32, s32, s31
  s_cmp_ge_u32 s32, 7
  s_cbranch_scc1 k4_nk19
  s_lshl_b32 s33, s32, 3
  s_add_u32 s33, s33, s30
  s_mul_i32 s36, s33, 16384
  s_add_u32 s36, s36, s34
  s_mul_i32 s37, s33, 262144
  s_add_u32 s37, s37, s35
  s_add_u32 m0, s38, s44
  s_nop 0
  buffer_load_dwordx4 v8, s[8:11], s36 offen offset:0 lds
  buffer_load_dwordx4 v8, s[8:11], s36 offen offset:1024 lds
  buffer_load_dwordx4 v8, s[8:11], s36 offen offset:2048 lds
  buffer_load_dwordx4 v8, s[8:11], s36 offen offset:3072 lds
  s_add_u32 m0, s38, s45
  s_nop 0
  buffer_load_dwordx4 v9, s[12:15], s37 offen offset:0 lds
  buffer_load_dwordx4 v10, s[12:15], s37 offen offset:1024 lds
  s_add_u32 s38, s38, 24576
  s_cmp_eq_u32 s38, 147456
  s_cselect_b32 s38, 0, s38
k4_nk20:
  s_add_u32 s30, s30, 1
  s_and_b32 s30, s30, 7
  s_cselect_b32 s32, 0, 1
  s_add_u32 s31, s31, s32
  s_sub_u32 s32, s30, s7
  s_and_b32 s32, s32, 7
  s_cmp_lt_u32 s32, 2
  s_cselect_b32 s32, 1, 0
  s_add_u32 s32, s32, s31
  s_cmp_ge_u32 s32, 7
  s_cbranch_scc1 k4_nk20
  s_lshl_b32 s33, s32, 3
  s_add_u32 s33, s33, s30
  s_mul_i32 s36, s33, 16384
  s_add_u32 s36, s36, s34
  s_mul_i32 s37, s33, 262144
  s_add_u32 s37, s37, s35
  s_add_u32 m0, s38, s44
  s_nop 0
  buffer_load_dwordx4 v8, s[8:11], s36 offen offset:0 lds
  buffer_load_dwordx4 v8, s[8:11], s36 offen offset:1024 lds
  buffer_load_dwordx4 v8, s[8:11], s36 offen offset:2048 lds
  buffer_load_dwordx4 v8, s[8:11], s36 offen offset:3072 lds
  s_add_u32 m0, s38, s45
  s_nop 0
  buffer_load_dwordx4 v9, s[12:15], s37 offen offset:0 lds
  buffer_load_dwordx4 v10, s[12:15], s37 offen offset:1024 lds
  s_add_u32 s38, s38, 24576
  s_cmp_eq_u32 s38, 147456
  s_cselect_b32 s38, 0, s38
k4_nk21:
  s_add_u32 s30, s30, 1
  s_and_b32 s30, s30, 7
  s_cselect_b32 s32, 0, 1
  s_add_u32 s31, s31, s32
  s_sub_u32 s32, s30, s7
  s_and_b32 s32, s32, 7
  s_cmp_lt_u32 s32, 2
  s_cselect_b32 s32, 1, 0
  s_add_u32 s32, s32, s31
  s_cmp_ge_u32 s32, 7
  s_cbranch_scc1 k4_nk21
  s_lshl_b32 s33, s32, 3
  s_add_u32 s33, s33, s30
  s_mul_i32 s36, s33, 16384
  s_add_u32 s36, s36, s34
  s_mul_i32 s37, s33, 262144
  s_add_u32 s37, s37, s35
  s_add_u32 m0, s38, s44
  s_nop 0
  buffer_load_dwordx4 v8, s[8:11], s36 offen offset:0 lds
  buffer_load_dwordx4 v8, s[8:11], s36 offen offset:1024 lds
  buffer_load_dwordx4 v8, s[8:11], s36 offen offset:2048 lds
  buffer_load_dwordx4 v8, s[8:11], s36 offen offset:3072 lds
  s_add_u32 m0, s38, s45
  s_nop 0
  buffer_load_dwordx4 v9, s[12:15], s37 offen offset:0 lds
  buffer_load_dwordx4 v10, s[12:15], s37 offen offset:1024 lds
  s_add_u32 s38, s38, 24576
  s_cmp_eq_u32 s38, 147456
  s_cselect_b32 s38, 0, s38
k4_nk22:
  s_add_u32 s30, s30, 1
  s_and_b32 s30, s30, 7
  s_cselect_b32 s32, 0, 1
  s_add_u32 s31, s31, s32
  s_sub_u32 s32, s30, s7
  s_and_b32 s32, s32, 7
  s_cmp_lt_u32 s32, 2
  s_cselect_b32 s32, 1, 0
  s_add_u32 s32, s32, s31
  s_cmp_ge_u32 s32, 7
  s_cbranch_scc1 k4_nk22
  s_lshl_b32 s33, s32, 3
  s_add_u32 s33, s33, s30
  s_mul_i32 s36, s33, 16384
  s_add_u32 s36, s36, s34
  s_mul_i32 s37, s33, 262144
  s_add_u32 s37, s37, s35
  s_add_u32 m0, s38, s44
  s_nop 0
  buffer_load_dwordx4 v8, s[8:11], s36 offen offset:0 lds
  buffer_load_dwordx4 v8, s[8:11], s36 offen offset:1024 lds
  buffer_load_dwordx4 v8, s[8:11], s36 offen offset:2048 lds
  buffer_load_dwordx4 v8, s[8:11], s36 offen offset:3072 lds
  s_add_u32 m0, s38, s45
  s_nop 0
  buffer_load_dwordx4 v9, s[12:15], s37 offen offset:0 lds
  buffer_load_dwordx4 v10, s[12:15], s37 offen offset:1024 lds
  s_add_u32 s38, s38, 24576
  s_cmp_eq_u32 s38, 147456
  s_cselect_b32 s38, 0, s38
  s_mov_b32 s39, 51
k4_lloop:
  s_waitcnt vmcnt(24)
  s_barrier
k4_nk23:
  s_add_u32 s30, s30, 1
  s_and_b32 s30, s30, 7
  s_cselect_b32 s32, 0, 1
  s_add_u32 s31, s31, s32
  s_sub_u32 s32, s30, s7
  s_and_b32 s32, s32, 7
  s_cmp_lt_u32 s32, 2
  s_cselect_b32 s32, 1, 0
  s_add_u32 s32, s32, s31
  s_cmp_ge_u32 s32, 7
  s_cbranch_scc1 k4_nk23
  s_lshl_b32 s33, s32, 3
  s_add_u32 s33, s33, s30
  s_mul_i32 s36, s33, 16384
  s_add_u32 s36, s36, s34
  s_mul_i32 s37, s33, 262144
  s_add_u32 s37, s37, s35
  s_add_u32 m0, s38, s44
  s_nop 0
  buffer_load_dwordx4 v8, s[8:11], s36 offen offset:0 lds
  buffer_load_dwordx4 v8, s[8:11], s36 offen offset:1024 lds
  buffer_load_dwordx4 v8, s[8:11], s36 offen offset:2048 lds
  buffer_load_dwordx4 v8, s[8:11], s36 offen offset:3072 lds
  s_add_u32 m0, s38, s45
  s_nop 0
  buffer_load_dwordx4 v9, s[12:15], s37 offen offset:0 lds
  buffer_load_dwordx4 v10, s[12:15], s37 offen offset:1024 lds
  s_add_u32 s38, s38, 24576
  s_cmp_eq_u32 s38, 147456
  s_cselect_b32 s38, 0, s38
  s_sub_u32 s39, s39, 1
  s_cmp_lg_u32 s39, 0
  s_cbranch_scc1 k4_lloop
  s_waitcnt vmcnt(24)
  s_barrier
  s_waitcnt vmcnt(18)
  s_barrier
  s_waitcnt vmcnt(12)
  s_barrier
  s_waitcnt vmcnt(6)
  s_barrier
  s_waitcnt vmcnt(0)
  s_barrier
k4_end:
  s_endpgm
  s_nop 7
  s_nop 7
.section .rodata,"a"
.p2align 6
.amdhsa_kernel k1a_kernel
  .amdhsa_next_free_vgpr 224
  .amdhsa_next_free_sgpr 96
  .amdhsa_accum_offset 224
  .amdhsa_group_segment_fixed_size 0
  .amdhsa_kernarg_size 88
  .amdhsa_user_sgpr_count 2
  .amdhsa_user_sgpr_kernarg_segment_ptr 1
  .amdhsa_system_sgpr_workgroup_id_x 1
.end_amdhsa_kernel
.p2align 6
.amdhsa_kernel k1b_kernel
  .amdhsa_next_free_vgpr 224
  .amdhsa_next_free_sgpr 96
  .amdhsa_accum_offset 224
  .amdhsa_group_segment_fixed_size 0
  .amdhsa_kernarg_size 88
  .amdhsa_user_sgpr_count 2
  .amdhsa_user_sgpr_kernarg_segment_ptr 1
  .amdhsa_system_sgpr_workgroup_id_x 1
.end_amdhsa_kernel
.p2align 6
.amdhsa_kernel k2a_kernel
  .amdhsa_next_free_vgpr 128
  .amdhsa_next_free_sgpr 96
  .amdhsa_accum_offset 128
  .amdhsa_group_segment_fixed_size 0
  .amdhsa_kernarg_size 88
  .amdhsa_user_sgpr_count 2
  .amdhsa_user_sgpr_kernarg_segment_ptr 1
  .amdhsa_system_sgpr_workgroup_id_x 1
.end_amdhsa_kernel
.p2align 6
.amdhsa_kernel k2b_kernel
  .amdhsa_next_free_vgpr 128
  .amdhsa_next_free_sgpr 96
  .amdhsa_accum_offset 128
  .amdhsa_group_segment_fixed_size 0
  .amdhsa_kernarg_size 88
  .amdhsa_user_sgpr_count 2
  .amdhsa_user_sgpr_kernarg_segment_ptr 1
  .amdhsa_system_sgpr_workgroup_id_x 1
.end_amdhsa_kernel
.p2align 6
.amdhsa_kernel k3_kernel
  .amdhsa_next_free_vgpr 160
  .amdhsa_next_free_sgpr 96
  .amdhsa_accum_offset 160
  .amdhsa_group_segment_fixed_size 0
  .amdhsa_kernarg_size 88
  .amdhsa_user_sgpr_count 2
  .amdhsa_user_sgpr_kernarg_segment_ptr 1
  .amdhsa_system_sgpr_workgroup_id_x 1
.end_amdhsa_kernel
.p2align 6
.amdhsa_kernel k4a_kernel
  .amdhsa_next_free_vgpr 128
  .amdhsa_next_free_sgpr 96
  .amdhsa_accum_offset 128
  .amdhsa_group_segment_fixed_size 0
  .amdhsa_kernarg_size 88
  .amdhsa_user_sgpr_count 2
  .amdhsa_user_sgpr_kernarg_segment_ptr 1
  .amdhsa_system_sgpr_workgroup_id_x 1
.end_amdhsa_kernel
.p2align 6
.amdhsa_kernel k4b_kernel
  .amdhsa_next_free_vgpr 128
  .amdhsa_next_free_sgpr 96
  .amdhsa_accum_offset 128
  .amdhsa_group_segment_fixed_size 0
  .amdhsa_kernarg_size 88
  .amdhsa_user_sgpr_count 2
  .amdhsa_user_sgpr_kernarg_segment_ptr 1
  .amdhsa_system_sgpr_workgroup_id_x 1
.end_amdhsa_kernel
```

```asm
; @launch kernel=k0_kernel grid=(256,1,1) block=(512,1,1) lds=0
; @launch kernel=mega_kernel grid=(256,1,1) block=(512,1,1) lds=163840
.amdgcn_target "amdgcn-amd-amdhsa--gfx950"
.text
.p2align 8
k0_kernel:
  s_cmp_ge_u32 s2, 256
  s_cbranch_scc1 k0_end
  s_load_dwordx16 s[64:79], s[0:1], 0
  s_load_dwordx2 s[84:85], s[0:1], 80
  v_lshrrev_b32 v1, 6, v0
  v_lshlrev_b32 v20, 4, v0
  v_and_b32 v0, 63, v0
  v_readfirstlane_b32 s4, v1
  s_lshl_b32 s30, s2, 3
  s_nop 0
  s_add_u32 s30, s30, s4
  s_lshl_b32 s31, s30, 11
  v_lshlrev_b32 v2, 5, v0
  s_lshl_b32 s32, s2, 2
  s_and_b32 s33, s4, 3
  s_add_u32 s32, s32, s33
  s_lshl_b32 s32, s32, 13
  v_lshlrev_b32 v3, 7, v0
  v_add_u32 v3, s32, v3
  v_subrev_u32 v4, 6291456, v3
  s_waitcnt lgkmcnt(0)
  s_mov_b32 s8, s64
  s_mov_b32 s9, s65
  s_mov_b32 s10, 4194304
  s_mov_b32 s11, 0x20000
  buffer_load_dwordx4 v[8:11], v2, s[8:11], s31 offen
  buffer_load_dwordx4 v[12:15], v2, s[8:11], s31 offen offset:16
  s_mov_b32 s12, s66
  s_mov_b32 s13, s67
  s_mov_b32 s14, 6291456
  s_mov_b32 s15, 0x20000
  s_mov_b32 s16, s68
  s_mov_b32 s17, s69
  s_mov_b32 s18, 2097152
  s_mov_b32 s19, 0x20000
  s_mov_b32 s24, s72
  s_mov_b32 s25, s73
  s_mov_b32 s26, 0
  s_mov_b32 s27, 0x20000
  s_sub_u32 s33, s4, 4
  s_lshl_b32 s33, s33, 8
  s_add_u32 s33, s33, s2
  s_lshl_b32 s33, s33, 13
  v_lshlrev_b32 v7, 7, v0
  s_cmp_ge_u32 s4, 4
  s_cbranch_scc1 k0_nw
  buffer_load_dword v5, v3, s[12:15], 0 offen
  buffer_load_dword v6, v4, s[16:19], 0 offen
  s_branch k0_nx
k0_nw:
  buffer_load_dword v5, v7, s[24:27], s33 offen
k0_nx:
  s_mov_b32 s20, s84
  s_mov_b32 s21, s85
  s_mov_b32 s22, 67108864
  s_mov_b32 s23, 0x20000
  s_cmp_eq_u32 s4, 0
  s_cselect_b32 s33, 0, -1
  v_mov_b32 v16, s33
  v_mov_b32 v17, s33
  v_mov_b32 v18, s33
  v_mov_b32 v19, s33
  s_mov_b32 s34, 20971520
  s_cselect_b32 s34, 29360128, s34
  s_cmp_eq_u32 s4, 2
  s_cselect_b32 s34, 54525952, s34
  s_lshl_b32 s35, s2, 10
  s_add_u32 s34, s34, s35
  v_lshlrev_b32 v20, 4, v0
  s_cmp_ge_u32 s4, 3
  s_cbranch_scc1 k0_nr
  buffer_store_dwordx4 v[16:19], v20, s[20:23], s34 offen
k0_nr:
  v_mov_b32 v22, 0
  v_mov_b32 v23, 0
  v_mov_b32 v21, 0x3f803f80
  v_lshrrev_b32 v24, 3, v0
  v_lshlrev_b32 v24, 14, v24
  s_lshl_b32 s36, s30, 3
  s_add_u32 s36, s36, 22020096
  s_waitcnt vmcnt(0)
  v_dot2c_f32_bf16 v22, v21, v8
  v_dot2c_f32_bf16 v23, v8, v8
  v_dot2c_f32_bf16 v22, v21, v9
  v_dot2c_f32_bf16 v23, v9, v9
  v_dot2c_f32_bf16 v22, v21, v10
  v_dot2c_f32_bf16 v23, v10, v10
  v_dot2c_f32_bf16 v22, v21, v11
  v_dot2c_f32_bf16 v23, v11, v11
  v_dot2c_f32_bf16 v22, v21, v12
  v_dot2c_f32_bf16 v23, v12, v12
  v_dot2c_f32_bf16 v22, v21, v13
  v_dot2c_f32_bf16 v23, v13, v13
  v_dot2c_f32_bf16 v22, v21, v14
  v_dot2c_f32_bf16 v23, v14, v14
  v_dot2c_f32_bf16 v22, v21, v15
  v_dot2c_f32_bf16 v23, v15, v15
  s_nop 1
  v_add_f32_dpp v22, v22, v22 quad_perm:[1,0,3,2] row_mask:0xf bank_mask:0xf
  v_add_f32_dpp v23, v23, v23 quad_perm:[1,0,3,2] row_mask:0xf bank_mask:0xf
  s_nop 0
  v_add_f32_dpp v22, v22, v22 quad_perm:[2,3,0,1] row_mask:0xf bank_mask:0xf
  v_add_f32_dpp v23, v23, v23 quad_perm:[2,3,0,1] row_mask:0xf bank_mask:0xf
  s_nop 0
  v_add_f32_dpp v22, v22, v22 row_half_mirror row_mask:0xf bank_mask:0xf
  v_add_f32_dpp v23, v23, v23 row_half_mirror row_mask:0xf bank_mask:0xf
  s_mov_b32 exec_lo, 0x01010101
  s_mov_b32 exec_hi, 0x01010101
  buffer_store_dwordx2 v[22:23], v24, s[20:23], s36 offen
k0_end:
  s_endpgm
  s_nop 7
  s_nop 7
.p2align 8
mega_kernel:
  s_cmp_ge_u32 s2, 256
  s_cbranch_scc1 mega_end
  s_load_dwordx16 s[64:79], s[0:1], 0
  s_load_dwordx2 s[80:81], s[0:1], 64
  s_load_dwordx2 s[84:85], s[0:1], 80
  v_lshrrev_b32 v1, 6, v0
  v_and_b32 v0, 63, v0
  v_readfirstlane_b32 s4, v1
  s_mov_b32 s3, 0
  s_nop 0
  s_cmp_ge_u32 s4, 4
  s_cbranch_scc1 L_start
  s_lshr_b32 s32, s2, 3
  s_lshr_b32 s5, s32, 3
  s_and_b32 s6, s32, 7
  s_lshl_b32 s7, s5, 1
  s_add_u32 s7, s7, s6
  s_and_b32 s7, s7, 7
  s_and_b32 s32, s2, 7
  s_lshr_b32 s28, s32, 1
  s_lshl_b32 s28, s28, 2
  s_add_u32 s28, s28, s5
  s_and_b32 s29, s32, 1
  s_mul_i32 s29, s29, 8
  s_add_u32 s29, s29, s6
  s_mov_b32 s30, 7
  s_mov_b32 s31, -1
  v_and_b32 v4, 15, v0
  v_lshrrev_b32 v5, 4, v0
  v_lshrrev_b32 v6, 2, v4
  v_and_b32 v7, 3, v0
  v_lshrrev_b32 v3, 5, v0
  v_and_b32 v2, 1, v5
  v_lshl_or_b32 v3, v2, 1, v3
  v_lshl_add_u32 v21, v5, 3, v6
  v_lshlrev_b32 v21, 7, v21
  v_lshl_add_u32 v21, v7, 3, v21
  v_lshrrev_b32 v22, 1, v6
  v_lshl_or_b32 v22, v2, 1, v22
  v_lshl_add_u32 v21, v22, 5, v21
  v_add_u32 v21, 18432, v21
  v_xor_b32 v8, 0, v21
  s_lshl_b32 s32, s4, 5
  v_xor_b32 v8, s32, v8
  v_lshrrev_b32 v21, 1, v4
  v_xor_b32 v21, v21, v5
  v_lshlrev_b32 v21, 4, v21
  v_lshlrev_b32 v22, 7, v4
  v_add_u32 v9, v21, v22
  v_xor_b32 v10, 64, v9
  v_and_b32 v21, 1, v4
  v_mul_u32_u24 v21, 28800, v21
  v_lshrrev_b32 v22, 1, v4
  v_mul_u32_u24 v22, 400, v22
  v_lshlrev_b32 v23, 3, v5
  v_add3_u32 v11, v21, v22, v23
  s_add_u32 s32, s32, 43008
  v_add_u32 v11, s32, v11
  v_lshlrev_b32 v12, 3, v4
  v_add_u32 v12, 129024, v12
  v_mov_b64 v[112:113], 0
  v_mov_b64 v[114:115], 0
  v_mov_b64 v[116:117], 0
  v_mov_b64 v[118:119], 0
  v_mov_b64 v[120:121], 0
  v_mov_b64 v[122:123], 0
  v_mov_b64 v[124:125], 0
  v_mov_b64 v[126:127], 0
  v_mov_b64 v[128:129], 0
  v_mov_b64 v[130:131], 0
  v_mov_b64 v[132:133], 0
  v_mov_b64 v[134:135], 0
  v_mov_b64 v[136:137], 0
  v_mov_b64 v[138:139], 0
  v_mov_b64 v[140:141], 0
  v_mov_b64 v[142:143], 0
  v_mov_b64 v[144:145], 0
  v_mov_b64 v[146:147], 0
  v_mov_b64 v[148:149], 0
  v_mov_b64 v[150:151], 0
  v_mov_b64 v[152:153], 0
  v_mov_b64 v[154:155], 0
  v_mov_b64 v[156:157], 0
  v_mov_b64 v[158:159], 0
  v_mov_b64 v[160:161], 0
  v_mov_b64 v[162:163], 0
  v_mov_b64 v[164:165], 0
  v_mov_b64 v[166:167], 0
  v_mov_b64 v[168:169], 0
  v_mov_b64 v[170:171], 0
  v_mov_b64 v[172:173], 0
  v_mov_b64 v[174:175], 0
  v_mov_b64 v[176:177], 0
  v_mov_b64 v[178:179], 0
  v_mov_b64 v[180:181], 0
  v_mov_b64 v[182:183], 0
  v_mov_b64 v[184:185], 0
  v_mov_b64 v[186:187], 0
  v_mov_b64 v[188:189], 0
  v_mov_b64 v[190:191], 0
  v_mov_b64 v[192:193], 0
  v_mov_b64 v[194:195], 0
  v_mov_b64 v[196:197], 0
  v_mov_b64 v[198:199], 0
  v_mov_b64 v[200:201], 0
  v_mov_b64 v[202:203], 0
  v_mov_b64 v[204:205], 0
  v_mov_b64 v[206:207], 0
  v_mov_b64 v[208:209], 0
  v_mov_b64 v[210:211], 0
  v_mov_b64 v[212:213], 0
  v_mov_b64 v[214:215], 0
  v_mov_b64 v[216:217], 0
  v_mov_b64 v[218:219], 0
  s_waitcnt lgkmcnt(0)
  s_mov_b32 s82, s84
  s_mov_b32 s83, s85
C_top:
  s_nop 7
  s_nop 7
  s_mov_b32 s43, 0
  s_mov_b32 s39, 15
  s_barrier
  ds_read_b64_tr_b16 v[16:17], v8 offset:0
  ds_read_b64_tr_b16 v[18:19], v8 offset:512
  ds_read_b128 v[28:31], v9 offset:0
  ds_read_b64_tr_b16 v[20:21], v8 offset:8192
  ds_read_b64_tr_b16 v[22:23], v8 offset:8704
  ds_read_b64_tr_b16 v[24:25], v8 offset:16384
  ds_read_b64_tr_b16 v[26:27], v8 offset:16896
  ds_read_b128 v[32:35], v9 offset:2048
  ds_read_b128 v[36:39], v9 offset:4096
  ds_read_b128 v[40:43], v9 offset:6144
  ds_read_b128 v[44:47], v9 offset:8192
  ds_read_b128 v[48:51], v9 offset:10240
  ds_read_b128 v[52:55], v9 offset:12288
  ds_read_b128 v[56:59], v9 offset:14336
  ds_read_b128 v[60:63], v9 offset:16384
  s_add_u32 s40, s43, 43008
  s_cmp_eq_u32 s40, 129024
  s_cselect_b32 s40, 0, s40
  s_sub_u32 s42, s40, s43
  s_mov_b32 s43, s40
cl1:
  s_waitcnt lgkmcnt(12)
  v_mfma_f32_16x16x32_bf16 v[112:115], v[16:19], v[28:31], v[112:115]
  ds_read_b64_tr_b16 v[64:65], v8 offset:4096
  s_waitcnt lgkmcnt(11)
  v_mfma_f32_16x16x32_bf16 v[148:151], v[20:23], v[28:31], v[148:151]
  ds_read_b64_tr_b16 v[66:67], v8 offset:4608
  s_waitcnt lgkmcnt(10)
  v_mfma_f32_16x16x32_bf16 v[184:187], v[24:27], v[28:31], v[184:187]
  ds_read_b128 v[76:79], v10 offset:0
  s_waitcnt lgkmcnt(10)
  v_mfma_f32_16x16x32_bf16 v[116:119], v[16:19], v[32:35], v[116:119]
  ds_read_b64_tr_b16 v[68:69], v8 offset:12288
  v_mfma_f32_16x16x32_bf16 v[152:155], v[20:23], v[32:35], v[152:155]
  ds_read_b64_tr_b16 v[70:71], v8 offset:12800
  v_mfma_f32_16x16x32_bf16 v[188:191], v[24:27], v[32:35], v[188:191]
  ds_read_b64_tr_b16 v[72:73], v8 offset:20480
  s_waitcnt lgkmcnt(12)
  v_mfma_f32_16x16x32_bf16 v[120:123], v[16:19], v[36:39], v[120:123]
  ds_read_b64_tr_b16 v[74:75], v8 offset:20992
  v_add_u32 v8, s42, v8
  v_mfma_f32_16x16x32_bf16 v[156:159], v[20:23], v[36:39], v[156:159]
  ds_read_b128 v[80:83], v10 offset:2048
  v_mfma_f32_16x16x32_bf16 v[192:195], v[24:27], v[36:39], v[192:195]
  ds_read_b128 v[84:87], v10 offset:4096
  s_waitcnt lgkmcnt(14)
  v_mfma_f32_16x16x32_bf16 v[124:127], v[16:19], v[40:43], v[124:127]
  ds_read_b128 v[88:91], v10 offset:6144
  v_mfma_f32_16x16x32_bf16 v[160:163], v[20:23], v[40:43], v[160:163]
  ds_read_b128 v[92:95], v10 offset:8192
  v_mfma_f32_16x16x32_bf16 v[196:199], v[24:27], v[40:43], v[196:199]
  ds_read_b128 v[96:99], v10 offset:10240
  s_waitcnt lgkmcnt(15)
  v_mfma_f32_16x16x32_bf16 v[128:131], v[16:19], v[44:47], v[128:131]
  ds_read_b128 v[100:103], v10 offset:12288
  v_mfma_f32_16x16x32_bf16 v[164:167], v[20:23], v[44:47], v[164:167]
  ds_read_b128 v[104:107], v10 offset:14336
  v_mfma_f32_16x16x32_bf16 v[200:203], v[24:27], v[44:47], v[200:203]
  ds_read_b128 v[108:111], v10 offset:16384
  v_add_u32 v9, s42, v9
  v_add_u32 v10, s42, v10
  s_waitcnt lgkmcnt(15)
  v_mfma_f32_16x16x32_bf16 v[132:135], v[16:19], v[48:51], v[132:135]
  v_mfma_f32_16x16x32_bf16 v[168:171], v[20:23], v[48:51], v[168:171]
  v_mfma_f32_16x16x32_bf16 v[204:207], v[24:27], v[48:51], v[204:207]
  s_waitcnt lgkmcnt(15)
  v_mfma_f32_16x16x32_bf16 v[136:139], v[16:19], v[52:55], v[136:139]
  v_mfma_f32_16x16x32_bf16 v[172:175], v[20:23], v[52:55], v[172:175]
  v_mfma_f32_16x16x32_bf16 v[208:211], v[24:27], v[52:55], v[208:211]
  s_waitcnt lgkmcnt(15)
  v_mfma_f32_16x16x32_bf16 v[140:143], v[16:19], v[56:59], v[140:143]
  v_mfma_f32_16x16x32_bf16 v[176:179], v[20:23], v[56:59], v[176:179]
  v_mfma_f32_16x16x32_bf16 v[212:215], v[24:27], v[56:59], v[212:215]
  s_waitcnt lgkmcnt(15)
  v_mfma_f32_16x16x32_bf16 v[144:147], v[16:19], v[60:63], v[144:147]
  v_mfma_f32_16x16x32_bf16 v[180:183], v[20:23], v[60:63], v[180:183]
  v_mfma_f32_16x16x32_bf16 v[216:219], v[24:27], v[60:63], v[216:219]
  s_waitcnt lgkmcnt(0)
  s_barrier
  v_mfma_f32_16x16x32_bf16 v[112:115], v[64:67], v[76:79], v[112:115]
  ds_read_b64_tr_b16 v[16:17], v8 offset:0
  s_add_u32 s40, s43, 43008
  v_mfma_f32_16x16x32_bf16 v[148:151], v[68:71], v[76:79], v[148:151]
  ds_read_b64_tr_b16 v[18:19], v8 offset:512
  s_cmp_eq_u32 s40, 129024
  v_mfma_f32_16x16x32_bf16 v[184:187], v[72:75], v[76:79], v[184:187]
  ds_read_b128 v[28:31], v9 offset:0
  s_cselect_b32 s40, 0, s40
  v_mfma_f32_16x16x32_bf16 v[116:119], v[64:67], v[80:83], v[116:119]
  ds_read_b64_tr_b16 v[20:21], v8 offset:8192
  s_sub_u32 s42, s40, s43
  v_mfma_f32_16x16x32_bf16 v[152:155], v[68:71], v[80:83], v[152:155]
  ds_read_b64_tr_b16 v[22:23], v8 offset:8704
  s_mov_b32 s43, s40
  v_mfma_f32_16x16x32_bf16 v[188:191], v[72:75], v[80:83], v[188:191]
  ds_read_b64_tr_b16 v[24:25], v8 offset:16384
  v_mfma_f32_16x16x32_bf16 v[120:123], v[64:67], v[84:87], v[120:123]
  ds_read_b64_tr_b16 v[26:27], v8 offset:16896
  v_mfma_f32_16x16x32_bf16 v[156:159], v[68:71], v[84:87], v[156:159]
  ds_read_b128 v[32:35], v9 offset:2048
  v_mfma_f32_16x16x32_bf16 v[192:195], v[72:75], v[84:87], v[192:195]
  ds_read_b128 v[36:39], v9 offset:4096
  v_mfma_f32_16x16x32_bf16 v[124:127], v[64:67], v[88:91], v[124:127]
  ds_read_b128 v[40:43], v9 offset:6144
  v_mfma_f32_16x16x32_bf16 v[160:163], v[68:71], v[88:91], v[160:163]
  ds_read_b128 v[44:47], v9 offset:8192
  v_mfma_f32_16x16x32_bf16 v[196:199], v[72:75], v[88:91], v[196:199]
  ds_read_b128 v[48:51], v9 offset:10240
  v_mfma_f32_16x16x32_bf16 v[128:131], v[64:67], v[92:95], v[128:131]
  ds_read_b128 v[52:55], v9 offset:12288
  v_mfma_f32_16x16x32_bf16 v[164:167], v[68:71], v[92:95], v[164:167]
  ds_read_b128 v[56:59], v9 offset:14336
  v_mfma_f32_16x16x32_bf16 v[200:203], v[72:75], v[92:95], v[200:203]
  ds_read_b128 v[60:63], v9 offset:16384
  v_mfma_f32_16x16x32_bf16 v[132:135], v[64:67], v[96:99], v[132:135]
  v_mfma_f32_16x16x32_bf16 v[168:171], v[68:71], v[96:99], v[168:171]
  v_mfma_f32_16x16x32_bf16 v[204:207], v[72:75], v[96:99], v[204:207]
  v_mfma_f32_16x16x32_bf16 v[136:139], v[64:67], v[100:103], v[136:139]
  v_mfma_f32_16x16x32_bf16 v[172:175], v[68:71], v[100:103], v[172:175]
  v_mfma_f32_16x16x32_bf16 v[208:211], v[72:75], v[100:103], v[208:211]
  v_mfma_f32_16x16x32_bf16 v[140:143], v[64:67], v[104:107], v[140:143]
  v_mfma_f32_16x16x32_bf16 v[176:179], v[68:71], v[104:107], v[176:179]
  v_mfma_f32_16x16x32_bf16 v[212:215], v[72:75], v[104:107], v[212:215]
  v_mfma_f32_16x16x32_bf16 v[144:147], v[64:67], v[108:111], v[144:147]
  v_mfma_f32_16x16x32_bf16 v[180:183], v[68:71], v[108:111], v[180:183]
  v_mfma_f32_16x16x32_bf16 v[216:219], v[72:75], v[108:111], v[216:219]
  s_sub_u32 s39, s39, 1
  s_cmp_lg_u32 s39, 0
  s_cbranch_scc1 cl1
  s_waitcnt lgkmcnt(12)
  v_mfma_f32_16x16x32_bf16 v[112:115], v[16:19], v[28:31], v[112:115]
  ds_read_b64_tr_b16 v[64:65], v8 offset:4096
  s_waitcnt lgkmcnt(11)
  v_mfma_f32_16x16x32_bf16 v[148:151], v[20:23], v[28:31], v[148:151]
  ds_read_b64_tr_b16 v[66:67], v8 offset:4608
  s_waitcnt lgkmcnt(10)
  v_mfma_f32_16x16x32_bf16 v[184:187], v[24:27], v[28:31], v[184:187]
  ds_read_b128 v[76:79], v10 offset:0
  s_waitcnt lgkmcnt(10)
  v_mfma_f32_16x16x32_bf16 v[116:119], v[16:19], v[32:35], v[116:119]
  ds_read_b64_tr_b16 v[68:69], v8 offset:12288
  v_mfma_f32_16x16x32_bf16 v[152:155], v[20:23], v[32:35], v[152:155]
  ds_read_b64_tr_b16 v[70:71], v8 offset:12800
  v_mfma_f32_16x16x32_bf16 v[188:191], v[24:27], v[32:35], v[188:191]
  ds_read_b64_tr_b16 v[72:73], v8 offset:20480
  s_waitcnt lgkmcnt(12)
  v_mfma_f32_16x16x32_bf16 v[120:123], v[16:19], v[36:39], v[120:123]
  ds_read_b64_tr_b16 v[74:75], v8 offset:20992
  v_mfma_f32_16x16x32_bf16 v[156:159], v[20:23], v[36:39], v[156:159]
  ds_read_b128 v[80:83], v10 offset:2048
  v_mfma_f32_16x16x32_bf16 v[192:195], v[24:27], v[36:39], v[192:195]
  ds_read_b128 v[84:87], v10 offset:4096
  s_waitcnt lgkmcnt(14)
  v_mfma_f32_16x16x32_bf16 v[124:127], v[16:19], v[40:43], v[124:127]
  ds_read_b128 v[88:91], v10 offset:6144
  v_mfma_f32_16x16x32_bf16 v[160:163], v[20:23], v[40:43], v[160:163]
  ds_read_b128 v[92:95], v10 offset:8192
  v_mfma_f32_16x16x32_bf16 v[196:199], v[24:27], v[40:43], v[196:199]
  ds_read_b128 v[96:99], v10 offset:10240
  s_waitcnt lgkmcnt(15)
  v_mfma_f32_16x16x32_bf16 v[128:131], v[16:19], v[44:47], v[128:131]
  ds_read_b128 v[100:103], v10 offset:12288
  v_mfma_f32_16x16x32_bf16 v[164:167], v[20:23], v[44:47], v[164:167]
  ds_read_b128 v[104:107], v10 offset:14336
  v_mfma_f32_16x16x32_bf16 v[200:203], v[24:27], v[44:47], v[200:203]
  ds_read_b128 v[108:111], v10 offset:16384
  s_waitcnt lgkmcnt(15)
  v_mfma_f32_16x16x32_bf16 v[132:135], v[16:19], v[48:51], v[132:135]
  v_mfma_f32_16x16x32_bf16 v[168:171], v[20:23], v[48:51], v[168:171]
  v_mfma_f32_16x16x32_bf16 v[204:207], v[24:27], v[48:51], v[204:207]
  s_waitcnt lgkmcnt(15)
  v_mfma_f32_16x16x32_bf16 v[136:139], v[16:19], v[52:55], v[136:139]
  v_mfma_f32_16x16x32_bf16 v[172:175], v[20:23], v[52:55], v[172:175]
  v_mfma_f32_16x16x32_bf16 v[208:211], v[24:27], v[52:55], v[208:211]
  s_waitcnt lgkmcnt(15)
  v_mfma_f32_16x16x32_bf16 v[140:143], v[16:19], v[56:59], v[140:143]
  v_mfma_f32_16x16x32_bf16 v[176:179], v[20:23], v[56:59], v[176:179]
  v_mfma_f32_16x16x32_bf16 v[212:215], v[24:27], v[56:59], v[212:215]
  s_waitcnt lgkmcnt(15)
  v_mfma_f32_16x16x32_bf16 v[144:147], v[16:19], v[60:63], v[144:147]
  v_mfma_f32_16x16x32_bf16 v[180:183], v[20:23], v[60:63], v[180:183]
  v_mfma_f32_16x16x32_bf16 v[216:219], v[24:27], v[60:63], v[216:219]
  s_waitcnt lgkmcnt(12)
  v_mfma_f32_16x16x32_bf16 v[112:115], v[64:67], v[76:79], v[112:115]
  s_waitcnt lgkmcnt(10)
  v_mfma_f32_16x16x32_bf16 v[148:151], v[68:71], v[76:79], v[148:151]
  s_waitcnt lgkmcnt(8)
  v_mfma_f32_16x16x32_bf16 v[184:187], v[72:75], v[76:79], v[184:187]
  s_waitcnt lgkmcnt(7)
  v_mfma_f32_16x16x32_bf16 v[116:119], v[64:67], v[80:83], v[116:119]
  v_mfma_f32_16x16x32_bf16 v[152:155], v[68:71], v[80:83], v[152:155]
  v_mfma_f32_16x16x32_bf16 v[188:191], v[72:75], v[80:83], v[188:191]
  s_waitcnt lgkmcnt(6)
  v_mfma_f32_16x16x32_bf16 v[120:123], v[64:67], v[84:87], v[120:123]
  v_mfma_f32_16x16x32_bf16 v[156:159], v[68:71], v[84:87], v[156:159]
  v_mfma_f32_16x16x32_bf16 v[192:195], v[72:75], v[84:87], v[192:195]
  s_waitcnt lgkmcnt(5)
  v_mfma_f32_16x16x32_bf16 v[124:127], v[64:67], v[88:91], v[124:127]
  v_mfma_f32_16x16x32_bf16 v[160:163], v[68:71], v[88:91], v[160:163]
  v_mfma_f32_16x16x32_bf16 v[196:199], v[72:75], v[88:91], v[196:199]
  s_waitcnt lgkmcnt(4)
  v_mfma_f32_16x16x32_bf16 v[128:131], v[64:67], v[92:95], v[128:131]
  v_mfma_f32_16x16x32_bf16 v[164:167], v[68:71], v[92:95], v[164:167]
  v_mfma_f32_16x16x32_bf16 v[200:203], v[72:75], v[92:95], v[200:203]
  s_waitcnt lgkmcnt(3)
  v_mfma_f32_16x16x32_bf16 v[132:135], v[64:67], v[96:99], v[132:135]
  v_mfma_f32_16x16x32_bf16 v[168:171], v[68:71], v[96:99], v[168:171]
  v_mfma_f32_16x16x32_bf16 v[204:207], v[72:75], v[96:99], v[204:207]
  s_waitcnt lgkmcnt(2)
  v_mfma_f32_16x16x32_bf16 v[136:139], v[64:67], v[100:103], v[136:139]
  v_mfma_f32_16x16x32_bf16 v[172:175], v[68:71], v[100:103], v[172:175]
  v_mfma_f32_16x16x32_bf16 v[208:211], v[72:75], v[100:103], v[208:211]
  s_waitcnt lgkmcnt(1)
  v_mfma_f32_16x16x32_bf16 v[140:143], v[64:67], v[104:107], v[140:143]
  v_mfma_f32_16x16x32_bf16 v[176:179], v[68:71], v[104:107], v[176:179]
  v_mfma_f32_16x16x32_bf16 v[212:215], v[72:75], v[104:107], v[212:215]
  s_waitcnt lgkmcnt(0)
  v_mfma_f32_16x16x32_bf16 v[144:147], v[64:67], v[108:111], v[144:147]
  v_mfma_f32_16x16x32_bf16 v[180:183], v[68:71], v[108:111], v[180:183]
  v_mfma_f32_16x16x32_bf16 v[216:219], v[72:75], v[108:111], v[216:219]
  s_waitcnt lgkmcnt(0)
  s_barrier
  ds_read_b64 v[32:33], v12 offset:0
  ds_read_b64 v[34:35], v12 offset:128
  ds_read_b64 v[36:37], v12 offset:256
  ds_read_b64 v[38:39], v12 offset:384
  ds_read_b64 v[40:41], v12 offset:512
  ds_read_b64 v[42:43], v12 offset:640
  ds_read_b64 v[44:45], v12 offset:768
  ds_read_b64 v[46:47], v12 offset:896
  ds_read_b64 v[48:49], v12 offset:1024
  v_mov_b32_dpp v16, v112 row_newbcast:0 row_mask:0xf bank_mask:0xf
  v_mov_b32_dpp v17, v113 row_newbcast:0 row_mask:0xf bank_mask:0xf
  v_mov_b32_dpp v18, v114 row_newbcast:0 row_mask:0xf bank_mask:0xf
  v_mov_b32_dpp v19, v115 row_newbcast:0 row_mask:0xf bank_mask:0xf
  v_mov_b32_dpp v20, v148 row_newbcast:0 row_mask:0xf bank_mask:0xf
  v_mov_b32_dpp v21, v149 row_newbcast:0 row_mask:0xf bank_mask:0xf
  v_mov_b32_dpp v22, v150 row_newbcast:0 row_mask:0xf bank_mask:0xf
  v_mov_b32_dpp v23, v151 row_newbcast:0 row_mask:0xf bank_mask:0xf
  v_mov_b32_dpp v24, v184 row_newbcast:0 row_mask:0xf bank_mask:0xf
  v_mov_b32_dpp v25, v185 row_newbcast:0 row_mask:0xf bank_mask:0xf
  v_mov_b32_dpp v26, v186 row_newbcast:0 row_mask:0xf bank_mask:0xf
  v_mov_b32_dpp v27, v187 row_newbcast:0 row_mask:0xf bank_mask:0xf
  s_waitcnt lgkmcnt(0)
  v_pk_fma_f32 v[148:149], v[20:21], v[32:33], v[148:149] op_sel_hi:[1,0,1] neg_lo:[0,1,0] neg_hi:[0,1,0]
  v_pk_fma_f32 v[150:151], v[22:23], v[32:33], v[150:151] op_sel_hi:[1,0,1] neg_lo:[0,1,0] neg_hi:[0,1,0]
  v_pk_fma_f32 v[184:185], v[24:25], v[32:33], v[184:185] op_sel_hi:[1,0,1] neg_lo:[0,1,0] neg_hi:[0,1,0]
  v_pk_fma_f32 v[186:187], v[26:27], v[32:33], v[186:187] op_sel_hi:[1,0,1] neg_lo:[0,1,0] neg_hi:[0,1,0]
  v_pk_mul_f32 v[148:149], v[148:149], v[32:33] op_sel:[0,1] op_sel_hi:[1,1]
  v_pk_mul_f32 v[150:151], v[150:151], v[32:33] op_sel:[0,1] op_sel_hi:[1,1]
  v_pk_mul_f32 v[184:185], v[184:185], v[32:33] op_sel:[0,1] op_sel_hi:[1,1]
  v_pk_mul_f32 v[186:187], v[186:187], v[32:33] op_sel:[0,1] op_sel_hi:[1,1]
  v_cvt_pk_bf16_f32 v52, v148, v149
  v_cvt_pk_bf16_f32 v53, v150, v151
  ds_write_b64 v11, v[52:53] offset:128
  v_cvt_pk_bf16_f32 v54, v184, v185
  v_cvt_pk_bf16_f32 v55, v186, v187
  ds_write_b64 v11, v[54:55] offset:256
  v_pk_fma_f32 v[116:117], v[16:17], v[34:35], v[116:117] op_sel_hi:[1,0,1] neg_lo:[0,1,0] neg_hi:[0,1,0]
  v_pk_fma_f32 v[118:119], v[18:19], v[34:35], v[118:119] op_sel_hi:[1,0,1] neg_lo:[0,1,0] neg_hi:[0,1,0]
  v_pk_fma_f32 v[152:153], v[20:21], v[34:35], v[152:153] op_sel_hi:[1,0,1] neg_lo:[0,1,0] neg_hi:[0,1,0]
  v_pk_fma_f32 v[154:155], v[22:23], v[34:35], v[154:155] op_sel_hi:[1,0,1] neg_lo:[0,1,0] neg_hi:[0,1,0]
  v_pk_fma_f32 v[188:189], v[24:25], v[34:35], v[188:189] op_sel_hi:[1,0,1] neg_lo:[0,1,0] neg_hi:[0,1,0]
  v_pk_fma_f32 v[190:191], v[26:27], v[34:35], v[190:191] op_sel_hi:[1,0,1] neg_lo:[0,1,0] neg_hi:[0,1,0]
  v_pk_mul_f32 v[116:117], v[116:117], v[34:35] op_sel:[0,1] op_sel_hi:[1,1]
  v_pk_mul_f32 v[118:119], v[118:119], v[34:35] op_sel:[0,1] op_sel_hi:[1,1]
  v_pk_mul_f32 v[152:153], v[152:153], v[34:35] op_sel:[0,1] op_sel_hi:[1,1]
  v_pk_mul_f32 v[154:155], v[154:155], v[34:35] op_sel:[0,1] op_sel_hi:[1,1]
  v_pk_mul_f32 v[188:189], v[188:189], v[34:35] op_sel:[0,1] op_sel_hi:[1,1]
  v_pk_mul_f32 v[190:191], v[190:191], v[34:35] op_sel:[0,1] op_sel_hi:[1,1]
  v_cvt_pk_bf16_f32 v56, v116, v117
  v_cvt_pk_bf16_f32 v57, v118, v119
  ds_write_b64 v11, v[56:57] offset:3200
  v_cvt_pk_bf16_f32 v58, v152, v153
  v_cvt_pk_bf16_f32 v59, v154, v155
  ds_write_b64 v11, v[58:59] offset:3328
  v_cvt_pk_bf16_f32 v60, v188, v189
  v_cvt_pk_bf16_f32 v61, v190, v191
  ds_write_b64 v11, v[60:61] offset:3456
  v_pk_fma_f32 v[120:121], v[16:17], v[36:37], v[120:121] op_sel_hi:[1,0,1] neg_lo:[0,1,0] neg_hi:[0,1,0]
  v_pk_fma_f32 v[122:123], v[18:19], v[36:37], v[122:123] op_sel_hi:[1,0,1] neg_lo:[0,1,0] neg_hi:[0,1,0]
  v_pk_fma_f32 v[156:157], v[20:21], v[36:37], v[156:157] op_sel_hi:[1,0,1] neg_lo:[0,1,0] neg_hi:[0,1,0]
  v_pk_fma_f32 v[158:159], v[22:23], v[36:37], v[158:159] op_sel_hi:[1,0,1] neg_lo:[0,1,0] neg_hi:[0,1,0]
  v_pk_fma_f32 v[192:193], v[24:25], v[36:37], v[192:193] op_sel_hi:[1,0,1] neg_lo:[0,1,0] neg_hi:[0,1,0]
  v_pk_fma_f32 v[194:195], v[26:27], v[36:37], v[194:195] op_sel_hi:[1,0,1] neg_lo:[0,1,0] neg_hi:[0,1,0]
  v_pk_mul_f32 v[120:121], v[120:121], v[36:37] op_sel:[0,1] op_sel_hi:[1,1]
  v_pk_mul_f32 v[122:123], v[122:123], v[36:37] op_sel:[0,1] op_sel_hi:[1,1]
  v_pk_mul_f32 v[156:157], v[156:157], v[36:37] op_sel:[0,1] op_sel_hi:[1,1]
  v_pk_mul_f32 v[158:159], v[158:159], v[36:37] op_sel:[0,1] op_sel_hi:[1,1]
  v_pk_mul_f32 v[192:193], v[192:193], v[36:37] op_sel:[0,1] op_sel_hi:[1,1]
  v_pk_mul_f32 v[194:195], v[194:195], v[36:37] op_sel:[0,1] op_sel_hi:[1,1]
  v_cvt_pk_bf16_f32 v62, v120, v121
  v_cvt_pk_bf16_f32 v63, v122, v123
  ds_write_b64 v11, v[62:63] offset:6400
  v_cvt_pk_bf16_f32 v64, v156, v157
  v_cvt_pk_bf16_f32 v65, v158, v159
  ds_write_b64 v11, v[64:65] offset:6528
  v_cvt_pk_bf16_f32 v66, v192, v193
  v_cvt_pk_bf16_f32 v67, v194, v195
  ds_write_b64 v11, v[66:67] offset:6656
  v_pk_fma_f32 v[124:125], v[16:17], v[38:39], v[124:125] op_sel_hi:[1,0,1] neg_lo:[0,1,0] neg_hi:[0,1,0]
  v_pk_fma_f32 v[126:127], v[18:19], v[38:39], v[126:127] op_sel_hi:[1,0,1] neg_lo:[0,1,0] neg_hi:[0,1,0]
  v_pk_fma_f32 v[160:161], v[20:21], v[38:39], v[160:161] op_sel_hi:[1,0,1] neg_lo:[0,1,0] neg_hi:[0,1,0]
  v_pk_fma_f32 v[162:163], v[22:23], v[38:39], v[162:163] op_sel_hi:[1,0,1] neg_lo:[0,1,0] neg_hi:[0,1,0]
  v_pk_fma_f32 v[196:197], v[24:25], v[38:39], v[196:197] op_sel_hi:[1,0,1] neg_lo:[0,1,0] neg_hi:[0,1,0]
  v_pk_fma_f32 v[198:199], v[26:27], v[38:39], v[198:199] op_sel_hi:[1,0,1] neg_lo:[0,1,0] neg_hi:[0,1,0]
  v_pk_mul_f32 v[124:125], v[124:125], v[38:39] op_sel:[0,1] op_sel_hi:[1,1]
  v_pk_mul_f32 v[126:127], v[126:127], v[38:39] op_sel:[0,1] op_sel_hi:[1,1]
  v_pk_mul_f32 v[160:161], v[160:161], v[38:39] op_sel:[0,1] op_sel_hi:[1,1]
  v_pk_mul_f32 v[162:163], v[162:163], v[38:39] op_sel:[0,1] op_sel_hi:[1,1]
  v_pk_mul_f32 v[196:197], v[196:197], v[38:39] op_sel:[0,1] op_sel_hi:[1,1]
  v_pk_mul_f32 v[198:199], v[198:199], v[38:39] op_sel:[0,1] op_sel_hi:[1,1]
  v_cvt_pk_bf16_f32 v52, v124, v125
  v_cvt_pk_bf16_f32 v53, v126, v127
  ds_write_b64 v11, v[52:53] offset:9600
  v_cvt_pk_bf16_f32 v54, v160, v161
  v_cvt_pk_bf16_f32 v55, v162, v163
  ds_write_b64 v11, v[54:55] offset:9728
  v_cvt_pk_bf16_f32 v56, v196, v197
  v_cvt_pk_bf16_f32 v57, v198, v199
  ds_write_b64 v11, v[56:57] offset:9856
  v_pk_fma_f32 v[128:129], v[16:17], v[40:41], v[128:129] op_sel_hi:[1,0,1] neg_lo:[0,1,0] neg_hi:[0,1,0]
  v_pk_fma_f32 v[130:131], v[18:19], v[40:41], v[130:131] op_sel_hi:[1,0,1] neg_lo:[0,1,0] neg_hi:[0,1,0]
  v_pk_fma_f32 v[164:165], v[20:21], v[40:41], v[164:165] op_sel_hi:[1,0,1] neg_lo:[0,1,0] neg_hi:[0,1,0]
  v_pk_fma_f32 v[166:167], v[22:23], v[40:41], v[166:167] op_sel_hi:[1,0,1] neg_lo:[0,1,0] neg_hi:[0,1,0]
  v_pk_fma_f32 v[200:201], v[24:25], v[40:41], v[200:201] op_sel_hi:[1,0,1] neg_lo:[0,1,0] neg_hi:[0,1,0]
  v_pk_fma_f32 v[202:203], v[26:27], v[40:41], v[202:203] op_sel_hi:[1,0,1] neg_lo:[0,1,0] neg_hi:[0,1,0]
  v_pk_mul_f32 v[128:129], v[128:129], v[40:41] op_sel:[0,1] op_sel_hi:[1,1]
  v_pk_mul_f32 v[130:131], v[130:131], v[40:41] op_sel:[0,1] op_sel_hi:[1,1]
  v_pk_mul_f32 v[164:165], v[164:165], v[40:41] op_sel:[0,1] op_sel_hi:[1,1]
  v_pk_mul_f32 v[166:167], v[166:167], v[40:41] op_sel:[0,1] op_sel_hi:[1,1]
  v_pk_mul_f32 v[200:201], v[200:201], v[40:41] op_sel:[0,1] op_sel_hi:[1,1]
  v_pk_mul_f32 v[202:203], v[202:203], v[40:41] op_sel:[0,1] op_sel_hi:[1,1]
  v_cvt_pk_bf16_f32 v58, v128, v129
  v_cvt_pk_bf16_f32 v59, v130, v131
  ds_write_b64 v11, v[58:59] offset:12800
  v_cvt_pk_bf16_f32 v60, v164, v165
  v_cvt_pk_bf16_f32 v61, v166, v167
  ds_write_b64 v11, v[60:61] offset:12928
  v_cvt_pk_bf16_f32 v62, v200, v201
  v_cvt_pk_bf16_f32 v63, v202, v203
  ds_write_b64 v11, v[62:63] offset:13056
  v_pk_fma_f32 v[132:133], v[16:17], v[42:43], v[132:133] op_sel_hi:[1,0,1] neg_lo:[0,1,0] neg_hi:[0,1,0]
  v_pk_fma_f32 v[134:135], v[18:19], v[42:43], v[134:135] op_sel_hi:[1,0,1] neg_lo:[0,1,0] neg_hi:[0,1,0]
  v_pk_fma_f32 v[168:169], v[20:21], v[42:43], v[168:169] op_sel_hi:[1,0,1] neg_lo:[0,1,0] neg_hi:[0,1,0]
  v_pk_fma_f32 v[170:171], v[22:23], v[42:43], v[170:171] op_sel_hi:[1,0,1] neg_lo:[0,1,0] neg_hi:[0,1,0]
  v_pk_fma_f32 v[204:205], v[24:25], v[42:43], v[204:205] op_sel_hi:[1,0,1] neg_lo:[0,1,0] neg_hi:[0,1,0]
  v_pk_fma_f32 v[206:207], v[26:27], v[42:43], v[206:207] op_sel_hi:[1,0,1] neg_lo:[0,1,0] neg_hi:[0,1,0]
  v_pk_mul_f32 v[132:133], v[132:133], v[42:43] op_sel:[0,1] op_sel_hi:[1,1]
  v_pk_mul_f32 v[134:135], v[134:135], v[42:43] op_sel:[0,1] op_sel_hi:[1,1]
  v_pk_mul_f32 v[168:169], v[168:169], v[42:43] op_sel:[0,1] op_sel_hi:[1,1]
  v_pk_mul_f32 v[170:171], v[170:171], v[42:43] op_sel:[0,1] op_sel_hi:[1,1]
  v_pk_mul_f32 v[204:205], v[204:205], v[42:43] op_sel:[0,1] op_sel_hi:[1,1]
  v_pk_mul_f32 v[206:207], v[206:207], v[42:43] op_sel:[0,1] op_sel_hi:[1,1]
  v_cvt_pk_bf16_f32 v64, v132, v133
  v_cvt_pk_bf16_f32 v65, v134, v135
  ds_write_b64 v11, v[64:65] offset:16000
  v_cvt_pk_bf16_f32 v66, v168, v169
  v_cvt_pk_bf16_f32 v67, v170, v171
  ds_write_b64 v11, v[66:67] offset:16128
  v_cvt_pk_bf16_f32 v52, v204, v205
  v_cvt_pk_bf16_f32 v53, v206, v207
  ds_write_b64 v11, v[52:53] offset:16256
  v_pk_fma_f32 v[136:137], v[16:17], v[44:45], v[136:137] op_sel_hi:[1,0,1] neg_lo:[0,1,0] neg_hi:[0,1,0]
  v_pk_fma_f32 v[138:139], v[18:19], v[44:45], v[138:139] op_sel_hi:[1,0,1] neg_lo:[0,1,0] neg_hi:[0,1,0]
  v_pk_fma_f32 v[172:173], v[20:21], v[44:45], v[172:173] op_sel_hi:[1,0,1] neg_lo:[0,1,0] neg_hi:[0,1,0]
  v_pk_fma_f32 v[174:175], v[22:23], v[44:45], v[174:175] op_sel_hi:[1,0,1] neg_lo:[0,1,0] neg_hi:[0,1,0]
  v_pk_fma_f32 v[208:209], v[24:25], v[44:45], v[208:209] op_sel_hi:[1,0,1] neg_lo:[0,1,0] neg_hi:[0,1,0]
  v_pk_fma_f32 v[210:211], v[26:27], v[44:45], v[210:211] op_sel_hi:[1,0,1] neg_lo:[0,1,0] neg_hi:[0,1,0]
  v_pk_mul_f32 v[136:137], v[136:137], v[44:45] op_sel:[0,1] op_sel_hi:[1,1]
  v_pk_mul_f32 v[138:139], v[138:139], v[44:45] op_sel:[0,1] op_sel_hi:[1,1]
  v_pk_mul_f32 v[172:173], v[172:173], v[44:45] op_sel:[0,1] op_sel_hi:[1,1]
  v_pk_mul_f32 v[174:175], v[174:175], v[44:45] op_sel:[0,1] op_sel_hi:[1,1]
  v_pk_mul_f32 v[208:209], v[208:209], v[44:45] op_sel:[0,1] op_sel_hi:[1,1]
  v_pk_mul_f32 v[210:211], v[210:211], v[44:45] op_sel:[0,1] op_sel_hi:[1,1]
  v_cvt_pk_bf16_f32 v54, v136, v137
  v_cvt_pk_bf16_f32 v55, v138, v139
  ds_write_b64 v11, v[54:55] offset:19200
  v_cvt_pk_bf16_f32 v56, v172, v173
  v_cvt_pk_bf16_f32 v57, v174, v175
  ds_write_b64 v11, v[56:57] offset:19328
  v_cvt_pk_bf16_f32 v58, v208, v209
  v_cvt_pk_bf16_f32 v59, v210, v211
  ds_write_b64 v11, v[58:59] offset:19456
  v_pk_fma_f32 v[140:141], v[16:17], v[46:47], v[140:141] op_sel_hi:[1,0,1] neg_lo:[0,1,0] neg_hi:[0,1,0]
  v_pk_fma_f32 v[142:143], v[18:19], v[46:47], v[142:143] op_sel_hi:[1,0,1] neg_lo:[0,1,0] neg_hi:[0,1,0]
  v_pk_fma_f32 v[176:177], v[20:21], v[46:47], v[176:177] op_sel_hi:[1,0,1] neg_lo:[0,1,0] neg_hi:[0,1,0]
  v_pk_fma_f32 v[178:179], v[22:23], v[46:47], v[178:179] op_sel_hi:[1,0,1] neg_lo:[0,1,0] neg_hi:[0,1,0]
  v_pk_fma_f32 v[212:213], v[24:25], v[46:47], v[212:213] op_sel_hi:[1,0,1] neg_lo:[0,1,0] neg_hi:[0,1,0]
  v_pk_fma_f32 v[214:215], v[26:27], v[46:47], v[214:215] op_sel_hi:[1,0,1] neg_lo:[0,1,0] neg_hi:[0,1,0]
  v_pk_mul_f32 v[140:141], v[140:141], v[46:47] op_sel:[0,1] op_sel_hi:[1,1]
  v_pk_mul_f32 v[142:143], v[142:143], v[46:47] op_sel:[0,1] op_sel_hi:[1,1]
  v_pk_mul_f32 v[176:177], v[176:177], v[46:47] op_sel:[0,1] op_sel_hi:[1,1]
  v_pk_mul_f32 v[178:179], v[178:179], v[46:47] op_sel:[0,1] op_sel_hi:[1,1]
  v_pk_mul_f32 v[212:213], v[212:213], v[46:47] op_sel:[0,1] op_sel_hi:[1,1]
  v_pk_mul_f32 v[214:215], v[214:215], v[46:47] op_sel:[0,1] op_sel_hi:[1,1]
  v_cvt_pk_bf16_f32 v60, v140, v141
  v_cvt_pk_bf16_f32 v61, v142, v143
  ds_write_b64 v11, v[60:61] offset:22400
  v_cvt_pk_bf16_f32 v62, v176, v177
  v_cvt_pk_bf16_f32 v63, v178, v179
  ds_write_b64 v11, v[62:63] offset:22528
  v_cvt_pk_bf16_f32 v64, v212, v213
  v_cvt_pk_bf16_f32 v65, v214, v215
  ds_write_b64 v11, v[64:65] offset:22656
  v_pk_fma_f32 v[144:145], v[16:17], v[48:49], v[144:145] op_sel_hi:[1,0,1] neg_lo:[0,1,0] neg_hi:[0,1,0]
  v_pk_fma_f32 v[146:147], v[18:19], v[48:49], v[146:147] op_sel_hi:[1,0,1] neg_lo:[0,1,0] neg_hi:[0,1,0]
  v_pk_fma_f32 v[180:181], v[20:21], v[48:49], v[180:181] op_sel_hi:[1,0,1] neg_lo:[0,1,0] neg_hi:[0,1,0]
  v_pk_fma_f32 v[182:183], v[22:23], v[48:49], v[182:183] op_sel_hi:[1,0,1] neg_lo:[0,1,0] neg_hi:[0,1,0]
  v_pk_fma_f32 v[216:217], v[24:25], v[48:49], v[216:217] op_sel_hi:[1,0,1] neg_lo:[0,1,0] neg_hi:[0,1,0]
  v_pk_fma_f32 v[218:219], v[26:27], v[48:49], v[218:219] op_sel_hi:[1,0,1] neg_lo:[0,1,0] neg_hi:[0,1,0]
  v_pk_mul_f32 v[144:145], v[144:145], v[48:49] op_sel:[0,1] op_sel_hi:[1,1]
  v_pk_mul_f32 v[146:147], v[146:147], v[48:49] op_sel:[0,1] op_sel_hi:[1,1]
  v_pk_mul_f32 v[180:181], v[180:181], v[48:49] op_sel:[0,1] op_sel_hi:[1,1]
  v_pk_mul_f32 v[182:183], v[182:183], v[48:49] op_sel:[0,1] op_sel_hi:[1,1]
  v_pk_mul_f32 v[216:217], v[216:217], v[48:49] op_sel:[0,1] op_sel_hi:[1,1]
  v_pk_mul_f32 v[218:219], v[218:219], v[48:49] op_sel:[0,1] op_sel_hi:[1,1]
  v_cvt_pk_bf16_f32 v66, v144, v145
  v_cvt_pk_bf16_f32 v67, v146, v147
  ds_write_b64 v11, v[66:67] offset:25600
  v_cvt_pk_bf16_f32 v52, v180, v181
  v_cvt_pk_bf16_f32 v53, v182, v183
  ds_write_b64 v11, v[52:53] offset:25728
  v_cvt_pk_bf16_f32 v54, v216, v217
  v_cvt_pk_bf16_f32 v55, v218, v219
  ds_write_b64 v11, v[54:55] offset:25856
attn:
  s_nop 7
  s_nop 7
  s_mov_b32 s20, s82
  s_mov_b32 s21, s83
  s_mov_b32 s22, 4194304
  s_mov_b32 s23, 0x20000
  s_lshr_b32 s40, s4, 1
  s_and_b32 s41, s4, 1
  s_mul_i32 s32, s41, 28800
  s_add_u32 s32, s32, 43008
  s_lshl_b32 s49, s40, 4
  v_add_u32 v16, s49, v4
  v_lshlrev_b32 v17, 4, v5
  v_add_u32 v17, s32, v17
  v_mul_u32_u24 v18, 400, v16
  v_add_u32 v8, v18, v17
  v_add_u32 v10, 3200, v8
  v_add_u32 v8, 128, v8
  v_add_u32 v16, 16, v16
  v_min_u32 v16, 71, v16
  v_mul_u32_u24 v18, 400, v16
  v_add3_u32 v9, v18, v17, 64
  v_add_u32 v9, 64, v9
  v_lshl_add_u32 v16, v5, 2, v6
  v_add_u32 v16, s49, v16
  v_lshlrev_b32 v17, 4, v7
  v_add_u32 v17, s32, v17
  v_add_u32 v17, 256, v17
  v_mul_u32_u24 v18, 400, v16
  v_add_u32 v14, v18, v17
  v_add_u32 v16, 16, v16
  v_min_u32 v16, 71, v16
  v_mul_u32_u24 v18, 400, v16
  v_add_u32 v15, v18, v17
  v_lshlrev_b32 v13, 4, v0
  s_lshl_b32 s50, s28, 2
  s_add_u32 s50, s50, s40
  s_lshl_b32 s50, s50, 16
  s_lshl_b32 s51, s29, 12
  s_add_u32 s50, s50, s51
  s_lshl_b32 s51, s41, 10
  s_add_u32 s50, s50, s51
  v_lshlrev_b32 v16, 2, v5
  v_sub_u32 v16, v16, v4
  s_or_b32 s51, s28, s40
  s_cmp_eq_u32 s51, 0
  s_cselect_b32 s51, 0, -1
  v_add_u32 v17, -1, v16
  v_cmp_gt_u32 s[86:87], 8, v17
  v_add_u32 v17, 0, v16
  v_cmp_gt_u32 s[88:89], 8, v17
  v_add_u32 v17, 1, v16
  v_cmp_gt_u32 s[90:91], 8, v17
  v_add_u32 v17, 2, v16
  v_cmp_gt_u32 s[92:93], 8, v17
  v_add_u32 v17, 15, v16
  v_cmp_gt_u32 s[94:95], 8, v17
  v_add_u32 v17, 16, v16
  v_cmp_gt_u32 s[96:97], 8, v17
  v_add_u32 v17, 17, v16
  v_cmp_gt_u32 s[98:99], 8, v17
  v_add_u32 v17, 18, v16
  v_cmp_gt_u32 s[100:101], 8, v17
  s_and_b32 s86, s86, s51
  s_and_b32 s88, s88, s51
  s_and_b32 s90, s90, s51
  s_and_b32 s92, s92, s51
  v_mov_b32 v18, 0x3e8293ee
  v_mov_b32 v19, 0xff800000
  s_waitcnt lgkmcnt(0)
  s_barrier
  ds_read_b128 v[32:35], v10 offset:0
  ds_read_b128 v[36:39], v8 offset:0
  ds_read_b128 v[40:43], v9 offset:0
  ds_read_b128 v[80:83], v10 offset:64
  ds_read_b128 v[84:87], v8 offset:64
  ds_read_b128 v[88:91], v9 offset:64
  ds_read_b64_tr_b16 v[44:45], v14 offset:0
  ds_read_b64_tr_b16 v[46:47], v15 offset:0
  ds_read_b64_tr_b16 v[48:49], v14 offset:8
  ds_read_b64_tr_b16 v[50:51], v15 offset:8
  ds_read_b64_tr_b16 v[92:93], v14 offset:64
  ds_read_b64_tr_b16 v[94:95], v15 offset:64
  ds_read_b64_tr_b16 v[96:97], v14 offset:72
  ds_read_b64_tr_b16 v[98:99], v15 offset:72
  s_waitcnt lgkmcnt(11)
  v_mfma_f32_16x16x32_bf16 v[52:55], v[36:39], v[32:35], 0
  v_mfma_f32_16x16x32_bf16 v[56:59], v[40:43], v[32:35], 0
  s_waitcnt lgkmcnt(8)
  v_mfma_f32_16x16x32_bf16 v[100:103], v[84:87], v[80:83], 0
  v_mfma_f32_16x16x32_bf16 v[104:107], v[88:91], v[80:83], 0
  s_nop 3
  v_cndmask_b32 v52, v19, v52, s[86:87]
  s_nop 1
  v_cndmask_b32 v100, v19, v100, s[86:87]
  v_cndmask_b32 v53, v19, v53, s[88:89]
  v_cndmask_b32 v101, v19, v101, s[88:89]
  v_cndmask_b32 v54, v19, v54, s[90:91]
  v_cndmask_b32 v102, v19, v102, s[90:91]
  v_cndmask_b32 v55, v19, v55, s[92:93]
  v_cndmask_b32 v103, v19, v103, s[92:93]
  v_cndmask_b32 v56, v19, v56, s[94:95]
  v_cndmask_b32 v104, v19, v104, s[94:95]
  v_cndmask_b32 v57, v19, v57, s[96:97]
  v_cndmask_b32 v105, v19, v105, s[96:97]
  v_cndmask_b32 v58, v19, v58, s[98:99]
  v_cndmask_b32 v106, v19, v106, s[98:99]
  v_cndmask_b32 v59, v19, v59, s[100:101]
  v_cndmask_b32 v107, v19, v107, s[100:101]
  v_max3_f32 v60, v52, v53, v54
  v_max3_f32 v108, v100, v101, v102
  v_max3_f32 v61, v55, v56, v57
  v_max3_f32 v109, v103, v104, v105
  v_max3_f32 v60, v60, v58, v59
  v_max3_f32 v108, v108, v106, v107
  v_max_f32 v60, v60, v61
  v_max_f32 v108, v108, v109
  v_mov_b32 v61, v60
  v_mov_b32 v109, v108
  s_nop 0
  v_permlane16_swap_b32 v60, v61
  v_permlane16_swap_b32 v108, v109
  v_max_f32 v60, v60, v61
  v_max_f32 v108, v108, v109
  v_mov_b32 v61, v60
  v_mov_b32 v109, v108
  s_nop 0
  v_permlane32_swap_b32 v60, v61
  v_permlane32_swap_b32 v108, v109
  v_max_f32 v60, v60, v61
  v_max_f32 v108, v108, v109
  v_mul_f32 v60, v18, v60
  v_mul_f32 v108, v18, v108
  v_fma_f32 v52, v52, v18, -v60
  v_fma_f32 v100, v100, v18, -v108
  v_fma_f32 v53, v53, v18, -v60
  v_fma_f32 v101, v101, v18, -v108
  v_fma_f32 v54, v54, v18, -v60
  v_fma_f32 v102, v102, v18, -v108
  v_fma_f32 v55, v55, v18, -v60
  v_fma_f32 v103, v103, v18, -v108
  v_fma_f32 v56, v56, v18, -v60
  v_fma_f32 v104, v104, v18, -v108
  v_fma_f32 v57, v57, v18, -v60
  v_fma_f32 v105, v105, v18, -v108
  v_fma_f32 v58, v58, v18, -v60
  v_fma_f32 v106, v106, v18, -v108
  v_fma_f32 v59, v59, v18, -v60
  v_fma_f32 v107, v107, v18, -v108
  v_exp_f32 v52, v52
  v_exp_f32 v100, v100
  v_exp_f32 v53, v53
  v_exp_f32 v101, v101
  v_exp_f32 v54, v54
  v_exp_f32 v102, v102
  v_exp_f32 v55, v55
  v_exp_f32 v103, v103
  v_exp_f32 v56, v56
  v_exp_f32 v104, v104
  v_exp_f32 v57, v57
  v_exp_f32 v105, v105
  v_exp_f32 v58, v58
  v_exp_f32 v106, v106
  v_exp_f32 v59, v59
  v_exp_f32 v107, v107
  v_pk_add_f32 v[60:61], v[52:53], v[54:55]
  v_pk_add_f32 v[108:109], v[100:101], v[102:103]
  v_pk_add_f32 v[62:63], v[56:57], v[58:59]
  v_pk_add_f32 v[110:111], v[104:105], v[106:107]
  v_pk_add_f32 v[60:61], v[60:61], v[62:63]
  v_pk_add_f32 v[108:109], v[108:109], v[110:111]
  v_add_f32 v60, v60, v61
  v_add_f32 v108, v108, v109
  v_mov_b32 v61, v60
  v_mov_b32 v109, v108
  s_nop 0
  v_permlane16_swap_b32 v60, v61
  v_permlane16_swap_b32 v108, v109
  v_add_f32 v60, v60, v61
  v_add_f32 v108, v108, v109
  v_mov_b32 v61, v60
  v_mov_b32 v109, v108
  s_nop 0
  v_permlane32_swap_b32 v60, v61
  v_permlane32_swap_b32 v108, v109
  v_add_f32 v60, v60, v61
  v_add_f32 v108, v108, v109
  v_rcp_f32 v60, v60
  v_rcp_f32 v108, v108
  v_pk_mul_f32 v[52:53], v[52:53], v[60:61] op_sel_hi:[1,0]
  v_pk_mul_f32 v[100:101], v[100:101], v[108:109] op_sel_hi:[1,0]
  v_pk_mul_f32 v[54:55], v[54:55], v[60:61] op_sel_hi:[1,0]
  v_pk_mul_f32 v[102:103], v[102:103], v[108:109] op_sel_hi:[1,0]
  v_pk_mul_f32 v[56:57], v[56:57], v[60:61] op_sel_hi:[1,0]
  v_pk_mul_f32 v[104:105], v[104:105], v[108:109] op_sel_hi:[1,0]
  v_pk_mul_f32 v[58:59], v[58:59], v[60:61] op_sel_hi:[1,0]
  v_pk_mul_f32 v[106:107], v[106:107], v[108:109] op_sel_hi:[1,0]
  v_cvt_pk_bf16_f32 v64, v52, v53
  v_cvt_pk_bf16_f32 v112, v100, v101
  v_cvt_pk_bf16_f32 v65, v54, v55
  v_cvt_pk_bf16_f32 v113, v102, v103
  v_cvt_pk_bf16_f32 v66, v56, v57
  v_cvt_pk_bf16_f32 v114, v104, v105
  v_cvt_pk_bf16_f32 v67, v58, v59
  v_cvt_pk_bf16_f32 v115, v106, v107
  s_waitcnt lgkmcnt(0)
  v_mfma_f32_16x16x32_bf16 v[68:71], v[44:47], v[64:67], 0
  v_mfma_f32_16x16x32_bf16 v[116:119], v[92:95], v[112:115], 0
  v_mfma_f32_16x16x32_bf16 v[72:75], v[48:51], v[64:67], 0
  v_mfma_f32_16x16x32_bf16 v[120:123], v[96:99], v[112:115], 0
  s_nop 4
  v_cvt_pk_bf16_f32 v32, v68, v69
  v_cvt_pk_bf16_f32 v80, v116, v117
  v_cvt_pk_bf16_f32 v33, v70, v71
  v_cvt_pk_bf16_f32 v81, v118, v119
  v_cvt_pk_bf16_f32 v34, v72, v73
  v_cvt_pk_bf16_f32 v82, v120, v121
  v_cvt_pk_bf16_f32 v35, v74, v75
  v_cvt_pk_bf16_f32 v83, v122, v123
  buffer_store_dwordx4 v[32:35], v13, s[20:23], s50 offen offset:0 sc0 sc1
  buffer_store_dwordx4 v[80:83], v13, s[20:23], s50 offen offset:2048 sc0 sc1
  s_cmp_ge_u32 s4, 4
  s_cbranch_scc1 L_k1done
  s_lshl_b32 s32, s28, 2
  s_add_u32 s32, s32, s4
  s_lshl_b32 s34, s32, 16
  s_lshl_b32 s40, s32, 5
  v_lshlrev_b32 v13, 1, v4
  v_add_u32 v13, s40, v13
  v_lshlrev_b32 v12, 11, v13
  v_lshl_add_u32 v12, v3, 4, v12
  s_lshl_b32 s32, s29, 7
  v_add_u32 v12, s32, v12
  v_lshlrev_b32 v14, 4, v0
  s_mov_b32 s8, s82
  s_mov_b32 s9, s83
  s_mov_b32 s10, 4194304
  s_mov_b32 s11, 0x20000
  s_cmp_eq_u32 s3, 0
  s_cselect_b32 s16, s64, s84
  s_cselect_b32 s17, s65, s85
  s_cselect_b32 s18, 0, 25165824
  s_add_u32 s16, s16, s18
  s_addc_u32 s17, s17, 0
  s_mov_b32 s18, 4194304
  s_mov_b32 s19, 0x20000
  s_add_u32 s12, s82, 20971520
  s_addc_u32 s13, s83, 0
  s_mov_b32 s14, 262144
  s_mov_b32 s15, 0x20000
  v_lshl_add_u32 v16, v5, 3, v6
  v_lshlrev_b32 v16, 7, v16
  v_lshl_add_u32 v16, v7, 3, v16
  v_lshrrev_b32 v17, 1, v6
  v_lshl_or_b32 v17, v2, 1, v17
  v_lshl_add_u32 v16, v17, 5, v16
  v_add_u32 v16, 131072, v16
  v_xor_b32 v8, 0, v16
  v_xor_b32 v9, 32, v16
  v_xor_b32 v10, 64, v16
  v_xor_b32 v11, 96, v16
  v_add_u32 v16, v13, v2
  v_lshlrev_b32 v16, 3, v16
  s_lshl_b32 s32, s29, 14
  v_add_u32 v112, s32, v16
  v_lshrrev_b32 v17, 5, v0
  v_lshlrev_b32 v17, 17, v17
  v_add_u32 v113, v16, v17
  s_lshl_b32 s32, s4, 12
  v_lshlrev_b32 v16, 8, v4
  v_lshl_add_u32 v16, v5, 3, v16
  v_add_u32 v16, s32, v16
  v_and_b32 v17, 1, v4
  v_bfe_u32 v18, v4, 2, 1
  v_lshl_or_b32 v17, v18, 1, v17
  v_lshl_add_u32 v114, v17, 5, v16
  s_lshl_b32 s44, s29, 8
  s_lshl_b32 s40, s28, 2
  s_add_u32 s44, s44, s40
  s_add_u32 s44, s44, s4
  s_lshl_b32 s44, s44, 10
  v_lshl_add_u32 v16, v5, 3, v6
  v_lshlrev_b32 v16, 7, v16
  v_lshl_add_u32 v16, v7, 3, v16
  v_lshrrev_b32 v17, 1, v6
  v_lshl_or_b32 v17, v2, 1, v17
  v_lshl_add_u32 v16, v17, 5, v16
  v_xor_b32 v115, 0, v16
  v_add_u32 v115, s32, v115
  s_add_u32 s45, s44, 65536
  s_add_u32 s46, s44, 131072
  s_add_u32 s47, s44, 196608
  s_mov_b32 s87, 16384
  s_mov_b32 s88, 32768
  s_mov_b32 s89, 49152
  s_mov_b32 s90, 65536
  s_mov_b32 s91, 81920
  s_mov_b32 s92, 98304
  s_mov_b32 s93, 114688
  s_lshl_b32 s48, 0x303, s7
  s_lshr_b32 s48, s48, 8
  s_mov_b32 s49, s34
  s_add_u32 s50, s34, 32768
  s_add_u32 s41, s34, 65536
  s_add_u32 s24, s84, 29360128
  s_addc_u32 s25, s85, 0
  s_mov_b32 s26, 262144
  s_mov_b32 s27, 0x20000
  s_lshl_b32 s32, s28, 4
  v_min_u32 v119, 15, v0
  v_add_u32 v119, s32, v119
  v_max_i32 v119, 0, v119
  v_lshlrev_b32 v119, 7, v119
  s_lshl_b32 s55, s3, 17
  s_add_u32 s55, s55, 0
  s_waitcnt vmcnt(0)
  s_barrier
  s_mov_b32 s39, 0
poll2:
  buffer_load_dword v16, v119, s[24:27], s55 offen sc0 sc1
  s_waitcnt vmcnt(0)
  v_cmp_eq_u32 vcc, 0, v16
  s_add_u32 s39, s39, 1
  s_cmp_gt_u32 s39, 100000
  s_cbranch_scc1 poll2d
  s_cbranch_vccnz poll2
poll2d:
  buffer_load_dwordx4 v[96:99], v12, s[16:19], 0 offen offset:0 sc1
  buffer_load_dwordx4 v[100:103], v12, s[16:19], 0 offen offset:64 sc1
  buffer_load_dwordx4 v[104:107], v12, s[16:19], 0 offen offset:2048 sc1
  buffer_load_dwordx4 v[108:111], v12, s[16:19], 0 offen offset:2112 sc1
  s_bitcmp1_b32 s48, 0
  s_cselect_b32 s36, s50, s49
  s_add_u32 s36, s36, 0
  buffer_load_dwordx4 v[120:123], v14, s[8:11], s36 offen offset:0 sc1
  buffer_load_dwordx4 v[124:127], v14, s[8:11], s36 offen offset:1024 sc1
  buffer_load_dwordx4 v[128:131], v14, s[8:11], s36 offen offset:2048 sc1
  buffer_load_dwordx4 v[132:135], v14, s[8:11], s36 offen offset:3072 sc1
  s_bitcmp1_b32 s48, 1
  s_cselect_b32 s36, s50, s49
  s_add_u32 s36, s36, 4096
  buffer_load_dwordx4 v[136:139], v14, s[8:11], s36 offen offset:0 sc1
  buffer_load_dwordx4 v[140:143], v14, s[8:11], s36 offen offset:1024 sc1
  buffer_load_dwordx4 v[144:147], v14, s[8:11], s36 offen offset:2048 sc1
  buffer_load_dwordx4 v[148:151], v14, s[8:11], s36 offen offset:3072 sc1
  s_waitcnt vmcnt(8)
  v_permlane16_swap_b32 v96, v98
  v_permlane16_swap_b32 v97, v99
  v_permlane16_swap_b32 v100, v102
  v_permlane16_swap_b32 v101, v103
  v_permlane16_swap_b32 v104, v106
  v_permlane16_swap_b32 v105, v107
  v_permlane16_swap_b32 v108, v110
  v_permlane16_swap_b32 v109, v111
  v_lshlrev_b32 v48, 16, v96
  v_and_b32 v49, 0xffff0000, v96
  v_lshlrev_b32 v50, 16, v97
  v_and_b32 v51, 0xffff0000, v97
  v_lshlrev_b32 v52, 16, v98
  v_and_b32 v53, 0xffff0000, v98
  v_lshlrev_b32 v54, 16, v99
  v_and_b32 v55, 0xffff0000, v99
  v_lshlrev_b32 v56, 16, v100
  v_and_b32 v57, 0xffff0000, v100
  v_lshlrev_b32 v58, 16, v101
  v_and_b32 v59, 0xffff0000, v101
  v_lshlrev_b32 v60, 16, v102
  v_and_b32 v61, 0xffff0000, v102
  v_lshlrev_b32 v62, 16, v103
  v_and_b32 v63, 0xffff0000, v103
  v_lshlrev_b32 v64, 16, v104
  v_and_b32 v65, 0xffff0000, v104
  v_lshlrev_b32 v66, 16, v105
  v_and_b32 v67, 0xffff0000, v105
  v_lshlrev_b32 v68, 16, v106
  v_and_b32 v69, 0xffff0000, v106
  v_lshlrev_b32 v70, 16, v107
  v_and_b32 v71, 0xffff0000, v107
  v_lshlrev_b32 v72, 16, v108
  v_and_b32 v73, 0xffff0000, v108
  v_lshlrev_b32 v74, 16, v109
  v_and_b32 v75, 0xffff0000, v109
  v_lshlrev_b32 v76, 16, v110
  v_and_b32 v77, 0xffff0000, v110
  v_lshlrev_b32 v78, 16, v111
  v_and_b32 v79, 0xffff0000, v111
  s_bitcmp1_b32 s48, 2
  s_cselect_b32 s36, s50, s49
  s_add_u32 s36, s36, 8192
  buffer_load_dwordx4 v[152:155], v14, s[8:11], s36 offen offset:0 sc1
  buffer_load_dwordx4 v[156:159], v14, s[8:11], s36 offen offset:1024 sc1
  buffer_load_dwordx4 v[160:163], v14, s[8:11], s36 offen offset:2048 sc1
  buffer_load_dwordx4 v[164:167], v14, s[8:11], s36 offen offset:3072 sc1
  s_bitcmp1_b32 s48, 3
  s_cselect_b32 s36, s50, s49
  s_add_u32 s36, s36, 12288
  buffer_load_dwordx4 v[168:171], v14, s[8:11], s36 offen offset:0 sc1
  buffer_load_dwordx4 v[172:175], v14, s[8:11], s36 offen offset:1024 sc1
  s_mov_b32 s43, 0
  s_mov_b32 s39, 1
  s_barrier
  ds_read_b64_tr_b16 v[16:17], v8 offset:0
  ds_read_b64_tr_b16 v[18:19], v8 offset:512
  ds_read_b64_tr_b16 v[20:21], v9 offset:0
  ds_read_b64_tr_b16 v[22:23], v9 offset:512
  ds_read_b64_tr_b16 v[24:25], v10 offset:0
  ds_read_b64_tr_b16 v[26:27], v10 offset:512
  ds_read_b64_tr_b16 v[28:29], v11 offset:0
  ds_read_b64_tr_b16 v[30:31], v11 offset:512
  s_waitcnt vmcnt(13) lgkmcnt(6)
  v_mfma_f32_16x16x32_bf16 v[48:51], v[16:19], v[120:123], v[48:51]
  ds_read_b64_tr_b16 v[32:33], v8 offset:4096
  s_waitcnt vmcnt(12)
  v_mfma_f32_16x16x32_bf16 v[64:67], v[16:19], v[124:127], v[64:67]
  ds_read_b64_tr_b16 v[34:35], v8 offset:4608
  v_add_u32 v8, 8192, v8
  s_waitcnt lgkmcnt(6)
  v_mfma_f32_16x16x32_bf16 v[52:55], v[20:23], v[120:123], v[52:55]
  ds_read_b64_tr_b16 v[36:37], v9 offset:4096
  buffer_load_dwordx4 v[176:179], v14, s[8:11], s36 offen offset:2048 sc1
  v_mfma_f32_16x16x32_bf16 v[68:71], v[20:23], v[124:127], v[68:71]
  ds_read_b64_tr_b16 v[38:39], v9 offset:4608
  v_add_u32 v9, 8192, v9
  s_waitcnt lgkmcnt(6)
  v_mfma_f32_16x16x32_bf16 v[56:59], v[24:27], v[120:123], v[56:59]
  ds_read_b64_tr_b16 v[40:41], v10 offset:4096
  v_mfma_f32_16x16x32_bf16 v[72:75], v[24:27], v[124:127], v[72:75]
  ds_read_b64_tr_b16 v[42:43], v10 offset:4608
  v_add_u32 v10, 8192, v10
  s_waitcnt lgkmcnt(6)
  v_mfma_f32_16x16x32_bf16 v[60:63], v[28:31], v[120:123], v[60:63]
  ds_read_b64_tr_b16 v[44:45], v11 offset:4096
  buffer_load_dwordx4 v[180:183], v14, s[8:11], s36 offen offset:3072 sc1
  v_mfma_f32_16x16x32_bf16 v[76:79], v[28:31], v[124:127], v[76:79]
  ds_read_b64_tr_b16 v[46:47], v11 offset:4608
  v_add_u32 v11, 8192, v11
  s_waitcnt vmcnt(13) lgkmcnt(6)
  v_mfma_f32_16x16x32_bf16 v[48:51], v[32:35], v[128:131], v[48:51]
  ds_read_b64_tr_b16 v[16:17], v8 offset:0
  s_bitcmp1_b32 s48, 4
  s_cselect_b32 s36, s50, s49
  s_waitcnt vmcnt(12)
  v_mfma_f32_16x16x32_bf16 v[64:67], v[32:35], v[132:135], v[64:67]
  ds_read_b64_tr_b16 v[18:19], v8 offset:512
  s_add_u32 s36, s36, 16384
  s_waitcnt lgkmcnt(6)
  v_mfma_f32_16x16x32_bf16 v[52:55], v[36:39], v[128:131], v[52:55]
  ds_read_b64_tr_b16 v[20:21], v9 offset:0
  v_mfma_f32_16x16x32_bf16 v[68:71], v[36:39], v[132:135], v[68:71]
  ds_read_b64_tr_b16 v[22:23], v9 offset:512
  s_waitcnt lgkmcnt(6)
  v_mfma_f32_16x16x32_bf16 v[56:59], v[40:43], v[128:131], v[56:59]
  ds_read_b64_tr_b16 v[24:25], v10 offset:0
  buffer_load_dwordx4 v[120:123], v14, s[8:11], s36 offen offset:0 sc1
  v_mfma_f32_16x16x32_bf16 v[72:75], v[40:43], v[132:135], v[72:75]
  ds_read_b64_tr_b16 v[26:27], v10 offset:512
  s_waitcnt lgkmcnt(6)
  v_mfma_f32_16x16x32_bf16 v[60:63], v[44:47], v[128:131], v[60:63]
  ds_read_b64_tr_b16 v[28:29], v11 offset:0
  v_mfma_f32_16x16x32_bf16 v[76:79], v[44:47], v[132:135], v[76:79]
  ds_read_b64_tr_b16 v[30:31], v11 offset:512
  buffer_load_dwordx4 v[124:127], v14, s[8:11], s36 offen offset:1024 sc1
  s_waitcnt vmcnt(13) lgkmcnt(6)
  v_mfma_f32_16x16x32_bf16 v[48:51], v[16:19], v[136:139], v[48:51]
  ds_read_b64_tr_b16 v[32:33], v8 offset:4096
  s_waitcnt vmcnt(12)
  v_mfma_f32_16x16x32_bf16 v[64:67], v[16:19], v[140:143], v[64:67]
  ds_read_b64_tr_b16 v[34:35], v8 offset:4608
  v_add_u32 v8, 8192, v8
  s_waitcnt lgkmcnt(6)
  v_mfma_f32_16x16x32_bf16 v[52:55], v[20:23], v[136:139], v[52:55]
  ds_read_b64_tr_b16 v[36:37], v9 offset:4096
  buffer_load_dwordx4 v[128:131], v14, s[8:11], s36 offen offset:2048 sc1
  v_mfma_f32_16x16x32_bf16 v[68:71], v[20:23], v[140:143], v[68:71]
  ds_read_b64_tr_b16 v[38:39], v9 offset:4608
  v_add_u32 v9, 8192, v9
  s_waitcnt lgkmcnt(6)
  v_mfma_f32_16x16x32_bf16 v[56:59], v[24:27], v[136:139], v[56:59]
  ds_read_b64_tr_b16 v[40:41], v10 offset:4096
  v_mfma_f32_16x16x32_bf16 v[72:75], v[24:27], v[140:143], v[72:75]
  ds_read_b64_tr_b16 v[42:43], v10 offset:4608
  v_add_u32 v10, 8192, v10
  s_waitcnt lgkmcnt(6)
  v_mfma_f32_16x16x32_bf16 v[60:63], v[28:31], v[136:139], v[60:63]
  ds_read_b64_tr_b16 v[44:45], v11 offset:4096
  buffer_load_dwordx4 v[132:135], v14, s[8:11], s36 offen offset:3072 sc1
  v_mfma_f32_16x16x32_bf16 v[76:79], v[28:31], v[140:143], v[76:79]
  ds_read_b64_tr_b16 v[46:47], v11 offset:4608
  v_add_u32 v11, 8192, v11
  s_waitcnt vmcnt(13) lgkmcnt(6)
  v_mfma_f32_16x16x32_bf16 v[48:51], v[32:35], v[144:147], v[48:51]
  ds_read_b64_tr_b16 v[16:17], v8 offset:0
  s_bitcmp1_b32 s48, 5
  s_cselect_b32 s36, s50, s49
  s_waitcnt vmcnt(12)
  v_mfma_f32_16x16x32_bf16 v[64:67], v[32:35], v[148:151], v[64:67]
  ds_read_b64_tr_b16 v[18:19], v8 offset:512
  s_add_u32 s36, s36, 20480
  s_waitcnt lgkmcnt(6)
  v_mfma_f32_16x16x32_bf16 v[52:55], v[36:39], v[144:147], v[52:55]
  ds_read_b64_tr_b16 v[20:21], v9 offset:0
  v_mfma_f32_16x16x32_bf16 v[68:71], v[36:39], v[148:151], v[68:71]
  ds_read_b64_tr_b16 v[22:23], v9 offset:512
  s_waitcnt lgkmcnt(6)
  v_mfma_f32_16x16x32_bf16 v[56:59], v[40:43], v[144:147], v[56:59]
  ds_read_b64_tr_b16 v[24:25], v10 offset:0
  buffer_load_dwordx4 v[136:139], v14, s[8:11], s36 offen offset:0 sc1
  v_mfma_f32_16x16x32_bf16 v[72:75], v[40:43], v[148:151], v[72:75]
  ds_read_b64_tr_b16 v[26:27], v10 offset:512
  s_waitcnt lgkmcnt(6)
  v_mfma_f32_16x16x32_bf16 v[60:63], v[44:47], v[144:147], v[60:63]
  ds_read_b64_tr_b16 v[28:29], v11 offset:0
  v_mfma_f32_16x16x32_bf16 v[76:79], v[44:47], v[148:151], v[76:79]
  ds_read_b64_tr_b16 v[30:31], v11 offset:512
  buffer_load_dwordx4 v[140:143], v14, s[8:11], s36 offen offset:1024 sc1
  s_waitcnt vmcnt(13) lgkmcnt(6)
  v_mfma_f32_16x16x32_bf16 v[48:51], v[16:19], v[152:155], v[48:51]
  ds_read_b64_tr_b16 v[32:33], v8 offset:4096
  s_waitcnt vmcnt(12)
  v_mfma_f32_16x16x32_bf16 v[64:67], v[16:19], v[156:159], v[64:67]
  ds_read_b64_tr_b16 v[34:35], v8 offset:4608
  v_add_u32 v8, 8192, v8
  s_waitcnt lgkmcnt(6)
  v_mfma_f32_16x16x32_bf16 v[52:55], v[20:23], v[152:155], v[52:55]
  ds_read_b64_tr_b16 v[36:37], v9 offset:4096
  buffer_load_dwordx4 v[144:147], v14, s[8:11], s36 offen offset:2048 sc1
  v_mfma_f32_16x16x32_bf16 v[68:71], v[20:23], v[156:159], v[68:71]
  ds_read_b64_tr_b16 v[38:39], v9 offset:4608
  v_add_u32 v9, 8192, v9
  s_waitcnt lgkmcnt(6)
  v_mfma_f32_16x16x32_bf16 v[56:59], v[24:27], v[152:155], v[56:59]
  ds_read_b64_tr_b16 v[40:41], v10 offset:4096
  v_mfma_f32_16x16x32_bf16 v[72:75], v[24:27], v[156:159], v[72:75]
  ds_read_b64_tr_b16 v[42:43], v10 offset:4608
  v_add_u32 v10, 8192, v10
  s_waitcnt lgkmcnt(6)
  v_mfma_f32_16x16x32_bf16 v[60:63], v[28:31], v[152:155], v[60:63]
  ds_read_b64_tr_b16 v[44:45], v11 offset:4096
  buffer_load_dwordx4 v[148:151], v14, s[8:11], s36 offen offset:3072 sc1
  v_mfma_f32_16x16x32_bf16 v[76:79], v[28:31], v[156:159], v[76:79]
  ds_read_b64_tr_b16 v[46:47], v11 offset:4608
  v_add_u32 v11, 8192, v11
  s_waitcnt vmcnt(13) lgkmcnt(6)
  v_mfma_f32_16x16x32_bf16 v[48:51], v[32:35], v[160:163], v[48:51]
  ds_read_b64_tr_b16 v[16:17], v8 offset:0
  s_bitcmp1_b32 s48, 6
  s_cselect_b32 s36, s50, s49
  s_waitcnt vmcnt(12)
  v_mfma_f32_16x16x32_bf16 v[64:67], v[32:35], v[164:167], v[64:67]
  ds_read_b64_tr_b16 v[18:19], v8 offset:512
  s_add_u32 s36, s36, 24576
  s_waitcnt lgkmcnt(6)
  v_mfma_f32_16x16x32_bf16 v[52:55], v[36:39], v[160:163], v[52:55]
  ds_read_b64_tr_b16 v[20:21], v9 offset:0
  v_mfma_f32_16x16x32_bf16 v[68:71], v[36:39], v[164:167], v[68:71]
  ds_read_b64_tr_b16 v[22:23], v9 offset:512
  s_waitcnt lgkmcnt(6)
  v_mfma_f32_16x16x32_bf16 v[56:59], v[40:43], v[160:163], v[56:59]
  ds_read_b64_tr_b16 v[24:25], v10 offset:0
  buffer_load_dwordx4 v[152:155], v14, s[8:11], s36 offen offset:0 sc1
  v_mfma_f32_16x16x32_bf16 v[72:75], v[40:43], v[164:167], v[72:75]
  ds_read_b64_tr_b16 v[26:27], v10 offset:512
  s_waitcnt lgkmcnt(6)
  v_mfma_f32_16x16x32_bf16 v[60:63], v[44:47], v[160:163], v[60:63]
  ds_read_b64_tr_b16 v[28:29], v11 offset:0
  v_mfma_f32_16x16x32_bf16 v[76:79], v[44:47], v[164:167], v[76:79]
  ds_read_b64_tr_b16 v[30:31], v11 offset:512
  buffer_load_dwordx4 v[156:159], v14, s[8:11], s36 offen offset:1024 sc1
  s_waitcnt vmcnt(13) lgkmcnt(6)
  v_mfma_f32_16x16x32_bf16 v[48:51], v[16:19], v[168:171], v[48:51]
  ds_read_b64_tr_b16 v[32:33], v8 offset:4096
  s_waitcnt vmcnt(12)
  v_mfma_f32_16x16x32_bf16 v[64:67], v[16:19], v[172:175], v[64:67]
  ds_read_b64_tr_b16 v[34:35], v8 offset:4608
  v_add_u32 v8, 4294912256, v8
  s_waitcnt lgkmcnt(6)
  v_mfma_f32_16x16x32_bf16 v[52:55], v[20:23], v[168:171], v[52:55]
  ds_read_b64_tr_b16 v[36:37], v9 offset:4096
  buffer_load_dwordx4 v[160:163], v14, s[8:11], s36 offen offset:2048 sc1
  v_mfma_f32_16x16x32_bf16 v[68:71], v[20:23], v[172:175], v[68:71]
  ds_read_b64_tr_b16 v[38:39], v9 offset:4608
  v_add_u32 v9, 4294912256, v9
  s_waitcnt lgkmcnt(6)
  v_mfma_f32_16x16x32_bf16 v[56:59], v[24:27], v[168:171], v[56:59]
  ds_read_b64_tr_b16 v[40:41], v10 offset:4096
  v_mfma_f32_16x16x32_bf16 v[72:75], v[24:27], v[172:175], v[72:75]
  ds_read_b64_tr_b16 v[42:43], v10 offset:4608
  v_add_u32 v10, 4294912256, v10
  s_waitcnt lgkmcnt(6)
  v_mfma_f32_16x16x32_bf16 v[60:63], v[28:31], v[168:171], v[60:63]
  ds_read_b64_tr_b16 v[44:45], v11 offset:4096
  buffer_load_dwordx4 v[164:167], v14, s[8:11], s36 offen offset:3072 sc1
  v_mfma_f32_16x16x32_bf16 v[76:79], v[28:31], v[172:175], v[76:79]
  ds_read_b64_tr_b16 v[46:47], v11 offset:4608
  v_add_u32 v11, 4294912256, v11
  s_waitcnt vmcnt(13) lgkmcnt(6)
  v_mfma_f32_16x16x32_bf16 v[48:51], v[32:35], v[176:179], v[48:51]
  ds_read_b64_tr_b16 v[16:17], v8 offset:0
  s_bitcmp1_b32 s48, 7
  s_cselect_b32 s36, s50, s49
  s_waitcnt vmcnt(12)
  v_mfma_f32_16x16x32_bf16 v[64:67], v[32:35], v[180:183], v[64:67]
  ds_read_b64_tr_b16 v[18:19], v8 offset:512
  s_add_u32 s36, s36, 28672
  s_waitcnt lgkmcnt(6)
  v_mfma_f32_16x16x32_bf16 v[52:55], v[36:39], v[176:179], v[52:55]
  ds_read_b64_tr_b16 v[20:21], v9 offset:0
  v_mfma_f32_16x16x32_bf16 v[68:71], v[36:39], v[180:183], v[68:71]
  ds_read_b64_tr_b16 v[22:23], v9 offset:512
  s_waitcnt lgkmcnt(6)
  v_mfma_f32_16x16x32_bf16 v[56:59], v[40:43], v[176:179], v[56:59]
  ds_read_b64_tr_b16 v[24:25], v10 offset:0
  buffer_load_dwordx4 v[168:171], v14, s[8:11], s36 offen offset:0 sc1
  v_mfma_f32_16x16x32_bf16 v[72:75], v[40:43], v[180:183], v[72:75]
  ds_read_b64_tr_b16 v[26:27], v10 offset:512
  s_waitcnt lgkmcnt(6)
  v_mfma_f32_16x16x32_bf16 v[60:63], v[44:47], v[176:179], v[60:63]
  ds_read_b64_tr_b16 v[28:29], v11 offset:0
  v_mfma_f32_16x16x32_bf16 v[76:79], v[44:47], v[180:183], v[76:79]
  ds_read_b64_tr_b16 v[30:31], v11 offset:512
  buffer_load_dwordx4 v[172:175], v14, s[8:11], s36 offen offset:1024 sc1
  s_waitcnt vmcnt(13) lgkmcnt(6)
  v_mfma_f32_16x16x32_bf16 v[48:51], v[16:19], v[120:123], v[48:51]
  ds_read_b64_tr_b16 v[32:33], v8 offset:4096
  s_waitcnt vmcnt(12)
  v_mfma_f32_16x16x32_bf16 v[64:67], v[16:19], v[124:127], v[64:67]
  ds_read_b64_tr_b16 v[34:35], v8 offset:4608
  v_add_u32 v8, 8192, v8
  s_waitcnt lgkmcnt(6)
  v_mfma_f32_16x16x32_bf16 v[52:55], v[20:23], v[120:123], v[52:55]
  ds_read_b64_tr_b16 v[36:37], v9 offset:4096
  buffer_load_dwordx4 v[176:179], v14, s[8:11], s36 offen offset:2048 sc1
  v_mfma_f32_16x16x32_bf16 v[68:71], v[20:23], v[124:127], v[68:71]
  ds_read_b64_tr_b16 v[38:39], v9 offset:4608
  v_add_u32 v9, 8192, v9
  s_waitcnt lgkmcnt(6)
  v_mfma_f32_16x16x32_bf16 v[56:59], v[24:27], v[120:123], v[56:59]
  ds_read_b64_tr_b16 v[40:41], v10 offset:4096
  v_mfma_f32_16x16x32_bf16 v[72:75], v[24:27], v[124:127], v[72:75]
  ds_read_b64_tr_b16 v[42:43], v10 offset:4608
  v_add_u32 v10, 8192, v10
  s_waitcnt lgkmcnt(6)
  v_mfma_f32_16x16x32_bf16 v[60:63], v[28:31], v[120:123], v[60:63]
  ds_read_b64_tr_b16 v[44:45], v11 offset:4096
  buffer_load_dwordx4 v[180:183], v14, s[8:11], s36 offen offset:3072 sc1
  v_mfma_f32_16x16x32_bf16 v[76:79], v[28:31], v[124:127], v[76:79]
  ds_read_b64_tr_b16 v[46:47], v11 offset:4608
  v_add_u32 v11, 8192, v11
  s_waitcnt vmcnt(13) lgkmcnt(6)
  v_mfma_f32_16x16x32_bf16 v[48:51], v[32:35], v[128:131], v[48:51]
  ds_read_b64_tr_b16 v[16:17], v8 offset:0
  s_mov_b32 s49, s50
  s_add_u32 s50, s50, 32768
  s_waitcnt vmcnt(12)
  v_mfma_f32_16x16x32_bf16 v[64:67], v[32:35], v[132:135], v[64:67]
  ds_read_b64_tr_b16 v[18:19], v8 offset:512
  s_cmp_eq_u32 s50, s41
  s_cselect_b32 s50, s34, s50
  s_waitcnt lgkmcnt(6)
  v_mfma_f32_16x16x32_bf16 v[52:55], v[36:39], v[128:131], v[52:55]
  ds_read_b64_tr_b16 v[20:21], v9 offset:0
  s_bitcmp1_b32 s48, 0
  s_cselect_b32 s36, s50, s49
  v_mfma_f32_16x16x32_bf16 v[68:71], v[36:39], v[132:135], v[68:71]
  ds_read_b64_tr_b16 v[22:23], v9 offset:512
  s_add_u32 s36, s36, 0
  s_waitcnt lgkmcnt(6)
  v_mfma_f32_16x16x32_bf16 v[56:59], v[40:43], v[128:131], v[56:59]
  ds_read_b64_tr_b16 v[24:25], v10 offset:0
  buffer_load_dwordx4 v[120:123], v14, s[8:11], s36 offen offset:0 sc1
  v_mfma_f32_16x16x32_bf16 v[72:75], v[40:43], v[132:135], v[72:75]
  ds_read_b64_tr_b16 v[26:27], v10 offset:512
  s_waitcnt lgkmcnt(6)
  v_mfma_f32_16x16x32_bf16 v[60:63], v[44:47], v[128:131], v[60:63]
  ds_read_b64_tr_b16 v[28:29], v11 offset:0
  v_mfma_f32_16x16x32_bf16 v[76:79], v[44:47], v[132:135], v[76:79]
  ds_read_b64_tr_b16 v[30:31], v11 offset:512
  buffer_load_dwordx4 v[124:127], v14, s[8:11], s36 offen offset:1024 sc1
  s_waitcnt vmcnt(13) lgkmcnt(6)
  v_mfma_f32_16x16x32_bf16 v[48:51], v[16:19], v[136:139], v[48:51]
  ds_read_b64_tr_b16 v[32:33], v8 offset:4096
  s_waitcnt vmcnt(12)
  v_mfma_f32_16x16x32_bf16 v[64:67], v[16:19], v[140:143], v[64:67]
  ds_read_b64_tr_b16 v[34:35], v8 offset:4608
  v_add_u32 v8, 8192, v8
  s_waitcnt lgkmcnt(6)
  v_mfma_f32_16x16x32_bf16 v[52:55], v[20:23], v[136:139], v[52:55]
  ds_read_b64_tr_b16 v[36:37], v9 offset:4096
  buffer_load_dwordx4 v[128:131], v14, s[8:11], s36 offen offset:2048 sc1
  v_mfma_f32_16x16x32_bf16 v[68:71], v[20:23], v[140:143], v[68:71]
  ds_read_b64_tr_b16 v[38:39], v9 offset:4608
  v_add_u32 v9, 8192, v9
  s_waitcnt lgkmcnt(6)
  v_mfma_f32_16x16x32_bf16 v[56:59], v[24:27], v[136:139], v[56:59]
  ds_read_b64_tr_b16 v[40:41], v10 offset:4096
  v_mfma_f32_16x16x32_bf16 v[72:75], v[24:27], v[140:143], v[72:75]
  ds_read_b64_tr_b16 v[42:43], v10 offset:4608
  v_add_u32 v10, 8192, v10
  s_waitcnt lgkmcnt(6)
  v_mfma_f32_16x16x32_bf16 v[60:63], v[28:31], v[136:139], v[60:63]
  ds_read_b64_tr_b16 v[44:45], v11 offset:4096
  buffer_load_dwordx4 v[132:135], v14, s[8:11], s36 offen offset:3072 sc1
  v_mfma_f32_16x16x32_bf16 v[76:79], v[28:31], v[140:143], v[76:79]
  ds_read_b64_tr_b16 v[46:47], v11 offset:4608
  v_add_u32 v11, 8192, v11
  s_waitcnt vmcnt(13) lgkmcnt(6)
  v_mfma_f32_16x16x32_bf16 v[48:51], v[32:35], v[144:147], v[48:51]
  ds_read_b64_tr_b16 v[16:17], v8 offset:0
  s_bitcmp1_b32 s48, 1
  s_cselect_b32 s36, s50, s49
  s_waitcnt vmcnt(12)
  v_mfma_f32_16x16x32_bf16 v[64:67], v[32:35], v[148:151], v[64:67]
  ds_read_b64_tr_b16 v[18:19], v8 offset:512
  s_add_u32 s36, s36, 4096
  s_waitcnt lgkmcnt(6)
  v_mfma_f32_16x16x32_bf16 v[52:55], v[36:39], v[144:147], v[52:55]
  ds_read_b64_tr_b16 v[20:21], v9 offset:0
  v_mfma_f32_16x16x32_bf16 v[68:71], v[36:39], v[148:151], v[68:71]
  ds_read_b64_tr_b16 v[22:23], v9 offset:512
  s_waitcnt lgkmcnt(6)
  v_mfma_f32_16x16x32_bf16 v[56:59], v[40:43], v[144:147], v[56:59]
  ds_read_b64_tr_b16 v[24:25], v10 offset:0
  buffer_load_dwordx4 v[136:139], v14, s[8:11], s36 offen offset:0 sc1
  v_mfma_f32_16x16x32_bf16 v[72:75], v[40:43], v[148:151], v[72:75]
  ds_read_b64_tr_b16 v[26:27], v10 offset:512
  s_waitcnt lgkmcnt(6)
  v_mfma_f32_16x16x32_bf16 v[60:63], v[44:47], v[144:147], v[60:63]
  ds_read_b64_tr_b16 v[28:29], v11 offset:0
  v_mfma_f32_16x16x32_bf16 v[76:79], v[44:47], v[148:151], v[76:79]
  ds_read_b64_tr_b16 v[30:31], v11 offset:512
  buffer_load_dwordx4 v[140:143], v14, s[8:11], s36 offen offset:1024 sc1
  s_waitcnt vmcnt(13) lgkmcnt(6)
  v_mfma_f32_16x16x32_bf16 v[48:51], v[16:19], v[152:155], v[48:51]
  ds_read_b64_tr_b16 v[32:33], v8 offset:4096
  s_waitcnt vmcnt(12)
  v_mfma_f32_16x16x32_bf16 v[64:67], v[16:19], v[156:159], v[64:67]
  ds_read_b64_tr_b16 v[34:35], v8 offset:4608
  v_add_u32 v8, 4294850304, v8
  s_waitcnt lgkmcnt(6)
  v_mfma_f32_16x16x32_bf16 v[52:55], v[20:23], v[152:155], v[52:55]
  ds_read_b64_tr_b16 v[36:37], v9 offset:4096
  buffer_load_dwordx4 v[144:147], v14, s[8:11], s36 offen offset:2048 sc1
  v_mfma_f32_16x16x32_bf16 v[68:71], v[20:23], v[156:159], v[68:71]
  ds_read_b64_tr_b16 v[38:39], v9 offset:4608
  v_add_u32 v9, 4294850304, v9
  s_waitcnt lgkmcnt(6)
  v_mfma_f32_16x16x32_bf16 v[56:59], v[24:27], v[152:155], v[56:59]
  ds_read_b64_tr_b16 v[40:41], v10 offset:4096
  v_mfma_f32_16x16x32_bf16 v[72:75], v[24:27], v[156:159], v[72:75]
  ds_read_b64_tr_b16 v[42:43], v10 offset:4608
  v_add_u32 v10, 4294850304, v10
  s_waitcnt lgkmcnt(6)
  v_mfma_f32_16x16x32_bf16 v[60:63], v[28:31], v[152:155], v[60:63]
  ds_read_b64_tr_b16 v[44:45], v11 offset:4096
  buffer_load_dwordx4 v[148:151], v14, s[8:11], s36 offen offset:3072 sc1
  v_mfma_f32_16x16x32_bf16 v[76:79], v[28:31], v[156:159], v[76:79]
  ds_read_b64_tr_b16 v[46:47], v11 offset:4608
  v_add_u32 v11, 4294850304, v11
  s_waitcnt vmcnt(13) lgkmcnt(6)
  v_mfma_f32_16x16x32_bf16 v[48:51], v[32:35], v[160:163], v[48:51]
  ds_read_b64_tr_b16 v[16:17], v8 offset:0
  s_bitcmp1_b32 s48, 2
  s_cselect_b32 s36, s50, s49
  s_waitcnt vmcnt(12)
  v_mfma_f32_16x16x32_bf16 v[64:67], v[32:35], v[164:167], v[64:67]
  ds_read_b64_tr_b16 v[18:19], v8 offset:512
  s_add_u32 s36, s36, 8192
  s_waitcnt lgkmcnt(6)
  v_mfma_f32_16x16x32_bf16 v[52:55], v[36:39], v[160:163], v[52:55]
  ds_read_b64_tr_b16 v[20:21], v9 offset:0
  v_mfma_f32_16x16x32_bf16 v[68:71], v[36:39], v[164:167], v[68:71]
  ds_read_b64_tr_b16 v[22:23], v9 offset:512
  s_waitcnt lgkmcnt(6)
  v_mfma_f32_16x16x32_bf16 v[56:59], v[40:43], v[160:163], v[56:59]
  ds_read_b64_tr_b16 v[24:25], v10 offset:0
  buffer_load_dwordx4 v[152:155], v14, s[8:11], s36 offen offset:0 sc1
  v_mfma_f32_16x16x32_bf16 v[72:75], v[40:43], v[164:167], v[72:75]
  ds_read_b64_tr_b16 v[26:27], v10 offset:512
  s_waitcnt lgkmcnt(6)
  v_mfma_f32_16x16x32_bf16 v[60:63], v[44:47], v[160:163], v[60:63]
  ds_read_b64_tr_b16 v[28:29], v11 offset:0
  v_mfma_f32_16x16x32_bf16 v[76:79], v[44:47], v[164:167], v[76:79]
  ds_read_b64_tr_b16 v[30:31], v11 offset:512
  buffer_load_dwordx4 v[156:159], v14, s[8:11], s36 offen offset:1024 sc1
  s_waitcnt vmcnt(13) lgkmcnt(6)
  v_mfma_f32_16x16x32_bf16 v[48:51], v[16:19], v[168:171], v[48:51]
  ds_read_b64_tr_b16 v[32:33], v8 offset:4096
  s_waitcnt vmcnt(12)
  v_mfma_f32_16x16x32_bf16 v[64:67], v[16:19], v[172:175], v[64:67]
  ds_read_b64_tr_b16 v[34:35], v8 offset:4608
  v_add_u32 v8, 8192, v8
  s_waitcnt lgkmcnt(6)
  v_mfma_f32_16x16x32_bf16 v[52:55], v[20:23], v[168:171], v[52:55]
  ds_read_b64_tr_b16 v[36:37], v9 offset:4096
  buffer_load_dwordx4 v[160:163], v14, s[8:11], s36 offen offset:2048 sc1
  v_mfma_f32_16x16x32_bf16 v[68:71], v[20:23], v[172:175], v[68:71]
  ds_read_b64_tr_b16 v[38:39], v9 offset:4608
  v_add_u32 v9, 8192, v9
  s_waitcnt lgkmcnt(6)
  v_mfma_f32_16x16x32_bf16 v[56:59], v[24:27], v[168:171], v[56:59]
  ds_read_b64_tr_b16 v[40:41], v10 offset:4096
  v_mfma_f32_16x16x32_bf16 v[72:75], v[24:27], v[172:175], v[72:75]
  ds_read_b64_tr_b16 v[42:43], v10 offset:4608
  v_add_u32 v10, 8192, v10
  s_waitcnt lgkmcnt(6)
  v_mfma_f32_16x16x32_bf16 v[60:63], v[28:31], v[168:171], v[60:63]
  ds_read_b64_tr_b16 v[44:45], v11 offset:4096
  buffer_load_dwordx4 v[164:167], v14, s[8:11], s36 offen offset:3072 sc1
  v_mfma_f32_16x16x32_bf16 v[76:79], v[28:31], v[172:175], v[76:79]
  ds_read_b64_tr_b16 v[46:47], v11 offset:4608
  v_add_u32 v11, 8192, v11
  s_waitcnt vmcnt(13) lgkmcnt(6)
  v_mfma_f32_16x16x32_bf16 v[48:51], v[32:35], v[176:179], v[48:51]
  ds_read_b64_tr_b16 v[16:17], v8 offset:0
  s_bitcmp1_b32 s48, 3
  s_cselect_b32 s36, s50, s49
  s_waitcnt vmcnt(12)
  v_mfma_f32_16x16x32_bf16 v[64:67], v[32:35], v[180:183], v[64:67]
  ds_read_b64_tr_b16 v[18:19], v8 offset:512
  s_add_u32 s36, s36, 12288
  s_waitcnt lgkmcnt(6)
  v_mfma_f32_16x16x32_bf16 v[52:55], v[36:39], v[176:179], v[52:55]
  ds_read_b64_tr_b16 v[20:21], v9 offset:0
  v_mfma_f32_16x16x32_bf16 v[68:71], v[36:39], v[180:183], v[68:71]
  ds_read_b64_tr_b16 v[22:23], v9 offset:512
  s_waitcnt lgkmcnt(6)
  v_mfma_f32_16x16x32_bf16 v[56:59], v[40:43], v[176:179], v[56:59]
  ds_read_b64_tr_b16 v[24:25], v10 offset:0
  buffer_load_dwordx4 v[168:171], v14, s[8:11], s36 offen offset:0 sc1
  v_mfma_f32_16x16x32_bf16 v[72:75], v[40:43], v[180:183], v[72:75]
  ds_read_b64_tr_b16 v[26:27], v10 offset:512
  s_waitcnt lgkmcnt(6)
  v_mfma_f32_16x16x32_bf16 v[60:63], v[44:47], v[176:179], v[60:63]
  ds_read_b64_tr_b16 v[28:29], v11 offset:0
  v_mfma_f32_16x16x32_bf16 v[76:79], v[44:47], v[180:183], v[76:79]
  ds_read_b64_tr_b16 v[30:31], v11 offset:512
  buffer_load_dwordx4 v[172:175], v14, s[8:11], s36 offen offset:1024 sc1
  s_waitcnt vmcnt(13) lgkmcnt(6)
  v_mfma_f32_16x16x32_bf16 v[48:51], v[16:19], v[120:123], v[48:51]
  ds_read_b64_tr_b16 v[32:33], v8 offset:4096
  s_waitcnt vmcnt(12)
  v_mfma_f32_16x16x32_bf16 v[64:67], v[16:19], v[124:127], v[64:67]
  ds_read_b64_tr_b16 v[34:35], v8 offset:4608
  v_add_u32 v8, 8192, v8
  s_waitcnt lgkmcnt(6)
  v_mfma_f32_16x16x32_bf16 v[52:55], v[20:23], v[120:123], v[52:55]
  ds_read_b64_tr_b16 v[36:37], v9 offset:4096
  buffer_load_dwordx4 v[176:179], v14, s[8:11], s36 offen offset:2048 sc1
  v_mfma_f32_16x16x32_bf16 v[68:71], v[20:23], v[124:127], v[68:71]
  ds_read_b64_tr_b16 v[38:39], v9 offset:4608
  v_add_u32 v9, 8192, v9
  s_waitcnt lgkmcnt(6)
  v_mfma_f32_16x16x32_bf16 v[56:59], v[24:27], v[120:123], v[56:59]
  ds_read_b64_tr_b16 v[40:41], v10 offset:4096
  v_mfma_f32_16x16x32_bf16 v[72:75], v[24:27], v[124:127], v[72:75]
  ds_read_b64_tr_b16 v[42:43], v10 offset:4608
  v_add_u32 v10, 8192, v10
  s_waitcnt lgkmcnt(6)
  v_mfma_f32_16x16x32_bf16 v[60:63], v[28:31], v[120:123], v[60:63]
  ds_read_b64_tr_b16 v[44:45], v11 offset:4096
  buffer_load_dwordx4 v[180:183], v14, s[8:11], s36 offen offset:3072 sc1
  v_mfma_f32_16x16x32_bf16 v[76:79], v[28:31], v[124:127], v[76:79]
  ds_read_b64_tr_b16 v[46:47], v11 offset:4608
  v_add_u32 v11, 8192, v11
  s_waitcnt vmcnt(13) lgkmcnt(6)
  v_mfma_f32_16x16x32_bf16 v[48:51], v[32:35], v[128:131], v[48:51]
  ds_read_b64_tr_b16 v[16:17], v8 offset:0
  s_bitcmp1_b32 s48, 4
  s_cselect_b32 s36, s50, s49
  s_waitcnt vmcnt(12)
  v_mfma_f32_16x16x32_bf16 v[64:67], v[32:35], v[132:135], v[64:67]
  ds_read_b64_tr_b16 v[18:19], v8 offset:512
  s_add_u32 s36, s36, 16384
  s_waitcnt lgkmcnt(6)
  v_mfma_f32_16x16x32_bf16 v[52:55], v[36:39], v[128:131], v[52:55]
  ds_read_b64_tr_b16 v[20:21], v9 offset:0
  v_mfma_f32_16x16x32_bf16 v[68:71], v[36:39], v[132:135], v[68:71]
  ds_read_b64_tr_b16 v[22:23], v9 offset:512
  s_waitcnt lgkmcnt(6)
  v_mfma_f32_16x16x32_bf16 v[56:59], v[40:43], v[128:131], v[56:59]
  ds_read_b64_tr_b16 v[24:25], v10 offset:0
  buffer_load_dwordx4 v[120:123], v14, s[8:11], s36 offen offset:0 sc1
  v_mfma_f32_16x16x32_bf16 v[72:75], v[40:43], v[132:135], v[72:75]
  ds_read_b64_tr_b16 v[26:27], v10 offset:512
  s_waitcnt lgkmcnt(6)
  v_mfma_f32_16x16x32_bf16 v[60:63], v[44:47], v[128:131], v[60:63]
  ds_read_b64_tr_b16 v[28:29], v11 offset:0
  v_mfma_f32_16x16x32_bf16 v[76:79], v[44:47], v[132:135], v[76:79]
  ds_read_b64_tr_b16 v[30:31], v11 offset:512
  buffer_load_dwordx4 v[124:127], v14, s[8:11], s36 offen offset:1024 sc1
  s_waitcnt vmcnt(13) lgkmcnt(6)
  v_mfma_f32_16x16x32_bf16 v[48:51], v[16:19], v[136:139], v[48:51]
  ds_read_b64_tr_b16 v[32:33], v8 offset:4096
  s_waitcnt vmcnt(12)
  v_mfma_f32_16x16x32_bf16 v[64:67], v[16:19], v[140:143], v[64:67]
  ds_read_b64_tr_b16 v[34:35], v8 offset:4608
  v_add_u32 v8, 8192, v8
  s_waitcnt lgkmcnt(6)
  v_mfma_f32_16x16x32_bf16 v[52:55], v[20:23], v[136:139], v[52:55]
  ds_read_b64_tr_b16 v[36:37], v9 offset:4096
  buffer_load_dwordx4 v[128:131], v14, s[8:11], s36 offen offset:2048 sc1
  v_mfma_f32_16x16x32_bf16 v[68:71], v[20:23], v[140:143], v[68:71]
  ds_read_b64_tr_b16 v[38:39], v9 offset:4608
  v_add_u32 v9, 8192, v9
  s_waitcnt lgkmcnt(6)
  v_mfma_f32_16x16x32_bf16 v[56:59], v[24:27], v[136:139], v[56:59]
  ds_read_b64_tr_b16 v[40:41], v10 offset:4096
  v_mfma_f32_16x16x32_bf16 v[72:75], v[24:27], v[140:143], v[72:75]
  ds_read_b64_tr_b16 v[42:43], v10 offset:4608
  v_add_u32 v10, 8192, v10
  s_waitcnt lgkmcnt(6)
  v_mfma_f32_16x16x32_bf16 v[60:63], v[28:31], v[136:139], v[60:63]
  ds_read_b64_tr_b16 v[44:45], v11 offset:4096
  buffer_load_dwordx4 v[132:135], v14, s[8:11], s36 offen offset:3072 sc1
  v_mfma_f32_16x16x32_bf16 v[76:79], v[28:31], v[140:143], v[76:79]
  ds_read_b64_tr_b16 v[46:47], v11 offset:4608
  v_add_u32 v11, 8192, v11
  s_waitcnt vmcnt(13) lgkmcnt(6)
  v_mfma_f32_16x16x32_bf16 v[48:51], v[32:35], v[144:147], v[48:51]
  ds_read_b64_tr_b16 v[16:17], v8 offset:0
  s_bitcmp1_b32 s48, 5
  s_cselect_b32 s36, s50, s49
  s_waitcnt vmcnt(12)
  v_mfma_f32_16x16x32_bf16 v[64:67], v[32:35], v[148:151], v[64:67]
  ds_read_b64_tr_b16 v[18:19], v8 offset:512
  s_add_u32 s36, s36, 20480
  s_waitcnt lgkmcnt(6)
  v_mfma_f32_16x16x32_bf16 v[52:55], v[36:39], v[144:147], v[52:55]
  ds_read_b64_tr_b16 v[20:21], v9 offset:0
  v_mfma_f32_16x16x32_bf16 v[68:71], v[36:39], v[148:151], v[68:71]
  ds_read_b64_tr_b16 v[22:23], v9 offset:512
  s_waitcnt lgkmcnt(6)
  v_mfma_f32_16x16x32_bf16 v[56:59], v[40:43], v[144:147], v[56:59]
  ds_read_b64_tr_b16 v[24:25], v10 offset:0
  buffer_load_dwordx4 v[136:139], v14, s[8:11], s36 offen offset:0 sc1
  v_mfma_f32_16x16x32_bf16 v[72:75], v[40:43], v[148:151], v[72:75]
  ds_read_b64_tr_b16 v[26:27], v10 offset:512
  s_waitcnt lgkmcnt(6)
  v_mfma_f32_16x16x32_bf16 v[60:63], v[44:47], v[144:147], v[60:63]
  ds_read_b64_tr_b16 v[28:29], v11 offset:0
  v_mfma_f32_16x16x32_bf16 v[76:79], v[44:47], v[148:151], v[76:79]
  ds_read_b64_tr_b16 v[30:31], v11 offset:512
  buffer_load_dwordx4 v[140:143], v14, s[8:11], s36 offen offset:1024 sc1
  s_waitcnt vmcnt(13) lgkmcnt(6)
  v_mfma_f32_16x16x32_bf16 v[48:51], v[16:19], v[152:155], v[48:51]
  ds_read_b64_tr_b16 v[32:33], v8 offset:4096
  s_waitcnt vmcnt(12)
  v_mfma_f32_16x16x32_bf16 v[64:67], v[16:19], v[156:159], v[64:67]
  ds_read_b64_tr_b16 v[34:35], v8 offset:4608
  v_add_u32 v8, 8192, v8
  s_waitcnt lgkmcnt(6)
  v_mfma_f32_16x16x32_bf16 v[52:55], v[20:23], v[152:155], v[52:55]
  ds_read_b64_tr_b16 v[36:37], v9 offset:4096
  buffer_load_dwordx4 v[144:147], v14, s[8:11], s36 offen offset:2048 sc1
  v_mfma_f32_16x16x32_bf16 v[68:71], v[20:23], v[156:159], v[68:71]
  ds_read_b64_tr_b16 v[38:39], v9 offset:4608
  v_add_u32 v9, 8192, v9
  s_waitcnt lgkmcnt(6)
  v_mfma_f32_16x16x32_bf16 v[56:59], v[24:27], v[152:155], v[56:59]
  ds_read_b64_tr_b16 v[40:41], v10 offset:4096
  v_mfma_f32_16x16x32_bf16 v[72:75], v[24:27], v[156:159], v[72:75]
  ds_read_b64_tr_b16 v[42:43], v10 offset:4608
  v_add_u32 v10, 8192, v10
  s_waitcnt lgkmcnt(6)
  v_mfma_f32_16x16x32_bf16 v[60:63], v[28:31], v[152:155], v[60:63]
  ds_read_b64_tr_b16 v[44:45], v11 offset:4096
  buffer_load_dwordx4 v[148:151], v14, s[8:11], s36 offen offset:3072 sc1
  v_mfma_f32_16x16x32_bf16 v[76:79], v[28:31], v[156:159], v[76:79]
  ds_read_b64_tr_b16 v[46:47], v11 offset:4608
  v_add_u32 v11, 8192, v11
  s_waitcnt vmcnt(13) lgkmcnt(6)
  v_mfma_f32_16x16x32_bf16 v[48:51], v[32:35], v[160:163], v[48:51]
  ds_read_b64_tr_b16 v[16:17], v8 offset:0
  s_bitcmp1_b32 s48, 6
  s_cselect_b32 s36, s50, s49
  s_waitcnt vmcnt(12)
  v_mfma_f32_16x16x32_bf16 v[64:67], v[32:35], v[164:167], v[64:67]
  ds_read_b64_tr_b16 v[18:19], v8 offset:512
  s_add_u32 s36, s36, 24576
  s_waitcnt lgkmcnt(6)
  v_mfma_f32_16x16x32_bf16 v[52:55], v[36:39], v[160:163], v[52:55]
  ds_read_b64_tr_b16 v[20:21], v9 offset:0
  v_mfma_f32_16x16x32_bf16 v[68:71], v[36:39], v[164:167], v[68:71]
  ds_read_b64_tr_b16 v[22:23], v9 offset:512
  s_waitcnt lgkmcnt(6)
  v_mfma_f32_16x16x32_bf16 v[56:59], v[40:43], v[160:163], v[56:59]
  ds_read_b64_tr_b16 v[24:25], v10 offset:0
  buffer_load_dwordx4 v[152:155], v14, s[8:11], s36 offen offset:0 sc1
  v_mfma_f32_16x16x32_bf16 v[72:75], v[40:43], v[164:167], v[72:75]
  ds_read_b64_tr_b16 v[26:27], v10 offset:512
  s_waitcnt lgkmcnt(6)
  v_mfma_f32_16x16x32_bf16 v[60:63], v[44:47], v[160:163], v[60:63]
  ds_read_b64_tr_b16 v[28:29], v11 offset:0
  v_mfma_f32_16x16x32_bf16 v[76:79], v[44:47], v[164:167], v[76:79]
  ds_read_b64_tr_b16 v[30:31], v11 offset:512
  buffer_load_dwordx4 v[156:159], v14, s[8:11], s36 offen offset:1024 sc1
  s_waitcnt vmcnt(13) lgkmcnt(6)
  v_mfma_f32_16x16x32_bf16 v[48:51], v[16:19], v[168:171], v[48:51]
  ds_read_b64_tr_b16 v[32:33], v8 offset:4096
  s_waitcnt vmcnt(12)
  v_mfma_f32_16x16x32_bf16 v[64:67], v[16:19], v[172:175], v[64:67]
  ds_read_b64_tr_b16 v[34:35], v8 offset:4608
  v_add_u32 v8, 10240, v8
  s_waitcnt lgkmcnt(6)
  v_mfma_f32_16x16x32_bf16 v[52:55], v[20:23], v[168:171], v[52:55]
  ds_read_b64_tr_b16 v[36:37], v9 offset:4096
  buffer_load_dwordx4 v[160:163], v14, s[8:11], s36 offen offset:2048 sc1
  v_mfma_f32_16x16x32_bf16 v[68:71], v[20:23], v[172:175], v[68:71]
  ds_read_b64_tr_b16 v[38:39], v9 offset:4608
  v_add_u32 v9, 10240, v9
  s_waitcnt lgkmcnt(6)
  v_mfma_f32_16x16x32_bf16 v[56:59], v[24:27], v[168:171], v[56:59]
  ds_read_b64_tr_b16 v[40:41], v10 offset:4096
  v_mfma_f32_16x16x32_bf16 v[72:75], v[24:27], v[172:175], v[72:75]
  ds_read_b64_tr_b16 v[42:43], v10 offset:4608
  v_add_u32 v10, 10240, v10
  s_waitcnt lgkmcnt(6)
  v_mfma_f32_16x16x32_bf16 v[60:63], v[28:31], v[168:171], v[60:63]
  ds_read_b64_tr_b16 v[44:45], v11 offset:4096
  buffer_load_dwordx4 v[164:167], v14, s[8:11], s36 offen offset:3072 sc1
  v_mfma_f32_16x16x32_bf16 v[76:79], v[28:31], v[172:175], v[76:79]
  ds_read_b64_tr_b16 v[46:47], v11 offset:4608
  v_add_u32 v11, 10240, v11
  s_waitcnt vmcnt(13) lgkmcnt(6)
  v_mfma_f32_16x16x32_bf16 v[48:51], v[32:35], v[176:179], v[48:51]
  ds_read_b64_tr_b16 v[16:17], v8 offset:0
  s_bitcmp1_b32 s48, 7
  s_cselect_b32 s36, s50, s49
  s_waitcnt vmcnt(12)
  v_mfma_f32_16x16x32_bf16 v[64:67], v[32:35], v[180:183], v[64:67]
  ds_read_b64_tr_b16 v[18:19], v8 offset:512
  s_add_u32 s36, s36, 28672
  s_waitcnt lgkmcnt(6)
  v_mfma_f32_16x16x32_bf16 v[52:55], v[36:39], v[176:179], v[52:55]
  ds_read_b64_tr_b16 v[20:21], v9 offset:0
  v_mfma_f32_16x16x32_bf16 v[68:71], v[36:39], v[180:183], v[68:71]
  ds_read_b64_tr_b16 v[22:23], v9 offset:512
  s_waitcnt lgkmcnt(6)
  v_mfma_f32_16x16x32_bf16 v[56:59], v[40:43], v[176:179], v[56:59]
  ds_read_b64_tr_b16 v[24:25], v10 offset:0
  buffer_load_dwordx4 v[168:171], v14, s[8:11], s36 offen offset:0 sc1
  v_mfma_f32_16x16x32_bf16 v[72:75], v[40:43], v[180:183], v[72:75]
  ds_read_b64_tr_b16 v[26:27], v10 offset:512
  s_waitcnt lgkmcnt(6)
  v_mfma_f32_16x16x32_bf16 v[60:63], v[44:47], v[176:179], v[60:63]
  ds_read_b64_tr_b16 v[28:29], v11 offset:0
  v_mfma_f32_16x16x32_bf16 v[76:79], v[44:47], v[180:183], v[76:79]
  ds_read_b64_tr_b16 v[30:31], v11 offset:512
  buffer_load_dwordx4 v[172:175], v14, s[8:11], s36 offen offset:1024 sc1
  s_waitcnt vmcnt(13) lgkmcnt(6)
  v_mfma_f32_16x16x32_bf16 v[48:51], v[16:19], v[120:123], v[48:51]
  ds_read_b64_tr_b16 v[32:33], v8 offset:4096
  s_waitcnt vmcnt(12)
  v_mfma_f32_16x16x32_bf16 v[64:67], v[16:19], v[124:127], v[64:67]
  ds_read_b64_tr_b16 v[34:35], v8 offset:4608
  v_add_u32 v8, 8192, v8
  s_waitcnt lgkmcnt(6)
  v_mfma_f32_16x16x32_bf16 v[52:55], v[20:23], v[120:123], v[52:55]
  ds_read_b64_tr_b16 v[36:37], v9 offset:4096
  buffer_load_dwordx4 v[176:179], v14, s[8:11], s36 offen offset:2048 sc1
  v_mfma_f32_16x16x32_bf16 v[68:71], v[20:23], v[124:127], v[68:71]
  ds_read_b64_tr_b16 v[38:39], v9 offset:4608
  v_add_u32 v9, 8192, v9
  s_waitcnt lgkmcnt(6)
  v_mfma_f32_16x16x32_bf16 v[56:59], v[24:27], v[120:123], v[56:59]
  ds_read_b64_tr_b16 v[40:41], v10 offset:4096
  v_mfma_f32_16x16x32_bf16 v[72:75], v[24:27], v[124:127], v[72:75]
  ds_read_b64_tr_b16 v[42:43], v10 offset:4608
  v_add_u32 v10, 8192, v10
  s_waitcnt lgkmcnt(6)
  v_mfma_f32_16x16x32_bf16 v[60:63], v[28:31], v[120:123], v[60:63]
  ds_read_b64_tr_b16 v[44:45], v11 offset:4096
  buffer_load_dwordx4 v[180:183], v14, s[8:11], s36 offen offset:3072 sc1
  v_mfma_f32_16x16x32_bf16 v[76:79], v[28:31], v[124:127], v[76:79]
  ds_read_b64_tr_b16 v[46:47], v11 offset:4608
  v_add_u32 v11, 8192, v11
  s_waitcnt vmcnt(13) lgkmcnt(6)
  v_mfma_f32_16x16x32_bf16 v[48:51], v[32:35], v[128:131], v[48:51]
  ds_read_b64_tr_b16 v[16:17], v8 offset:0
  s_waitcnt vmcnt(12)
  v_mfma_f32_16x16x32_bf16 v[64:67], v[32:35], v[132:135], v[64:67]
  ds_read_b64_tr_b16 v[18:19], v8 offset:512
  s_waitcnt lgkmcnt(6)
  v_mfma_f32_16x16x32_bf16 v[52:55], v[36:39], v[128:131], v[52:55]
  ds_read_b64_tr_b16 v[20:21], v9 offset:0
  v_mfma_f32_16x16x32_bf16 v[68:71], v[36:39], v[132:135], v[68:71]
  ds_read_b64_tr_b16 v[22:23], v9 offset:512
  s_waitcnt lgkmcnt(6)
  v_mfma_f32_16x16x32_bf16 v[56:59], v[40:43], v[128:131], v[56:59]
  ds_read_b64_tr_b16 v[24:25], v10 offset:0
  v_mfma_f32_16x16x32_bf16 v[72:75], v[40:43], v[132:135], v[72:75]
  ds_read_b64_tr_b16 v[26:27], v10 offset:512
  s_waitcnt lgkmcnt(6)
  v_mfma_f32_16x16x32_bf16 v[60:63], v[44:47], v[128:131], v[60:63]
  ds_read_b64_tr_b16 v[28:29], v11 offset:0
  v_mfma_f32_16x16x32_bf16 v[76:79], v[44:47], v[132:135], v[76:79]
  ds_read_b64_tr_b16 v[30:31], v11 offset:512
  s_waitcnt vmcnt(11) lgkmcnt(6)
  v_mfma_f32_16x16x32_bf16 v[48:51], v[16:19], v[136:139], v[48:51]
  ds_read_b64_tr_b16 v[32:33], v8 offset:4096
  s_waitcnt vmcnt(10)
  v_mfma_f32_16x16x32_bf16 v[64:67], v[16:19], v[140:143], v[64:67]
  ds_read_b64_tr_b16 v[34:35], v8 offset:4608
  v_add_u32 v8, 8192, v8
  s_waitcnt lgkmcnt(6)
  v_mfma_f32_16x16x32_bf16 v[52:55], v[20:23], v[136:139], v[52:55]
  ds_read_b64_tr_b16 v[36:37], v9 offset:4096
  v_mfma_f32_16x16x32_bf16 v[68:71], v[20:23], v[140:143], v[68:71]
  ds_read_b64_tr_b16 v[38:39], v9 offset:4608
  v_add_u32 v9, 8192, v9
  s_waitcnt lgkmcnt(6)
  v_mfma_f32_16x16x32_bf16 v[56:59], v[24:27], v[136:139], v[56:59]
  ds_read_b64_tr_b16 v[40:41], v10 offset:4096
  v_mfma_f32_16x16x32_bf16 v[72:75], v[24:27], v[140:143], v[72:75]
  ds_read_b64_tr_b16 v[42:43], v10 offset:4608
  v_add_u32 v10, 8192, v10
  s_waitcnt lgkmcnt(6)
  v_mfma_f32_16x16x32_bf16 v[60:63], v[28:31], v[136:139], v[60:63]
  ds_read_b64_tr_b16 v[44:45], v11 offset:4096
  v_mfma_f32_16x16x32_bf16 v[76:79], v[28:31], v[140:143], v[76:79]
  ds_read_b64_tr_b16 v[46:47], v11 offset:4608
  v_add_u32 v11, 8192, v11
  s_waitcnt vmcnt(9) lgkmcnt(6)
  v_mfma_f32_16x16x32_bf16 v[48:51], v[32:35], v[144:147], v[48:51]
  ds_read_b64_tr_b16 v[16:17], v8 offset:0
  s_waitcnt vmcnt(8)
  v_mfma_f32_16x16x32_bf16 v[64:67], v[32:35], v[148:151], v[64:67]
  ds_read_b64_tr_b16 v[18:19], v8 offset:512
  s_waitcnt lgkmcnt(6)
  v_mfma_f32_16x16x32_bf16 v[52:55], v[36:39], v[144:147], v[52:55]
  ds_read_b64_tr_b16 v[20:21], v9 offset:0
  v_mfma_f32_16x16x32_bf16 v[68:71], v[36:39], v[148:151], v[68:71]
  ds_read_b64_tr_b16 v[22:23], v9 offset:512
  s_waitcnt lgkmcnt(6)
  v_mfma_f32_16x16x32_bf16 v[56:59], v[40:43], v[144:147], v[56:59]
  ds_read_b64_tr_b16 v[24:25], v10 offset:0
  v_mfma_f32_16x16x32_bf16 v[72:75], v[40:43], v[148:151], v[72:75]
  ds_read_b64_tr_b16 v[26:27], v10 offset:512
  s_waitcnt lgkmcnt(6)
  v_mfma_f32_16x16x32_bf16 v[60:63], v[44:47], v[144:147], v[60:63]
  ds_read_b64_tr_b16 v[28:29], v11 offset:0
  v_mfma_f32_16x16x32_bf16 v[76:79], v[44:47], v[148:151], v[76:79]
  ds_read_b64_tr_b16 v[30:31], v11 offset:512
  s_waitcnt vmcnt(7) lgkmcnt(6)
  v_mfma_f32_16x16x32_bf16 v[48:51], v[16:19], v[152:155], v[48:51]
  ds_read_b64_tr_b16 v[32:33], v8 offset:4096
  s_waitcnt vmcnt(6)
  v_mfma_f32_16x16x32_bf16 v[64:67], v[16:19], v[156:159], v[64:67]
  ds_read_b64_tr_b16 v[34:35], v8 offset:4608
  v_add_u32 v8, 8192, v8
  s_waitcnt lgkmcnt(6)
  v_mfma_f32_16x16x32_bf16 v[52:55], v[20:23], v[152:155], v[52:55]
  ds_read_b64_tr_b16 v[36:37], v9 offset:4096
  v_mfma_f32_16x16x32_bf16 v[68:71], v[20:23], v[156:159], v[68:71]
  ds_read_b64_tr_b16 v[38:39], v9 offset:4608
  v_add_u32 v9, 8192, v9
  s_waitcnt lgkmcnt(6)
  v_mfma_f32_16x16x32_bf16 v[56:59], v[24:27], v[152:155], v[56:59]
  ds_read_b64_tr_b16 v[40:41], v10 offset:4096
  v_mfma_f32_16x16x32_bf16 v[72:75], v[24:27], v[156:159], v[72:75]
  ds_read_b64_tr_b16 v[42:43], v10 offset:4608
  v_add_u32 v10, 8192, v10
  s_waitcnt lgkmcnt(6)
  v_mfma_f32_16x16x32_bf16 v[60:63], v[28:31], v[152:155], v[60:63]
  ds_read_b64_tr_b16 v[44:45], v11 offset:4096
  v_mfma_f32_16x16x32_bf16 v[76:79], v[28:31], v[156:159], v[76:79]
  ds_read_b64_tr_b16 v[46:47], v11 offset:4608
  v_add_u32 v11, 8192, v11
  s_waitcnt vmcnt(5) lgkmcnt(6)
  v_mfma_f32_16x16x32_bf16 v[48:51], v[32:35], v[160:163], v[48:51]
  ds_read_b64_tr_b16 v[16:17], v8 offset:0
  s_waitcnt vmcnt(4)
  v_mfma_f32_16x16x32_bf16 v[64:67], v[32:35], v[164:167], v[64:67]
  ds_read_b64_tr_b16 v[18:19], v8 offset:512
  s_waitcnt lgkmcnt(6)
  v_mfma_f32_16x16x32_bf16 v[52:55], v[36:39], v[160:163], v[52:55]
  ds_read_b64_tr_b16 v[20:21], v9 offset:0
  v_mfma_f32_16x16x32_bf16 v[68:71], v[36:39], v[164:167], v[68:71]
  ds_read_b64_tr_b16 v[22:23], v9 offset:512
  s_waitcnt lgkmcnt(6)
  v_mfma_f32_16x16x32_bf16 v[56:59], v[40:43], v[160:163], v[56:59]
  ds_read_b64_tr_b16 v[24:25], v10 offset:0
  v_mfma_f32_16x16x32_bf16 v[72:75], v[40:43], v[164:167], v[72:75]
  ds_read_b64_tr_b16 v[26:27], v10 offset:512
  s_waitcnt lgkmcnt(6)
  v_mfma_f32_16x16x32_bf16 v[60:63], v[44:47], v[160:163], v[60:63]
  ds_read_b64_tr_b16 v[28:29], v11 offset:0
  v_mfma_f32_16x16x32_bf16 v[76:79], v[44:47], v[164:167], v[76:79]
  ds_read_b64_tr_b16 v[30:31], v11 offset:512
  s_waitcnt vmcnt(3) lgkmcnt(6)
  v_mfma_f32_16x16x32_bf16 v[48:51], v[16:19], v[168:171], v[48:51]
  ds_read_b64_tr_b16 v[32:33], v8 offset:4096
  s_waitcnt vmcnt(2)
  v_mfma_f32_16x16x32_bf16 v[64:67], v[16:19], v[172:175], v[64:67]
  ds_read_b64_tr_b16 v[34:35], v8 offset:4608
  s_waitcnt lgkmcnt(6)
  v_mfma_f32_16x16x32_bf16 v[52:55], v[20:23], v[168:171], v[52:55]
  ds_read_b64_tr_b16 v[36:37], v9 offset:4096
  v_mfma_f32_16x16x32_bf16 v[68:71], v[20:23], v[172:175], v[68:71]
  ds_read_b64_tr_b16 v[38:39], v9 offset:4608
  s_waitcnt lgkmcnt(6)
  v_mfma_f32_16x16x32_bf16 v[56:59], v[24:27], v[168:171], v[56:59]
  ds_read_b64_tr_b16 v[40:41], v10 offset:4096
  v_mfma_f32_16x16x32_bf16 v[72:75], v[24:27], v[172:175], v[72:75]
  ds_read_b64_tr_b16 v[42:43], v10 offset:4608
  s_waitcnt lgkmcnt(6)
  v_mfma_f32_16x16x32_bf16 v[60:63], v[28:31], v[168:171], v[60:63]
  ds_read_b64_tr_b16 v[44:45], v11 offset:4096
  v_mfma_f32_16x16x32_bf16 v[76:79], v[28:31], v[172:175], v[76:79]
  ds_read_b64_tr_b16 v[46:47], v11 offset:4608
  s_waitcnt vmcnt(1) lgkmcnt(6)
  v_mfma_f32_16x16x32_bf16 v[48:51], v[32:35], v[176:179], v[48:51]
  s_waitcnt vmcnt(0)
  v_mfma_f32_16x16x32_bf16 v[64:67], v[32:35], v[180:183], v[64:67]
  s_waitcnt lgkmcnt(4)
  v_mfma_f32_16x16x32_bf16 v[52:55], v[36:39], v[176:179], v[52:55]
  v_mfma_f32_16x16x32_bf16 v[68:71], v[36:39], v[180:183], v[68:71]
  s_waitcnt lgkmcnt(2)
  v_mfma_f32_16x16x32_bf16 v[56:59], v[40:43], v[176:179], v[56:59]
  v_mfma_f32_16x16x32_bf16 v[72:75], v[40:43], v[180:183], v[72:75]
  s_waitcnt lgkmcnt(0)
  v_mfma_f32_16x16x32_bf16 v[60:63], v[44:47], v[176:179], v[60:63]
  v_mfma_f32_16x16x32_bf16 v[76:79], v[44:47], v[180:183], v[76:79]
  s_waitcnt lgkmcnt(0)
  s_barrier
  s_add_u32 s20, s82, 4194304
  s_addc_u32 s21, s83, 0
  s_mov_b32 s22, 4194304
  s_mov_b32 s23, 0x20000
  s_add_u32 s24, s82, 8388608
  s_addc_u32 s25, s83, 0
  s_mov_b32 s26, 4194304
  s_mov_b32 s27, 0x20000
  v_pk_add_f32 v[16:17], v[48:49], v[50:51]
  v_pk_mul_f32 v[18:19], v[48:49], v[48:49]
  v_pk_fma_f32 v[18:19], v[50:51], v[50:51], v[18:19]
  v_pk_add_f32 v[16:17], v[16:17], v[52:53]
  v_pk_fma_f32 v[18:19], v[52:53], v[52:53], v[18:19]
  v_pk_add_f32 v[16:17], v[16:17], v[54:55]
  v_pk_fma_f32 v[18:19], v[54:55], v[54:55], v[18:19]
  v_pk_add_f32 v[16:17], v[16:17], v[56:57]
  v_pk_fma_f32 v[18:19], v[56:57], v[56:57], v[18:19]
  v_pk_add_f32 v[16:17], v[16:17], v[58:59]
  v_pk_fma_f32 v[18:19], v[58:59], v[58:59], v[18:19]
  v_pk_add_f32 v[16:17], v[16:17], v[60:61]
  v_pk_fma_f32 v[18:19], v[60:61], v[60:61], v[18:19]
  v_pk_add_f32 v[16:17], v[16:17], v[62:63]
  v_pk_fma_f32 v[18:19], v[62:63], v[62:63], v[18:19]
  v_add_f32 v24, v16, v17
  v_add_f32 v26, v18, v19
  v_pk_add_f32 v[20:21], v[64:65], v[66:67]
  v_pk_mul_f32 v[22:23], v[64:65], v[64:65]
  v_pk_fma_f32 v[22:23], v[66:67], v[66:67], v[22:23]
  v_pk_add_f32 v[20:21], v[20:21], v[68:69]
  v_pk_fma_f32 v[22:23], v[68:69], v[68:69], v[22:23]
  v_pk_add_f32 v[20:21], v[20:21], v[70:71]
  v_pk_fma_f32 v[22:23], v[70:71], v[70:71], v[22:23]
  v_pk_add_f32 v[20:21], v[20:21], v[72:73]
  v_pk_fma_f32 v[22:23], v[72:73], v[72:73], v[22:23]
  v_pk_add_f32 v[20:21], v[20:21], v[74:75]
  v_pk_fma_f32 v[22:23], v[74:75], v[74:75], v[22:23]
  v_pk_add_f32 v[20:21], v[20:21], v[76:77]
  v_pk_fma_f32 v[22:23], v[76:77], v[76:77], v[22:23]
  v_pk_add_f32 v[20:21], v[20:21], v[78:79]
  v_pk_fma_f32 v[22:23], v[78:79], v[78:79], v[22:23]
  v_add_f32 v25, v20, v21
  v_add_f32 v27, v22, v23
  s_nop 0
  v_permlane16_swap_b32 v24, v25
  v_permlane16_swap_b32 v26, v27
  v_add_f32 v28, v24, v25
  v_add_f32 v29, v26, v27
  v_mov_b32 v30, v28
  v_mov_b32 v31, v29
  s_nop 0
  v_permlane32_swap_b32 v28, v30
  v_permlane32_swap_b32 v29, v31
  v_add_f32 v28, v28, v30
  v_add_f32 v29, v29, v31
  v_and_b32 v29, 0x7fffffff, v29
  s_mov_b32 exec_hi, 0
  buffer_store_dwordx2 v[28:29], v112, s[12:15], 0 offen sc0 sc1
  s_mov_b64 exec, -1
  v_cvt_pk_bf16_f32 v96, v48, v49
  v_cvt_pk_bf16_f32 v97, v50, v51
  v_cvt_pk_bf16_f32 v98, v52, v53
  v_cvt_pk_bf16_f32 v99, v54, v55
  v_cvt_pk_bf16_f32 v100, v56, v57
  v_cvt_pk_bf16_f32 v101, v58, v59
  v_cvt_pk_bf16_f32 v102, v60, v61
  v_cvt_pk_bf16_f32 v103, v62, v63
  v_cvt_pk_bf16_f32 v104, v64, v65
  v_cvt_pk_bf16_f32 v105, v66, v67
  v_cvt_pk_bf16_f32 v106, v68, v69
  v_cvt_pk_bf16_f32 v107, v70, v71
  v_cvt_pk_bf16_f32 v108, v72, v73
  v_cvt_pk_bf16_f32 v109, v74, v75
  v_cvt_pk_bf16_f32 v110, v76, v77
  v_cvt_pk_bf16_f32 v111, v78, v79
  v_permlane16_swap_b32 v96, v98
  v_permlane16_swap_b32 v97, v99
  v_permlane16_swap_b32 v100, v102
  v_permlane16_swap_b32 v101, v103
  v_permlane16_swap_b32 v104, v106
  v_permlane16_swap_b32 v105, v107
  v_permlane16_swap_b32 v108, v110
  v_permlane16_swap_b32 v109, v111
  v_xor_b32 v116, 32, v115
  v_xor_b32 v121, 32, v114
  v_xor_b32 v117, 64, v115
  v_xor_b32 v122, 64, v114
  v_xor_b32 v118, 96, v115
  v_xor_b32 v123, 96, v114
  v_mov_b32 v120, v114
  s_mov_b32 s39, 0
k2_poll:
  buffer_load_dwordx2 v[32:33], v113, s[12:15], 0 offen sc0 sc1
  buffer_load_dwordx2 v[34:35], v113, s[12:15], s87 offen sc0 sc1
  buffer_load_dwordx2 v[36:37], v113, s[12:15], s88 offen sc0 sc1
  buffer_load_dwordx2 v[38:39], v113, s[12:15], s89 offen sc0 sc1
  buffer_load_dwordx2 v[40:41], v113, s[12:15], s90 offen sc0 sc1
  buffer_load_dwordx2 v[42:43], v113, s[12:15], s91 offen sc0 sc1
  buffer_load_dwordx2 v[44:45], v113, s[12:15], s92 offen sc0 sc1
  buffer_load_dwordx2 v[46:47], v113, s[12:15], s93 offen sc0 sc1
  s_waitcnt vmcnt(0)
  v_min3_i32 v16, v33, v35, v37
  v_min3_i32 v17, v39, v41, v43
  v_min3_i32 v16, v16, v45, v47
  v_min_i32 v16, v16, v17
  v_cmp_gt_i32 vcc, 0, v16
  s_add_u32 s39, s39, 1
  s_cmp_gt_u32 s39, 100000
  s_cbranch_scc1 k2_pdone
  s_cbranch_vccnz k2_poll
k2_pdone:
  buffer_store_dwordx4 v[96:99], v12, s[20:23], 0 offen offset:0 sc0 sc1
  buffer_store_dwordx4 v[100:103], v12, s[20:23], 0 offen offset:64 sc0 sc1
  buffer_store_dwordx4 v[104:107], v12, s[20:23], 0 offen offset:2048 sc0 sc1
  buffer_store_dwordx4 v[108:111], v12, s[20:23], 0 offen offset:2112 sc0 sc1
  v_pk_add_f32 v[32:33], v[32:33], v[34:35]
  v_pk_add_f32 v[36:37], v[36:37], v[38:39]
  v_pk_add_f32 v[40:41], v[40:41], v[42:43]
  v_pk_add_f32 v[44:45], v[44:45], v[46:47]
  v_pk_add_f32 v[32:33], v[32:33], v[36:37]
  v_pk_add_f32 v[40:41], v[40:41], v[44:45]
  v_pk_add_f32 v[32:33], v[32:33], v[40:41]
  v_mov_b32 v34, v32
  v_mov_b32 v35, v33
  s_nop 0
  v_permlane32_swap_b32 v32, v34
  v_permlane32_swap_b32 v33, v35
  v_add_f32 v32, v32, v34
  v_add_f32 v33, v33, v35
  v_mul_f32 v32, 0x3a800000, v32
  v_mul_f32 v33, 0x3a800000, v33
  v_fma_f32 v33, -v32, v32, v33
  v_max_f32 v33, 0, v33
  v_mov_b32 v36, v33
  v_cvt_pk_bf16_f32 v36, v36, v36
  v_lshlrev_b32 v36, 16, v36
  v_add_f32 v36, 0x3727c5ac, v36
  v_cvt_pk_bf16_f32 v36, v36, v36
  v_lshlrev_b32 v36, 16, v36
  v_sqrt_f32 v36, v36
  s_nop 0
  v_cvt_pk_bf16_f32 v36, v36, v36
  v_lshlrev_b32 v36, 16, v36
  v_rcp_f32 v36, v36
  s_nop 0
  v_mul_f32 v33, v33, v36
  v_mul_f32 v33, v33, v36
  v_cvt_pk_bf16_f32 v33, v33, v33
  v_lshlrev_b32 v33, 16, v33
  v_add_f32 v33, 0x3727c5ac, v33
  v_cvt_pk_bf16_f32 v33, v33, v33
  v_lshlrev_b32 v33, 16, v33
  v_sqrt_f32 v33, v33
  s_nop 0
  v_cvt_pk_bf16_f32 v33, v33, v33
  v_lshlrev_b32 v33, 16, v33
  v_rcp_f32 v33, v33
  s_nop 0
  v_mul_f32 v33, v33, v36
  v_mov_b32 v34, v32
  v_mov_b32 v35, v33
  s_nop 0
  v_permlane16_swap_b32 v32, v34
  v_permlane16_swap_b32 v33, v35
  v_pk_add_f32 v[48:49], v[48:49], v[32:33] op_sel_hi:[1,0] neg_lo:[0,1] neg_hi:[0,1]
  v_pk_add_f32 v[50:51], v[50:51], v[32:33] op_sel_hi:[1,0] neg_lo:[0,1] neg_hi:[0,1]
  v_pk_add_f32 v[52:53], v[52:53], v[32:33] op_sel_hi:[1,0] neg_lo:[0,1] neg_hi:[0,1]
  v_pk_add_f32 v[54:55], v[54:55], v[32:33] op_sel_hi:[1,0] neg_lo:[0,1] neg_hi:[0,1]
  v_pk_add_f32 v[56:57], v[56:57], v[32:33] op_sel_hi:[1,0] neg_lo:[0,1] neg_hi:[0,1]
  v_pk_add_f32 v[58:59], v[58:59], v[32:33] op_sel_hi:[1,0] neg_lo:[0,1] neg_hi:[0,1]
  v_pk_add_f32 v[60:61], v[60:61], v[32:33] op_sel_hi:[1,0] neg_lo:[0,1] neg_hi:[0,1]
  v_pk_add_f32 v[62:63], v[62:63], v[32:33] op_sel_hi:[1,0] neg_lo:[0,1] neg_hi:[0,1]
  v_pk_mul_f32 v[48:49], v[48:49], v[32:33] op_sel:[0,1] op_sel_hi:[1,1]
  v_pk_mul_f32 v[50:51], v[50:51], v[32:33] op_sel:[0,1] op_sel_hi:[1,1]
  v_pk_mul_f32 v[52:53], v[52:53], v[32:33] op_sel:[0,1] op_sel_hi:[1,1]
  v_pk_mul_f32 v[54:55], v[54:55], v[32:33] op_sel:[0,1] op_sel_hi:[1,1]
  v_pk_mul_f32 v[56:57], v[56:57], v[32:33] op_sel:[0,1] op_sel_hi:[1,1]
  v_pk_mul_f32 v[58:59], v[58:59], v[32:33] op_sel:[0,1] op_sel_hi:[1,1]
  v_pk_mul_f32 v[60:61], v[60:61], v[32:33] op_sel:[0,1] op_sel_hi:[1,1]
  v_pk_mul_f32 v[62:63], v[62:63], v[32:33] op_sel:[0,1] op_sel_hi:[1,1]
  v_cvt_pk_bf16_f32 v160, v48, v49
  v_cvt_pk_bf16_f32 v161, v50, v51
  ds_write_b64 v120, v[160:161] offset:0
  v_cvt_pk_bf16_f32 v162, v52, v53
  v_cvt_pk_bf16_f32 v163, v54, v55
  ds_write_b64 v121, v[162:163] offset:0
  v_cvt_pk_bf16_f32 v164, v56, v57
  v_cvt_pk_bf16_f32 v165, v58, v59
  ds_write_b64 v122, v[164:165] offset:0
  v_cvt_pk_bf16_f32 v166, v60, v61
  v_cvt_pk_bf16_f32 v167, v62, v63
  ds_write_b64 v123, v[166:167] offset:0
  v_pk_add_f32 v[64:65], v[64:65], v[34:35] op_sel_hi:[1,0] neg_lo:[0,1] neg_hi:[0,1]
  v_pk_add_f32 v[66:67], v[66:67], v[34:35] op_sel_hi:[1,0] neg_lo:[0,1] neg_hi:[0,1]
  v_pk_add_f32 v[68:69], v[68:69], v[34:35] op_sel_hi:[1,0] neg_lo:[0,1] neg_hi:[0,1]
  v_pk_add_f32 v[70:71], v[70:71], v[34:35] op_sel_hi:[1,0] neg_lo:[0,1] neg_hi:[0,1]
  v_pk_add_f32 v[72:73], v[72:73], v[34:35] op_sel_hi:[1,0] neg_lo:[0,1] neg_hi:[0,1]
  v_pk_add_f32 v[74:75], v[74:75], v[34:35] op_sel_hi:[1,0] neg_lo:[0,1] neg_hi:[0,1]
  v_pk_add_f32 v[76:77], v[76:77], v[34:35] op_sel_hi:[1,0] neg_lo:[0,1] neg_hi:[0,1]
  v_pk_add_f32 v[78:79], v[78:79], v[34:35] op_sel_hi:[1,0] neg_lo:[0,1] neg_hi:[0,1]
  v_pk_mul_f32 v[64:65], v[64:65], v[34:35] op_sel:[0,1] op_sel_hi:[1,1]
  v_pk_mul_f32 v[66:67], v[66:67], v[34:35] op_sel:[0,1] op_sel_hi:[1,1]
  v_pk_mul_f32 v[68:69], v[68:69], v[34:35] op_sel:[0,1] op_sel_hi:[1,1]
  v_pk_mul_f32 v[70:71], v[70:71], v[34:35] op_sel:[0,1] op_sel_hi:[1,1]
  v_pk_mul_f32 v[72:73], v[72:73], v[34:35] op_sel:[0,1] op_sel_hi:[1,1]
  v_pk_mul_f32 v[74:75], v[74:75], v[34:35] op_sel:[0,1] op_sel_hi:[1,1]
  v_pk_mul_f32 v[76:77], v[76:77], v[34:35] op_sel:[0,1] op_sel_hi:[1,1]
  v_pk_mul_f32 v[78:79], v[78:79], v[34:35] op_sel:[0,1] op_sel_hi:[1,1]
  v_cvt_pk_bf16_f32 v168, v64, v65
  v_cvt_pk_bf16_f32 v169, v66, v67
  ds_write_b64 v120, v[168:169] offset:128
  v_cvt_pk_bf16_f32 v170, v68, v69
  v_cvt_pk_bf16_f32 v171, v70, v71
  ds_write_b64 v121, v[170:171] offset:128
  v_cvt_pk_bf16_f32 v172, v72, v73
  v_cvt_pk_bf16_f32 v173, v74, v75
  ds_write_b64 v122, v[172:173] offset:128
  v_cvt_pk_bf16_f32 v174, v76, v77
  v_cvt_pk_bf16_f32 v175, v78, v79
  ds_write_b64 v123, v[174:175] offset:128
  s_waitcnt lgkmcnt(0)
  ds_read_b64_tr_b16 v[176:177], v115
  ds_read_b64_tr_b16 v[178:179], v115 offset:512
  ds_read_b64_tr_b16 v[180:181], v116
  ds_read_b64_tr_b16 v[182:183], v116 offset:512
  ds_read_b64_tr_b16 v[184:185], v117
  ds_read_b64_tr_b16 v[186:187], v117 offset:512
  ds_read_b64_tr_b16 v[188:189], v118
  ds_read_b64_tr_b16 v[190:191], v118 offset:512
  s_waitcnt lgkmcnt(6)
  buffer_store_dwordx4 v[176:179], v14, s[24:27], s44 offen sc0 sc1
  s_waitcnt lgkmcnt(4)
  buffer_store_dwordx4 v[180:183], v14, s[24:27], s45 offen sc0 sc1
  s_waitcnt lgkmcnt(2)
  buffer_store_dwordx4 v[184:187], v14, s[24:27], s46 offen sc0 sc1
  s_waitcnt lgkmcnt(0)
  buffer_store_dwordx4 v[188:191], v14, s[24:27], s47 offen sc0 sc1
  s_cmp_ge_u32 s2, 224
  s_cbranch_scc1 C_k3skip
  s_lshr_b32 s32, s2, 3
  s_mul_i32 s5, s32, 9363
  s_lshr_b32 s5, s5, 16
  s_mul_i32 s6, s5, 7
  s_sub_u32 s6, s32, s6
  s_lshl_b32 s7, s5, 1
  s_add_u32 s7, s7, s6
  s_and_b32 s7, s7, 7
  s_and_b32 s32, s2, 7
  s_lshr_b32 s28, s32, 2
  s_lshl_b32 s28, s28, 2
  s_add_u32 s28, s28, s5
  s_and_b32 s29, s32, 3
  s_mul_i32 s29, s29, 7
  s_add_u32 s29, s29, s6
  s_mov_b32 s30, 7
  s_mov_b32 s31, -1
  s_and_b32 s46, s4, 1
  s_lshr_b32 s41, s4, 1
  s_lshl_b32 s32, s29, 8
  s_lshl_b32 s44, s46, 7
  s_add_u32 s32, s32, s44
  v_lshlrev_b32 v16, 3, v5
  v_add_u32 v16, s32, v16
  s_mov_b32 s16, s74
  s_mov_b32 s17, s75
  s_mov_b32 s18, 7168
  s_mov_b32 s19, 0x20000
  buffer_load_dwordx2 v[144:145], v16, s[16:19], 0 offen offset:0
  buffer_load_dwordx2 v[146:147], v16, s[16:19], 0 offen offset:32
  buffer_load_dwordx2 v[148:149], v16, s[16:19], 0 offen offset:64
  buffer_load_dwordx2 v[150:151], v16, s[16:19], 0 offen offset:96
  s_add_u32 s20, s82, 12582912
  s_addc_u32 s21, s83, 0
  s_mov_b32 s22, 7340032
  s_mov_b32 s23, 0x20000
  v_lshl_add_u32 v17, v5, 3, v6
  v_lshlrev_b32 v17, 8, v17
  v_lshl_add_u32 v17, v7, 3, v17
  v_lshl_or_b32 v18, v2, 2, v6
  v_lshl_add_u32 v17, v18, 5, v17
  s_lshl_b32 s32, s46, 7
  s_add_u32 s32, s32, 16384
  v_xor_b32 v18, s32, v17
  s_lshl_b32 s32, s41, 13
  v_add_u32 v12, s32, v14
  v_xor_b32 v8, 0, v18
  v_xor_b32 v9, 32, v18
  v_xor_b32 v10, 64, v18
  v_xor_b32 v11, 96, v18
  v_bfe_u32 v17, v4, 2, 1
  v_lshlrev_b32 v17, 10, v17
  v_lshl_add_u32 v17, v3, 8, v17
  v_lshrrev_b32 v18, 3, v4
  v_lshl_add_u32 v17, v18, 6, v17
  v_lshl_add_u32 v152, v7, 4, v17
  v_add_u32 v153, 128, v152
  s_lshl_b32 s32, s28, 1
  s_add_u32 s32, s32, s41
  s_mul_i32 s32, s32, 224
  s_lshl_b32 s44, s29, 2
  s_add_u32 s32, s32, s44
  s_lshl_b32 s44, s46, 1
  s_add_u32 s32, s32, s44
  s_lshl_b32 s44, s32, 11
  s_add_u32 s45, s44, 229376
  s_waitcnt vmcnt(0)
  s_barrier
  v_lshlrev_b32 v80, 16, v144
  v_and_b32 v81, 0xffff0000, v144
  v_lshlrev_b32 v82, 16, v145
  v_and_b32 v83, 0xffff0000, v145
  v_mov_b64 v[96:97], v[80:81]
  v_mov_b64 v[98:99], v[82:83]
  v_mov_b64 v[112:113], v[80:81]
  v_mov_b64 v[114:115], v[82:83]
  v_mov_b64 v[128:129], v[80:81]
  v_mov_b64 v[130:131], v[82:83]
  v_lshlrev_b32 v84, 16, v146
  v_and_b32 v85, 0xffff0000, v146
  v_lshlrev_b32 v86, 16, v147
  v_and_b32 v87, 0xffff0000, v147
  v_mov_b64 v[100:101], v[84:85]
  v_mov_b64 v[102:103], v[86:87]
  v_mov_b64 v[116:117], v[84:85]
  v_mov_b64 v[118:119], v[86:87]
  v_mov_b64 v[132:133], v[84:85]
  v_mov_b64 v[134:135], v[86:87]
  v_lshlrev_b32 v88, 16, v148
  v_and_b32 v89, 0xffff0000, v148
  v_lshlrev_b32 v90, 16, v149
  v_and_b32 v91, 0xffff0000, v149
  v_mov_b64 v[104:105], v[88:89]
  v_mov_b64 v[106:107], v[90:91]
  v_mov_b64 v[120:121], v[88:89]
  v_mov_b64 v[122:123], v[90:91]
  v_mov_b64 v[136:137], v[88:89]
  v_mov_b64 v[138:139], v[90:91]
  v_lshlrev_b32 v92, 16, v150
  v_and_b32 v93, 0xffff0000, v150
  v_lshlrev_b32 v94, 16, v151
  v_and_b32 v95, 0xffff0000, v151
  v_mov_b64 v[108:109], v[92:93]
  v_mov_b64 v[110:111], v[94:95]
  v_mov_b64 v[124:125], v[92:93]
  v_mov_b64 v[126:127], v[94:95]
  v_mov_b64 v[140:141], v[92:93]
  v_mov_b64 v[142:143], v[94:95]
  s_mov_b32 s43, 0
  s_mov_b32 s39, 31
  s_barrier
  ds_read_b64_tr_b16 v[16:17], v8 offset:0
  ds_read_b64_tr_b16 v[18:19], v8 offset:1024
  ds_read_b128 v[32:35], v12 offset:0
  ds_read_b64_tr_b16 v[20:21], v9 offset:0
  ds_read_b64_tr_b16 v[22:23], v9 offset:1024
  ds_read_b128 v[36:39], v12 offset:2048
  ds_read_b64_tr_b16 v[24:25], v10 offset:0
  ds_read_b64_tr_b16 v[26:27], v10 offset:1024
  ds_read_b128 v[40:43], v12 offset:4096
  ds_read_b64_tr_b16 v[28:29], v11 offset:0
  ds_read_b64_tr_b16 v[30:31], v11 offset:1024
  ds_read_b128 v[44:47], v12 offset:6144
  s_add_u32 s40, s43, 32768
  s_cmp_eq_u32 s40, 163840
  s_cselect_b32 s40, 0, s40
  s_sub_u32 s42, s40, s43
  s_mov_b32 s43, s40
cl3:
  s_waitcnt lgkmcnt(9)
  v_mfma_f32_16x16x32_bf16 v[80:83], v[16:19], v[32:35], v[80:83]
  ds_read_b64_tr_b16 v[48:49], v8 offset:8192
  s_waitcnt lgkmcnt(7)
  v_mfma_f32_16x16x32_bf16 v[96:99], v[16:19], v[36:39], v[96:99]
  ds_read_b64_tr_b16 v[50:51], v8 offset:9216
  v_add_u32 v8, s42, v8
  v_mfma_f32_16x16x32_bf16 v[84:87], v[20:23], v[32:35], v[84:87]
  ds_read_b128 v[64:67], v12 offset:1024
  v_mfma_f32_16x16x32_bf16 v[100:103], v[20:23], v[36:39], v[100:103]
  ds_read_b64_tr_b16 v[52:53], v9 offset:8192
  s_waitcnt lgkmcnt(7)
  v_mfma_f32_16x16x32_bf16 v[112:115], v[16:19], v[40:43], v[112:115]
  ds_read_b64_tr_b16 v[54:55], v9 offset:9216
  v_add_u32 v9, s42, v9
  v_mfma_f32_16x16x32_bf16 v[116:119], v[20:23], v[40:43], v[116:119]
  ds_read_b128 v[68:71], v12 offset:3072
  v_mfma_f32_16x16x32_bf16 v[88:91], v[24:27], v[32:35], v[88:91]
  ds_read_b64_tr_b16 v[56:57], v10 offset:8192
  v_mfma_f32_16x16x32_bf16 v[104:107], v[24:27], v[36:39], v[104:107]
  ds_read_b64_tr_b16 v[58:59], v10 offset:9216
  v_add_u32 v10, s42, v10
  v_mfma_f32_16x16x32_bf16 v[120:123], v[24:27], v[40:43], v[120:123]
  ds_read_b128 v[72:75], v12 offset:5120
  s_waitcnt lgkmcnt(9)
  v_mfma_f32_16x16x32_bf16 v[128:131], v[16:19], v[44:47], v[128:131]
  ds_read_b64_tr_b16 v[60:61], v11 offset:8192
  v_mfma_f32_16x16x32_bf16 v[132:135], v[20:23], v[44:47], v[132:135]
  ds_read_b64_tr_b16 v[62:63], v11 offset:9216
  v_add_u32 v11, s42, v11
  v_mfma_f32_16x16x32_bf16 v[136:139], v[24:27], v[44:47], v[136:139]
  ds_read_b128 v[76:79], v12 offset:7168
  v_add_u32 v12, s42, v12
  v_mfma_f32_16x16x32_bf16 v[92:95], v[28:31], v[32:35], v[92:95]
  v_mfma_f32_16x16x32_bf16 v[108:111], v[28:31], v[36:39], v[108:111]
  v_mfma_f32_16x16x32_bf16 v[124:127], v[28:31], v[40:43], v[124:127]
  v_mfma_f32_16x16x32_bf16 v[140:143], v[28:31], v[44:47], v[140:143]
  s_barrier
  s_waitcnt lgkmcnt(9)
  v_mfma_f32_16x16x32_bf16 v[80:83], v[48:51], v[64:67], v[80:83]
  ds_read_b64_tr_b16 v[16:17], v8 offset:0
  s_add_u32 s40, s43, 32768
  s_waitcnt lgkmcnt(7)
  v_mfma_f32_16x16x32_bf16 v[96:99], v[48:51], v[68:71], v[96:99]
  ds_read_b64_tr_b16 v[18:19], v8 offset:1024
  s_cmp_eq_u32 s40, 163840
  v_mfma_f32_16x16x32_bf16 v[84:87], v[52:55], v[64:67], v[84:87]
  ds_read_b128 v[32:35], v12 offset:0
  s_cselect_b32 s40, 0, s40
  v_mfma_f32_16x16x32_bf16 v[100:103], v[52:55], v[68:71], v[100:103]
  ds_read_b64_tr_b16 v[20:21], v9 offset:0
  s_sub_u32 s42, s40, s43
  s_waitcnt lgkmcnt(7)
  v_mfma_f32_16x16x32_bf16 v[112:115], v[48:51], v[72:75], v[112:115]
  ds_read_b64_tr_b16 v[22:23], v9 offset:1024
  s_mov_b32 s43, s40
  v_mfma_f32_16x16x32_bf16 v[116:119], v[52:55], v[72:75], v[116:119]
  ds_read_b128 v[36:39], v12 offset:2048
  v_mfma_f32_16x16x32_bf16 v[88:91], v[56:59], v[64:67], v[88:91]
  ds_read_b64_tr_b16 v[24:25], v10 offset:0
  v_mfma_f32_16x16x32_bf16 v[104:107], v[56:59], v[68:71], v[104:107]
  ds_read_b64_tr_b16 v[26:27], v10 offset:1024
  v_mfma_f32_16x16x32_bf16 v[120:123], v[56:59], v[72:75], v[120:123]
  ds_read_b128 v[40:43], v12 offset:4096
  s_waitcnt lgkmcnt(9)
  v_mfma_f32_16x16x32_bf16 v[128:131], v[48:51], v[76:79], v[128:131]
  ds_read_b64_tr_b16 v[28:29], v11 offset:0
  v_mfma_f32_16x16x32_bf16 v[132:135], v[52:55], v[76:79], v[132:135]
  ds_read_b64_tr_b16 v[30:31], v11 offset:1024
  v_mfma_f32_16x16x32_bf16 v[136:139], v[56:59], v[76:79], v[136:139]
  ds_read_b128 v[44:47], v12 offset:6144
  v_mfma_f32_16x16x32_bf16 v[92:95], v[60:63], v[64:67], v[92:95]
  v_mfma_f32_16x16x32_bf16 v[108:111], v[60:63], v[68:71], v[108:111]
  v_mfma_f32_16x16x32_bf16 v[124:127], v[60:63], v[72:75], v[124:127]
  v_mfma_f32_16x16x32_bf16 v[140:143], v[60:63], v[76:79], v[140:143]
  s_sub_u32 s39, s39, 1
  s_cmp_lg_u32 s39, 0
  s_cbranch_scc1 cl3
  s_waitcnt lgkmcnt(9)
  v_mfma_f32_16x16x32_bf16 v[80:83], v[16:19], v[32:35], v[80:83]
  ds_read_b64_tr_b16 v[48:49], v8 offset:8192
  s_waitcnt lgkmcnt(7)
  v_mfma_f32_16x16x32_bf16 v[96:99], v[16:19], v[36:39], v[96:99]
  ds_read_b64_tr_b16 v[50:51], v8 offset:9216
  v_mfma_f32_16x16x32_bf16 v[84:87], v[20:23], v[32:35], v[84:87]
  ds_read_b128 v[64:67], v12 offset:1024
  v_mfma_f32_16x16x32_bf16 v[100:103], v[20:23], v[36:39], v[100:103]
  ds_read_b64_tr_b16 v[52:53], v9 offset:8192
  s_waitcnt lgkmcnt(7)
  v_mfma_f32_16x16x32_bf16 v[112:115], v[16:19], v[40:43], v[112:115]
  ds_read_b64_tr_b16 v[54:55], v9 offset:9216
  v_mfma_f32_16x16x32_bf16 v[116:119], v[20:23], v[40:43], v[116:119]
  ds_read_b128 v[68:71], v12 offset:3072
  v_mfma_f32_16x16x32_bf16 v[88:91], v[24:27], v[32:35], v[88:91]
  ds_read_b64_tr_b16 v[56:57], v10 offset:8192
  v_mfma_f32_16x16x32_bf16 v[104:107], v[24:27], v[36:39], v[104:107]
  ds_read_b64_tr_b16 v[58:59], v10 offset:9216
  v_mfma_f32_16x16x32_bf16 v[120:123], v[24:27], v[40:43], v[120:123]
  ds_read_b128 v[72:75], v12 offset:5120
  s_waitcnt lgkmcnt(9)
  v_mfma_f32_16x16x32_bf16 v[128:131], v[16:19], v[44:47], v[128:131]
  ds_read_b64_tr_b16 v[60:61], v11 offset:8192
  v_mfma_f32_16x16x32_bf16 v[132:135], v[20:23], v[44:47], v[132:135]
  ds_read_b64_tr_b16 v[62:63], v11 offset:9216
  v_mfma_f32_16x16x32_bf16 v[136:139], v[24:27], v[44:47], v[136:139]
  ds_read_b128 v[76:79], v12 offset:7168
  v_mfma_f32_16x16x32_bf16 v[92:95], v[28:31], v[32:35], v[92:95]
  v_mfma_f32_16x16x32_bf16 v[108:111], v[28:31], v[36:39], v[108:111]
  v_mfma_f32_16x16x32_bf16 v[124:127], v[28:31], v[40:43], v[124:127]
  v_mfma_f32_16x16x32_bf16 v[140:143], v[28:31], v[44:47], v[140:143]
  s_waitcnt lgkmcnt(9)
  v_mfma_f32_16x16x32_bf16 v[80:83], v[48:51], v[64:67], v[80:83]
  s_waitcnt lgkmcnt(6)
  v_mfma_f32_16x16x32_bf16 v[96:99], v[48:51], v[68:71], v[96:99]
  v_mfma_f32_16x16x32_bf16 v[84:87], v[52:55], v[64:67], v[84:87]
  v_mfma_f32_16x16x32_bf16 v[100:103], v[52:55], v[68:71], v[100:103]
  s_waitcnt lgkmcnt(3)
  v_mfma_f32_16x16x32_bf16 v[112:115], v[48:51], v[72:75], v[112:115]
  v_mfma_f32_16x16x32_bf16 v[116:119], v[52:55], v[72:75], v[116:119]
  v_mfma_f32_16x16x32_bf16 v[88:91], v[56:59], v[64:67], v[88:91]
  v_mfma_f32_16x16x32_bf16 v[104:107], v[56:59], v[68:71], v[104:107]
  v_mfma_f32_16x16x32_bf16 v[120:123], v[56:59], v[72:75], v[120:123]
  s_waitcnt lgkmcnt(0)
  v_mfma_f32_16x16x32_bf16 v[128:131], v[48:51], v[76:79], v[128:131]
  v_mfma_f32_16x16x32_bf16 v[132:135], v[52:55], v[76:79], v[132:135]
  v_mfma_f32_16x16x32_bf16 v[136:139], v[56:59], v[76:79], v[136:139]
  v_mfma_f32_16x16x32_bf16 v[92:95], v[60:63], v[64:67], v[92:95]
  v_mfma_f32_16x16x32_bf16 v[108:111], v[60:63], v[68:71], v[108:111]
  v_mfma_f32_16x16x32_bf16 v[124:127], v[60:63], v[72:75], v[124:127]
  v_mfma_f32_16x16x32_bf16 v[140:143], v[60:63], v[76:79], v[140:143]
  s_waitcnt lgkmcnt(0)
  v_mov_b32 v16, 0xc0135761
  v_mov_b32 v17, 0xbdd2d3e8
  v_pk_mul_f32 v[24:25], v[80:81], v[80:81]
  v_pk_mul_f32 v[26:27], v[82:83], v[82:83]
  v_pk_mul_f32 v[28:29], v[84:85], v[84:85]
  v_pk_mul_f32 v[30:31], v[86:87], v[86:87]
  v_pk_fma_f32 v[24:25], v[24:25], v[16:17], v[16:17] op_sel:[0,1,0] op_sel_hi:[1,1,0]
  v_pk_fma_f32 v[26:27], v[26:27], v[16:17], v[16:17] op_sel:[0,1,0] op_sel_hi:[1,1,0]
  v_pk_fma_f32 v[28:29], v[28:29], v[16:17], v[16:17] op_sel:[0,1,0] op_sel_hi:[1,1,0]
  v_pk_fma_f32 v[30:31], v[30:31], v[16:17], v[16:17] op_sel:[0,1,0] op_sel_hi:[1,1,0]
  v_pk_mul_f32 v[24:25], v[24:25], v[80:81]
  v_pk_mul_f32 v[26:27], v[26:27], v[82:83]
  v_pk_mul_f32 v[28:29], v[28:29], v[84:85]
  v_pk_mul_f32 v[30:31], v[30:31], v[86:87]
  v_exp_f32 v24, v24
  v_exp_f32 v25, v25
  v_exp_f32 v26, v26
  v_exp_f32 v27, v27
  v_exp_f32 v28, v28
  v_exp_f32 v29, v29
  v_exp_f32 v30, v30
  v_exp_f32 v31, v31
  v_pk_add_f32 v[24:25], v[24:25], 1.0 op_sel_hi:[1,0]
  v_pk_add_f32 v[26:27], v[26:27], 1.0 op_sel_hi:[1,0]
  v_pk_add_f32 v[28:29], v[28:29], 1.0 op_sel_hi:[1,0]
  v_pk_add_f32 v[30:31], v[30:31], 1.0 op_sel_hi:[1,0]
  v_rcp_f32 v24, v24
  v_rcp_f32 v25, v25
  v_rcp_f32 v26, v26
  v_rcp_f32 v27, v27
  v_rcp_f32 v28, v28
  v_rcp_f32 v29, v29
  v_rcp_f32 v30, v30
  v_rcp_f32 v31, v31
  v_pk_mul_f32 v[24:25], v[24:25], v[80:81]
  v_pk_mul_f32 v[26:27], v[26:27], v[82:83]
  v_pk_mul_f32 v[28:29], v[28:29], v[84:85]
  v_pk_mul_f32 v[30:31], v[30:31], v[86:87]
  v_cvt_pk_bf16_f32 v164, v24, v25
  v_cvt_pk_bf16_f32 v165, v26, v27
  v_cvt_pk_bf16_f32 v166, v28, v29
  v_cvt_pk_bf16_f32 v167, v30, v31
  s_nop 0
  v_permlane16_swap_b32 v164, v166
  v_permlane16_swap_b32 v165, v167
  buffer_store_dwordx4 v[164:167], v152, s[20:23], s44 offen offset:0 sc0 sc1
  v_pk_mul_f32 v[40:41], v[88:89], v[88:89]
  v_pk_mul_f32 v[42:43], v[90:91], v[90:91]
  v_pk_mul_f32 v[44:45], v[92:93], v[92:93]
  v_pk_mul_f32 v[46:47], v[94:95], v[94:95]
  v_pk_fma_f32 v[40:41], v[40:41], v[16:17], v[16:17] op_sel:[0,1,0] op_sel_hi:[1,1,0]
  v_pk_fma_f32 v[42:43], v[42:43], v[16:17], v[16:17] op_sel:[0,1,0] op_sel_hi:[1,1,0]
  v_pk_fma_f32 v[44:45], v[44:45], v[16:17], v[16:17] op_sel:[0,1,0] op_sel_hi:[1,1,0]
  v_pk_fma_f32 v[46:47], v[46:47], v[16:17], v[16:17] op_sel:[0,1,0] op_sel_hi:[1,1,0]
  v_pk_mul_f32 v[40:41], v[40:41], v[88:89]
  v_pk_mul_f32 v[42:43], v[42:43], v[90:91]
  v_pk_mul_f32 v[44:45], v[44:45], v[92:93]
  v_pk_mul_f32 v[46:47], v[46:47], v[94:95]
  v_exp_f32 v40, v40
  v_exp_f32 v41, v41
  v_exp_f32 v42, v42
  v_exp_f32 v43, v43
  v_exp_f32 v44, v44
  v_exp_f32 v45, v45
  v_exp_f32 v46, v46
  v_exp_f32 v47, v47
  v_pk_add_f32 v[40:41], v[40:41], 1.0 op_sel_hi:[1,0]
  v_pk_add_f32 v[42:43], v[42:43], 1.0 op_sel_hi:[1,0]
  v_pk_add_f32 v[44:45], v[44:45], 1.0 op_sel_hi:[1,0]
  v_pk_add_f32 v[46:47], v[46:47], 1.0 op_sel_hi:[1,0]
  v_rcp_f32 v40, v40
  v_rcp_f32 v41, v41
  v_rcp_f32 v42, v42
  v_rcp_f32 v43, v43
  v_rcp_f32 v44, v44
  v_rcp_f32 v45, v45
  v_rcp_f32 v46, v46
  v_rcp_f32 v47, v47
  v_pk_mul_f32 v[40:41], v[40:41], v[88:89]
  v_pk_mul_f32 v[42:43], v[42:43], v[90:91]
  v_pk_mul_f32 v[44:45], v[44:45], v[92:93]
  v_pk_mul_f32 v[46:47], v[46:47], v[94:95]
  v_cvt_pk_bf16_f32 v168, v40, v41
  v_cvt_pk_bf16_f32 v169, v42, v43
  v_cvt_pk_bf16_f32 v170, v44, v45
  v_cvt_pk_bf16_f32 v171, v46, v47
  s_nop 0
  v_permlane16_swap_b32 v168, v170
  v_permlane16_swap_b32 v169, v171
  buffer_store_dwordx4 v[168:171], v152, s[20:23], s44 offen offset:2048 sc0 sc1
  v_pk_mul_f32 v[24:25], v[96:97], v[96:97]
  v_pk_mul_f32 v[26:27], v[98:99], v[98:99]
  v_pk_mul_f32 v[28:29], v[100:101], v[100:101]
  v_pk_mul_f32 v[30:31], v[102:103], v[102:103]
  v_pk_fma_f32 v[24:25], v[24:25], v[16:17], v[16:17] op_sel:[0,1,0] op_sel_hi:[1,1,0]
  v_pk_fma_f32 v[26:27], v[26:27], v[16:17], v[16:17] op_sel:[0,1,0] op_sel_hi:[1,1,0]
  v_pk_fma_f32 v[28:29], v[28:29], v[16:17], v[16:17] op_sel:[0,1,0] op_sel_hi:[1,1,0]
  v_pk_fma_f32 v[30:31], v[30:31], v[16:17], v[16:17] op_sel:[0,1,0] op_sel_hi:[1,1,0]
  v_pk_mul_f32 v[24:25], v[24:25], v[96:97]
  v_pk_mul_f32 v[26:27], v[26:27], v[98:99]
  v_pk_mul_f32 v[28:29], v[28:29], v[100:101]
  v_pk_mul_f32 v[30:31], v[30:31], v[102:103]
  v_exp_f32 v24, v24
  v_exp_f32 v25, v25
  v_exp_f32 v26, v26
  v_exp_f32 v27, v27
  v_exp_f32 v28, v28
  v_exp_f32 v29, v29
  v_exp_f32 v30, v30
  v_exp_f32 v31, v31
  v_pk_add_f32 v[24:25], v[24:25], 1.0 op_sel_hi:[1,0]
  v_pk_add_f32 v[26:27], v[26:27], 1.0 op_sel_hi:[1,0]
  v_pk_add_f32 v[28:29], v[28:29], 1.0 op_sel_hi:[1,0]
  v_pk_add_f32 v[30:31], v[30:31], 1.0 op_sel_hi:[1,0]
  v_rcp_f32 v24, v24
  v_rcp_f32 v25, v25
  v_rcp_f32 v26, v26
  v_rcp_f32 v27, v27
  v_rcp_f32 v28, v28
  v_rcp_f32 v29, v29
  v_rcp_f32 v30, v30
  v_rcp_f32 v31, v31
  v_pk_mul_f32 v[24:25], v[24:25], v[96:97]
  v_pk_mul_f32 v[26:27], v[26:27], v[98:99]
  v_pk_mul_f32 v[28:29], v[28:29], v[100:101]
  v_pk_mul_f32 v[30:31], v[30:31], v[102:103]
  v_cvt_pk_bf16_f32 v172, v24, v25
  v_cvt_pk_bf16_f32 v173, v26, v27
  v_cvt_pk_bf16_f32 v174, v28, v29
  v_cvt_pk_bf16_f32 v175, v30, v31
  s_nop 0
  v_permlane16_swap_b32 v172, v174
  v_permlane16_swap_b32 v173, v175
  buffer_store_dwordx4 v[172:175], v153, s[20:23], s44 offen offset:0 sc0 sc1
  v_pk_mul_f32 v[40:41], v[104:105], v[104:105]
  v_pk_mul_f32 v[42:43], v[106:107], v[106:107]
  v_pk_mul_f32 v[44:45], v[108:109], v[108:109]
  v_pk_mul_f32 v[46:47], v[110:111], v[110:111]
  v_pk_fma_f32 v[40:41], v[40:41], v[16:17], v[16:17] op_sel:[0,1,0] op_sel_hi:[1,1,0]
  v_pk_fma_f32 v[42:43], v[42:43], v[16:17], v[16:17] op_sel:[0,1,0] op_sel_hi:[1,1,0]
  v_pk_fma_f32 v[44:45], v[44:45], v[16:17], v[16:17] op_sel:[0,1,0] op_sel_hi:[1,1,0]
  v_pk_fma_f32 v[46:47], v[46:47], v[16:17], v[16:17] op_sel:[0,1,0] op_sel_hi:[1,1,0]
  v_pk_mul_f32 v[40:41], v[40:41], v[104:105]
  v_pk_mul_f32 v[42:43], v[42:43], v[106:107]
  v_pk_mul_f32 v[44:45], v[44:45], v[108:109]
  v_pk_mul_f32 v[46:47], v[46:47], v[110:111]
  v_exp_f32 v40, v40
  v_exp_f32 v41, v41
  v_exp_f32 v42, v42
  v_exp_f32 v43, v43
  v_exp_f32 v44, v44
  v_exp_f32 v45, v45
  v_exp_f32 v46, v46
  v_exp_f32 v47, v47
  v_pk_add_f32 v[40:41], v[40:41], 1.0 op_sel_hi:[1,0]
  v_pk_add_f32 v[42:43], v[42:43], 1.0 op_sel_hi:[1,0]
  v_pk_add_f32 v[44:45], v[44:45], 1.0 op_sel_hi:[1,0]
  v_pk_add_f32 v[46:47], v[46:47], 1.0 op_sel_hi:[1,0]
  v_rcp_f32 v40, v40
  v_rcp_f32 v41, v41
  v_rcp_f32 v42, v42
  v_rcp_f32 v43, v43
  v_rcp_f32 v44, v44
  v_rcp_f32 v45, v45
  v_rcp_f32 v46, v46
  v_rcp_f32 v47, v47
  v_pk_mul_f32 v[40:41], v[40:41], v[104:105]
  v_pk_mul_f32 v[42:43], v[42:43], v[106:107]
  v_pk_mul_f32 v[44:45], v[44:45], v[108:109]
  v_pk_mul_f32 v[46:47], v[46:47], v[110:111]
  v_cvt_pk_bf16_f32 v176, v40, v41
  v_cvt_pk_bf16_f32 v177, v42, v43
  v_cvt_pk_bf16_f32 v178, v44, v45
  v_cvt_pk_bf16_f32 v179, v46, v47
  s_nop 0
  v_permlane16_swap_b32 v176, v178
  v_permlane16_swap_b32 v177, v179
  buffer_store_dwordx4 v[176:179], v153, s[20:23], s44 offen offset:2048 sc0 sc1
  v_pk_mul_f32 v[24:25], v[112:113], v[112:113]
  v_pk_mul_f32 v[26:27], v[114:115], v[114:115]
  v_pk_mul_f32 v[28:29], v[116:117], v[116:117]
  v_pk_mul_f32 v[30:31], v[118:119], v[118:119]
  v_pk_fma_f32 v[24:25], v[24:25], v[16:17], v[16:17] op_sel:[0,1,0] op_sel_hi:[1,1,0]
  v_pk_fma_f32 v[26:27], v[26:27], v[16:17], v[16:17] op_sel:[0,1,0] op_sel_hi:[1,1,0]
  v_pk_fma_f32 v[28:29], v[28:29], v[16:17], v[16:17] op_sel:[0,1,0] op_sel_hi:[1,1,0]
  v_pk_fma_f32 v[30:31], v[30:31], v[16:17], v[16:17] op_sel:[0,1,0] op_sel_hi:[1,1,0]
  v_pk_mul_f32 v[24:25], v[24:25], v[112:113]
  v_pk_mul_f32 v[26:27], v[26:27], v[114:115]
  v_pk_mul_f32 v[28:29], v[28:29], v[116:117]
  v_pk_mul_f32 v[30:31], v[30:31], v[118:119]
  v_exp_f32 v24, v24
  v_exp_f32 v25, v25
  v_exp_f32 v26, v26
  v_exp_f32 v27, v27
  v_exp_f32 v28, v28
  v_exp_f32 v29, v29
  v_exp_f32 v30, v30
  v_exp_f32 v31, v31
  v_pk_add_f32 v[24:25], v[24:25], 1.0 op_sel_hi:[1,0]
  v_pk_add_f32 v[26:27], v[26:27], 1.0 op_sel_hi:[1,0]
  v_pk_add_f32 v[28:29], v[28:29], 1.0 op_sel_hi:[1,0]
  v_pk_add_f32 v[30:31], v[30:31], 1.0 op_sel_hi:[1,0]
  v_rcp_f32 v24, v24
  v_rcp_f32 v25, v25
  v_rcp_f32 v26, v26
  v_rcp_f32 v27, v27
  v_rcp_f32 v28, v28
  v_rcp_f32 v29, v29
  v_rcp_f32 v30, v30
  v_rcp_f32 v31, v31
  v_pk_mul_f32 v[24:25], v[24:25], v[112:113]
  v_pk_mul_f32 v[26:27], v[26:27], v[114:115]
  v_pk_mul_f32 v[28:29], v[28:29], v[116:117]
  v_pk_mul_f32 v[30:31], v[30:31], v[118:119]
  v_cvt_pk_bf16_f32 v180, v24, v25
  v_cvt_pk_bf16_f32 v181, v26, v27
  v_cvt_pk_bf16_f32 v182, v28, v29
  v_cvt_pk_bf16_f32 v183, v30, v31
  s_nop 0
  v_permlane16_swap_b32 v180, v182
  v_permlane16_swap_b32 v181, v183
  buffer_store_dwordx4 v[180:183], v152, s[20:23], s45 offen offset:0 sc0 sc1
  v_pk_mul_f32 v[40:41], v[120:121], v[120:121]
  v_pk_mul_f32 v[42:43], v[122:123], v[122:123]
  v_pk_mul_f32 v[44:45], v[124:125], v[124:125]
  v_pk_mul_f32 v[46:47], v[126:127], v[126:127]
  v_pk_fma_f32 v[40:41], v[40:41], v[16:17], v[16:17] op_sel:[0,1,0] op_sel_hi:[1,1,0]
  v_pk_fma_f32 v[42:43], v[42:43], v[16:17], v[16:17] op_sel:[0,1,0] op_sel_hi:[1,1,0]
  v_pk_fma_f32 v[44:45], v[44:45], v[16:17], v[16:17] op_sel:[0,1,0] op_sel_hi:[1,1,0]
  v_pk_fma_f32 v[46:47], v[46:47], v[16:17], v[16:17] op_sel:[0,1,0] op_sel_hi:[1,1,0]
  v_pk_mul_f32 v[40:41], v[40:41], v[120:121]
  v_pk_mul_f32 v[42:43], v[42:43], v[122:123]
  v_pk_mul_f32 v[44:45], v[44:45], v[124:125]
  v_pk_mul_f32 v[46:47], v[46:47], v[126:127]
  v_exp_f32 v40, v40
  v_exp_f32 v41, v41
  v_exp_f32 v42, v42
  v_exp_f32 v43, v43
  v_exp_f32 v44, v44
  v_exp_f32 v45, v45
  v_exp_f32 v46, v46
  v_exp_f32 v47, v47
  v_pk_add_f32 v[40:41], v[40:41], 1.0 op_sel_hi:[1,0]
  v_pk_add_f32 v[42:43], v[42:43], 1.0 op_sel_hi:[1,0]
  v_pk_add_f32 v[44:45], v[44:45], 1.0 op_sel_hi:[1,0]
  v_pk_add_f32 v[46:47], v[46:47], 1.0 op_sel_hi:[1,0]
  v_rcp_f32 v40, v40
  v_rcp_f32 v41, v41
  v_rcp_f32 v42, v42
  v_rcp_f32 v43, v43
  v_rcp_f32 v44, v44
  v_rcp_f32 v45, v45
  v_rcp_f32 v46, v46
  v_rcp_f32 v47, v47
  v_pk_mul_f32 v[40:41], v[40:41], v[120:121]
  v_pk_mul_f32 v[42:43], v[42:43], v[122:123]
  v_pk_mul_f32 v[44:45], v[44:45], v[124:125]
  v_pk_mul_f32 v[46:47], v[46:47], v[126:127]
  v_cvt_pk_bf16_f32 v184, v40, v41
  v_cvt_pk_bf16_f32 v185, v42, v43
  v_cvt_pk_bf16_f32 v186, v44, v45
  v_cvt_pk_bf16_f32 v187, v46, v47
  s_nop 0
  v_permlane16_swap_b32 v184, v186
  v_permlane16_swap_b32 v185, v187
  buffer_store_dwordx4 v[184:187], v152, s[20:23], s45 offen offset:2048 sc0 sc1
  v_pk_mul_f32 v[24:25], v[128:129], v[128:129]
  v_pk_mul_f32 v[26:27], v[130:131], v[130:131]
  v_pk_mul_f32 v[28:29], v[132:133], v[132:133]
  v_pk_mul_f32 v[30:31], v[134:135], v[134:135]
  v_pk_fma_f32 v[24:25], v[24:25], v[16:17], v[16:17] op_sel:[0,1,0] op_sel_hi:[1,1,0]
  v_pk_fma_f32 v[26:27], v[26:27], v[16:17], v[16:17] op_sel:[0,1,0] op_sel_hi:[1,1,0]
  v_pk_fma_f32 v[28:29], v[28:29], v[16:17], v[16:17] op_sel:[0,1,0] op_sel_hi:[1,1,0]
  v_pk_fma_f32 v[30:31], v[30:31], v[16:17], v[16:17] op_sel:[0,1,0] op_sel_hi:[1,1,0]
  v_pk_mul_f32 v[24:25], v[24:25], v[128:129]
  v_pk_mul_f32 v[26:27], v[26:27], v[130:131]
  v_pk_mul_f32 v[28:29], v[28:29], v[132:133]
  v_pk_mul_f32 v[30:31], v[30:31], v[134:135]
  v_exp_f32 v24, v24
  v_exp_f32 v25, v25
  v_exp_f32 v26, v26
  v_exp_f32 v27, v27
  v_exp_f32 v28, v28
  v_exp_f32 v29, v29
  v_exp_f32 v30, v30
  v_exp_f32 v31, v31
  v_pk_add_f32 v[24:25], v[24:25], 1.0 op_sel_hi:[1,0]
  v_pk_add_f32 v[26:27], v[26:27], 1.0 op_sel_hi:[1,0]
  v_pk_add_f32 v[28:29], v[28:29], 1.0 op_sel_hi:[1,0]
  v_pk_add_f32 v[30:31], v[30:31], 1.0 op_sel_hi:[1,0]
  v_rcp_f32 v24, v24
  v_rcp_f32 v25, v25
  v_rcp_f32 v26, v26
  v_rcp_f32 v27, v27
  v_rcp_f32 v28, v28
  v_rcp_f32 v29, v29
  v_rcp_f32 v30, v30
  v_rcp_f32 v31, v31
  v_pk_mul_f32 v[24:25], v[24:25], v[128:129]
  v_pk_mul_f32 v[26:27], v[26:27], v[130:131]
  v_pk_mul_f32 v[28:29], v[28:29], v[132:133]
  v_pk_mul_f32 v[30:31], v[30:31], v[134:135]
  v_cvt_pk_bf16_f32 v188, v24, v25
  v_cvt_pk_bf16_f32 v189, v26, v27
  v_cvt_pk_bf16_f32 v190, v28, v29
  v_cvt_pk_bf16_f32 v191, v30, v31
  s_nop 0
  v_permlane16_swap_b32 v188, v190
  v_permlane16_swap_b32 v189, v191
  buffer_store_dwordx4 v[188:191], v153, s[20:23], s45 offen offset:0 sc0 sc1
  v_pk_mul_f32 v[40:41], v[136:137], v[136:137]
  v_pk_mul_f32 v[42:43], v[138:139], v[138:139]
  v_pk_mul_f32 v[44:45], v[140:141], v[140:141]
  v_pk_mul_f32 v[46:47], v[142:143], v[142:143]
  v_pk_fma_f32 v[40:41], v[40:41], v[16:17], v[16:17] op_sel:[0,1,0] op_sel_hi:[1,1,0]
  v_pk_fma_f32 v[42:43], v[42:43], v[16:17], v[16:17] op_sel:[0,1,0] op_sel_hi:[1,1,0]
  v_pk_fma_f32 v[44:45], v[44:45], v[16:17], v[16:17] op_sel:[0,1,0] op_sel_hi:[1,1,0]
  v_pk_fma_f32 v[46:47], v[46:47], v[16:17], v[16:17] op_sel:[0,1,0] op_sel_hi:[1,1,0]
  v_pk_mul_f32 v[40:41], v[40:41], v[136:137]
  v_pk_mul_f32 v[42:43], v[42:43], v[138:139]
  v_pk_mul_f32 v[44:45], v[44:45], v[140:141]
  v_pk_mul_f32 v[46:47], v[46:47], v[142:143]
  v_exp_f32 v40, v40
  v_exp_f32 v41, v41
  v_exp_f32 v42, v42
  v_exp_f32 v43, v43
  v_exp_f32 v44, v44
  v_exp_f32 v45, v45
  v_exp_f32 v46, v46
  v_exp_f32 v47, v47
  v_pk_add_f32 v[40:41], v[40:41], 1.0 op_sel_hi:[1,0]
  v_pk_add_f32 v[42:43], v[42:43], 1.0 op_sel_hi:[1,0]
  v_pk_add_f32 v[44:45], v[44:45], 1.0 op_sel_hi:[1,0]
  v_pk_add_f32 v[46:47], v[46:47], 1.0 op_sel_hi:[1,0]
  v_rcp_f32 v40, v40
  v_rcp_f32 v41, v41
  v_rcp_f32 v42, v42
  v_rcp_f32 v43, v43
  v_rcp_f32 v44, v44
  v_rcp_f32 v45, v45
  v_rcp_f32 v46, v46
  v_rcp_f32 v47, v47
  v_pk_mul_f32 v[40:41], v[40:41], v[136:137]
  v_pk_mul_f32 v[42:43], v[42:43], v[138:139]
  v_pk_mul_f32 v[44:45], v[44:45], v[140:141]
  v_pk_mul_f32 v[46:47], v[46:47], v[142:143]
  v_cvt_pk_bf16_f32 v192, v40, v41
  v_cvt_pk_bf16_f32 v193, v42, v43
  v_cvt_pk_bf16_f32 v194, v44, v45
  v_cvt_pk_bf16_f32 v195, v46, v47
  s_nop 0
  v_permlane16_swap_b32 v192, v194
  v_permlane16_swap_b32 v193, v195
  buffer_store_dwordx4 v[192:195], v153, s[20:23], s45 offen offset:2048 sc0 sc1
C_k3skip:
  s_nop 7
  s_nop 7
  s_lshr_b32 s32, s2, 3
  s_lshr_b32 s5, s32, 3
  s_and_b32 s6, s32, 7
  s_lshl_b32 s7, s5, 1
  s_add_u32 s7, s7, s6
  s_and_b32 s7, s7, 7
  s_and_b32 s32, s2, 7
  s_lshr_b32 s28, s32, 2
  s_lshl_b32 s28, s28, 2
  s_add_u32 s28, s28, s5
  s_and_b32 s29, s32, 3
  s_mul_i32 s29, s29, 8
  s_add_u32 s29, s29, s6
  s_mov_b32 s30, 7
  s_mov_b32 s31, -1
  s_lshl_b32 s32, s29, 6
  v_add_u32 v13, s32, v4
  v_lshlrev_b32 v12, 11, v13
  v_lshl_add_u32 v12, v5, 4, v12
  s_lshl_b32 s32, s28, 8
  s_lshl_b32 s40, s4, 6
  s_add_u32 s32, s32, s40
  v_add_u32 v12, s32, v12
  v_lshlrev_b32 v13, 1, v13
  v_lshlrev_b32 v14, 4, v0
  s_lshl_b32 s34, s28, 2
  s_add_u32 s34, s34, s4
  s_mul_i32 s34, s34, 229376
  s_mov_b32 s45, 32768
  s_mov_b32 s46, 65536
  s_mov_b32 s47, 98304
  s_add_u32 s8, s82, 12582912
  s_addc_u32 s9, s83, 0
  s_mov_b32 s10, 7340032
  s_mov_b32 s11, 0x20000
  s_add_u32 s16, s82, 4194304
  s_addc_u32 s17, s83, 0
  s_mov_b32 s18, 4194304
  s_mov_b32 s19, 0x20000
  s_mov_b32 s12, s78
  s_mov_b32 s13, s79
  s_mov_b32 s14, 4096
  s_mov_b32 s15, 0x20000
  buffer_load_ushort v112, v13, s[12:15], 0 offen offset:0
  buffer_load_ushort v114, v13, s[12:15], 0 offen offset:32
  buffer_load_ushort v116, v13, s[12:15], 0 offen offset:64
  buffer_load_ushort v118, v13, s[12:15], 0 offen offset:96
  v_lshl_add_u32 v16, v5, 3, v6
  v_lshlrev_b32 v16, 7, v16
  v_lshl_add_u32 v16, v7, 3, v16
  v_lshrrev_b32 v17, 1, v6
  v_lshl_or_b32 v17, v2, 1, v17
  v_lshl_add_u32 v16, v17, 5, v16
  v_add_u32 v16, 98304, v16
  v_xor_b32 v8, 0, v16
  v_xor_b32 v9, 32, v16
  v_xor_b32 v10, 64, v16
  v_xor_b32 v11, 96, v16
  s_lshl_b32 s48, 0x303, s7
  s_lshr_b32 s48, s48, 8
  s_mov_b32 s49, s34
  s_add_u32 s50, s34, 32768
  s_add_u32 s41, s34, 229376
  s_add_u32 s24, s84, 29360128
  s_addc_u32 s25, s85, 0
  s_mov_b32 s26, 262144
  s_mov_b32 s27, 0x20000
  s_lshl_b32 s32, s28, 5
  v_min_u32 v15, 27, v0
  v_add_u32 v15, s32, v15
  v_max_i32 v15, 0, v15
  v_lshlrev_b32 v15, 7, v15
  s_lshl_b32 s55, s3, 17
  s_add_u32 s55, s55, 65536
  s_waitcnt vmcnt(0)
  s_barrier
  s_cmp_lt_u32 s2, 224
  s_cbranch_scc1 C_nopf
  s_cmp_lg_u32 s3, 0
  s_cbranch_scc1 C_nopf
  s_mov_b32 s20, s76
  s_mov_b32 s21, s77
  s_mov_b32 s22, 14680064
  s_mov_b32 s23, 0x20000
  s_sub_u32 s32, s2, 224
  s_lshl_b32 s32, s32, 2
  s_add_u32 s32, s32, s4
  s_lshl_b32 s32, s32, 13
  v_lshlrev_b32 v17, 7, v0
  buffer_load_dword v18, v17, s[20:23], s32 offen
  s_add_u32 s32, s32, 1048576
  buffer_load_dword v18, v17, s[20:23], s32 offen
  s_add_u32 s32, s32, 1048576
  s_waitcnt vmcnt(1)
  buffer_load_dword v18, v17, s[20:23], s32 offen
  s_add_u32 s32, s32, 1048576
  s_waitcnt vmcnt(1)
  buffer_load_dword v18, v17, s[20:23], s32 offen
  s_add_u32 s32, s32, 1048576
  s_waitcnt vmcnt(1)
  buffer_load_dword v18, v17, s[20:23], s32 offen
  s_add_u32 s32, s32, 1048576
  s_waitcnt vmcnt(1)
  buffer_load_dword v18, v17, s[20:23], s32 offen
  s_add_u32 s32, s32, 1048576
  s_waitcnt vmcnt(1)
  buffer_load_dword v18, v17, s[20:23], s32 offen
  s_add_u32 s32, s32, 1048576
  s_waitcnt vmcnt(1)
  buffer_load_dword v18, v17, s[20:23], s32 offen
  s_add_u32 s32, s32, 1048576
  s_waitcnt vmcnt(1)
  buffer_load_dword v18, v17, s[20:23], s32 offen
  s_add_u32 s32, s32, 1048576
  s_waitcnt vmcnt(1)
  buffer_load_dword v18, v17, s[20:23], s32 offen
  s_add_u32 s32, s32, 1048576
  s_waitcnt vmcnt(1)
  buffer_load_dword v18, v17, s[20:23], s32 offen
  s_add_u32 s32, s32, 1048576
  s_waitcnt vmcnt(1)
  buffer_load_dword v18, v17, s[20:23], s32 offen
  s_add_u32 s32, s32, 1048576
  s_waitcnt vmcnt(1)
  buffer_load_dword v18, v17, s[20:23], s32 offen
  s_add_u32 s32, s32, 1048576
  s_waitcnt vmcnt(1)
  buffer_load_dword v18, v17, s[20:23], s32 offen
  s_add_u32 s32, s32, 1048576
  s_waitcnt vmcnt(1)
C_nopf:
  s_mov_b32 s39, 0
poll4:
  buffer_load_dword v16, v15, s[24:27], s55 offen sc0 sc1
  s_waitcnt vmcnt(0)
  v_cmp_eq_u32 vcc, 0, v16
  s_add_u32 s39, s39, 1
  s_cmp_gt_u32 s39, 100000
  s_cbranch_scc1 poll4d
  s_cbranch_vccnz poll4
poll4d:
  buffer_load_dwordx4 v[96:99], v12, s[16:19], 0 offen sc1
  buffer_load_dwordx4 v[100:103], v12, s[16:19], s45 offen sc1
  buffer_load_dwordx4 v[104:107], v12, s[16:19], s46 offen sc1
  buffer_load_dwordx4 v[108:111], v12, s[16:19], s47 offen sc1
  s_cmp_eq_u32 s3, 0
  s_cselect_b32 s24, s84, s80
  s_cselect_b32 s25, s85, s81
  s_cselect_b32 s26, 25165824, 0
  s_add_u32 s24, s24, s26
  s_addc_u32 s25, s25, 0
  s_mov_b32 s26, 4194304
  s_mov_b32 s27, 0x20000
  s_add_u32 s12, s84, 55574528
  s_addc_u32 s13, s85, 0
  s_mov_b32 s14, 131072
  s_mov_b32 s15, 0x20000
  s_bitcmp1_b32 s48, 0
  s_cselect_b32 s36, s50, s49
  s_add_u32 s36, s36, 0
  buffer_load_dwordx4 v[120:123], v14, s[8:11], s36 offen offset:0 sc1
  buffer_load_dwordx4 v[124:127], v14, s[8:11], s36 offen offset:1024 sc1
  buffer_load_dwordx4 v[128:131], v14, s[8:11], s36 offen offset:2048 sc1
  buffer_load_dwordx4 v[132:135], v14, s[8:11], s36 offen offset:3072 sc1
  s_bitcmp1_b32 s48, 1
  s_cselect_b32 s36, s50, s49
  s_add_u32 s36, s36, 4096
  buffer_load_dwordx4 v[136:139], v14, s[8:11], s36 offen offset:0 sc1
  buffer_load_dwordx4 v[140:143], v14, s[8:11], s36 offen offset:1024 sc1
  buffer_load_dwordx4 v[144:147], v14, s[8:11], s36 offen offset:2048 sc1
  buffer_load_dwordx4 v[148:151], v14, s[8:11], s36 offen offset:3072 sc1
  s_waitcnt vmcnt(8)
  v_lshlrev_b32 v112, 16, v112
  v_lshlrev_b32 v48, 16, v96
  v_and_b32 v49, 0xffff0000, v96
  v_lshlrev_b32 v50, 16, v97
  v_and_b32 v51, 0xffff0000, v97
  v_lshlrev_b32 v52, 16, v98
  v_and_b32 v53, 0xffff0000, v98
  v_lshlrev_b32 v54, 16, v99
  v_and_b32 v55, 0xffff0000, v99
  v_pk_add_f32 v[48:49], v[48:49], v[112:113] op_sel_hi:[1,0]
  v_pk_add_f32 v[50:51], v[50:51], v[112:113] op_sel_hi:[1,0]
  v_pk_add_f32 v[52:53], v[52:53], v[112:113] op_sel_hi:[1,0]
  v_pk_add_f32 v[54:55], v[54:55], v[112:113] op_sel_hi:[1,0]
  v_lshlrev_b32 v114, 16, v114
  v_lshlrev_b32 v56, 16, v100
  v_and_b32 v57, 0xffff0000, v100
  v_lshlrev_b32 v58, 16, v101
  v_and_b32 v59, 0xffff0000, v101
  v_lshlrev_b32 v60, 16, v102
  v_and_b32 v61, 0xffff0000, v102
  v_lshlrev_b32 v62, 16, v103
  v_and_b32 v63, 0xffff0000, v103
  v_pk_add_f32 v[56:57], v[56:57], v[114:115] op_sel_hi:[1,0]
  v_pk_add_f32 v[58:59], v[58:59], v[114:115] op_sel_hi:[1,0]
  v_pk_add_f32 v[60:61], v[60:61], v[114:115] op_sel_hi:[1,0]
  v_pk_add_f32 v[62:63], v[62:63], v[114:115] op_sel_hi:[1,0]
  v_lshlrev_b32 v116, 16, v116
  v_lshlrev_b32 v64, 16, v104
  v_and_b32 v65, 0xffff0000, v104
  v_lshlrev_b32 v66, 16, v105
  v_and_b32 v67, 0xffff0000, v105
  v_lshlrev_b32 v68, 16, v106
  v_and_b32 v69, 0xffff0000, v106
  v_lshlrev_b32 v70, 16, v107
  v_and_b32 v71, 0xffff0000, v107
  v_pk_add_f32 v[64:65], v[64:65], v[116:117] op_sel_hi:[1,0]
  v_pk_add_f32 v[66:67], v[66:67], v[116:117] op_sel_hi:[1,0]
  v_pk_add_f32 v[68:69], v[68:69], v[116:117] op_sel_hi:[1,0]
  v_pk_add_f32 v[70:71], v[70:71], v[116:117] op_sel_hi:[1,0]
  v_lshlrev_b32 v118, 16, v118
  v_lshlrev_b32 v72, 16, v108
  v_and_b32 v73, 0xffff0000, v108
  v_lshlrev_b32 v74, 16, v109
  v_and_b32 v75, 0xffff0000, v109
  v_lshlrev_b32 v76, 16, v110
  v_and_b32 v77, 0xffff0000, v110
  v_lshlrev_b32 v78, 16, v111
  v_and_b32 v79, 0xffff0000, v111
  v_pk_add_f32 v[72:73], v[72:73], v[118:119] op_sel_hi:[1,0]
  v_pk_add_f32 v[74:75], v[74:75], v[118:119] op_sel_hi:[1,0]
  v_pk_add_f32 v[76:77], v[76:77], v[118:119] op_sel_hi:[1,0]
  v_pk_add_f32 v[78:79], v[78:79], v[118:119] op_sel_hi:[1,0]
  s_bitcmp1_b32 s48, 2
  s_cselect_b32 s36, s50, s49
  s_add_u32 s36, s36, 8192
  buffer_load_dwordx4 v[152:155], v14, s[8:11], s36 offen offset:0 sc1
  buffer_load_dwordx4 v[156:159], v14, s[8:11], s36 offen offset:1024 sc1
  buffer_load_dwordx4 v[160:163], v14, s[8:11], s36 offen offset:2048 sc1
  buffer_load_dwordx4 v[164:167], v14, s[8:11], s36 offen offset:3072 sc1
  s_bitcmp1_b32 s48, 3
  s_cselect_b32 s36, s50, s49
  s_add_u32 s36, s36, 12288
  buffer_load_dwordx4 v[168:171], v14, s[8:11], s36 offen offset:0 sc1
  buffer_load_dwordx4 v[172:175], v14, s[8:11], s36 offen offset:1024 sc1
  s_mov_b32 s43, 0
  s_mov_b32 s39, 6
  s_barrier
  ds_read_b64_tr_b16 v[16:17], v8 offset:0
  ds_read_b64_tr_b16 v[18:19], v8 offset:512
  ds_read_b64_tr_b16 v[20:21], v9 offset:0
  ds_read_b64_tr_b16 v[22:23], v9 offset:512
  ds_read_b64_tr_b16 v[24:25], v10 offset:0
  ds_read_b64_tr_b16 v[26:27], v10 offset:512
  ds_read_b64_tr_b16 v[28:29], v11 offset:0
  ds_read_b64_tr_b16 v[30:31], v11 offset:512
  s_add_u32 s40, s43, 8192
  s_cmp_eq_u32 s40, 65536
  s_cselect_b32 s40, 0, s40
  s_sub_u32 s42, s40, s43
  s_mov_b32 s43, s40
cd5:
  s_waitcnt vmcnt(13) lgkmcnt(6)
  v_mfma_f32_16x16x32_bf16 v[48:51], v[120:123], v[16:19], v[48:51]
  ds_read_b64_tr_b16 v[32:33], v8 offset:4096
  s_waitcnt vmcnt(12)
  v_mfma_f32_16x16x32_bf16 v[52:55], v[124:127], v[16:19], v[52:55]
  ds_read_b64_tr_b16 v[34:35], v8 offset:4608
  v_add_u32 v8, s42, v8
  s_waitcnt lgkmcnt(6)
  v_mfma_f32_16x16x32_bf16 v[56:59], v[120:123], v[20:23], v[56:59]
  ds_read_b64_tr_b16 v[36:37], v9 offset:4096
  buffer_load_dwordx4 v[176:179], v14, s[8:11], s36 offen offset:2048 sc1
  v_mfma_f32_16x16x32_bf16 v[60:63], v[124:127], v[20:23], v[60:63]
  ds_read_b64_tr_b16 v[38:39], v9 offset:4608
  v_add_u32 v9, s42, v9
  s_waitcnt lgkmcnt(6)
  v_mfma_f32_16x16x32_bf16 v[64:67], v[120:123], v[24:27], v[64:67]
  ds_read_b64_tr_b16 v[40:41], v10 offset:4096
  v_mfma_f32_16x16x32_bf16 v[68:71], v[124:127], v[24:27], v[68:71]
  ds_read_b64_tr_b16 v[42:43], v10 offset:4608
  v_add_u32 v10, s42, v10
  s_waitcnt lgkmcnt(6)
  v_mfma_f32_16x16x32_bf16 v[72:75], v[120:123], v[28:31], v[72:75]
  ds_read_b64_tr_b16 v[44:45], v11 offset:4096
  buffer_load_dwordx4 v[180:183], v14, s[8:11], s36 offen offset:3072 sc1
  v_mfma_f32_16x16x32_bf16 v[76:79], v[124:127], v[28:31], v[76:79]
  ds_read_b64_tr_b16 v[46:47], v11 offset:4608
  v_add_u32 v11, s42, v11
  s_barrier
  s_waitcnt vmcnt(13) lgkmcnt(6)
  v_mfma_f32_16x16x32_bf16 v[48:51], v[128:131], v[32:35], v[48:51]
  ds_read_b64_tr_b16 v[16:17], v8 offset:0
  s_bitcmp1_b32 s48, 4
  s_cselect_b32 s36, s50, s49
  s_waitcnt vmcnt(12)
  v_mfma_f32_16x16x32_bf16 v[52:55], v[132:135], v[32:35], v[52:55]
  ds_read_b64_tr_b16 v[18:19], v8 offset:512
  s_add_u32 s36, s36, 16384
  s_add_u32 s40, s43, 8192
  s_waitcnt lgkmcnt(6)
  v_mfma_f32_16x16x32_bf16 v[56:59], v[128:131], v[36:39], v[56:59]
  ds_read_b64_tr_b16 v[20:21], v9 offset:0
  s_cmp_eq_u32 s40, 65536
  s_cselect_b32 s40, 0, s40
  v_mfma_f32_16x16x32_bf16 v[60:63], v[132:135], v[36:39], v[60:63]
  ds_read_b64_tr_b16 v[22:23], v9 offset:512
  s_sub_u32 s42, s40, s43
  s_mov_b32 s43, s40
  s_waitcnt lgkmcnt(6)
  v_mfma_f32_16x16x32_bf16 v[64:67], v[128:131], v[40:43], v[64:67]
  ds_read_b64_tr_b16 v[24:25], v10 offset:0
  buffer_load_dwordx4 v[120:123], v14, s[8:11], s36 offen offset:0 sc1
  v_mfma_f32_16x16x32_bf16 v[68:71], v[132:135], v[40:43], v[68:71]
  ds_read_b64_tr_b16 v[26:27], v10 offset:512
  s_waitcnt lgkmcnt(6)
  v_mfma_f32_16x16x32_bf16 v[72:75], v[128:131], v[44:47], v[72:75]
  ds_read_b64_tr_b16 v[28:29], v11 offset:0
  v_mfma_f32_16x16x32_bf16 v[76:79], v[132:135], v[44:47], v[76:79]
  ds_read_b64_tr_b16 v[30:31], v11 offset:512
  buffer_load_dwordx4 v[124:127], v14, s[8:11], s36 offen offset:1024 sc1
  s_waitcnt vmcnt(13) lgkmcnt(6)
  v_mfma_f32_16x16x32_bf16 v[48:51], v[136:139], v[16:19], v[48:51]
  ds_read_b64_tr_b16 v[32:33], v8 offset:4096
  s_waitcnt vmcnt(12)
  v_mfma_f32_16x16x32_bf16 v[52:55], v[140:143], v[16:19], v[52:55]
  ds_read_b64_tr_b16 v[34:35], v8 offset:4608
  v_add_u32 v8, s42, v8
  s_waitcnt lgkmcnt(6)
  v_mfma_f32_16x16x32_bf16 v[56:59], v[136:139], v[20:23], v[56:59]
  ds_read_b64_tr_b16 v[36:37], v9 offset:4096
  buffer_load_dwordx4 v[128:131], v14, s[8:11], s36 offen offset:2048 sc1
  v_mfma_f32_16x16x32_bf16 v[60:63], v[140:143], v[20:23], v[60:63]
  ds_read_b64_tr_b16 v[38:39], v9 offset:4608
  v_add_u32 v9, s42, v9
  s_waitcnt lgkmcnt(6)
  v_mfma_f32_16x16x32_bf16 v[64:67], v[136:139], v[24:27], v[64:67]
  ds_read_b64_tr_b16 v[40:41], v10 offset:4096
  v_mfma_f32_16x16x32_bf16 v[68:71], v[140:143], v[24:27], v[68:71]
  ds_read_b64_tr_b16 v[42:43], v10 offset:4608
  v_add_u32 v10, s42, v10
  s_waitcnt lgkmcnt(6)
  v_mfma_f32_16x16x32_bf16 v[72:75], v[136:139], v[28:31], v[72:75]
  ds_read_b64_tr_b16 v[44:45], v11 offset:4096
  buffer_load_dwordx4 v[132:135], v14, s[8:11], s36 offen offset:3072 sc1
  v_mfma_f32_16x16x32_bf16 v[76:79], v[140:143], v[28:31], v[76:79]
  ds_read_b64_tr_b16 v[46:47], v11 offset:4608
  v_add_u32 v11, s42, v11
  s_barrier
  s_waitcnt vmcnt(13) lgkmcnt(6)
  v_mfma_f32_16x16x32_bf16 v[48:51], v[144:147], v[32:35], v[48:51]
  ds_read_b64_tr_b16 v[16:17], v8 offset:0
  s_bitcmp1_b32 s48, 5
  s_cselect_b32 s36, s50, s49
  s_waitcnt vmcnt(12)
  v_mfma_f32_16x16x32_bf16 v[52:55], v[148:151], v[32:35], v[52:55]
  ds_read_b64_tr_b16 v[18:19], v8 offset:512
  s_add_u32 s36, s36, 20480
  s_add_u32 s40, s43, 8192
  s_waitcnt lgkmcnt(6)
  v_mfma_f32_16x16x32_bf16 v[56:59], v[144:147], v[36:39], v[56:59]
  ds_read_b64_tr_b16 v[20:21], v9 offset:0
  s_cmp_eq_u32 s40, 65536
  s_cselect_b32 s40, 0, s40
  v_mfma_f32_16x16x32_bf16 v[60:63], v[148:151], v[36:39], v[60:63]
  ds_read_b64_tr_b16 v[22:23], v9 offset:512
  s_sub_u32 s42, s40, s43
  s_mov_b32 s43, s40
  s_waitcnt lgkmcnt(6)
  v_mfma_f32_16x16x32_bf16 v[64:67], v[144:147], v[40:43], v[64:67]
  ds_read_b64_tr_b16 v[24:25], v10 offset:0
  buffer_load_dwordx4 v[136:139], v14, s[8:11], s36 offen offset:0 sc1
  v_mfma_f32_16x16x32_bf16 v[68:71], v[148:151], v[40:43], v[68:71]
  ds_read_b64_tr_b16 v[26:27], v10 offset:512
  s_waitcnt lgkmcnt(6)
  v_mfma_f32_16x16x32_bf16 v[72:75], v[144:147], v[44:47], v[72:75]
  ds_read_b64_tr_b16 v[28:29], v11 offset:0
  v_mfma_f32_16x16x32_bf16 v[76:79], v[148:151], v[44:47], v[76:79]
  ds_read_b64_tr_b16 v[30:31], v11 offset:512
  buffer_load_dwordx4 v[140:143], v14, s[8:11], s36 offen offset:1024 sc1
  s_waitcnt vmcnt(13) lgkmcnt(6)
  v_mfma_f32_16x16x32_bf16 v[48:51], v[152:155], v[16:19], v[48:51]
  ds_read_b64_tr_b16 v[32:33], v8 offset:4096
  s_waitcnt vmcnt(12)
  v_mfma_f32_16x16x32_bf16 v[52:55], v[156:159], v[16:19], v[52:55]
  ds_read_b64_tr_b16 v[34:35], v8 offset:4608
  v_add_u32 v8, s42, v8
  s_waitcnt lgkmcnt(6)
  v_mfma_f32_16x16x32_bf16 v[56:59], v[152:155], v[20:23], v[56:59]
  ds_read_b64_tr_b16 v[36:37], v9 offset:4096
  buffer_load_dwordx4 v[144:147], v14, s[8:11], s36 offen offset:2048 sc1
  v_mfma_f32_16x16x32_bf16 v[60:63], v[156:159], v[20:23], v[60:63]
  ds_read_b64_tr_b16 v[38:39], v9 offset:4608
  v_add_u32 v9, s42, v9
  s_waitcnt lgkmcnt(6)
  v_mfma_f32_16x16x32_bf16 v[64:67], v[152:155], v[24:27], v[64:67]
  ds_read_b64_tr_b16 v[40:41], v10 offset:4096
  v_mfma_f32_16x16x32_bf16 v[68:71], v[156:159], v[24:27], v[68:71]
  ds_read_b64_tr_b16 v[42:43], v10 offset:4608
  v_add_u32 v10, s42, v10
  s_waitcnt lgkmcnt(6)
  v_mfma_f32_16x16x32_bf16 v[72:75], v[152:155], v[28:31], v[72:75]
  ds_read_b64_tr_b16 v[44:45], v11 offset:4096
  buffer_load_dwordx4 v[148:151], v14, s[8:11], s36 offen offset:3072 sc1
  v_mfma_f32_16x16x32_bf16 v[76:79], v[156:159], v[28:31], v[76:79]
  ds_read_b64_tr_b16 v[46:47], v11 offset:4608
  v_add_u32 v11, s42, v11
  s_barrier
  s_waitcnt vmcnt(13) lgkmcnt(6)
  v_mfma_f32_16x16x32_bf16 v[48:51], v[160:163], v[32:35], v[48:51]
  ds_read_b64_tr_b16 v[16:17], v8 offset:0
  s_bitcmp1_b32 s48, 6
  s_cselect_b32 s36, s50, s49
  s_waitcnt vmcnt(12)
  v_mfma_f32_16x16x32_bf16 v[52:55], v[164:167], v[32:35], v[52:55]
  ds_read_b64_tr_b16 v[18:19], v8 offset:512
  s_add_u32 s36, s36, 24576
  s_add_u32 s40, s43, 8192
  s_waitcnt lgkmcnt(6)
  v_mfma_f32_16x16x32_bf16 v[56:59], v[160:163], v[36:39], v[56:59]
  ds_read_b64_tr_b16 v[20:21], v9 offset:0
  s_cmp_eq_u32 s40, 65536
  s_cselect_b32 s40, 0, s40
  v_mfma_f32_16x16x32_bf16 v[60:63], v[164:167], v[36:39], v[60:63]
  ds_read_b64_tr_b16 v[22:23], v9 offset:512
  s_sub_u32 s42, s40, s43
  s_mov_b32 s43, s40
  s_waitcnt lgkmcnt(6)
  v_mfma_f32_16x16x32_bf16 v[64:67], v[160:163], v[40:43], v[64:67]
  ds_read_b64_tr_b16 v[24:25], v10 offset:0
  buffer_load_dwordx4 v[152:155], v14, s[8:11], s36 offen offset:0 sc1
  v_mfma_f32_16x16x32_bf16 v[68:71], v[164:167], v[40:43], v[68:71]
  ds_read_b64_tr_b16 v[26:27], v10 offset:512
  s_waitcnt lgkmcnt(6)
  v_mfma_f32_16x16x32_bf16 v[72:75], v[160:163], v[44:47], v[72:75]
  ds_read_b64_tr_b16 v[28:29], v11 offset:0
  v_mfma_f32_16x16x32_bf16 v[76:79], v[164:167], v[44:47], v[76:79]
  ds_read_b64_tr_b16 v[30:31], v11 offset:512
  buffer_load_dwordx4 v[156:159], v14, s[8:11], s36 offen offset:1024 sc1
  s_waitcnt vmcnt(13) lgkmcnt(6)
  v_mfma_f32_16x16x32_bf16 v[48:51], v[168:171], v[16:19], v[48:51]
  ds_read_b64_tr_b16 v[32:33], v8 offset:4096
  s_waitcnt vmcnt(12)
  v_mfma_f32_16x16x32_bf16 v[52:55], v[172:175], v[16:19], v[52:55]
  ds_read_b64_tr_b16 v[34:35], v8 offset:4608
  v_add_u32 v8, s42, v8
  s_waitcnt lgkmcnt(6)
  v_mfma_f32_16x16x32_bf16 v[56:59], v[168:171], v[20:23], v[56:59]
  ds_read_b64_tr_b16 v[36:37], v9 offset:4096
  buffer_load_dwordx4 v[160:163], v14, s[8:11], s36 offen offset:2048 sc1
  v_mfma_f32_16x16x32_bf16 v[60:63], v[172:175], v[20:23], v[60:63]
  ds_read_b64_tr_b16 v[38:39], v9 offset:4608
  v_add_u32 v9, s42, v9
  s_waitcnt lgkmcnt(6)
  v_mfma_f32_16x16x32_bf16 v[64:67], v[168:171], v[24:27], v[64:67]
  ds_read_b64_tr_b16 v[40:41], v10 offset:4096
  v_mfma_f32_16x16x32_bf16 v[68:71], v[172:175], v[24:27], v[68:71]
  ds_read_b64_tr_b16 v[42:43], v10 offset:4608
  v_add_u32 v10, s42, v10
  s_waitcnt lgkmcnt(6)
  v_mfma_f32_16x16x32_bf16 v[72:75], v[168:171], v[28:31], v[72:75]
  ds_read_b64_tr_b16 v[44:45], v11 offset:4096
  buffer_load_dwordx4 v[164:167], v14, s[8:11], s36 offen offset:3072 sc1
  v_mfma_f32_16x16x32_bf16 v[76:79], v[172:175], v[28:31], v[76:79]
  ds_read_b64_tr_b16 v[46:47], v11 offset:4608
  v_add_u32 v11, s42, v11
  s_barrier
  s_waitcnt vmcnt(13) lgkmcnt(6)
  v_mfma_f32_16x16x32_bf16 v[48:51], v[176:179], v[32:35], v[48:51]
  ds_read_b64_tr_b16 v[16:17], v8 offset:0
  s_bitcmp1_b32 s48, 7
  s_cselect_b32 s36, s50, s49
  s_waitcnt vmcnt(12)
  v_mfma_f32_16x16x32_bf16 v[52:55], v[180:183], v[32:35], v[52:55]
  ds_read_b64_tr_b16 v[18:19], v8 offset:512
  s_add_u32 s36, s36, 28672
  s_add_u32 s40, s43, 8192
  s_waitcnt lgkmcnt(6)
  v_mfma_f32_16x16x32_bf16 v[56:59], v[176:179], v[36:39], v[56:59]
  ds_read_b64_tr_b16 v[20:21], v9 offset:0
  s_cmp_eq_u32 s40, 65536
  s_cselect_b32 s40, 0, s40
  v_mfma_f32_16x16x32_bf16 v[60:63], v[180:183], v[36:39], v[60:63]
  ds_read_b64_tr_b16 v[22:23], v9 offset:512
  s_sub_u32 s42, s40, s43
  s_mov_b32 s43, s40
  s_waitcnt lgkmcnt(6)
  v_mfma_f32_16x16x32_bf16 v[64:67], v[176:179], v[40:43], v[64:67]
  ds_read_b64_tr_b16 v[24:25], v10 offset:0
  buffer_load_dwordx4 v[168:171], v14, s[8:11], s36 offen offset:0 sc1
  v_mfma_f32_16x16x32_bf16 v[68:71], v[180:183], v[40:43], v[68:71]
  ds_read_b64_tr_b16 v[26:27], v10 offset:512
  s_waitcnt lgkmcnt(6)
  v_mfma_f32_16x16x32_bf16 v[72:75], v[176:179], v[44:47], v[72:75]
  ds_read_b64_tr_b16 v[28:29], v11 offset:0
  v_mfma_f32_16x16x32_bf16 v[76:79], v[180:183], v[44:47], v[76:79]
  ds_read_b64_tr_b16 v[30:31], v11 offset:512
  buffer_load_dwordx4 v[172:175], v14, s[8:11], s36 offen offset:1024 sc1
  s_waitcnt vmcnt(13) lgkmcnt(6)
  v_mfma_f32_16x16x32_bf16 v[48:51], v[120:123], v[16:19], v[48:51]
  ds_read_b64_tr_b16 v[32:33], v8 offset:4096
  s_waitcnt vmcnt(12)
  v_mfma_f32_16x16x32_bf16 v[52:55], v[124:127], v[16:19], v[52:55]
  ds_read_b64_tr_b16 v[34:35], v8 offset:4608
  v_add_u32 v8, s42, v8
  s_waitcnt lgkmcnt(6)
  v_mfma_f32_16x16x32_bf16 v[56:59], v[120:123], v[20:23], v[56:59]
  ds_read_b64_tr_b16 v[36:37], v9 offset:4096
  buffer_load_dwordx4 v[176:179], v14, s[8:11], s36 offen offset:2048 sc1
  v_mfma_f32_16x16x32_bf16 v[60:63], v[124:127], v[20:23], v[60:63]
  ds_read_b64_tr_b16 v[38:39], v9 offset:4608
  v_add_u32 v9, s42, v9
  s_waitcnt lgkmcnt(6)
  v_mfma_f32_16x16x32_bf16 v[64:67], v[120:123], v[24:27], v[64:67]
  ds_read_b64_tr_b16 v[40:41], v10 offset:4096
  v_mfma_f32_16x16x32_bf16 v[68:71], v[124:127], v[24:27], v[68:71]
  ds_read_b64_tr_b16 v[42:43], v10 offset:4608
  v_add_u32 v10, s42, v10
  s_waitcnt lgkmcnt(6)
  v_mfma_f32_16x16x32_bf16 v[72:75], v[120:123], v[28:31], v[72:75]
  ds_read_b64_tr_b16 v[44:45], v11 offset:4096
  buffer_load_dwordx4 v[180:183], v14, s[8:11], s36 offen offset:3072 sc1
  v_mfma_f32_16x16x32_bf16 v[76:79], v[124:127], v[28:31], v[76:79]
  ds_read_b64_tr_b16 v[46:47], v11 offset:4608
  v_add_u32 v11, s42, v11
  s_barrier
  s_waitcnt vmcnt(13) lgkmcnt(6)
  v_mfma_f32_16x16x32_bf16 v[48:51], v[128:131], v[32:35], v[48:51]
  ds_read_b64_tr_b16 v[16:17], v8 offset:0
  s_mov_b32 s49, s50
  s_add_u32 s50, s50, 32768
  s_waitcnt vmcnt(12)
  v_mfma_f32_16x16x32_bf16 v[52:55], v[132:135], v[32:35], v[52:55]
  ds_read_b64_tr_b16 v[18:19], v8 offset:512
  s_cmp_eq_u32 s50, s41
  s_cselect_b32 s50, s34, s50
  s_waitcnt lgkmcnt(6)
  v_mfma_f32_16x16x32_bf16 v[56:59], v[128:131], v[36:39], v[56:59]
  ds_read_b64_tr_b16 v[20:21], v9 offset:0
  s_bitcmp1_b32 s48, 0
  s_cselect_b32 s36, s50, s49
  v_mfma_f32_16x16x32_bf16 v[60:63], v[132:135], v[36:39], v[60:63]
  ds_read_b64_tr_b16 v[22:23], v9 offset:512
  s_add_u32 s36, s36, 0
  s_add_u32 s40, s43, 8192
  s_waitcnt lgkmcnt(6)
  v_mfma_f32_16x16x32_bf16 v[64:67], v[128:131], v[40:43], v[64:67]
  ds_read_b64_tr_b16 v[24:25], v10 offset:0
  s_cmp_eq_u32 s40, 65536
  s_cselect_b32 s40, 0, s40
  buffer_load_dwordx4 v[120:123], v14, s[8:11], s36 offen offset:0 sc1
  v_mfma_f32_16x16x32_bf16 v[68:71], v[132:135], v[40:43], v[68:71]
  ds_read_b64_tr_b16 v[26:27], v10 offset:512
  s_sub_u32 s42, s40, s43
  s_mov_b32 s43, s40
  s_waitcnt lgkmcnt(6)
  v_mfma_f32_16x16x32_bf16 v[72:75], v[128:131], v[44:47], v[72:75]
  ds_read_b64_tr_b16 v[28:29], v11 offset:0
  v_mfma_f32_16x16x32_bf16 v[76:79], v[132:135], v[44:47], v[76:79]
  ds_read_b64_tr_b16 v[30:31], v11 offset:512
  buffer_load_dwordx4 v[124:127], v14, s[8:11], s36 offen offset:1024 sc1
  s_waitcnt vmcnt(13) lgkmcnt(6)
  v_mfma_f32_16x16x32_bf16 v[48:51], v[136:139], v[16:19], v[48:51]
  ds_read_b64_tr_b16 v[32:33], v8 offset:4096
  s_waitcnt vmcnt(12)
  v_mfma_f32_16x16x32_bf16 v[52:55], v[140:143], v[16:19], v[52:55]
  ds_read_b64_tr_b16 v[34:35], v8 offset:4608
  v_add_u32 v8, s42, v8
  s_waitcnt lgkmcnt(6)
  v_mfma_f32_16x16x32_bf16 v[56:59], v[136:139], v[20:23], v[56:59]
  ds_read_b64_tr_b16 v[36:37], v9 offset:4096
  buffer_load_dwordx4 v[128:131], v14, s[8:11], s36 offen offset:2048 sc1
  v_mfma_f32_16x16x32_bf16 v[60:63], v[140:143], v[20:23], v[60:63]
  ds_read_b64_tr_b16 v[38:39], v9 offset:4608
  v_add_u32 v9, s42, v9
  s_waitcnt lgkmcnt(6)
  v_mfma_f32_16x16x32_bf16 v[64:67], v[136:139], v[24:27], v[64:67]
  ds_read_b64_tr_b16 v[40:41], v10 offset:4096
  v_mfma_f32_16x16x32_bf16 v[68:71], v[140:143], v[24:27], v[68:71]
  ds_read_b64_tr_b16 v[42:43], v10 offset:4608
  v_add_u32 v10, s42, v10
  s_waitcnt lgkmcnt(6)
  v_mfma_f32_16x16x32_bf16 v[72:75], v[136:139], v[28:31], v[72:75]
  ds_read_b64_tr_b16 v[44:45], v11 offset:4096
  buffer_load_dwordx4 v[132:135], v14, s[8:11], s36 offen offset:3072 sc1
  v_mfma_f32_16x16x32_bf16 v[76:79], v[140:143], v[28:31], v[76:79]
  ds_read_b64_tr_b16 v[46:47], v11 offset:4608
  v_add_u32 v11, s42, v11
  s_barrier
  s_waitcnt vmcnt(13) lgkmcnt(6)
  v_mfma_f32_16x16x32_bf16 v[48:51], v[144:147], v[32:35], v[48:51]
  ds_read_b64_tr_b16 v[16:17], v8 offset:0
  s_bitcmp1_b32 s48, 1
  s_cselect_b32 s36, s50, s49
  s_waitcnt vmcnt(12)
  v_mfma_f32_16x16x32_bf16 v[52:55], v[148:151], v[32:35], v[52:55]
  ds_read_b64_tr_b16 v[18:19], v8 offset:512
  s_add_u32 s36, s36, 4096
  s_add_u32 s40, s43, 8192
  s_waitcnt lgkmcnt(6)
  v_mfma_f32_16x16x32_bf16 v[56:59], v[144:147], v[36:39], v[56:59]
  ds_read_b64_tr_b16 v[20:21], v9 offset:0
  s_cmp_eq_u32 s40, 65536
  s_cselect_b32 s40, 0, s40
  v_mfma_f32_16x16x32_bf16 v[60:63], v[148:151], v[36:39], v[60:63]
  ds_read_b64_tr_b16 v[22:23], v9 offset:512
  s_sub_u32 s42, s40, s43
  s_mov_b32 s43, s40
  s_waitcnt lgkmcnt(6)
  v_mfma_f32_16x16x32_bf16 v[64:67], v[144:147], v[40:43], v[64:67]
  ds_read_b64_tr_b16 v[24:25], v10 offset:0
  buffer_load_dwordx4 v[136:139], v14, s[8:11], s36 offen offset:0 sc1
  v_mfma_f32_16x16x32_bf16 v[68:71], v[148:151], v[40:43], v[68:71]
  ds_read_b64_tr_b16 v[26:27], v10 offset:512
  s_waitcnt lgkmcnt(6)
  v_mfma_f32_16x16x32_bf16 v[72:75], v[144:147], v[44:47], v[72:75]
  ds_read_b64_tr_b16 v[28:29], v11 offset:0
  v_mfma_f32_16x16x32_bf16 v[76:79], v[148:151], v[44:47], v[76:79]
  ds_read_b64_tr_b16 v[30:31], v11 offset:512
  buffer_load_dwordx4 v[140:143], v14, s[8:11], s36 offen offset:1024 sc1
  s_waitcnt vmcnt(13) lgkmcnt(6)
  v_mfma_f32_16x16x32_bf16 v[48:51], v[152:155], v[16:19], v[48:51]
  ds_read_b64_tr_b16 v[32:33], v8 offset:4096
  s_waitcnt vmcnt(12)
  v_mfma_f32_16x16x32_bf16 v[52:55], v[156:159], v[16:19], v[52:55]
  ds_read_b64_tr_b16 v[34:35], v8 offset:4608
  v_add_u32 v8, s42, v8
  s_waitcnt lgkmcnt(6)
  v_mfma_f32_16x16x32_bf16 v[56:59], v[152:155], v[20:23], v[56:59]
  ds_read_b64_tr_b16 v[36:37], v9 offset:4096
  buffer_load_dwordx4 v[144:147], v14, s[8:11], s36 offen offset:2048 sc1
  v_mfma_f32_16x16x32_bf16 v[60:63], v[156:159], v[20:23], v[60:63]
  ds_read_b64_tr_b16 v[38:39], v9 offset:4608
  v_add_u32 v9, s42, v9
  s_waitcnt lgkmcnt(6)
  v_mfma_f32_16x16x32_bf16 v[64:67], v[152:155], v[24:27], v[64:67]
  ds_read_b64_tr_b16 v[40:41], v10 offset:4096
  v_mfma_f32_16x16x32_bf16 v[68:71], v[156:159], v[24:27], v[68:71]
  ds_read_b64_tr_b16 v[42:43], v10 offset:4608
  v_add_u32 v10, s42, v10
  s_waitcnt lgkmcnt(6)
  v_mfma_f32_16x16x32_bf16 v[72:75], v[152:155], v[28:31], v[72:75]
  ds_read_b64_tr_b16 v[44:45], v11 offset:4096
  buffer_load_dwordx4 v[148:151], v14, s[8:11], s36 offen offset:3072 sc1
  v_mfma_f32_16x16x32_bf16 v[76:79], v[156:159], v[28:31], v[76:79]
  ds_read_b64_tr_b16 v[46:47], v11 offset:4608
  v_add_u32 v11, s42, v11
  s_barrier
  s_waitcnt vmcnt(13) lgkmcnt(6)
  v_mfma_f32_16x16x32_bf16 v[48:51], v[160:163], v[32:35], v[48:51]
  ds_read_b64_tr_b16 v[16:17], v8 offset:0
  s_bitcmp1_b32 s48, 2
  s_cselect_b32 s36, s50, s49
  s_waitcnt vmcnt(12)
  v_mfma_f32_16x16x32_bf16 v[52:55], v[164:167], v[32:35], v[52:55]
  ds_read_b64_tr_b16 v[18:19], v8 offset:512
  s_add_u32 s36, s36, 8192
  s_add_u32 s40, s43, 8192
  s_waitcnt lgkmcnt(6)
  v_mfma_f32_16x16x32_bf16 v[56:59], v[160:163], v[36:39], v[56:59]
  ds_read_b64_tr_b16 v[20:21], v9 offset:0
  s_cmp_eq_u32 s40, 65536
  s_cselect_b32 s40, 0, s40
  v_mfma_f32_16x16x32_bf16 v[60:63], v[164:167], v[36:39], v[60:63]
  ds_read_b64_tr_b16 v[22:23], v9 offset:512
  s_sub_u32 s42, s40, s43
  s_mov_b32 s43, s40
  s_waitcnt lgkmcnt(6)
  v_mfma_f32_16x16x32_bf16 v[64:67], v[160:163], v[40:43], v[64:67]
  ds_read_b64_tr_b16 v[24:25], v10 offset:0
  buffer_load_dwordx4 v[152:155], v14, s[8:11], s36 offen offset:0 sc1
  v_mfma_f32_16x16x32_bf16 v[68:71], v[164:167], v[40:43], v[68:71]
  ds_read_b64_tr_b16 v[26:27], v10 offset:512
  s_waitcnt lgkmcnt(6)
  v_mfma_f32_16x16x32_bf16 v[72:75], v[160:163], v[44:47], v[72:75]
  ds_read_b64_tr_b16 v[28:29], v11 offset:0
  v_mfma_f32_16x16x32_bf16 v[76:79], v[164:167], v[44:47], v[76:79]
  ds_read_b64_tr_b16 v[30:31], v11 offset:512
  buffer_load_dwordx4 v[156:159], v14, s[8:11], s36 offen offset:1024 sc1
  s_waitcnt vmcnt(13) lgkmcnt(6)
  v_mfma_f32_16x16x32_bf16 v[48:51], v[168:171], v[16:19], v[48:51]
  ds_read_b64_tr_b16 v[32:33], v8 offset:4096
  s_waitcnt vmcnt(12)
  v_mfma_f32_16x16x32_bf16 v[52:55], v[172:175], v[16:19], v[52:55]
  ds_read_b64_tr_b16 v[34:35], v8 offset:4608
  v_add_u32 v8, s42, v8
  s_waitcnt lgkmcnt(6)
  v_mfma_f32_16x16x32_bf16 v[56:59], v[168:171], v[20:23], v[56:59]
  ds_read_b64_tr_b16 v[36:37], v9 offset:4096
  buffer_load_dwordx4 v[160:163], v14, s[8:11], s36 offen offset:2048 sc1
  v_mfma_f32_16x16x32_bf16 v[60:63], v[172:175], v[20:23], v[60:63]
  ds_read_b64_tr_b16 v[38:39], v9 offset:4608
  v_add_u32 v9, s42, v9
  s_waitcnt lgkmcnt(6)
  v_mfma_f32_16x16x32_bf16 v[64:67], v[168:171], v[24:27], v[64:67]
  ds_read_b64_tr_b16 v[40:41], v10 offset:4096
  v_mfma_f32_16x16x32_bf16 v[68:71], v[172:175], v[24:27], v[68:71]
  ds_read_b64_tr_b16 v[42:43], v10 offset:4608
  v_add_u32 v10, s42, v10
  s_waitcnt lgkmcnt(6)
  v_mfma_f32_16x16x32_bf16 v[72:75], v[168:171], v[28:31], v[72:75]
  ds_read_b64_tr_b16 v[44:45], v11 offset:4096
  buffer_load_dwordx4 v[164:167], v14, s[8:11], s36 offen offset:3072 sc1
  v_mfma_f32_16x16x32_bf16 v[76:79], v[172:175], v[28:31], v[76:79]
  ds_read_b64_tr_b16 v[46:47], v11 offset:4608
  v_add_u32 v11, s42, v11
  s_barrier
  s_waitcnt vmcnt(13) lgkmcnt(6)
  v_mfma_f32_16x16x32_bf16 v[48:51], v[176:179], v[32:35], v[48:51]
  ds_read_b64_tr_b16 v[16:17], v8 offset:0
  s_bitcmp1_b32 s48, 3
  s_cselect_b32 s36, s50, s49
  s_waitcnt vmcnt(12)
  v_mfma_f32_16x16x32_bf16 v[52:55], v[180:183], v[32:35], v[52:55]
  ds_read_b64_tr_b16 v[18:19], v8 offset:512
  s_add_u32 s36, s36, 12288
  s_add_u32 s40, s43, 8192
  s_waitcnt lgkmcnt(6)
  v_mfma_f32_16x16x32_bf16 v[56:59], v[176:179], v[36:39], v[56:59]
  ds_read_b64_tr_b16 v[20:21], v9 offset:0
  s_cmp_eq_u32 s40, 65536
  s_cselect_b32 s40, 0, s40
  v_mfma_f32_16x16x32_bf16 v[60:63], v[180:183], v[36:39], v[60:63]
  ds_read_b64_tr_b16 v[22:23], v9 offset:512
  s_sub_u32 s42, s40, s43
  s_mov_b32 s43, s40
  s_waitcnt lgkmcnt(6)
  v_mfma_f32_16x16x32_bf16 v[64:67], v[176:179], v[40:43], v[64:67]
  ds_read_b64_tr_b16 v[24:25], v10 offset:0
  buffer_load_dwordx4 v[168:171], v14, s[8:11], s36 offen offset:0 sc1
  v_mfma_f32_16x16x32_bf16 v[68:71], v[180:183], v[40:43], v[68:71]
  ds_read_b64_tr_b16 v[26:27], v10 offset:512
  s_waitcnt lgkmcnt(6)
  v_mfma_f32_16x16x32_bf16 v[72:75], v[176:179], v[44:47], v[72:75]
  ds_read_b64_tr_b16 v[28:29], v11 offset:0
  v_mfma_f32_16x16x32_bf16 v[76:79], v[180:183], v[44:47], v[76:79]
  ds_read_b64_tr_b16 v[30:31], v11 offset:512
  buffer_load_dwordx4 v[172:175], v14, s[8:11], s36 offen offset:1024 sc1
  s_sub_u32 s39, s39, 1
  s_cmp_lg_u32 s39, 0
  s_cbranch_scc1 cd5
  s_waitcnt vmcnt(13) lgkmcnt(6)
  v_mfma_f32_16x16x32_bf16 v[48:51], v[120:123], v[16:19], v[48:51]
  ds_read_b64_tr_b16 v[32:33], v8 offset:4096
  s_waitcnt vmcnt(12)
  v_mfma_f32_16x16x32_bf16 v[52:55], v[124:127], v[16:19], v[52:55]
  ds_read_b64_tr_b16 v[34:35], v8 offset:4608
  v_add_u32 v8, s42, v8
  s_waitcnt lgkmcnt(6)
  v_mfma_f32_16x16x32_bf16 v[56:59], v[120:123], v[20:23], v[56:59]
  ds_read_b64_tr_b16 v[36:37], v9 offset:4096
  buffer_load_dwordx4 v[176:179], v14, s[8:11], s36 offen offset:2048 sc1
  v_mfma_f32_16x16x32_bf16 v[60:63], v[124:127], v[20:23], v[60:63]
  ds_read_b64_tr_b16 v[38:39], v9 offset:4608
  v_add_u32 v9, s42, v9
  s_waitcnt lgkmcnt(6)
  v_mfma_f32_16x16x32_bf16 v[64:67], v[120:123], v[24:27], v[64:67]
  ds_read_b64_tr_b16 v[40:41], v10 offset:4096
  v_mfma_f32_16x16x32_bf16 v[68:71], v[124:127], v[24:27], v[68:71]
  ds_read_b64_tr_b16 v[42:43], v10 offset:4608
  v_add_u32 v10, s42, v10
  s_waitcnt lgkmcnt(6)
  v_mfma_f32_16x16x32_bf16 v[72:75], v[120:123], v[28:31], v[72:75]
  ds_read_b64_tr_b16 v[44:45], v11 offset:4096
  buffer_load_dwordx4 v[180:183], v14, s[8:11], s36 offen offset:3072 sc1
  v_mfma_f32_16x16x32_bf16 v[76:79], v[124:127], v[28:31], v[76:79]
  ds_read_b64_tr_b16 v[46:47], v11 offset:4608
  v_add_u32 v11, s42, v11
  s_barrier
  s_waitcnt vmcnt(13) lgkmcnt(6)
  v_mfma_f32_16x16x32_bf16 v[48:51], v[128:131], v[32:35], v[48:51]
  ds_read_b64_tr_b16 v[16:17], v8 offset:0
  s_bitcmp1_b32 s48, 4
  s_cselect_b32 s36, s50, s49
  s_waitcnt vmcnt(12)
  v_mfma_f32_16x16x32_bf16 v[52:55], v[132:135], v[32:35], v[52:55]
  ds_read_b64_tr_b16 v[18:19], v8 offset:512
  s_add_u32 s36, s36, 16384
  s_add_u32 s40, s43, 8192
  s_waitcnt lgkmcnt(6)
  v_mfma_f32_16x16x32_bf16 v[56:59], v[128:131], v[36:39], v[56:59]
  ds_read_b64_tr_b16 v[20:21], v9 offset:0
  s_cmp_eq_u32 s40, 65536
  s_cselect_b32 s40, 0, s40
  v_mfma_f32_16x16x32_bf16 v[60:63], v[132:135], v[36:39], v[60:63]
  ds_read_b64_tr_b16 v[22:23], v9 offset:512
  s_sub_u32 s42, s40, s43
  s_mov_b32 s43, s40
  s_waitcnt lgkmcnt(6)
  v_mfma_f32_16x16x32_bf16 v[64:67], v[128:131], v[40:43], v[64:67]
  ds_read_b64_tr_b16 v[24:25], v10 offset:0
  buffer_load_dwordx4 v[120:123], v14, s[8:11], s36 offen offset:0 sc1
  v_mfma_f32_16x16x32_bf16 v[68:71], v[132:135], v[40:43], v[68:71]
  ds_read_b64_tr_b16 v[26:27], v10 offset:512
  s_waitcnt lgkmcnt(6)
  v_mfma_f32_16x16x32_bf16 v[72:75], v[128:131], v[44:47], v[72:75]
  ds_read_b64_tr_b16 v[28:29], v11 offset:0
  v_mfma_f32_16x16x32_bf16 v[76:79], v[132:135], v[44:47], v[76:79]
  ds_read_b64_tr_b16 v[30:31], v11 offset:512
  buffer_load_dwordx4 v[124:127], v14, s[8:11], s36 offen offset:1024 sc1
  s_waitcnt vmcnt(13) lgkmcnt(6)
  v_mfma_f32_16x16x32_bf16 v[48:51], v[136:139], v[16:19], v[48:51]
  ds_read_b64_tr_b16 v[32:33], v8 offset:4096
  s_waitcnt vmcnt(12)
  v_mfma_f32_16x16x32_bf16 v[52:55], v[140:143], v[16:19], v[52:55]
  ds_read_b64_tr_b16 v[34:35], v8 offset:4608
  v_add_u32 v8, s42, v8
  s_waitcnt lgkmcnt(6)
  v_mfma_f32_16x16x32_bf16 v[56:59], v[136:139], v[20:23], v[56:59]
  ds_read_b64_tr_b16 v[36:37], v9 offset:4096
  buffer_load_dwordx4 v[128:131], v14, s[8:11], s36 offen offset:2048 sc1
  v_mfma_f32_16x16x32_bf16 v[60:63], v[140:143], v[20:23], v[60:63]
  ds_read_b64_tr_b16 v[38:39], v9 offset:4608
  v_add_u32 v9, s42, v9
  s_waitcnt lgkmcnt(6)
  v_mfma_f32_16x16x32_bf16 v[64:67], v[136:139], v[24:27], v[64:67]
  ds_read_b64_tr_b16 v[40:41], v10 offset:4096
  v_mfma_f32_16x16x32_bf16 v[68:71], v[140:143], v[24:27], v[68:71]
  ds_read_b64_tr_b16 v[42:43], v10 offset:4608
  v_add_u32 v10, s42, v10
  s_waitcnt lgkmcnt(6)
  v_mfma_f32_16x16x32_bf16 v[72:75], v[136:139], v[28:31], v[72:75]
  ds_read_b64_tr_b16 v[44:45], v11 offset:4096
  buffer_load_dwordx4 v[132:135], v14, s[8:11], s36 offen offset:3072 sc1
  v_mfma_f32_16x16x32_bf16 v[76:79], v[140:143], v[28:31], v[76:79]
  ds_read_b64_tr_b16 v[46:47], v11 offset:4608
  v_add_u32 v11, s42, v11
  s_barrier
  s_waitcnt vmcnt(13) lgkmcnt(6)
  v_mfma_f32_16x16x32_bf16 v[48:51], v[144:147], v[32:35], v[48:51]
  ds_read_b64_tr_b16 v[16:17], v8 offset:0
  s_bitcmp1_b32 s48, 5
  s_cselect_b32 s36, s50, s49
  s_waitcnt vmcnt(12)
  v_mfma_f32_16x16x32_bf16 v[52:55], v[148:151], v[32:35], v[52:55]
  ds_read_b64_tr_b16 v[18:19], v8 offset:512
  s_add_u32 s36, s36, 20480
  s_add_u32 s40, s43, 8192
  s_waitcnt lgkmcnt(6)
  v_mfma_f32_16x16x32_bf16 v[56:59], v[144:147], v[36:39], v[56:59]
  ds_read_b64_tr_b16 v[20:21], v9 offset:0
  s_cmp_eq_u32 s40, 65536
  s_cselect_b32 s40, 0, s40
  v_mfma_f32_16x16x32_bf16 v[60:63], v[148:151], v[36:39], v[60:63]
  ds_read_b64_tr_b16 v[22:23], v9 offset:512
  s_sub_u32 s42, s40, s43
  s_mov_b32 s43, s40
  s_waitcnt lgkmcnt(6)
  v_mfma_f32_16x16x32_bf16 v[64:67], v[144:147], v[40:43], v[64:67]
  ds_read_b64_tr_b16 v[24:25], v10 offset:0
  buffer_load_dwordx4 v[136:139], v14, s[8:11], s36 offen offset:0 sc1
  v_mfma_f32_16x16x32_bf16 v[68:71], v[148:151], v[40:43], v[68:71]
  ds_read_b64_tr_b16 v[26:27], v10 offset:512
  s_waitcnt lgkmcnt(6)
  v_mfma_f32_16x16x32_bf16 v[72:75], v[144:147], v[44:47], v[72:75]
  ds_read_b64_tr_b16 v[28:29], v11 offset:0
  v_mfma_f32_16x16x32_bf16 v[76:79], v[148:151], v[44:47], v[76:79]
  ds_read_b64_tr_b16 v[30:31], v11 offset:512
  buffer_load_dwordx4 v[140:143], v14, s[8:11], s36 offen offset:1024 sc1
  s_waitcnt vmcnt(13) lgkmcnt(6)
  v_mfma_f32_16x16x32_bf16 v[48:51], v[152:155], v[16:19], v[48:51]
  ds_read_b64_tr_b16 v[32:33], v8 offset:4096
  s_waitcnt vmcnt(12)
  v_mfma_f32_16x16x32_bf16 v[52:55], v[156:159], v[16:19], v[52:55]
  ds_read_b64_tr_b16 v[34:35], v8 offset:4608
  v_add_u32 v8, s42, v8
  s_waitcnt lgkmcnt(6)
  v_mfma_f32_16x16x32_bf16 v[56:59], v[152:155], v[20:23], v[56:59]
  ds_read_b64_tr_b16 v[36:37], v9 offset:4096
  buffer_load_dwordx4 v[144:147], v14, s[8:11], s36 offen offset:2048 sc1
  v_mfma_f32_16x16x32_bf16 v[60:63], v[156:159], v[20:23], v[60:63]
  ds_read_b64_tr_b16 v[38:39], v9 offset:4608
  v_add_u32 v9, s42, v9
  s_waitcnt lgkmcnt(6)
  v_mfma_f32_16x16x32_bf16 v[64:67], v[152:155], v[24:27], v[64:67]
  ds_read_b64_tr_b16 v[40:41], v10 offset:4096
  v_mfma_f32_16x16x32_bf16 v[68:71], v[156:159], v[24:27], v[68:71]
  ds_read_b64_tr_b16 v[42:43], v10 offset:4608
  v_add_u32 v10, s42, v10
  s_waitcnt lgkmcnt(6)
  v_mfma_f32_16x16x32_bf16 v[72:75], v[152:155], v[28:31], v[72:75]
  ds_read_b64_tr_b16 v[44:45], v11 offset:4096
  buffer_load_dwordx4 v[148:151], v14, s[8:11], s36 offen offset:3072 sc1
  v_mfma_f32_16x16x32_bf16 v[76:79], v[156:159], v[28:31], v[76:79]
  ds_read_b64_tr_b16 v[46:47], v11 offset:4608
  v_add_u32 v11, s42, v11
  s_barrier
  s_waitcnt vmcnt(13) lgkmcnt(6)
  v_mfma_f32_16x16x32_bf16 v[48:51], v[160:163], v[32:35], v[48:51]
  ds_read_b64_tr_b16 v[16:17], v8 offset:0
  s_bitcmp1_b32 s48, 6
  s_cselect_b32 s36, s50, s49
  s_waitcnt vmcnt(12)
  v_mfma_f32_16x16x32_bf16 v[52:55], v[164:167], v[32:35], v[52:55]
  ds_read_b64_tr_b16 v[18:19], v8 offset:512
  s_add_u32 s36, s36, 24576
  s_add_u32 s40, s43, 8192
  s_waitcnt lgkmcnt(6)
  v_mfma_f32_16x16x32_bf16 v[56:59], v[160:163], v[36:39], v[56:59]
  ds_read_b64_tr_b16 v[20:21], v9 offset:0
  s_cmp_eq_u32 s40, 65536
  s_cselect_b32 s40, 0, s40
  v_mfma_f32_16x16x32_bf16 v[60:63], v[164:167], v[36:39], v[60:63]
  ds_read_b64_tr_b16 v[22:23], v9 offset:512
  s_sub_u32 s42, s40, s43
  s_mov_b32 s43, s40
  s_waitcnt lgkmcnt(6)
  v_mfma_f32_16x16x32_bf16 v[64:67], v[160:163], v[40:43], v[64:67]
  ds_read_b64_tr_b16 v[24:25], v10 offset:0
  buffer_load_dwordx4 v[152:155], v14, s[8:11], s36 offen offset:0 sc1
  v_mfma_f32_16x16x32_bf16 v[68:71], v[164:167], v[40:43], v[68:71]
  ds_read_b64_tr_b16 v[26:27], v10 offset:512
  s_waitcnt lgkmcnt(6)
  v_mfma_f32_16x16x32_bf16 v[72:75], v[160:163], v[44:47], v[72:75]
  ds_read_b64_tr_b16 v[28:29], v11 offset:0
  v_mfma_f32_16x16x32_bf16 v[76:79], v[164:167], v[44:47], v[76:79]
  ds_read_b64_tr_b16 v[30:31], v11 offset:512
  buffer_load_dwordx4 v[156:159], v14, s[8:11], s36 offen offset:1024 sc1
  s_waitcnt vmcnt(13) lgkmcnt(6)
  v_mfma_f32_16x16x32_bf16 v[48:51], v[168:171], v[16:19], v[48:51]
  ds_read_b64_tr_b16 v[32:33], v8 offset:4096
  s_waitcnt vmcnt(12)
  v_mfma_f32_16x16x32_bf16 v[52:55], v[172:175], v[16:19], v[52:55]
  ds_read_b64_tr_b16 v[34:35], v8 offset:4608
  v_add_u32 v8, s42, v8
  s_waitcnt lgkmcnt(6)
  v_mfma_f32_16x16x32_bf16 v[56:59], v[168:171], v[20:23], v[56:59]
  ds_read_b64_tr_b16 v[36:37], v9 offset:4096
  buffer_load_dwordx4 v[160:163], v14, s[8:11], s36 offen offset:2048 sc1
  v_mfma_f32_16x16x32_bf16 v[60:63], v[172:175], v[20:23], v[60:63]
  ds_read_b64_tr_b16 v[38:39], v9 offset:4608
  v_add_u32 v9, s42, v9
  s_waitcnt lgkmcnt(6)
  v_mfma_f32_16x16x32_bf16 v[64:67], v[168:171], v[24:27], v[64:67]
  ds_read_b64_tr_b16 v[40:41], v10 offset:4096
  v_mfma_f32_16x16x32_bf16 v[68:71], v[172:175], v[24:27], v[68:71]
  ds_read_b64_tr_b16 v[42:43], v10 offset:4608
  v_add_u32 v10, s42, v10
  s_waitcnt lgkmcnt(6)
  v_mfma_f32_16x16x32_bf16 v[72:75], v[168:171], v[28:31], v[72:75]
  ds_read_b64_tr_b16 v[44:45], v11 offset:4096
  buffer_load_dwordx4 v[164:167], v14, s[8:11], s36 offen offset:3072 sc1
  v_mfma_f32_16x16x32_bf16 v[76:79], v[172:175], v[28:31], v[76:79]
  ds_read_b64_tr_b16 v[46:47], v11 offset:4608
  v_add_u32 v11, s42, v11
  s_barrier
  s_waitcnt vmcnt(13) lgkmcnt(6)
  v_mfma_f32_16x16x32_bf16 v[48:51], v[176:179], v[32:35], v[48:51]
  ds_read_b64_tr_b16 v[16:17], v8 offset:0
  s_bitcmp1_b32 s48, 7
  s_cselect_b32 s36, s50, s49
  s_waitcnt vmcnt(12)
  v_mfma_f32_16x16x32_bf16 v[52:55], v[180:183], v[32:35], v[52:55]
  ds_read_b64_tr_b16 v[18:19], v8 offset:512
  s_add_u32 s36, s36, 28672
  s_add_u32 s40, s43, 8192
  s_waitcnt lgkmcnt(6)
  v_mfma_f32_16x16x32_bf16 v[56:59], v[176:179], v[36:39], v[56:59]
  ds_read_b64_tr_b16 v[20:21], v9 offset:0
  s_cmp_eq_u32 s40, 65536
  s_cselect_b32 s40, 0, s40
  v_mfma_f32_16x16x32_bf16 v[60:63], v[180:183], v[36:39], v[60:63]
  ds_read_b64_tr_b16 v[22:23], v9 offset:512
  s_sub_u32 s42, s40, s43
  s_mov_b32 s43, s40
  s_waitcnt lgkmcnt(6)
  v_mfma_f32_16x16x32_bf16 v[64:67], v[176:179], v[40:43], v[64:67]
  ds_read_b64_tr_b16 v[24:25], v10 offset:0
  buffer_load_dwordx4 v[168:171], v14, s[8:11], s36 offen offset:0 sc1
  v_mfma_f32_16x16x32_bf16 v[68:71], v[180:183], v[40:43], v[68:71]
  ds_read_b64_tr_b16 v[26:27], v10 offset:512
  s_waitcnt lgkmcnt(6)
  v_mfma_f32_16x16x32_bf16 v[72:75], v[176:179], v[44:47], v[72:75]
  ds_read_b64_tr_b16 v[28:29], v11 offset:0
  v_mfma_f32_16x16x32_bf16 v[76:79], v[180:183], v[44:47], v[76:79]
  ds_read_b64_tr_b16 v[30:31], v11 offset:512
  buffer_load_dwordx4 v[172:175], v14, s[8:11], s36 offen offset:1024 sc1
  s_waitcnt vmcnt(13) lgkmcnt(6)
  v_mfma_f32_16x16x32_bf16 v[48:51], v[120:123], v[16:19], v[48:51]
  ds_read_b64_tr_b16 v[32:33], v8 offset:4096
  s_waitcnt vmcnt(12)
  v_mfma_f32_16x16x32_bf16 v[52:55], v[124:127], v[16:19], v[52:55]
  ds_read_b64_tr_b16 v[34:35], v8 offset:4608
  v_add_u32 v8, s42, v8
  s_waitcnt lgkmcnt(6)
  v_mfma_f32_16x16x32_bf16 v[56:59], v[120:123], v[20:23], v[56:59]
  ds_read_b64_tr_b16 v[36:37], v9 offset:4096
  buffer_load_dwordx4 v[176:179], v14, s[8:11], s36 offen offset:2048 sc1
  v_mfma_f32_16x16x32_bf16 v[60:63], v[124:127], v[20:23], v[60:63]
  ds_read_b64_tr_b16 v[38:39], v9 offset:4608
  v_add_u32 v9, s42, v9
  s_waitcnt lgkmcnt(6)
  v_mfma_f32_16x16x32_bf16 v[64:67], v[120:123], v[24:27], v[64:67]
  ds_read_b64_tr_b16 v[40:41], v10 offset:4096
  v_mfma_f32_16x16x32_bf16 v[68:71], v[124:127], v[24:27], v[68:71]
  ds_read_b64_tr_b16 v[42:43], v10 offset:4608
  v_add_u32 v10, s42, v10
  s_waitcnt lgkmcnt(6)
  v_mfma_f32_16x16x32_bf16 v[72:75], v[120:123], v[28:31], v[72:75]
  ds_read_b64_tr_b16 v[44:45], v11 offset:4096
  buffer_load_dwordx4 v[180:183], v14, s[8:11], s36 offen offset:3072 sc1
  v_mfma_f32_16x16x32_bf16 v[76:79], v[124:127], v[28:31], v[76:79]
  ds_read_b64_tr_b16 v[46:47], v11 offset:4608
  v_add_u32 v11, s42, v11
  s_barrier
  s_waitcnt vmcnt(13) lgkmcnt(6)
  v_mfma_f32_16x16x32_bf16 v[48:51], v[128:131], v[32:35], v[48:51]
  ds_read_b64_tr_b16 v[16:17], v8 offset:0
  s_add_u32 s40, s43, 8192
  s_cmp_eq_u32 s40, 65536
  s_waitcnt vmcnt(12)
  v_mfma_f32_16x16x32_bf16 v[52:55], v[132:135], v[32:35], v[52:55]
  ds_read_b64_tr_b16 v[18:19], v8 offset:512
  s_cselect_b32 s40, 0, s40
  s_sub_u32 s42, s40, s43
  s_waitcnt lgkmcnt(6)
  v_mfma_f32_16x16x32_bf16 v[56:59], v[128:131], v[36:39], v[56:59]
  ds_read_b64_tr_b16 v[20:21], v9 offset:0
  s_mov_b32 s43, s40
  v_mfma_f32_16x16x32_bf16 v[60:63], v[132:135], v[36:39], v[60:63]
  ds_read_b64_tr_b16 v[22:23], v9 offset:512
  s_waitcnt lgkmcnt(6)
  v_mfma_f32_16x16x32_bf16 v[64:67], v[128:131], v[40:43], v[64:67]
  ds_read_b64_tr_b16 v[24:25], v10 offset:0
  v_mfma_f32_16x16x32_bf16 v[68:71], v[132:135], v[40:43], v[68:71]
  ds_read_b64_tr_b16 v[26:27], v10 offset:512
  s_waitcnt lgkmcnt(6)
  v_mfma_f32_16x16x32_bf16 v[72:75], v[128:131], v[44:47], v[72:75]
  ds_read_b64_tr_b16 v[28:29], v11 offset:0
  v_mfma_f32_16x16x32_bf16 v[76:79], v[132:135], v[44:47], v[76:79]
  ds_read_b64_tr_b16 v[30:31], v11 offset:512
  s_waitcnt vmcnt(11) lgkmcnt(6)
  v_mfma_f32_16x16x32_bf16 v[48:51], v[136:139], v[16:19], v[48:51]
  ds_read_b64_tr_b16 v[32:33], v8 offset:4096
  s_waitcnt vmcnt(10)
  v_mfma_f32_16x16x32_bf16 v[52:55], v[140:143], v[16:19], v[52:55]
  ds_read_b64_tr_b16 v[34:35], v8 offset:4608
  v_add_u32 v8, s42, v8
  s_waitcnt lgkmcnt(6)
  v_mfma_f32_16x16x32_bf16 v[56:59], v[136:139], v[20:23], v[56:59]
  ds_read_b64_tr_b16 v[36:37], v9 offset:4096
  v_mfma_f32_16x16x32_bf16 v[60:63], v[140:143], v[20:23], v[60:63]
  ds_read_b64_tr_b16 v[38:39], v9 offset:4608
  v_add_u32 v9, s42, v9
  s_waitcnt lgkmcnt(6)
  v_mfma_f32_16x16x32_bf16 v[64:67], v[136:139], v[24:27], v[64:67]
  ds_read_b64_tr_b16 v[40:41], v10 offset:4096
  v_mfma_f32_16x16x32_bf16 v[68:71], v[140:143], v[24:27], v[68:71]
  ds_read_b64_tr_b16 v[42:43], v10 offset:4608
  v_add_u32 v10, s42, v10
  s_waitcnt lgkmcnt(6)
  v_mfma_f32_16x16x32_bf16 v[72:75], v[136:139], v[28:31], v[72:75]
  ds_read_b64_tr_b16 v[44:45], v11 offset:4096
  v_mfma_f32_16x16x32_bf16 v[76:79], v[140:143], v[28:31], v[76:79]
  ds_read_b64_tr_b16 v[46:47], v11 offset:4608
  v_add_u32 v11, s42, v11
  s_barrier
  s_waitcnt vmcnt(9) lgkmcnt(6)
  v_mfma_f32_16x16x32_bf16 v[48:51], v[144:147], v[32:35], v[48:51]
  ds_read_b64_tr_b16 v[16:17], v8 offset:0
  s_add_u32 s40, s43, 8192
  s_cmp_eq_u32 s40, 65536
  s_waitcnt vmcnt(8)
  v_mfma_f32_16x16x32_bf16 v[52:55], v[148:151], v[32:35], v[52:55]
  ds_read_b64_tr_b16 v[18:19], v8 offset:512
  s_cselect_b32 s40, 0, s40
  s_sub_u32 s42, s40, s43
  s_waitcnt lgkmcnt(6)
  v_mfma_f32_16x16x32_bf16 v[56:59], v[144:147], v[36:39], v[56:59]
  ds_read_b64_tr_b16 v[20:21], v9 offset:0
  s_mov_b32 s43, s40
  v_mfma_f32_16x16x32_bf16 v[60:63], v[148:151], v[36:39], v[60:63]
  ds_read_b64_tr_b16 v[22:23], v9 offset:512
  s_waitcnt lgkmcnt(6)
  v_mfma_f32_16x16x32_bf16 v[64:67], v[144:147], v[40:43], v[64:67]
  ds_read_b64_tr_b16 v[24:25], v10 offset:0
  v_mfma_f32_16x16x32_bf16 v[68:71], v[148:151], v[40:43], v[68:71]
  ds_read_b64_tr_b16 v[26:27], v10 offset:512
  s_waitcnt lgkmcnt(6)
  v_mfma_f32_16x16x32_bf16 v[72:75], v[144:147], v[44:47], v[72:75]
  ds_read_b64_tr_b16 v[28:29], v11 offset:0
  v_mfma_f32_16x16x32_bf16 v[76:79], v[148:151], v[44:47], v[76:79]
  ds_read_b64_tr_b16 v[30:31], v11 offset:512
  s_waitcnt vmcnt(7) lgkmcnt(6)
  v_mfma_f32_16x16x32_bf16 v[48:51], v[152:155], v[16:19], v[48:51]
  ds_read_b64_tr_b16 v[32:33], v8 offset:4096
  s_waitcnt vmcnt(6)
  v_mfma_f32_16x16x32_bf16 v[52:55], v[156:159], v[16:19], v[52:55]
  ds_read_b64_tr_b16 v[34:35], v8 offset:4608
  v_add_u32 v8, s42, v8
  s_waitcnt lgkmcnt(6)
  v_mfma_f32_16x16x32_bf16 v[56:59], v[152:155], v[20:23], v[56:59]
  ds_read_b64_tr_b16 v[36:37], v9 offset:4096
  v_mfma_f32_16x16x32_bf16 v[60:63], v[156:159], v[20:23], v[60:63]
  ds_read_b64_tr_b16 v[38:39], v9 offset:4608
  v_add_u32 v9, s42, v9
  s_waitcnt lgkmcnt(6)
  v_mfma_f32_16x16x32_bf16 v[64:67], v[152:155], v[24:27], v[64:67]
  ds_read_b64_tr_b16 v[40:41], v10 offset:4096
  v_mfma_f32_16x16x32_bf16 v[68:71], v[156:159], v[24:27], v[68:71]
  ds_read_b64_tr_b16 v[42:43], v10 offset:4608
  v_add_u32 v10, s42, v10
  s_waitcnt lgkmcnt(6)
  v_mfma_f32_16x16x32_bf16 v[72:75], v[152:155], v[28:31], v[72:75]
  ds_read_b64_tr_b16 v[44:45], v11 offset:4096
  v_mfma_f32_16x16x32_bf16 v[76:79], v[156:159], v[28:31], v[76:79]
  ds_read_b64_tr_b16 v[46:47], v11 offset:4608
  v_add_u32 v11, s42, v11
  s_barrier
  s_waitcnt vmcnt(5) lgkmcnt(6)
  v_mfma_f32_16x16x32_bf16 v[48:51], v[160:163], v[32:35], v[48:51]
  ds_read_b64_tr_b16 v[16:17], v8 offset:0
  s_add_u32 s40, s43, 8192
  s_cmp_eq_u32 s40, 65536
  s_waitcnt vmcnt(4)
  v_mfma_f32_16x16x32_bf16 v[52:55], v[164:167], v[32:35], v[52:55]
  ds_read_b64_tr_b16 v[18:19], v8 offset:512
  s_cselect_b32 s40, 0, s40
  s_sub_u32 s42, s40, s43
  s_waitcnt lgkmcnt(6)
  v_mfma_f32_16x16x32_bf16 v[56:59], v[160:163], v[36:39], v[56:59]
  ds_read_b64_tr_b16 v[20:21], v9 offset:0
  s_mov_b32 s43, s40
  v_mfma_f32_16x16x32_bf16 v[60:63], v[164:167], v[36:39], v[60:63]
  ds_read_b64_tr_b16 v[22:23], v9 offset:512
  s_waitcnt lgkmcnt(6)
  v_mfma_f32_16x16x32_bf16 v[64:67], v[160:163], v[40:43], v[64:67]
  ds_read_b64_tr_b16 v[24:25], v10 offset:0
  v_mfma_f32_16x16x32_bf16 v[68:71], v[164:167], v[40:43], v[68:71]
  ds_read_b64_tr_b16 v[26:27], v10 offset:512
  s_waitcnt lgkmcnt(6)
  v_mfma_f32_16x16x32_bf16 v[72:75], v[160:163], v[44:47], v[72:75]
  ds_read_b64_tr_b16 v[28:29], v11 offset:0
  v_mfma_f32_16x16x32_bf16 v[76:79], v[164:167], v[44:47], v[76:79]
  ds_read_b64_tr_b16 v[30:31], v11 offset:512
  s_waitcnt vmcnt(3) lgkmcnt(6)
  v_mfma_f32_16x16x32_bf16 v[48:51], v[168:171], v[16:19], v[48:51]
  ds_read_b64_tr_b16 v[32:33], v8 offset:4096
  s_waitcnt vmcnt(2)
  v_mfma_f32_16x16x32_bf16 v[52:55], v[172:175], v[16:19], v[52:55]
  ds_read_b64_tr_b16 v[34:35], v8 offset:4608
  s_waitcnt lgkmcnt(6)
  v_mfma_f32_16x16x32_bf16 v[56:59], v[168:171], v[20:23], v[56:59]
  ds_read_b64_tr_b16 v[36:37], v9 offset:4096
  v_mfma_f32_16x16x32_bf16 v[60:63], v[172:175], v[20:23], v[60:63]
  ds_read_b64_tr_b16 v[38:39], v9 offset:4608
  s_waitcnt lgkmcnt(6)
  v_mfma_f32_16x16x32_bf16 v[64:67], v[168:171], v[24:27], v[64:67]
  ds_read_b64_tr_b16 v[40:41], v10 offset:4096
  v_mfma_f32_16x16x32_bf16 v[68:71], v[172:175], v[24:27], v[68:71]
  ds_read_b64_tr_b16 v[42:43], v10 offset:4608
  s_waitcnt lgkmcnt(6)
  v_mfma_f32_16x16x32_bf16 v[72:75], v[168:171], v[28:31], v[72:75]
  ds_read_b64_tr_b16 v[44:45], v11 offset:4096
  v_mfma_f32_16x16x32_bf16 v[76:79], v[172:175], v[28:31], v[76:79]
  ds_read_b64_tr_b16 v[46:47], v11 offset:4608
  s_waitcnt vmcnt(1) lgkmcnt(6)
  v_mfma_f32_16x16x32_bf16 v[48:51], v[176:179], v[32:35], v[48:51]
  s_waitcnt vmcnt(0)
  v_mfma_f32_16x16x32_bf16 v[52:55], v[180:183], v[32:35], v[52:55]
  s_waitcnt lgkmcnt(4)
  v_mfma_f32_16x16x32_bf16 v[56:59], v[176:179], v[36:39], v[56:59]
  v_mfma_f32_16x16x32_bf16 v[60:63], v[180:183], v[36:39], v[60:63]
  s_waitcnt lgkmcnt(2)
  v_mfma_f32_16x16x32_bf16 v[64:67], v[176:179], v[40:43], v[64:67]
  v_mfma_f32_16x16x32_bf16 v[68:71], v[180:183], v[40:43], v[68:71]
  s_waitcnt lgkmcnt(0)
  v_mfma_f32_16x16x32_bf16 v[72:75], v[176:179], v[44:47], v[72:75]
  v_mfma_f32_16x16x32_bf16 v[76:79], v[180:183], v[44:47], v[76:79]
  s_waitcnt lgkmcnt(0)
  v_cvt_pk_bf16_f32 v96, v48, v49
  v_cvt_pk_bf16_f32 v97, v50, v51
  v_cvt_pk_bf16_f32 v98, v52, v53
  v_cvt_pk_bf16_f32 v99, v54, v55
  buffer_store_dwordx4 v[96:99], v12, s[24:27], 0 offen sc0 sc1
  v_cvt_pk_bf16_f32 v100, v56, v57
  v_cvt_pk_bf16_f32 v101, v58, v59
  v_cvt_pk_bf16_f32 v102, v60, v61
  v_cvt_pk_bf16_f32 v103, v62, v63
  buffer_store_dwordx4 v[100:103], v12, s[24:27], s45 offen sc0 sc1
  v_cvt_pk_bf16_f32 v104, v64, v65
  v_cvt_pk_bf16_f32 v105, v66, v67
  v_cvt_pk_bf16_f32 v106, v68, v69
  v_cvt_pk_bf16_f32 v107, v70, v71
  buffer_store_dwordx4 v[104:107], v12, s[24:27], s46 offen sc0 sc1
  v_cvt_pk_bf16_f32 v108, v72, v73
  v_cvt_pk_bf16_f32 v109, v74, v75
  v_cvt_pk_bf16_f32 v110, v76, v77
  v_cvt_pk_bf16_f32 v111, v78, v79
  buffer_store_dwordx4 v[108:111], v12, s[24:27], s47 offen sc0 sc1
  s_cmp_lg_u32 s3, 0
  s_cbranch_scc1 C_end
  v_lshlrev_b32 v48, 16, v96
  v_and_b32 v49, 0xffff0000, v96
  v_lshlrev_b32 v50, 16, v97
  v_and_b32 v51, 0xffff0000, v97
  v_lshlrev_b32 v52, 16, v98
  v_and_b32 v53, 0xffff0000, v98
  v_lshlrev_b32 v54, 16, v99
  v_and_b32 v55, 0xffff0000, v99
  v_lshlrev_b32 v56, 16, v100
  v_and_b32 v57, 0xffff0000, v100
  v_lshlrev_b32 v58, 16, v101
  v_and_b32 v59, 0xffff0000, v101
  v_lshlrev_b32 v60, 16, v102
  v_and_b32 v61, 0xffff0000, v102
  v_lshlrev_b32 v62, 16, v103
  v_and_b32 v63, 0xffff0000, v103
  v_lshlrev_b32 v64, 16, v104
  v_and_b32 v65, 0xffff0000, v104
  v_lshlrev_b32 v66, 16, v105
  v_and_b32 v67, 0xffff0000, v105
  v_lshlrev_b32 v68, 16, v106
  v_and_b32 v69, 0xffff0000, v106
  v_lshlrev_b32 v70, 16, v107
  v_and_b32 v71, 0xffff0000, v107
  v_lshlrev_b32 v72, 16, v108
  v_and_b32 v73, 0xffff0000, v108
  v_lshlrev_b32 v74, 16, v109
  v_and_b32 v75, 0xffff0000, v109
  v_lshlrev_b32 v76, 16, v110
  v_and_b32 v77, 0xffff0000, v110
  v_lshlrev_b32 v78, 16, v111
  v_and_b32 v79, 0xffff0000, v111
  v_pk_add_f32 v[16:17], v[48:49], v[50:51]
  v_pk_mul_f32 v[18:19], v[48:49], v[48:49]
  v_pk_fma_f32 v[18:19], v[50:51], v[50:51], v[18:19]
  v_pk_add_f32 v[16:17], v[16:17], v[52:53]
  v_pk_fma_f32 v[18:19], v[52:53], v[52:53], v[18:19]
  v_pk_add_f32 v[16:17], v[16:17], v[54:55]
  v_pk_fma_f32 v[18:19], v[54:55], v[54:55], v[18:19]
  v_add_f32 v32, v16, v17
  v_add_f32 v36, v18, v19
  v_pk_add_f32 v[20:21], v[56:57], v[58:59]
  v_pk_mul_f32 v[22:23], v[56:57], v[56:57]
  v_pk_fma_f32 v[22:23], v[58:59], v[58:59], v[22:23]
  v_pk_add_f32 v[20:21], v[20:21], v[60:61]
  v_pk_fma_f32 v[22:23], v[60:61], v[60:61], v[22:23]
  v_pk_add_f32 v[20:21], v[20:21], v[62:63]
  v_pk_fma_f32 v[22:23], v[62:63], v[62:63], v[22:23]
  v_add_f32 v33, v20, v21
  v_add_f32 v37, v22, v23
  v_pk_add_f32 v[24:25], v[64:65], v[66:67]
  v_pk_mul_f32 v[26:27], v[64:65], v[64:65]
  v_pk_fma_f32 v[26:27], v[66:67], v[66:67], v[26:27]
  v_pk_add_f32 v[24:25], v[24:25], v[68:69]
  v_pk_fma_f32 v[26:27], v[68:69], v[68:69], v[26:27]
  v_pk_add_f32 v[24:25], v[24:25], v[70:71]
  v_pk_fma_f32 v[26:27], v[70:71], v[70:71], v[26:27]
  v_add_f32 v34, v24, v25
  v_add_f32 v38, v26, v27
  v_pk_add_f32 v[28:29], v[72:73], v[74:75]
  v_pk_mul_f32 v[30:31], v[72:73], v[72:73]
  v_pk_fma_f32 v[30:31], v[74:75], v[74:75], v[30:31]
  v_pk_add_f32 v[28:29], v[28:29], v[76:77]
  v_pk_fma_f32 v[30:31], v[76:77], v[76:77], v[30:31]
  v_pk_add_f32 v[28:29], v[28:29], v[78:79]
  v_pk_fma_f32 v[30:31], v[78:79], v[78:79], v[30:31]
  v_add_f32 v35, v28, v29
  v_add_f32 v39, v30, v31
  v_permlane16_swap_b32 v32, v33
  v_permlane16_swap_b32 v34, v35
  v_permlane16_swap_b32 v36, v37
  v_permlane16_swap_b32 v38, v39
  v_add_f32 v32, v32, v33
  v_add_f32 v34, v34, v35
  v_add_f32 v36, v36, v37
  v_add_f32 v38, v38, v39
  v_permlane32_swap_b32 v32, v34
  s_nop 0
  v_permlane32_swap_b32 v36, v38
  v_add_f32 v40, v32, v34
  v_add_f32 v41, v36, v38
  v_lshlrev_b32 v42, 3, v0
  s_lshl_b32 s32, s4, 9
  s_add_u32 s32, s32, 90112
  v_add_u32 v43, s32, v42
  ds_write_b64 v43, v[40:41]
  s_waitcnt lgkmcnt(0)
  s_barrier
  s_cmp_lg_u32 s4, 0
  s_cbranch_scc1 C_nost
  ds_read_b64 v[44:45], v43 offset:512
  ds_read_b64 v[46:47], v43 offset:1024
  ds_read_b64 v[48:49], v43 offset:1536
  s_lshl_b32 s32, s28, 14
  s_lshl_b32 s40, s29, 9
  s_add_u32 s32, s32, s40
  s_waitcnt lgkmcnt(0)
  v_pk_add_f32 v[40:41], v[40:41], v[44:45]
  v_pk_add_f32 v[46:47], v[46:47], v[48:49]
  v_pk_add_f32 v[40:41], v[40:41], v[46:47]
  buffer_store_dwordx2 v[40:41], v42, s[12:15], s32 offen sc0 sc1
C_nost:
  s_nop 1
  s_lshr_b32 s32, s2, 3
  s_lshr_b32 s5, s32, 3
  s_and_b32 s6, s32, 7
  s_lshl_b32 s7, s5, 1
  s_add_u32 s7, s7, s6
  s_and_b32 s7, s7, 7
  s_and_b32 s32, s2, 7
  s_lshr_b32 s28, s32, 1
  s_lshl_b32 s28, s28, 2
  s_add_u32 s28, s28, s5
  s_and_b32 s29, s32, 1
  s_mul_i32 s29, s29, 8
  s_add_u32 s29, s29, s6
  s_mov_b32 s30, 7
  s_mov_b32 s31, -1
  v_and_b32 v4, 15, v0
  v_lshrrev_b32 v5, 4, v0
  v_lshrrev_b32 v6, 2, v4
  v_and_b32 v7, 3, v0
  v_lshrrev_b32 v3, 5, v0
  v_and_b32 v2, 1, v5
  v_lshl_or_b32 v3, v2, 1, v3
  v_lshl_add_u32 v21, v5, 3, v6
  v_lshlrev_b32 v21, 7, v21
  v_lshl_add_u32 v21, v7, 3, v21
  v_lshrrev_b32 v22, 1, v6
  v_lshl_or_b32 v22, v2, 1, v22
  v_lshl_add_u32 v21, v22, 5, v21
  v_add_u32 v21, 18432, v21
  v_xor_b32 v8, 0, v21
  s_lshl_b32 s32, s4, 5
  v_xor_b32 v8, s32, v8
  v_lshrrev_b32 v21, 1, v4
  v_xor_b32 v21, v21, v5
  v_lshlrev_b32 v21, 4, v21
  v_lshlrev_b32 v22, 7, v4
  v_add_u32 v9, v21, v22
  v_xor_b32 v10, 64, v9
  v_and_b32 v21, 1, v4
  v_mul_u32_u24 v21, 28800, v21
  v_lshrrev_b32 v22, 1, v4
  v_mul_u32_u24 v22, 400, v22
  v_lshlrev_b32 v23, 3, v5
  v_add3_u32 v11, v21, v22, v23
  s_add_u32 s32, s32, 43008
  v_add_u32 v11, s32, v11
  v_lshlrev_b32 v12, 3, v4
  v_add_u32 v12, 129024, v12
  v_mov_b64 v[112:113], 0
  v_mov_b64 v[114:115], 0
  v_mov_b64 v[116:117], 0
  v_mov_b64 v[118:119], 0
  v_mov_b64 v[120:121], 0
  v_mov_b64 v[122:123], 0
  v_mov_b64 v[124:125], 0
  v_mov_b64 v[126:127], 0
  v_mov_b64 v[128:129], 0
  v_mov_b64 v[130:131], 0
  v_mov_b64 v[132:133], 0
  v_mov_b64 v[134:135], 0
  v_mov_b64 v[136:137], 0
  v_mov_b64 v[138:139], 0
  v_mov_b64 v[140:141], 0
  v_mov_b64 v[142:143], 0
  v_mov_b64 v[144:145], 0
  v_mov_b64 v[146:147], 0
  v_mov_b64 v[148:149], 0
  v_mov_b64 v[150:151], 0
  v_mov_b64 v[152:153], 0
  v_mov_b64 v[154:155], 0
  v_mov_b64 v[156:157], 0
  v_mov_b64 v[158:159], 0
  v_mov_b64 v[160:161], 0
  v_mov_b64 v[162:163], 0
  v_mov_b64 v[164:165], 0
  v_mov_b64 v[166:167], 0
  v_mov_b64 v[168:169], 0
  v_mov_b64 v[170:171], 0
  v_mov_b64 v[172:173], 0
  v_mov_b64 v[174:175], 0
  v_mov_b64 v[176:177], 0
  v_mov_b64 v[178:179], 0
  v_mov_b64 v[180:181], 0
  v_mov_b64 v[182:183], 0
  v_mov_b64 v[184:185], 0
  v_mov_b64 v[186:187], 0
  v_mov_b64 v[188:189], 0
  v_mov_b64 v[190:191], 0
  v_mov_b64 v[192:193], 0
  v_mov_b64 v[194:195], 0
  v_mov_b64 v[196:197], 0
  v_mov_b64 v[198:199], 0
  v_mov_b64 v[200:201], 0
  v_mov_b64 v[202:203], 0
  v_mov_b64 v[204:205], 0
  v_mov_b64 v[206:207], 0
  v_mov_b64 v[208:209], 0
  v_mov_b64 v[210:211], 0
  v_mov_b64 v[212:213], 0
  v_mov_b64 v[214:215], 0
  v_mov_b64 v[216:217], 0
  v_mov_b64 v[218:219], 0
  s_waitcnt vmcnt(0)
  s_barrier
  s_mov_b32 s3, 1
  s_add_u32 s82, s84, 33554432
  s_addc_u32 s83, s85, 0
  s_branch C_top
C_end:
  s_endpgm
L_start:
  s_nop 7
  s_nop 7
  s_sub_u32 s57, s4, 4
  s_lshr_b32 s32, s2, 3
  s_lshr_b32 s5, s32, 3
  s_and_b32 s6, s32, 7
  s_lshl_b32 s7, s5, 1
  s_add_u32 s7, s7, s6
  s_and_b32 s7, s7, 7
  s_and_b32 s32, s2, 7
  s_lshr_b32 s28, s32, 1
  s_lshl_b32 s28, s28, 2
  s_add_u32 s28, s28, s5
  s_and_b32 s29, s32, 1
  s_mul_i32 s29, s29, 8
  s_add_u32 s29, s29, s6
  s_mov_b32 s30, 7
  s_mov_b32 s31, -1
  s_mov_b32 s41, s57
  s_mul_i32 s32, s41, 16
  s_add_u32 s32, s32, 0
  v_lshrrev_b32 v2, 3, v0
  v_add_u32 v2, s32, v2
  v_bfe_u32 v3, v2, 1, 1
  v_bfe_u32 v4, v2, 3, 1
  v_lshl_or_b32 v3, v4, 1, v3
  v_lshlrev_b32 v3, 1, v3
  v_and_b32 v4, 7, v0
  v_xor_b32 v3, v3, v4
  v_lshlrev_b32 v3, 4, v3
  s_mov_b32 s32, 6144
  v_mul_lo_u32 v2, v2, s32
  v_add_u32 v13, v2, v3
  s_mul_i32 s32, s41, 16
  s_add_u32 s32, s32, 8
  v_lshrrev_b32 v2, 3, v0
  v_add_u32 v2, s32, v2
  v_bfe_u32 v3, v2, 1, 1
  v_bfe_u32 v4, v2, 3, 1
  v_lshl_or_b32 v3, v4, 1, v3
  v_lshlrev_b32 v3, 1, v3
  v_and_b32 v4, 7, v0
  v_xor_b32 v3, v3, v4
  v_lshlrev_b32 v3, 4, v3
  s_mov_b32 s32, 6144
  v_mul_lo_u32 v2, v2, s32
  v_add_u32 v14, v2, v3
  v_subrev_u32 v14, 1024, v14
  v_add_u32 v15, 2048, v13
  v_add_u32 v16, 2048, v14
  v_add_u32 v17, 4096, v13
  v_add_u32 v18, 4096, v14
  s_lshl_b32 s46, s41, 11
  s_add_u32 s46, s46, 18432
  s_add_u32 s47, s46, 8192
  s_add_u32 s48, s46, 16384
  s_lshl_b32 s35, s29, 7
  s_waitcnt lgkmcnt(0)
  s_mov_b32 s12, s66
  s_mov_b32 s13, s67
  s_mov_b32 s14, 6291456
  s_mov_b32 s15, 0x20000
  s_mov_b32 s30, 7
  s_mov_b32 s31, -1
  s_mov_b32 s38, 0
  s_add_u32 s30, s30, 1
  s_and_b32 s30, s30, 7
  s_cselect_b32 s32, 0, 1
  s_add_u32 s31, s31, s32
  s_sub_u32 s32, s30, s7
  s_and_b32 s32, s32, 7
  s_cmp_lt_u32 s32, 2
  s_cselect_b32 s32, 1, 0
  s_add_u32 s32, s32, s31
  s_cmp_ge_u32 s32, 2
  s_cselect_b32 s32, 0, s32
  s_lshl_b32 s33, s32, 3
  s_add_u32 s33, s33, s30
  s_mul_i32 s37, s33, 393216
  s_add_u32 s37, s37, s35
  s_add_u32 m0, s38, s46
  s_nop 0
  buffer_load_dwordx4 v13, s[12:15], s37 offen offset:0  lds
  buffer_load_dwordx4 v14, s[12:15], s37 offen offset:1024  lds
  s_add_u32 m0, s38, s47
  s_nop 0
  buffer_load_dwordx4 v15, s[12:15], s37 offen offset:0  lds
  buffer_load_dwordx4 v16, s[12:15], s37 offen offset:1024  lds
  s_add_u32 m0, s38, s48
  s_nop 0
  buffer_load_dwordx4 v17, s[12:15], s37 offen offset:0  lds
  buffer_load_dwordx4 v18, s[12:15], s37 offen offset:1024  lds
  s_add_u32 s38, s38, 43008
  s_cmp_eq_u32 s38, 129024
  s_cselect_b32 s38, 0, s38
  s_add_u32 s30, s30, 1
  s_and_b32 s30, s30, 7
  s_cselect_b32 s32, 0, 1
  s_add_u32 s31, s31, s32
  s_sub_u32 s32, s30, s7
  s_and_b32 s32, s32, 7
  s_cmp_lt_u32 s32, 2
  s_cselect_b32 s32, 1, 0
  s_add_u32 s32, s32, s31
  s_cmp_ge_u32 s32, 2
  s_cselect_b32 s32, 0, s32
  s_lshl_b32 s33, s32, 3
  s_add_u32 s33, s33, s30
  s_mul_i32 s37, s33, 393216
  s_add_u32 s37, s37, s35
  s_add_u32 m0, s38, s46
  s_nop 0
  buffer_load_dwordx4 v13, s[12:15], s37 offen offset:0  lds
  buffer_load_dwordx4 v14, s[12:15], s37 offen offset:1024  lds
  s_add_u32 m0, s38, s47
  s_nop 0
  buffer_load_dwordx4 v15, s[12:15], s37 offen offset:0  lds
  buffer_load_dwordx4 v16, s[12:15], s37 offen offset:1024  lds
  s_add_u32 m0, s38, s48
  s_nop 0
  buffer_load_dwordx4 v17, s[12:15], s37 offen offset:0  lds
  buffer_load_dwordx4 v18, s[12:15], s37 offen offset:1024  lds
  s_add_u32 s38, s38, 43008
  s_cmp_eq_u32 s38, 129024
  s_cselect_b32 s38, 0, s38
  s_lshl_b32 s40, s28, 7
  s_sub_u32 s40, s40, 16
  s_lshl_b32 s32, s41, 5
  s_add_u32 s32, s32, 16
  v_lshrrev_b32 v2, 3, v0
  v_add_u32 v2, s32, v2
  v_bfe_u32 v3, v2, 1, 3
  v_and_b32 v4, 7, v0
  v_xor_b32 v3, v3, v4
  v_lshlrev_b32 v3, 4, v3
  v_add_u32 v2, s40, v2
  v_max_i32 v2, 0, v2
  v_lshlrev_b32 v2, 11, v2
  v_add_u32 v8, v2, v3
  v_add_u32 v10, 30720, v8
  s_lshl_b32 s32, s41, 5
  s_add_u32 s32, s32, 24
  v_lshrrev_b32 v2, 3, v0
  v_add_u32 v2, s32, v2
  v_bfe_u32 v3, v2, 1, 3
  v_and_b32 v4, 7, v0
  v_xor_b32 v3, v3, v4
  v_lshlrev_b32 v3, 4, v3
  v_add_u32 v2, s40, v2
  v_max_i32 v2, 0, v2
  v_lshlrev_b32 v2, 11, v2
  v_add_u32 v9, v2, v3
  v_subrev_u32 v9, 1024, v9
  v_add_u32 v11, 30720, v9
  s_lshl_b32 s32, s41, 3
  v_lshrrev_b32 v2, 3, v0
  v_add_u32 v2, s32, v2
  v_bfe_u32 v3, v2, 1, 3
  v_and_b32 v4, 7, v0
  v_xor_b32 v3, v3, v4
  v_lshlrev_b32 v3, 4, v3
  v_add_u32 v2, s40, v2
  v_max_i32 v2, 0, v2
  v_lshlrev_b32 v2, 11, v2
  v_add_u32 v12, v2, v3
  s_lshl_b32 s44, s41, 12
  s_add_u32 s44, s44, 2048
  s_lshl_b32 s45, s41, 10
  s_mov_b32 s34, 0
  s_cmp_eq_u32 s41, 0
  s_cselect_b32 s52, 0xffffff00, -1
  s_mov_b32 s53, -1
  v_mov_b32 v20, 0x3f803f80
  v_mov_b32 v21, v20
  v_mov_b32 v22, v20
  v_mov_b32 v23, v20
  v_lshlrev_b32 v24, 4, v0
  v_add_u32 v25, 86016, v24
  s_mov_b64 exec, 0xff
  ds_write_b128 v24, v[20:23]
  ds_write_b128 v24, v[20:23] offset:43008
  ds_write_b128 v25, v[20:23]
  s_mov_b64 exec, -1
  s_mov_b32 s8, s64
  s_mov_b32 s9, s65
  s_mov_b32 s10, 4194304
  s_mov_b32 s11, 0x20000
  s_add_u32 s20, s84, 22020096
  s_addc_u32 s21, s85, 0
  s_mov_b32 s22, 131072
  s_mov_b32 s23, 0x20000
  s_lshl_b32 s32, s41, 6
  v_add_u32 v26, s32, v0
  v_min_u32 v26, 143, v26
  v_add_u32 v27, s40, v26
  v_max_i32 v27, 0, v27
  v_lshlrev_b32 v27, 3, v27
  v_lshlrev_b32 v26, 3, v26
  v_add_u32 v26, 129024, v26
  s_waitcnt lgkmcnt(0)
  s_mov_b32 s82, s84
  s_mov_b32 s83, s85
L_top:
  s_nop 7
  s_nop 7
  s_lshl_b32 s56, s3, 10
  s_mul_i32 s32, s28, 16
  s_add_u32 s56, s56, s32
  s_add_u32 s56, s56, s29
  s_add_u32 s56, s56, 0
  s_lshl_b32 s56, s56, 7
  s_mov_b32 s24, s72
  s_mov_b32 s25, s73
  s_mov_b32 s26, 14680064
  s_mov_b32 s27, 0x20000
  s_lshl_b32 s54, s2, 2
  s_add_u32 s54, s54, s57
  s_mul_i32 s54, s54, 0
  s_add_u32 s54, s54, 0
  s_cmp_ge_u32 s57, 2
  s_cbranch_scc1 L_k1B
  s_mov_b32 s30, 7
  s_mov_b32 s31, -1
  s_mov_b32 s38, 0
  s_add_u32 s30, s30, 1
  s_and_b32 s30, s30, 7
  s_cselect_b32 s32, 0, 1
  s_add_u32 s31, s31, s32
  s_sub_u32 s32, s30, s7
  s_and_b32 s32, s32, 7
  s_cmp_lt_u32 s32, 2
  s_cselect_b32 s32, 1, 0
  s_add_u32 s32, s32, s31
  s_cmp_ge_u32 s32, 2
  s_cselect_b32 s32, 0, s32
  s_lshl_b32 s33, s32, 3
  s_add_u32 s33, s33, s30
  s_mul_i32 s36, s33, 128
  s_add_u32 s36, s36, s34
  s_add_u32 m0, s38, s45
  s_mov_b64 exec, s[52:53]
  buffer_load_dwordx4 v12, s[8:11], s36 offen offset:0 sc1 lds
  s_mov_b64 exec, -1
  s_add_u32 m0, s38, s44
  s_nop 0
  buffer_load_dwordx4 v8, s[8:11], s36 offen offset:0 sc1 lds
  buffer_load_dwordx4 v9, s[8:11], s36 offen offset:1024 sc1 lds
  buffer_load_dwordx4 v10, s[8:11], s36 offen offset:2048 sc1 lds
  buffer_load_dwordx4 v11, s[8:11], s36 offen offset:3072 sc1 lds
  s_add_u32 s38, s38, 43008
  s_cmp_eq_u32 s38, 129024
  s_cselect_b32 s38, 0, s38
  s_add_u32 s30, s30, 1
  s_and_b32 s30, s30, 7
  s_cselect_b32 s32, 0, 1
  s_add_u32 s31, s31, s32
  s_sub_u32 s32, s30, s7
  s_and_b32 s32, s32, 7
  s_cmp_lt_u32 s32, 2
  s_cselect_b32 s32, 1, 0
  s_add_u32 s32, s32, s31
  s_cmp_ge_u32 s32, 2
  s_cselect_b32 s32, 0, s32
  s_lshl_b32 s33, s32, 3
  s_add_u32 s33, s33, s30
  s_mul_i32 s36, s33, 128
  s_add_u32 s36, s36, s34
  s_add_u32 m0, s38, s45
  s_mov_b64 exec, s[52:53]
  buffer_load_dwordx4 v12, s[8:11], s36 offen offset:0 sc1 lds
  s_mov_b64 exec, -1
  s_add_u32 m0, s38, s44
  s_nop 0
  buffer_load_dwordx4 v8, s[8:11], s36 offen offset:0 sc1 lds
  buffer_load_dwordx4 v9, s[8:11], s36 offen offset:1024 sc1 lds
  buffer_load_dwordx4 v10, s[8:11], s36 offen offset:2048 sc1 lds
  buffer_load_dwordx4 v11, s[8:11], s36 offen offset:3072 sc1 lds
  s_add_u32 s38, s38, 43008
  s_cmp_eq_u32 s38, 129024
  s_cselect_b32 s38, 0, s38
  s_waitcnt vmcnt(5)
  s_barrier
  s_add_u32 s30, s30, 1
  s_and_b32 s30, s30, 7
  s_cselect_b32 s32, 0, 1
  s_add_u32 s31, s31, s32
  s_sub_u32 s32, s30, s7
  s_and_b32 s32, s32, 7
  s_cmp_lt_u32 s32, 2
  s_cselect_b32 s32, 1, 0
  s_add_u32 s32, s32, s31
  s_cmp_ge_u32 s32, 2
  s_cselect_b32 s32, 0, s32
  s_lshl_b32 s33, s32, 3
  s_add_u32 s33, s33, s30
  s_mul_i32 s36, s33, 128
  s_add_u32 s36, s36, s34
  s_mul_i32 s37, s33, 393216
  s_add_u32 s37, s37, s35
  s_add_u32 m0, s38, s45
  s_mov_b64 exec, s[52:53]
  buffer_load_dwordx4 v12, s[8:11], s36 offen offset:0 sc1 lds
  s_mov_b64 exec, -1
  s_add_u32 m0, s38, s44
  s_nop 0
  buffer_load_dwordx4 v8, s[8:11], s36 offen offset:0 sc1 lds
  buffer_load_dwordx4 v9, s[8:11], s36 offen offset:1024 sc1 lds
  buffer_load_dwordx4 v10, s[8:11], s36 offen offset:2048 sc1 lds
  buffer_load_dwordx4 v11, s[8:11], s36 offen offset:3072 sc1 lds
  s_add_u32 m0, s38, s46
  s_nop 0
  buffer_load_dwordx4 v13, s[12:15], s37 offen offset:0  lds
  buffer_load_dwordx4 v14, s[12:15], s37 offen offset:1024  lds
  s_add_u32 m0, s38, s47
  s_nop 0
  buffer_load_dwordx4 v15, s[12:15], s37 offen offset:0  lds
  buffer_load_dwordx4 v16, s[12:15], s37 offen offset:1024  lds
  s_add_u32 m0, s38, s48
  s_nop 0
  buffer_load_dwordx4 v17, s[12:15], s37 offen offset:0  lds
  buffer_load_dwordx4 v18, s[12:15], s37 offen offset:1024  lds
  s_add_u32 s38, s38, 43008
  s_cmp_eq_u32 s38, 129024
  s_cselect_b32 s38, 0, s38
  s_mov_b32 s39, 13
ll6:
  s_waitcnt vmcnt(11)
  s_barrier
  s_add_u32 s30, s30, 1
  s_and_b32 s30, s30, 7
  s_cselect_b32 s32, 0, 1
  s_add_u32 s31, s31, s32
  s_sub_u32 s32, s30, s7
  s_and_b32 s32, s32, 7
  s_cmp_lt_u32 s32, 2
  s_cselect_b32 s32, 1, 0
  s_add_u32 s32, s32, s31
  s_cmp_ge_u32 s32, 2
  s_cselect_b32 s32, 0, s32
  s_lshl_b32 s33, s32, 3
  s_add_u32 s33, s33, s30
  s_mul_i32 s36, s33, 128
  s_add_u32 s36, s36, s34
  s_mul_i32 s37, s33, 393216
  s_add_u32 s37, s37, s35
  s_add_u32 m0, s38, s45
  s_mov_b64 exec, s[52:53]
  buffer_load_dwordx4 v12, s[8:11], s36 offen offset:0 sc1 lds
  s_mov_b64 exec, -1
  s_add_u32 m0, s38, s44
  s_nop 0
  buffer_load_dwordx4 v8, s[8:11], s36 offen offset:0 sc1 lds
  buffer_load_dwordx4 v9, s[8:11], s36 offen offset:1024 sc1 lds
  buffer_load_dwordx4 v10, s[8:11], s36 offen offset:2048 sc1 lds
  buffer_load_dwordx4 v11, s[8:11], s36 offen offset:3072 sc1 lds
  s_add_u32 m0, s38, s46
  s_nop 0
  buffer_load_dwordx4 v13, s[12:15], s37 offen offset:0  lds
  buffer_load_dwordx4 v14, s[12:15], s37 offen offset:1024  lds
  s_add_u32 m0, s38, s47
  s_nop 0
  buffer_load_dwordx4 v15, s[12:15], s37 offen offset:0  lds
  buffer_load_dwordx4 v16, s[12:15], s37 offen offset:1024  lds
  s_add_u32 m0, s38, s48
  s_nop 0
  buffer_load_dwordx4 v17, s[12:15], s37 offen offset:0  lds
  buffer_load_dwordx4 v18, s[12:15], s37 offen offset:1024  lds
  s_add_u32 s38, s38, 43008
  s_cmp_eq_u32 s38, 129024
  s_cselect_b32 s38, 0, s38
  s_sub_u32 s39, s39, 1
  s_cmp_lg_u32 s39, 0
  s_cbranch_scc1 ll6
  s_waitcnt vmcnt(11)
  s_barrier
  s_branch L_k1t
L_k1B:
  s_nop 7
  s_nop 7
  s_mov_b32 s30, 7
  s_mov_b32 s31, -1
  s_mov_b32 s38, 0
  s_add_u32 s30, s30, 1
  s_and_b32 s30, s30, 7
  s_cselect_b32 s32, 0, 1
  s_add_u32 s31, s31, s32
  s_sub_u32 s32, s30, s7
  s_and_b32 s32, s32, 7
  s_cmp_lt_u32 s32, 2
  s_cselect_b32 s32, 1, 0
  s_add_u32 s32, s32, s31
  s_cmp_ge_u32 s32, 2
  s_cselect_b32 s32, 0, s32
  s_lshl_b32 s33, s32, 3
  s_add_u32 s33, s33, s30
  s_mul_i32 s36, s33, 128
  s_add_u32 s36, s36, s34
  s_add_u32 m0, s38, s44
  s_nop 0
  buffer_load_dwordx4 v8, s[8:11], s36 offen offset:0 sc1 lds
  buffer_load_dwordx4 v9, s[8:11], s36 offen offset:1024 sc1 lds
  buffer_load_dwordx4 v10, s[8:11], s36 offen offset:2048 sc1 lds
  buffer_load_dwordx4 v11, s[8:11], s36 offen offset:3072 sc1 lds
  s_add_u32 s38, s38, 43008
  s_cmp_eq_u32 s38, 129024
  s_cselect_b32 s38, 0, s38
  s_add_u32 s30, s30, 1
  s_and_b32 s30, s30, 7
  s_cselect_b32 s32, 0, 1
  s_add_u32 s31, s31, s32
  s_sub_u32 s32, s30, s7
  s_and_b32 s32, s32, 7
  s_cmp_lt_u32 s32, 2
  s_cselect_b32 s32, 1, 0
  s_add_u32 s32, s32, s31
  s_cmp_ge_u32 s32, 2
  s_cselect_b32 s32, 0, s32
  s_lshl_b32 s33, s32, 3
  s_add_u32 s33, s33, s30
  s_mul_i32 s36, s33, 128
  s_add_u32 s36, s36, s34
  s_add_u32 m0, s38, s44
  s_nop 0
  buffer_load_dwordx4 v8, s[8:11], s36 offen offset:0 sc1 lds
  buffer_load_dwordx4 v9, s[8:11], s36 offen offset:1024 sc1 lds
  buffer_load_dwordx4 v10, s[8:11], s36 offen offset:2048 sc1 lds
  buffer_load_dwordx4 v11, s[8:11], s36 offen offset:3072 sc1 lds
  s_add_u32 s38, s38, 43008
  s_cmp_eq_u32 s38, 129024
  s_cselect_b32 s38, 0, s38
  s_waitcnt vmcnt(4)
  s_barrier
  s_add_u32 s30, s30, 1
  s_and_b32 s30, s30, 7
  s_cselect_b32 s32, 0, 1
  s_add_u32 s31, s31, s32
  s_sub_u32 s32, s30, s7
  s_and_b32 s32, s32, 7
  s_cmp_lt_u32 s32, 2
  s_cselect_b32 s32, 1, 0
  s_add_u32 s32, s32, s31
  s_cmp_ge_u32 s32, 2
  s_cselect_b32 s32, 0, s32
  s_lshl_b32 s33, s32, 3
  s_add_u32 s33, s33, s30
  s_mul_i32 s36, s33, 128
  s_add_u32 s36, s36, s34
  s_mul_i32 s37, s33, 393216
  s_add_u32 s37, s37, s35
  s_add_u32 m0, s38, s44
  s_nop 0
  buffer_load_dwordx4 v8, s[8:11], s36 offen offset:0 sc1 lds
  buffer_load_dwordx4 v9, s[8:11], s36 offen offset:1024 sc1 lds
  buffer_load_dwordx4 v10, s[8:11], s36 offen offset:2048 sc1 lds
  buffer_load_dwordx4 v11, s[8:11], s36 offen offset:3072 sc1 lds
  s_add_u32 m0, s38, s46
  s_nop 0
  buffer_load_dwordx4 v13, s[12:15], s37 offen offset:0  lds
  buffer_load_dwordx4 v14, s[12:15], s37 offen offset:1024  lds
  s_add_u32 m0, s38, s47
  s_nop 0
  buffer_load_dwordx4 v15, s[12:15], s37 offen offset:0  lds
  buffer_load_dwordx4 v16, s[12:15], s37 offen offset:1024  lds
  s_add_u32 m0, s38, s48
  s_nop 0
  buffer_load_dwordx4 v17, s[12:15], s37 offen offset:0  lds
  buffer_load_dwordx4 v18, s[12:15], s37 offen offset:1024  lds
  s_add_u32 s38, s38, 43008
  s_cmp_eq_u32 s38, 129024
  s_cselect_b32 s38, 0, s38
  s_mov_b32 s39, 13
ll7:
  s_waitcnt vmcnt(10)
  s_barrier
  s_add_u32 s30, s30, 1
  s_and_b32 s30, s30, 7
  s_cselect_b32 s32, 0, 1
  s_add_u32 s31, s31, s32
  s_sub_u32 s32, s30, s7
  s_and_b32 s32, s32, 7
  s_cmp_lt_u32 s32, 2
  s_cselect_b32 s32, 1, 0
  s_add_u32 s32, s32, s31
  s_cmp_ge_u32 s32, 2
  s_cselect_b32 s32, 0, s32
  s_lshl_b32 s33, s32, 3
  s_add_u32 s33, s33, s30
  s_mul_i32 s36, s33, 128
  s_add_u32 s36, s36, s34
  s_mul_i32 s37, s33, 393216
  s_add_u32 s37, s37, s35
  s_add_u32 m0, s38, s44
  s_nop 0
  buffer_load_dwordx4 v8, s[8:11], s36 offen offset:0 sc1 lds
  buffer_load_dwordx4 v9, s[8:11], s36 offen offset:1024 sc1 lds
  buffer_load_dwordx4 v10, s[8:11], s36 offen offset:2048 sc1 lds
  buffer_load_dwordx4 v11, s[8:11], s36 offen offset:3072 sc1 lds
  s_add_u32 m0, s38, s46
  s_nop 0
  buffer_load_dwordx4 v13, s[12:15], s37 offen offset:0  lds
  buffer_load_dwordx4 v14, s[12:15], s37 offen offset:1024  lds
  s_add_u32 m0, s38, s47
  s_nop 0
  buffer_load_dwordx4 v15, s[12:15], s37 offen offset:0  lds
  buffer_load_dwordx4 v16, s[12:15], s37 offen offset:1024  lds
  s_add_u32 m0, s38, s48
  s_nop 0
  buffer_load_dwordx4 v17, s[12:15], s37 offen offset:0  lds
  buffer_load_dwordx4 v18, s[12:15], s37 offen offset:1024  lds
  s_add_u32 s38, s38, 43008
  s_cmp_eq_u32 s38, 129024
  s_cselect_b32 s38, 0, s38
  s_sub_u32 s39, s39, 1
  s_cmp_lg_u32 s39, 0
  s_cbranch_scc1 ll7
  s_waitcnt vmcnt(10)
  s_barrier
L_k1t:
  s_nop 7
  s_nop 7
  buffer_load_dwordx2 v[30:31], v27, s[20:23], 0 offen sc1
  s_mov_b32 s32, 16384
  buffer_load_dwordx2 v[32:33], v27, s[20:23], s32 offen sc1
  s_mov_b32 s32, 32768
  buffer_load_dwordx2 v[34:35], v27, s[20:23], s32 offen sc1
  s_mov_b32 s32, 49152
  buffer_load_dwordx2 v[36:37], v27, s[20:23], s32 offen sc1
  s_mov_b32 s32, 65536
  buffer_load_dwordx2 v[38:39], v27, s[20:23], s32 offen sc1
  s_mov_b32 s32, 81920
  buffer_load_dwordx2 v[40:41], v27, s[20:23], s32 offen sc1
  s_mov_b32 s32, 98304
  buffer_load_dwordx2 v[42:43], v27, s[20:23], s32 offen sc1
  s_mov_b32 s32, 114688
  buffer_load_dwordx2 v[44:45], v27, s[20:23], s32 offen sc1
  s_mov_b32 s41, s57
  s_mul_i32 s32, s41, 16
  s_add_u32 s32, s32, 0
  v_lshrrev_b32 v2, 3, v0
  v_add_u32 v2, s32, v2
  v_bfe_u32 v3, v2, 1, 1
  v_bfe_u32 v4, v2, 3, 1
  v_lshl_or_b32 v3, v4, 1, v3
  v_lshlrev_b32 v3, 1, v3
  v_and_b32 v4, 7, v0
  v_xor_b32 v3, v3, v4
  v_lshlrev_b32 v3, 4, v3
  s_mov_b32 s32, 2048
  v_mul_lo_u32 v2, v2, s32
  v_add_u32 v130, v2, v3
  s_mul_i32 s32, s41, 16
  s_add_u32 s32, s32, 8
  v_lshrrev_b32 v2, 3, v0
  v_add_u32 v2, s32, v2
  v_bfe_u32 v3, v2, 1, 1
  v_bfe_u32 v4, v2, 3, 1
  v_lshl_or_b32 v3, v4, 1, v3
  v_lshlrev_b32 v3, 1, v3
  v_and_b32 v4, 7, v0
  v_xor_b32 v3, v3, v4
  v_lshlrev_b32 v3, 4, v3
  s_mov_b32 s32, 2048
  v_mul_lo_u32 v2, v2, s32
  v_add_u32 v131, v2, v3
  v_subrev_u32 v131, 1024, v131
  s_mov_b32 s12, s68
  s_mov_b32 s13, s69
  s_mov_b32 s14, 2097152
  s_mov_b32 s15, 0x20000
  s_mov_b32 s30, 7
  s_mov_b32 s31, -1
  s_lshl_b32 s52, s57, 11
  s_add_u32 s30, s30, 1
  s_and_b32 s30, s30, 7
  s_cselect_b32 s32, 0, 1
  s_add_u32 s31, s31, s32
  s_sub_u32 s32, s30, s7
  s_and_b32 s32, s32, 7
  s_cmp_lt_u32 s32, 2
  s_cselect_b32 s32, 1, 0
  s_add_u32 s32, s32, s31
  s_cmp_ge_u32 s32, 2
  s_cselect_b32 s32, 0, s32
  s_lshl_b32 s33, s32, 3
  s_add_u32 s33, s33, s30
  s_lshl_b32 s37, s33, 17
  s_add_u32 s37, s37, s35
  s_add_u32 m0, s52, 131072
  s_nop 0
  buffer_load_dwordx4 v130, s[12:15], s37 offen lds
  buffer_load_dwordx4 v131, s[12:15], s37 offen offset:1024 lds
  s_add_u32 s30, s30, 1
  s_and_b32 s30, s30, 7
  s_cselect_b32 s32, 0, 1
  s_add_u32 s31, s31, s32
  s_sub_u32 s32, s30, s7
  s_and_b32 s32, s32, 7
  s_cmp_lt_u32 s32, 2
  s_cselect_b32 s32, 1, 0
  s_add_u32 s32, s32, s31
  s_cmp_ge_u32 s32, 2
  s_cselect_b32 s32, 0, s32
  s_lshl_b32 s33, s32, 3
  s_add_u32 s33, s33, s30
  s_lshl_b32 s37, s33, 17
  s_add_u32 s37, s37, s35
  s_add_u32 m0, s52, 139264
  s_nop 0
  buffer_load_dwordx4 v130, s[12:15], s37 offen lds
  buffer_load_dwordx4 v131, s[12:15], s37 offen offset:1024 lds
  s_add_u32 s30, s30, 1
  s_and_b32 s30, s30, 7
  s_cselect_b32 s32, 0, 1
  s_add_u32 s31, s31, s32
  s_sub_u32 s32, s30, s7
  s_and_b32 s32, s32, 7
  s_cmp_lt_u32 s32, 2
  s_cselect_b32 s32, 1, 0
  s_add_u32 s32, s32, s31
  s_cmp_ge_u32 s32, 2
  s_cselect_b32 s32, 0, s32
  s_lshl_b32 s33, s32, 3
  s_add_u32 s33, s33, s30
  s_lshl_b32 s37, s33, 17
  s_add_u32 s37, s37, s35
  s_add_u32 m0, s52, 147456
  s_nop 0
  buffer_load_dwordx4 v130, s[12:15], s37 offen lds
  buffer_load_dwordx4 v131, s[12:15], s37 offen offset:1024 lds
  s_add_u32 s30, s30, 1
  s_and_b32 s30, s30, 7
  s_cselect_b32 s32, 0, 1
  s_add_u32 s31, s31, s32
  s_sub_u32 s32, s30, s7
  s_and_b32 s32, s32, 7
  s_cmp_lt_u32 s32, 2
  s_cselect_b32 s32, 1, 0
  s_add_u32 s32, s32, s31
  s_cmp_ge_u32 s32, 2
  s_cselect_b32 s32, 0, s32
  s_lshl_b32 s33, s32, 3
  s_add_u32 s33, s33, s30
  s_lshl_b32 s37, s33, 17
  s_add_u32 s37, s37, s35
  s_add_u32 m0, s52, 155648
  s_nop 0
  buffer_load_dwordx4 v130, s[12:15], s37 offen lds
  buffer_load_dwordx4 v131, s[12:15], s37 offen offset:1024 lds
  s_waitcnt vmcnt(16)
  s_barrier
  s_add_u32 s30, s30, 1
  s_and_b32 s30, s30, 7
  s_cselect_b32 s32, 0, 1
  s_add_u32 s31, s31, s32
  s_sub_u32 s32, s30, s7
  s_and_b32 s32, s32, 7
  s_cmp_lt_u32 s32, 2
  s_cselect_b32 s32, 1, 0
  s_add_u32 s32, s32, s31
  s_cmp_ge_u32 s32, 2
  s_cselect_b32 s32, 0, s32
  s_lshl_b32 s33, s32, 3
  s_add_u32 s33, s33, s30
  s_lshl_b32 s37, s33, 17
  s_add_u32 s37, s37, s35
  s_add_u32 m0, s52, 100608
  s_nop 0
  buffer_load_dwordx4 v130, s[12:15], s37 offen lds
  buffer_load_dwordx4 v131, s[12:15], s37 offen offset:1024 lds
  s_add_u32 s30, s30, 1
  s_and_b32 s30, s30, 7
  s_cselect_b32 s32, 0, 1
  s_add_u32 s31, s31, s32
  s_sub_u32 s32, s30, s7
  s_and_b32 s32, s32, 7
  s_cmp_lt_u32 s32, 2
  s_cselect_b32 s32, 1, 0
  s_add_u32 s32, s32, s31
  s_cmp_ge_u32 s32, 2
  s_cselect_b32 s32, 0, s32
  s_lshl_b32 s33, s32, 3
  s_add_u32 s33, s33, s30
  s_lshl_b32 s37, s33, 17
  s_add_u32 s37, s37, s35
  s_add_u32 m0, s52, 108800
  s_nop 0
  buffer_load_dwordx4 v130, s[12:15], s37 offen lds
  buffer_load_dwordx4 v131, s[12:15], s37 offen offset:1024 lds
  s_add_u32 s30, s30, 1
  s_and_b32 s30, s30, 7
  s_cselect_b32 s32, 0, 1
  s_add_u32 s31, s31, s32
  s_sub_u32 s32, s30, s7
  s_and_b32 s32, s32, 7
  s_cmp_lt_u32 s32, 2
  s_cselect_b32 s32, 1, 0
  s_add_u32 s32, s32, s31
  s_cmp_ge_u32 s32, 2
  s_cselect_b32 s32, 0, s32
  s_lshl_b32 s33, s32, 3
  s_add_u32 s33, s33, s30
  s_lshl_b32 s37, s33, 17
  s_add_u32 s37, s37, s35
  s_add_u32 m0, s52, 116992
  s_nop 0
  buffer_load_dwordx4 v130, s[12:15], s37 offen lds
  buffer_load_dwordx4 v131, s[12:15], s37 offen offset:1024 lds
  s_waitcnt vmcnt(14)
  v_pk_add_f32 v[30:31], v[30:31], v[32:33]
  v_pk_add_f32 v[34:35], v[34:35], v[36:37]
  v_pk_add_f32 v[38:39], v[38:39], v[40:41]
  v_pk_add_f32 v[42:43], v[42:43], v[44:45]
  v_pk_add_f32 v[30:31], v[30:31], v[34:35]
  v_pk_add_f32 v[38:39], v[38:39], v[42:43]
  v_pk_add_f32 v[30:31], v[30:31], v[38:39]
  v_mul_f32 v30, 0x3a800000, v30
  v_mul_f32 v31, 0x3a800000, v31
  v_fma_f32 v31, -v30, v30, v31
  v_max_f32 v31, 0, v31
  v_mov_b32 v32, v31
  v_cvt_pk_bf16_f32 v32, v32, v32
  v_lshlrev_b32 v32, 16, v32
  v_add_f32 v32, 0x3727c5ac, v32
  v_cvt_pk_bf16_f32 v32, v32, v32
  v_lshlrev_b32 v32, 16, v32
  v_sqrt_f32 v32, v32
  s_nop 0
  v_cvt_pk_bf16_f32 v32, v32, v32
  v_lshlrev_b32 v32, 16, v32
  v_rcp_f32 v32, v32
  v_cvt_pk_bf16_f32 v30, v30, v30
  v_lshlrev_b32 v30, 16, v30
  v_mov_b32 v31, v32
  ds_write_b64 v26, v[30:31]
  v_and_b32 v4, 15, v0
  v_lshrrev_b32 v5, 4, v0
  v_lshrrev_b32 v6, 2, v4
  v_and_b32 v7, 3, v0
  v_lshrrev_b32 v3, 5, v0
  v_and_b32 v2, 1, v5
  v_lshl_or_b32 v3, v2, 1, v3
  s_waitcnt lgkmcnt(0)
  s_barrier
  s_add_u32 s30, s30, 1
  s_and_b32 s30, s30, 7
  s_cselect_b32 s32, 0, 1
  s_add_u32 s31, s31, s32
  s_sub_u32 s32, s30, s7
  s_and_b32 s32, s32, 7
  s_cmp_lt_u32 s32, 2
  s_cselect_b32 s32, 1, 0
  s_add_u32 s32, s32, s31
  s_cmp_ge_u32 s32, 2
  s_cselect_b32 s32, 0, s32
  s_lshl_b32 s33, s32, 3
  s_add_u32 s33, s33, s30
  s_lshl_b32 s37, s33, 17
  s_add_u32 s37, s37, s35
  s_add_u32 m0, s52, 0
  s_nop 0
  buffer_load_dwordx4 v130, s[12:15], s37 offen lds
  buffer_load_dwordx4 v131, s[12:15], s37 offen offset:1024 lds
  s_add_u32 s30, s30, 1
  s_and_b32 s30, s30, 7
  s_cselect_b32 s32, 0, 1
  s_add_u32 s31, s31, s32
  s_sub_u32 s32, s30, s7
  s_and_b32 s32, s32, 7
  s_cmp_lt_u32 s32, 2
  s_cselect_b32 s32, 1, 0
  s_add_u32 s32, s32, s31
  s_cmp_ge_u32 s32, 2
  s_cselect_b32 s32, 0, s32
  s_lshl_b32 s33, s32, 3
  s_add_u32 s33, s33, s30
  s_lshl_b32 s37, s33, 17
  s_add_u32 s37, s37, s35
  s_add_u32 m0, s52, 8192
  s_nop 0
  buffer_load_dwordx4 v130, s[12:15], s37 offen lds
  buffer_load_dwordx4 v131, s[12:15], s37 offen offset:1024 lds
  s_add_u32 s30, s30, 1
  s_and_b32 s30, s30, 7
  s_cselect_b32 s32, 0, 1
  s_add_u32 s31, s31, s32
  s_sub_u32 s32, s30, s7
  s_and_b32 s32, s32, 7
  s_cmp_lt_u32 s32, 2
  s_cselect_b32 s32, 1, 0
  s_add_u32 s32, s32, s31
  s_cmp_ge_u32 s32, 2
  s_cselect_b32 s32, 0, s32
  s_lshl_b32 s33, s32, 3
  s_add_u32 s33, s33, s30
  s_lshl_b32 s37, s33, 17
  s_add_u32 s37, s37, s35
  s_add_u32 m0, s52, 16384
  s_nop 0
  buffer_load_dwordx4 v130, s[12:15], s37 offen lds
  buffer_load_dwordx4 v131, s[12:15], s37 offen offset:1024 lds
  s_add_u32 s30, s30, 1
  s_and_b32 s30, s30, 7
  s_cselect_b32 s32, 0, 1
  s_add_u32 s31, s31, s32
  s_sub_u32 s32, s30, s7
  s_and_b32 s32, s32, 7
  s_cmp_lt_u32 s32, 2
  s_cselect_b32 s32, 1, 0
  s_add_u32 s32, s32, s31
  s_cmp_ge_u32 s32, 2
  s_cselect_b32 s32, 0, s32
  s_lshl_b32 s33, s32, 3
  s_add_u32 s33, s33, s30
  s_lshl_b32 s37, s33, 17
  s_add_u32 s37, s37, s35
  s_add_u32 m0, s52, 24576
  s_nop 0
  buffer_load_dwordx4 v130, s[12:15], s37 offen lds
  buffer_load_dwordx4 v131, s[12:15], s37 offen offset:1024 lds
  s_add_u32 s30, s30, 1
  s_and_b32 s30, s30, 7
  s_cselect_b32 s32, 0, 1
  s_add_u32 s31, s31, s32
  s_sub_u32 s32, s30, s7
  s_and_b32 s32, s32, 7
  s_cmp_lt_u32 s32, 2
  s_cselect_b32 s32, 1, 0
  s_add_u32 s32, s32, s31
  s_cmp_ge_u32 s32, 2
  s_cselect_b32 s32, 0, s32
  s_lshl_b32 s33, s32, 3
  s_add_u32 s33, s33, s30
  s_lshl_b32 s37, s33, 17
  s_add_u32 s37, s37, s35
  s_add_u32 m0, s52, 32768
  s_nop 0
  buffer_load_dwordx4 v130, s[12:15], s37 offen lds
  buffer_load_dwordx4 v131, s[12:15], s37 offen offset:1024 lds
  s_branch attn
L_k1done:
  s_nop 7
  s_nop 7
  s_waitcnt vmcnt(0)
  s_barrier
  s_cmp_lg_u32 s57, 0
  s_cbranch_scc1 pub8
  s_add_u32 s24, s84, 29360128
  s_addc_u32 s25, s85, 0
  s_mov_b32 s26, 262144
  s_mov_b32 s27, 0x20000
  v_mov_b32 v2, 0
  v_mov_b32 v3, 1
  s_mov_b64 exec, 1
  buffer_store_dword v3, v2, s[24:27], s56 offen sc0 sc1
  s_mov_b64 exec, -1
pub8:
  s_add_u32 s30, s30, 1
  s_and_b32 s30, s30, 7
  s_cselect_b32 s32, 0, 1
  s_add_u32 s31, s31, s32
  s_sub_u32 s32, s30, s7
  s_and_b32 s32, s32, 7
  s_cmp_lt_u32 s32, 2
  s_cselect_b32 s32, 1, 0
  s_add_u32 s32, s32, s31
  s_cmp_ge_u32 s32, 2
  s_cselect_b32 s32, 0, s32
  s_lshl_b32 s33, s32, 3
  s_add_u32 s33, s33, s30
  s_lshl_b32 s37, s33, 17
  s_add_u32 s37, s37, s35
  s_add_u32 m0, s52, 43008
  s_nop 0
  buffer_load_dwordx4 v130, s[12:15], s37 offen lds
  buffer_load_dwordx4 v131, s[12:15], s37 offen offset:1024 lds
  s_add_u32 s30, s30, 1
  s_and_b32 s30, s30, 7
  s_cselect_b32 s32, 0, 1
  s_add_u32 s31, s31, s32
  s_sub_u32 s32, s30, s7
  s_and_b32 s32, s32, 7
  s_cmp_lt_u32 s32, 2
  s_cselect_b32 s32, 1, 0
  s_add_u32 s32, s32, s31
  s_cmp_ge_u32 s32, 2
  s_cselect_b32 s32, 0, s32
  s_lshl_b32 s33, s32, 3
  s_add_u32 s33, s33, s30
  s_lshl_b32 s37, s33, 17
  s_add_u32 s37, s37, s35
  s_add_u32 m0, s52, 51200
  s_nop 0
  buffer_load_dwordx4 v130, s[12:15], s37 offen lds
  buffer_load_dwordx4 v131, s[12:15], s37 offen offset:1024 lds
  s_add_u32 s30, s30, 1
  s_and_b32 s30, s30, 7
  s_cselect_b32 s32, 0, 1
  s_add_u32 s31, s31, s32
  s_sub_u32 s32, s30, s7
  s_and_b32 s32, s32, 7
  s_cmp_lt_u32 s32, 2
  s_cselect_b32 s32, 1, 0
  s_add_u32 s32, s32, s31
  s_cmp_ge_u32 s32, 2
  s_cselect_b32 s32, 0, s32
  s_lshl_b32 s33, s32, 3
  s_add_u32 s33, s33, s30
  s_lshl_b32 s37, s33, 17
  s_add_u32 s37, s37, s35
  s_add_u32 m0, s52, 59392
  s_nop 0
  buffer_load_dwordx4 v130, s[12:15], s37 offen lds
  buffer_load_dwordx4 v131, s[12:15], s37 offen offset:1024 lds
  s_add_u32 s30, s30, 1
  s_and_b32 s30, s30, 7
  s_cselect_b32 s32, 0, 1
  s_add_u32 s31, s31, s32
  s_sub_u32 s32, s30, s7
  s_and_b32 s32, s32, 7
  s_cmp_lt_u32 s32, 2
  s_cselect_b32 s32, 1, 0
  s_add_u32 s32, s32, s31
  s_cmp_ge_u32 s32, 2
  s_cselect_b32 s32, 0, s32
  s_lshl_b32 s33, s32, 3
  s_add_u32 s33, s33, s30
  s_lshl_b32 s37, s33, 17
  s_add_u32 s37, s37, s35
  s_add_u32 m0, s52, 67584
  s_nop 0
  buffer_load_dwordx4 v130, s[12:15], s37 offen lds
  buffer_load_dwordx4 v131, s[12:15], s37 offen offset:1024 lds
  s_lshl_b32 s56, s3, 10
  s_mul_i32 s32, s29, 16
  s_add_u32 s56, s56, s32
  s_add_u32 s56, s56, s28
  s_add_u32 s56, s56, 256
  s_lshl_b32 s56, s56, 7
  s_waitcnt vmcnt(0)
  s_barrier
  s_cmp_ge_u32 s2, 224
  s_cbranch_scc1 L_k3skip
  s_lshr_b32 s32, s2, 3
  s_mul_i32 s5, s32, 9363
  s_lshr_b32 s5, s5, 16
  s_mul_i32 s6, s5, 7
  s_sub_u32 s6, s32, s6
  s_lshl_b32 s7, s5, 1
  s_add_u32 s7, s7, s6
  s_and_b32 s7, s7, 7
  s_and_b32 s32, s2, 7
  s_lshr_b32 s28, s32, 2
  s_lshl_b32 s28, s28, 2
  s_add_u32 s28, s28, s5
  s_and_b32 s29, s32, 3
  s_mul_i32 s29, s29, 7
  s_add_u32 s29, s29, s6
  s_mov_b32 s30, 7
  s_mov_b32 s31, -1
  s_lshl_b32 s44, s57, 12
  s_add_u32 s45, s44, 16384
  v_lshlrev_b32 v8, 4, v0
  v_add_u32 v13, 63488, v8
  v_lshrrev_b32 v2, 4, v0
  v_lshlrev_b32 v3, 1, v2
  v_and_b32 v4, 15, v0
  v_xor_b32 v3, v3, v4
  v_lshlrev_b32 v3, 4, v3
  s_lshl_b32 s32, s57, 4
  v_add_u32 v2, s32, v2
  s_mov_b32 s32, 7168
  v_mul_lo_u32 v2, v2, s32
  v_add_u32 v9, v2, v3
  v_xor_b32 v3, 128, v3
  v_add_u32 v11, v2, v3
  v_add_u32 v10, 27648, v9
  v_add_u32 v12, 82944, v11
  v_add_u32 v11, 55296, v11
  s_lshl_b32 s34, s28, 2
  s_add_u32 s34, s34, s57
  s_lshl_b32 s34, s34, 17
  s_lshl_b32 s35, s29, 8
  s_add_u32 s8, s82, 8388608
  s_addc_u32 s9, s83, 0
  s_mov_b32 s10, 4194304
  s_mov_b32 s11, 0x20000
  s_mov_b32 s12, s72
  s_mov_b32 s13, s73
  s_mov_b32 s14, 14680064
  s_mov_b32 s15, 0x20000
  s_add_u32 s16, s84, 29360128
  s_addc_u32 s17, s85, 0
  s_mov_b32 s18, 262144
  s_mov_b32 s19, 0x20000
  s_lshl_b32 s32, s28, 5
  v_min_u32 v14, 31, v0
  v_add_u32 v14, s32, v14
  v_max_i32 v14, 0, v14
  v_lshlrev_b32 v14, 7, v14
  s_lshl_b32 s55, s3, 17
  s_add_u32 s55, s55, 32768
  s_barrier
  s_barrier
  s_cmp_lg_u32 s57, 0
  s_cbranch_scc1 pub9
  s_add_u32 s24, s84, 29360128
  s_addc_u32 s25, s85, 0
  s_mov_b32 s26, 262144
  s_mov_b32 s27, 0x20000
  v_mov_b32 v2, 0
  v_mov_b32 v3, 1
  s_mov_b64 exec, 1
  buffer_store_dword v3, v2, s[24:27], s56 offen sc0 sc1
  s_mov_b64 exec, -1
pub9:
  s_mov_b32 s30, 7
  s_mov_b32 s31, -1
  s_mov_b32 s38, 0
  s_add_u32 s30, s30, 1
  s_and_b32 s30, s30, 7
  s_cselect_b32 s32, 0, 1
  s_add_u32 s31, s31, s32
  s_sub_u32 s32, s30, s7
  s_and_b32 s32, s32, 7
  s_cmp_lt_u32 s32, 2
  s_cselect_b32 s32, 1, 0
  s_add_u32 s32, s32, s31
  s_cmp_ge_u32 s32, 4
  s_cselect_b32 s32, 0, s32
  s_lshl_b32 s33, s32, 3
  s_add_u32 s33, s33, s30
  s_mul_i32 s37, s33, 458752
  s_add_u32 s37, s37, s35
  s_add_u32 m0, s38, s45
  s_nop 0
  buffer_load_dwordx4 v9, s[12:15], s37 offen offset:0  lds
  buffer_load_dwordx4 v10, s[12:15], s37 offen offset:1024  lds
  buffer_load_dwordx4 v11, s[12:15], s37 offen offset:2048  lds
  buffer_load_dwordx4 v12, s[12:15], s37 offen offset:3072  lds
  s_add_u32 s38, s38, 32768
  s_cmp_eq_u32 s38, 163840
  s_cselect_b32 s38, 0, s38
  s_add_u32 s30, s30, 1
  s_and_b32 s30, s30, 7
  s_cselect_b32 s32, 0, 1
  s_add_u32 s31, s31, s32
  s_sub_u32 s32, s30, s7
  s_and_b32 s32, s32, 7
  s_cmp_lt_u32 s32, 2
  s_cselect_b32 s32, 1, 0
  s_add_u32 s32, s32, s31
  s_cmp_ge_u32 s32, 4
  s_cselect_b32 s32, 0, s32
  s_lshl_b32 s33, s32, 3
  s_add_u32 s33, s33, s30
  s_mul_i32 s37, s33, 458752
  s_add_u32 s37, s37, s35
  s_add_u32 m0, s38, s45
  s_nop 0
  buffer_load_dwordx4 v9, s[12:15], s37 offen offset:0  lds
  buffer_load_dwordx4 v10, s[12:15], s37 offen offset:1024  lds
  buffer_load_dwordx4 v11, s[12:15], s37 offen offset:2048  lds
  buffer_load_dwordx4 v12, s[12:15], s37 offen offset:3072  lds
  s_add_u32 s38, s38, 32768
  s_cmp_eq_u32 s38, 163840
  s_cselect_b32 s38, 0, s38
  s_add_u32 s30, s30, 1
  s_and_b32 s30, s30, 7
  s_cselect_b32 s32, 0, 1
  s_add_u32 s31, s31, s32
  s_sub_u32 s32, s30, s7
  s_and_b32 s32, s32, 7
  s_cmp_lt_u32 s32, 2
  s_cselect_b32 s32, 1, 0
  s_add_u32 s32, s32, s31
  s_cmp_ge_u32 s32, 4
  s_cselect_b32 s32, 0, s32
  s_lshl_b32 s33, s32, 3
  s_add_u32 s33, s33, s30
  s_mul_i32 s37, s33, 458752
  s_add_u32 s37, s37, s35
  s_add_u32 m0, s38, s45
  s_nop 0
  buffer_load_dwordx4 v9, s[12:15], s37 offen offset:0  lds
  buffer_load_dwordx4 v10, s[12:15], s37 offen offset:1024  lds
  buffer_load_dwordx4 v11, s[12:15], s37 offen offset:2048  lds
  buffer_load_dwordx4 v12, s[12:15], s37 offen offset:3072  lds
  s_add_u32 s38, s38, 32768
  s_cmp_eq_u32 s38, 163840
  s_cselect_b32 s38, 0, s38
  s_lshl_b32 s56, s3, 10
  s_mul_i32 s32, s28, 32
  s_add_u32 s56, s56, s32
  s_add_u32 s56, s56, s29
  s_add_u32 s56, s56, 512
  s_lshl_b32 s56, s56, 7
  s_mov_b32 s39, 0
poll10:
  buffer_load_dword v15, v14, s[16:19], s55 offen sc0 sc1
  s_waitcnt vmcnt(0)
  v_cmp_eq_u32 vcc, 0, v15
  s_add_u32 s39, s39, 1
  s_cmp_gt_u32 s39, 100000
  s_cbranch_scc1 poll10d
  s_cbranch_vccnz poll10
poll10d:
  s_mov_b32 s30, 7
  s_mov_b32 s31, -1
  s_mov_b32 s38, 0
  s_add_u32 s30, s30, 1
  s_and_b32 s30, s30, 7
  s_cselect_b32 s32, 0, 1
  s_add_u32 s31, s31, s32
  s_sub_u32 s32, s30, s7
  s_and_b32 s32, s32, 7
  s_cmp_lt_u32 s32, 2
  s_cselect_b32 s32, 1, 0
  s_add_u32 s32, s32, s31
  s_cmp_ge_u32 s32, 4
  s_cselect_b32 s32, 0, s32
  s_lshl_b32 s33, s32, 3
  s_add_u32 s33, s33, s30
  s_mul_i32 s36, s33, 2048
  s_add_u32 s36, s36, s34
  s_add_u32 m0, s38, s44
  s_nop 0
  buffer_load_dwordx4 v8, s[8:11], s36 offen offset:0 sc1 lds
  buffer_load_dwordx4 v8, s[8:11], s36 offen offset:1024 sc1 lds
  buffer_load_dwordx4 v13, s[8:11], s36 offen offset:2048 sc1 lds
  buffer_load_dwordx4 v13, s[8:11], s36 offen offset:3072 sc1 lds
  s_add_u32 s38, s38, 32768
  s_cmp_eq_u32 s38, 163840
  s_cselect_b32 s38, 0, s38
  s_add_u32 s30, s30, 1
  s_and_b32 s30, s30, 7
  s_cselect_b32 s32, 0, 1
  s_add_u32 s31, s31, s32
  s_sub_u32 s32, s30, s7
  s_and_b32 s32, s32, 7
  s_cmp_lt_u32 s32, 2
  s_cselect_b32 s32, 1, 0
  s_add_u32 s32, s32, s31
  s_cmp_ge_u32 s32, 4
  s_cselect_b32 s32, 0, s32
  s_lshl_b32 s33, s32, 3
  s_add_u32 s33, s33, s30
  s_mul_i32 s36, s33, 2048
  s_add_u32 s36, s36, s34
  s_add_u32 m0, s38, s44
  s_nop 0
  buffer_load_dwordx4 v8, s[8:11], s36 offen offset:0 sc1 lds
  buffer_load_dwordx4 v8, s[8:11], s36 offen offset:1024 sc1 lds
  buffer_load_dwordx4 v13, s[8:11], s36 offen offset:2048 sc1 lds
  buffer_load_dwordx4 v13, s[8:11], s36 offen offset:3072 sc1 lds
  s_add_u32 s38, s38, 32768
  s_cmp_eq_u32 s38, 163840
  s_cselect_b32 s38, 0, s38
  s_add_u32 s30, s30, 1
  s_and_b32 s30, s30, 7
  s_cselect_b32 s32, 0, 1
  s_add_u32 s31, s31, s32
  s_sub_u32 s32, s30, s7
  s_and_b32 s32, s32, 7
  s_cmp_lt_u32 s32, 2
  s_cselect_b32 s32, 1, 0
  s_add_u32 s32, s32, s31
  s_cmp_ge_u32 s32, 4
  s_cselect_b32 s32, 0, s32
  s_lshl_b32 s33, s32, 3
  s_add_u32 s33, s33, s30
  s_mul_i32 s36, s33, 2048
  s_add_u32 s36, s36, s34
  s_add_u32 m0, s38, s44
  s_nop 0
  buffer_load_dwordx4 v8, s[8:11], s36 offen offset:0 sc1 lds
  buffer_load_dwordx4 v8, s[8:11], s36 offen offset:1024 sc1 lds
  buffer_load_dwordx4 v13, s[8:11], s36 offen offset:2048 sc1 lds
  buffer_load_dwordx4 v13, s[8:11], s36 offen offset:3072 sc1 lds
  s_add_u32 s38, s38, 32768
  s_cmp_eq_u32 s38, 163840
  s_cselect_b32 s38, 0, s38
  s_waitcnt vmcnt(8)
  s_barrier
  s_add_u32 s30, s30, 1
  s_and_b32 s30, s30, 7
  s_cselect_b32 s32, 0, 1
  s_add_u32 s31, s31, s32
  s_sub_u32 s32, s30, s7
  s_and_b32 s32, s32, 7
  s_cmp_lt_u32 s32, 2
  s_cselect_b32 s32, 1, 0
  s_add_u32 s32, s32, s31
  s_cmp_ge_u32 s32, 4
  s_cselect_b32 s32, 0, s32
  s_lshl_b32 s33, s32, 3
  s_add_u32 s33, s33, s30
  s_mul_i32 s36, s33, 2048
  s_add_u32 s36, s36, s34
  s_mul_i32 s37, s33, 458752
  s_add_u32 s37, s37, s35
  s_add_u32 m0, s38, s44
  s_nop 0
  buffer_load_dwordx4 v8, s[8:11], s36 offen offset:0 sc1 lds
  buffer_load_dwordx4 v8, s[8:11], s36 offen offset:1024 sc1 lds
  buffer_load_dwordx4 v13, s[8:11], s36 offen offset:2048 sc1 lds
  buffer_load_dwordx4 v13, s[8:11], s36 offen offset:3072 sc1 lds
  s_add_u32 m0, s38, s45
  s_nop 0
  buffer_load_dwordx4 v9, s[12:15], s37 offen offset:0  lds
  buffer_load_dwordx4 v10, s[12:15], s37 offen offset:1024  lds
  buffer_load_dwordx4 v11, s[12:15], s37 offen offset:2048  lds
  buffer_load_dwordx4 v12, s[12:15], s37 offen offset:3072  lds
  s_add_u32 s38, s38, 32768
  s_cmp_eq_u32 s38, 163840
  s_cselect_b32 s38, 0, s38
  s_waitcnt vmcnt(12)
  s_barrier
  s_add_u32 s30, s30, 1
  s_and_b32 s30, s30, 7
  s_cselect_b32 s32, 0, 1
  s_add_u32 s31, s31, s32
  s_sub_u32 s32, s30, s7
  s_and_b32 s32, s32, 7
  s_cmp_lt_u32 s32, 2
  s_cselect_b32 s32, 1, 0
  s_add_u32 s32, s32, s31
  s_cmp_ge_u32 s32, 4
  s_cselect_b32 s32, 0, s32
  s_lshl_b32 s33, s32, 3
  s_add_u32 s33, s33, s30
  s_mul_i32 s36, s33, 2048
  s_add_u32 s36, s36, s34
  s_mul_i32 s37, s33, 458752
  s_add_u32 s37, s37, s35
  s_add_u32 m0, s38, s44
  s_nop 0
  buffer_load_dwordx4 v8, s[8:11], s36 offen offset:0 sc1 lds
  buffer_load_dwordx4 v8, s[8:11], s36 offen offset:1024 sc1 lds
  buffer_load_dwordx4 v13, s[8:11], s36 offen offset:2048 sc1 lds
  buffer_load_dwordx4 v13, s[8:11], s36 offen offset:3072 sc1 lds
  s_add_u32 m0, s38, s45
  s_nop 0
  buffer_load_dwordx4 v9, s[12:15], s37 offen offset:0  lds
  buffer_load_dwordx4 v10, s[12:15], s37 offen offset:1024  lds
  buffer_load_dwordx4 v11, s[12:15], s37 offen offset:2048  lds
  buffer_load_dwordx4 v12, s[12:15], s37 offen offset:3072  lds
  s_add_u32 s38, s38, 32768
  s_cmp_eq_u32 s38, 163840
  s_cselect_b32 s38, 0, s38
  s_mov_b32 s39, 27
ll11:
  s_waitcnt vmcnt(16)
  s_barrier
  s_add_u32 s30, s30, 1
  s_and_b32 s30, s30, 7
  s_cselect_b32 s32, 0, 1
  s_add_u32 s31, s31, s32
  s_sub_u32 s32, s30, s7
  s_and_b32 s32, s32, 7
  s_cmp_lt_u32 s32, 2
  s_cselect_b32 s32, 1, 0
  s_add_u32 s32, s32, s31
  s_cmp_ge_u32 s32, 4
  s_cselect_b32 s32, 0, s32
  s_lshl_b32 s33, s32, 3
  s_add_u32 s33, s33, s30
  s_mul_i32 s36, s33, 2048
  s_add_u32 s36, s36, s34
  s_mul_i32 s37, s33, 458752
  s_add_u32 s37, s37, s35
  s_add_u32 m0, s38, s44
  s_nop 0
  buffer_load_dwordx4 v8, s[8:11], s36 offen offset:0 sc1 lds
  buffer_load_dwordx4 v8, s[8:11], s36 offen offset:1024 sc1 lds
  buffer_load_dwordx4 v13, s[8:11], s36 offen offset:2048 sc1 lds
  buffer_load_dwordx4 v13, s[8:11], s36 offen offset:3072 sc1 lds
  s_add_u32 m0, s38, s45
  s_nop 0
  buffer_load_dwordx4 v9, s[12:15], s37 offen offset:0  lds
  buffer_load_dwordx4 v10, s[12:15], s37 offen offset:1024  lds
  buffer_load_dwordx4 v11, s[12:15], s37 offen offset:2048  lds
  buffer_load_dwordx4 v12, s[12:15], s37 offen offset:3072  lds
  s_add_u32 s38, s38, 32768
  s_cmp_eq_u32 s38, 163840
  s_cselect_b32 s38, 0, s38
  s_sub_u32 s39, s39, 1
  s_cmp_lg_u32 s39, 0
  s_cbranch_scc1 ll11
  s_waitcnt vmcnt(16)
  s_barrier
  s_waitcnt vmcnt(8)
  s_barrier
  s_waitcnt vmcnt(0)
  s_barrier
  s_lshr_b32 s32, s2, 3
  s_lshr_b32 s5, s32, 3
  s_and_b32 s6, s32, 7
  s_lshl_b32 s7, s5, 1
  s_add_u32 s7, s7, s6
  s_and_b32 s7, s7, 7
  s_and_b32 s32, s2, 7
  s_lshr_b32 s28, s32, 2
  s_lshl_b32 s28, s28, 2
  s_add_u32 s28, s28, s5
  s_and_b32 s29, s32, 3
  s_mul_i32 s29, s29, 8
  s_add_u32 s29, s29, s6
  s_mov_b32 s30, 7
  s_mov_b32 s31, -1
  s_mov_b32 s41, s57
  s_lshl_b32 s45, s41, 11
  s_mul_i32 s32, s41, 16
  s_add_u32 s32, s32, 0
  v_lshrrev_b32 v2, 3, v0
  v_add_u32 v2, s32, v2
  v_bfe_u32 v3, v2, 1, 1
  v_bfe_u32 v4, v2, 3, 1
  v_lshl_or_b32 v3, v4, 1, v3
  v_lshlrev_b32 v3, 1, v3
  v_and_b32 v4, 7, v0
  v_xor_b32 v3, v3, v4
  v_lshlrev_b32 v3, 4, v3
  s_mov_b32 s32, 4096
  v_mul_lo_u32 v2, v2, s32
  v_add_u32 v9, v2, v3
  s_mul_i32 s32, s41, 16
  s_add_u32 s32, s32, 8
  v_lshrrev_b32 v2, 3, v0
  v_add_u32 v2, s32, v2
  v_bfe_u32 v3, v2, 1, 1
  v_bfe_u32 v4, v2, 3, 1
  v_lshl_or_b32 v3, v4, 1, v3
  v_lshlrev_b32 v3, 1, v3
  v_and_b32 v4, 7, v0
  v_xor_b32 v3, v3, v4
  v_lshlrev_b32 v3, 4, v3
  s_mov_b32 s32, 4096
  v_mul_lo_u32 v2, v2, s32
  v_add_u32 v10, v2, v3
  v_subrev_u32 v10, 1024, v10
  s_lshl_b32 s35, s29, 7
  s_mov_b32 s12, s76
  s_mov_b32 s13, s77
  s_mov_b32 s14, 14680064
  s_mov_b32 s15, 0x20000
  s_branch L_k4
L_k3skip:
  s_nop 7
  s_nop 7
  s_lshr_b32 s32, s2, 3
  s_lshr_b32 s5, s32, 3
  s_and_b32 s6, s32, 7
  s_lshl_b32 s7, s5, 1
  s_add_u32 s7, s7, s6
  s_and_b32 s7, s7, 7
  s_and_b32 s32, s2, 7
  s_lshr_b32 s28, s32, 2
  s_lshl_b32 s28, s28, 2
  s_add_u32 s28, s28, s5
  s_and_b32 s29, s32, 3
  s_mul_i32 s29, s29, 8
  s_add_u32 s29, s29, s6
  s_mov_b32 s30, 7
  s_mov_b32 s31, -1
  s_mov_b32 s41, s57
  s_lshl_b32 s45, s41, 11
  s_mul_i32 s32, s41, 16
  s_add_u32 s32, s32, 0
  v_lshrrev_b32 v2, 3, v0
  v_add_u32 v2, s32, v2
  v_bfe_u32 v3, v2, 1, 1
  v_bfe_u32 v4, v2, 3, 1
  v_lshl_or_b32 v3, v4, 1, v3
  v_lshlrev_b32 v3, 1, v3
  v_and_b32 v4, 7, v0
  v_xor_b32 v3, v3, v4
  v_lshlrev_b32 v3, 4, v3
  s_mov_b32 s32, 4096
  v_mul_lo_u32 v2, v2, s32
  v_add_u32 v9, v2, v3
  s_mul_i32 s32, s41, 16
  s_add_u32 s32, s32, 8
  v_lshrrev_b32 v2, 3, v0
  v_add_u32 v2, s32, v2
  v_bfe_u32 v3, v2, 1, 1
  v_bfe_u32 v4, v2, 3, 1
  v_lshl_or_b32 v3, v4, 1, v3
  v_lshlrev_b32 v3, 1, v3
  v_and_b32 v4, 7, v0
  v_xor_b32 v3, v3, v4
  v_lshlrev_b32 v3, 4, v3
  s_mov_b32 s32, 4096
  v_mul_lo_u32 v2, v2, s32
  v_add_u32 v10, v2, v3
  v_subrev_u32 v10, 1024, v10
  s_lshl_b32 s35, s29, 7
  s_mov_b32 s12, s76
  s_mov_b32 s13, s77
  s_mov_b32 s14, 14680064
  s_mov_b32 s15, 0x20000
  s_barrier
L_k4:
  s_nop 7
  s_nop 7
  s_mov_b32 s30, 7
  s_mov_b32 s31, -1
  s_mov_b32 s38, 98304
  s_add_u32 s30, s30, 1
  s_and_b32 s30, s30, 7
  s_cselect_b32 s32, 0, 1
  s_add_u32 s31, s31, s32
  s_sub_u32 s32, s30, s7
  s_and_b32 s32, s32, 7
  s_cmp_lt_u32 s32, 2
  s_cselect_b32 s32, 1, 0
  s_add_u32 s32, s32, s31
  s_cmp_ge_u32 s32, 7
  s_cselect_b32 s32, 0, s32
  s_lshl_b32 s33, s32, 3
  s_add_u32 s33, s33, s30
  s_mul_i32 s37, s33, 262144
  s_add_u32 s37, s37, s35
  s_add_u32 m0, s38, s45
  s_nop 0
  buffer_load_dwordx4 v9, s[12:15], s37 offen offset:0  lds
  buffer_load_dwordx4 v10, s[12:15], s37 offen offset:1024  lds
  s_add_u32 s38, s38, 8192
  s_cmp_eq_u32 s38, 163840
  s_cselect_b32 s38, 98304, s38
  s_add_u32 s30, s30, 1
  s_and_b32 s30, s30, 7
  s_cselect_b32 s32, 0, 1
  s_add_u32 s31, s31, s32
  s_sub_u32 s32, s30, s7
  s_and_b32 s32, s32, 7
  s_cmp_lt_u32 s32, 2
  s_cselect_b32 s32, 1, 0
  s_add_u32 s32, s32, s31
  s_cmp_ge_u32 s32, 7
  s_cselect_b32 s32, 0, s32
  s_lshl_b32 s33, s32, 3
  s_add_u32 s33, s33, s30
  s_mul_i32 s37, s33, 262144
  s_add_u32 s37, s37, s35
  s_add_u32 m0, s38, s45
  s_nop 0
  buffer_load_dwordx4 v9, s[12:15], s37 offen offset:0  lds
  buffer_load_dwordx4 v10, s[12:15], s37 offen offset:1024  lds
  s_add_u32 s38, s38, 8192
  s_cmp_eq_u32 s38, 163840
  s_cselect_b32 s38, 98304, s38
  s_add_u32 s30, s30, 1
  s_and_b32 s30, s30, 7
  s_cselect_b32 s32, 0, 1
  s_add_u32 s31, s31, s32
  s_sub_u32 s32, s30, s7
  s_and_b32 s32, s32, 7
  s_cmp_lt_u32 s32, 2
  s_cselect_b32 s32, 1, 0
  s_add_u32 s32, s32, s31
  s_cmp_ge_u32 s32, 7
  s_cselect_b32 s32, 0, s32
  s_lshl_b32 s33, s32, 3
  s_add_u32 s33, s33, s30
  s_mul_i32 s37, s33, 262144
  s_add_u32 s37, s37, s35
  s_add_u32 m0, s38, s45
  s_nop 0
  buffer_load_dwordx4 v9, s[12:15], s37 offen offset:0  lds
  buffer_load_dwordx4 v10, s[12:15], s37 offen offset:1024  lds
  s_add_u32 s38, s38, 8192
  s_cmp_eq_u32 s38, 163840
  s_cselect_b32 s38, 98304, s38
  s_add_u32 s30, s30, 1
  s_and_b32 s30, s30, 7
  s_cselect_b32 s32, 0, 1
  s_add_u32 s31, s31, s32
  s_sub_u32 s32, s30, s7
  s_and_b32 s32, s32, 7
  s_cmp_lt_u32 s32, 2
  s_cselect_b32 s32, 1, 0
  s_add_u32 s32, s32, s31
  s_cmp_ge_u32 s32, 7
  s_cselect_b32 s32, 0, s32
  s_lshl_b32 s33, s32, 3
  s_add_u32 s33, s33, s30
  s_mul_i32 s37, s33, 262144
  s_add_u32 s37, s37, s35
  s_add_u32 m0, s38, s45
  s_nop 0
  buffer_load_dwordx4 v9, s[12:15], s37 offen offset:0  lds
  buffer_load_dwordx4 v10, s[12:15], s37 offen offset:1024  lds
  s_add_u32 s38, s38, 8192
  s_cmp_eq_u32 s38, 163840
  s_cselect_b32 s38, 98304, s38
  s_add_u32 s30, s30, 1
  s_and_b32 s30, s30, 7
  s_cselect_b32 s32, 0, 1
  s_add_u32 s31, s31, s32
  s_sub_u32 s32, s30, s7
  s_and_b32 s32, s32, 7
  s_cmp_lt_u32 s32, 2
  s_cselect_b32 s32, 1, 0
  s_add_u32 s32, s32, s31
  s_cmp_ge_u32 s32, 7
  s_cselect_b32 s32, 0, s32
  s_lshl_b32 s33, s32, 3
  s_add_u32 s33, s33, s30
  s_mul_i32 s37, s33, 262144
  s_add_u32 s37, s37, s35
  s_add_u32 m0, s38, s45
  s_nop 0
  buffer_load_dwordx4 v9, s[12:15], s37 offen offset:0  lds
  buffer_load_dwordx4 v10, s[12:15], s37 offen offset:1024  lds
  s_add_u32 s38, s38, 8192
  s_cmp_eq_u32 s38, 163840
  s_cselect_b32 s38, 98304, s38
  s_add_u32 s30, s30, 1
  s_and_b32 s30, s30, 7
  s_cselect_b32 s32, 0, 1
  s_add_u32 s31, s31, s32
  s_sub_u32 s32, s30, s7
  s_and_b32 s32, s32, 7
  s_cmp_lt_u32 s32, 2
  s_cselect_b32 s32, 1, 0
  s_add_u32 s32, s32, s31
  s_cmp_ge_u32 s32, 7
  s_cselect_b32 s32, 0, s32
  s_lshl_b32 s33, s32, 3
  s_add_u32 s33, s33, s30
  s_mul_i32 s37, s33, 262144
  s_add_u32 s37, s37, s35
  s_add_u32 m0, s38, s45
  s_nop 0
  buffer_load_dwordx4 v9, s[12:15], s37 offen offset:0  lds
  buffer_load_dwordx4 v10, s[12:15], s37 offen offset:1024  lds
  s_add_u32 s38, s38, 8192
  s_cmp_eq_u32 s38, 163840
  s_cselect_b32 s38, 98304, s38
  s_barrier
  s_cmp_lg_u32 s57, 0
  s_cbranch_scc1 pub12
  s_add_u32 s24, s84, 29360128
  s_addc_u32 s25, s85, 0
  s_mov_b32 s26, 262144
  s_mov_b32 s27, 0x20000
  v_mov_b32 v2, 0
  v_mov_b32 v3, 1
  s_mov_b64 exec, 1
  buffer_store_dword v3, v2, s[24:27], s56 offen sc0 sc1
  s_mov_b64 exec, -1
pub12:
  s_lshl_b32 s56, s3, 10
  s_mul_i32 s32, s29, 8
  s_add_u32 s56, s56, s32
  s_add_u32 s56, s56, s28
  s_add_u32 s56, s56, 768
  s_lshl_b32 s56, s56, 7
  s_mov_b32 s39, 50
ll13:
  s_waitcnt vmcnt(10)
  s_barrier
  s_add_u32 s30, s30, 1
  s_and_b32 s30, s30, 7
  s_cselect_b32 s32, 0, 1
  s_add_u32 s31, s31, s32
  s_sub_u32 s32, s30, s7
  s_and_b32 s32, s32, 7
  s_cmp_lt_u32 s32, 2
  s_cselect_b32 s32, 1, 0
  s_add_u32 s32, s32, s31
  s_cmp_ge_u32 s32, 7
  s_cselect_b32 s32, 0, s32
  s_lshl_b32 s33, s32, 3
  s_add_u32 s33, s33, s30
  s_mul_i32 s37, s33, 262144
  s_add_u32 s37, s37, s35
  s_add_u32 m0, s38, s45
  s_nop 0
  buffer_load_dwordx4 v9, s[12:15], s37 offen offset:0  lds
  buffer_load_dwordx4 v10, s[12:15], s37 offen offset:1024  lds
  s_add_u32 s38, s38, 8192
  s_cmp_eq_u32 s38, 163840
  s_cselect_b32 s38, 98304, s38
  s_sub_u32 s39, s39, 1
  s_cmp_lg_u32 s39, 0
  s_cbranch_scc1 ll13
  s_waitcnt vmcnt(10)
  s_barrier
  s_waitcnt vmcnt(8)
  s_barrier
  s_waitcnt vmcnt(6)
  s_barrier
  s_waitcnt vmcnt(4)
  s_barrier
  s_waitcnt vmcnt(2)
  s_barrier
  s_waitcnt vmcnt(0)
  s_barrier
  s_cmp_lg_u32 s3, 0
  s_cbranch_scc1 L_end
  s_lshr_b32 s32, s2, 3
  s_lshr_b32 s5, s32, 3
  s_and_b32 s6, s32, 7
  s_lshl_b32 s7, s5, 1
  s_add_u32 s7, s7, s6
  s_and_b32 s7, s7, 7
  s_and_b32 s32, s2, 7
  s_lshr_b32 s28, s32, 1
  s_lshl_b32 s28, s28, 2
  s_add_u32 s28, s28, s5
  s_and_b32 s29, s32, 1
  s_mul_i32 s29, s29, 8
  s_add_u32 s29, s29, s6
  s_mov_b32 s30, 7
  s_mov_b32 s31, -1
  s_mov_b32 s41, s57
  s_mul_i32 s32, s41, 16
  s_add_u32 s32, s32, 0
  v_lshrrev_b32 v2, 3, v0
  v_add_u32 v2, s32, v2
  v_bfe_u32 v3, v2, 1, 1
  v_bfe_u32 v4, v2, 3, 1
  v_lshl_or_b32 v3, v4, 1, v3
  v_lshlrev_b32 v3, 1, v3
  v_and_b32 v4, 7, v0
  v_xor_b32 v3, v3, v4
  v_lshlrev_b32 v3, 4, v3
  s_mov_b32 s32, 6144
  v_mul_lo_u32 v2, v2, s32
  v_add_u32 v13, v2, v3
  s_mul_i32 s32, s41, 16
  s_add_u32 s32, s32, 8
  v_lshrrev_b32 v2, 3, v0
  v_add_u32 v2, s32, v2
  v_bfe_u32 v3, v2, 1, 1
  v_bfe_u32 v4, v2, 3, 1
  v_lshl_or_b32 v3, v4, 1, v3
  v_lshlrev_b32 v3, 1, v3
  v_and_b32 v4, 7, v0
  v_xor_b32 v3, v3, v4
  v_lshlrev_b32 v3, 4, v3
  s_mov_b32 s32, 6144
  v_mul_lo_u32 v2, v2, s32
  v_add_u32 v14, v2, v3
  v_subrev_u32 v14, 1024, v14
  v_add_u32 v15, 2048, v13
  v_add_u32 v16, 2048, v14
  v_add_u32 v17, 4096, v13
  v_add_u32 v18, 4096, v14
  s_lshl_b32 s46, s41, 11
  s_add_u32 s46, s46, 18432
  s_add_u32 s47, s46, 8192
  s_add_u32 s48, s46, 16384
  s_lshl_b32 s35, s29, 7
  s_mov_b32 s12, s66
  s_mov_b32 s13, s67
  s_mov_b32 s14, 6291456
  s_mov_b32 s15, 0x20000
  s_mov_b32 s30, 7
  s_mov_b32 s31, -1
  s_mov_b32 s38, 0
  s_add_u32 s30, s30, 1
  s_and_b32 s30, s30, 7
  s_cselect_b32 s32, 0, 1
  s_add_u32 s31, s31, s32
  s_sub_u32 s32, s30, s7
  s_and_b32 s32, s32, 7
  s_cmp_lt_u32 s32, 2
  s_cselect_b32 s32, 1, 0
  s_add_u32 s32, s32, s31
  s_cmp_ge_u32 s32, 2
  s_cselect_b32 s32, 0, s32
  s_lshl_b32 s33, s32, 3
  s_add_u32 s33, s33, s30
  s_mul_i32 s37, s33, 393216
  s_add_u32 s37, s37, s35
  s_add_u32 m0, s38, s46
  s_nop 0
  buffer_load_dwordx4 v13, s[12:15], s37 offen offset:0  lds
  buffer_load_dwordx4 v14, s[12:15], s37 offen offset:1024  lds
  s_add_u32 m0, s38, s47
  s_nop 0
  buffer_load_dwordx4 v15, s[12:15], s37 offen offset:0  lds
  buffer_load_dwordx4 v16, s[12:15], s37 offen offset:1024  lds
  s_add_u32 m0, s38, s48
  s_nop 0
  buffer_load_dwordx4 v17, s[12:15], s37 offen offset:0  lds
  buffer_load_dwordx4 v18, s[12:15], s37 offen offset:1024  lds
  s_add_u32 s38, s38, 43008
  s_cmp_eq_u32 s38, 129024
  s_cselect_b32 s38, 0, s38
  s_add_u32 s30, s30, 1
  s_and_b32 s30, s30, 7
  s_cselect_b32 s32, 0, 1
  s_add_u32 s31, s31, s32
  s_sub_u32 s32, s30, s7
  s_and_b32 s32, s32, 7
  s_cmp_lt_u32 s32, 2
  s_cselect_b32 s32, 1, 0
  s_add_u32 s32, s32, s31
  s_cmp_ge_u32 s32, 2
  s_cselect_b32 s32, 0, s32
  s_lshl_b32 s33, s32, 3
  s_add_u32 s33, s33, s30
  s_mul_i32 s37, s33, 393216
  s_add_u32 s37, s37, s35
  s_add_u32 m0, s38, s46
  s_nop 0
  buffer_load_dwordx4 v13, s[12:15], s37 offen offset:0  lds
  buffer_load_dwordx4 v14, s[12:15], s37 offen offset:1024  lds
  s_add_u32 m0, s38, s47
  s_nop 0
  buffer_load_dwordx4 v15, s[12:15], s37 offen offset:0  lds
  buffer_load_dwordx4 v16, s[12:15], s37 offen offset:1024  lds
  s_add_u32 m0, s38, s48
  s_nop 0
  buffer_load_dwordx4 v17, s[12:15], s37 offen offset:0  lds
  buffer_load_dwordx4 v18, s[12:15], s37 offen offset:1024  lds
  s_add_u32 s38, s38, 43008
  s_cmp_eq_u32 s38, 129024
  s_cselect_b32 s38, 0, s38
  s_lshl_b32 s40, s28, 7
  s_sub_u32 s40, s40, 16
  s_lshl_b32 s32, s41, 5
  s_add_u32 s32, s32, 16
  v_lshrrev_b32 v2, 3, v0
  v_add_u32 v2, s32, v2
  v_bfe_u32 v3, v2, 1, 3
  v_and_b32 v4, 7, v0
  v_xor_b32 v3, v3, v4
  v_lshlrev_b32 v3, 4, v3
  v_add_u32 v2, s40, v2
  v_max_i32 v2, 0, v2
  v_lshlrev_b32 v2, 11, v2
  v_add_u32 v8, v2, v3
  v_add_u32 v10, 30720, v8
  s_lshl_b32 s32, s41, 5
  s_add_u32 s32, s32, 24
  v_lshrrev_b32 v2, 3, v0
  v_add_u32 v2, s32, v2
  v_bfe_u32 v3, v2, 1, 3
  v_and_b32 v4, 7, v0
  v_xor_b32 v3, v3, v4
  v_lshlrev_b32 v3, 4, v3
  v_add_u32 v2, s40, v2
  v_max_i32 v2, 0, v2
  v_lshlrev_b32 v2, 11, v2
  v_add_u32 v9, v2, v3
  v_subrev_u32 v9, 1024, v9
  v_add_u32 v11, 30720, v9
  s_lshl_b32 s32, s41, 3
  v_lshrrev_b32 v2, 3, v0
  v_add_u32 v2, s32, v2
  v_bfe_u32 v3, v2, 1, 3
  v_and_b32 v4, 7, v0
  v_xor_b32 v3, v3, v4
  v_lshlrev_b32 v3, 4, v3
  v_add_u32 v2, s40, v2
  v_max_i32 v2, 0, v2
  v_lshlrev_b32 v2, 11, v2
  v_add_u32 v12, v2, v3
  s_lshl_b32 s44, s41, 12
  s_add_u32 s44, s44, 2048
  s_lshl_b32 s45, s41, 10
  s_mov_b32 s34, 0
  s_cmp_eq_u32 s41, 0
  s_cselect_b32 s52, 0xffffff00, -1
  s_mov_b32 s53, -1
  v_mov_b32 v20, 0x3f803f80
  v_mov_b32 v21, v20
  v_mov_b32 v22, v20
  v_mov_b32 v23, v20
  v_lshlrev_b32 v24, 4, v0
  v_add_u32 v25, 86016, v24
  s_mov_b64 exec, 0xff
  ds_write_b128 v24, v[20:23]
  ds_write_b128 v24, v[20:23] offset:43008
  ds_write_b128 v25, v[20:23]
  s_mov_b64 exec, -1
  s_add_u32 s8, s84, 25165824
  s_addc_u32 s9, s85, 0
  s_mov_b32 s10, 4194304
  s_mov_b32 s11, 0x20000
  s_add_u32 s20, s84, 55574528
  s_addc_u32 s21, s85, 0
  s_mov_b32 s22, 131072
  s_mov_b32 s23, 0x20000
  s_lshl_b32 s32, s41, 6
  v_add_u32 v26, s32, v0
  v_min_u32 v26, 143, v26
  v_add_u32 v27, s40, v26
  v_max_i32 v27, 0, v27
  v_lshlrev_b32 v27, 3, v27
  v_lshlrev_b32 v26, 3, v26
  v_add_u32 v26, 129024, v26
  s_waitcnt lgkmcnt(0)
  s_add_u32 s16, s84, 29360128
  s_addc_u32 s17, s85, 0
  s_mov_b32 s18, 262144
  s_mov_b32 s19, 0x20000
  s_lshl_b32 s32, s28, 4
  s_sub_u32 s32, s32, 8
  v_min_u32 v28, 23, v0
  v_add_u32 v28, s32, v28
  v_max_i32 v28, 0, v28
  v_lshlrev_b32 v28, 7, v28
  s_lshl_b32 s55, s3, 17
  s_add_u32 s55, s55, 98304
  s_barrier
  s_barrier
  s_cmp_lg_u32 s57, 0
  s_cbranch_scc1 pub14
  s_add_u32 s24, s84, 29360128
  s_addc_u32 s25, s85, 0
  s_mov_b32 s26, 262144
  s_mov_b32 s27, 0x20000
  v_mov_b32 v2, 0
  v_mov_b32 v3, 1
  s_mov_b64 exec, 1
  buffer_store_dword v3, v2, s[24:27], s56 offen sc0 sc1
  s_mov_b64 exec, -1
pub14:
  s_mov_b32 s39, 0
poll15:
  buffer_load_dword v29, v28, s[16:19], s55 offen sc0 sc1
  s_waitcnt vmcnt(0)
  v_cmp_eq_u32 vcc, 0, v29
  s_add_u32 s39, s39, 1
  s_cmp_gt_u32 s39, 100000
  s_cbranch_scc1 poll15d
  s_cbranch_vccnz poll15
poll15d:
  s_mov_b32 s3, 1
  s_add_u32 s82, s84, 33554432
  s_addc_u32 s83, s85, 0
  s_branch L_top
L_end:
mega_end:
  s_endpgm
.section .rodata,"a"
.p2align 6
.amdhsa_kernel k0_kernel
  .amdhsa_next_free_vgpr 32
  .amdhsa_next_free_sgpr 102
  .amdhsa_accum_offset 32
  .amdhsa_group_segment_fixed_size 0
  .amdhsa_kernarg_size 88
  .amdhsa_user_sgpr_count 2
  .amdhsa_user_sgpr_kernarg_segment_ptr 1
  .amdhsa_system_sgpr_workgroup_id_x 1
.end_amdhsa_kernel
.p2align 6
.amdhsa_kernel mega_kernel
  .amdhsa_next_free_vgpr 224
  .amdhsa_next_free_sgpr 102
  .amdhsa_accum_offset 224
  .amdhsa_group_segment_fixed_size 0
  .amdhsa_kernarg_size 88
  .amdhsa_user_sgpr_count 2
  .amdhsa_user_sgpr_kernarg_segment_ptr 1
  .amdhsa_system_sgpr_workgroup_id_x 1
.end_amdhsa_kernel
```

```asm
; @launch grid=(256,1,1) block=(512,1,1) lds=163840
.amdgcn_target "amdgcn-amd-amdhsa--gfx950"
.text
.globl interleave_layers__sliding_local_dilated__mixer_token_mlp__prompt_kernel
.type interleave_layers__sliding_local_dilated__mixer_token_mlp__prompt_kernel,@function
.p2align 8
interleave_layers__sliding_local_dilated__mixer_token_mlp__prompt_kernel:
  s_cmp_ge_u32 s2, 256
  s_cbranch_scc1 mega_end
  s_load_dwordx16 s[64:79], s[0:1], 0
  s_load_dwordx2 s[80:81], s[0:1], 64
  s_load_dwordx2 s[84:85], s[0:1], 80
  s_load_dwordx2 s[62:63], s[0:1], 72
  v_lshrrev_b32 v1, 6, v0
  v_and_b32 v0, 63, v0
  v_readfirstlane_b32 s4, v1
  s_mov_b32 s3, 0
  v_mov_b32 v130, 0
  v_mov_b32 v131, 0
  v_mov_b32 v220, 0
  v_mov_b32 v134, 0
  s_cmp_ge_u32 s4, 4
  s_cbranch_scc1 L_start
  s_lshl_b32 s32, s2, 3
  s_lshl_b32 s40, s4, 1
  s_add_u32 s32, s32, s40
  v_lshrrev_b32 v16, 5, v0
  v_add_u32 v16, s32, v16
  v_lshlrev_b32 v17, 11, v16
  v_and_b32 v18, 31, v0
  v_lshl_add_u32 v17, v18, 4, v17
  v_lshlrev_b32 v16, 3, v16
  v_add_u32 v16, 22020096, v16
  s_cmp_eq_u32 s4, 0
  s_cselect_b32 s44, 0, -1
  v_mov_b32 v24, s44
  v_mov_b32 v25, s44
  v_mov_b32 v26, s44
  v_mov_b32 v27, s44
  v_lshrrev_b32 v19, 3, v0
  v_lshlrev_b32 v19, 15, v19
  v_and_b32 v20, 7, v0
  v_lshl_add_u32 v19, v20, 4, v19
  v_lshlrev_b32 v20, 4, v0
  s_cselect_b64 vcc, -1, 0
  s_lshl_b32 s45, s2, 7
  s_add_u32 s45, s45, 29360128
  s_lshl_b32 s46, s2, 10
  s_add_u32 s46, s46, 20971520
  s_cmp_eq_u32 s4, 0
  s_cselect_b32 s45, s45, s46
  s_add_u32 s46, s46, 33554432
  s_cmp_eq_u32 s4, 2
  s_cselect_b32 s45, s46, s45
  v_cndmask_b32 v19, v20, v19, vcc
  s_waitcnt lgkmcnt(0)
  s_mov_b32 s8, s64
  s_mov_b32 s9, s65
  s_mov_b32 s10, 4194304
  s_mov_b32 s11, 0x20000
  buffer_load_dwordx4 v[32:35], v17, s[8:11], 0 offen offset:0
  buffer_load_dwordx4 v[36:39], v17, s[8:11], 0 offen offset:512
  buffer_load_dwordx4 v[40:43], v17, s[8:11], 0 offen offset:1024
  buffer_load_dwordx4 v[44:47], v17, s[8:11], 0 offen offset:1536
  s_mov_b32 s20, s66
  s_mov_b32 s21, s67
  s_mov_b32 s22, 6291456
  s_mov_b32 s23, 0x20000
  s_mov_b32 s24, s68
  s_mov_b32 s25, s69
  s_mov_b32 s26, 2097152
  s_mov_b32 s27, 0x20000
  s_lshl_b32 s47, s4, 8
  s_add_u32 s47, s47, s2
  s_lshl_b32 s47, s47, 13
  v_lshlrev_b32 v21, 7, v0
  v_add_u32 v21, s47, v21
  v_subrev_u32 v22, 6291456, v21
  buffer_load_dword v222, v21, s[20:23], 0 offen
  buffer_load_dword v223, v22, s[24:27], 0 offen
  s_mov_b32 s16, s84
  s_mov_b32 s17, s85
  s_mov_b32 s18, 67108864
  s_mov_b32 s19, 0x20000
  s_mov_b32 s12, s84
  s_mov_b32 s13, s85
  s_mov_b32 s14, 0
  s_mov_b32 s15, 0x20000
  s_cmp_eq_u32 s4, 3
  s_cbranch_scc1 C_nors
  buffer_store_dwordx4 v[24:27], v19, s[16:19], s45 offen sc0 sc1
C_nors:
  s_lshr_b32 s32, s2, 3
  s_lshr_b32 s5, s32, 3
  s_and_b32 s6, s32, 7
  s_lshl_b32 s7, s5, 1
  s_add_u32 s7, s7, s6
  s_and_b32 s7, s7, 7
  s_and_b32 s32, s2, 7
  s_lshr_b32 s28, s32, 1
  s_lshl_b32 s28, s28, 2
  s_add_u32 s28, s28, s5
  s_and_b32 s29, s32, 1
  s_mul_i32 s29, s29, 8
  s_add_u32 s29, s29, s6
  s_mov_b32 s30, 7
  s_mov_b32 s31, -1
  v_and_b32 v4, 15, v0
  v_lshrrev_b32 v5, 4, v0
  v_lshrrev_b32 v6, 2, v4
  v_and_b32 v7, 3, v0
  v_lshrrev_b32 v3, 5, v0
  v_and_b32 v2, 1, v5
  v_lshl_or_b32 v3, v2, 1, v3
  v_lshl_add_u32 v21, v5, 3, v6
  v_lshlrev_b32 v21, 7, v21
  v_lshl_add_u32 v21, v7, 3, v21
  v_lshrrev_b32 v22, 1, v6
  v_lshl_or_b32 v22, v2, 1, v22
  v_lshl_add_u32 v21, v22, 5, v21
  v_add_u32 v21, 18432, v21
  v_xor_b32 v8, 0, v21
  s_lshl_b32 s32, s4, 5
  v_xor_b32 v8, s32, v8
  v_lshrrev_b32 v21, 1, v4
  v_xor_b32 v21, v21, v5
  v_lshlrev_b32 v21, 4, v21
  v_lshlrev_b32 v22, 7, v4
  v_add_u32 v9, v21, v22
  v_xor_b32 v10, 64, v9
  v_and_b32 v21, 1, v4
  v_mul_u32_u24 v21, 28800, v21
  v_lshrrev_b32 v22, 1, v4
  v_mul_u32_u24 v22, 400, v22
  v_lshlrev_b32 v23, 3, v5
  v_add3_u32 v11, v21, v22, v23
  s_add_u32 s32, s32, 43008
  v_add_u32 v11, s32, v11
  v_lshlrev_b32 v12, 3, v4
  v_add_u32 v12, 129024, v12
  v_mov_b64 v[112:113], 0
  v_mov_b64 v[114:115], 0
  v_mov_b64 v[116:117], 0
  v_mov_b64 v[118:119], 0
  v_mov_b64 v[120:121], 0
  v_mov_b64 v[122:123], 0
  v_mov_b64 v[124:125], 0
  v_mov_b64 v[126:127], 0
  v_mov_b64 v[128:129], 0
  v_mov_b64 v[130:131], 0
  v_mov_b64 v[132:133], 0
  v_mov_b64 v[134:135], 0
  v_mov_b64 v[136:137], 0
  v_mov_b64 v[138:139], 0
  v_mov_b64 v[140:141], 0
  v_mov_b64 v[142:143], 0
  v_mov_b64 v[144:145], 0
  v_mov_b64 v[146:147], 0
  v_mov_b64 v[148:149], 0
  v_mov_b64 v[150:151], 0
  v_mov_b64 v[152:153], 0
  v_mov_b64 v[154:155], 0
  v_mov_b64 v[156:157], 0
  v_mov_b64 v[158:159], 0
  v_mov_b64 v[160:161], 0
  v_mov_b64 v[162:163], 0
  v_mov_b64 v[164:165], 0
  v_mov_b64 v[166:167], 0
  v_mov_b64 v[168:169], 0
  v_mov_b64 v[170:171], 0
  v_mov_b64 v[172:173], 0
  v_mov_b64 v[174:175], 0
  v_mov_b64 v[176:177], 0
  v_mov_b64 v[178:179], 0
  v_mov_b64 v[180:181], 0
  v_mov_b64 v[182:183], 0
  v_mov_b64 v[184:185], 0
  v_mov_b64 v[186:187], 0
  v_mov_b64 v[188:189], 0
  v_mov_b64 v[190:191], 0
  v_mov_b64 v[192:193], 0
  v_mov_b64 v[194:195], 0
  v_mov_b64 v[196:197], 0
  v_mov_b64 v[198:199], 0
  v_mov_b64 v[200:201], 0
  v_mov_b64 v[202:203], 0
  v_mov_b64 v[204:205], 0
  v_mov_b64 v[206:207], 0
  v_mov_b64 v[208:209], 0
  v_mov_b64 v[210:211], 0
  v_mov_b64 v[212:213], 0
  v_mov_b64 v[214:215], 0
  v_mov_b64 v[216:217], 0
  v_mov_b64 v[218:219], 0
  s_waitcnt lgkmcnt(0)
  s_mov_b32 s82, s84
  s_mov_b32 s83, s85
  v_mov_b32 v28, 0
  v_mov_b32 v29, 0
  v_mov_b32 v31, 0x3f803f80
  s_and_b32 s44, s2, 3
  s_lshl_b32 s44, s44, 6
  v_mov_b32 v220, s44
  v_mov_b32 v221, 1
  s_cmp_eq_u32 s4, 3
  s_cbranch_scc0 C_w1
  s_waitcnt vmcnt(2)
C_w1:
  s_waitcnt vmcnt(3)
  v_dot2c_f32_bf16 v28, v31, v32
  v_dot2c_f32_bf16 v29, v32, v32
  v_dot2c_f32_bf16 v28, v31, v33
  v_dot2c_f32_bf16 v29, v33, v33
  v_dot2c_f32_bf16 v28, v31, v34
  v_dot2c_f32_bf16 v29, v34, v34
  v_dot2c_f32_bf16 v28, v31, v35
  v_dot2c_f32_bf16 v29, v35, v35
  v_dot2c_f32_bf16 v28, v31, v36
  v_dot2c_f32_bf16 v29, v36, v36
  v_dot2c_f32_bf16 v28, v31, v37
  v_dot2c_f32_bf16 v29, v37, v37
  v_dot2c_f32_bf16 v28, v31, v38
  v_dot2c_f32_bf16 v29, v38, v38
  v_dot2c_f32_bf16 v28, v31, v39
  v_dot2c_f32_bf16 v29, v39, v39
  v_dot2c_f32_bf16 v28, v31, v40
  v_dot2c_f32_bf16 v29, v40, v40
  v_dot2c_f32_bf16 v28, v31, v41
  v_dot2c_f32_bf16 v29, v41, v41
  v_dot2c_f32_bf16 v28, v31, v42
  v_dot2c_f32_bf16 v29, v42, v42
  v_dot2c_f32_bf16 v28, v31, v43
  v_dot2c_f32_bf16 v29, v43, v43
  v_dot2c_f32_bf16 v28, v31, v44
  v_dot2c_f32_bf16 v29, v44, v44
  v_dot2c_f32_bf16 v28, v31, v45
  v_dot2c_f32_bf16 v29, v45, v45
  v_dot2c_f32_bf16 v28, v31, v46
  v_dot2c_f32_bf16 v29, v46, v46
  v_dot2c_f32_bf16 v28, v31, v47
  v_dot2c_f32_bf16 v29, v47, v47
  s_nop 1
  v_add_f32_dpp v28, v28, v28 quad_perm:[1,0,3,2] row_mask:0xf bank_mask:0xf
  v_add_f32_dpp v29, v29, v29 quad_perm:[1,0,3,2] row_mask:0xf bank_mask:0xf
  s_nop 0
  v_add_f32_dpp v28, v28, v28 quad_perm:[2,3,0,1] row_mask:0xf bank_mask:0xf
  v_add_f32_dpp v29, v29, v29 quad_perm:[2,3,0,1] row_mask:0xf bank_mask:0xf
  s_nop 0
  v_add_f32_dpp v28, v28, v28 row_half_mirror row_mask:0xf bank_mask:0xf
  v_add_f32_dpp v29, v29, v29 row_half_mirror row_mask:0xf bank_mask:0xf
  s_nop 0
  v_add_f32_dpp v28, v28, v28 row_mirror row_mask:0xf bank_mask:0xf
  v_add_f32_dpp v29, v29, v29 row_mirror row_mask:0xf bank_mask:0xf
  v_mov_b32 v30, v28
  v_mov_b32 v31, v29
  s_nop 0
  v_permlane16_swap_b32 v28, v30
  v_permlane16_swap_b32 v29, v31
  v_add_f32 v28, v28, v30
  v_add_f32 v29, v29, v31
  s_mov_b32 exec_lo, 1
  s_mov_b32 exec_hi, 1
  buffer_store_dwordx2 v[28:29], v16, s[16:19], 0 offen sc0 sc1
  s_mov_b64 exec, -1
C_top:
  s_nop 7
  s_nop 7
  s_or_b32 s51, s3, s4
  s_mov_b32 s43, 0
  s_mov_b32 s39, 14
  s_barrier
  ds_read_b64_tr_b16 v[16:17], v8 offset:0
  ds_read_b64_tr_b16 v[18:19], v8 offset:512
  ds_read_b128 v[28:31], v9 offset:0
  ds_read_b64_tr_b16 v[20:21], v8 offset:8192
  ds_read_b64_tr_b16 v[22:23], v8 offset:8704
  ds_read_b64_tr_b16 v[24:25], v8 offset:16384
  ds_read_b64_tr_b16 v[26:27], v8 offset:16896
  ds_read_b128 v[32:35], v9 offset:2048
  ds_read_b128 v[36:39], v9 offset:4096
  ds_read_b128 v[40:43], v9 offset:6144
  ds_read_b128 v[44:47], v9 offset:8192
  ds_read_b128 v[48:51], v9 offset:10240
  ds_read_b128 v[52:55], v9 offset:12288
  ds_read_b128 v[56:59], v9 offset:14336
  ds_read_b128 v[60:63], v9 offset:16384
  s_add_u32 s40, s43, 43008
  s_cmp_eq_u32 s40, 129024
  s_cselect_b32 s40, 0, s40
  s_sub_u32 s42, s40, s43
  s_mov_b32 s43, s40
  s_waitcnt lgkmcnt(12)
  v_mfma_f32_16x16x32_bf16 v[112:115], v[16:19], v[28:31], v[112:115]
  ds_read_b64_tr_b16 v[64:65], v8 offset:4096
  s_waitcnt lgkmcnt(11)
  v_mfma_f32_16x16x32_bf16 v[148:151], v[20:23], v[28:31], v[148:151]
  ds_read_b64_tr_b16 v[66:67], v8 offset:4608
  s_waitcnt lgkmcnt(10)
  v_mfma_f32_16x16x32_bf16 v[184:187], v[24:27], v[28:31], v[184:187]
  ds_read_b128 v[76:79], v10 offset:0
  s_waitcnt lgkmcnt(10)
  v_mfma_f32_16x16x32_bf16 v[116:119], v[16:19], v[32:35], v[116:119]
  ds_read_b64_tr_b16 v[68:69], v8 offset:12288
  v_mfma_f32_16x16x32_bf16 v[152:155], v[20:23], v[32:35], v[152:155]
  ds_read_b64_tr_b16 v[70:71], v8 offset:12800
  v_mfma_f32_16x16x32_bf16 v[188:191], v[24:27], v[32:35], v[188:191]
  ds_read_b64_tr_b16 v[72:73], v8 offset:20480
  s_waitcnt lgkmcnt(12)
  v_mfma_f32_16x16x32_bf16 v[120:123], v[16:19], v[36:39], v[120:123]
  ds_read_b64_tr_b16 v[74:75], v8 offset:20992
  v_add_u32 v8, s42, v8
  v_mfma_f32_16x16x32_bf16 v[156:159], v[20:23], v[36:39], v[156:159]
  ds_read_b128 v[80:83], v10 offset:2048
  v_mfma_f32_16x16x32_bf16 v[192:195], v[24:27], v[36:39], v[192:195]
  ds_read_b128 v[84:87], v10 offset:4096
  s_waitcnt lgkmcnt(14)
  v_mfma_f32_16x16x32_bf16 v[124:127], v[16:19], v[40:43], v[124:127]
  ds_read_b128 v[88:91], v10 offset:6144
  v_mfma_f32_16x16x32_bf16 v[160:163], v[20:23], v[40:43], v[160:163]
  ds_read_b128 v[92:95], v10 offset:8192
  v_mfma_f32_16x16x32_bf16 v[196:199], v[24:27], v[40:43], v[196:199]
  ds_read_b128 v[96:99], v10 offset:10240
  s_waitcnt lgkmcnt(15)
  v_mfma_f32_16x16x32_bf16 v[128:131], v[16:19], v[44:47], v[128:131]
  ds_read_b128 v[100:103], v10 offset:12288
  v_mfma_f32_16x16x32_bf16 v[164:167], v[20:23], v[44:47], v[164:167]
  ds_read_b128 v[104:107], v10 offset:14336
  v_mfma_f32_16x16x32_bf16 v[200:203], v[24:27], v[44:47], v[200:203]
  ds_read_b128 v[108:111], v10 offset:16384
  v_add_u32 v9, s42, v9
  v_add_u32 v10, s42, v10
  s_waitcnt lgkmcnt(15)
  v_mfma_f32_16x16x32_bf16 v[132:135], v[16:19], v[48:51], v[132:135]
  v_mfma_f32_16x16x32_bf16 v[168:171], v[20:23], v[48:51], v[168:171]
  v_mfma_f32_16x16x32_bf16 v[204:207], v[24:27], v[48:51], v[204:207]
  s_waitcnt lgkmcnt(15)
  v_mfma_f32_16x16x32_bf16 v[136:139], v[16:19], v[52:55], v[136:139]
  v_mfma_f32_16x16x32_bf16 v[172:175], v[20:23], v[52:55], v[172:175]
  v_mfma_f32_16x16x32_bf16 v[208:211], v[24:27], v[52:55], v[208:211]
  s_waitcnt lgkmcnt(15)
  v_mfma_f32_16x16x32_bf16 v[140:143], v[16:19], v[56:59], v[140:143]
  v_mfma_f32_16x16x32_bf16 v[176:179], v[20:23], v[56:59], v[176:179]
  v_mfma_f32_16x16x32_bf16 v[212:215], v[24:27], v[56:59], v[212:215]
  s_waitcnt lgkmcnt(15)
  v_mfma_f32_16x16x32_bf16 v[144:147], v[16:19], v[60:63], v[144:147]
  v_mfma_f32_16x16x32_bf16 v[180:183], v[20:23], v[60:63], v[180:183]
  v_mfma_f32_16x16x32_bf16 v[216:219], v[24:27], v[60:63], v[216:219]
  s_waitcnt lgkmcnt(0)
  s_waitcnt vmcnt(0)
  s_barrier
  s_cmp_lg_u32 s51, 0
  s_cbranch_scc1 C_nogate
  s_mov_b64 exec, 1
  global_atomic_add v220, v221, s[62:63] sc1
  s_mov_b64 exec, -1
C_nogate:
  v_mfma_f32_16x16x32_bf16 v[112:115], v[64:67], v[76:79], v[112:115]
  ds_read_b64_tr_b16 v[16:17], v8 offset:0
  s_add_u32 s40, s43, 43008
  v_mfma_f32_16x16x32_bf16 v[148:151], v[68:71], v[76:79], v[148:151]
  ds_read_b64_tr_b16 v[18:19], v8 offset:512
  s_cmp_eq_u32 s40, 129024
  v_mfma_f32_16x16x32_bf16 v[184:187], v[72:75], v[76:79], v[184:187]
  ds_read_b128 v[28:31], v9 offset:0
  s_cselect_b32 s40, 0, s40
  v_mfma_f32_16x16x32_bf16 v[116:119], v[64:67], v[80:83], v[116:119]
  ds_read_b64_tr_b16 v[20:21], v8 offset:8192
  s_sub_u32 s42, s40, s43
  v_mfma_f32_16x16x32_bf16 v[152:155], v[68:71], v[80:83], v[152:155]
  ds_read_b64_tr_b16 v[22:23], v8 offset:8704
  s_mov_b32 s43, s40
  v_mfma_f32_16x16x32_bf16 v[188:191], v[72:75], v[80:83], v[188:191]
  ds_read_b64_tr_b16 v[24:25], v8 offset:16384
  v_mfma_f32_16x16x32_bf16 v[120:123], v[64:67], v[84:87], v[120:123]
  ds_read_b64_tr_b16 v[26:27], v8 offset:16896
  v_mfma_f32_16x16x32_bf16 v[156:159], v[68:71], v[84:87], v[156:159]
  ds_read_b128 v[32:35], v9 offset:2048
  v_mfma_f32_16x16x32_bf16 v[192:195], v[72:75], v[84:87], v[192:195]
  ds_read_b128 v[36:39], v9 offset:4096
  v_mfma_f32_16x16x32_bf16 v[124:127], v[64:67], v[88:91], v[124:127]
  ds_read_b128 v[40:43], v9 offset:6144
  v_mfma_f32_16x16x32_bf16 v[160:163], v[68:71], v[88:91], v[160:163]
  ds_read_b128 v[44:47], v9 offset:8192
  v_mfma_f32_16x16x32_bf16 v[196:199], v[72:75], v[88:91], v[196:199]
  ds_read_b128 v[48:51], v9 offset:10240
  v_mfma_f32_16x16x32_bf16 v[128:131], v[64:67], v[92:95], v[128:131]
  ds_read_b128 v[52:55], v9 offset:12288
  v_mfma_f32_16x16x32_bf16 v[164:167], v[68:71], v[92:95], v[164:167]
  ds_read_b128 v[56:59], v9 offset:14336
  v_mfma_f32_16x16x32_bf16 v[200:203], v[72:75], v[92:95], v[200:203]
  ds_read_b128 v[60:63], v9 offset:16384
  v_mfma_f32_16x16x32_bf16 v[132:135], v[64:67], v[96:99], v[132:135]
  v_mfma_f32_16x16x32_bf16 v[168:171], v[68:71], v[96:99], v[168:171]
  v_mfma_f32_16x16x32_bf16 v[204:207], v[72:75], v[96:99], v[204:207]
  v_mfma_f32_16x16x32_bf16 v[136:139], v[64:67], v[100:103], v[136:139]
  v_mfma_f32_16x16x32_bf16 v[172:175], v[68:71], v[100:103], v[172:175]
  v_mfma_f32_16x16x32_bf16 v[208:211], v[72:75], v[100:103], v[208:211]
  v_mfma_f32_16x16x32_bf16 v[140:143], v[64:67], v[104:107], v[140:143]
  v_mfma_f32_16x16x32_bf16 v[176:179], v[68:71], v[104:107], v[176:179]
  v_mfma_f32_16x16x32_bf16 v[212:215], v[72:75], v[104:107], v[212:215]
  v_mfma_f32_16x16x32_bf16 v[144:147], v[64:67], v[108:111], v[144:147]
  v_mfma_f32_16x16x32_bf16 v[180:183], v[68:71], v[108:111], v[180:183]
  v_mfma_f32_16x16x32_bf16 v[216:219], v[72:75], v[108:111], v[216:219]
cl1:
  s_waitcnt lgkmcnt(12)
  v_mfma_f32_16x16x32_bf16 v[112:115], v[16:19], v[28:31], v[112:115]
  ds_read_b64_tr_b16 v[64:65], v8 offset:4096
  s_waitcnt lgkmcnt(11)
  v_mfma_f32_16x16x32_bf16 v[148:151], v[20:23], v[28:31], v[148:151]
  ds_read_b64_tr_b16 v[66:67], v8 offset:4608
  s_waitcnt lgkmcnt(10)
  v_mfma_f32_16x16x32_bf16 v[184:187], v[24:27], v[28:31], v[184:187]
  ds_read_b128 v[76:79], v10 offset:0
  s_waitcnt lgkmcnt(10)
  v_mfma_f32_16x16x32_bf16 v[116:119], v[16:19], v[32:35], v[116:119]
  ds_read_b64_tr_b16 v[68:69], v8 offset:12288
  v_mfma_f32_16x16x32_bf16 v[152:155], v[20:23], v[32:35], v[152:155]
  ds_read_b64_tr_b16 v[70:71], v8 offset:12800
  v_mfma_f32_16x16x32_bf16 v[188:191], v[24:27], v[32:35], v[188:191]
  ds_read_b64_tr_b16 v[72:73], v8 offset:20480
  s_waitcnt lgkmcnt(12)
  v_mfma_f32_16x16x32_bf16 v[120:123], v[16:19], v[36:39], v[120:123]
  ds_read_b64_tr_b16 v[74:75], v8 offset:20992
  v_add_u32 v8, s42, v8
  v_mfma_f32_16x16x32_bf16 v[156:159], v[20:23], v[36:39], v[156:159]
  ds_read_b128 v[80:83], v10 offset:2048
  v_mfma_f32_16x16x32_bf16 v[192:195], v[24:27], v[36:39], v[192:195]
  ds_read_b128 v[84:87], v10 offset:4096
  s_waitcnt lgkmcnt(14)
  v_mfma_f32_16x16x32_bf16 v[124:127], v[16:19], v[40:43], v[124:127]
  ds_read_b128 v[88:91], v10 offset:6144
  v_mfma_f32_16x16x32_bf16 v[160:163], v[20:23], v[40:43], v[160:163]
  ds_read_b128 v[92:95], v10 offset:8192
  v_mfma_f32_16x16x32_bf16 v[196:199], v[24:27], v[40:43], v[196:199]
  ds_read_b128 v[96:99], v10 offset:10240
  s_waitcnt lgkmcnt(15)
  v_mfma_f32_16x16x32_bf16 v[128:131], v[16:19], v[44:47], v[128:131]
  ds_read_b128 v[100:103], v10 offset:12288
  v_mfma_f32_16x16x32_bf16 v[164:167], v[20:23], v[44:47], v[164:167]
  ds_read_b128 v[104:107], v10 offset:14336
  v_mfma_f32_16x16x32_bf16 v[200:203], v[24:27], v[44:47], v[200:203]
  ds_read_b128 v[108:111], v10 offset:16384
  v_add_u32 v9, s42, v9
  v_add_u32 v10, s42, v10
  s_waitcnt lgkmcnt(15)
  v_mfma_f32_16x16x32_bf16 v[132:135], v[16:19], v[48:51], v[132:135]
  v_mfma_f32_16x16x32_bf16 v[168:171], v[20:23], v[48:51], v[168:171]
  v_mfma_f32_16x16x32_bf16 v[204:207], v[24:27], v[48:51], v[204:207]
  s_waitcnt lgkmcnt(15)
  v_mfma_f32_16x16x32_bf16 v[136:139], v[16:19], v[52:55], v[136:139]
  v_mfma_f32_16x16x32_bf16 v[172:175], v[20:23], v[52:55], v[172:175]
  v_mfma_f32_16x16x32_bf16 v[208:211], v[24:27], v[52:55], v[208:211]
  s_waitcnt lgkmcnt(15)
  v_mfma_f32_16x16x32_bf16 v[140:143], v[16:19], v[56:59], v[140:143]
  v_mfma_f32_16x16x32_bf16 v[176:179], v[20:23], v[56:59], v[176:179]
  v_mfma_f32_16x16x32_bf16 v[212:215], v[24:27], v[56:59], v[212:215]
  s_waitcnt lgkmcnt(15)
  v_mfma_f32_16x16x32_bf16 v[144:147], v[16:19], v[60:63], v[144:147]
  v_mfma_f32_16x16x32_bf16 v[180:183], v[20:23], v[60:63], v[180:183]
  v_mfma_f32_16x16x32_bf16 v[216:219], v[24:27], v[60:63], v[216:219]
  s_waitcnt lgkmcnt(0)
  s_barrier
  v_mfma_f32_16x16x32_bf16 v[112:115], v[64:67], v[76:79], v[112:115]
  ds_read_b64_tr_b16 v[16:17], v8 offset:0
  s_add_u32 s40, s43, 43008
  v_mfma_f32_16x16x32_bf16 v[148:151], v[68:71], v[76:79], v[148:151]
  ds_read_b64_tr_b16 v[18:19], v8 offset:512
  s_cmp_eq_u32 s40, 129024
  v_mfma_f32_16x16x32_bf16 v[184:187], v[72:75], v[76:79], v[184:187]
  ds_read_b128 v[28:31], v9 offset:0
  s_cselect_b32 s40, 0, s40
  v_mfma_f32_16x16x32_bf16 v[116:119], v[64:67], v[80:83], v[116:119]
  ds_read_b64_tr_b16 v[20:21], v8 offset:8192
  s_sub_u32 s42, s40, s43
  v_mfma_f32_16x16x32_bf16 v[152:155], v[68:71], v[80:83], v[152:155]
  ds_read_b64_tr_b16 v[22:23], v8 offset:8704
  s_mov_b32 s43, s40
  v_mfma_f32_16x16x32_bf16 v[188:191], v[72:75], v[80:83], v[188:191]
  ds_read_b64_tr_b16 v[24:25], v8 offset:16384
  v_mfma_f32_16x16x32_bf16 v[120:123], v[64:67], v[84:87], v[120:123]
  ds_read_b64_tr_b16 v[26:27], v8 offset:16896
  v_mfma_f32_16x16x32_bf16 v[156:159], v[68:71], v[84:87], v[156:159]
  ds_read_b128 v[32:35], v9 offset:2048
  v_mfma_f32_16x16x32_bf16 v[192:195], v[72:75], v[84:87], v[192:195]
  ds_read_b128 v[36:39], v9 offset:4096
  v_mfma_f32_16x16x32_bf16 v[124:127], v[64:67], v[88:91], v[124:127]
  ds_read_b128 v[40:43], v9 offset:6144
  v_mfma_f32_16x16x32_bf16 v[160:163], v[68:71], v[88:91], v[160:163]
  ds_read_b128 v[44:47], v9 offset:8192
  v_mfma_f32_16x16x32_bf16 v[196:199], v[72:75], v[88:91], v[196:199]
  ds_read_b128 v[48:51], v9 offset:10240
  v_mfma_f32_16x16x32_bf16 v[128:131], v[64:67], v[92:95], v[128:131]
  ds_read_b128 v[52:55], v9 offset:12288
  v_mfma_f32_16x16x32_bf16 v[164:167], v[68:71], v[92:95], v[164:167]
  ds_read_b128 v[56:59], v9 offset:14336
  v_mfma_f32_16x16x32_bf16 v[200:203], v[72:75], v[92:95], v[200:203]
  ds_read_b128 v[60:63], v9 offset:16384
  v_mfma_f32_16x16x32_bf16 v[132:135], v[64:67], v[96:99], v[132:135]
  v_mfma_f32_16x16x32_bf16 v[168:171], v[68:71], v[96:99], v[168:171]
  v_mfma_f32_16x16x32_bf16 v[204:207], v[72:75], v[96:99], v[204:207]
  v_mfma_f32_16x16x32_bf16 v[136:139], v[64:67], v[100:103], v[136:139]
  v_mfma_f32_16x16x32_bf16 v[172:175], v[68:71], v[100:103], v[172:175]
  v_mfma_f32_16x16x32_bf16 v[208:211], v[72:75], v[100:103], v[208:211]
  v_mfma_f32_16x16x32_bf16 v[140:143], v[64:67], v[104:107], v[140:143]
  v_mfma_f32_16x16x32_bf16 v[176:179], v[68:71], v[104:107], v[176:179]
  v_mfma_f32_16x16x32_bf16 v[212:215], v[72:75], v[104:107], v[212:215]
  v_mfma_f32_16x16x32_bf16 v[144:147], v[64:67], v[108:111], v[144:147]
  v_mfma_f32_16x16x32_bf16 v[180:183], v[68:71], v[108:111], v[180:183]
  v_mfma_f32_16x16x32_bf16 v[216:219], v[72:75], v[108:111], v[216:219]
  s_sub_u32 s39, s39, 1
  s_cmp_lg_u32 s39, 0
  s_cbranch_scc1 cl1
  s_waitcnt lgkmcnt(12)
  v_mfma_f32_16x16x32_bf16 v[112:115], v[16:19], v[28:31], v[112:115]
  ds_read_b64_tr_b16 v[64:65], v8 offset:4096
  s_waitcnt lgkmcnt(11)
  v_mfma_f32_16x16x32_bf16 v[148:151], v[20:23], v[28:31], v[148:151]
  ds_read_b64_tr_b16 v[66:67], v8 offset:4608
  s_waitcnt lgkmcnt(10)
  v_mfma_f32_16x16x32_bf16 v[184:187], v[24:27], v[28:31], v[184:187]
  ds_read_b128 v[76:79], v10 offset:0
  s_waitcnt lgkmcnt(10)
  v_mfma_f32_16x16x32_bf16 v[116:119], v[16:19], v[32:35], v[116:119]
  ds_read_b64_tr_b16 v[68:69], v8 offset:12288
  v_mfma_f32_16x16x32_bf16 v[152:155], v[20:23], v[32:35], v[152:155]
  ds_read_b64_tr_b16 v[70:71], v8 offset:12800
  v_mfma_f32_16x16x32_bf16 v[188:191], v[24:27], v[32:35], v[188:191]
  ds_read_b64_tr_b16 v[72:73], v8 offset:20480
  s_waitcnt lgkmcnt(12)
  v_mfma_f32_16x16x32_bf16 v[120:123], v[16:19], v[36:39], v[120:123]
  ds_read_b64_tr_b16 v[74:75], v8 offset:20992
  v_mfma_f32_16x16x32_bf16 v[156:159], v[20:23], v[36:39], v[156:159]
  ds_read_b128 v[80:83], v10 offset:2048
  v_mfma_f32_16x16x32_bf16 v[192:195], v[24:27], v[36:39], v[192:195]
  ds_read_b128 v[84:87], v10 offset:4096
  s_waitcnt lgkmcnt(14)
  v_mfma_f32_16x16x32_bf16 v[124:127], v[16:19], v[40:43], v[124:127]
  ds_read_b128 v[88:91], v10 offset:6144
  v_mfma_f32_16x16x32_bf16 v[160:163], v[20:23], v[40:43], v[160:163]
  ds_read_b128 v[92:95], v10 offset:8192
  v_mfma_f32_16x16x32_bf16 v[196:199], v[24:27], v[40:43], v[196:199]
  ds_read_b128 v[96:99], v10 offset:10240
  s_waitcnt lgkmcnt(15)
  v_mfma_f32_16x16x32_bf16 v[128:131], v[16:19], v[44:47], v[128:131]
  ds_read_b128 v[100:103], v10 offset:12288
  v_mfma_f32_16x16x32_bf16 v[164:167], v[20:23], v[44:47], v[164:167]
  ds_read_b128 v[104:107], v10 offset:14336
  v_mfma_f32_16x16x32_bf16 v[200:203], v[24:27], v[44:47], v[200:203]
  ds_read_b128 v[108:111], v10 offset:16384
  s_waitcnt lgkmcnt(15)
  v_mfma_f32_16x16x32_bf16 v[132:135], v[16:19], v[48:51], v[132:135]
  ds_read_b64 v[224:225], v12 offset:0
  v_mfma_f32_16x16x32_bf16 v[168:171], v[20:23], v[48:51], v[168:171]
  ds_read_b64 v[226:227], v12 offset:128
  v_mfma_f32_16x16x32_bf16 v[204:207], v[24:27], v[48:51], v[204:207]
  ds_read_b64 v[228:229], v12 offset:256
  s_waitcnt lgkmcnt(15)
  v_mfma_f32_16x16x32_bf16 v[136:139], v[16:19], v[52:55], v[136:139]
  ds_read_b64 v[230:231], v12 offset:384
  v_mfma_f32_16x16x32_bf16 v[172:175], v[20:23], v[52:55], v[172:175]
  ds_read_b64 v[232:233], v12 offset:512
  v_mfma_f32_16x16x32_bf16 v[208:211], v[24:27], v[52:55], v[208:211]
  ds_read_b64 v[234:235], v12 offset:640
  s_waitcnt lgkmcnt(15)
  v_mfma_f32_16x16x32_bf16 v[140:143], v[16:19], v[56:59], v[140:143]
  ds_read_b64 v[236:237], v12 offset:768
  v_mfma_f32_16x16x32_bf16 v[176:179], v[20:23], v[56:59], v[176:179]
  ds_read_b64 v[238:239], v12 offset:896
  v_mfma_f32_16x16x32_bf16 v[212:215], v[24:27], v[56:59], v[212:215]
  ds_read_b64 v[240:241], v12 offset:1024
  s_waitcnt lgkmcnt(15)
  v_mfma_f32_16x16x32_bf16 v[144:147], v[16:19], v[60:63], v[144:147]
  v_mfma_f32_16x16x32_bf16 v[180:183], v[20:23], v[60:63], v[180:183]
  v_mfma_f32_16x16x32_bf16 v[216:219], v[24:27], v[60:63], v[216:219]
  s_waitcnt lgkmcnt(0)
  v_mfma_f32_16x16x32_bf16 v[112:115], v[64:67], v[76:79], v[112:115]
  v_mfma_f32_16x16x32_bf16 v[148:151], v[68:71], v[76:79], v[148:151]
  v_mfma_f32_16x16x32_bf16 v[184:187], v[72:75], v[76:79], v[184:187]
  v_mfma_f32_16x16x32_bf16 v[116:119], v[64:67], v[80:83], v[116:119]
  s_nop 4
  v_mov_b32_dpp v242, v112 row_newbcast:0 row_mask:0xf bank_mask:0xf
  v_mov_b32_dpp v243, v113 row_newbcast:0 row_mask:0xf bank_mask:0xf
  v_mov_b32_dpp v244, v114 row_newbcast:0 row_mask:0xf bank_mask:0xf
  v_mov_b32_dpp v245, v115 row_newbcast:0 row_mask:0xf bank_mask:0xf
  v_mov_b32_dpp v246, v148 row_newbcast:0 row_mask:0xf bank_mask:0xf
  v_mov_b32_dpp v247, v149 row_newbcast:0 row_mask:0xf bank_mask:0xf
  v_mov_b32_dpp v248, v150 row_newbcast:0 row_mask:0xf bank_mask:0xf
  v_mfma_f32_16x16x32_bf16 v[152:155], v[68:71], v[80:83], v[152:155]
  v_mov_b32_dpp v249, v151 row_newbcast:0 row_mask:0xf bank_mask:0xf
  v_mov_b32_dpp v250, v184 row_newbcast:0 row_mask:0xf bank_mask:0xf
  v_mov_b32_dpp v251, v185 row_newbcast:0 row_mask:0xf bank_mask:0xf
  v_mov_b32_dpp v252, v186 row_newbcast:0 row_mask:0xf bank_mask:0xf
  v_mov_b32_dpp v253, v187 row_newbcast:0 row_mask:0xf bank_mask:0xf
  v_pk_fma_f32 v[148:149], v[246:247], v[224:225], v[148:149] op_sel_hi:[1,0,1] neg_lo:[0,1,0] neg_hi:[0,1,0]
  v_pk_fma_f32 v[150:151], v[248:249], v[224:225], v[150:151] op_sel_hi:[1,0,1] neg_lo:[0,1,0] neg_hi:[0,1,0]
  v_mfma_f32_16x16x32_bf16 v[188:191], v[72:75], v[80:83], v[188:191]
  v_pk_fma_f32 v[184:185], v[250:251], v[224:225], v[184:185] op_sel_hi:[1,0,1] neg_lo:[0,1,0] neg_hi:[0,1,0]
  v_pk_fma_f32 v[186:187], v[252:253], v[224:225], v[186:187] op_sel_hi:[1,0,1] neg_lo:[0,1,0] neg_hi:[0,1,0]
  v_pk_mul_f32 v[148:149], v[148:149], v[224:225] op_sel:[0,1] op_sel_hi:[1,1]
  v_pk_mul_f32 v[150:151], v[150:151], v[224:225] op_sel:[0,1] op_sel_hi:[1,1]
  v_pk_mul_f32 v[184:185], v[184:185], v[224:225] op_sel:[0,1] op_sel_hi:[1,1]
  v_pk_mul_f32 v[186:187], v[186:187], v[224:225] op_sel:[0,1] op_sel_hi:[1,1]
  v_cvt_pk_bf16_f32 v16, v148, v149
  v_mfma_f32_16x16x32_bf16 v[120:123], v[64:67], v[84:87], v[120:123]
  v_cvt_pk_bf16_f32 v17, v150, v151
  ds_write_b64 v11, v[16:17] offset:128
  v_cvt_pk_bf16_f32 v18, v184, v185
  v_cvt_pk_bf16_f32 v19, v186, v187
  ds_write_b64 v11, v[18:19] offset:256
  v_pk_fma_f32 v[116:117], v[242:243], v[226:227], v[116:117] op_sel_hi:[1,0,1] neg_lo:[0,1,0] neg_hi:[0,1,0]
  v_pk_fma_f32 v[118:119], v[244:245], v[226:227], v[118:119] op_sel_hi:[1,0,1] neg_lo:[0,1,0] neg_hi:[0,1,0]
  v_mfma_f32_16x16x32_bf16 v[156:159], v[68:71], v[84:87], v[156:159]
  v_pk_fma_f32 v[152:153], v[246:247], v[226:227], v[152:153] op_sel_hi:[1,0,1] neg_lo:[0,1,0] neg_hi:[0,1,0]
  v_pk_fma_f32 v[154:155], v[248:249], v[226:227], v[154:155] op_sel_hi:[1,0,1] neg_lo:[0,1,0] neg_hi:[0,1,0]
  v_pk_fma_f32 v[188:189], v[250:251], v[226:227], v[188:189] op_sel_hi:[1,0,1] neg_lo:[0,1,0] neg_hi:[0,1,0]
  v_pk_fma_f32 v[190:191], v[252:253], v[226:227], v[190:191] op_sel_hi:[1,0,1] neg_lo:[0,1,0] neg_hi:[0,1,0]
  v_pk_mul_f32 v[116:117], v[116:117], v[226:227] op_sel:[0,1] op_sel_hi:[1,1]
  v_pk_mul_f32 v[118:119], v[118:119], v[226:227] op_sel:[0,1] op_sel_hi:[1,1]
  v_pk_mul_f32 v[152:153], v[152:153], v[226:227] op_sel:[0,1] op_sel_hi:[1,1]
  v_mfma_f32_16x16x32_bf16 v[192:195], v[72:75], v[84:87], v[192:195]
  v_pk_mul_f32 v[154:155], v[154:155], v[226:227] op_sel:[0,1] op_sel_hi:[1,1]
  v_pk_mul_f32 v[188:189], v[188:189], v[226:227] op_sel:[0,1] op_sel_hi:[1,1]
  v_pk_mul_f32 v[190:191], v[190:191], v[226:227] op_sel:[0,1] op_sel_hi:[1,1]
  v_cvt_pk_bf16_f32 v22, v116, v117
  v_cvt_pk_bf16_f32 v23, v118, v119
  ds_write_b64 v11, v[22:23] offset:3200
  v_cvt_pk_bf16_f32 v24, v152, v153
  v_mfma_f32_16x16x32_bf16 v[124:127], v[64:67], v[88:91], v[124:127]
  v_cvt_pk_bf16_f32 v25, v154, v155
  ds_write_b64 v11, v[24:25] offset:3328
  v_cvt_pk_bf16_f32 v26, v188, v189
  v_cvt_pk_bf16_f32 v27, v190, v191
  ds_write_b64 v11, v[26:27] offset:3456
  v_pk_fma_f32 v[120:121], v[242:243], v[228:229], v[120:121] op_sel_hi:[1,0,1] neg_lo:[0,1,0] neg_hi:[0,1,0]
  v_pk_fma_f32 v[122:123], v[244:245], v[228:229], v[122:123] op_sel_hi:[1,0,1] neg_lo:[0,1,0] neg_hi:[0,1,0]
  v_mfma_f32_16x16x32_bf16 v[160:163], v[68:71], v[88:91], v[160:163]
  v_pk_fma_f32 v[156:157], v[246:247], v[228:229], v[156:157] op_sel_hi:[1,0,1] neg_lo:[0,1,0] neg_hi:[0,1,0]
  v_pk_fma_f32 v[158:159], v[248:249], v[228:229], v[158:159] op_sel_hi:[1,0,1] neg_lo:[0,1,0] neg_hi:[0,1,0]
  v_pk_fma_f32 v[192:193], v[250:251], v[228:229], v[192:193] op_sel_hi:[1,0,1] neg_lo:[0,1,0] neg_hi:[0,1,0]
  v_pk_fma_f32 v[194:195], v[252:253], v[228:229], v[194:195] op_sel_hi:[1,0,1] neg_lo:[0,1,0] neg_hi:[0,1,0]
  v_pk_mul_f32 v[120:121], v[120:121], v[228:229] op_sel:[0,1] op_sel_hi:[1,1]
  v_pk_mul_f32 v[122:123], v[122:123], v[228:229] op_sel:[0,1] op_sel_hi:[1,1]
  v_pk_mul_f32 v[156:157], v[156:157], v[228:229] op_sel:[0,1] op_sel_hi:[1,1]
  v_mfma_f32_16x16x32_bf16 v[196:199], v[72:75], v[88:91], v[196:199]
  v_pk_mul_f32 v[158:159], v[158:159], v[228:229] op_sel:[0,1] op_sel_hi:[1,1]
  v_pk_mul_f32 v[192:193], v[192:193], v[228:229] op_sel:[0,1] op_sel_hi:[1,1]
  v_pk_mul_f32 v[194:195], v[194:195], v[228:229] op_sel:[0,1] op_sel_hi:[1,1]
  v_cvt_pk_bf16_f32 v28, v120, v121
  v_cvt_pk_bf16_f32 v29, v122, v123
  ds_write_b64 v11, v[28:29] offset:6400
  v_cvt_pk_bf16_f32 v30, v156, v157
  v_mfma_f32_16x16x32_bf16 v[128:131], v[64:67], v[92:95], v[128:131]
  v_cvt_pk_bf16_f32 v31, v158, v159
  ds_write_b64 v11, v[30:31] offset:6528
  v_cvt_pk_bf16_f32 v32, v192, v193
  v_cvt_pk_bf16_f32 v33, v194, v195
  ds_write_b64 v11, v[32:33] offset:6656
  v_pk_fma_f32 v[124:125], v[242:243], v[230:231], v[124:125] op_sel_hi:[1,0,1] neg_lo:[0,1,0] neg_hi:[0,1,0]
  v_pk_fma_f32 v[126:127], v[244:245], v[230:231], v[126:127] op_sel_hi:[1,0,1] neg_lo:[0,1,0] neg_hi:[0,1,0]
  v_mfma_f32_16x16x32_bf16 v[164:167], v[68:71], v[92:95], v[164:167]
  v_pk_fma_f32 v[160:161], v[246:247], v[230:231], v[160:161] op_sel_hi:[1,0,1] neg_lo:[0,1,0] neg_hi:[0,1,0]
  v_pk_fma_f32 v[162:163], v[248:249], v[230:231], v[162:163] op_sel_hi:[1,0,1] neg_lo:[0,1,0] neg_hi:[0,1,0]
  v_pk_fma_f32 v[196:197], v[250:251], v[230:231], v[196:197] op_sel_hi:[1,0,1] neg_lo:[0,1,0] neg_hi:[0,1,0]
  v_pk_fma_f32 v[198:199], v[252:253], v[230:231], v[198:199] op_sel_hi:[1,0,1] neg_lo:[0,1,0] neg_hi:[0,1,0]
  v_pk_mul_f32 v[124:125], v[124:125], v[230:231] op_sel:[0,1] op_sel_hi:[1,1]
  v_pk_mul_f32 v[126:127], v[126:127], v[230:231] op_sel:[0,1] op_sel_hi:[1,1]
  v_pk_mul_f32 v[160:161], v[160:161], v[230:231] op_sel:[0,1] op_sel_hi:[1,1]
  v_mfma_f32_16x16x32_bf16 v[200:203], v[72:75], v[92:95], v[200:203]
  v_pk_mul_f32 v[162:163], v[162:163], v[230:231] op_sel:[0,1] op_sel_hi:[1,1]
  v_pk_mul_f32 v[196:197], v[196:197], v[230:231] op_sel:[0,1] op_sel_hi:[1,1]
  v_pk_mul_f32 v[198:199], v[198:199], v[230:231] op_sel:[0,1] op_sel_hi:[1,1]
  v_cvt_pk_bf16_f32 v34, v124, v125
  v_cvt_pk_bf16_f32 v35, v126, v127
  ds_write_b64 v11, v[34:35] offset:9600
  v_cvt_pk_bf16_f32 v36, v160, v161
  v_mfma_f32_16x16x32_bf16 v[132:135], v[64:67], v[96:99], v[132:135]
  v_cvt_pk_bf16_f32 v37, v162, v163
  ds_write_b64 v11, v[36:37] offset:9728
  v_cvt_pk_bf16_f32 v38, v196, v197
  v_cvt_pk_bf16_f32 v39, v198, v199
  ds_write_b64 v11, v[38:39] offset:9856
  v_pk_fma_f32 v[128:129], v[242:243], v[232:233], v[128:129] op_sel_hi:[1,0,1] neg_lo:[0,1,0] neg_hi:[0,1,0]
  v_pk_fma_f32 v[130:131], v[244:245], v[232:233], v[130:131] op_sel_hi:[1,0,1] neg_lo:[0,1,0] neg_hi:[0,1,0]
  v_mfma_f32_16x16x32_bf16 v[168:171], v[68:71], v[96:99], v[168:171]
  v_pk_fma_f32 v[164:165], v[246:247], v[232:233], v[164:165] op_sel_hi:[1,0,1] neg_lo:[0,1,0] neg_hi:[0,1,0]
  v_pk_fma_f32 v[166:167], v[248:249], v[232:233], v[166:167] op_sel_hi:[1,0,1] neg_lo:[0,1,0] neg_hi:[0,1,0]
  v_pk_fma_f32 v[200:201], v[250:251], v[232:233], v[200:201] op_sel_hi:[1,0,1] neg_lo:[0,1,0] neg_hi:[0,1,0]
  v_pk_fma_f32 v[202:203], v[252:253], v[232:233], v[202:203] op_sel_hi:[1,0,1] neg_lo:[0,1,0] neg_hi:[0,1,0]
  v_pk_mul_f32 v[128:129], v[128:129], v[232:233] op_sel:[0,1] op_sel_hi:[1,1]
  v_pk_mul_f32 v[130:131], v[130:131], v[232:233] op_sel:[0,1] op_sel_hi:[1,1]
  v_pk_mul_f32 v[164:165], v[164:165], v[232:233] op_sel:[0,1] op_sel_hi:[1,1]
  v_mfma_f32_16x16x32_bf16 v[204:207], v[72:75], v[96:99], v[204:207]
  v_pk_mul_f32 v[166:167], v[166:167], v[232:233] op_sel:[0,1] op_sel_hi:[1,1]
  v_pk_mul_f32 v[200:201], v[200:201], v[232:233] op_sel:[0,1] op_sel_hi:[1,1]
  v_pk_mul_f32 v[202:203], v[202:203], v[232:233] op_sel:[0,1] op_sel_hi:[1,1]
  v_cvt_pk_bf16_f32 v40, v128, v129
  v_cvt_pk_bf16_f32 v41, v130, v131
  ds_write_b64 v11, v[40:41] offset:12800
  v_cvt_pk_bf16_f32 v42, v164, v165
  v_mfma_f32_16x16x32_bf16 v[136:139], v[64:67], v[100:103], v[136:139]
  v_cvt_pk_bf16_f32 v43, v166, v167
  ds_write_b64 v11, v[42:43] offset:12928
  v_cvt_pk_bf16_f32 v44, v200, v201
  v_cvt_pk_bf16_f32 v45, v202, v203
  ds_write_b64 v11, v[44:45] offset:13056
  v_pk_fma_f32 v[132:133], v[242:243], v[234:235], v[132:133] op_sel_hi:[1,0,1] neg_lo:[0,1,0] neg_hi:[0,1,0]
  v_pk_fma_f32 v[134:135], v[244:245], v[234:235], v[134:135] op_sel_hi:[1,0,1] neg_lo:[0,1,0] neg_hi:[0,1,0]
  v_mfma_f32_16x16x32_bf16 v[172:175], v[68:71], v[100:103], v[172:175]
  v_pk_fma_f32 v[168:169], v[246:247], v[234:235], v[168:169] op_sel_hi:[1,0,1] neg_lo:[0,1,0] neg_hi:[0,1,0]
  v_pk_fma_f32 v[170:171], v[248:249], v[234:235], v[170:171] op_sel_hi:[1,0,1] neg_lo:[0,1,0] neg_hi:[0,1,0]
  v_pk_fma_f32 v[204:205], v[250:251], v[234:235], v[204:205] op_sel_hi:[1,0,1] neg_lo:[0,1,0] neg_hi:[0,1,0]
  v_pk_fma_f32 v[206:207], v[252:253], v[234:235], v[206:207] op_sel_hi:[1,0,1] neg_lo:[0,1,0] neg_hi:[0,1,0]
  v_pk_mul_f32 v[132:133], v[132:133], v[234:235] op_sel:[0,1] op_sel_hi:[1,1]
  v_pk_mul_f32 v[134:135], v[134:135], v[234:235] op_sel:[0,1] op_sel_hi:[1,1]
  v_pk_mul_f32 v[168:169], v[168:169], v[234:235] op_sel:[0,1] op_sel_hi:[1,1]
  v_mfma_f32_16x16x32_bf16 v[208:211], v[72:75], v[100:103], v[208:211]
  v_pk_mul_f32 v[170:171], v[170:171], v[234:235] op_sel:[0,1] op_sel_hi:[1,1]
  v_pk_mul_f32 v[204:205], v[204:205], v[234:235] op_sel:[0,1] op_sel_hi:[1,1]
  v_pk_mul_f32 v[206:207], v[206:207], v[234:235] op_sel:[0,1] op_sel_hi:[1,1]
  v_cvt_pk_bf16_f32 v46, v132, v133
  v_cvt_pk_bf16_f32 v47, v134, v135
  ds_write_b64 v11, v[46:47] offset:16000
  v_cvt_pk_bf16_f32 v48, v168, v169
  v_mfma_f32_16x16x32_bf16 v[140:143], v[64:67], v[104:107], v[140:143]
  v_cvt_pk_bf16_f32 v49, v170, v171
  ds_write_b64 v11, v[48:49] offset:16128
  v_cvt_pk_bf16_f32 v50, v204, v205
  v_cvt_pk_bf16_f32 v51, v206, v207
  ds_write_b64 v11, v[50:51] offset:16256
  v_pk_fma_f32 v[136:137], v[242:243], v[236:237], v[136:137] op_sel_hi:[1,0,1] neg_lo:[0,1,0] neg_hi:[0,1,0]
  v_pk_fma_f32 v[138:139], v[244:245], v[236:237], v[138:139] op_sel_hi:[1,0,1] neg_lo:[0,1,0] neg_hi:[0,1,0]
  v_mfma_f32_16x16x32_bf16 v[176:179], v[68:71], v[104:107], v[176:179]
  v_pk_fma_f32 v[172:173], v[246:247], v[236:237], v[172:173] op_sel_hi:[1,0,1] neg_lo:[0,1,0] neg_hi:[0,1,0]
  v_pk_fma_f32 v[174:175], v[248:249], v[236:237], v[174:175] op_sel_hi:[1,0,1] neg_lo:[0,1,0] neg_hi:[0,1,0]
  v_pk_fma_f32 v[208:209], v[250:251], v[236:237], v[208:209] op_sel_hi:[1,0,1] neg_lo:[0,1,0] neg_hi:[0,1,0]
  v_pk_fma_f32 v[210:211], v[252:253], v[236:237], v[210:211] op_sel_hi:[1,0,1] neg_lo:[0,1,0] neg_hi:[0,1,0]
  v_pk_mul_f32 v[136:137], v[136:137], v[236:237] op_sel:[0,1] op_sel_hi:[1,1]
  v_pk_mul_f32 v[138:139], v[138:139], v[236:237] op_sel:[0,1] op_sel_hi:[1,1]
  v_pk_mul_f32 v[172:173], v[172:173], v[236:237] op_sel:[0,1] op_sel_hi:[1,1]
  v_mfma_f32_16x16x32_bf16 v[212:215], v[72:75], v[104:107], v[212:215]
  v_pk_mul_f32 v[174:175], v[174:175], v[236:237] op_sel:[0,1] op_sel_hi:[1,1]
  v_pk_mul_f32 v[208:209], v[208:209], v[236:237] op_sel:[0,1] op_sel_hi:[1,1]
  v_pk_mul_f32 v[210:211], v[210:211], v[236:237] op_sel:[0,1] op_sel_hi:[1,1]
  v_cvt_pk_bf16_f32 v52, v136, v137
  v_cvt_pk_bf16_f32 v53, v138, v139
  ds_write_b64 v11, v[52:53] offset:19200
  v_cvt_pk_bf16_f32 v54, v172, v173
  v_mfma_f32_16x16x32_bf16 v[144:147], v[64:67], v[108:111], v[144:147]
  v_cvt_pk_bf16_f32 v55, v174, v175
  ds_write_b64 v11, v[54:55] offset:19328
  v_cvt_pk_bf16_f32 v56, v208, v209
  v_cvt_pk_bf16_f32 v57, v210, v211
  ds_write_b64 v11, v[56:57] offset:19456
  v_pk_fma_f32 v[140:141], v[242:243], v[238:239], v[140:141] op_sel_hi:[1,0,1] neg_lo:[0,1,0] neg_hi:[0,1,0]
  v_pk_fma_f32 v[142:143], v[244:245], v[238:239], v[142:143] op_sel_hi:[1,0,1] neg_lo:[0,1,0] neg_hi:[0,1,0]
  v_mfma_f32_16x16x32_bf16 v[180:183], v[68:71], v[108:111], v[180:183]
  v_pk_fma_f32 v[176:177], v[246:247], v[238:239], v[176:177] op_sel_hi:[1,0,1] neg_lo:[0,1,0] neg_hi:[0,1,0]
  v_pk_fma_f32 v[178:179], v[248:249], v[238:239], v[178:179] op_sel_hi:[1,0,1] neg_lo:[0,1,0] neg_hi:[0,1,0]
  v_pk_fma_f32 v[212:213], v[250:251], v[238:239], v[212:213] op_sel_hi:[1,0,1] neg_lo:[0,1,0] neg_hi:[0,1,0]
  v_pk_fma_f32 v[214:215], v[252:253], v[238:239], v[214:215] op_sel_hi:[1,0,1] neg_lo:[0,1,0] neg_hi:[0,1,0]
  v_pk_mul_f32 v[140:141], v[140:141], v[238:239] op_sel:[0,1] op_sel_hi:[1,1]
  v_pk_mul_f32 v[142:143], v[142:143], v[238:239] op_sel:[0,1] op_sel_hi:[1,1]
  v_pk_mul_f32 v[176:177], v[176:177], v[238:239] op_sel:[0,1] op_sel_hi:[1,1]
  v_mfma_f32_16x16x32_bf16 v[216:219], v[72:75], v[108:111], v[216:219]
  v_pk_mul_f32 v[178:179], v[178:179], v[238:239] op_sel:[0,1] op_sel_hi:[1,1]
  v_pk_mul_f32 v[212:213], v[212:213], v[238:239] op_sel:[0,1] op_sel_hi:[1,1]
  v_pk_mul_f32 v[214:215], v[214:215], v[238:239] op_sel:[0,1] op_sel_hi:[1,1]
  v_cvt_pk_bf16_f32 v58, v140, v141
  v_cvt_pk_bf16_f32 v59, v142, v143
  ds_write_b64 v11, v[58:59] offset:22400
  v_cvt_pk_bf16_f32 v60, v176, v177
  s_barrier
  v_cvt_pk_bf16_f32 v61, v178, v179
  ds_write_b64 v11, v[60:61] offset:22528
  v_cvt_pk_bf16_f32 v62, v212, v213
  v_cvt_pk_bf16_f32 v63, v214, v215
  ds_write_b64 v11, v[62:63] offset:22656
  v_pk_fma_f32 v[144:145], v[242:243], v[240:241], v[144:145] op_sel_hi:[1,0,1] neg_lo:[0,1,0] neg_hi:[0,1,0]
  v_pk_fma_f32 v[146:147], v[244:245], v[240:241], v[146:147] op_sel_hi:[1,0,1] neg_lo:[0,1,0] neg_hi:[0,1,0]
  v_pk_fma_f32 v[180:181], v[246:247], v[240:241], v[180:181] op_sel_hi:[1,0,1] neg_lo:[0,1,0] neg_hi:[0,1,0]
  v_pk_fma_f32 v[182:183], v[248:249], v[240:241], v[182:183] op_sel_hi:[1,0,1] neg_lo:[0,1,0] neg_hi:[0,1,0]
  v_pk_fma_f32 v[216:217], v[250:251], v[240:241], v[216:217] op_sel_hi:[1,0,1] neg_lo:[0,1,0] neg_hi:[0,1,0]
  v_pk_fma_f32 v[218:219], v[252:253], v[240:241], v[218:219] op_sel_hi:[1,0,1] neg_lo:[0,1,0] neg_hi:[0,1,0]
  v_pk_mul_f32 v[144:145], v[144:145], v[240:241] op_sel:[0,1] op_sel_hi:[1,1]
  v_pk_mul_f32 v[146:147], v[146:147], v[240:241] op_sel:[0,1] op_sel_hi:[1,1]
  v_pk_mul_f32 v[180:181], v[180:181], v[240:241] op_sel:[0,1] op_sel_hi:[1,1]
  v_pk_mul_f32 v[182:183], v[182:183], v[240:241] op_sel:[0,1] op_sel_hi:[1,1]
  v_pk_mul_f32 v[216:217], v[216:217], v[240:241] op_sel:[0,1] op_sel_hi:[1,1]
  v_pk_mul_f32 v[218:219], v[218:219], v[240:241] op_sel:[0,1] op_sel_hi:[1,1]
  v_cvt_pk_bf16_f32 v16, v144, v145
  v_cvt_pk_bf16_f32 v17, v146, v147
  ds_write_b64 v11, v[16:17] offset:25600
  v_cvt_pk_bf16_f32 v18, v180, v181
  v_cvt_pk_bf16_f32 v19, v182, v183
  ds_write_b64 v11, v[18:19] offset:25728
  v_cvt_pk_bf16_f32 v20, v216, v217
  v_cvt_pk_bf16_f32 v21, v218, v219
  ds_write_b64 v11, v[20:21] offset:25856
attn:
  s_nop 7
  s_nop 7
  s_mov_b32 s20, s82
  s_mov_b32 s21, s83
  s_mov_b32 s22, 4194304
  s_mov_b32 s23, 0x20000
  s_lshr_b32 s40, s4, 1
  s_and_b32 s41, s4, 1
  s_mul_i32 s32, s41, 28800
  s_add_u32 s32, s32, 43008
  s_lshl_b32 s49, s40, 4
  v_add_u32 v16, s49, v4
  v_lshlrev_b32 v17, 4, v5
  v_add_u32 v17, s32, v17
  v_mul_u32_u24 v18, 400, v16
  v_add_u32 v8, v18, v17
  v_add_u32 v10, 3200, v8
  v_add_u32 v8, 128, v8
  v_add_u32 v16, 16, v16
  v_min_u32 v16, 71, v16
  v_mul_u32_u24 v18, 400, v16
  v_add3_u32 v9, v18, v17, 64
  v_add_u32 v9, 64, v9
  v_lshl_add_u32 v16, v5, 2, v6
  v_add_u32 v16, s49, v16
  v_lshlrev_b32 v17, 4, v7
  v_add_u32 v17, s32, v17
  v_add_u32 v17, 256, v17
  v_mul_u32_u24 v18, 400, v16
  v_add_u32 v14, v18, v17
  v_add_u32 v16, 16, v16
  v_min_u32 v16, 71, v16
  v_mul_u32_u24 v18, 400, v16
  v_add_u32 v15, v18, v17
  v_lshlrev_b32 v13, 4, v0
  s_lshl_b32 s50, s28, 2
  s_add_u32 s50, s50, s40
  s_lshl_b32 s50, s50, 16
  s_lshl_b32 s51, s29, 12
  s_add_u32 s50, s50, s51
  s_lshl_b32 s51, s41, 10
  s_add_u32 s50, s50, s51
  v_lshlrev_b32 v16, 2, v5
  v_sub_u32 v16, v16, v4
  s_or_b32 s51, s28, s40
  s_cmp_eq_u32 s51, 0
  s_cselect_b32 s51, 0, -1
  v_add_u32 v17, -1, v16
  v_cmp_gt_u32 s[86:87], 8, v17
  v_add_u32 v17, 0, v16
  v_cmp_gt_u32 s[88:89], 8, v17
  v_add_u32 v17, 1, v16
  v_cmp_gt_u32 s[90:91], 8, v17
  v_add_u32 v17, 2, v16
  v_cmp_gt_u32 s[92:93], 8, v17
  v_add_u32 v17, 15, v16
  v_cmp_gt_u32 s[94:95], 8, v17
  v_add_u32 v17, 16, v16
  v_cmp_gt_u32 s[96:97], 8, v17
  v_add_u32 v17, 17, v16
  v_cmp_gt_u32 s[98:99], 8, v17
  v_add_u32 v17, 18, v16
  v_cmp_gt_u32 s[100:101], 8, v17
  s_and_b32 s86, s86, s51
  s_and_b32 s88, s88, s51
  s_and_b32 s90, s90, s51
  s_and_b32 s92, s92, s51
  v_mov_b32 v18, 0x3e8293ee
  v_mov_b32 v19, 0xff800000
  s_waitcnt lgkmcnt(0)
  s_barrier
  ds_read_b128 v[32:35], v10 offset:0
  ds_read_b128 v[36:39], v8 offset:0
  ds_read_b128 v[40:43], v9 offset:0
  ds_read_b128 v[80:83], v10 offset:64
  ds_read_b128 v[84:87], v8 offset:64
  ds_read_b128 v[88:91], v9 offset:64
  ds_read_b64_tr_b16 v[44:45], v14 offset:0
  ds_read_b64_tr_b16 v[46:47], v15 offset:0
  ds_read_b64_tr_b16 v[48:49], v14 offset:8
  ds_read_b64_tr_b16 v[50:51], v15 offset:8
  ds_read_b64_tr_b16 v[92:93], v14 offset:64
  ds_read_b64_tr_b16 v[94:95], v15 offset:64
  ds_read_b64_tr_b16 v[96:97], v14 offset:72
  ds_read_b64_tr_b16 v[98:99], v15 offset:72
  s_waitcnt lgkmcnt(11)
  v_mfma_f32_16x16x32_bf16 v[52:55], v[36:39], v[32:35], 0
  v_mfma_f32_16x16x32_bf16 v[56:59], v[40:43], v[32:35], 0
  s_waitcnt lgkmcnt(8)
  v_mfma_f32_16x16x32_bf16 v[100:103], v[84:87], v[80:83], 0
  v_mfma_f32_16x16x32_bf16 v[104:107], v[88:91], v[80:83], 0
  s_nop 3
  v_cndmask_b32 v52, v19, v52, s[86:87]
  s_nop 1
  v_cndmask_b32 v100, v19, v100, s[86:87]
  v_cndmask_b32 v53, v19, v53, s[88:89]
  v_cndmask_b32 v101, v19, v101, s[88:89]
  v_cndmask_b32 v54, v19, v54, s[90:91]
  v_cndmask_b32 v102, v19, v102, s[90:91]
  v_cndmask_b32 v55, v19, v55, s[92:93]
  v_cndmask_b32 v103, v19, v103, s[92:93]
  v_cndmask_b32 v56, v19, v56, s[94:95]
  v_cndmask_b32 v104, v19, v104, s[94:95]
  v_cndmask_b32 v57, v19, v57, s[96:97]
  v_cndmask_b32 v105, v19, v105, s[96:97]
  v_cndmask_b32 v58, v19, v58, s[98:99]
  v_cndmask_b32 v106, v19, v106, s[98:99]
  v_cndmask_b32 v59, v19, v59, s[100:101]
  v_cndmask_b32 v107, v19, v107, s[100:101]
  v_max3_f32 v60, v52, v53, v54
  v_max3_f32 v108, v100, v101, v102
  v_max3_f32 v61, v55, v56, v57
  v_max3_f32 v109, v103, v104, v105
  v_max3_f32 v60, v60, v58, v59
  v_max3_f32 v108, v108, v106, v107
  v_max_f32 v60, v60, v61
  v_max_f32 v108, v108, v109
  v_mov_b32 v61, v60
  v_mov_b32 v109, v108
  s_nop 0
  v_permlane16_swap_b32 v60, v61
  v_permlane16_swap_b32 v108, v109
  v_max_f32 v60, v60, v61
  v_max_f32 v108, v108, v109
  v_mov_b32 v61, v60
  v_mov_b32 v109, v108
  s_nop 0
  v_permlane32_swap_b32 v60, v61
  v_permlane32_swap_b32 v108, v109
  v_max_f32 v60, v60, v61
  v_max_f32 v108, v108, v109
  v_mul_f32 v60, v18, v60
  v_mul_f32 v108, v18, v108
  v_fma_f32 v52, v52, v18, -v60
  v_fma_f32 v100, v100, v18, -v108
  v_fma_f32 v53, v53, v18, -v60
  v_fma_f32 v101, v101, v18, -v108
  v_fma_f32 v54, v54, v18, -v60
  v_fma_f32 v102, v102, v18, -v108
  v_fma_f32 v55, v55, v18, -v60
  v_fma_f32 v103, v103, v18, -v108
  v_fma_f32 v56, v56, v18, -v60
  v_fma_f32 v104, v104, v18, -v108
  v_fma_f32 v57, v57, v18, -v60
  v_fma_f32 v105, v105, v18, -v108
  v_fma_f32 v58, v58, v18, -v60
  v_fma_f32 v106, v106, v18, -v108
  v_fma_f32 v59, v59, v18, -v60
  v_fma_f32 v107, v107, v18, -v108
  v_exp_f32 v52, v52
  v_exp_f32 v100, v100
  v_exp_f32 v53, v53
  v_exp_f32 v101, v101
  v_exp_f32 v54, v54
  v_exp_f32 v102, v102
  v_exp_f32 v55, v55
  v_exp_f32 v103, v103
  v_exp_f32 v56, v56
  v_exp_f32 v104, v104
  v_exp_f32 v57, v57
  v_exp_f32 v105, v105
  v_exp_f32 v58, v58
  v_exp_f32 v106, v106
  v_exp_f32 v59, v59
  v_exp_f32 v107, v107
  v_pk_add_f32 v[60:61], v[52:53], v[54:55]
  v_pk_add_f32 v[108:109], v[100:101], v[102:103]
  v_pk_add_f32 v[62:63], v[56:57], v[58:59]
  v_pk_add_f32 v[110:111], v[104:105], v[106:107]
  v_pk_add_f32 v[60:61], v[60:61], v[62:63]
  v_pk_add_f32 v[108:109], v[108:109], v[110:111]
  v_add_f32 v60, v60, v61
  v_add_f32 v108, v108, v109
  v_mov_b32 v61, v60
  v_mov_b32 v109, v108
  s_nop 0
  v_permlane16_swap_b32 v60, v61
  v_permlane16_swap_b32 v108, v109
  v_add_f32 v60, v60, v61
  v_add_f32 v108, v108, v109
  v_mov_b32 v61, v60
  v_mov_b32 v109, v108
  s_nop 0
  v_permlane32_swap_b32 v60, v61
  v_permlane32_swap_b32 v108, v109
  v_add_f32 v60, v60, v61
  v_add_f32 v108, v108, v109
  v_rcp_f32 v60, v60
  v_rcp_f32 v108, v108
  v_pk_mul_f32 v[52:53], v[52:53], v[60:61] op_sel_hi:[1,0]
  v_pk_mul_f32 v[100:101], v[100:101], v[108:109] op_sel_hi:[1,0]
  v_pk_mul_f32 v[54:55], v[54:55], v[60:61] op_sel_hi:[1,0]
  v_pk_mul_f32 v[102:103], v[102:103], v[108:109] op_sel_hi:[1,0]
  v_pk_mul_f32 v[56:57], v[56:57], v[60:61] op_sel_hi:[1,0]
  v_pk_mul_f32 v[104:105], v[104:105], v[108:109] op_sel_hi:[1,0]
  v_pk_mul_f32 v[58:59], v[58:59], v[60:61] op_sel_hi:[1,0]
  v_pk_mul_f32 v[106:107], v[106:107], v[108:109] op_sel_hi:[1,0]
  v_cvt_pk_bf16_f32 v64, v52, v53
  v_cvt_pk_bf16_f32 v112, v100, v101
  v_cvt_pk_bf16_f32 v65, v54, v55
  v_cvt_pk_bf16_f32 v113, v102, v103
  v_cvt_pk_bf16_f32 v66, v56, v57
  v_cvt_pk_bf16_f32 v114, v104, v105
  v_cvt_pk_bf16_f32 v67, v58, v59
  v_cvt_pk_bf16_f32 v115, v106, v107
  s_waitcnt lgkmcnt(0)
  v_mfma_f32_16x16x32_bf16 v[68:71], v[44:47], v[64:67], 0
  v_mfma_f32_16x16x32_bf16 v[116:119], v[92:95], v[112:115], 0
  v_mfma_f32_16x16x32_bf16 v[72:75], v[48:51], v[64:67], 0
  v_mfma_f32_16x16x32_bf16 v[120:123], v[96:99], v[112:115], 0
  s_nop 4
  v_cvt_pk_bf16_f32 v32, v68, v69
  v_cvt_pk_bf16_f32 v80, v116, v117
  v_cvt_pk_bf16_f32 v33, v70, v71
  v_cvt_pk_bf16_f32 v81, v118, v119
  v_cvt_pk_bf16_f32 v34, v72, v73
  v_cvt_pk_bf16_f32 v82, v120, v121
  v_cvt_pk_bf16_f32 v35, v74, v75
  v_cvt_pk_bf16_f32 v83, v122, v123
  buffer_store_dwordx4 v[32:35], v13, s[20:23], s50 offen offset:0 sc0 sc1
  buffer_store_dwordx4 v[80:83], v13, s[20:23], s50 offen offset:2048 sc0 sc1
  s_cmp_ge_u32 s4, 4
  s_cbranch_scc1 L_k1done
  s_lshl_b32 s32, s28, 2
  s_add_u32 s32, s32, s4
  s_lshl_b32 s34, s32, 16
  s_lshl_b32 s40, s32, 5
  v_lshlrev_b32 v13, 1, v4
  v_add_u32 v13, s40, v13
  v_lshlrev_b32 v12, 11, v13
  v_lshl_add_u32 v12, v3, 4, v12
  s_lshl_b32 s32, s29, 7
  v_add_u32 v12, s32, v12
  v_lshlrev_b32 v14, 4, v0
  s_mov_b32 s8, s82
  s_mov_b32 s9, s83
  s_mov_b32 s10, 4194304
  s_mov_b32 s11, 0x20000
  s_cmp_eq_u32 s3, 0
  s_cselect_b32 s16, s64, s84
  s_cselect_b32 s17, s65, s85
  s_cselect_b32 s18, 0, 25165824
  s_add_u32 s16, s16, s18
  s_addc_u32 s17, s17, 0
  s_mov_b32 s18, 4194304
  s_mov_b32 s19, 0x20000
  s_add_u32 s12, s82, 20971520
  s_addc_u32 s13, s83, 0
  s_mov_b32 s14, 262144
  s_mov_b32 s15, 0x20000
  v_lshl_add_u32 v16, v5, 3, v6
  v_lshlrev_b32 v16, 7, v16
  v_lshl_add_u32 v16, v7, 3, v16
  v_lshrrev_b32 v17, 1, v6
  v_lshl_or_b32 v17, v2, 1, v17
  v_lshl_add_u32 v16, v17, 5, v16
  v_add_u32 v16, 131072, v16
  v_xor_b32 v8, 0, v16
  v_xor_b32 v9, 32, v16
  v_xor_b32 v10, 64, v16
  v_xor_b32 v11, 96, v16
  v_add_u32 v16, v13, v2
  v_lshlrev_b32 v16, 3, v16
  s_lshl_b32 s32, s29, 14
  v_add_u32 v112, s32, v16
  v_lshrrev_b32 v17, 5, v0
  v_lshlrev_b32 v17, 17, v17
  v_add_u32 v113, v16, v17
  s_lshl_b32 s32, s4, 12
  v_lshlrev_b32 v16, 8, v4
  v_lshl_add_u32 v16, v5, 3, v16
  v_add_u32 v16, s32, v16
  v_and_b32 v17, 1, v4
  v_bfe_u32 v18, v4, 2, 1
  v_lshl_or_b32 v17, v18, 1, v17
  v_lshl_add_u32 v114, v17, 5, v16
  s_lshl_b32 s44, s29, 8
  s_lshl_b32 s40, s28, 2
  s_add_u32 s44, s44, s40
  s_add_u32 s44, s44, s4
  s_lshl_b32 s44, s44, 10
  v_lshl_add_u32 v16, v5, 3, v6
  v_lshlrev_b32 v16, 7, v16
  v_lshl_add_u32 v16, v7, 3, v16
  v_lshrrev_b32 v17, 1, v6
  v_lshl_or_b32 v17, v2, 1, v17
  v_lshl_add_u32 v16, v17, 5, v16
  v_xor_b32 v115, 0, v16
  v_add_u32 v115, s32, v115
  s_add_u32 s45, s44, 65536
  s_add_u32 s46, s44, 131072
  s_add_u32 s47, s44, 196608
  s_mov_b32 s87, 16384
  s_mov_b32 s88, 32768
  s_mov_b32 s89, 49152
  s_mov_b32 s90, 65536
  s_mov_b32 s91, 81920
  s_mov_b32 s92, 98304
  s_mov_b32 s93, 114688
  s_lshl_b32 s48, 0x303, s7
  s_lshr_b32 s48, s48, 8
  s_mov_b32 s49, s34
  s_add_u32 s50, s34, 32768
  s_add_u32 s41, s34, 65536
  s_add_u32 s24, s84, 29360128
  s_addc_u32 s25, s85, 0
  s_mov_b32 s26, 262144
  s_mov_b32 s27, 0x20000
  s_lshl_b32 s32, s28, 4
  v_min_u32 v119, 15, v0
  v_add_u32 v119, s32, v119
  v_max_i32 v119, 0, v119
  v_lshlrev_b32 v119, 7, v119
  s_lshl_b32 s55, s3, 17
  s_add_u32 s55, s55, 0
  s_waitcnt vmcnt(0)
  s_barrier
  s_mov_b32 s39, 0
poll2:
  buffer_load_dword v16, v119, s[24:27], s55 offen sc0 sc1
  s_waitcnt vmcnt(0)
  v_cmp_eq_u32 vcc, 0, v16
  s_add_u32 s39, s39, 1
  s_cmp_gt_u32 s39, 100000
  s_cbranch_scc1 poll2d
  s_cbranch_vccnz poll2
poll2d:
  buffer_load_dwordx4 v[96:99], v12, s[16:19], 0 offen offset:0 sc1
  buffer_load_dwordx4 v[100:103], v12, s[16:19], 0 offen offset:64 sc1
  buffer_load_dwordx4 v[104:107], v12, s[16:19], 0 offen offset:2048 sc1
  buffer_load_dwordx4 v[108:111], v12, s[16:19], 0 offen offset:2112 sc1
  s_bitcmp1_b32 s48, 0
  s_cselect_b32 s36, s50, s49
  s_add_u32 s36, s36, 0
  buffer_load_dwordx4 v[120:123], v14, s[8:11], s36 offen offset:0 sc1
  buffer_load_dwordx4 v[124:127], v14, s[8:11], s36 offen offset:1024 sc1
  buffer_load_dwordx4 v[128:131], v14, s[8:11], s36 offen offset:2048 sc1
  buffer_load_dwordx4 v[132:135], v14, s[8:11], s36 offen offset:3072 sc1
  s_bitcmp1_b32 s48, 1
  s_cselect_b32 s36, s50, s49
  s_add_u32 s36, s36, 4096
  buffer_load_dwordx4 v[136:139], v14, s[8:11], s36 offen offset:0 sc1
  buffer_load_dwordx4 v[140:143], v14, s[8:11], s36 offen offset:1024 sc1
  buffer_load_dwordx4 v[144:147], v14, s[8:11], s36 offen offset:2048 sc1
  buffer_load_dwordx4 v[148:151], v14, s[8:11], s36 offen offset:3072 sc1
  s_waitcnt vmcnt(8)
  v_permlane16_swap_b32 v96, v98
  v_permlane16_swap_b32 v97, v99
  v_permlane16_swap_b32 v100, v102
  v_permlane16_swap_b32 v101, v103
  v_permlane16_swap_b32 v104, v106
  v_permlane16_swap_b32 v105, v107
  v_permlane16_swap_b32 v108, v110
  v_permlane16_swap_b32 v109, v111
  v_lshlrev_b32 v48, 16, v96
  v_and_b32 v49, 0xffff0000, v96
  v_lshlrev_b32 v50, 16, v97
  v_and_b32 v51, 0xffff0000, v97
  v_lshlrev_b32 v52, 16, v98
  v_and_b32 v53, 0xffff0000, v98
  v_lshlrev_b32 v54, 16, v99
  v_and_b32 v55, 0xffff0000, v99
  v_lshlrev_b32 v56, 16, v100
  v_and_b32 v57, 0xffff0000, v100
  v_lshlrev_b32 v58, 16, v101
  v_and_b32 v59, 0xffff0000, v101
  v_lshlrev_b32 v60, 16, v102
  v_and_b32 v61, 0xffff0000, v102
  v_lshlrev_b32 v62, 16, v103
  v_and_b32 v63, 0xffff0000, v103
  v_lshlrev_b32 v64, 16, v104
  v_and_b32 v65, 0xffff0000, v104
  v_lshlrev_b32 v66, 16, v105
  v_and_b32 v67, 0xffff0000, v105
  v_lshlrev_b32 v68, 16, v106
  v_and_b32 v69, 0xffff0000, v106
  v_lshlrev_b32 v70, 16, v107
  v_and_b32 v71, 0xffff0000, v107
  v_lshlrev_b32 v72, 16, v108
  v_and_b32 v73, 0xffff0000, v108
  v_lshlrev_b32 v74, 16, v109
  v_and_b32 v75, 0xffff0000, v109
  v_lshlrev_b32 v76, 16, v110
  v_and_b32 v77, 0xffff0000, v110
  v_lshlrev_b32 v78, 16, v111
  v_and_b32 v79, 0xffff0000, v111
  s_bitcmp1_b32 s48, 2
  s_cselect_b32 s36, s50, s49
  s_add_u32 s36, s36, 8192
  buffer_load_dwordx4 v[152:155], v14, s[8:11], s36 offen offset:0 sc1
  buffer_load_dwordx4 v[156:159], v14, s[8:11], s36 offen offset:1024 sc1
  buffer_load_dwordx4 v[160:163], v14, s[8:11], s36 offen offset:2048 sc1
  buffer_load_dwordx4 v[164:167], v14, s[8:11], s36 offen offset:3072 sc1
  s_bitcmp1_b32 s48, 3
  s_cselect_b32 s36, s50, s49
  s_add_u32 s36, s36, 12288
  buffer_load_dwordx4 v[168:171], v14, s[8:11], s36 offen offset:0 sc1
  buffer_load_dwordx4 v[172:175], v14, s[8:11], s36 offen offset:1024 sc1
  s_mov_b32 s43, 0
  s_mov_b32 s39, 1
  s_barrier
  ds_read_b64_tr_b16 v[16:17], v8 offset:0
  ds_read_b64_tr_b16 v[18:19], v8 offset:512
  ds_read_b64_tr_b16 v[20:21], v9 offset:0
  ds_read_b64_tr_b16 v[22:23], v9 offset:512
  ds_read_b64_tr_b16 v[24:25], v10 offset:0
  ds_read_b64_tr_b16 v[26:27], v10 offset:512
  ds_read_b64_tr_b16 v[28:29], v11 offset:0
  ds_read_b64_tr_b16 v[30:31], v11 offset:512
  s_waitcnt vmcnt(13) lgkmcnt(6)
  v_mfma_f32_16x16x32_bf16 v[48:51], v[16:19], v[120:123], v[48:51]
  ds_read_b64_tr_b16 v[32:33], v8 offset:4096
  s_waitcnt vmcnt(12)
  v_mfma_f32_16x16x32_bf16 v[64:67], v[16:19], v[124:127], v[64:67]
  ds_read_b64_tr_b16 v[34:35], v8 offset:4608
  v_add_u32 v8, 8192, v8
  s_waitcnt lgkmcnt(6)
  v_mfma_f32_16x16x32_bf16 v[52:55], v[20:23], v[120:123], v[52:55]
  ds_read_b64_tr_b16 v[36:37], v9 offset:4096
  buffer_load_dwordx4 v[176:179], v14, s[8:11], s36 offen offset:2048 sc1
  v_mfma_f32_16x16x32_bf16 v[68:71], v[20:23], v[124:127], v[68:71]
  ds_read_b64_tr_b16 v[38:39], v9 offset:4608
  v_add_u32 v9, 8192, v9
  s_waitcnt lgkmcnt(6)
  v_mfma_f32_16x16x32_bf16 v[56:59], v[24:27], v[120:123], v[56:59]
  ds_read_b64_tr_b16 v[40:41], v10 offset:4096
  v_mfma_f32_16x16x32_bf16 v[72:75], v[24:27], v[124:127], v[72:75]
  ds_read_b64_tr_b16 v[42:43], v10 offset:4608
  v_add_u32 v10, 8192, v10
  s_waitcnt lgkmcnt(6)
  v_mfma_f32_16x16x32_bf16 v[60:63], v[28:31], v[120:123], v[60:63]
  ds_read_b64_tr_b16 v[44:45], v11 offset:4096
  buffer_load_dwordx4 v[180:183], v14, s[8:11], s36 offen offset:3072 sc1
  v_mfma_f32_16x16x32_bf16 v[76:79], v[28:31], v[124:127], v[76:79]
  ds_read_b64_tr_b16 v[46:47], v11 offset:4608
  v_add_u32 v11, 8192, v11
  s_waitcnt vmcnt(13) lgkmcnt(6)
  v_mfma_f32_16x16x32_bf16 v[48:51], v[32:35], v[128:131], v[48:51]
  ds_read_b64_tr_b16 v[16:17], v8 offset:0
  s_bitcmp1_b32 s48, 4
  s_cselect_b32 s36, s50, s49
  s_waitcnt vmcnt(12)
  v_mfma_f32_16x16x32_bf16 v[64:67], v[32:35], v[132:135], v[64:67]
  ds_read_b64_tr_b16 v[18:19], v8 offset:512
  s_add_u32 s36, s36, 16384
  s_waitcnt lgkmcnt(6)
  v_mfma_f32_16x16x32_bf16 v[52:55], v[36:39], v[128:131], v[52:55]
  ds_read_b64_tr_b16 v[20:21], v9 offset:0
  v_mfma_f32_16x16x32_bf16 v[68:71], v[36:39], v[132:135], v[68:71]
  ds_read_b64_tr_b16 v[22:23], v9 offset:512
  s_waitcnt lgkmcnt(6)
  v_mfma_f32_16x16x32_bf16 v[56:59], v[40:43], v[128:131], v[56:59]
  ds_read_b64_tr_b16 v[24:25], v10 offset:0
  buffer_load_dwordx4 v[120:123], v14, s[8:11], s36 offen offset:0 sc1
  v_mfma_f32_16x16x32_bf16 v[72:75], v[40:43], v[132:135], v[72:75]
  ds_read_b64_tr_b16 v[26:27], v10 offset:512
  s_waitcnt lgkmcnt(6)
  v_mfma_f32_16x16x32_bf16 v[60:63], v[44:47], v[128:131], v[60:63]
  ds_read_b64_tr_b16 v[28:29], v11 offset:0
  v_mfma_f32_16x16x32_bf16 v[76:79], v[44:47], v[132:135], v[76:79]
  ds_read_b64_tr_b16 v[30:31], v11 offset:512
  buffer_load_dwordx4 v[124:127], v14, s[8:11], s36 offen offset:1024 sc1
  s_waitcnt vmcnt(13) lgkmcnt(6)
  v_mfma_f32_16x16x32_bf16 v[48:51], v[16:19], v[136:139], v[48:51]
  ds_read_b64_tr_b16 v[32:33], v8 offset:4096
  s_waitcnt vmcnt(12)
  v_mfma_f32_16x16x32_bf16 v[64:67], v[16:19], v[140:143], v[64:67]
  ds_read_b64_tr_b16 v[34:35], v8 offset:4608
  v_add_u32 v8, 8192, v8
  s_waitcnt lgkmcnt(6)
  v_mfma_f32_16x16x32_bf16 v[52:55], v[20:23], v[136:139], v[52:55]
  ds_read_b64_tr_b16 v[36:37], v9 offset:4096
  buffer_load_dwordx4 v[128:131], v14, s[8:11], s36 offen offset:2048 sc1
  v_mfma_f32_16x16x32_bf16 v[68:71], v[20:23], v[140:143], v[68:71]
  ds_read_b64_tr_b16 v[38:39], v9 offset:4608
  v_add_u32 v9, 8192, v9
  s_waitcnt lgkmcnt(6)
  v_mfma_f32_16x16x32_bf16 v[56:59], v[24:27], v[136:139], v[56:59]
  ds_read_b64_tr_b16 v[40:41], v10 offset:4096
  v_mfma_f32_16x16x32_bf16 v[72:75], v[24:27], v[140:143], v[72:75]
  ds_read_b64_tr_b16 v[42:43], v10 offset:4608
  v_add_u32 v10, 8192, v10
  s_waitcnt lgkmcnt(6)
  v_mfma_f32_16x16x32_bf16 v[60:63], v[28:31], v[136:139], v[60:63]
  ds_read_b64_tr_b16 v[44:45], v11 offset:4096
  buffer_load_dwordx4 v[132:135], v14, s[8:11], s36 offen offset:3072 sc1
  v_mfma_f32_16x16x32_bf16 v[76:79], v[28:31], v[140:143], v[76:79]
  ds_read_b64_tr_b16 v[46:47], v11 offset:4608
  v_add_u32 v11, 8192, v11
  s_waitcnt vmcnt(13) lgkmcnt(6)
  v_mfma_f32_16x16x32_bf16 v[48:51], v[32:35], v[144:147], v[48:51]
  ds_read_b64_tr_b16 v[16:17], v8 offset:0
  s_bitcmp1_b32 s48, 5
  s_cselect_b32 s36, s50, s49
  s_waitcnt vmcnt(12)
  v_mfma_f32_16x16x32_bf16 v[64:67], v[32:35], v[148:151], v[64:67]
  ds_read_b64_tr_b16 v[18:19], v8 offset:512
  s_add_u32 s36, s36, 20480
  s_waitcnt lgkmcnt(6)
  v_mfma_f32_16x16x32_bf16 v[52:55], v[36:39], v[144:147], v[52:55]
  ds_read_b64_tr_b16 v[20:21], v9 offset:0
  v_mfma_f32_16x16x32_bf16 v[68:71], v[36:39], v[148:151], v[68:71]
  ds_read_b64_tr_b16 v[22:23], v9 offset:512
  s_waitcnt lgkmcnt(6)
  v_mfma_f32_16x16x32_bf16 v[56:59], v[40:43], v[144:147], v[56:59]
  ds_read_b64_tr_b16 v[24:25], v10 offset:0
  buffer_load_dwordx4 v[136:139], v14, s[8:11], s36 offen offset:0 sc1
  v_mfma_f32_16x16x32_bf16 v[72:75], v[40:43], v[148:151], v[72:75]
  ds_read_b64_tr_b16 v[26:27], v10 offset:512
  s_waitcnt lgkmcnt(6)
  v_mfma_f32_16x16x32_bf16 v[60:63], v[44:47], v[144:147], v[60:63]
  ds_read_b64_tr_b16 v[28:29], v11 offset:0
  v_mfma_f32_16x16x32_bf16 v[76:79], v[44:47], v[148:151], v[76:79]
  ds_read_b64_tr_b16 v[30:31], v11 offset:512
  buffer_load_dwordx4 v[140:143], v14, s[8:11], s36 offen offset:1024 sc1
  s_waitcnt vmcnt(13) lgkmcnt(6)
  v_mfma_f32_16x16x32_bf16 v[48:51], v[16:19], v[152:155], v[48:51]
  ds_read_b64_tr_b16 v[32:33], v8 offset:4096
  s_waitcnt vmcnt(12)
  v_mfma_f32_16x16x32_bf16 v[64:67], v[16:19], v[156:159], v[64:67]
  ds_read_b64_tr_b16 v[34:35], v8 offset:4608
  v_add_u32 v8, 8192, v8
  s_waitcnt lgkmcnt(6)
  v_mfma_f32_16x16x32_bf16 v[52:55], v[20:23], v[152:155], v[52:55]
  ds_read_b64_tr_b16 v[36:37], v9 offset:4096
  buffer_load_dwordx4 v[144:147], v14, s[8:11], s36 offen offset:2048 sc1
  v_mfma_f32_16x16x32_bf16 v[68:71], v[20:23], v[156:159], v[68:71]
  ds_read_b64_tr_b16 v[38:39], v9 offset:4608
  v_add_u32 v9, 8192, v9
  s_waitcnt lgkmcnt(6)
  v_mfma_f32_16x16x32_bf16 v[56:59], v[24:27], v[152:155], v[56:59]
  ds_read_b64_tr_b16 v[40:41], v10 offset:4096
  v_mfma_f32_16x16x32_bf16 v[72:75], v[24:27], v[156:159], v[72:75]
  ds_read_b64_tr_b16 v[42:43], v10 offset:4608
  v_add_u32 v10, 8192, v10
  s_waitcnt lgkmcnt(6)
  v_mfma_f32_16x16x32_bf16 v[60:63], v[28:31], v[152:155], v[60:63]
  ds_read_b64_tr_b16 v[44:45], v11 offset:4096
  buffer_load_dwordx4 v[148:151], v14, s[8:11], s36 offen offset:3072 sc1
  v_mfma_f32_16x16x32_bf16 v[76:79], v[28:31], v[156:159], v[76:79]
  ds_read_b64_tr_b16 v[46:47], v11 offset:4608
  v_add_u32 v11, 8192, v11
  s_waitcnt vmcnt(13) lgkmcnt(6)
  v_mfma_f32_16x16x32_bf16 v[48:51], v[32:35], v[160:163], v[48:51]
  ds_read_b64_tr_b16 v[16:17], v8 offset:0
  s_bitcmp1_b32 s48, 6
  s_cselect_b32 s36, s50, s49
  s_waitcnt vmcnt(12)
  v_mfma_f32_16x16x32_bf16 v[64:67], v[32:35], v[164:167], v[64:67]
  ds_read_b64_tr_b16 v[18:19], v8 offset:512
  s_add_u32 s36, s36, 24576
  s_waitcnt lgkmcnt(6)
  v_mfma_f32_16x16x32_bf16 v[52:55], v[36:39], v[160:163], v[52:55]
  ds_read_b64_tr_b16 v[20:21], v9 offset:0
  v_mfma_f32_16x16x32_bf16 v[68:71], v[36:39], v[164:167], v[68:71]
  ds_read_b64_tr_b16 v[22:23], v9 offset:512
  s_waitcnt lgkmcnt(6)
  v_mfma_f32_16x16x32_bf16 v[56:59], v[40:43], v[160:163], v[56:59]
  ds_read_b64_tr_b16 v[24:25], v10 offset:0
  buffer_load_dwordx4 v[152:155], v14, s[8:11], s36 offen offset:0 sc1
  v_mfma_f32_16x16x32_bf16 v[72:75], v[40:43], v[164:167], v[72:75]
  ds_read_b64_tr_b16 v[26:27], v10 offset:512
  s_waitcnt lgkmcnt(6)
  v_mfma_f32_16x16x32_bf16 v[60:63], v[44:47], v[160:163], v[60:63]
  ds_read_b64_tr_b16 v[28:29], v11 offset:0
  v_mfma_f32_16x16x32_bf16 v[76:79], v[44:47], v[164:167], v[76:79]
  ds_read_b64_tr_b16 v[30:31], v11 offset:512
  buffer_load_dwordx4 v[156:159], v14, s[8:11], s36 offen offset:1024 sc1
  s_waitcnt vmcnt(13) lgkmcnt(6)
  v_mfma_f32_16x16x32_bf16 v[48:51], v[16:19], v[168:171], v[48:51]
  ds_read_b64_tr_b16 v[32:33], v8 offset:4096
  s_waitcnt vmcnt(12)
  v_mfma_f32_16x16x32_bf16 v[64:67], v[16:19], v[172:175], v[64:67]
  ds_read_b64_tr_b16 v[34:35], v8 offset:4608
  v_add_u32 v8, 4294912256, v8
  s_waitcnt lgkmcnt(6)
  v_mfma_f32_16x16x32_bf16 v[52:55], v[20:23], v[168:171], v[52:55]
  ds_read_b64_tr_b16 v[36:37], v9 offset:4096
  buffer_load_dwordx4 v[160:163], v14, s[8:11], s36 offen offset:2048 sc1
  v_mfma_f32_16x16x32_bf16 v[68:71], v[20:23], v[172:175], v[68:71]
  ds_read_b64_tr_b16 v[38:39], v9 offset:4608
  v_add_u32 v9, 4294912256, v9
  s_waitcnt lgkmcnt(6)
  v_mfma_f32_16x16x32_bf16 v[56:59], v[24:27], v[168:171], v[56:59]
  ds_read_b64_tr_b16 v[40:41], v10 offset:4096
  v_mfma_f32_16x16x32_bf16 v[72:75], v[24:27], v[172:175], v[72:75]
  ds_read_b64_tr_b16 v[42:43], v10 offset:4608
  v_add_u32 v10, 4294912256, v10
  s_waitcnt lgkmcnt(6)
  v_mfma_f32_16x16x32_bf16 v[60:63], v[28:31], v[168:171], v[60:63]
  ds_read_b64_tr_b16 v[44:45], v11 offset:4096
  buffer_load_dwordx4 v[164:167], v14, s[8:11], s36 offen offset:3072 sc1
  v_mfma_f32_16x16x32_bf16 v[76:79], v[28:31], v[172:175], v[76:79]
  ds_read_b64_tr_b16 v[46:47], v11 offset:4608
  v_add_u32 v11, 4294912256, v11
  s_waitcnt vmcnt(13) lgkmcnt(6)
  v_mfma_f32_16x16x32_bf16 v[48:51], v[32:35], v[176:179], v[48:51]
  ds_read_b64_tr_b16 v[16:17], v8 offset:0
  s_bitcmp1_b32 s48, 7
  s_cselect_b32 s36, s50, s49
  s_waitcnt vmcnt(12)
  v_mfma_f32_16x16x32_bf16 v[64:67], v[32:35], v[180:183], v[64:67]
  ds_read_b64_tr_b16 v[18:19], v8 offset:512
  s_add_u32 s36, s36, 28672
  s_waitcnt lgkmcnt(6)
  v_mfma_f32_16x16x32_bf16 v[52:55], v[36:39], v[176:179], v[52:55]
  ds_read_b64_tr_b16 v[20:21], v9 offset:0
  v_mfma_f32_16x16x32_bf16 v[68:71], v[36:39], v[180:183], v[68:71]
  ds_read_b64_tr_b16 v[22:23], v9 offset:512
  s_waitcnt lgkmcnt(6)
  v_mfma_f32_16x16x32_bf16 v[56:59], v[40:43], v[176:179], v[56:59]
  ds_read_b64_tr_b16 v[24:25], v10 offset:0
  buffer_load_dwordx4 v[168:171], v14, s[8:11], s36 offen offset:0 sc1
  v_mfma_f32_16x16x32_bf16 v[72:75], v[40:43], v[180:183], v[72:75]
  ds_read_b64_tr_b16 v[26:27], v10 offset:512
  s_waitcnt lgkmcnt(6)
  v_mfma_f32_16x16x32_bf16 v[60:63], v[44:47], v[176:179], v[60:63]
  ds_read_b64_tr_b16 v[28:29], v11 offset:0
  v_mfma_f32_16x16x32_bf16 v[76:79], v[44:47], v[180:183], v[76:79]
  ds_read_b64_tr_b16 v[30:31], v11 offset:512
  buffer_load_dwordx4 v[172:175], v14, s[8:11], s36 offen offset:1024 sc1
  s_waitcnt vmcnt(13) lgkmcnt(6)
  v_mfma_f32_16x16x32_bf16 v[48:51], v[16:19], v[120:123], v[48:51]
  ds_read_b64_tr_b16 v[32:33], v8 offset:4096
  s_waitcnt vmcnt(12)
  v_mfma_f32_16x16x32_bf16 v[64:67], v[16:19], v[124:127], v[64:67]
  ds_read_b64_tr_b16 v[34:35], v8 offset:4608
  v_add_u32 v8, 8192, v8
  s_waitcnt lgkmcnt(6)
  v_mfma_f32_16x16x32_bf16 v[52:55], v[20:23], v[120:123], v[52:55]
  ds_read_b64_tr_b16 v[36:37], v9 offset:4096
  buffer_load_dwordx4 v[176:179], v14, s[8:11], s36 offen offset:2048 sc1
  v_mfma_f32_16x16x32_bf16 v[68:71], v[20:23], v[124:127], v[68:71]
  ds_read_b64_tr_b16 v[38:39], v9 offset:4608
  v_add_u32 v9, 8192, v9
  s_waitcnt lgkmcnt(6)
  v_mfma_f32_16x16x32_bf16 v[56:59], v[24:27], v[120:123], v[56:59]
  ds_read_b64_tr_b16 v[40:41], v10 offset:4096
  v_mfma_f32_16x16x32_bf16 v[72:75], v[24:27], v[124:127], v[72:75]
  ds_read_b64_tr_b16 v[42:43], v10 offset:4608
  v_add_u32 v10, 8192, v10
  s_waitcnt lgkmcnt(6)
  v_mfma_f32_16x16x32_bf16 v[60:63], v[28:31], v[120:123], v[60:63]
  ds_read_b64_tr_b16 v[44:45], v11 offset:4096
  buffer_load_dwordx4 v[180:183], v14, s[8:11], s36 offen offset:3072 sc1
  v_mfma_f32_16x16x32_bf16 v[76:79], v[28:31], v[124:127], v[76:79]
  ds_read_b64_tr_b16 v[46:47], v11 offset:4608
  v_add_u32 v11, 8192, v11
  s_waitcnt vmcnt(13) lgkmcnt(6)
  v_mfma_f32_16x16x32_bf16 v[48:51], v[32:35], v[128:131], v[48:51]
  ds_read_b64_tr_b16 v[16:17], v8 offset:0
  s_mov_b32 s49, s50
  s_add_u32 s50, s50, 32768
  s_waitcnt vmcnt(12)
  v_mfma_f32_16x16x32_bf16 v[64:67], v[32:35], v[132:135], v[64:67]
  ds_read_b64_tr_b16 v[18:19], v8 offset:512
  s_cmp_eq_u32 s50, s41
  s_cselect_b32 s50, s34, s50
  s_waitcnt lgkmcnt(6)
  v_mfma_f32_16x16x32_bf16 v[52:55], v[36:39], v[128:131], v[52:55]
  ds_read_b64_tr_b16 v[20:21], v9 offset:0
  s_bitcmp1_b32 s48, 0
  s_cselect_b32 s36, s50, s49
  v_mfma_f32_16x16x32_bf16 v[68:71], v[36:39], v[132:135], v[68:71]
  ds_read_b64_tr_b16 v[22:23], v9 offset:512
  s_add_u32 s36, s36, 0
  s_waitcnt lgkmcnt(6)
  v_mfma_f32_16x16x32_bf16 v[56:59], v[40:43], v[128:131], v[56:59]
  ds_read_b64_tr_b16 v[24:25], v10 offset:0
  buffer_load_dwordx4 v[120:123], v14, s[8:11], s36 offen offset:0 sc1
  v_mfma_f32_16x16x32_bf16 v[72:75], v[40:43], v[132:135], v[72:75]
  ds_read_b64_tr_b16 v[26:27], v10 offset:512
  s_waitcnt lgkmcnt(6)
  v_mfma_f32_16x16x32_bf16 v[60:63], v[44:47], v[128:131], v[60:63]
  ds_read_b64_tr_b16 v[28:29], v11 offset:0
  v_mfma_f32_16x16x32_bf16 v[76:79], v[44:47], v[132:135], v[76:79]
  ds_read_b64_tr_b16 v[30:31], v11 offset:512
  buffer_load_dwordx4 v[124:127], v14, s[8:11], s36 offen offset:1024 sc1
  s_waitcnt vmcnt(13) lgkmcnt(6)
  v_mfma_f32_16x16x32_bf16 v[48:51], v[16:19], v[136:139], v[48:51]
  ds_read_b64_tr_b16 v[32:33], v8 offset:4096
  s_waitcnt vmcnt(12)
  v_mfma_f32_16x16x32_bf16 v[64:67], v[16:19], v[140:143], v[64:67]
  ds_read_b64_tr_b16 v[34:35], v8 offset:4608
  v_add_u32 v8, 8192, v8
  s_waitcnt lgkmcnt(6)
  v_mfma_f32_16x16x32_bf16 v[52:55], v[20:23], v[136:139], v[52:55]
  ds_read_b64_tr_b16 v[36:37], v9 offset:4096
  buffer_load_dwordx4 v[128:131], v14, s[8:11], s36 offen offset:2048 sc1
  v_mfma_f32_16x16x32_bf16 v[68:71], v[20:23], v[140:143], v[68:71]
  ds_read_b64_tr_b16 v[38:39], v9 offset:4608
  v_add_u32 v9, 8192, v9
  s_waitcnt lgkmcnt(6)
  v_mfma_f32_16x16x32_bf16 v[56:59], v[24:27], v[136:139], v[56:59]
  ds_read_b64_tr_b16 v[40:41], v10 offset:4096
  v_mfma_f32_16x16x32_bf16 v[72:75], v[24:27], v[140:143], v[72:75]
  ds_read_b64_tr_b16 v[42:43], v10 offset:4608
  v_add_u32 v10, 8192, v10
  s_waitcnt lgkmcnt(6)
  v_mfma_f32_16x16x32_bf16 v[60:63], v[28:31], v[136:139], v[60:63]
  ds_read_b64_tr_b16 v[44:45], v11 offset:4096
  buffer_load_dwordx4 v[132:135], v14, s[8:11], s36 offen offset:3072 sc1
  v_mfma_f32_16x16x32_bf16 v[76:79], v[28:31], v[140:143], v[76:79]
  ds_read_b64_tr_b16 v[46:47], v11 offset:4608
  v_add_u32 v11, 8192, v11
  s_waitcnt vmcnt(13) lgkmcnt(6)
  v_mfma_f32_16x16x32_bf16 v[48:51], v[32:35], v[144:147], v[48:51]
  ds_read_b64_tr_b16 v[16:17], v8 offset:0
  s_bitcmp1_b32 s48, 1
  s_cselect_b32 s36, s50, s49
  s_waitcnt vmcnt(12)
  v_mfma_f32_16x16x32_bf16 v[64:67], v[32:35], v[148:151], v[64:67]
  ds_read_b64_tr_b16 v[18:19], v8 offset:512
  s_add_u32 s36, s36, 4096
  s_waitcnt lgkmcnt(6)
  v_mfma_f32_16x16x32_bf16 v[52:55], v[36:39], v[144:147], v[52:55]
  ds_read_b64_tr_b16 v[20:21], v9 offset:0
  v_mfma_f32_16x16x32_bf16 v[68:71], v[36:39], v[148:151], v[68:71]
  ds_read_b64_tr_b16 v[22:23], v9 offset:512
  s_waitcnt lgkmcnt(6)
  v_mfma_f32_16x16x32_bf16 v[56:59], v[40:43], v[144:147], v[56:59]
  ds_read_b64_tr_b16 v[24:25], v10 offset:0
  buffer_load_dwordx4 v[136:139], v14, s[8:11], s36 offen offset:0 sc1
  v_mfma_f32_16x16x32_bf16 v[72:75], v[40:43], v[148:151], v[72:75]
  ds_read_b64_tr_b16 v[26:27], v10 offset:512
  s_waitcnt lgkmcnt(6)
  v_mfma_f32_16x16x32_bf16 v[60:63], v[44:47], v[144:147], v[60:63]
  ds_read_b64_tr_b16 v[28:29], v11 offset:0
  v_mfma_f32_16x16x32_bf16 v[76:79], v[44:47], v[148:151], v[76:79]
  ds_read_b64_tr_b16 v[30:31], v11 offset:512
  buffer_load_dwordx4 v[140:143], v14, s[8:11], s36 offen offset:1024 sc1
  s_waitcnt vmcnt(13) lgkmcnt(6)
  v_mfma_f32_16x16x32_bf16 v[48:51], v[16:19], v[152:155], v[48:51]
  ds_read_b64_tr_b16 v[32:33], v8 offset:4096
  s_waitcnt vmcnt(12)
  v_mfma_f32_16x16x32_bf16 v[64:67], v[16:19], v[156:159], v[64:67]
  ds_read_b64_tr_b16 v[34:35], v8 offset:4608
  v_add_u32 v8, 4294850304, v8
  s_waitcnt lgkmcnt(6)
  v_mfma_f32_16x16x32_bf16 v[52:55], v[20:23], v[152:155], v[52:55]
  ds_read_b64_tr_b16 v[36:37], v9 offset:4096
  buffer_load_dwordx4 v[144:147], v14, s[8:11], s36 offen offset:2048 sc1
  v_mfma_f32_16x16x32_bf16 v[68:71], v[20:23], v[156:159], v[68:71]
  ds_read_b64_tr_b16 v[38:39], v9 offset:4608
  v_add_u32 v9, 4294850304, v9
  s_waitcnt lgkmcnt(6)
  v_mfma_f32_16x16x32_bf16 v[56:59], v[24:27], v[152:155], v[56:59]
  ds_read_b64_tr_b16 v[40:41], v10 offset:4096
  v_mfma_f32_16x16x32_bf16 v[72:75], v[24:27], v[156:159], v[72:75]
  ds_read_b64_tr_b16 v[42:43], v10 offset:4608
  v_add_u32 v10, 4294850304, v10
  s_waitcnt lgkmcnt(6)
  v_mfma_f32_16x16x32_bf16 v[60:63], v[28:31], v[152:155], v[60:63]
  ds_read_b64_tr_b16 v[44:45], v11 offset:4096
  buffer_load_dwordx4 v[148:151], v14, s[8:11], s36 offen offset:3072 sc1
  v_mfma_f32_16x16x32_bf16 v[76:79], v[28:31], v[156:159], v[76:79]
  ds_read_b64_tr_b16 v[46:47], v11 offset:4608
  v_add_u32 v11, 4294850304, v11
  s_waitcnt vmcnt(13) lgkmcnt(6)
  v_mfma_f32_16x16x32_bf16 v[48:51], v[32:35], v[160:163], v[48:51]
  ds_read_b64_tr_b16 v[16:17], v8 offset:0
  s_bitcmp1_b32 s48, 2
  s_cselect_b32 s36, s50, s49
  s_waitcnt vmcnt(12)
  v_mfma_f32_16x16x32_bf16 v[64:67], v[32:35], v[164:167], v[64:67]
  ds_read_b64_tr_b16 v[18:19], v8 offset:512
  s_add_u32 s36, s36, 8192
  s_waitcnt lgkmcnt(6)
  v_mfma_f32_16x16x32_bf16 v[52:55], v[36:39], v[160:163], v[52:55]
  ds_read_b64_tr_b16 v[20:21], v9 offset:0
  v_mfma_f32_16x16x32_bf16 v[68:71], v[36:39], v[164:167], v[68:71]
  ds_read_b64_tr_b16 v[22:23], v9 offset:512
  s_waitcnt lgkmcnt(6)
  v_mfma_f32_16x16x32_bf16 v[56:59], v[40:43], v[160:163], v[56:59]
  ds_read_b64_tr_b16 v[24:25], v10 offset:0
  buffer_load_dwordx4 v[152:155], v14, s[8:11], s36 offen offset:0 sc1
  v_mfma_f32_16x16x32_bf16 v[72:75], v[40:43], v[164:167], v[72:75]
  ds_read_b64_tr_b16 v[26:27], v10 offset:512
  s_waitcnt lgkmcnt(6)
  v_mfma_f32_16x16x32_bf16 v[60:63], v[44:47], v[160:163], v[60:63]
  ds_read_b64_tr_b16 v[28:29], v11 offset:0
  v_mfma_f32_16x16x32_bf16 v[76:79], v[44:47], v[164:167], v[76:79]
  ds_read_b64_tr_b16 v[30:31], v11 offset:512
  buffer_load_dwordx4 v[156:159], v14, s[8:11], s36 offen offset:1024 sc1
  s_waitcnt vmcnt(13) lgkmcnt(6)
  v_mfma_f32_16x16x32_bf16 v[48:51], v[16:19], v[168:171], v[48:51]
  ds_read_b64_tr_b16 v[32:33], v8 offset:4096
  s_waitcnt vmcnt(12)
  v_mfma_f32_16x16x32_bf16 v[64:67], v[16:19], v[172:175], v[64:67]
  ds_read_b64_tr_b16 v[34:35], v8 offset:4608
  v_add_u32 v8, 8192, v8
  s_waitcnt lgkmcnt(6)
  v_mfma_f32_16x16x32_bf16 v[52:55], v[20:23], v[168:171], v[52:55]
  ds_read_b64_tr_b16 v[36:37], v9 offset:4096
  buffer_load_dwordx4 v[160:163], v14, s[8:11], s36 offen offset:2048 sc1
  v_mfma_f32_16x16x32_bf16 v[68:71], v[20:23], v[172:175], v[68:71]
  ds_read_b64_tr_b16 v[38:39], v9 offset:4608
  v_add_u32 v9, 8192, v9
  s_waitcnt lgkmcnt(6)
  v_mfma_f32_16x16x32_bf16 v[56:59], v[24:27], v[168:171], v[56:59]
  ds_read_b64_tr_b16 v[40:41], v10 offset:4096
  v_mfma_f32_16x16x32_bf16 v[72:75], v[24:27], v[172:175], v[72:75]
  ds_read_b64_tr_b16 v[42:43], v10 offset:4608
  v_add_u32 v10, 8192, v10
  s_waitcnt lgkmcnt(6)
  v_mfma_f32_16x16x32_bf16 v[60:63], v[28:31], v[168:171], v[60:63]
  ds_read_b64_tr_b16 v[44:45], v11 offset:4096
  buffer_load_dwordx4 v[164:167], v14, s[8:11], s36 offen offset:3072 sc1
  v_mfma_f32_16x16x32_bf16 v[76:79], v[28:31], v[172:175], v[76:79]
  ds_read_b64_tr_b16 v[46:47], v11 offset:4608
  v_add_u32 v11, 8192, v11
  s_waitcnt vmcnt(13) lgkmcnt(6)
  v_mfma_f32_16x16x32_bf16 v[48:51], v[32:35], v[176:179], v[48:51]
  ds_read_b64_tr_b16 v[16:17], v8 offset:0
  s_bitcmp1_b32 s48, 3
  s_cselect_b32 s36, s50, s49
  s_waitcnt vmcnt(12)
  v_mfma_f32_16x16x32_bf16 v[64:67], v[32:35], v[180:183], v[64:67]
  ds_read_b64_tr_b16 v[18:19], v8 offset:512
  s_add_u32 s36, s36, 12288
  s_waitcnt lgkmcnt(6)
  v_mfma_f32_16x16x32_bf16 v[52:55], v[36:39], v[176:179], v[52:55]
  ds_read_b64_tr_b16 v[20:21], v9 offset:0
  v_mfma_f32_16x16x32_bf16 v[68:71], v[36:39], v[180:183], v[68:71]
  ds_read_b64_tr_b16 v[22:23], v9 offset:512
  s_waitcnt lgkmcnt(6)
  v_mfma_f32_16x16x32_bf16 v[56:59], v[40:43], v[176:179], v[56:59]
  ds_read_b64_tr_b16 v[24:25], v10 offset:0
  buffer_load_dwordx4 v[168:171], v14, s[8:11], s36 offen offset:0 sc1
  v_mfma_f32_16x16x32_bf16 v[72:75], v[40:43], v[180:183], v[72:75]
  ds_read_b64_tr_b16 v[26:27], v10 offset:512
  s_waitcnt lgkmcnt(6)
  v_mfma_f32_16x16x32_bf16 v[60:63], v[44:47], v[176:179], v[60:63]
  ds_read_b64_tr_b16 v[28:29], v11 offset:0
  v_mfma_f32_16x16x32_bf16 v[76:79], v[44:47], v[180:183], v[76:79]
  ds_read_b64_tr_b16 v[30:31], v11 offset:512
  buffer_load_dwordx4 v[172:175], v14, s[8:11], s36 offen offset:1024 sc1
  s_waitcnt vmcnt(13) lgkmcnt(6)
  v_mfma_f32_16x16x32_bf16 v[48:51], v[16:19], v[120:123], v[48:51]
  ds_read_b64_tr_b16 v[32:33], v8 offset:4096
  s_waitcnt vmcnt(12)
  v_mfma_f32_16x16x32_bf16 v[64:67], v[16:19], v[124:127], v[64:67]
  ds_read_b64_tr_b16 v[34:35], v8 offset:4608
  v_add_u32 v8, 8192, v8
  s_waitcnt lgkmcnt(6)
  v_mfma_f32_16x16x32_bf16 v[52:55], v[20:23], v[120:123], v[52:55]
  ds_read_b64_tr_b16 v[36:37], v9 offset:4096
  buffer_load_dwordx4 v[176:179], v14, s[8:11], s36 offen offset:2048 sc1
  v_mfma_f32_16x16x32_bf16 v[68:71], v[20:23], v[124:127], v[68:71]
  ds_read_b64_tr_b16 v[38:39], v9 offset:4608
  v_add_u32 v9, 8192, v9
  s_waitcnt lgkmcnt(6)
  v_mfma_f32_16x16x32_bf16 v[56:59], v[24:27], v[120:123], v[56:59]
  ds_read_b64_tr_b16 v[40:41], v10 offset:4096
  v_mfma_f32_16x16x32_bf16 v[72:75], v[24:27], v[124:127], v[72:75]
  ds_read_b64_tr_b16 v[42:43], v10 offset:4608
  v_add_u32 v10, 8192, v10
  s_waitcnt lgkmcnt(6)
  v_mfma_f32_16x16x32_bf16 v[60:63], v[28:31], v[120:123], v[60:63]
  ds_read_b64_tr_b16 v[44:45], v11 offset:4096
  buffer_load_dwordx4 v[180:183], v14, s[8:11], s36 offen offset:3072 sc1
  v_mfma_f32_16x16x32_bf16 v[76:79], v[28:31], v[124:127], v[76:79]
  ds_read_b64_tr_b16 v[46:47], v11 offset:4608
  v_add_u32 v11, 8192, v11
  s_waitcnt vmcnt(13) lgkmcnt(6)
  v_mfma_f32_16x16x32_bf16 v[48:51], v[32:35], v[128:131], v[48:51]
  ds_read_b64_tr_b16 v[16:17], v8 offset:0
  s_bitcmp1_b32 s48, 4
  s_cselect_b32 s36, s50, s49
  s_waitcnt vmcnt(12)
  v_mfma_f32_16x16x32_bf16 v[64:67], v[32:35], v[132:135], v[64:67]
  ds_read_b64_tr_b16 v[18:19], v8 offset:512
  s_add_u32 s36, s36, 16384
  s_waitcnt lgkmcnt(6)
  v_mfma_f32_16x16x32_bf16 v[52:55], v[36:39], v[128:131], v[52:55]
  ds_read_b64_tr_b16 v[20:21], v9 offset:0
  v_mfma_f32_16x16x32_bf16 v[68:71], v[36:39], v[132:135], v[68:71]
  ds_read_b64_tr_b16 v[22:23], v9 offset:512
  s_waitcnt lgkmcnt(6)
  v_mfma_f32_16x16x32_bf16 v[56:59], v[40:43], v[128:131], v[56:59]
  ds_read_b64_tr_b16 v[24:25], v10 offset:0
  buffer_load_dwordx4 v[120:123], v14, s[8:11], s36 offen offset:0 sc1
  v_mfma_f32_16x16x32_bf16 v[72:75], v[40:43], v[132:135], v[72:75]
  ds_read_b64_tr_b16 v[26:27], v10 offset:512
  s_waitcnt lgkmcnt(6)
  v_mfma_f32_16x16x32_bf16 v[60:63], v[44:47], v[128:131], v[60:63]
  ds_read_b64_tr_b16 v[28:29], v11 offset:0
  v_mfma_f32_16x16x32_bf16 v[76:79], v[44:47], v[132:135], v[76:79]
  ds_read_b64_tr_b16 v[30:31], v11 offset:512
  buffer_load_dwordx4 v[124:127], v14, s[8:11], s36 offen offset:1024 sc1
  s_waitcnt vmcnt(13) lgkmcnt(6)
  v_mfma_f32_16x16x32_bf16 v[48:51], v[16:19], v[136:139], v[48:51]
  ds_read_b64_tr_b16 v[32:33], v8 offset:4096
  s_waitcnt vmcnt(12)
  v_mfma_f32_16x16x32_bf16 v[64:67], v[16:19], v[140:143], v[64:67]
  ds_read_b64_tr_b16 v[34:35], v8 offset:4608
  v_add_u32 v8, 8192, v8
  s_waitcnt lgkmcnt(6)
  v_mfma_f32_16x16x32_bf16 v[52:55], v[20:23], v[136:139], v[52:55]
  ds_read_b64_tr_b16 v[36:37], v9 offset:4096
  buffer_load_dwordx4 v[128:131], v14, s[8:11], s36 offen offset:2048 sc1
  v_mfma_f32_16x16x32_bf16 v[68:71], v[20:23], v[140:143], v[68:71]
  ds_read_b64_tr_b16 v[38:39], v9 offset:4608
  v_add_u32 v9, 8192, v9
  s_waitcnt lgkmcnt(6)
  v_mfma_f32_16x16x32_bf16 v[56:59], v[24:27], v[136:139], v[56:59]
  ds_read_b64_tr_b16 v[40:41], v10 offset:4096
  v_mfma_f32_16x16x32_bf16 v[72:75], v[24:27], v[140:143], v[72:75]
  ds_read_b64_tr_b16 v[42:43], v10 offset:4608
  v_add_u32 v10, 8192, v10
  s_waitcnt lgkmcnt(6)
  v_mfma_f32_16x16x32_bf16 v[60:63], v[28:31], v[136:139], v[60:63]
  ds_read_b64_tr_b16 v[44:45], v11 offset:4096
  buffer_load_dwordx4 v[132:135], v14, s[8:11], s36 offen offset:3072 sc1
  v_mfma_f32_16x16x32_bf16 v[76:79], v[28:31], v[140:143], v[76:79]
  ds_read_b64_tr_b16 v[46:47], v11 offset:4608
  v_add_u32 v11, 8192, v11
  s_waitcnt vmcnt(13) lgkmcnt(6)
  v_mfma_f32_16x16x32_bf16 v[48:51], v[32:35], v[144:147], v[48:51]
  ds_read_b64_tr_b16 v[16:17], v8 offset:0
  s_bitcmp1_b32 s48, 5
  s_cselect_b32 s36, s50, s49
  s_waitcnt vmcnt(12)
  v_mfma_f32_16x16x32_bf16 v[64:67], v[32:35], v[148:151], v[64:67]
  ds_read_b64_tr_b16 v[18:19], v8 offset:512
  s_add_u32 s36, s36, 20480
  s_waitcnt lgkmcnt(6)
  v_mfma_f32_16x16x32_bf16 v[52:55], v[36:39], v[144:147], v[52:55]
  ds_read_b64_tr_b16 v[20:21], v9 offset:0
  v_mfma_f32_16x16x32_bf16 v[68:71], v[36:39], v[148:151], v[68:71]
  ds_read_b64_tr_b16 v[22:23], v9 offset:512
  s_waitcnt lgkmcnt(6)
  v_mfma_f32_16x16x32_bf16 v[56:59], v[40:43], v[144:147], v[56:59]
  ds_read_b64_tr_b16 v[24:25], v10 offset:0
  buffer_load_dwordx4 v[136:139], v14, s[8:11], s36 offen offset:0 sc1
  v_mfma_f32_16x16x32_bf16 v[72:75], v[40:43], v[148:151], v[72:75]
  ds_read_b64_tr_b16 v[26:27], v10 offset:512
  s_waitcnt lgkmcnt(6)
  v_mfma_f32_16x16x32_bf16 v[60:63], v[44:47], v[144:147], v[60:63]
  ds_read_b64_tr_b16 v[28:29], v11 offset:0
  v_mfma_f32_16x16x32_bf16 v[76:79], v[44:47], v[148:151], v[76:79]
  ds_read_b64_tr_b16 v[30:31], v11 offset:512
  buffer_load_dwordx4 v[140:143], v14, s[8:11], s36 offen offset:1024 sc1
  s_waitcnt vmcnt(13) lgkmcnt(6)
  v_mfma_f32_16x16x32_bf16 v[48:51], v[16:19], v[152:155], v[48:51]
  ds_read_b64_tr_b16 v[32:33], v8 offset:4096
  s_waitcnt vmcnt(12)
  v_mfma_f32_16x16x32_bf16 v[64:67], v[16:19], v[156:159], v[64:67]
  ds_read_b64_tr_b16 v[34:35], v8 offset:4608
  v_add_u32 v8, 8192, v8
  s_waitcnt lgkmcnt(6)
  v_mfma_f32_16x16x32_bf16 v[52:55], v[20:23], v[152:155], v[52:55]
  ds_read_b64_tr_b16 v[36:37], v9 offset:4096
  buffer_load_dwordx4 v[144:147], v14, s[8:11], s36 offen offset:2048 sc1
  v_mfma_f32_16x16x32_bf16 v[68:71], v[20:23], v[156:159], v[68:71]
  ds_read_b64_tr_b16 v[38:39], v9 offset:4608
  v_add_u32 v9, 8192, v9
  s_waitcnt lgkmcnt(6)
  v_mfma_f32_16x16x32_bf16 v[56:59], v[24:27], v[152:155], v[56:59]
  ds_read_b64_tr_b16 v[40:41], v10 offset:4096
  v_mfma_f32_16x16x32_bf16 v[72:75], v[24:27], v[156:159], v[72:75]
  ds_read_b64_tr_b16 v[42:43], v10 offset:4608
  v_add_u32 v10, 8192, v10
  s_waitcnt lgkmcnt(6)
  v_mfma_f32_16x16x32_bf16 v[60:63], v[28:31], v[152:155], v[60:63]
  ds_read_b64_tr_b16 v[44:45], v11 offset:4096
  buffer_load_dwordx4 v[148:151], v14, s[8:11], s36 offen offset:3072 sc1
  v_mfma_f32_16x16x32_bf16 v[76:79], v[28:31], v[156:159], v[76:79]
  ds_read_b64_tr_b16 v[46:47], v11 offset:4608
  v_add_u32 v11, 8192, v11
  s_waitcnt vmcnt(13) lgkmcnt(6)
  v_mfma_f32_16x16x32_bf16 v[48:51], v[32:35], v[160:163], v[48:51]
  ds_read_b64_tr_b16 v[16:17], v8 offset:0
  s_bitcmp1_b32 s48, 6
  s_cselect_b32 s36, s50, s49
  s_waitcnt vmcnt(12)
  v_mfma_f32_16x16x32_bf16 v[64:67], v[32:35], v[164:167], v[64:67]
  ds_read_b64_tr_b16 v[18:19], v8 offset:512
  s_add_u32 s36, s36, 24576
  s_waitcnt lgkmcnt(6)
  v_mfma_f32_16x16x32_bf16 v[52:55], v[36:39], v[160:163], v[52:55]
  ds_read_b64_tr_b16 v[20:21], v9 offset:0
  v_mfma_f32_16x16x32_bf16 v[68:71], v[36:39], v[164:167], v[68:71]
  ds_read_b64_tr_b16 v[22:23], v9 offset:512
  s_waitcnt lgkmcnt(6)
  v_mfma_f32_16x16x32_bf16 v[56:59], v[40:43], v[160:163], v[56:59]
  ds_read_b64_tr_b16 v[24:25], v10 offset:0
  buffer_load_dwordx4 v[152:155], v14, s[8:11], s36 offen offset:0 sc1
  v_mfma_f32_16x16x32_bf16 v[72:75], v[40:43], v[164:167], v[72:75]
  ds_read_b64_tr_b16 v[26:27], v10 offset:512
  s_waitcnt lgkmcnt(6)
  v_mfma_f32_16x16x32_bf16 v[60:63], v[44:47], v[160:163], v[60:63]
  ds_read_b64_tr_b16 v[28:29], v11 offset:0
  v_mfma_f32_16x16x32_bf16 v[76:79], v[44:47], v[164:167], v[76:79]
  ds_read_b64_tr_b16 v[30:31], v11 offset:512
  buffer_load_dwordx4 v[156:159], v14, s[8:11], s36 offen offset:1024 sc1
  s_waitcnt vmcnt(13) lgkmcnt(6)
  v_mfma_f32_16x16x32_bf16 v[48:51], v[16:19], v[168:171], v[48:51]
  ds_read_b64_tr_b16 v[32:33], v8 offset:4096
  s_waitcnt vmcnt(12)
  v_mfma_f32_16x16x32_bf16 v[64:67], v[16:19], v[172:175], v[64:67]
  ds_read_b64_tr_b16 v[34:35], v8 offset:4608
  v_add_u32 v8, 10240, v8
  s_waitcnt lgkmcnt(6)
  v_mfma_f32_16x16x32_bf16 v[52:55], v[20:23], v[168:171], v[52:55]
  ds_read_b64_tr_b16 v[36:37], v9 offset:4096
  buffer_load_dwordx4 v[160:163], v14, s[8:11], s36 offen offset:2048 sc1
  v_mfma_f32_16x16x32_bf16 v[68:71], v[20:23], v[172:175], v[68:71]
  ds_read_b64_tr_b16 v[38:39], v9 offset:4608
  v_add_u32 v9, 10240, v9
  s_waitcnt lgkmcnt(6)
  v_mfma_f32_16x16x32_bf16 v[56:59], v[24:27], v[168:171], v[56:59]
  ds_read_b64_tr_b16 v[40:41], v10 offset:4096
  v_mfma_f32_16x16x32_bf16 v[72:75], v[24:27], v[172:175], v[72:75]
  ds_read_b64_tr_b16 v[42:43], v10 offset:4608
  v_add_u32 v10, 10240, v10
  s_waitcnt lgkmcnt(6)
  v_mfma_f32_16x16x32_bf16 v[60:63], v[28:31], v[168:171], v[60:63]
  ds_read_b64_tr_b16 v[44:45], v11 offset:4096
  buffer_load_dwordx4 v[164:167], v14, s[8:11], s36 offen offset:3072 sc1
  v_mfma_f32_16x16x32_bf16 v[76:79], v[28:31], v[172:175], v[76:79]
  ds_read_b64_tr_b16 v[46:47], v11 offset:4608
  v_add_u32 v11, 10240, v11
  s_waitcnt vmcnt(13) lgkmcnt(6)
  v_mfma_f32_16x16x32_bf16 v[48:51], v[32:35], v[176:179], v[48:51]
  ds_read_b64_tr_b16 v[16:17], v8 offset:0
  s_bitcmp1_b32 s48, 7
  s_cselect_b32 s36, s50, s49
  s_waitcnt vmcnt(12)
  v_mfma_f32_16x16x32_bf16 v[64:67], v[32:35], v[180:183], v[64:67]
  ds_read_b64_tr_b16 v[18:19], v8 offset:512
  s_add_u32 s36, s36, 28672
  s_waitcnt lgkmcnt(6)
  v_mfma_f32_16x16x32_bf16 v[52:55], v[36:39], v[176:179], v[52:55]
  ds_read_b64_tr_b16 v[20:21], v9 offset:0
  v_mfma_f32_16x16x32_bf16 v[68:71], v[36:39], v[180:183], v[68:71]
  ds_read_b64_tr_b16 v[22:23], v9 offset:512
  s_waitcnt lgkmcnt(6)
  v_mfma_f32_16x16x32_bf16 v[56:59], v[40:43], v[176:179], v[56:59]
  ds_read_b64_tr_b16 v[24:25], v10 offset:0
  buffer_load_dwordx4 v[168:171], v14, s[8:11], s36 offen offset:0 sc1
  v_mfma_f32_16x16x32_bf16 v[72:75], v[40:43], v[180:183], v[72:75]
  ds_read_b64_tr_b16 v[26:27], v10 offset:512
  s_waitcnt lgkmcnt(6)
  v_mfma_f32_16x16x32_bf16 v[60:63], v[44:47], v[176:179], v[60:63]
  ds_read_b64_tr_b16 v[28:29], v11 offset:0
  v_mfma_f32_16x16x32_bf16 v[76:79], v[44:47], v[180:183], v[76:79]
  ds_read_b64_tr_b16 v[30:31], v11 offset:512
  buffer_load_dwordx4 v[172:175], v14, s[8:11], s36 offen offset:1024 sc1
  s_waitcnt vmcnt(13) lgkmcnt(6)
  v_mfma_f32_16x16x32_bf16 v[48:51], v[16:19], v[120:123], v[48:51]
  ds_read_b64_tr_b16 v[32:33], v8 offset:4096
  s_waitcnt vmcnt(12)
  v_mfma_f32_16x16x32_bf16 v[64:67], v[16:19], v[124:127], v[64:67]
  ds_read_b64_tr_b16 v[34:35], v8 offset:4608
  v_add_u32 v8, 8192, v8
  s_waitcnt lgkmcnt(6)
  v_mfma_f32_16x16x32_bf16 v[52:55], v[20:23], v[120:123], v[52:55]
  ds_read_b64_tr_b16 v[36:37], v9 offset:4096
  buffer_load_dwordx4 v[176:179], v14, s[8:11], s36 offen offset:2048 sc1
  v_mfma_f32_16x16x32_bf16 v[68:71], v[20:23], v[124:127], v[68:71]
  ds_read_b64_tr_b16 v[38:39], v9 offset:4608
  v_add_u32 v9, 8192, v9
  s_waitcnt lgkmcnt(6)
  v_mfma_f32_16x16x32_bf16 v[56:59], v[24:27], v[120:123], v[56:59]
  ds_read_b64_tr_b16 v[40:41], v10 offset:4096
  v_mfma_f32_16x16x32_bf16 v[72:75], v[24:27], v[124:127], v[72:75]
  ds_read_b64_tr_b16 v[42:43], v10 offset:4608
  v_add_u32 v10, 8192, v10
  s_waitcnt lgkmcnt(6)
  v_mfma_f32_16x16x32_bf16 v[60:63], v[28:31], v[120:123], v[60:63]
  ds_read_b64_tr_b16 v[44:45], v11 offset:4096
  buffer_load_dwordx4 v[180:183], v14, s[8:11], s36 offen offset:3072 sc1
  v_mfma_f32_16x16x32_bf16 v[76:79], v[28:31], v[124:127], v[76:79]
  ds_read_b64_tr_b16 v[46:47], v11 offset:4608
  v_add_u32 v11, 8192, v11
  s_waitcnt vmcnt(13) lgkmcnt(6)
  v_mfma_f32_16x16x32_bf16 v[48:51], v[32:35], v[128:131], v[48:51]
  ds_read_b64_tr_b16 v[16:17], v8 offset:0
  s_waitcnt vmcnt(12)
  v_mfma_f32_16x16x32_bf16 v[64:67], v[32:35], v[132:135], v[64:67]
  ds_read_b64_tr_b16 v[18:19], v8 offset:512
  s_waitcnt lgkmcnt(6)
  v_mfma_f32_16x16x32_bf16 v[52:55], v[36:39], v[128:131], v[52:55]
  ds_read_b64_tr_b16 v[20:21], v9 offset:0
  v_mfma_f32_16x16x32_bf16 v[68:71], v[36:39], v[132:135], v[68:71]
  ds_read_b64_tr_b16 v[22:23], v9 offset:512
  s_waitcnt lgkmcnt(6)
  v_mfma_f32_16x16x32_bf16 v[56:59], v[40:43], v[128:131], v[56:59]
  ds_read_b64_tr_b16 v[24:25], v10 offset:0
  v_mfma_f32_16x16x32_bf16 v[72:75], v[40:43], v[132:135], v[72:75]
  ds_read_b64_tr_b16 v[26:27], v10 offset:512
  s_waitcnt lgkmcnt(6)
  v_mfma_f32_16x16x32_bf16 v[60:63], v[44:47], v[128:131], v[60:63]
  ds_read_b64_tr_b16 v[28:29], v11 offset:0
  v_mfma_f32_16x16x32_bf16 v[76:79], v[44:47], v[132:135], v[76:79]
  ds_read_b64_tr_b16 v[30:31], v11 offset:512
  s_waitcnt vmcnt(11) lgkmcnt(6)
  v_mfma_f32_16x16x32_bf16 v[48:51], v[16:19], v[136:139], v[48:51]
  ds_read_b64_tr_b16 v[32:33], v8 offset:4096
  s_waitcnt vmcnt(10)
  v_mfma_f32_16x16x32_bf16 v[64:67], v[16:19], v[140:143], v[64:67]
  ds_read_b64_tr_b16 v[34:35], v8 offset:4608
  v_add_u32 v8, 8192, v8
  s_waitcnt lgkmcnt(6)
  v_mfma_f32_16x16x32_bf16 v[52:55], v[20:23], v[136:139], v[52:55]
  ds_read_b64_tr_b16 v[36:37], v9 offset:4096
  v_mfma_f32_16x16x32_bf16 v[68:71], v[20:23], v[140:143], v[68:71]
  ds_read_b64_tr_b16 v[38:39], v9 offset:4608
  v_add_u32 v9, 8192, v9
  s_waitcnt lgkmcnt(6)
  v_mfma_f32_16x16x32_bf16 v[56:59], v[24:27], v[136:139], v[56:59]
  ds_read_b64_tr_b16 v[40:41], v10 offset:4096
  v_mfma_f32_16x16x32_bf16 v[72:75], v[24:27], v[140:143], v[72:75]
  ds_read_b64_tr_b16 v[42:43], v10 offset:4608
  v_add_u32 v10, 8192, v10
  s_waitcnt lgkmcnt(6)
  v_mfma_f32_16x16x32_bf16 v[60:63], v[28:31], v[136:139], v[60:63]
  ds_read_b64_tr_b16 v[44:45], v11 offset:4096
  v_mfma_f32_16x16x32_bf16 v[76:79], v[28:31], v[140:143], v[76:79]
  ds_read_b64_tr_b16 v[46:47], v11 offset:4608
  v_add_u32 v11, 8192, v11
  s_waitcnt vmcnt(9) lgkmcnt(6)
  v_mfma_f32_16x16x32_bf16 v[48:51], v[32:35], v[144:147], v[48:51]
  ds_read_b64_tr_b16 v[16:17], v8 offset:0
  s_waitcnt vmcnt(8)
  v_mfma_f32_16x16x32_bf16 v[64:67], v[32:35], v[148:151], v[64:67]
  ds_read_b64_tr_b16 v[18:19], v8 offset:512
  s_waitcnt lgkmcnt(6)
  v_mfma_f32_16x16x32_bf16 v[52:55], v[36:39], v[144:147], v[52:55]
  ds_read_b64_tr_b16 v[20:21], v9 offset:0
  v_mfma_f32_16x16x32_bf16 v[68:71], v[36:39], v[148:151], v[68:71]
  ds_read_b64_tr_b16 v[22:23], v9 offset:512
  s_waitcnt lgkmcnt(6)
  v_mfma_f32_16x16x32_bf16 v[56:59], v[40:43], v[144:147], v[56:59]
  ds_read_b64_tr_b16 v[24:25], v10 offset:0
  v_mfma_f32_16x16x32_bf16 v[72:75], v[40:43], v[148:151], v[72:75]
  ds_read_b64_tr_b16 v[26:27], v10 offset:512
  s_waitcnt lgkmcnt(6)
  v_mfma_f32_16x16x32_bf16 v[60:63], v[44:47], v[144:147], v[60:63]
  ds_read_b64_tr_b16 v[28:29], v11 offset:0
  v_mfma_f32_16x16x32_bf16 v[76:79], v[44:47], v[148:151], v[76:79]
  ds_read_b64_tr_b16 v[30:31], v11 offset:512
  s_waitcnt vmcnt(7) lgkmcnt(6)
  v_mfma_f32_16x16x32_bf16 v[48:51], v[16:19], v[152:155], v[48:51]
  ds_read_b64_tr_b16 v[32:33], v8 offset:4096
  s_waitcnt vmcnt(6)
  v_mfma_f32_16x16x32_bf16 v[64:67], v[16:19], v[156:159], v[64:67]
  ds_read_b64_tr_b16 v[34:35], v8 offset:4608
  v_add_u32 v8, 8192, v8
  s_waitcnt lgkmcnt(6)
  v_mfma_f32_16x16x32_bf16 v[52:55], v[20:23], v[152:155], v[52:55]
  ds_read_b64_tr_b16 v[36:37], v9 offset:4096
  v_mfma_f32_16x16x32_bf16 v[68:71], v[20:23], v[156:159], v[68:71]
  ds_read_b64_tr_b16 v[38:39], v9 offset:4608
  v_add_u32 v9, 8192, v9
  s_waitcnt lgkmcnt(6)
  v_mfma_f32_16x16x32_bf16 v[56:59], v[24:27], v[152:155], v[56:59]
  ds_read_b64_tr_b16 v[40:41], v10 offset:4096
  v_mfma_f32_16x16x32_bf16 v[72:75], v[24:27], v[156:159], v[72:75]
  ds_read_b64_tr_b16 v[42:43], v10 offset:4608
  v_add_u32 v10, 8192, v10
  s_waitcnt lgkmcnt(6)
  v_mfma_f32_16x16x32_bf16 v[60:63], v[28:31], v[152:155], v[60:63]
  ds_read_b64_tr_b16 v[44:45], v11 offset:4096
  v_mfma_f32_16x16x32_bf16 v[76:79], v[28:31], v[156:159], v[76:79]
  ds_read_b64_tr_b16 v[46:47], v11 offset:4608
  v_add_u32 v11, 8192, v11
  s_waitcnt vmcnt(5) lgkmcnt(6)
  v_mfma_f32_16x16x32_bf16 v[48:51], v[32:35], v[160:163], v[48:51]
  ds_read_b64_tr_b16 v[16:17], v8 offset:0
  s_waitcnt vmcnt(4)
  v_mfma_f32_16x16x32_bf16 v[64:67], v[32:35], v[164:167], v[64:67]
  ds_read_b64_tr_b16 v[18:19], v8 offset:512
  s_waitcnt lgkmcnt(6)
  v_mfma_f32_16x16x32_bf16 v[52:55], v[36:39], v[160:163], v[52:55]
  ds_read_b64_tr_b16 v[20:21], v9 offset:0
  v_mfma_f32_16x16x32_bf16 v[68:71], v[36:39], v[164:167], v[68:71]
  ds_read_b64_tr_b16 v[22:23], v9 offset:512
  s_waitcnt lgkmcnt(6)
  v_mfma_f32_16x16x32_bf16 v[56:59], v[40:43], v[160:163], v[56:59]
  ds_read_b64_tr_b16 v[24:25], v10 offset:0
  v_mfma_f32_16x16x32_bf16 v[72:75], v[40:43], v[164:167], v[72:75]
  ds_read_b64_tr_b16 v[26:27], v10 offset:512
  s_waitcnt lgkmcnt(6)
  v_mfma_f32_16x16x32_bf16 v[60:63], v[44:47], v[160:163], v[60:63]
  ds_read_b64_tr_b16 v[28:29], v11 offset:0
  v_mfma_f32_16x16x32_bf16 v[76:79], v[44:47], v[164:167], v[76:79]
  ds_read_b64_tr_b16 v[30:31], v11 offset:512
  s_waitcnt vmcnt(3) lgkmcnt(6)
  v_mfma_f32_16x16x32_bf16 v[48:51], v[16:19], v[168:171], v[48:51]
  ds_read_b64_tr_b16 v[32:33], v8 offset:4096
  s_waitcnt vmcnt(2)
  v_mfma_f32_16x16x32_bf16 v[64:67], v[16:19], v[172:175], v[64:67]
  ds_read_b64_tr_b16 v[34:35], v8 offset:4608
  s_waitcnt lgkmcnt(6)
  v_mfma_f32_16x16x32_bf16 v[52:55], v[20:23], v[168:171], v[52:55]
  ds_read_b64_tr_b16 v[36:37], v9 offset:4096
  v_mfma_f32_16x16x32_bf16 v[68:71], v[20:23], v[172:175], v[68:71]
  ds_read_b64_tr_b16 v[38:39], v9 offset:4608
  s_waitcnt lgkmcnt(6)
  v_mfma_f32_16x16x32_bf16 v[56:59], v[24:27], v[168:171], v[56:59]
  ds_read_b64_tr_b16 v[40:41], v10 offset:4096
  v_mfma_f32_16x16x32_bf16 v[72:75], v[24:27], v[172:175], v[72:75]
  ds_read_b64_tr_b16 v[42:43], v10 offset:4608
  s_waitcnt lgkmcnt(6)
  v_mfma_f32_16x16x32_bf16 v[60:63], v[28:31], v[168:171], v[60:63]
  ds_read_b64_tr_b16 v[44:45], v11 offset:4096
  v_mfma_f32_16x16x32_bf16 v[76:79], v[28:31], v[172:175], v[76:79]
  ds_read_b64_tr_b16 v[46:47], v11 offset:4608
  s_waitcnt vmcnt(1) lgkmcnt(6)
  v_mfma_f32_16x16x32_bf16 v[48:51], v[32:35], v[176:179], v[48:51]
  s_waitcnt vmcnt(0)
  v_mfma_f32_16x16x32_bf16 v[64:67], v[32:35], v[180:183], v[64:67]
  s_waitcnt lgkmcnt(4)
  v_mfma_f32_16x16x32_bf16 v[52:55], v[36:39], v[176:179], v[52:55]
  v_mfma_f32_16x16x32_bf16 v[68:71], v[36:39], v[180:183], v[68:71]
  s_waitcnt lgkmcnt(2)
  v_mfma_f32_16x16x32_bf16 v[56:59], v[40:43], v[176:179], v[56:59]
  v_mfma_f32_16x16x32_bf16 v[72:75], v[40:43], v[180:183], v[72:75]
  s_waitcnt lgkmcnt(0)
  v_mfma_f32_16x16x32_bf16 v[60:63], v[44:47], v[176:179], v[60:63]
  v_mfma_f32_16x16x32_bf16 v[76:79], v[44:47], v[180:183], v[76:79]
  s_waitcnt lgkmcnt(0)
  s_barrier
  s_add_u32 s20, s82, 4194304
  s_addc_u32 s21, s83, 0
  s_mov_b32 s22, 4194304
  s_mov_b32 s23, 0x20000
  s_add_u32 s24, s82, 8388608
  s_addc_u32 s25, s83, 0
  s_mov_b32 s26, 4194304
  s_mov_b32 s27, 0x20000
  v_pk_add_f32 v[16:17], v[48:49], v[50:51]
  v_pk_mul_f32 v[18:19], v[48:49], v[48:49]
  v_pk_fma_f32 v[18:19], v[50:51], v[50:51], v[18:19]
  v_pk_add_f32 v[16:17], v[16:17], v[52:53]
  v_pk_fma_f32 v[18:19], v[52:53], v[52:53], v[18:19]
  v_pk_add_f32 v[16:17], v[16:17], v[54:55]
  v_pk_fma_f32 v[18:19], v[54:55], v[54:55], v[18:19]
  v_pk_add_f32 v[16:17], v[16:17], v[56:57]
  v_pk_fma_f32 v[18:19], v[56:57], v[56:57], v[18:19]
  v_pk_add_f32 v[16:17], v[16:17], v[58:59]
  v_pk_fma_f32 v[18:19], v[58:59], v[58:59], v[18:19]
  v_pk_add_f32 v[16:17], v[16:17], v[60:61]
  v_pk_fma_f32 v[18:19], v[60:61], v[60:61], v[18:19]
  v_pk_add_f32 v[16:17], v[16:17], v[62:63]
  v_pk_fma_f32 v[18:19], v[62:63], v[62:63], v[18:19]
  v_add_f32 v24, v16, v17
  v_add_f32 v26, v18, v19
  v_pk_add_f32 v[20:21], v[64:65], v[66:67]
  v_pk_mul_f32 v[22:23], v[64:65], v[64:65]
  v_pk_fma_f32 v[22:23], v[66:67], v[66:67], v[22:23]
  v_pk_add_f32 v[20:21], v[20:21], v[68:69]
  v_pk_fma_f32 v[22:23], v[68:69], v[68:69], v[22:23]
  v_pk_add_f32 v[20:21], v[20:21], v[70:71]
  v_pk_fma_f32 v[22:23], v[70:71], v[70:71], v[22:23]
  v_pk_add_f32 v[20:21], v[20:21], v[72:73]
  v_pk_fma_f32 v[22:23], v[72:73], v[72:73], v[22:23]
  v_pk_add_f32 v[20:21], v[20:21], v[74:75]
  v_pk_fma_f32 v[22:23], v[74:75], v[74:75], v[22:23]
  v_pk_add_f32 v[20:21], v[20:21], v[76:77]
  v_pk_fma_f32 v[22:23], v[76:77], v[76:77], v[22:23]
  v_pk_add_f32 v[20:21], v[20:21], v[78:79]
  v_pk_fma_f32 v[22:23], v[78:79], v[78:79], v[22:23]
  v_add_f32 v25, v20, v21
  v_add_f32 v27, v22, v23
  s_nop 0
  v_permlane16_swap_b32 v24, v25
  v_permlane16_swap_b32 v26, v27
  v_add_f32 v28, v24, v25
  v_add_f32 v29, v26, v27
  v_mov_b32 v30, v28
  v_mov_b32 v31, v29
  s_nop 0
  v_permlane32_swap_b32 v28, v30
  v_permlane32_swap_b32 v29, v31
  v_add_f32 v28, v28, v30
  v_add_f32 v29, v29, v31
  v_and_b32 v29, 0x7fffffff, v29
  s_mov_b32 exec_hi, 0
  buffer_store_dwordx2 v[28:29], v112, s[12:15], 0 offen sc0 sc1
  s_mov_b64 exec, -1
  v_cvt_pk_bf16_f32 v96, v48, v49
  v_cvt_pk_bf16_f32 v97, v50, v51
  v_cvt_pk_bf16_f32 v98, v52, v53
  v_cvt_pk_bf16_f32 v99, v54, v55
  v_cvt_pk_bf16_f32 v100, v56, v57
  v_cvt_pk_bf16_f32 v101, v58, v59
  v_cvt_pk_bf16_f32 v102, v60, v61
  v_cvt_pk_bf16_f32 v103, v62, v63
  v_cvt_pk_bf16_f32 v104, v64, v65
  v_cvt_pk_bf16_f32 v105, v66, v67
  v_cvt_pk_bf16_f32 v106, v68, v69
  v_cvt_pk_bf16_f32 v107, v70, v71
  v_cvt_pk_bf16_f32 v108, v72, v73
  v_cvt_pk_bf16_f32 v109, v74, v75
  v_cvt_pk_bf16_f32 v110, v76, v77
  v_cvt_pk_bf16_f32 v111, v78, v79
  v_permlane16_swap_b32 v96, v98
  v_permlane16_swap_b32 v97, v99
  v_permlane16_swap_b32 v100, v102
  v_permlane16_swap_b32 v101, v103
  v_permlane16_swap_b32 v104, v106
  v_permlane16_swap_b32 v105, v107
  v_permlane16_swap_b32 v108, v110
  v_permlane16_swap_b32 v109, v111
  v_xor_b32 v116, 32, v115
  v_xor_b32 v121, 32, v114
  v_xor_b32 v117, 64, v115
  v_xor_b32 v122, 64, v114
  v_xor_b32 v118, 96, v115
  v_xor_b32 v123, 96, v114
  v_mov_b32 v120, v114
  s_mov_b32 s39, 0
k2_poll:
  buffer_load_dwordx2 v[32:33], v113, s[12:15], 0 offen sc0 sc1
  buffer_load_dwordx2 v[34:35], v113, s[12:15], s87 offen sc0 sc1
  buffer_load_dwordx2 v[36:37], v113, s[12:15], s88 offen sc0 sc1
  buffer_load_dwordx2 v[38:39], v113, s[12:15], s89 offen sc0 sc1
  buffer_load_dwordx2 v[40:41], v113, s[12:15], s90 offen sc0 sc1
  buffer_load_dwordx2 v[42:43], v113, s[12:15], s91 offen sc0 sc1
  buffer_load_dwordx2 v[44:45], v113, s[12:15], s92 offen sc0 sc1
  buffer_load_dwordx2 v[46:47], v113, s[12:15], s93 offen sc0 sc1
  s_waitcnt vmcnt(0)
  v_min3_i32 v16, v33, v35, v37
  v_min3_i32 v17, v39, v41, v43
  v_min3_i32 v16, v16, v45, v47
  v_min_i32 v16, v16, v17
  v_cmp_gt_i32 vcc, 0, v16
  s_add_u32 s39, s39, 1
  s_cmp_gt_u32 s39, 100000
  s_cbranch_scc1 k2_pdone
  s_cbranch_vccnz k2_poll
k2_pdone:
  buffer_store_dwordx4 v[96:99], v12, s[20:23], 0 offen offset:0 sc0 sc1
  buffer_store_dwordx4 v[100:103], v12, s[20:23], 0 offen offset:64 sc0 sc1
  buffer_store_dwordx4 v[104:107], v12, s[20:23], 0 offen offset:2048 sc0 sc1
  buffer_store_dwordx4 v[108:111], v12, s[20:23], 0 offen offset:2112 sc0 sc1
  v_pk_add_f32 v[32:33], v[32:33], v[34:35]
  v_pk_add_f32 v[36:37], v[36:37], v[38:39]
  v_pk_add_f32 v[40:41], v[40:41], v[42:43]
  v_pk_add_f32 v[44:45], v[44:45], v[46:47]
  v_pk_add_f32 v[32:33], v[32:33], v[36:37]
  v_pk_add_f32 v[40:41], v[40:41], v[44:45]
  v_pk_add_f32 v[32:33], v[32:33], v[40:41]
  v_mov_b32 v34, v32
  v_mov_b32 v35, v33
  s_nop 0
  v_permlane32_swap_b32 v32, v34
  v_permlane32_swap_b32 v33, v35
  v_add_f32 v32, v32, v34
  v_add_f32 v33, v33, v35
  v_mul_f32 v32, 0x3a800000, v32
  v_mul_f32 v33, 0x3a800000, v33
  v_fma_f32 v33, -v32, v32, v33
  v_max_f32 v33, 0, v33
  v_mov_b32 v36, v33
  v_cvt_pk_bf16_f32 v36, v36, v36
  v_lshlrev_b32 v36, 16, v36
  v_add_f32 v36, 0x3727c5ac, v36
  v_cvt_pk_bf16_f32 v36, v36, v36
  v_lshlrev_b32 v36, 16, v36
  v_sqrt_f32 v36, v36
  s_nop 0
  v_cvt_pk_bf16_f32 v36, v36, v36
  v_lshlrev_b32 v36, 16, v36
  v_rcp_f32 v36, v36
  s_nop 0
  v_mul_f32 v33, v33, v36
  v_mul_f32 v33, v33, v36
  v_cvt_pk_bf16_f32 v33, v33, v33
  v_lshlrev_b32 v33, 16, v33
  v_add_f32 v33, 0x3727c5ac, v33
  v_cvt_pk_bf16_f32 v33, v33, v33
  v_lshlrev_b32 v33, 16, v33
  v_sqrt_f32 v33, v33
  s_nop 0
  v_cvt_pk_bf16_f32 v33, v33, v33
  v_lshlrev_b32 v33, 16, v33
  v_rcp_f32 v33, v33
  s_nop 0
  v_mul_f32 v33, v33, v36
  v_mov_b32 v34, v32
  v_mov_b32 v35, v33
  s_nop 0
  v_permlane16_swap_b32 v32, v34
  v_permlane16_swap_b32 v33, v35
  v_pk_add_f32 v[48:49], v[48:49], v[32:33] op_sel_hi:[1,0] neg_lo:[0,1] neg_hi:[0,1]
  v_pk_add_f32 v[50:51], v[50:51], v[32:33] op_sel_hi:[1,0] neg_lo:[0,1] neg_hi:[0,1]
  v_pk_add_f32 v[52:53], v[52:53], v[32:33] op_sel_hi:[1,0] neg_lo:[0,1] neg_hi:[0,1]
  v_pk_add_f32 v[54:55], v[54:55], v[32:33] op_sel_hi:[1,0] neg_lo:[0,1] neg_hi:[0,1]
  v_pk_add_f32 v[56:57], v[56:57], v[32:33] op_sel_hi:[1,0] neg_lo:[0,1] neg_hi:[0,1]
  v_pk_add_f32 v[58:59], v[58:59], v[32:33] op_sel_hi:[1,0] neg_lo:[0,1] neg_hi:[0,1]
  v_pk_add_f32 v[60:61], v[60:61], v[32:33] op_sel_hi:[1,0] neg_lo:[0,1] neg_hi:[0,1]
  v_pk_add_f32 v[62:63], v[62:63], v[32:33] op_sel_hi:[1,0] neg_lo:[0,1] neg_hi:[0,1]
  v_pk_mul_f32 v[48:49], v[48:49], v[32:33] op_sel:[0,1] op_sel_hi:[1,1]
  v_pk_mul_f32 v[50:51], v[50:51], v[32:33] op_sel:[0,1] op_sel_hi:[1,1]
  v_pk_mul_f32 v[52:53], v[52:53], v[32:33] op_sel:[0,1] op_sel_hi:[1,1]
  v_pk_mul_f32 v[54:55], v[54:55], v[32:33] op_sel:[0,1] op_sel_hi:[1,1]
  v_pk_mul_f32 v[56:57], v[56:57], v[32:33] op_sel:[0,1] op_sel_hi:[1,1]
  v_pk_mul_f32 v[58:59], v[58:59], v[32:33] op_sel:[0,1] op_sel_hi:[1,1]
  v_pk_mul_f32 v[60:61], v[60:61], v[32:33] op_sel:[0,1] op_sel_hi:[1,1]
  v_pk_mul_f32 v[62:63], v[62:63], v[32:33] op_sel:[0,1] op_sel_hi:[1,1]
  v_cvt_pk_bf16_f32 v160, v48, v49
  v_cvt_pk_bf16_f32 v161, v50, v51
  ds_write_b64 v120, v[160:161] offset:0
  v_cvt_pk_bf16_f32 v162, v52, v53
  v_cvt_pk_bf16_f32 v163, v54, v55
  ds_write_b64 v121, v[162:163] offset:0
  v_cvt_pk_bf16_f32 v164, v56, v57
  v_cvt_pk_bf16_f32 v165, v58, v59
  ds_write_b64 v122, v[164:165] offset:0
  v_cvt_pk_bf16_f32 v166, v60, v61
  v_cvt_pk_bf16_f32 v167, v62, v63
  ds_write_b64 v123, v[166:167] offset:0
  v_pk_add_f32 v[64:65], v[64:65], v[34:35] op_sel_hi:[1,0] neg_lo:[0,1] neg_hi:[0,1]
  v_pk_add_f32 v[66:67], v[66:67], v[34:35] op_sel_hi:[1,0] neg_lo:[0,1] neg_hi:[0,1]
  v_pk_add_f32 v[68:69], v[68:69], v[34:35] op_sel_hi:[1,0] neg_lo:[0,1] neg_hi:[0,1]
  v_pk_add_f32 v[70:71], v[70:71], v[34:35] op_sel_hi:[1,0] neg_lo:[0,1] neg_hi:[0,1]
  v_pk_add_f32 v[72:73], v[72:73], v[34:35] op_sel_hi:[1,0] neg_lo:[0,1] neg_hi:[0,1]
  v_pk_add_f32 v[74:75], v[74:75], v[34:35] op_sel_hi:[1,0] neg_lo:[0,1] neg_hi:[0,1]
  v_pk_add_f32 v[76:77], v[76:77], v[34:35] op_sel_hi:[1,0] neg_lo:[0,1] neg_hi:[0,1]
  v_pk_add_f32 v[78:79], v[78:79], v[34:35] op_sel_hi:[1,0] neg_lo:[0,1] neg_hi:[0,1]
  v_pk_mul_f32 v[64:65], v[64:65], v[34:35] op_sel:[0,1] op_sel_hi:[1,1]
  v_pk_mul_f32 v[66:67], v[66:67], v[34:35] op_sel:[0,1] op_sel_hi:[1,1]
  v_pk_mul_f32 v[68:69], v[68:69], v[34:35] op_sel:[0,1] op_sel_hi:[1,1]
  v_pk_mul_f32 v[70:71], v[70:71], v[34:35] op_sel:[0,1] op_sel_hi:[1,1]
  v_pk_mul_f32 v[72:73], v[72:73], v[34:35] op_sel:[0,1] op_sel_hi:[1,1]
  v_pk_mul_f32 v[74:75], v[74:75], v[34:35] op_sel:[0,1] op_sel_hi:[1,1]
  v_pk_mul_f32 v[76:77], v[76:77], v[34:35] op_sel:[0,1] op_sel_hi:[1,1]
  v_pk_mul_f32 v[78:79], v[78:79], v[34:35] op_sel:[0,1] op_sel_hi:[1,1]
  v_cvt_pk_bf16_f32 v168, v64, v65
  v_cvt_pk_bf16_f32 v169, v66, v67
  ds_write_b64 v120, v[168:169] offset:128
  v_cvt_pk_bf16_f32 v170, v68, v69
  v_cvt_pk_bf16_f32 v171, v70, v71
  ds_write_b64 v121, v[170:171] offset:128
  v_cvt_pk_bf16_f32 v172, v72, v73
  v_cvt_pk_bf16_f32 v173, v74, v75
  ds_write_b64 v122, v[172:173] offset:128
  v_cvt_pk_bf16_f32 v174, v76, v77
  v_cvt_pk_bf16_f32 v175, v78, v79
  ds_write_b64 v123, v[174:175] offset:128
  s_waitcnt lgkmcnt(0)
  ds_read_b64_tr_b16 v[176:177], v115
  ds_read_b64_tr_b16 v[178:179], v115 offset:512
  ds_read_b64_tr_b16 v[180:181], v116
  ds_read_b64_tr_b16 v[182:183], v116 offset:512
  ds_read_b64_tr_b16 v[184:185], v117
  ds_read_b64_tr_b16 v[186:187], v117 offset:512
  ds_read_b64_tr_b16 v[188:189], v118
  ds_read_b64_tr_b16 v[190:191], v118 offset:512
  s_waitcnt lgkmcnt(6)
  buffer_store_dwordx4 v[176:179], v14, s[24:27], s44 offen sc0 sc1
  s_waitcnt lgkmcnt(4)
  buffer_store_dwordx4 v[180:183], v14, s[24:27], s45 offen sc0 sc1
  s_waitcnt lgkmcnt(2)
  buffer_store_dwordx4 v[184:187], v14, s[24:27], s46 offen sc0 sc1
  s_waitcnt lgkmcnt(0)
  buffer_store_dwordx4 v[188:191], v14, s[24:27], s47 offen sc0 sc1
  s_cmp_ge_u32 s2, 224
  s_cbranch_scc1 C_k3skip
  s_lshr_b32 s32, s2, 3
  s_mul_i32 s5, s32, 9363
  s_lshr_b32 s5, s5, 16
  s_mul_i32 s6, s5, 7
  s_sub_u32 s6, s32, s6
  s_lshl_b32 s7, s5, 1
  s_add_u32 s7, s7, s6
  s_and_b32 s7, s7, 7
  s_and_b32 s32, s2, 7
  s_lshr_b32 s28, s32, 2
  s_lshl_b32 s28, s28, 2
  s_add_u32 s28, s28, s5
  s_and_b32 s29, s32, 3
  s_mul_i32 s29, s29, 7
  s_add_u32 s29, s29, s6
  s_mov_b32 s30, 7
  s_mov_b32 s31, -1
  s_and_b32 s46, s4, 1
  s_lshr_b32 s41, s4, 1
  s_lshl_b32 s32, s29, 8
  s_lshl_b32 s44, s46, 7
  s_add_u32 s32, s32, s44
  v_lshlrev_b32 v16, 3, v5
  v_add_u32 v16, s32, v16
  s_mov_b32 s16, s74
  s_mov_b32 s17, s75
  s_mov_b32 s18, 7168
  s_mov_b32 s19, 0x20000
  buffer_load_dwordx2 v[144:145], v16, s[16:19], 0 offen offset:0
  buffer_load_dwordx2 v[146:147], v16, s[16:19], 0 offen offset:32
  buffer_load_dwordx2 v[148:149], v16, s[16:19], 0 offen offset:64
  buffer_load_dwordx2 v[150:151], v16, s[16:19], 0 offen offset:96
  s_add_u32 s20, s82, 12582912
  s_addc_u32 s21, s83, 0
  s_mov_b32 s22, 7340032
  s_mov_b32 s23, 0x20000
  v_lshl_add_u32 v17, v5, 3, v6
  v_lshlrev_b32 v17, 8, v17
  v_lshl_add_u32 v17, v7, 3, v17
  v_lshl_or_b32 v18, v2, 2, v6
  v_lshl_add_u32 v17, v18, 5, v17
  s_lshl_b32 s32, s46, 7
  s_add_u32 s32, s32, 16384
  v_xor_b32 v18, s32, v17
  s_lshl_b32 s32, s41, 13
  v_add_u32 v12, s32, v14
  v_xor_b32 v8, 0, v18
  v_xor_b32 v9, 32, v18
  v_xor_b32 v10, 64, v18
  v_xor_b32 v11, 96, v18
  v_bfe_u32 v17, v4, 2, 1
  v_lshlrev_b32 v17, 10, v17
  v_lshl_add_u32 v17, v3, 8, v17
  v_lshrrev_b32 v18, 3, v4
  v_lshl_add_u32 v17, v18, 6, v17
  v_lshl_add_u32 v152, v7, 4, v17
  v_add_u32 v153, 128, v152
  s_lshl_b32 s32, s28, 1
  s_add_u32 s32, s32, s41
  s_mul_i32 s32, s32, 224
  s_lshl_b32 s44, s29, 2
  s_add_u32 s32, s32, s44
  s_lshl_b32 s44, s46, 1
  s_add_u32 s32, s32, s44
  s_lshl_b32 s44, s32, 11
  s_add_u32 s45, s44, 229376
  s_waitcnt vmcnt(0)
  s_barrier
  v_lshlrev_b32 v80, 16, v144
  v_and_b32 v81, 0xffff0000, v144
  v_lshlrev_b32 v82, 16, v145
  v_and_b32 v83, 0xffff0000, v145
  v_mov_b64 v[96:97], v[80:81]
  v_mov_b64 v[98:99], v[82:83]
  v_mov_b64 v[112:113], v[80:81]
  v_mov_b64 v[114:115], v[82:83]
  v_mov_b64 v[128:129], v[80:81]
  v_mov_b64 v[130:131], v[82:83]
  v_lshlrev_b32 v84, 16, v146
  v_and_b32 v85, 0xffff0000, v146
  v_lshlrev_b32 v86, 16, v147
  v_and_b32 v87, 0xffff0000, v147
  v_mov_b64 v[100:101], v[84:85]
  v_mov_b64 v[102:103], v[86:87]
  v_mov_b64 v[116:117], v[84:85]
  v_mov_b64 v[118:119], v[86:87]
  v_mov_b64 v[132:133], v[84:85]
  v_mov_b64 v[134:135], v[86:87]
  v_lshlrev_b32 v88, 16, v148
  v_and_b32 v89, 0xffff0000, v148
  v_lshlrev_b32 v90, 16, v149
  v_and_b32 v91, 0xffff0000, v149
  v_mov_b64 v[104:105], v[88:89]
  v_mov_b64 v[106:107], v[90:91]
  v_mov_b64 v[120:121], v[88:89]
  v_mov_b64 v[122:123], v[90:91]
  v_mov_b64 v[136:137], v[88:89]
  v_mov_b64 v[138:139], v[90:91]
  v_lshlrev_b32 v92, 16, v150
  v_and_b32 v93, 0xffff0000, v150
  v_lshlrev_b32 v94, 16, v151
  v_and_b32 v95, 0xffff0000, v151
  v_mov_b64 v[108:109], v[92:93]
  v_mov_b64 v[110:111], v[94:95]
  v_mov_b64 v[124:125], v[92:93]
  v_mov_b64 v[126:127], v[94:95]
  v_mov_b64 v[140:141], v[92:93]
  v_mov_b64 v[142:143], v[94:95]
  s_mov_b32 s43, 0
  s_mov_b32 s39, 31
  s_barrier
  ds_read_b64_tr_b16 v[16:17], v8 offset:0
  ds_read_b64_tr_b16 v[18:19], v8 offset:1024
  ds_read_b128 v[32:35], v12 offset:0
  ds_read_b64_tr_b16 v[20:21], v9 offset:0
  ds_read_b64_tr_b16 v[22:23], v9 offset:1024
  ds_read_b128 v[36:39], v12 offset:2048
  ds_read_b64_tr_b16 v[24:25], v10 offset:0
  ds_read_b64_tr_b16 v[26:27], v10 offset:1024
  ds_read_b128 v[40:43], v12 offset:4096
  ds_read_b64_tr_b16 v[28:29], v11 offset:0
  ds_read_b64_tr_b16 v[30:31], v11 offset:1024
  ds_read_b128 v[44:47], v12 offset:6144
  s_add_u32 s40, s43, 32768
  s_cmp_eq_u32 s40, 163840
  s_cselect_b32 s40, 0, s40
  s_sub_u32 s42, s40, s43
  s_mov_b32 s43, s40
cl3:
  s_waitcnt lgkmcnt(9)
  v_mfma_f32_16x16x32_bf16 v[80:83], v[16:19], v[32:35], v[80:83]
  ds_read_b64_tr_b16 v[48:49], v8 offset:8192
  s_waitcnt lgkmcnt(7)
  v_mfma_f32_16x16x32_bf16 v[96:99], v[16:19], v[36:39], v[96:99]
  ds_read_b64_tr_b16 v[50:51], v8 offset:9216
  v_add_u32 v8, s42, v8
  v_mfma_f32_16x16x32_bf16 v[84:87], v[20:23], v[32:35], v[84:87]
  ds_read_b128 v[64:67], v12 offset:1024
  v_mfma_f32_16x16x32_bf16 v[100:103], v[20:23], v[36:39], v[100:103]
  ds_read_b64_tr_b16 v[52:53], v9 offset:8192
  s_waitcnt lgkmcnt(7)
  v_mfma_f32_16x16x32_bf16 v[112:115], v[16:19], v[40:43], v[112:115]
  ds_read_b64_tr_b16 v[54:55], v9 offset:9216
  v_add_u32 v9, s42, v9
  v_mfma_f32_16x16x32_bf16 v[116:119], v[20:23], v[40:43], v[116:119]
  ds_read_b128 v[68:71], v12 offset:3072
  v_mfma_f32_16x16x32_bf16 v[88:91], v[24:27], v[32:35], v[88:91]
  ds_read_b64_tr_b16 v[56:57], v10 offset:8192
  v_mfma_f32_16x16x32_bf16 v[104:107], v[24:27], v[36:39], v[104:107]
  ds_read_b64_tr_b16 v[58:59], v10 offset:9216
  v_add_u32 v10, s42, v10
  v_mfma_f32_16x16x32_bf16 v[120:123], v[24:27], v[40:43], v[120:123]
  ds_read_b128 v[72:75], v12 offset:5120
  s_waitcnt lgkmcnt(9)
  v_mfma_f32_16x16x32_bf16 v[128:131], v[16:19], v[44:47], v[128:131]
  ds_read_b64_tr_b16 v[60:61], v11 offset:8192
  v_mfma_f32_16x16x32_bf16 v[132:135], v[20:23], v[44:47], v[132:135]
  ds_read_b64_tr_b16 v[62:63], v11 offset:9216
  v_add_u32 v11, s42, v11
  v_mfma_f32_16x16x32_bf16 v[136:139], v[24:27], v[44:47], v[136:139]
  ds_read_b128 v[76:79], v12 offset:7168
  v_add_u32 v12, s42, v12
  v_mfma_f32_16x16x32_bf16 v[92:95], v[28:31], v[32:35], v[92:95]
  v_mfma_f32_16x16x32_bf16 v[108:111], v[28:31], v[36:39], v[108:111]
  v_mfma_f32_16x16x32_bf16 v[124:127], v[28:31], v[40:43], v[124:127]
  v_mfma_f32_16x16x32_bf16 v[140:143], v[28:31], v[44:47], v[140:143]
  s_barrier
  s_waitcnt lgkmcnt(9)
  v_mfma_f32_16x16x32_bf16 v[80:83], v[48:51], v[64:67], v[80:83]
  ds_read_b64_tr_b16 v[16:17], v8 offset:0
  s_add_u32 s40, s43, 32768
  s_waitcnt lgkmcnt(7)
  v_mfma_f32_16x16x32_bf16 v[96:99], v[48:51], v[68:71], v[96:99]
  ds_read_b64_tr_b16 v[18:19], v8 offset:1024
  s_cmp_eq_u32 s40, 163840
  v_mfma_f32_16x16x32_bf16 v[84:87], v[52:55], v[64:67], v[84:87]
  ds_read_b128 v[32:35], v12 offset:0
  s_cselect_b32 s40, 0, s40
  v_mfma_f32_16x16x32_bf16 v[100:103], v[52:55], v[68:71], v[100:103]
  ds_read_b64_tr_b16 v[20:21], v9 offset:0
  s_sub_u32 s42, s40, s43
  s_waitcnt lgkmcnt(7)
  v_mfma_f32_16x16x32_bf16 v[112:115], v[48:51], v[72:75], v[112:115]
  ds_read_b64_tr_b16 v[22:23], v9 offset:1024
  s_mov_b32 s43, s40
  v_mfma_f32_16x16x32_bf16 v[116:119], v[52:55], v[72:75], v[116:119]
  ds_read_b128 v[36:39], v12 offset:2048
  v_mfma_f32_16x16x32_bf16 v[88:91], v[56:59], v[64:67], v[88:91]
  ds_read_b64_tr_b16 v[24:25], v10 offset:0
  v_mfma_f32_16x16x32_bf16 v[104:107], v[56:59], v[68:71], v[104:107]
  ds_read_b64_tr_b16 v[26:27], v10 offset:1024
  v_mfma_f32_16x16x32_bf16 v[120:123], v[56:59], v[72:75], v[120:123]
  ds_read_b128 v[40:43], v12 offset:4096
  s_waitcnt lgkmcnt(9)
  v_mfma_f32_16x16x32_bf16 v[128:131], v[48:51], v[76:79], v[128:131]
  ds_read_b64_tr_b16 v[28:29], v11 offset:0
  v_mfma_f32_16x16x32_bf16 v[132:135], v[52:55], v[76:79], v[132:135]
  ds_read_b64_tr_b16 v[30:31], v11 offset:1024
  v_mfma_f32_16x16x32_bf16 v[136:139], v[56:59], v[76:79], v[136:139]
  ds_read_b128 v[44:47], v12 offset:6144
  v_mfma_f32_16x16x32_bf16 v[92:95], v[60:63], v[64:67], v[92:95]
  v_mfma_f32_16x16x32_bf16 v[108:111], v[60:63], v[68:71], v[108:111]
  v_mfma_f32_16x16x32_bf16 v[124:127], v[60:63], v[72:75], v[124:127]
  v_mfma_f32_16x16x32_bf16 v[140:143], v[60:63], v[76:79], v[140:143]
  s_sub_u32 s39, s39, 1
  s_cmp_lg_u32 s39, 0
  s_cbranch_scc1 cl3
  s_waitcnt lgkmcnt(9)
  v_mfma_f32_16x16x32_bf16 v[80:83], v[16:19], v[32:35], v[80:83]
  ds_read_b64_tr_b16 v[48:49], v8 offset:8192
  s_waitcnt lgkmcnt(7)
  v_mfma_f32_16x16x32_bf16 v[96:99], v[16:19], v[36:39], v[96:99]
  ds_read_b64_tr_b16 v[50:51], v8 offset:9216
  v_mfma_f32_16x16x32_bf16 v[84:87], v[20:23], v[32:35], v[84:87]
  ds_read_b128 v[64:67], v12 offset:1024
  v_mfma_f32_16x16x32_bf16 v[100:103], v[20:23], v[36:39], v[100:103]
  ds_read_b64_tr_b16 v[52:53], v9 offset:8192
  s_waitcnt lgkmcnt(7)
  v_mfma_f32_16x16x32_bf16 v[112:115], v[16:19], v[40:43], v[112:115]
  ds_read_b64_tr_b16 v[54:55], v9 offset:9216
  v_mfma_f32_16x16x32_bf16 v[116:119], v[20:23], v[40:43], v[116:119]
  ds_read_b128 v[68:71], v12 offset:3072
  v_mfma_f32_16x16x32_bf16 v[88:91], v[24:27], v[32:35], v[88:91]
  ds_read_b64_tr_b16 v[56:57], v10 offset:8192
  v_mfma_f32_16x16x32_bf16 v[104:107], v[24:27], v[36:39], v[104:107]
  ds_read_b64_tr_b16 v[58:59], v10 offset:9216
  v_mfma_f32_16x16x32_bf16 v[120:123], v[24:27], v[40:43], v[120:123]
  ds_read_b128 v[72:75], v12 offset:5120
  s_waitcnt lgkmcnt(9)
  v_mfma_f32_16x16x32_bf16 v[128:131], v[16:19], v[44:47], v[128:131]
  ds_read_b64_tr_b16 v[60:61], v11 offset:8192
  v_mfma_f32_16x16x32_bf16 v[132:135], v[20:23], v[44:47], v[132:135]
  ds_read_b64_tr_b16 v[62:63], v11 offset:9216
  v_mfma_f32_16x16x32_bf16 v[136:139], v[24:27], v[44:47], v[136:139]
  ds_read_b128 v[76:79], v12 offset:7168
  v_mfma_f32_16x16x32_bf16 v[92:95], v[28:31], v[32:35], v[92:95]
  v_mfma_f32_16x16x32_bf16 v[108:111], v[28:31], v[36:39], v[108:111]
  v_mfma_f32_16x16x32_bf16 v[124:127], v[28:31], v[40:43], v[124:127]
  v_mfma_f32_16x16x32_bf16 v[140:143], v[28:31], v[44:47], v[140:143]
  s_waitcnt lgkmcnt(9)
  v_mfma_f32_16x16x32_bf16 v[80:83], v[48:51], v[64:67], v[80:83]
  s_waitcnt lgkmcnt(6)
  v_mfma_f32_16x16x32_bf16 v[96:99], v[48:51], v[68:71], v[96:99]
  v_mfma_f32_16x16x32_bf16 v[84:87], v[52:55], v[64:67], v[84:87]
  v_mfma_f32_16x16x32_bf16 v[100:103], v[52:55], v[68:71], v[100:103]
  s_waitcnt lgkmcnt(3)
  v_mfma_f32_16x16x32_bf16 v[112:115], v[48:51], v[72:75], v[112:115]
  v_mfma_f32_16x16x32_bf16 v[116:119], v[52:55], v[72:75], v[116:119]
  v_mfma_f32_16x16x32_bf16 v[88:91], v[56:59], v[64:67], v[88:91]
  v_mfma_f32_16x16x32_bf16 v[104:107], v[56:59], v[68:71], v[104:107]
  v_mfma_f32_16x16x32_bf16 v[120:123], v[56:59], v[72:75], v[120:123]
  s_waitcnt lgkmcnt(0)
  v_mfma_f32_16x16x32_bf16 v[128:131], v[48:51], v[76:79], v[128:131]
  v_mfma_f32_16x16x32_bf16 v[132:135], v[52:55], v[76:79], v[132:135]
  v_mfma_f32_16x16x32_bf16 v[136:139], v[56:59], v[76:79], v[136:139]
  v_mfma_f32_16x16x32_bf16 v[92:95], v[60:63], v[64:67], v[92:95]
  v_mfma_f32_16x16x32_bf16 v[108:111], v[60:63], v[68:71], v[108:111]
  v_mfma_f32_16x16x32_bf16 v[124:127], v[60:63], v[72:75], v[124:127]
  v_mfma_f32_16x16x32_bf16 v[140:143], v[60:63], v[76:79], v[140:143]
  s_waitcnt lgkmcnt(0)
  v_mov_b32 v16, 0xc0135761
  v_mov_b32 v17, 0xbdd2d3e8
  v_pk_mul_f32 v[24:25], v[80:81], v[80:81]
  v_pk_mul_f32 v[26:27], v[82:83], v[82:83]
  v_pk_mul_f32 v[28:29], v[84:85], v[84:85]
  v_pk_mul_f32 v[30:31], v[86:87], v[86:87]
  v_pk_fma_f32 v[24:25], v[24:25], v[16:17], v[16:17] op_sel:[0,1,0] op_sel_hi:[1,1,0]
  v_pk_fma_f32 v[26:27], v[26:27], v[16:17], v[16:17] op_sel:[0,1,0] op_sel_hi:[1,1,0]
  v_pk_fma_f32 v[28:29], v[28:29], v[16:17], v[16:17] op_sel:[0,1,0] op_sel_hi:[1,1,0]
  v_pk_fma_f32 v[30:31], v[30:31], v[16:17], v[16:17] op_sel:[0,1,0] op_sel_hi:[1,1,0]
  v_pk_mul_f32 v[24:25], v[24:25], v[80:81]
  v_pk_mul_f32 v[26:27], v[26:27], v[82:83]
  v_pk_mul_f32 v[28:29], v[28:29], v[84:85]
  v_pk_mul_f32 v[30:31], v[30:31], v[86:87]
  v_exp_f32 v24, v24
  v_exp_f32 v25, v25
  v_exp_f32 v26, v26
  v_exp_f32 v27, v27
  v_exp_f32 v28, v28
  v_exp_f32 v29, v29
  v_exp_f32 v30, v30
  v_exp_f32 v31, v31
  v_pk_add_f32 v[24:25], v[24:25], 1.0 op_sel_hi:[1,0]
  v_pk_add_f32 v[26:27], v[26:27], 1.0 op_sel_hi:[1,0]
  v_pk_add_f32 v[28:29], v[28:29], 1.0 op_sel_hi:[1,0]
  v_pk_add_f32 v[30:31], v[30:31], 1.0 op_sel_hi:[1,0]
  v_rcp_f32 v24, v24
  v_rcp_f32 v25, v25
  v_rcp_f32 v26, v26
  v_rcp_f32 v27, v27
  v_rcp_f32 v28, v28
  v_rcp_f32 v29, v29
  v_rcp_f32 v30, v30
  v_rcp_f32 v31, v31
  v_pk_mul_f32 v[24:25], v[24:25], v[80:81]
  v_pk_mul_f32 v[26:27], v[26:27], v[82:83]
  v_pk_mul_f32 v[28:29], v[28:29], v[84:85]
  v_pk_mul_f32 v[30:31], v[30:31], v[86:87]
  v_cvt_pk_bf16_f32 v164, v24, v25
  v_cvt_pk_bf16_f32 v165, v26, v27
  v_cvt_pk_bf16_f32 v166, v28, v29
  v_cvt_pk_bf16_f32 v167, v30, v31
  s_nop 0
  v_permlane16_swap_b32 v164, v166
  v_permlane16_swap_b32 v165, v167
  buffer_store_dwordx4 v[164:167], v152, s[20:23], s44 offen offset:0 sc0 sc1
  v_pk_mul_f32 v[40:41], v[88:89], v[88:89]
  v_pk_mul_f32 v[42:43], v[90:91], v[90:91]
  v_pk_mul_f32 v[44:45], v[92:93], v[92:93]
  v_pk_mul_f32 v[46:47], v[94:95], v[94:95]
  v_pk_fma_f32 v[40:41], v[40:41], v[16:17], v[16:17] op_sel:[0,1,0] op_sel_hi:[1,1,0]
  v_pk_fma_f32 v[42:43], v[42:43], v[16:17], v[16:17] op_sel:[0,1,0] op_sel_hi:[1,1,0]
  v_pk_fma_f32 v[44:45], v[44:45], v[16:17], v[16:17] op_sel:[0,1,0] op_sel_hi:[1,1,0]
  v_pk_fma_f32 v[46:47], v[46:47], v[16:17], v[16:17] op_sel:[0,1,0] op_sel_hi:[1,1,0]
  v_pk_mul_f32 v[40:41], v[40:41], v[88:89]
  v_pk_mul_f32 v[42:43], v[42:43], v[90:91]
  v_pk_mul_f32 v[44:45], v[44:45], v[92:93]
  v_pk_mul_f32 v[46:47], v[46:47], v[94:95]
  v_exp_f32 v40, v40
  v_exp_f32 v41, v41
  v_exp_f32 v42, v42
  v_exp_f32 v43, v43
  v_exp_f32 v44, v44
  v_exp_f32 v45, v45
  v_exp_f32 v46, v46
  v_exp_f32 v47, v47
  v_pk_add_f32 v[40:41], v[40:41], 1.0 op_sel_hi:[1,0]
  v_pk_add_f32 v[42:43], v[42:43], 1.0 op_sel_hi:[1,0]
  v_pk_add_f32 v[44:45], v[44:45], 1.0 op_sel_hi:[1,0]
  v_pk_add_f32 v[46:47], v[46:47], 1.0 op_sel_hi:[1,0]
  v_rcp_f32 v40, v40
  v_rcp_f32 v41, v41
  v_rcp_f32 v42, v42
  v_rcp_f32 v43, v43
  v_rcp_f32 v44, v44
  v_rcp_f32 v45, v45
  v_rcp_f32 v46, v46
  v_rcp_f32 v47, v47
  v_pk_mul_f32 v[40:41], v[40:41], v[88:89]
  v_pk_mul_f32 v[42:43], v[42:43], v[90:91]
  v_pk_mul_f32 v[44:45], v[44:45], v[92:93]
  v_pk_mul_f32 v[46:47], v[46:47], v[94:95]
  v_cvt_pk_bf16_f32 v168, v40, v41
  v_cvt_pk_bf16_f32 v169, v42, v43
  v_cvt_pk_bf16_f32 v170, v44, v45
  v_cvt_pk_bf16_f32 v171, v46, v47
  s_nop 0
  v_permlane16_swap_b32 v168, v170
  v_permlane16_swap_b32 v169, v171
  buffer_store_dwordx4 v[168:171], v152, s[20:23], s44 offen offset:2048 sc0 sc1
  v_pk_mul_f32 v[24:25], v[96:97], v[96:97]
  v_pk_mul_f32 v[26:27], v[98:99], v[98:99]
  v_pk_mul_f32 v[28:29], v[100:101], v[100:101]
  v_pk_mul_f32 v[30:31], v[102:103], v[102:103]
  v_pk_fma_f32 v[24:25], v[24:25], v[16:17], v[16:17] op_sel:[0,1,0] op_sel_hi:[1,1,0]
  v_pk_fma_f32 v[26:27], v[26:27], v[16:17], v[16:17] op_sel:[0,1,0] op_sel_hi:[1,1,0]
  v_pk_fma_f32 v[28:29], v[28:29], v[16:17], v[16:17] op_sel:[0,1,0] op_sel_hi:[1,1,0]
  v_pk_fma_f32 v[30:31], v[30:31], v[16:17], v[16:17] op_sel:[0,1,0] op_sel_hi:[1,1,0]
  v_pk_mul_f32 v[24:25], v[24:25], v[96:97]
  v_pk_mul_f32 v[26:27], v[26:27], v[98:99]
  v_pk_mul_f32 v[28:29], v[28:29], v[100:101]
  v_pk_mul_f32 v[30:31], v[30:31], v[102:103]
  v_exp_f32 v24, v24
  v_exp_f32 v25, v25
  v_exp_f32 v26, v26
  v_exp_f32 v27, v27
  v_exp_f32 v28, v28
  v_exp_f32 v29, v29
  v_exp_f32 v30, v30
  v_exp_f32 v31, v31
  v_pk_add_f32 v[24:25], v[24:25], 1.0 op_sel_hi:[1,0]
  v_pk_add_f32 v[26:27], v[26:27], 1.0 op_sel_hi:[1,0]
  v_pk_add_f32 v[28:29], v[28:29], 1.0 op_sel_hi:[1,0]
  v_pk_add_f32 v[30:31], v[30:31], 1.0 op_sel_hi:[1,0]
  v_rcp_f32 v24, v24
  v_rcp_f32 v25, v25
  v_rcp_f32 v26, v26
  v_rcp_f32 v27, v27
  v_rcp_f32 v28, v28
  v_rcp_f32 v29, v29
  v_rcp_f32 v30, v30
  v_rcp_f32 v31, v31
  v_pk_mul_f32 v[24:25], v[24:25], v[96:97]
  v_pk_mul_f32 v[26:27], v[26:27], v[98:99]
  v_pk_mul_f32 v[28:29], v[28:29], v[100:101]
  v_pk_mul_f32 v[30:31], v[30:31], v[102:103]
  v_cvt_pk_bf16_f32 v172, v24, v25
  v_cvt_pk_bf16_f32 v173, v26, v27
  v_cvt_pk_bf16_f32 v174, v28, v29
  v_cvt_pk_bf16_f32 v175, v30, v31
  s_nop 0
  v_permlane16_swap_b32 v172, v174
  v_permlane16_swap_b32 v173, v175
  buffer_store_dwordx4 v[172:175], v153, s[20:23], s44 offen offset:0 sc0 sc1
  v_pk_mul_f32 v[40:41], v[104:105], v[104:105]
  v_pk_mul_f32 v[42:43], v[106:107], v[106:107]
  v_pk_mul_f32 v[44:45], v[108:109], v[108:109]
  v_pk_mul_f32 v[46:47], v[110:111], v[110:111]
  v_pk_fma_f32 v[40:41], v[40:41], v[16:17], v[16:17] op_sel:[0,1,0] op_sel_hi:[1,1,0]
  v_pk_fma_f32 v[42:43], v[42:43], v[16:17], v[16:17] op_sel:[0,1,0] op_sel_hi:[1,1,0]
  v_pk_fma_f32 v[44:45], v[44:45], v[16:17], v[16:17] op_sel:[0,1,0] op_sel_hi:[1,1,0]
  v_pk_fma_f32 v[46:47], v[46:47], v[16:17], v[16:17] op_sel:[0,1,0] op_sel_hi:[1,1,0]
  v_pk_mul_f32 v[40:41], v[40:41], v[104:105]
  v_pk_mul_f32 v[42:43], v[42:43], v[106:107]
  v_pk_mul_f32 v[44:45], v[44:45], v[108:109]
  v_pk_mul_f32 v[46:47], v[46:47], v[110:111]
  v_exp_f32 v40, v40
  v_exp_f32 v41, v41
  v_exp_f32 v42, v42
  v_exp_f32 v43, v43
  v_exp_f32 v44, v44
  v_exp_f32 v45, v45
  v_exp_f32 v46, v46
  v_exp_f32 v47, v47
  v_pk_add_f32 v[40:41], v[40:41], 1.0 op_sel_hi:[1,0]
  v_pk_add_f32 v[42:43], v[42:43], 1.0 op_sel_hi:[1,0]
  v_pk_add_f32 v[44:45], v[44:45], 1.0 op_sel_hi:[1,0]
  v_pk_add_f32 v[46:47], v[46:47], 1.0 op_sel_hi:[1,0]
  v_rcp_f32 v40, v40
  v_rcp_f32 v41, v41
  v_rcp_f32 v42, v42
  v_rcp_f32 v43, v43
  v_rcp_f32 v44, v44
  v_rcp_f32 v45, v45
  v_rcp_f32 v46, v46
  v_rcp_f32 v47, v47
  v_pk_mul_f32 v[40:41], v[40:41], v[104:105]
  v_pk_mul_f32 v[42:43], v[42:43], v[106:107]
  v_pk_mul_f32 v[44:45], v[44:45], v[108:109]
  v_pk_mul_f32 v[46:47], v[46:47], v[110:111]
  v_cvt_pk_bf16_f32 v176, v40, v41
  v_cvt_pk_bf16_f32 v177, v42, v43
  v_cvt_pk_bf16_f32 v178, v44, v45
  v_cvt_pk_bf16_f32 v179, v46, v47
  s_nop 0
  v_permlane16_swap_b32 v176, v178
  v_permlane16_swap_b32 v177, v179
  buffer_store_dwordx4 v[176:179], v153, s[20:23], s44 offen offset:2048 sc0 sc1
  v_pk_mul_f32 v[24:25], v[112:113], v[112:113]
  v_pk_mul_f32 v[26:27], v[114:115], v[114:115]
  v_pk_mul_f32 v[28:29], v[116:117], v[116:117]
  v_pk_mul_f32 v[30:31], v[118:119], v[118:119]
  v_pk_fma_f32 v[24:25], v[24:25], v[16:17], v[16:17] op_sel:[0,1,0] op_sel_hi:[1,1,0]
  v_pk_fma_f32 v[26:27], v[26:27], v[16:17], v[16:17] op_sel:[0,1,0] op_sel_hi:[1,1,0]
  v_pk_fma_f32 v[28:29], v[28:29], v[16:17], v[16:17] op_sel:[0,1,0] op_sel_hi:[1,1,0]
  v_pk_fma_f32 v[30:31], v[30:31], v[16:17], v[16:17] op_sel:[0,1,0] op_sel_hi:[1,1,0]
  v_pk_mul_f32 v[24:25], v[24:25], v[112:113]
  v_pk_mul_f32 v[26:27], v[26:27], v[114:115]
  v_pk_mul_f32 v[28:29], v[28:29], v[116:117]
  v_pk_mul_f32 v[30:31], v[30:31], v[118:119]
  v_exp_f32 v24, v24
  v_exp_f32 v25, v25
  v_exp_f32 v26, v26
  v_exp_f32 v27, v27
  v_exp_f32 v28, v28
  v_exp_f32 v29, v29
  v_exp_f32 v30, v30
  v_exp_f32 v31, v31
  v_pk_add_f32 v[24:25], v[24:25], 1.0 op_sel_hi:[1,0]
  v_pk_add_f32 v[26:27], v[26:27], 1.0 op_sel_hi:[1,0]
  v_pk_add_f32 v[28:29], v[28:29], 1.0 op_sel_hi:[1,0]
  v_pk_add_f32 v[30:31], v[30:31], 1.0 op_sel_hi:[1,0]
  v_rcp_f32 v24, v24
  v_rcp_f32 v25, v25
  v_rcp_f32 v26, v26
  v_rcp_f32 v27, v27
  v_rcp_f32 v28, v28
  v_rcp_f32 v29, v29
  v_rcp_f32 v30, v30
  v_rcp_f32 v31, v31
  v_pk_mul_f32 v[24:25], v[24:25], v[112:113]
  v_pk_mul_f32 v[26:27], v[26:27], v[114:115]
  v_pk_mul_f32 v[28:29], v[28:29], v[116:117]
  v_pk_mul_f32 v[30:31], v[30:31], v[118:119]
  v_cvt_pk_bf16_f32 v180, v24, v25
  v_cvt_pk_bf16_f32 v181, v26, v27
  v_cvt_pk_bf16_f32 v182, v28, v29
  v_cvt_pk_bf16_f32 v183, v30, v31
  s_nop 0
  v_permlane16_swap_b32 v180, v182
  v_permlane16_swap_b32 v181, v183
  buffer_store_dwordx4 v[180:183], v152, s[20:23], s45 offen offset:0 sc0 sc1
  v_pk_mul_f32 v[40:41], v[120:121], v[120:121]
  v_pk_mul_f32 v[42:43], v[122:123], v[122:123]
  v_pk_mul_f32 v[44:45], v[124:125], v[124:125]
  v_pk_mul_f32 v[46:47], v[126:127], v[126:127]
  v_pk_fma_f32 v[40:41], v[40:41], v[16:17], v[16:17] op_sel:[0,1,0] op_sel_hi:[1,1,0]
  v_pk_fma_f32 v[42:43], v[42:43], v[16:17], v[16:17] op_sel:[0,1,0] op_sel_hi:[1,1,0]
  v_pk_fma_f32 v[44:45], v[44:45], v[16:17], v[16:17] op_sel:[0,1,0] op_sel_hi:[1,1,0]
  v_pk_fma_f32 v[46:47], v[46:47], v[16:17], v[16:17] op_sel:[0,1,0] op_sel_hi:[1,1,0]
  v_pk_mul_f32 v[40:41], v[40:41], v[120:121]
  v_pk_mul_f32 v[42:43], v[42:43], v[122:123]
  v_pk_mul_f32 v[44:45], v[44:45], v[124:125]
  v_pk_mul_f32 v[46:47], v[46:47], v[126:127]
  v_exp_f32 v40, v40
  v_exp_f32 v41, v41
  v_exp_f32 v42, v42
  v_exp_f32 v43, v43
  v_exp_f32 v44, v44
  v_exp_f32 v45, v45
  v_exp_f32 v46, v46
  v_exp_f32 v47, v47
  v_pk_add_f32 v[40:41], v[40:41], 1.0 op_sel_hi:[1,0]
  v_pk_add_f32 v[42:43], v[42:43], 1.0 op_sel_hi:[1,0]
  v_pk_add_f32 v[44:45], v[44:45], 1.0 op_sel_hi:[1,0]
  v_pk_add_f32 v[46:47], v[46:47], 1.0 op_sel_hi:[1,0]
  v_rcp_f32 v40, v40
  v_rcp_f32 v41, v41
  v_rcp_f32 v42, v42
  v_rcp_f32 v43, v43
  v_rcp_f32 v44, v44
  v_rcp_f32 v45, v45
  v_rcp_f32 v46, v46
  v_rcp_f32 v47, v47
  v_pk_mul_f32 v[40:41], v[40:41], v[120:121]
  v_pk_mul_f32 v[42:43], v[42:43], v[122:123]
  v_pk_mul_f32 v[44:45], v[44:45], v[124:125]
  v_pk_mul_f32 v[46:47], v[46:47], v[126:127]
  v_cvt_pk_bf16_f32 v184, v40, v41
  v_cvt_pk_bf16_f32 v185, v42, v43
  v_cvt_pk_bf16_f32 v186, v44, v45
  v_cvt_pk_bf16_f32 v187, v46, v47
  s_nop 0
  v_permlane16_swap_b32 v184, v186
  v_permlane16_swap_b32 v185, v187
  buffer_store_dwordx4 v[184:187], v152, s[20:23], s45 offen offset:2048 sc0 sc1
  v_pk_mul_f32 v[24:25], v[128:129], v[128:129]
  v_pk_mul_f32 v[26:27], v[130:131], v[130:131]
  v_pk_mul_f32 v[28:29], v[132:133], v[132:133]
  v_pk_mul_f32 v[30:31], v[134:135], v[134:135]
  v_pk_fma_f32 v[24:25], v[24:25], v[16:17], v[16:17] op_sel:[0,1,0] op_sel_hi:[1,1,0]
  v_pk_fma_f32 v[26:27], v[26:27], v[16:17], v[16:17] op_sel:[0,1,0] op_sel_hi:[1,1,0]
  v_pk_fma_f32 v[28:29], v[28:29], v[16:17], v[16:17] op_sel:[0,1,0] op_sel_hi:[1,1,0]
  v_pk_fma_f32 v[30:31], v[30:31], v[16:17], v[16:17] op_sel:[0,1,0] op_sel_hi:[1,1,0]
  v_pk_mul_f32 v[24:25], v[24:25], v[128:129]
  v_pk_mul_f32 v[26:27], v[26:27], v[130:131]
  v_pk_mul_f32 v[28:29], v[28:29], v[132:133]
  v_pk_mul_f32 v[30:31], v[30:31], v[134:135]
  v_exp_f32 v24, v24
  v_exp_f32 v25, v25
  v_exp_f32 v26, v26
  v_exp_f32 v27, v27
  v_exp_f32 v28, v28
  v_exp_f32 v29, v29
  v_exp_f32 v30, v30
  v_exp_f32 v31, v31
  v_pk_add_f32 v[24:25], v[24:25], 1.0 op_sel_hi:[1,0]
  v_pk_add_f32 v[26:27], v[26:27], 1.0 op_sel_hi:[1,0]
  v_pk_add_f32 v[28:29], v[28:29], 1.0 op_sel_hi:[1,0]
  v_pk_add_f32 v[30:31], v[30:31], 1.0 op_sel_hi:[1,0]
  v_rcp_f32 v24, v24
  v_rcp_f32 v25, v25
  v_rcp_f32 v26, v26
  v_rcp_f32 v27, v27
  v_rcp_f32 v28, v28
  v_rcp_f32 v29, v29
  v_rcp_f32 v30, v30
  v_rcp_f32 v31, v31
  v_pk_mul_f32 v[24:25], v[24:25], v[128:129]
  v_pk_mul_f32 v[26:27], v[26:27], v[130:131]
  v_pk_mul_f32 v[28:29], v[28:29], v[132:133]
  v_pk_mul_f32 v[30:31], v[30:31], v[134:135]
  v_cvt_pk_bf16_f32 v188, v24, v25
  v_cvt_pk_bf16_f32 v189, v26, v27
  v_cvt_pk_bf16_f32 v190, v28, v29
  v_cvt_pk_bf16_f32 v191, v30, v31
  s_nop 0
  v_permlane16_swap_b32 v188, v190
  v_permlane16_swap_b32 v189, v191
  buffer_store_dwordx4 v[188:191], v153, s[20:23], s45 offen offset:0 sc0 sc1
  v_pk_mul_f32 v[40:41], v[136:137], v[136:137]
  v_pk_mul_f32 v[42:43], v[138:139], v[138:139]
  v_pk_mul_f32 v[44:45], v[140:141], v[140:141]
  v_pk_mul_f32 v[46:47], v[142:143], v[142:143]
  v_pk_fma_f32 v[40:41], v[40:41], v[16:17], v[16:17] op_sel:[0,1,0] op_sel_hi:[1,1,0]
  v_pk_fma_f32 v[42:43], v[42:43], v[16:17], v[16:17] op_sel:[0,1,0] op_sel_hi:[1,1,0]
  v_pk_fma_f32 v[44:45], v[44:45], v[16:17], v[16:17] op_sel:[0,1,0] op_sel_hi:[1,1,0]
  v_pk_fma_f32 v[46:47], v[46:47], v[16:17], v[16:17] op_sel:[0,1,0] op_sel_hi:[1,1,0]
  v_pk_mul_f32 v[40:41], v[40:41], v[136:137]
  v_pk_mul_f32 v[42:43], v[42:43], v[138:139]
  v_pk_mul_f32 v[44:45], v[44:45], v[140:141]
  v_pk_mul_f32 v[46:47], v[46:47], v[142:143]
  v_exp_f32 v40, v40
  v_exp_f32 v41, v41
  v_exp_f32 v42, v42
  v_exp_f32 v43, v43
  v_exp_f32 v44, v44
  v_exp_f32 v45, v45
  v_exp_f32 v46, v46
  v_exp_f32 v47, v47
  v_pk_add_f32 v[40:41], v[40:41], 1.0 op_sel_hi:[1,0]
  v_pk_add_f32 v[42:43], v[42:43], 1.0 op_sel_hi:[1,0]
  v_pk_add_f32 v[44:45], v[44:45], 1.0 op_sel_hi:[1,0]
  v_pk_add_f32 v[46:47], v[46:47], 1.0 op_sel_hi:[1,0]
  v_rcp_f32 v40, v40
  v_rcp_f32 v41, v41
  v_rcp_f32 v42, v42
  v_rcp_f32 v43, v43
  v_rcp_f32 v44, v44
  v_rcp_f32 v45, v45
  v_rcp_f32 v46, v46
  v_rcp_f32 v47, v47
  v_pk_mul_f32 v[40:41], v[40:41], v[136:137]
  v_pk_mul_f32 v[42:43], v[42:43], v[138:139]
  v_pk_mul_f32 v[44:45], v[44:45], v[140:141]
  v_pk_mul_f32 v[46:47], v[46:47], v[142:143]
  v_cvt_pk_bf16_f32 v192, v40, v41
  v_cvt_pk_bf16_f32 v193, v42, v43
  v_cvt_pk_bf16_f32 v194, v44, v45
  v_cvt_pk_bf16_f32 v195, v46, v47
  s_nop 0
  v_permlane16_swap_b32 v192, v194
  v_permlane16_swap_b32 v193, v195
  buffer_store_dwordx4 v[192:195], v153, s[20:23], s45 offen offset:2048 sc0 sc1
C_k3skip:
  s_nop 7
  s_nop 7
  s_lshr_b32 s32, s2, 3
  s_lshr_b32 s5, s32, 3
  s_and_b32 s6, s32, 7
  s_lshl_b32 s7, s5, 1
  s_add_u32 s7, s7, s6
  s_and_b32 s7, s7, 7
  s_and_b32 s32, s2, 7
  s_lshr_b32 s28, s32, 2
  s_lshl_b32 s28, s28, 2
  s_add_u32 s28, s28, s5
  s_and_b32 s29, s32, 3
  s_mul_i32 s29, s29, 8
  s_add_u32 s29, s29, s6
  s_mov_b32 s30, 7
  s_mov_b32 s31, -1
  s_lshl_b32 s32, s29, 6
  v_add_u32 v13, s32, v4
  v_lshlrev_b32 v12, 11, v13
  v_lshl_add_u32 v12, v5, 4, v12
  s_lshl_b32 s32, s28, 8
  s_lshl_b32 s40, s4, 6
  s_add_u32 s32, s32, s40
  v_add_u32 v12, s32, v12
  v_lshlrev_b32 v13, 1, v13
  v_lshlrev_b32 v14, 4, v0
  s_lshl_b32 s34, s28, 2
  s_add_u32 s34, s34, s4
  s_mul_i32 s34, s34, 229376
  s_mov_b32 s45, 32768
  s_mov_b32 s46, 65536
  s_mov_b32 s47, 98304
  s_add_u32 s8, s82, 12582912
  s_addc_u32 s9, s83, 0
  s_mov_b32 s10, 7340032
  s_mov_b32 s11, 0x20000
  s_add_u32 s16, s82, 4194304
  s_addc_u32 s17, s83, 0
  s_mov_b32 s18, 4194304
  s_mov_b32 s19, 0x20000
  s_mov_b32 s12, s78
  s_mov_b32 s13, s79
  s_mov_b32 s14, 4096
  s_mov_b32 s15, 0x20000
  buffer_load_ushort v112, v13, s[12:15], 0 offen offset:0
  buffer_load_ushort v114, v13, s[12:15], 0 offen offset:32
  buffer_load_ushort v116, v13, s[12:15], 0 offen offset:64
  buffer_load_ushort v118, v13, s[12:15], 0 offen offset:96
  v_lshl_add_u32 v16, v5, 3, v6
  v_lshlrev_b32 v16, 7, v16
  v_lshl_add_u32 v16, v7, 3, v16
  v_lshrrev_b32 v17, 1, v6
  v_lshl_or_b32 v17, v2, 1, v17
  v_lshl_add_u32 v16, v17, 5, v16
  v_add_u32 v16, 98304, v16
  v_xor_b32 v8, 0, v16
  v_xor_b32 v9, 32, v16
  v_xor_b32 v10, 64, v16
  v_xor_b32 v11, 96, v16
  s_lshl_b32 s48, 0x303, s7
  s_lshr_b32 s48, s48, 8
  s_mov_b32 s49, s34
  s_add_u32 s50, s34, 32768
  s_add_u32 s41, s34, 229376
  v_lshlrev_b32 v222, 3, v0
  s_lshl_b32 s32, s4, 9
  s_add_u32 s32, s32, 90112
  v_add_u32 v223, s32, v222
  s_add_u32 s24, s84, 29360128
  s_addc_u32 s25, s85, 0
  s_mov_b32 s26, 262144
  s_mov_b32 s27, 0x20000
  s_lshl_b32 s32, s28, 5
  v_min_u32 v15, 27, v0
  v_add_u32 v15, s32, v15
  v_max_i32 v15, 0, v15
  v_lshlrev_b32 v15, 7, v15
  s_lshl_b32 s55, s3, 17
  s_add_u32 s55, s55, 65536
  s_waitcnt vmcnt(0)
  s_barrier
  s_cmp_lt_u32 s2, 224
  s_cbranch_scc1 C_nopf
  s_cmp_lg_u32 s3, 0
  s_cbranch_scc1 C_nopf
  s_mov_b32 s20, s76
  s_mov_b32 s21, s77
  s_mov_b32 s22, 14680064
  s_mov_b32 s23, 0x20000
  s_sub_u32 s32, s2, 224
  s_lshl_b32 s32, s32, 2
  s_add_u32 s32, s32, s4
  s_lshl_b32 s32, s32, 13
  v_lshlrev_b32 v17, 7, v0
  buffer_load_dword v18, v17, s[20:23], s32 offen
  s_add_u32 s32, s32, 1048576
  buffer_load_dword v18, v17, s[20:23], s32 offen
  s_add_u32 s32, s32, 1048576
  s_waitcnt vmcnt(1)
  buffer_load_dword v18, v17, s[20:23], s32 offen
  s_add_u32 s32, s32, 1048576
  s_waitcnt vmcnt(1)
  buffer_load_dword v18, v17, s[20:23], s32 offen
  s_add_u32 s32, s32, 1048576
  s_waitcnt vmcnt(1)
  buffer_load_dword v18, v17, s[20:23], s32 offen
  s_add_u32 s32, s32, 1048576
  s_waitcnt vmcnt(1)
  buffer_load_dword v18, v17, s[20:23], s32 offen
  s_add_u32 s32, s32, 1048576
  s_waitcnt vmcnt(1)
  buffer_load_dword v18, v17, s[20:23], s32 offen
  s_add_u32 s32, s32, 1048576
  s_waitcnt vmcnt(1)
  buffer_load_dword v18, v17, s[20:23], s32 offen
  s_add_u32 s32, s32, 1048576
  s_waitcnt vmcnt(1)
  buffer_load_dword v18, v17, s[20:23], s32 offen
  s_add_u32 s32, s32, 1048576
  s_waitcnt vmcnt(1)
  buffer_load_dword v18, v17, s[20:23], s32 offen
  s_add_u32 s32, s32, 1048576
  s_waitcnt vmcnt(1)
  buffer_load_dword v18, v17, s[20:23], s32 offen
  s_add_u32 s32, s32, 1048576
  s_waitcnt vmcnt(1)
  buffer_load_dword v18, v17, s[20:23], s32 offen
  s_add_u32 s32, s32, 1048576
  s_waitcnt vmcnt(1)
  buffer_load_dword v18, v17, s[20:23], s32 offen
  s_add_u32 s32, s32, 1048576
  s_waitcnt vmcnt(1)
  buffer_load_dword v18, v17, s[20:23], s32 offen
  s_add_u32 s32, s32, 1048576
  s_waitcnt vmcnt(1)
C_nopf:
  s_mov_b32 s39, 0
poll4:
  buffer_load_dword v16, v15, s[24:27], s55 offen sc0 sc1
  s_waitcnt vmcnt(0)
  v_cmp_eq_u32 vcc, 0, v16
  s_add_u32 s39, s39, 1
  s_cmp_gt_u32 s39, 100000
  s_cbranch_scc1 poll4d
  s_cbranch_vccnz poll4
poll4d:
  buffer_load_dwordx4 v[96:99], v12, s[16:19], 0 offen sc1
  buffer_load_dwordx4 v[100:103], v12, s[16:19], s45 offen sc1
  buffer_load_dwordx4 v[104:107], v12, s[16:19], s46 offen sc1
  buffer_load_dwordx4 v[108:111], v12, s[16:19], s47 offen sc1
  s_cmp_eq_u32 s3, 0
  s_cselect_b32 s24, s84, s80
  s_cselect_b32 s25, s85, s81
  s_cselect_b32 s26, 25165824, 0
  s_add_u32 s24, s24, s26
  s_addc_u32 s25, s25, 0
  s_mov_b32 s26, 4194304
  s_mov_b32 s27, 0x20000
  s_add_u32 s12, s84, 55574528
  s_addc_u32 s13, s85, 0
  s_mov_b32 s14, 131072
  s_mov_b32 s15, 0x20000
  s_bitcmp1_b32 s48, 0
  s_cselect_b32 s36, s50, s49
  s_add_u32 s36, s36, 0
  buffer_load_dwordx4 v[120:123], v14, s[8:11], s36 offen offset:0 sc1
  buffer_load_dwordx4 v[124:127], v14, s[8:11], s36 offen offset:1024 sc1
  buffer_load_dwordx4 v[128:131], v14, s[8:11], s36 offen offset:2048 sc1
  buffer_load_dwordx4 v[132:135], v14, s[8:11], s36 offen offset:3072 sc1
  s_bitcmp1_b32 s48, 1
  s_cselect_b32 s36, s50, s49
  s_add_u32 s36, s36, 4096
  buffer_load_dwordx4 v[136:139], v14, s[8:11], s36 offen offset:0 sc1
  buffer_load_dwordx4 v[140:143], v14, s[8:11], s36 offen offset:1024 sc1
  buffer_load_dwordx4 v[144:147], v14, s[8:11], s36 offen offset:2048 sc1
  buffer_load_dwordx4 v[148:151], v14, s[8:11], s36 offen offset:3072 sc1
  s_waitcnt vmcnt(8)
  v_lshlrev_b32 v112, 16, v112
  v_lshlrev_b32 v48, 16, v96
  v_and_b32 v49, 0xffff0000, v96
  v_lshlrev_b32 v50, 16, v97
  v_and_b32 v51, 0xffff0000, v97
  v_lshlrev_b32 v52, 16, v98
  v_and_b32 v53, 0xffff0000, v98
  v_lshlrev_b32 v54, 16, v99
  v_and_b32 v55, 0xffff0000, v99
  v_pk_add_f32 v[48:49], v[48:49], v[112:113] op_sel_hi:[1,0]
  v_pk_add_f32 v[50:51], v[50:51], v[112:113] op_sel_hi:[1,0]
  v_pk_add_f32 v[52:53], v[52:53], v[112:113] op_sel_hi:[1,0]
  v_pk_add_f32 v[54:55], v[54:55], v[112:113] op_sel_hi:[1,0]
  v_lshlrev_b32 v114, 16, v114
  v_lshlrev_b32 v56, 16, v100
  v_and_b32 v57, 0xffff0000, v100
  v_lshlrev_b32 v58, 16, v101
  v_and_b32 v59, 0xffff0000, v101
  v_lshlrev_b32 v60, 16, v102
  v_and_b32 v61, 0xffff0000, v102
  v_lshlrev_b32 v62, 16, v103
  v_and_b32 v63, 0xffff0000, v103
  v_pk_add_f32 v[56:57], v[56:57], v[114:115] op_sel_hi:[1,0]
  v_pk_add_f32 v[58:59], v[58:59], v[114:115] op_sel_hi:[1,0]
  v_pk_add_f32 v[60:61], v[60:61], v[114:115] op_sel_hi:[1,0]
  v_pk_add_f32 v[62:63], v[62:63], v[114:115] op_sel_hi:[1,0]
  v_lshlrev_b32 v116, 16, v116
  v_lshlrev_b32 v64, 16, v104
  v_and_b32 v65, 0xffff0000, v104
  v_lshlrev_b32 v66, 16, v105
  v_and_b32 v67, 0xffff0000, v105
  v_lshlrev_b32 v68, 16, v106
  v_and_b32 v69, 0xffff0000, v106
  v_lshlrev_b32 v70, 16, v107
  v_and_b32 v71, 0xffff0000, v107
  v_pk_add_f32 v[64:65], v[64:65], v[116:117] op_sel_hi:[1,0]
  v_pk_add_f32 v[66:67], v[66:67], v[116:117] op_sel_hi:[1,0]
  v_pk_add_f32 v[68:69], v[68:69], v[116:117] op_sel_hi:[1,0]
  v_pk_add_f32 v[70:71], v[70:71], v[116:117] op_sel_hi:[1,0]
  v_lshlrev_b32 v118, 16, v118
  v_lshlrev_b32 v72, 16, v108
  v_and_b32 v73, 0xffff0000, v108
  v_lshlrev_b32 v74, 16, v109
  v_and_b32 v75, 0xffff0000, v109
  v_lshlrev_b32 v76, 16, v110
  v_and_b32 v77, 0xffff0000, v110
  v_lshlrev_b32 v78, 16, v111
  v_and_b32 v79, 0xffff0000, v111
  v_pk_add_f32 v[72:73], v[72:73], v[118:119] op_sel_hi:[1,0]
  v_pk_add_f32 v[74:75], v[74:75], v[118:119] op_sel_hi:[1,0]
  v_pk_add_f32 v[76:77], v[76:77], v[118:119] op_sel_hi:[1,0]
  v_pk_add_f32 v[78:79], v[78:79], v[118:119] op_sel_hi:[1,0]
  s_bitcmp1_b32 s48, 2
  s_cselect_b32 s36, s50, s49
  s_add_u32 s36, s36, 8192
  buffer_load_dwordx4 v[152:155], v14, s[8:11], s36 offen offset:0 sc1
  buffer_load_dwordx4 v[156:159], v14, s[8:11], s36 offen offset:1024 sc1
  buffer_load_dwordx4 v[160:163], v14, s[8:11], s36 offen offset:2048 sc1
  buffer_load_dwordx4 v[164:167], v14, s[8:11], s36 offen offset:3072 sc1
  s_bitcmp1_b32 s48, 3
  s_cselect_b32 s36, s50, s49
  s_add_u32 s36, s36, 12288
  buffer_load_dwordx4 v[168:171], v14, s[8:11], s36 offen offset:0 sc1
  buffer_load_dwordx4 v[172:175], v14, s[8:11], s36 offen offset:1024 sc1
  s_mov_b32 s43, 0
  s_mov_b32 s39, 6
  s_barrier
  ds_read_b64_tr_b16 v[16:17], v8 offset:0
  ds_read_b64_tr_b16 v[18:19], v8 offset:512
  ds_read_b64_tr_b16 v[20:21], v9 offset:0
  ds_read_b64_tr_b16 v[22:23], v9 offset:512
  ds_read_b64_tr_b16 v[24:25], v10 offset:0
  ds_read_b64_tr_b16 v[26:27], v10 offset:512
  ds_read_b64_tr_b16 v[28:29], v11 offset:0
  ds_read_b64_tr_b16 v[30:31], v11 offset:512
  s_add_u32 s40, s43, 8192
  s_cmp_eq_u32 s40, 65536
  s_cselect_b32 s40, 0, s40
  s_sub_u32 s42, s40, s43
  s_mov_b32 s43, s40
cd5:
  s_waitcnt vmcnt(13) lgkmcnt(6)
  v_mfma_f32_16x16x32_bf16 v[48:51], v[120:123], v[16:19], v[48:51]
  ds_read_b64_tr_b16 v[32:33], v8 offset:4096
  s_waitcnt vmcnt(12)
  v_mfma_f32_16x16x32_bf16 v[52:55], v[124:127], v[16:19], v[52:55]
  ds_read_b64_tr_b16 v[34:35], v8 offset:4608
  v_add_u32 v8, s42, v8
  s_waitcnt lgkmcnt(6)
  v_mfma_f32_16x16x32_bf16 v[56:59], v[120:123], v[20:23], v[56:59]
  ds_read_b64_tr_b16 v[36:37], v9 offset:4096
  buffer_load_dwordx4 v[176:179], v14, s[8:11], s36 offen offset:2048 sc1
  v_mfma_f32_16x16x32_bf16 v[60:63], v[124:127], v[20:23], v[60:63]
  ds_read_b64_tr_b16 v[38:39], v9 offset:4608
  v_add_u32 v9, s42, v9
  s_waitcnt lgkmcnt(6)
  v_mfma_f32_16x16x32_bf16 v[64:67], v[120:123], v[24:27], v[64:67]
  ds_read_b64_tr_b16 v[40:41], v10 offset:4096
  v_mfma_f32_16x16x32_bf16 v[68:71], v[124:127], v[24:27], v[68:71]
  ds_read_b64_tr_b16 v[42:43], v10 offset:4608
  v_add_u32 v10, s42, v10
  s_waitcnt lgkmcnt(6)
  v_mfma_f32_16x16x32_bf16 v[72:75], v[120:123], v[28:31], v[72:75]
  ds_read_b64_tr_b16 v[44:45], v11 offset:4096
  buffer_load_dwordx4 v[180:183], v14, s[8:11], s36 offen offset:3072 sc1
  v_mfma_f32_16x16x32_bf16 v[76:79], v[124:127], v[28:31], v[76:79]
  ds_read_b64_tr_b16 v[46:47], v11 offset:4608
  v_add_u32 v11, s42, v11
  s_barrier
  s_waitcnt vmcnt(13) lgkmcnt(6)
  v_mfma_f32_16x16x32_bf16 v[48:51], v[128:131], v[32:35], v[48:51]
  ds_read_b64_tr_b16 v[16:17], v8 offset:0
  s_bitcmp1_b32 s48, 4
  s_cselect_b32 s36, s50, s49
  s_waitcnt vmcnt(12)
  v_mfma_f32_16x16x32_bf16 v[52:55], v[132:135], v[32:35], v[52:55]
  ds_read_b64_tr_b16 v[18:19], v8 offset:512
  s_add_u32 s36, s36, 16384
  s_add_u32 s40, s43, 8192
  s_waitcnt lgkmcnt(6)
  v_mfma_f32_16x16x32_bf16 v[56:59], v[128:131], v[36:39], v[56:59]
  ds_read_b64_tr_b16 v[20:21], v9 offset:0
  s_cmp_eq_u32 s40, 65536
  s_cselect_b32 s40, 0, s40
  v_mfma_f32_16x16x32_bf16 v[60:63], v[132:135], v[36:39], v[60:63]
  ds_read_b64_tr_b16 v[22:23], v9 offset:512
  s_sub_u32 s42, s40, s43
  s_mov_b32 s43, s40
  s_waitcnt lgkmcnt(6)
  v_mfma_f32_16x16x32_bf16 v[64:67], v[128:131], v[40:43], v[64:67]
  ds_read_b64_tr_b16 v[24:25], v10 offset:0
  buffer_load_dwordx4 v[120:123], v14, s[8:11], s36 offen offset:0 sc1
  v_mfma_f32_16x16x32_bf16 v[68:71], v[132:135], v[40:43], v[68:71]
  ds_read_b64_tr_b16 v[26:27], v10 offset:512
  s_waitcnt lgkmcnt(6)
  v_mfma_f32_16x16x32_bf16 v[72:75], v[128:131], v[44:47], v[72:75]
  ds_read_b64_tr_b16 v[28:29], v11 offset:0
  v_mfma_f32_16x16x32_bf16 v[76:79], v[132:135], v[44:47], v[76:79]
  ds_read_b64_tr_b16 v[30:31], v11 offset:512
  buffer_load_dwordx4 v[124:127], v14, s[8:11], s36 offen offset:1024 sc1
  s_waitcnt vmcnt(13) lgkmcnt(6)
  v_mfma_f32_16x16x32_bf16 v[48:51], v[136:139], v[16:19], v[48:51]
  ds_read_b64_tr_b16 v[32:33], v8 offset:4096
  s_waitcnt vmcnt(12)
  v_mfma_f32_16x16x32_bf16 v[52:55], v[140:143], v[16:19], v[52:55]
  ds_read_b64_tr_b16 v[34:35], v8 offset:4608
  v_add_u32 v8, s42, v8
  s_waitcnt lgkmcnt(6)
  v_mfma_f32_16x16x32_bf16 v[56:59], v[136:139], v[20:23], v[56:59]
  ds_read_b64_tr_b16 v[36:37], v9 offset:4096
  buffer_load_dwordx4 v[128:131], v14, s[8:11], s36 offen offset:2048 sc1
  v_mfma_f32_16x16x32_bf16 v[60:63], v[140:143], v[20:23], v[60:63]
  ds_read_b64_tr_b16 v[38:39], v9 offset:4608
  v_add_u32 v9, s42, v9
  s_waitcnt lgkmcnt(6)
  v_mfma_f32_16x16x32_bf16 v[64:67], v[136:139], v[24:27], v[64:67]
  ds_read_b64_tr_b16 v[40:41], v10 offset:4096
  v_mfma_f32_16x16x32_bf16 v[68:71], v[140:143], v[24:27], v[68:71]
  ds_read_b64_tr_b16 v[42:43], v10 offset:4608
  v_add_u32 v10, s42, v10
  s_waitcnt lgkmcnt(6)
  v_mfma_f32_16x16x32_bf16 v[72:75], v[136:139], v[28:31], v[72:75]
  ds_read_b64_tr_b16 v[44:45], v11 offset:4096
  buffer_load_dwordx4 v[132:135], v14, s[8:11], s36 offen offset:3072 sc1
  v_mfma_f32_16x16x32_bf16 v[76:79], v[140:143], v[28:31], v[76:79]
  ds_read_b64_tr_b16 v[46:47], v11 offset:4608
  v_add_u32 v11, s42, v11
  s_barrier
  s_waitcnt vmcnt(13) lgkmcnt(6)
  v_mfma_f32_16x16x32_bf16 v[48:51], v[144:147], v[32:35], v[48:51]
  ds_read_b64_tr_b16 v[16:17], v8 offset:0
  s_bitcmp1_b32 s48, 5
  s_cselect_b32 s36, s50, s49
  s_waitcnt vmcnt(12)
  v_mfma_f32_16x16x32_bf16 v[52:55], v[148:151], v[32:35], v[52:55]
  ds_read_b64_tr_b16 v[18:19], v8 offset:512
  s_add_u32 s36, s36, 20480
  s_add_u32 s40, s43, 8192
  s_waitcnt lgkmcnt(6)
  v_mfma_f32_16x16x32_bf16 v[56:59], v[144:147], v[36:39], v[56:59]
  ds_read_b64_tr_b16 v[20:21], v9 offset:0
  s_cmp_eq_u32 s40, 65536
  s_cselect_b32 s40, 0, s40
  v_mfma_f32_16x16x32_bf16 v[60:63], v[148:151], v[36:39], v[60:63]
  ds_read_b64_tr_b16 v[22:23], v9 offset:512
  s_sub_u32 s42, s40, s43
  s_mov_b32 s43, s40
  s_waitcnt lgkmcnt(6)
  v_mfma_f32_16x16x32_bf16 v[64:67], v[144:147], v[40:43], v[64:67]
  ds_read_b64_tr_b16 v[24:25], v10 offset:0
  buffer_load_dwordx4 v[136:139], v14, s[8:11], s36 offen offset:0 sc1
  v_mfma_f32_16x16x32_bf16 v[68:71], v[148:151], v[40:43], v[68:71]
  ds_read_b64_tr_b16 v[26:27], v10 offset:512
  s_waitcnt lgkmcnt(6)
  v_mfma_f32_16x16x32_bf16 v[72:75], v[144:147], v[44:47], v[72:75]
  ds_read_b64_tr_b16 v[28:29], v11 offset:0
  v_mfma_f32_16x16x32_bf16 v[76:79], v[148:151], v[44:47], v[76:79]
  ds_read_b64_tr_b16 v[30:31], v11 offset:512
  buffer_load_dwordx4 v[140:143], v14, s[8:11], s36 offen offset:1024 sc1
  s_waitcnt vmcnt(13) lgkmcnt(6)
  v_mfma_f32_16x16x32_bf16 v[48:51], v[152:155], v[16:19], v[48:51]
  ds_read_b64_tr_b16 v[32:33], v8 offset:4096
  s_waitcnt vmcnt(12)
  v_mfma_f32_16x16x32_bf16 v[52:55], v[156:159], v[16:19], v[52:55]
  ds_read_b64_tr_b16 v[34:35], v8 offset:4608
  v_add_u32 v8, s42, v8
  s_waitcnt lgkmcnt(6)
  v_mfma_f32_16x16x32_bf16 v[56:59], v[152:155], v[20:23], v[56:59]
  ds_read_b64_tr_b16 v[36:37], v9 offset:4096
  buffer_load_dwordx4 v[144:147], v14, s[8:11], s36 offen offset:2048 sc1
  v_mfma_f32_16x16x32_bf16 v[60:63], v[156:159], v[20:23], v[60:63]
  ds_read_b64_tr_b16 v[38:39], v9 offset:4608
  v_add_u32 v9, s42, v9
  s_waitcnt lgkmcnt(6)
  v_mfma_f32_16x16x32_bf16 v[64:67], v[152:155], v[24:27], v[64:67]
  ds_read_b64_tr_b16 v[40:41], v10 offset:4096
  v_mfma_f32_16x16x32_bf16 v[68:71], v[156:159], v[24:27], v[68:71]
  ds_read_b64_tr_b16 v[42:43], v10 offset:4608
  v_add_u32 v10, s42, v10
  s_waitcnt lgkmcnt(6)
  v_mfma_f32_16x16x32_bf16 v[72:75], v[152:155], v[28:31], v[72:75]
  ds_read_b64_tr_b16 v[44:45], v11 offset:4096
  buffer_load_dwordx4 v[148:151], v14, s[8:11], s36 offen offset:3072 sc1
  v_mfma_f32_16x16x32_bf16 v[76:79], v[156:159], v[28:31], v[76:79]
  ds_read_b64_tr_b16 v[46:47], v11 offset:4608
  v_add_u32 v11, s42, v11
  s_barrier
  s_waitcnt vmcnt(13) lgkmcnt(6)
  v_mfma_f32_16x16x32_bf16 v[48:51], v[160:163], v[32:35], v[48:51]
  ds_read_b64_tr_b16 v[16:17], v8 offset:0
  s_bitcmp1_b32 s48, 6
  s_cselect_b32 s36, s50, s49
  s_waitcnt vmcnt(12)
  v_mfma_f32_16x16x32_bf16 v[52:55], v[164:167], v[32:35], v[52:55]
  ds_read_b64_tr_b16 v[18:19], v8 offset:512
  s_add_u32 s36, s36, 24576
  s_add_u32 s40, s43, 8192
  s_waitcnt lgkmcnt(6)
  v_mfma_f32_16x16x32_bf16 v[56:59], v[160:163], v[36:39], v[56:59]
  ds_read_b64_tr_b16 v[20:21], v9 offset:0
  s_cmp_eq_u32 s40, 65536
  s_cselect_b32 s40, 0, s40
  v_mfma_f32_16x16x32_bf16 v[60:63], v[164:167], v[36:39], v[60:63]
  ds_read_b64_tr_b16 v[22:23], v9 offset:512
  s_sub_u32 s42, s40, s43
  s_mov_b32 s43, s40
  s_waitcnt lgkmcnt(6)
  v_mfma_f32_16x16x32_bf16 v[64:67], v[160:163], v[40:43], v[64:67]
  ds_read_b64_tr_b16 v[24:25], v10 offset:0
  buffer_load_dwordx4 v[152:155], v14, s[8:11], s36 offen offset:0 sc1
  v_mfma_f32_16x16x32_bf16 v[68:71], v[164:167], v[40:43], v[68:71]
  ds_read_b64_tr_b16 v[26:27], v10 offset:512
  s_waitcnt lgkmcnt(6)
  v_mfma_f32_16x16x32_bf16 v[72:75], v[160:163], v[44:47], v[72:75]
  ds_read_b64_tr_b16 v[28:29], v11 offset:0
  v_mfma_f32_16x16x32_bf16 v[76:79], v[164:167], v[44:47], v[76:79]
  ds_read_b64_tr_b16 v[30:31], v11 offset:512
  buffer_load_dwordx4 v[156:159], v14, s[8:11], s36 offen offset:1024 sc1
  s_waitcnt vmcnt(13) lgkmcnt(6)
  v_mfma_f32_16x16x32_bf16 v[48:51], v[168:171], v[16:19], v[48:51]
  ds_read_b64_tr_b16 v[32:33], v8 offset:4096
  s_waitcnt vmcnt(12)
  v_mfma_f32_16x16x32_bf16 v[52:55], v[172:175], v[16:19], v[52:55]
  ds_read_b64_tr_b16 v[34:35], v8 offset:4608
  v_add_u32 v8, s42, v8
  s_waitcnt lgkmcnt(6)
  v_mfma_f32_16x16x32_bf16 v[56:59], v[168:171], v[20:23], v[56:59]
  ds_read_b64_tr_b16 v[36:37], v9 offset:4096
  buffer_load_dwordx4 v[160:163], v14, s[8:11], s36 offen offset:2048 sc1
  v_mfma_f32_16x16x32_bf16 v[60:63], v[172:175], v[20:23], v[60:63]
  ds_read_b64_tr_b16 v[38:39], v9 offset:4608
  v_add_u32 v9, s42, v9
  s_waitcnt lgkmcnt(6)
  v_mfma_f32_16x16x32_bf16 v[64:67], v[168:171], v[24:27], v[64:67]
  ds_read_b64_tr_b16 v[40:41], v10 offset:4096
  v_mfma_f32_16x16x32_bf16 v[68:71], v[172:175], v[24:27], v[68:71]
  ds_read_b64_tr_b16 v[42:43], v10 offset:4608
  v_add_u32 v10, s42, v10
  s_waitcnt lgkmcnt(6)
  v_mfma_f32_16x16x32_bf16 v[72:75], v[168:171], v[28:31], v[72:75]
  ds_read_b64_tr_b16 v[44:45], v11 offset:4096
  buffer_load_dwordx4 v[164:167], v14, s[8:11], s36 offen offset:3072 sc1
  v_mfma_f32_16x16x32_bf16 v[76:79], v[172:175], v[28:31], v[76:79]
  ds_read_b64_tr_b16 v[46:47], v11 offset:4608
  v_add_u32 v11, s42, v11
  s_barrier
  s_waitcnt vmcnt(13) lgkmcnt(6)
  v_mfma_f32_16x16x32_bf16 v[48:51], v[176:179], v[32:35], v[48:51]
  ds_read_b64_tr_b16 v[16:17], v8 offset:0
  s_bitcmp1_b32 s48, 7
  s_cselect_b32 s36, s50, s49
  s_waitcnt vmcnt(12)
  v_mfma_f32_16x16x32_bf16 v[52:55], v[180:183], v[32:35], v[52:55]
  ds_read_b64_tr_b16 v[18:19], v8 offset:512
  s_add_u32 s36, s36, 28672
  s_add_u32 s40, s43, 8192
  s_waitcnt lgkmcnt(6)
  v_mfma_f32_16x16x32_bf16 v[56:59], v[176:179], v[36:39], v[56:59]
  ds_read_b64_tr_b16 v[20:21], v9 offset:0
  s_cmp_eq_u32 s40, 65536
  s_cselect_b32 s40, 0, s40
  v_mfma_f32_16x16x32_bf16 v[60:63], v[180:183], v[36:39], v[60:63]
  ds_read_b64_tr_b16 v[22:23], v9 offset:512
  s_sub_u32 s42, s40, s43
  s_mov_b32 s43, s40
  s_waitcnt lgkmcnt(6)
  v_mfma_f32_16x16x32_bf16 v[64:67], v[176:179], v[40:43], v[64:67]
  ds_read_b64_tr_b16 v[24:25], v10 offset:0
  buffer_load_dwordx4 v[168:171], v14, s[8:11], s36 offen offset:0 sc1
  v_mfma_f32_16x16x32_bf16 v[68:71], v[180:183], v[40:43], v[68:71]
  ds_read_b64_tr_b16 v[26:27], v10 offset:512
  s_waitcnt lgkmcnt(6)
  v_mfma_f32_16x16x32_bf16 v[72:75], v[176:179], v[44:47], v[72:75]
  ds_read_b64_tr_b16 v[28:29], v11 offset:0
  v_mfma_f32_16x16x32_bf16 v[76:79], v[180:183], v[44:47], v[76:79]
  ds_read_b64_tr_b16 v[30:31], v11 offset:512
  buffer_load_dwordx4 v[172:175], v14, s[8:11], s36 offen offset:1024 sc1
  s_waitcnt vmcnt(13) lgkmcnt(6)
  v_mfma_f32_16x16x32_bf16 v[48:51], v[120:123], v[16:19], v[48:51]
  ds_read_b64_tr_b16 v[32:33], v8 offset:4096
  s_waitcnt vmcnt(12)
  v_mfma_f32_16x16x32_bf16 v[52:55], v[124:127], v[16:19], v[52:55]
  ds_read_b64_tr_b16 v[34:35], v8 offset:4608
  v_add_u32 v8, s42, v8
  s_waitcnt lgkmcnt(6)
  v_mfma_f32_16x16x32_bf16 v[56:59], v[120:123], v[20:23], v[56:59]
  ds_read_b64_tr_b16 v[36:37], v9 offset:4096
  buffer_load_dwordx4 v[176:179], v14, s[8:11], s36 offen offset:2048 sc1
  v_mfma_f32_16x16x32_bf16 v[60:63], v[124:127], v[20:23], v[60:63]
  ds_read_b64_tr_b16 v[38:39], v9 offset:4608
  v_add_u32 v9, s42, v9
  s_waitcnt lgkmcnt(6)
  v_mfma_f32_16x16x32_bf16 v[64:67], v[120:123], v[24:27], v[64:67]
  ds_read_b64_tr_b16 v[40:41], v10 offset:4096
  v_mfma_f32_16x16x32_bf16 v[68:71], v[124:127], v[24:27], v[68:71]
  ds_read_b64_tr_b16 v[42:43], v10 offset:4608
  v_add_u32 v10, s42, v10
  s_waitcnt lgkmcnt(6)
  v_mfma_f32_16x16x32_bf16 v[72:75], v[120:123], v[28:31], v[72:75]
  ds_read_b64_tr_b16 v[44:45], v11 offset:4096
  buffer_load_dwordx4 v[180:183], v14, s[8:11], s36 offen offset:3072 sc1
  v_mfma_f32_16x16x32_bf16 v[76:79], v[124:127], v[28:31], v[76:79]
  ds_read_b64_tr_b16 v[46:47], v11 offset:4608
  v_add_u32 v11, s42, v11
  s_barrier
  s_waitcnt vmcnt(13) lgkmcnt(6)
  v_mfma_f32_16x16x32_bf16 v[48:51], v[128:131], v[32:35], v[48:51]
  ds_read_b64_tr_b16 v[16:17], v8 offset:0
  s_mov_b32 s49, s50
  s_add_u32 s50, s50, 32768
  s_waitcnt vmcnt(12)
  v_mfma_f32_16x16x32_bf16 v[52:55], v[132:135], v[32:35], v[52:55]
  ds_read_b64_tr_b16 v[18:19], v8 offset:512
  s_cmp_eq_u32 s50, s41
  s_cselect_b32 s50, s34, s50
  s_waitcnt lgkmcnt(6)
  v_mfma_f32_16x16x32_bf16 v[56:59], v[128:131], v[36:39], v[56:59]
  ds_read_b64_tr_b16 v[20:21], v9 offset:0
  s_bitcmp1_b32 s48, 0
  s_cselect_b32 s36, s50, s49
  v_mfma_f32_16x16x32_bf16 v[60:63], v[132:135], v[36:39], v[60:63]
  ds_read_b64_tr_b16 v[22:23], v9 offset:512
  s_add_u32 s36, s36, 0
  s_add_u32 s40, s43, 8192
  s_waitcnt lgkmcnt(6)
  v_mfma_f32_16x16x32_bf16 v[64:67], v[128:131], v[40:43], v[64:67]
  ds_read_b64_tr_b16 v[24:25], v10 offset:0
  s_cmp_eq_u32 s40, 65536
  s_cselect_b32 s40, 0, s40
  buffer_load_dwordx4 v[120:123], v14, s[8:11], s36 offen offset:0 sc1
  v_mfma_f32_16x16x32_bf16 v[68:71], v[132:135], v[40:43], v[68:71]
  ds_read_b64_tr_b16 v[26:27], v10 offset:512
  s_sub_u32 s42, s40, s43
  s_mov_b32 s43, s40
  s_waitcnt lgkmcnt(6)
  v_mfma_f32_16x16x32_bf16 v[72:75], v[128:131], v[44:47], v[72:75]
  ds_read_b64_tr_b16 v[28:29], v11 offset:0
  v_mfma_f32_16x16x32_bf16 v[76:79], v[132:135], v[44:47], v[76:79]
  ds_read_b64_tr_b16 v[30:31], v11 offset:512
  buffer_load_dwordx4 v[124:127], v14, s[8:11], s36 offen offset:1024 sc1
  s_waitcnt vmcnt(13) lgkmcnt(6)
  v_mfma_f32_16x16x32_bf16 v[48:51], v[136:139], v[16:19], v[48:51]
  ds_read_b64_tr_b16 v[32:33], v8 offset:4096
  s_waitcnt vmcnt(12)
  v_mfma_f32_16x16x32_bf16 v[52:55], v[140:143], v[16:19], v[52:55]
  ds_read_b64_tr_b16 v[34:35], v8 offset:4608
  v_add_u32 v8, s42, v8
  s_waitcnt lgkmcnt(6)
  v_mfma_f32_16x16x32_bf16 v[56:59], v[136:139], v[20:23], v[56:59]
  ds_read_b64_tr_b16 v[36:37], v9 offset:4096
  buffer_load_dwordx4 v[128:131], v14, s[8:11], s36 offen offset:2048 sc1
  v_mfma_f32_16x16x32_bf16 v[60:63], v[140:143], v[20:23], v[60:63]
  ds_read_b64_tr_b16 v[38:39], v9 offset:4608
  v_add_u32 v9, s42, v9
  s_waitcnt lgkmcnt(6)
  v_mfma_f32_16x16x32_bf16 v[64:67], v[136:139], v[24:27], v[64:67]
  ds_read_b64_tr_b16 v[40:41], v10 offset:4096
  v_mfma_f32_16x16x32_bf16 v[68:71], v[140:143], v[24:27], v[68:71]
  ds_read_b64_tr_b16 v[42:43], v10 offset:4608
  v_add_u32 v10, s42, v10
  s_waitcnt lgkmcnt(6)
  v_mfma_f32_16x16x32_bf16 v[72:75], v[136:139], v[28:31], v[72:75]
  ds_read_b64_tr_b16 v[44:45], v11 offset:4096
  buffer_load_dwordx4 v[132:135], v14, s[8:11], s36 offen offset:3072 sc1
  v_mfma_f32_16x16x32_bf16 v[76:79], v[140:143], v[28:31], v[76:79]
  ds_read_b64_tr_b16 v[46:47], v11 offset:4608
  v_add_u32 v11, s42, v11
  s_barrier
  s_waitcnt vmcnt(13) lgkmcnt(6)
  v_mfma_f32_16x16x32_bf16 v[48:51], v[144:147], v[32:35], v[48:51]
  ds_read_b64_tr_b16 v[16:17], v8 offset:0
  s_bitcmp1_b32 s48, 1
  s_cselect_b32 s36, s50, s49
  s_waitcnt vmcnt(12)
  v_mfma_f32_16x16x32_bf16 v[52:55], v[148:151], v[32:35], v[52:55]
  ds_read_b64_tr_b16 v[18:19], v8 offset:512
  s_add_u32 s36, s36, 4096
  s_add_u32 s40, s43, 8192
  s_waitcnt lgkmcnt(6)
  v_mfma_f32_16x16x32_bf16 v[56:59], v[144:147], v[36:39], v[56:59]
  ds_read_b64_tr_b16 v[20:21], v9 offset:0
  s_cmp_eq_u32 s40, 65536
  s_cselect_b32 s40, 0, s40
  v_mfma_f32_16x16x32_bf16 v[60:63], v[148:151], v[36:39], v[60:63]
  ds_read_b64_tr_b16 v[22:23], v9 offset:512
  s_sub_u32 s42, s40, s43
  s_mov_b32 s43, s40
  s_waitcnt lgkmcnt(6)
  v_mfma_f32_16x16x32_bf16 v[64:67], v[144:147], v[40:43], v[64:67]
  ds_read_b64_tr_b16 v[24:25], v10 offset:0
  buffer_load_dwordx4 v[136:139], v14, s[8:11], s36 offen offset:0 sc1
  v_mfma_f32_16x16x32_bf16 v[68:71], v[148:151], v[40:43], v[68:71]
  ds_read_b64_tr_b16 v[26:27], v10 offset:512
  s_waitcnt lgkmcnt(6)
  v_mfma_f32_16x16x32_bf16 v[72:75], v[144:147], v[44:47], v[72:75]
  ds_read_b64_tr_b16 v[28:29], v11 offset:0
  v_mfma_f32_16x16x32_bf16 v[76:79], v[148:151], v[44:47], v[76:79]
  ds_read_b64_tr_b16 v[30:31], v11 offset:512
  buffer_load_dwordx4 v[140:143], v14, s[8:11], s36 offen offset:1024 sc1
  s_waitcnt vmcnt(13) lgkmcnt(6)
  v_mfma_f32_16x16x32_bf16 v[48:51], v[152:155], v[16:19], v[48:51]
  ds_read_b64_tr_b16 v[32:33], v8 offset:4096
  s_waitcnt vmcnt(12)
  v_mfma_f32_16x16x32_bf16 v[52:55], v[156:159], v[16:19], v[52:55]
  ds_read_b64_tr_b16 v[34:35], v8 offset:4608
  v_add_u32 v8, s42, v8
  s_waitcnt lgkmcnt(6)
  v_mfma_f32_16x16x32_bf16 v[56:59], v[152:155], v[20:23], v[56:59]
  ds_read_b64_tr_b16 v[36:37], v9 offset:4096
  buffer_load_dwordx4 v[144:147], v14, s[8:11], s36 offen offset:2048 sc1
  v_mfma_f32_16x16x32_bf16 v[60:63], v[156:159], v[20:23], v[60:63]
  ds_read_b64_tr_b16 v[38:39], v9 offset:4608
  v_add_u32 v9, s42, v9
  s_waitcnt lgkmcnt(6)
  v_mfma_f32_16x16x32_bf16 v[64:67], v[152:155], v[24:27], v[64:67]
  ds_read_b64_tr_b16 v[40:41], v10 offset:4096
  v_mfma_f32_16x16x32_bf16 v[68:71], v[156:159], v[24:27], v[68:71]
  ds_read_b64_tr_b16 v[42:43], v10 offset:4608
  v_add_u32 v10, s42, v10
  s_waitcnt lgkmcnt(6)
  v_mfma_f32_16x16x32_bf16 v[72:75], v[152:155], v[28:31], v[72:75]
  ds_read_b64_tr_b16 v[44:45], v11 offset:4096
  buffer_load_dwordx4 v[148:151], v14, s[8:11], s36 offen offset:3072 sc1
  v_mfma_f32_16x16x32_bf16 v[76:79], v[156:159], v[28:31], v[76:79]
  ds_read_b64_tr_b16 v[46:47], v11 offset:4608
  v_add_u32 v11, s42, v11
  s_barrier
  s_waitcnt vmcnt(13) lgkmcnt(6)
  v_mfma_f32_16x16x32_bf16 v[48:51], v[160:163], v[32:35], v[48:51]
  ds_read_b64_tr_b16 v[16:17], v8 offset:0
  s_bitcmp1_b32 s48, 2
  s_cselect_b32 s36, s50, s49
  s_waitcnt vmcnt(12)
  v_mfma_f32_16x16x32_bf16 v[52:55], v[164:167], v[32:35], v[52:55]
  ds_read_b64_tr_b16 v[18:19], v8 offset:512
  s_add_u32 s36, s36, 8192
  s_add_u32 s40, s43, 8192
  s_waitcnt lgkmcnt(6)
  v_mfma_f32_16x16x32_bf16 v[56:59], v[160:163], v[36:39], v[56:59]
  ds_read_b64_tr_b16 v[20:21], v9 offset:0
  s_cmp_eq_u32 s40, 65536
  s_cselect_b32 s40, 0, s40
  v_mfma_f32_16x16x32_bf16 v[60:63], v[164:167], v[36:39], v[60:63]
  ds_read_b64_tr_b16 v[22:23], v9 offset:512
  s_sub_u32 s42, s40, s43
  s_mov_b32 s43, s40
  s_waitcnt lgkmcnt(6)
  v_mfma_f32_16x16x32_bf16 v[64:67], v[160:163], v[40:43], v[64:67]
  ds_read_b64_tr_b16 v[24:25], v10 offset:0
  buffer_load_dwordx4 v[152:155], v14, s[8:11], s36 offen offset:0 sc1
  v_mfma_f32_16x16x32_bf16 v[68:71], v[164:167], v[40:43], v[68:71]
  ds_read_b64_tr_b16 v[26:27], v10 offset:512
  s_waitcnt lgkmcnt(6)
  v_mfma_f32_16x16x32_bf16 v[72:75], v[160:163], v[44:47], v[72:75]
  ds_read_b64_tr_b16 v[28:29], v11 offset:0
  v_mfma_f32_16x16x32_bf16 v[76:79], v[164:167], v[44:47], v[76:79]
  ds_read_b64_tr_b16 v[30:31], v11 offset:512
  buffer_load_dwordx4 v[156:159], v14, s[8:11], s36 offen offset:1024 sc1
  s_waitcnt vmcnt(13) lgkmcnt(6)
  v_mfma_f32_16x16x32_bf16 v[48:51], v[168:171], v[16:19], v[48:51]
  ds_read_b64_tr_b16 v[32:33], v8 offset:4096
  s_waitcnt vmcnt(12)
  v_mfma_f32_16x16x32_bf16 v[52:55], v[172:175], v[16:19], v[52:55]
  ds_read_b64_tr_b16 v[34:35], v8 offset:4608
  v_add_u32 v8, s42, v8
  s_waitcnt lgkmcnt(6)
  v_mfma_f32_16x16x32_bf16 v[56:59], v[168:171], v[20:23], v[56:59]
  ds_read_b64_tr_b16 v[36:37], v9 offset:4096
  buffer_load_dwordx4 v[160:163], v14, s[8:11], s36 offen offset:2048 sc1
  v_mfma_f32_16x16x32_bf16 v[60:63], v[172:175], v[20:23], v[60:63]
  ds_read_b64_tr_b16 v[38:39], v9 offset:4608
  v_add_u32 v9, s42, v9
  s_waitcnt lgkmcnt(6)
  v_mfma_f32_16x16x32_bf16 v[64:67], v[168:171], v[24:27], v[64:67]
  ds_read_b64_tr_b16 v[40:41], v10 offset:4096
  v_mfma_f32_16x16x32_bf16 v[68:71], v[172:175], v[24:27], v[68:71]
  ds_read_b64_tr_b16 v[42:43], v10 offset:4608
  v_add_u32 v10, s42, v10
  s_waitcnt lgkmcnt(6)
  v_mfma_f32_16x16x32_bf16 v[72:75], v[168:171], v[28:31], v[72:75]
  ds_read_b64_tr_b16 v[44:45], v11 offset:4096
  buffer_load_dwordx4 v[164:167], v14, s[8:11], s36 offen offset:3072 sc1
  v_mfma_f32_16x16x32_bf16 v[76:79], v[172:175], v[28:31], v[76:79]
  ds_read_b64_tr_b16 v[46:47], v11 offset:4608
  v_add_u32 v11, s42, v11
  s_barrier
  s_waitcnt vmcnt(13) lgkmcnt(6)
  v_mfma_f32_16x16x32_bf16 v[48:51], v[176:179], v[32:35], v[48:51]
  ds_read_b64_tr_b16 v[16:17], v8 offset:0
  s_bitcmp1_b32 s48, 3
  s_cselect_b32 s36, s50, s49
  s_waitcnt vmcnt(12)
  v_mfma_f32_16x16x32_bf16 v[52:55], v[180:183], v[32:35], v[52:55]
  ds_read_b64_tr_b16 v[18:19], v8 offset:512
  s_add_u32 s36, s36, 12288
  s_add_u32 s40, s43, 8192
  s_waitcnt lgkmcnt(6)
  v_mfma_f32_16x16x32_bf16 v[56:59], v[176:179], v[36:39], v[56:59]
  ds_read_b64_tr_b16 v[20:21], v9 offset:0
  s_cmp_eq_u32 s40, 65536
  s_cselect_b32 s40, 0, s40
  v_mfma_f32_16x16x32_bf16 v[60:63], v[180:183], v[36:39], v[60:63]
  ds_read_b64_tr_b16 v[22:23], v9 offset:512
  s_sub_u32 s42, s40, s43
  s_mov_b32 s43, s40
  s_waitcnt lgkmcnt(6)
  v_mfma_f32_16x16x32_bf16 v[64:67], v[176:179], v[40:43], v[64:67]
  ds_read_b64_tr_b16 v[24:25], v10 offset:0
  buffer_load_dwordx4 v[168:171], v14, s[8:11], s36 offen offset:0 sc1
  v_mfma_f32_16x16x32_bf16 v[68:71], v[180:183], v[40:43], v[68:71]
  ds_read_b64_tr_b16 v[26:27], v10 offset:512
  s_waitcnt lgkmcnt(6)
  v_mfma_f32_16x16x32_bf16 v[72:75], v[176:179], v[44:47], v[72:75]
  ds_read_b64_tr_b16 v[28:29], v11 offset:0
  v_mfma_f32_16x16x32_bf16 v[76:79], v[180:183], v[44:47], v[76:79]
  ds_read_b64_tr_b16 v[30:31], v11 offset:512
  buffer_load_dwordx4 v[172:175], v14, s[8:11], s36 offen offset:1024 sc1
  s_sub_u32 s39, s39, 1
  s_cmp_lg_u32 s39, 0
  s_cbranch_scc1 cd5
  s_waitcnt vmcnt(13) lgkmcnt(6)
  v_mfma_f32_16x16x32_bf16 v[48:51], v[120:123], v[16:19], v[48:51]
  ds_read_b64_tr_b16 v[32:33], v8 offset:4096
  s_waitcnt vmcnt(12)
  v_mfma_f32_16x16x32_bf16 v[52:55], v[124:127], v[16:19], v[52:55]
  ds_read_b64_tr_b16 v[34:35], v8 offset:4608
  v_add_u32 v8, s42, v8
  s_waitcnt lgkmcnt(6)
  v_mfma_f32_16x16x32_bf16 v[56:59], v[120:123], v[20:23], v[56:59]
  ds_read_b64_tr_b16 v[36:37], v9 offset:4096
  buffer_load_dwordx4 v[176:179], v14, s[8:11], s36 offen offset:2048 sc1
  v_mfma_f32_16x16x32_bf16 v[60:63], v[124:127], v[20:23], v[60:63]
  ds_read_b64_tr_b16 v[38:39], v9 offset:4608
  v_add_u32 v9, s42, v9
  s_waitcnt lgkmcnt(6)
  v_mfma_f32_16x16x32_bf16 v[64:67], v[120:123], v[24:27], v[64:67]
  ds_read_b64_tr_b16 v[40:41], v10 offset:4096
  v_mfma_f32_16x16x32_bf16 v[68:71], v[124:127], v[24:27], v[68:71]
  ds_read_b64_tr_b16 v[42:43], v10 offset:4608
  v_add_u32 v10, s42, v10
  s_waitcnt lgkmcnt(6)
  v_mfma_f32_16x16x32_bf16 v[72:75], v[120:123], v[28:31], v[72:75]
  ds_read_b64_tr_b16 v[44:45], v11 offset:4096
  buffer_load_dwordx4 v[180:183], v14, s[8:11], s36 offen offset:3072 sc1
  v_mfma_f32_16x16x32_bf16 v[76:79], v[124:127], v[28:31], v[76:79]
  ds_read_b64_tr_b16 v[46:47], v11 offset:4608
  v_add_u32 v11, s42, v11
  s_barrier
  s_waitcnt vmcnt(13) lgkmcnt(6)
  v_mfma_f32_16x16x32_bf16 v[48:51], v[128:131], v[32:35], v[48:51]
  ds_read_b64_tr_b16 v[16:17], v8 offset:0
  s_bitcmp1_b32 s48, 4
  s_cselect_b32 s36, s50, s49
  s_waitcnt vmcnt(12)
  v_mfma_f32_16x16x32_bf16 v[52:55], v[132:135], v[32:35], v[52:55]
  ds_read_b64_tr_b16 v[18:19], v8 offset:512
  s_add_u32 s36, s36, 16384
  s_add_u32 s40, s43, 8192
  s_waitcnt lgkmcnt(6)
  v_mfma_f32_16x16x32_bf16 v[56:59], v[128:131], v[36:39], v[56:59]
  ds_read_b64_tr_b16 v[20:21], v9 offset:0
  s_cmp_eq_u32 s40, 65536
  s_cselect_b32 s40, 0, s40
  v_mfma_f32_16x16x32_bf16 v[60:63], v[132:135], v[36:39], v[60:63]
  ds_read_b64_tr_b16 v[22:23], v9 offset:512
  s_sub_u32 s42, s40, s43
  s_mov_b32 s43, s40
  s_waitcnt lgkmcnt(6)
  v_mfma_f32_16x16x32_bf16 v[64:67], v[128:131], v[40:43], v[64:67]
  ds_read_b64_tr_b16 v[24:25], v10 offset:0
  buffer_load_dwordx4 v[120:123], v14, s[8:11], s36 offen offset:0 sc1
  v_mfma_f32_16x16x32_bf16 v[68:71], v[132:135], v[40:43], v[68:71]
  ds_read_b64_tr_b16 v[26:27], v10 offset:512
  s_waitcnt lgkmcnt(6)
  v_mfma_f32_16x16x32_bf16 v[72:75], v[128:131], v[44:47], v[72:75]
  ds_read_b64_tr_b16 v[28:29], v11 offset:0
  v_mfma_f32_16x16x32_bf16 v[76:79], v[132:135], v[44:47], v[76:79]
  ds_read_b64_tr_b16 v[30:31], v11 offset:512
  buffer_load_dwordx4 v[124:127], v14, s[8:11], s36 offen offset:1024 sc1
  s_waitcnt vmcnt(13) lgkmcnt(6)
  v_mfma_f32_16x16x32_bf16 v[48:51], v[136:139], v[16:19], v[48:51]
  ds_read_b64_tr_b16 v[32:33], v8 offset:4096
  s_waitcnt vmcnt(12)
  v_mfma_f32_16x16x32_bf16 v[52:55], v[140:143], v[16:19], v[52:55]
  ds_read_b64_tr_b16 v[34:35], v8 offset:4608
  v_add_u32 v8, s42, v8
  s_waitcnt lgkmcnt(6)
  v_mfma_f32_16x16x32_bf16 v[56:59], v[136:139], v[20:23], v[56:59]
  ds_read_b64_tr_b16 v[36:37], v9 offset:4096
  buffer_load_dwordx4 v[128:131], v14, s[8:11], s36 offen offset:2048 sc1
  v_mfma_f32_16x16x32_bf16 v[60:63], v[140:143], v[20:23], v[60:63]
  ds_read_b64_tr_b16 v[38:39], v9 offset:4608
  v_add_u32 v9, s42, v9
  s_waitcnt lgkmcnt(6)
  v_mfma_f32_16x16x32_bf16 v[64:67], v[136:139], v[24:27], v[64:67]
  ds_read_b64_tr_b16 v[40:41], v10 offset:4096
  v_mfma_f32_16x16x32_bf16 v[68:71], v[140:143], v[24:27], v[68:71]
  ds_read_b64_tr_b16 v[42:43], v10 offset:4608
  v_add_u32 v10, s42, v10
  s_waitcnt lgkmcnt(6)
  v_mfma_f32_16x16x32_bf16 v[72:75], v[136:139], v[28:31], v[72:75]
  ds_read_b64_tr_b16 v[44:45], v11 offset:4096
  buffer_load_dwordx4 v[132:135], v14, s[8:11], s36 offen offset:3072 sc1
  v_mfma_f32_16x16x32_bf16 v[76:79], v[140:143], v[28:31], v[76:79]
  ds_read_b64_tr_b16 v[46:47], v11 offset:4608
  v_add_u32 v11, s42, v11
  s_barrier
  s_waitcnt vmcnt(13) lgkmcnt(6)
  v_mfma_f32_16x16x32_bf16 v[48:51], v[144:147], v[32:35], v[48:51]
  ds_read_b64_tr_b16 v[16:17], v8 offset:0
  s_bitcmp1_b32 s48, 5
  s_cselect_b32 s36, s50, s49
  s_waitcnt vmcnt(12)
  v_mfma_f32_16x16x32_bf16 v[52:55], v[148:151], v[32:35], v[52:55]
  ds_read_b64_tr_b16 v[18:19], v8 offset:512
  s_add_u32 s36, s36, 20480
  s_add_u32 s40, s43, 8192
  s_waitcnt lgkmcnt(6)
  v_mfma_f32_16x16x32_bf16 v[56:59], v[144:147], v[36:39], v[56:59]
  ds_read_b64_tr_b16 v[20:21], v9 offset:0
  s_cmp_eq_u32 s40, 65536
  s_cselect_b32 s40, 0, s40
  v_mfma_f32_16x16x32_bf16 v[60:63], v[148:151], v[36:39], v[60:63]
  ds_read_b64_tr_b16 v[22:23], v9 offset:512
  s_sub_u32 s42, s40, s43
  s_mov_b32 s43, s40
  s_waitcnt lgkmcnt(6)
  v_mfma_f32_16x16x32_bf16 v[64:67], v[144:147], v[40:43], v[64:67]
  ds_read_b64_tr_b16 v[24:25], v10 offset:0
  buffer_load_dwordx4 v[136:139], v14, s[8:11], s36 offen offset:0 sc1
  v_mfma_f32_16x16x32_bf16 v[68:71], v[148:151], v[40:43], v[68:71]
  ds_read_b64_tr_b16 v[26:27], v10 offset:512
  s_waitcnt lgkmcnt(6)
  v_mfma_f32_16x16x32_bf16 v[72:75], v[144:147], v[44:47], v[72:75]
  ds_read_b64_tr_b16 v[28:29], v11 offset:0
  v_mfma_f32_16x16x32_bf16 v[76:79], v[148:151], v[44:47], v[76:79]
  ds_read_b64_tr_b16 v[30:31], v11 offset:512
  buffer_load_dwordx4 v[140:143], v14, s[8:11], s36 offen offset:1024 sc1
  s_waitcnt vmcnt(13) lgkmcnt(6)
  v_mfma_f32_16x16x32_bf16 v[48:51], v[152:155], v[16:19], v[48:51]
  ds_read_b64_tr_b16 v[32:33], v8 offset:4096
  s_waitcnt vmcnt(12)
  v_mfma_f32_16x16x32_bf16 v[52:55], v[156:159], v[16:19], v[52:55]
  ds_read_b64_tr_b16 v[34:35], v8 offset:4608
  v_add_u32 v8, s42, v8
  s_waitcnt lgkmcnt(6)
  v_mfma_f32_16x16x32_bf16 v[56:59], v[152:155], v[20:23], v[56:59]
  ds_read_b64_tr_b16 v[36:37], v9 offset:4096
  buffer_load_dwordx4 v[144:147], v14, s[8:11], s36 offen offset:2048 sc1
  v_mfma_f32_16x16x32_bf16 v[60:63], v[156:159], v[20:23], v[60:63]
  ds_read_b64_tr_b16 v[38:39], v9 offset:4608
  v_add_u32 v9, s42, v9
  s_waitcnt lgkmcnt(6)
  v_mfma_f32_16x16x32_bf16 v[64:67], v[152:155], v[24:27], v[64:67]
  ds_read_b64_tr_b16 v[40:41], v10 offset:4096
  v_mfma_f32_16x16x32_bf16 v[68:71], v[156:159], v[24:27], v[68:71]
  ds_read_b64_tr_b16 v[42:43], v10 offset:4608
  v_add_u32 v10, s42, v10
  s_waitcnt lgkmcnt(6)
  v_mfma_f32_16x16x32_bf16 v[72:75], v[152:155], v[28:31], v[72:75]
  ds_read_b64_tr_b16 v[44:45], v11 offset:4096
  buffer_load_dwordx4 v[148:151], v14, s[8:11], s36 offen offset:3072 sc1
  v_mfma_f32_16x16x32_bf16 v[76:79], v[156:159], v[28:31], v[76:79]
  ds_read_b64_tr_b16 v[46:47], v11 offset:4608
  v_add_u32 v11, s42, v11
  s_barrier
  s_waitcnt vmcnt(13) lgkmcnt(6)
  v_mfma_f32_16x16x32_bf16 v[48:51], v[160:163], v[32:35], v[48:51]
  ds_read_b64_tr_b16 v[16:17], v8 offset:0
  s_bitcmp1_b32 s48, 6
  s_cselect_b32 s36, s50, s49
  s_waitcnt vmcnt(12)
  v_mfma_f32_16x16x32_bf16 v[52:55], v[164:167], v[32:35], v[52:55]
  ds_read_b64_tr_b16 v[18:19], v8 offset:512
  s_add_u32 s36, s36, 24576
  s_add_u32 s40, s43, 8192
  s_waitcnt lgkmcnt(6)
  v_mfma_f32_16x16x32_bf16 v[56:59], v[160:163], v[36:39], v[56:59]
  ds_read_b64_tr_b16 v[20:21], v9 offset:0
  s_cmp_eq_u32 s40, 65536
  s_cselect_b32 s40, 0, s40
  v_mfma_f32_16x16x32_bf16 v[60:63], v[164:167], v[36:39], v[60:63]
  ds_read_b64_tr_b16 v[22:23], v9 offset:512
  s_sub_u32 s42, s40, s43
  s_mov_b32 s43, s40
  s_waitcnt lgkmcnt(6)
  v_mfma_f32_16x16x32_bf16 v[64:67], v[160:163], v[40:43], v[64:67]
  ds_read_b64_tr_b16 v[24:25], v10 offset:0
  buffer_load_dwordx4 v[152:155], v14, s[8:11], s36 offen offset:0 sc1
  v_mfma_f32_16x16x32_bf16 v[68:71], v[164:167], v[40:43], v[68:71]
  ds_read_b64_tr_b16 v[26:27], v10 offset:512
  s_waitcnt lgkmcnt(6)
  v_mfma_f32_16x16x32_bf16 v[72:75], v[160:163], v[44:47], v[72:75]
  ds_read_b64_tr_b16 v[28:29], v11 offset:0
  v_mfma_f32_16x16x32_bf16 v[76:79], v[164:167], v[44:47], v[76:79]
  ds_read_b64_tr_b16 v[30:31], v11 offset:512
  buffer_load_dwordx4 v[156:159], v14, s[8:11], s36 offen offset:1024 sc1
  s_waitcnt vmcnt(13) lgkmcnt(6)
  v_mfma_f32_16x16x32_bf16 v[48:51], v[168:171], v[16:19], v[48:51]
  ds_read_b64_tr_b16 v[32:33], v8 offset:4096
  s_waitcnt vmcnt(12)
  v_mfma_f32_16x16x32_bf16 v[52:55], v[172:175], v[16:19], v[52:55]
  ds_read_b64_tr_b16 v[34:35], v8 offset:4608
  v_add_u32 v8, s42, v8
  s_waitcnt lgkmcnt(6)
  v_mfma_f32_16x16x32_bf16 v[56:59], v[168:171], v[20:23], v[56:59]
  ds_read_b64_tr_b16 v[36:37], v9 offset:4096
  buffer_load_dwordx4 v[160:163], v14, s[8:11], s36 offen offset:2048 sc1
  v_mfma_f32_16x16x32_bf16 v[60:63], v[172:175], v[20:23], v[60:63]
  ds_read_b64_tr_b16 v[38:39], v9 offset:4608
  v_add_u32 v9, s42, v9
  s_waitcnt lgkmcnt(6)
  v_mfma_f32_16x16x32_bf16 v[64:67], v[168:171], v[24:27], v[64:67]
  ds_read_b64_tr_b16 v[40:41], v10 offset:4096
  v_mfma_f32_16x16x32_bf16 v[68:71], v[172:175], v[24:27], v[68:71]
  ds_read_b64_tr_b16 v[42:43], v10 offset:4608
  v_add_u32 v10, s42, v10
  s_waitcnt lgkmcnt(6)
  v_mfma_f32_16x16x32_bf16 v[72:75], v[168:171], v[28:31], v[72:75]
  ds_read_b64_tr_b16 v[44:45], v11 offset:4096
  buffer_load_dwordx4 v[164:167], v14, s[8:11], s36 offen offset:3072 sc1
  v_mfma_f32_16x16x32_bf16 v[76:79], v[172:175], v[28:31], v[76:79]
  ds_read_b64_tr_b16 v[46:47], v11 offset:4608
  v_add_u32 v11, s42, v11
  s_barrier
  s_waitcnt vmcnt(13) lgkmcnt(6)
  v_mfma_f32_16x16x32_bf16 v[48:51], v[176:179], v[32:35], v[48:51]
  ds_read_b64_tr_b16 v[16:17], v8 offset:0
  s_bitcmp1_b32 s48, 7
  s_cselect_b32 s36, s50, s49
  s_waitcnt vmcnt(12)
  v_mfma_f32_16x16x32_bf16 v[52:55], v[180:183], v[32:35], v[52:55]
  ds_read_b64_tr_b16 v[18:19], v8 offset:512
  s_add_u32 s36, s36, 28672
  s_add_u32 s40, s43, 8192
  s_waitcnt lgkmcnt(6)
  v_mfma_f32_16x16x32_bf16 v[56:59], v[176:179], v[36:39], v[56:59]
  ds_read_b64_tr_b16 v[20:21], v9 offset:0
  s_cmp_eq_u32 s40, 65536
  s_cselect_b32 s40, 0, s40
  v_mfma_f32_16x16x32_bf16 v[60:63], v[180:183], v[36:39], v[60:63]
  ds_read_b64_tr_b16 v[22:23], v9 offset:512
  s_sub_u32 s42, s40, s43
  s_mov_b32 s43, s40
  s_waitcnt lgkmcnt(6)
  v_mfma_f32_16x16x32_bf16 v[64:67], v[176:179], v[40:43], v[64:67]
  ds_read_b64_tr_b16 v[24:25], v10 offset:0
  buffer_load_dwordx4 v[168:171], v14, s[8:11], s36 offen offset:0 sc1
  v_mfma_f32_16x16x32_bf16 v[68:71], v[180:183], v[40:43], v[68:71]
  ds_read_b64_tr_b16 v[26:27], v10 offset:512
  s_waitcnt lgkmcnt(6)
  v_mfma_f32_16x16x32_bf16 v[72:75], v[176:179], v[44:47], v[72:75]
  ds_read_b64_tr_b16 v[28:29], v11 offset:0
  v_mfma_f32_16x16x32_bf16 v[76:79], v[180:183], v[44:47], v[76:79]
  ds_read_b64_tr_b16 v[30:31], v11 offset:512
  buffer_load_dwordx4 v[172:175], v14, s[8:11], s36 offen offset:1024 sc1
  s_waitcnt vmcnt(13) lgkmcnt(6)
  v_mfma_f32_16x16x32_bf16 v[48:51], v[120:123], v[16:19], v[48:51]
  ds_read_b64_tr_b16 v[32:33], v8 offset:4096
  s_waitcnt vmcnt(12)
  v_mfma_f32_16x16x32_bf16 v[52:55], v[124:127], v[16:19], v[52:55]
  ds_read_b64_tr_b16 v[34:35], v8 offset:4608
  v_add_u32 v8, s42, v8
  s_waitcnt lgkmcnt(6)
  v_mfma_f32_16x16x32_bf16 v[56:59], v[120:123], v[20:23], v[56:59]
  ds_read_b64_tr_b16 v[36:37], v9 offset:4096
  buffer_load_dwordx4 v[176:179], v14, s[8:11], s36 offen offset:2048 sc1
  v_mfma_f32_16x16x32_bf16 v[60:63], v[124:127], v[20:23], v[60:63]
  ds_read_b64_tr_b16 v[38:39], v9 offset:4608
  v_add_u32 v9, s42, v9
  s_waitcnt lgkmcnt(6)
  v_mfma_f32_16x16x32_bf16 v[64:67], v[120:123], v[24:27], v[64:67]
  ds_read_b64_tr_b16 v[40:41], v10 offset:4096
  v_mfma_f32_16x16x32_bf16 v[68:71], v[124:127], v[24:27], v[68:71]
  ds_read_b64_tr_b16 v[42:43], v10 offset:4608
  v_add_u32 v10, s42, v10
  s_waitcnt lgkmcnt(6)
  v_mfma_f32_16x16x32_bf16 v[72:75], v[120:123], v[28:31], v[72:75]
  ds_read_b64_tr_b16 v[44:45], v11 offset:4096
  buffer_load_dwordx4 v[180:183], v14, s[8:11], s36 offen offset:3072 sc1
  v_mfma_f32_16x16x32_bf16 v[76:79], v[124:127], v[28:31], v[76:79]
  ds_read_b64_tr_b16 v[46:47], v11 offset:4608
  v_add_u32 v11, s42, v11
  s_barrier
  s_waitcnt vmcnt(13) lgkmcnt(6)
  v_mfma_f32_16x16x32_bf16 v[48:51], v[128:131], v[32:35], v[48:51]
  ds_read_b64_tr_b16 v[16:17], v8 offset:0
  s_add_u32 s40, s43, 8192
  s_cmp_eq_u32 s40, 65536
  s_waitcnt vmcnt(12)
  v_mfma_f32_16x16x32_bf16 v[52:55], v[132:135], v[32:35], v[52:55]
  ds_read_b64_tr_b16 v[18:19], v8 offset:512
  s_cselect_b32 s40, 0, s40
  s_sub_u32 s42, s40, s43
  s_waitcnt lgkmcnt(6)
  v_mfma_f32_16x16x32_bf16 v[56:59], v[128:131], v[36:39], v[56:59]
  ds_read_b64_tr_b16 v[20:21], v9 offset:0
  s_mov_b32 s43, s40
  v_mfma_f32_16x16x32_bf16 v[60:63], v[132:135], v[36:39], v[60:63]
  ds_read_b64_tr_b16 v[22:23], v9 offset:512
  s_waitcnt lgkmcnt(6)
  v_mfma_f32_16x16x32_bf16 v[64:67], v[128:131], v[40:43], v[64:67]
  ds_read_b64_tr_b16 v[24:25], v10 offset:0
  v_mfma_f32_16x16x32_bf16 v[68:71], v[132:135], v[40:43], v[68:71]
  ds_read_b64_tr_b16 v[26:27], v10 offset:512
  s_waitcnt lgkmcnt(6)
  v_mfma_f32_16x16x32_bf16 v[72:75], v[128:131], v[44:47], v[72:75]
  ds_read_b64_tr_b16 v[28:29], v11 offset:0
  v_mfma_f32_16x16x32_bf16 v[76:79], v[132:135], v[44:47], v[76:79]
  ds_read_b64_tr_b16 v[30:31], v11 offset:512
  s_waitcnt vmcnt(11) lgkmcnt(6)
  v_mfma_f32_16x16x32_bf16 v[48:51], v[136:139], v[16:19], v[48:51]
  ds_read_b64_tr_b16 v[32:33], v8 offset:4096
  s_waitcnt vmcnt(10)
  v_mfma_f32_16x16x32_bf16 v[52:55], v[140:143], v[16:19], v[52:55]
  ds_read_b64_tr_b16 v[34:35], v8 offset:4608
  v_add_u32 v8, s42, v8
  s_waitcnt lgkmcnt(6)
  v_mfma_f32_16x16x32_bf16 v[56:59], v[136:139], v[20:23], v[56:59]
  ds_read_b64_tr_b16 v[36:37], v9 offset:4096
  v_mfma_f32_16x16x32_bf16 v[60:63], v[140:143], v[20:23], v[60:63]
  ds_read_b64_tr_b16 v[38:39], v9 offset:4608
  v_add_u32 v9, s42, v9
  s_waitcnt lgkmcnt(6)
  v_mfma_f32_16x16x32_bf16 v[64:67], v[136:139], v[24:27], v[64:67]
  ds_read_b64_tr_b16 v[40:41], v10 offset:4096
  v_mfma_f32_16x16x32_bf16 v[68:71], v[140:143], v[24:27], v[68:71]
  ds_read_b64_tr_b16 v[42:43], v10 offset:4608
  v_add_u32 v10, s42, v10
  s_waitcnt lgkmcnt(6)
  v_mfma_f32_16x16x32_bf16 v[72:75], v[136:139], v[28:31], v[72:75]
  ds_read_b64_tr_b16 v[44:45], v11 offset:4096
  v_mfma_f32_16x16x32_bf16 v[76:79], v[140:143], v[28:31], v[76:79]
  ds_read_b64_tr_b16 v[46:47], v11 offset:4608
  v_add_u32 v11, s42, v11
  s_barrier
  s_waitcnt vmcnt(9) lgkmcnt(6)
  v_mfma_f32_16x16x32_bf16 v[48:51], v[144:147], v[32:35], v[48:51]
  ds_read_b64_tr_b16 v[16:17], v8 offset:0
  s_add_u32 s40, s43, 8192
  s_cmp_eq_u32 s40, 65536
  s_waitcnt vmcnt(8)
  v_mfma_f32_16x16x32_bf16 v[52:55], v[148:151], v[32:35], v[52:55]
  ds_read_b64_tr_b16 v[18:19], v8 offset:512
  s_cselect_b32 s40, 0, s40
  s_sub_u32 s42, s40, s43
  s_waitcnt lgkmcnt(6)
  v_mfma_f32_16x16x32_bf16 v[56:59], v[144:147], v[36:39], v[56:59]
  ds_read_b64_tr_b16 v[20:21], v9 offset:0
  s_mov_b32 s43, s40
  v_mfma_f32_16x16x32_bf16 v[60:63], v[148:151], v[36:39], v[60:63]
  ds_read_b64_tr_b16 v[22:23], v9 offset:512
  s_waitcnt lgkmcnt(6)
  v_mfma_f32_16x16x32_bf16 v[64:67], v[144:147], v[40:43], v[64:67]
  ds_read_b64_tr_b16 v[24:25], v10 offset:0
  v_mfma_f32_16x16x32_bf16 v[68:71], v[148:151], v[40:43], v[68:71]
  ds_read_b64_tr_b16 v[26:27], v10 offset:512
  s_waitcnt lgkmcnt(6)
  v_mfma_f32_16x16x32_bf16 v[72:75], v[144:147], v[44:47], v[72:75]
  ds_read_b64_tr_b16 v[28:29], v11 offset:0
  v_mfma_f32_16x16x32_bf16 v[76:79], v[148:151], v[44:47], v[76:79]
  ds_read_b64_tr_b16 v[30:31], v11 offset:512
  s_waitcnt vmcnt(7) lgkmcnt(6)
  v_mfma_f32_16x16x32_bf16 v[48:51], v[152:155], v[16:19], v[48:51]
  ds_read_b64_tr_b16 v[32:33], v8 offset:4096
  s_waitcnt vmcnt(6)
  v_mfma_f32_16x16x32_bf16 v[52:55], v[156:159], v[16:19], v[52:55]
  ds_read_b64_tr_b16 v[34:35], v8 offset:4608
  v_add_u32 v8, s42, v8
  s_waitcnt lgkmcnt(6)
  v_mfma_f32_16x16x32_bf16 v[56:59], v[152:155], v[20:23], v[56:59]
  ds_read_b64_tr_b16 v[36:37], v9 offset:4096
  v_mfma_f32_16x16x32_bf16 v[60:63], v[156:159], v[20:23], v[60:63]
  ds_read_b64_tr_b16 v[38:39], v9 offset:4608
  v_add_u32 v9, s42, v9
  s_waitcnt lgkmcnt(6)
  v_mfma_f32_16x16x32_bf16 v[64:67], v[152:155], v[24:27], v[64:67]
  ds_read_b64_tr_b16 v[40:41], v10 offset:4096
  v_mfma_f32_16x16x32_bf16 v[68:71], v[156:159], v[24:27], v[68:71]
  ds_read_b64_tr_b16 v[42:43], v10 offset:4608
  v_add_u32 v10, s42, v10
  s_waitcnt lgkmcnt(6)
  v_mfma_f32_16x16x32_bf16 v[72:75], v[152:155], v[28:31], v[72:75]
  ds_read_b64_tr_b16 v[44:45], v11 offset:4096
  v_mfma_f32_16x16x32_bf16 v[76:79], v[156:159], v[28:31], v[76:79]
  ds_read_b64_tr_b16 v[46:47], v11 offset:4608
  v_add_u32 v11, s42, v11
  s_barrier
  s_waitcnt vmcnt(5) lgkmcnt(6)
  v_mfma_f32_16x16x32_bf16 v[48:51], v[160:163], v[32:35], v[48:51]
  ds_read_b64_tr_b16 v[16:17], v8 offset:0
  s_add_u32 s40, s43, 8192
  s_cmp_eq_u32 s40, 65536
  s_waitcnt vmcnt(4)
  v_mfma_f32_16x16x32_bf16 v[52:55], v[164:167], v[32:35], v[52:55]
  ds_read_b64_tr_b16 v[18:19], v8 offset:512
  s_cselect_b32 s40, 0, s40
  s_sub_u32 s42, s40, s43
  s_waitcnt lgkmcnt(6)
  v_mfma_f32_16x16x32_bf16 v[56:59], v[160:163], v[36:39], v[56:59]
  ds_read_b64_tr_b16 v[20:21], v9 offset:0
  s_mov_b32 s43, s40
  v_mfma_f32_16x16x32_bf16 v[60:63], v[164:167], v[36:39], v[60:63]
  ds_read_b64_tr_b16 v[22:23], v9 offset:512
  s_waitcnt lgkmcnt(6)
  v_mfma_f32_16x16x32_bf16 v[64:67], v[160:163], v[40:43], v[64:67]
  ds_read_b64_tr_b16 v[24:25], v10 offset:0
  v_mfma_f32_16x16x32_bf16 v[68:71], v[164:167], v[40:43], v[68:71]
  ds_read_b64_tr_b16 v[26:27], v10 offset:512
  s_waitcnt lgkmcnt(6)
  v_mfma_f32_16x16x32_bf16 v[72:75], v[160:163], v[44:47], v[72:75]
  ds_read_b64_tr_b16 v[28:29], v11 offset:0
  v_mfma_f32_16x16x32_bf16 v[76:79], v[164:167], v[44:47], v[76:79]
  ds_read_b64_tr_b16 v[30:31], v11 offset:512
  s_waitcnt vmcnt(3) lgkmcnt(6)
  v_mfma_f32_16x16x32_bf16 v[48:51], v[168:171], v[16:19], v[48:51]
  ds_read_b64_tr_b16 v[32:33], v8 offset:4096
  s_waitcnt vmcnt(2)
  v_mfma_f32_16x16x32_bf16 v[52:55], v[172:175], v[16:19], v[52:55]
  ds_read_b64_tr_b16 v[34:35], v8 offset:4608
  s_waitcnt lgkmcnt(6)
  v_mfma_f32_16x16x32_bf16 v[56:59], v[168:171], v[20:23], v[56:59]
  ds_read_b64_tr_b16 v[36:37], v9 offset:4096
  v_mfma_f32_16x16x32_bf16 v[60:63], v[172:175], v[20:23], v[60:63]
  ds_read_b64_tr_b16 v[38:39], v9 offset:4608
  s_waitcnt lgkmcnt(6)
  v_mfma_f32_16x16x32_bf16 v[64:67], v[168:171], v[24:27], v[64:67]
  ds_read_b64_tr_b16 v[40:41], v10 offset:4096
  v_mfma_f32_16x16x32_bf16 v[68:71], v[172:175], v[24:27], v[68:71]
  ds_read_b64_tr_b16 v[42:43], v10 offset:4608
  s_waitcnt lgkmcnt(6)
  v_mfma_f32_16x16x32_bf16 v[72:75], v[168:171], v[28:31], v[72:75]
  ds_read_b64_tr_b16 v[44:45], v11 offset:4096
  v_mfma_f32_16x16x32_bf16 v[76:79], v[172:175], v[28:31], v[76:79]
  ds_read_b64_tr_b16 v[46:47], v11 offset:4608
  s_waitcnt vmcnt(1) lgkmcnt(6)
  v_mfma_f32_16x16x32_bf16 v[48:51], v[176:179], v[32:35], v[48:51]
  s_waitcnt vmcnt(0)
  v_mfma_f32_16x16x32_bf16 v[52:55], v[180:183], v[32:35], v[52:55]
  s_waitcnt lgkmcnt(4)
  v_mfma_f32_16x16x32_bf16 v[56:59], v[176:179], v[36:39], v[56:59]
  v_mfma_f32_16x16x32_bf16 v[60:63], v[180:183], v[36:39], v[60:63]
  s_waitcnt lgkmcnt(2)
  v_mfma_f32_16x16x32_bf16 v[64:67], v[176:179], v[40:43], v[64:67]
  v_mfma_f32_16x16x32_bf16 v[68:71], v[180:183], v[40:43], v[68:71]
  s_waitcnt lgkmcnt(0)
  v_mfma_f32_16x16x32_bf16 v[72:75], v[176:179], v[44:47], v[72:75]
  v_mfma_f32_16x16x32_bf16 v[76:79], v[180:183], v[44:47], v[76:79]
  s_waitcnt lgkmcnt(0)
  s_cmp_eq_u32 s3, 0
  s_cbranch_scc1 C_st
  v_cvt_pk_bf16_f32 v96, v48, v49
  v_cvt_pk_bf16_f32 v97, v50, v51
  v_cvt_pk_bf16_f32 v98, v52, v53
  v_cvt_pk_bf16_f32 v99, v54, v55
  buffer_store_dwordx4 v[96:99], v12, s[24:27], 0 offen sc0 sc1
  v_cvt_pk_bf16_f32 v100, v56, v57
  v_cvt_pk_bf16_f32 v101, v58, v59
  v_cvt_pk_bf16_f32 v102, v60, v61
  v_cvt_pk_bf16_f32 v103, v62, v63
  buffer_store_dwordx4 v[100:103], v12, s[24:27], s45 offen sc0 sc1
  v_cvt_pk_bf16_f32 v104, v64, v65
  v_cvt_pk_bf16_f32 v105, v66, v67
  v_cvt_pk_bf16_f32 v106, v68, v69
  v_cvt_pk_bf16_f32 v107, v70, v71
  buffer_store_dwordx4 v[104:107], v12, s[24:27], s46 offen sc0 sc1
  v_cvt_pk_bf16_f32 v108, v72, v73
  v_cvt_pk_bf16_f32 v109, v74, v75
  v_cvt_pk_bf16_f32 v110, v76, v77
  v_cvt_pk_bf16_f32 v111, v78, v79
  buffer_store_dwordx4 v[108:111], v12, s[24:27], s47 offen sc0 sc1
  s_branch C_end
C_st:
  s_nop 7
  v_pk_add_f32 v[16:17], v[48:49], v[50:51]
  v_pk_mul_f32 v[18:19], v[48:49], v[48:49]
  v_pk_fma_f32 v[18:19], v[50:51], v[50:51], v[18:19]
  v_pk_add_f32 v[16:17], v[16:17], v[52:53]
  v_pk_fma_f32 v[18:19], v[52:53], v[52:53], v[18:19]
  v_pk_add_f32 v[16:17], v[16:17], v[54:55]
  v_pk_fma_f32 v[18:19], v[54:55], v[54:55], v[18:19]
  v_add_f32 v32, v16, v17
  v_add_f32 v36, v18, v19
  v_pk_add_f32 v[20:21], v[56:57], v[58:59]
  v_pk_mul_f32 v[22:23], v[56:57], v[56:57]
  v_pk_fma_f32 v[22:23], v[58:59], v[58:59], v[22:23]
  v_pk_add_f32 v[20:21], v[20:21], v[60:61]
  v_pk_fma_f32 v[22:23], v[60:61], v[60:61], v[22:23]
  v_pk_add_f32 v[20:21], v[20:21], v[62:63]
  v_pk_fma_f32 v[22:23], v[62:63], v[62:63], v[22:23]
  v_add_f32 v33, v20, v21
  v_add_f32 v37, v22, v23
  v_pk_add_f32 v[24:25], v[64:65], v[66:67]
  v_pk_mul_f32 v[26:27], v[64:65], v[64:65]
  v_pk_fma_f32 v[26:27], v[66:67], v[66:67], v[26:27]
  v_pk_add_f32 v[24:25], v[24:25], v[68:69]
  v_pk_fma_f32 v[26:27], v[68:69], v[68:69], v[26:27]
  v_pk_add_f32 v[24:25], v[24:25], v[70:71]
  v_pk_fma_f32 v[26:27], v[70:71], v[70:71], v[26:27]
  v_add_f32 v34, v24, v25
  v_add_f32 v38, v26, v27
  v_pk_add_f32 v[28:29], v[72:73], v[74:75]
  v_pk_mul_f32 v[30:31], v[72:73], v[72:73]
  v_pk_fma_f32 v[30:31], v[74:75], v[74:75], v[30:31]
  v_pk_add_f32 v[28:29], v[28:29], v[76:77]
  v_pk_fma_f32 v[30:31], v[76:77], v[76:77], v[30:31]
  v_pk_add_f32 v[28:29], v[28:29], v[78:79]
  v_pk_fma_f32 v[30:31], v[78:79], v[78:79], v[30:31]
  v_add_f32 v35, v28, v29
  v_add_f32 v39, v30, v31
  v_permlane16_swap_b32 v32, v33
  v_permlane16_swap_b32 v34, v35
  v_permlane16_swap_b32 v36, v37
  v_permlane16_swap_b32 v38, v39
  v_add_f32 v32, v32, v33
  v_add_f32 v34, v34, v35
  v_add_f32 v36, v36, v37
  v_add_f32 v38, v38, v39
  v_permlane32_swap_b32 v32, v34
  s_nop 0
  v_permlane32_swap_b32 v36, v38
  v_add_f32 v40, v32, v34
  v_add_f32 v41, v36, v38
  ds_write_b64 v223, v[40:41]
  v_cvt_pk_bf16_f32 v96, v48, v49
  v_cvt_pk_bf16_f32 v97, v50, v51
  v_cvt_pk_bf16_f32 v98, v52, v53
  v_cvt_pk_bf16_f32 v99, v54, v55
  buffer_store_dwordx4 v[96:99], v12, s[24:27], 0 offen sc0 sc1
  v_cvt_pk_bf16_f32 v100, v56, v57
  v_cvt_pk_bf16_f32 v101, v58, v59
  v_cvt_pk_bf16_f32 v102, v60, v61
  v_cvt_pk_bf16_f32 v103, v62, v63
  buffer_store_dwordx4 v[100:103], v12, s[24:27], s45 offen sc0 sc1
  v_cvt_pk_bf16_f32 v104, v64, v65
  v_cvt_pk_bf16_f32 v105, v66, v67
  v_cvt_pk_bf16_f32 v106, v68, v69
  v_cvt_pk_bf16_f32 v107, v70, v71
  buffer_store_dwordx4 v[104:107], v12, s[24:27], s46 offen sc0 sc1
  v_cvt_pk_bf16_f32 v108, v72, v73
  v_cvt_pk_bf16_f32 v109, v74, v75
  v_cvt_pk_bf16_f32 v110, v76, v77
  v_cvt_pk_bf16_f32 v111, v78, v79
  buffer_store_dwordx4 v[108:111], v12, s[24:27], s47 offen sc0 sc1
  s_waitcnt lgkmcnt(0)
  s_barrier
  s_cmp_lg_u32 s4, 0
  s_cbranch_scc1 C_nost
  ds_read_b64 v[44:45], v223 offset:512
  ds_read_b64 v[46:47], v223 offset:1024
  ds_read_b64 v[18:19], v223 offset:1536
  s_lshl_b32 s32, s28, 14
  s_lshl_b32 s40, s29, 9
  s_add_u32 s32, s32, s40
  s_waitcnt lgkmcnt(0)
  v_pk_add_f32 v[40:41], v[40:41], v[44:45]
  v_pk_add_f32 v[46:47], v[46:47], v[18:19]
  v_pk_add_f32 v[40:41], v[40:41], v[46:47]
  buffer_store_dwordx2 v[40:41], v222, s[12:15], s32 offen sc0 sc1
C_nost:
  s_nop 1
  s_lshr_b32 s32, s2, 3
  s_lshr_b32 s5, s32, 3
  s_and_b32 s6, s32, 7
  s_lshl_b32 s7, s5, 1
  s_add_u32 s7, s7, s6
  s_and_b32 s7, s7, 7
  s_and_b32 s32, s2, 7
  s_lshr_b32 s28, s32, 1
  s_lshl_b32 s28, s28, 2
  s_add_u32 s28, s28, s5
  s_and_b32 s29, s32, 1
  s_mul_i32 s29, s29, 8
  s_add_u32 s29, s29, s6
  s_mov_b32 s30, 7
  s_mov_b32 s31, -1
  v_and_b32 v4, 15, v0
  v_lshrrev_b32 v5, 4, v0
  v_lshrrev_b32 v6, 2, v4
  v_and_b32 v7, 3, v0
  v_lshrrev_b32 v3, 5, v0
  v_and_b32 v2, 1, v5
  v_lshl_or_b32 v3, v2, 1, v3
  v_lshl_add_u32 v21, v5, 3, v6
  v_lshlrev_b32 v21, 7, v21
  v_lshl_add_u32 v21, v7, 3, v21
  v_lshrrev_b32 v22, 1, v6
  v_lshl_or_b32 v22, v2, 1, v22
  v_lshl_add_u32 v21, v22, 5, v21
  v_add_u32 v21, 18432, v21
  v_xor_b32 v8, 0, v21
  s_lshl_b32 s32, s4, 5
  v_xor_b32 v8, s32, v8
  v_lshrrev_b32 v21, 1, v4
  v_xor_b32 v21, v21, v5
  v_lshlrev_b32 v21, 4, v21
  v_lshlrev_b32 v22, 7, v4
  v_add_u32 v9, v21, v22
  v_xor_b32 v10, 64, v9
  v_and_b32 v21, 1, v4
  v_mul_u32_u24 v21, 28800, v21
  v_lshrrev_b32 v22, 1, v4
  v_mul_u32_u24 v22, 400, v22
  v_lshlrev_b32 v23, 3, v5
  v_add3_u32 v11, v21, v22, v23
  s_add_u32 s32, s32, 43008
  v_add_u32 v11, s32, v11
  v_lshlrev_b32 v12, 3, v4
  v_add_u32 v12, 129024, v12
  v_mov_b64 v[112:113], 0
  v_mov_b64 v[114:115], 0
  v_mov_b64 v[116:117], 0
  v_mov_b64 v[118:119], 0
  v_mov_b64 v[120:121], 0
  v_mov_b64 v[122:123], 0
  v_mov_b64 v[124:125], 0
  v_mov_b64 v[126:127], 0
  v_mov_b64 v[128:129], 0
  v_mov_b64 v[130:131], 0
  v_mov_b64 v[132:133], 0
  v_mov_b64 v[134:135], 0
  v_mov_b64 v[136:137], 0
  v_mov_b64 v[138:139], 0
  v_mov_b64 v[140:141], 0
  v_mov_b64 v[142:143], 0
  v_mov_b64 v[144:145], 0
  v_mov_b64 v[146:147], 0
  v_mov_b64 v[148:149], 0
  v_mov_b64 v[150:151], 0
  v_mov_b64 v[152:153], 0
  v_mov_b64 v[154:155], 0
  v_mov_b64 v[156:157], 0
  v_mov_b64 v[158:159], 0
  v_mov_b64 v[160:161], 0
  v_mov_b64 v[162:163], 0
  v_mov_b64 v[164:165], 0
  v_mov_b64 v[166:167], 0
  v_mov_b64 v[168:169], 0
  v_mov_b64 v[170:171], 0
  v_mov_b64 v[172:173], 0
  v_mov_b64 v[174:175], 0
  v_mov_b64 v[176:177], 0
  v_mov_b64 v[178:179], 0
  v_mov_b64 v[180:181], 0
  v_mov_b64 v[182:183], 0
  v_mov_b64 v[184:185], 0
  v_mov_b64 v[186:187], 0
  v_mov_b64 v[188:189], 0
  v_mov_b64 v[190:191], 0
  v_mov_b64 v[192:193], 0
  v_mov_b64 v[194:195], 0
  v_mov_b64 v[196:197], 0
  v_mov_b64 v[198:199], 0
  v_mov_b64 v[200:201], 0
  v_mov_b64 v[202:203], 0
  v_mov_b64 v[204:205], 0
  v_mov_b64 v[206:207], 0
  v_mov_b64 v[208:209], 0
  v_mov_b64 v[210:211], 0
  v_mov_b64 v[212:213], 0
  v_mov_b64 v[214:215], 0
  v_mov_b64 v[216:217], 0
  v_mov_b64 v[218:219], 0
  s_waitcnt vmcnt(0)
  s_barrier
  s_mov_b32 s3, 1
  s_add_u32 s82, s84, 33554432
  s_addc_u32 s83, s85, 0
  s_branch C_top
C_end:
  s_endpgm
L_start:
  s_nop 7
  s_nop 7
  s_sub_u32 s57, s4, 4
  v_and_b32 v134, 3, v0
  v_lshlrev_b32 v134, 6, v134
  s_lshr_b32 s32, s2, 3
  s_lshr_b32 s5, s32, 3
  s_and_b32 s6, s32, 7
  s_lshl_b32 s7, s5, 1
  s_add_u32 s7, s7, s6
  s_and_b32 s7, s7, 7
  s_and_b32 s32, s2, 7
  s_lshr_b32 s28, s32, 1
  s_lshl_b32 s28, s28, 2
  s_add_u32 s28, s28, s5
  s_and_b32 s29, s32, 1
  s_mul_i32 s29, s29, 8
  s_add_u32 s29, s29, s6
  s_mov_b32 s30, 7
  s_mov_b32 s31, -1
  s_mov_b32 s41, s57
  s_mul_i32 s32, s41, 16
  s_add_u32 s32, s32, 0
  v_lshrrev_b32 v2, 3, v0
  v_add_u32 v2, s32, v2
  v_bfe_u32 v3, v2, 1, 1
  v_bfe_u32 v4, v2, 3, 1
  v_lshl_or_b32 v3, v4, 1, v3
  v_lshlrev_b32 v3, 1, v3
  v_and_b32 v4, 7, v0
  v_xor_b32 v3, v3, v4
  v_lshlrev_b32 v3, 4, v3
  s_mov_b32 s32, 6144
  v_mul_lo_u32 v2, v2, s32
  v_add_u32 v13, v2, v3
  s_mul_i32 s32, s41, 16
  s_add_u32 s32, s32, 8
  v_lshrrev_b32 v2, 3, v0
  v_add_u32 v2, s32, v2
  v_bfe_u32 v3, v2, 1, 1
  v_bfe_u32 v4, v2, 3, 1
  v_lshl_or_b32 v3, v4, 1, v3
  v_lshlrev_b32 v3, 1, v3
  v_and_b32 v4, 7, v0
  v_xor_b32 v3, v3, v4
  v_lshlrev_b32 v3, 4, v3
  s_mov_b32 s32, 6144
  v_mul_lo_u32 v2, v2, s32
  v_add_u32 v14, v2, v3
  v_subrev_u32 v14, 1024, v14
  v_add_u32 v15, 2048, v13
  v_add_u32 v16, 2048, v14
  v_add_u32 v17, 4096, v13
  v_add_u32 v18, 4096, v14
  s_lshl_b32 s46, s41, 11
  s_add_u32 s46, s46, 18432
  s_add_u32 s47, s46, 8192
  s_add_u32 s48, s46, 16384
  s_lshl_b32 s35, s29, 7
  s_waitcnt lgkmcnt(0)
  s_mov_b32 s12, s66
  s_mov_b32 s13, s67
  s_mov_b32 s14, 6291456
  s_mov_b32 s15, 0x20000
  s_mov_b32 s30, 7
  s_mov_b32 s31, -1
  s_mov_b32 s38, 0
  s_add_u32 s30, s30, 1
  s_and_b32 s30, s30, 7
  s_cselect_b32 s32, 0, 1
  s_add_u32 s31, s31, s32
  s_sub_u32 s32, s30, s7
  s_and_b32 s32, s32, 7
  s_cmp_lt_u32 s32, 2
  s_cselect_b32 s32, 1, 0
  s_add_u32 s32, s32, s31
  s_cmp_ge_u32 s32, 2
  s_cselect_b32 s32, 0, s32
  s_lshl_b32 s33, s32, 3
  s_add_u32 s33, s33, s30
  s_mul_i32 s37, s33, 393216
  s_add_u32 s37, s37, s35
  s_add_u32 m0, s38, s46
  s_nop 0
  buffer_load_dwordx4 v13, s[12:15], s37 offen offset:0  lds
  buffer_load_dwordx4 v14, s[12:15], s37 offen offset:1024  lds
  s_add_u32 m0, s38, s47
  s_nop 0
  buffer_load_dwordx4 v15, s[12:15], s37 offen offset:0  lds
  buffer_load_dwordx4 v16, s[12:15], s37 offen offset:1024  lds
  s_add_u32 m0, s38, s48
  s_nop 0
  buffer_load_dwordx4 v17, s[12:15], s37 offen offset:0  lds
  buffer_load_dwordx4 v18, s[12:15], s37 offen offset:1024  lds
  s_add_u32 s38, s38, 43008
  s_cmp_eq_u32 s38, 129024
  s_cselect_b32 s38, 0, s38
  s_add_u32 s30, s30, 1
  s_and_b32 s30, s30, 7
  s_cselect_b32 s32, 0, 1
  s_add_u32 s31, s31, s32
  s_sub_u32 s32, s30, s7
  s_and_b32 s32, s32, 7
  s_cmp_lt_u32 s32, 2
  s_cselect_b32 s32, 1, 0
  s_add_u32 s32, s32, s31
  s_cmp_ge_u32 s32, 2
  s_cselect_b32 s32, 0, s32
  s_lshl_b32 s33, s32, 3
  s_add_u32 s33, s33, s30
  s_mul_i32 s37, s33, 393216
  s_add_u32 s37, s37, s35
  s_add_u32 m0, s38, s46
  s_nop 0
  buffer_load_dwordx4 v13, s[12:15], s37 offen offset:0  lds
  buffer_load_dwordx4 v14, s[12:15], s37 offen offset:1024  lds
  s_add_u32 m0, s38, s47
  s_nop 0
  buffer_load_dwordx4 v15, s[12:15], s37 offen offset:0  lds
  buffer_load_dwordx4 v16, s[12:15], s37 offen offset:1024  lds
  s_add_u32 m0, s38, s48
  s_nop 0
  buffer_load_dwordx4 v17, s[12:15], s37 offen offset:0  lds
  buffer_load_dwordx4 v18, s[12:15], s37 offen offset:1024  lds
  s_add_u32 s38, s38, 43008
  s_cmp_eq_u32 s38, 129024
  s_cselect_b32 s38, 0, s38
  s_lshl_b32 s40, s28, 7
  s_sub_u32 s40, s40, 16
  s_lshl_b32 s32, s41, 5
  s_add_u32 s32, s32, 16
  v_lshrrev_b32 v2, 3, v0
  v_add_u32 v2, s32, v2
  v_bfe_u32 v3, v2, 1, 3
  v_and_b32 v4, 7, v0
  v_xor_b32 v3, v3, v4
  v_lshlrev_b32 v3, 4, v3
  v_add_u32 v2, s40, v2
  v_max_i32 v2, 0, v2
  v_lshlrev_b32 v2, 11, v2
  v_add_u32 v8, v2, v3
  v_add_u32 v10, 30720, v8
  s_lshl_b32 s32, s41, 5
  s_add_u32 s32, s32, 24
  v_lshrrev_b32 v2, 3, v0
  v_add_u32 v2, s32, v2
  v_bfe_u32 v3, v2, 1, 3
  v_and_b32 v4, 7, v0
  v_xor_b32 v3, v3, v4
  v_lshlrev_b32 v3, 4, v3
  v_add_u32 v2, s40, v2
  v_max_i32 v2, 0, v2
  v_lshlrev_b32 v2, 11, v2
  v_add_u32 v9, v2, v3
  v_subrev_u32 v9, 1024, v9
  v_add_u32 v11, 30720, v9
  s_lshl_b32 s32, s41, 3
  v_lshrrev_b32 v2, 3, v0
  v_add_u32 v2, s32, v2
  v_bfe_u32 v3, v2, 1, 3
  v_and_b32 v4, 7, v0
  v_xor_b32 v3, v3, v4
  v_lshlrev_b32 v3, 4, v3
  v_add_u32 v2, s40, v2
  v_max_i32 v2, 0, v2
  v_lshlrev_b32 v2, 11, v2
  v_add_u32 v12, v2, v3
  s_lshl_b32 s44, s41, 12
  s_add_u32 s44, s44, 2048
  s_lshl_b32 s45, s41, 10
  s_mov_b32 s34, 0
  s_cmp_eq_u32 s41, 0
  s_cselect_b32 s52, 0xffffff00, -1
  s_mov_b32 s53, -1
  v_mov_b32 v20, 0x3f803f80
  v_mov_b32 v21, v20
  v_mov_b32 v22, v20
  v_mov_b32 v23, v20
  v_lshlrev_b32 v24, 4, v0
  v_add_u32 v25, 86016, v24
  s_mov_b64 exec, 0xff
  ds_write_b128 v24, v[20:23]
  ds_write_b128 v24, v[20:23] offset:43008
  ds_write_b128 v25, v[20:23]
  s_mov_b64 exec, -1
  s_mov_b32 s8, s64
  s_mov_b32 s9, s65
  s_mov_b32 s10, 4194304
  s_mov_b32 s11, 0x20000
  s_add_u32 s20, s84, 22020096
  s_addc_u32 s21, s85, 0
  s_mov_b32 s22, 16384
  s_mov_b32 s23, 0x20000
  s_lshl_b32 s32, s41, 6
  v_add_u32 v26, s32, v0
  v_min_u32 v26, 143, v26
  v_add_u32 v27, s40, v26
  v_max_i32 v27, 0, v27
  v_lshlrev_b32 v27, 3, v27
  v_lshlrev_b32 v26, 3, v26
  v_add_u32 v26, 129024, v26
  s_waitcnt lgkmcnt(0)
  s_mov_b32 s82, s84
  s_mov_b32 s83, s85
L_top:
  s_nop 7
  s_nop 7
  s_lshl_b32 s56, s3, 10
  s_mul_i32 s32, s28, 16
  s_add_u32 s56, s56, s32
  s_add_u32 s56, s56, s29
  s_add_u32 s56, s56, 0
  s_lshl_b32 s56, s56, 7
  s_mov_b32 s24, s72
  s_mov_b32 s25, s73
  s_mov_b32 s26, 14680064
  s_mov_b32 s27, 0x20000
  s_lshl_b32 s54, s2, 2
  s_add_u32 s54, s54, s57
  s_mul_i32 s54, s54, 0
  s_add_u32 s54, s54, 0
  s_cmp_ge_u32 s57, 2
  s_cbranch_scc1 L_k1B
  s_mov_b32 s30, 7
  s_mov_b32 s31, -1
  s_mov_b32 s38, 0
  s_add_u32 s30, s30, 1
  s_and_b32 s30, s30, 7
  s_cselect_b32 s32, 0, 1
  s_add_u32 s31, s31, s32
  s_sub_u32 s32, s30, s7
  s_and_b32 s32, s32, 7
  s_cmp_lt_u32 s32, 2
  s_cselect_b32 s32, 1, 0
  s_add_u32 s32, s32, s31
  s_cmp_ge_u32 s32, 2
  s_cselect_b32 s32, 0, s32
  s_lshl_b32 s33, s32, 3
  s_add_u32 s33, s33, s30
  s_mul_i32 s36, s33, 128
  s_add_u32 s36, s36, s34
  s_add_u32 m0, s38, s45
  s_mov_b64 exec, s[52:53]
  buffer_load_dwordx4 v12, s[8:11], s36 offen offset:0 sc1 lds
  s_mov_b64 exec, -1
  s_add_u32 m0, s38, s44
  s_nop 0
  buffer_load_dwordx4 v8, s[8:11], s36 offen offset:0 sc1 lds
  buffer_load_dwordx4 v9, s[8:11], s36 offen offset:1024 sc1 lds
  buffer_load_dwordx4 v10, s[8:11], s36 offen offset:2048 sc1 lds
  buffer_load_dwordx4 v11, s[8:11], s36 offen offset:3072 sc1 lds
  s_add_u32 s38, s38, 43008
  s_cmp_eq_u32 s38, 129024
  s_cselect_b32 s38, 0, s38
  s_add_u32 s30, s30, 1
  s_and_b32 s30, s30, 7
  s_cselect_b32 s32, 0, 1
  s_add_u32 s31, s31, s32
  s_sub_u32 s32, s30, s7
  s_and_b32 s32, s32, 7
  s_cmp_lt_u32 s32, 2
  s_cselect_b32 s32, 1, 0
  s_add_u32 s32, s32, s31
  s_cmp_ge_u32 s32, 2
  s_cselect_b32 s32, 0, s32
  s_lshl_b32 s33, s32, 3
  s_add_u32 s33, s33, s30
  s_mul_i32 s36, s33, 128
  s_add_u32 s36, s36, s34
  s_add_u32 m0, s38, s45
  s_mov_b64 exec, s[52:53]
  buffer_load_dwordx4 v12, s[8:11], s36 offen offset:0 sc1 lds
  s_mov_b64 exec, -1
  s_add_u32 m0, s38, s44
  s_nop 0
  buffer_load_dwordx4 v8, s[8:11], s36 offen offset:0 sc1 lds
  buffer_load_dwordx4 v9, s[8:11], s36 offen offset:1024 sc1 lds
  buffer_load_dwordx4 v10, s[8:11], s36 offen offset:2048 sc1 lds
  buffer_load_dwordx4 v11, s[8:11], s36 offen offset:3072 sc1 lds
  s_add_u32 s38, s38, 43008
  s_cmp_eq_u32 s38, 129024
  s_cselect_b32 s38, 0, s38
  s_waitcnt vmcnt(5)
  s_barrier
  s_add_u32 s30, s30, 1
  s_and_b32 s30, s30, 7
  s_cselect_b32 s32, 0, 1
  s_add_u32 s31, s31, s32
  s_sub_u32 s32, s30, s7
  s_and_b32 s32, s32, 7
  s_cmp_lt_u32 s32, 2
  s_cselect_b32 s32, 1, 0
  s_add_u32 s32, s32, s31
  s_cmp_ge_u32 s32, 2
  s_cselect_b32 s32, 0, s32
  s_lshl_b32 s33, s32, 3
  s_add_u32 s33, s33, s30
  s_mul_i32 s36, s33, 128
  s_add_u32 s36, s36, s34
  s_mul_i32 s37, s33, 393216
  s_add_u32 s37, s37, s35
  s_add_u32 m0, s38, s45
  s_mov_b64 exec, s[52:53]
  buffer_load_dwordx4 v12, s[8:11], s36 offen offset:0 sc1 lds
  s_mov_b64 exec, -1
  s_add_u32 m0, s38, s44
  s_nop 0
  buffer_load_dwordx4 v8, s[8:11], s36 offen offset:0 sc1 lds
  buffer_load_dwordx4 v9, s[8:11], s36 offen offset:1024 sc1 lds
  buffer_load_dwordx4 v10, s[8:11], s36 offen offset:2048 sc1 lds
  buffer_load_dwordx4 v11, s[8:11], s36 offen offset:3072 sc1 lds
  s_add_u32 m0, s38, s46
  s_nop 0
  buffer_load_dwordx4 v13, s[12:15], s37 offen offset:0  lds
  buffer_load_dwordx4 v14, s[12:15], s37 offen offset:1024  lds
  s_add_u32 m0, s38, s47
  s_nop 0
  buffer_load_dwordx4 v15, s[12:15], s37 offen offset:0  lds
  buffer_load_dwordx4 v16, s[12:15], s37 offen offset:1024  lds
  s_add_u32 m0, s38, s48
  s_nop 0
  buffer_load_dwordx4 v17, s[12:15], s37 offen offset:0  lds
  buffer_load_dwordx4 v18, s[12:15], s37 offen offset:1024  lds
  s_add_u32 s38, s38, 43008
  s_cmp_eq_u32 s38, 129024
  s_cselect_b32 s38, 0, s38
  s_mov_b32 s39, 11
ll6:
  s_waitcnt vmcnt(11)
  s_barrier
  s_add_u32 s30, s30, 1
  s_and_b32 s30, s30, 7
  s_cselect_b32 s32, 0, 1
  s_add_u32 s31, s31, s32
  s_sub_u32 s32, s30, s7
  s_and_b32 s32, s32, 7
  s_cmp_lt_u32 s32, 2
  s_cselect_b32 s32, 1, 0
  s_add_u32 s32, s32, s31
  s_cmp_ge_u32 s32, 2
  s_cselect_b32 s32, 0, s32
  s_lshl_b32 s33, s32, 3
  s_add_u32 s33, s33, s30
  s_mul_i32 s36, s33, 128
  s_add_u32 s36, s36, s34
  s_mul_i32 s37, s33, 393216
  s_add_u32 s37, s37, s35
  s_add_u32 m0, s38, s45
  s_mov_b64 exec, s[52:53]
  buffer_load_dwordx4 v12, s[8:11], s36 offen offset:0 sc1 lds
  s_mov_b64 exec, -1
  s_add_u32 m0, s38, s44
  s_nop 0
  buffer_load_dwordx4 v8, s[8:11], s36 offen offset:0 sc1 lds
  buffer_load_dwordx4 v9, s[8:11], s36 offen offset:1024 sc1 lds
  buffer_load_dwordx4 v10, s[8:11], s36 offen offset:2048 sc1 lds
  buffer_load_dwordx4 v11, s[8:11], s36 offen offset:3072 sc1 lds
  s_add_u32 m0, s38, s46
  s_nop 0
  buffer_load_dwordx4 v13, s[12:15], s37 offen offset:0  lds
  buffer_load_dwordx4 v14, s[12:15], s37 offen offset:1024  lds
  s_add_u32 m0, s38, s47
  s_nop 0
  buffer_load_dwordx4 v15, s[12:15], s37 offen offset:0  lds
  buffer_load_dwordx4 v16, s[12:15], s37 offen offset:1024  lds
  s_add_u32 m0, s38, s48
  s_nop 0
  buffer_load_dwordx4 v17, s[12:15], s37 offen offset:0  lds
  buffer_load_dwordx4 v18, s[12:15], s37 offen offset:1024  lds
  s_add_u32 s38, s38, 43008
  s_cmp_eq_u32 s38, 129024
  s_cselect_b32 s38, 0, s38
  s_sub_u32 s39, s39, 1
  s_cmp_lg_u32 s39, 0
  s_cbranch_scc1 ll6
  s_waitcnt vmcnt(11)
  s_barrier
  s_add_u32 s30, s30, 1
  s_and_b32 s30, s30, 7
  s_cselect_b32 s32, 0, 1
  s_add_u32 s31, s31, s32
  s_sub_u32 s32, s30, s7
  s_and_b32 s32, s32, 7
  s_cmp_lt_u32 s32, 2
  s_cselect_b32 s32, 1, 0
  s_add_u32 s32, s32, s31
  s_cmp_ge_u32 s32, 2
  s_cselect_b32 s32, 0, s32
  s_lshl_b32 s33, s32, 3
  s_add_u32 s33, s33, s30
  s_mul_i32 s36, s33, 128
  s_add_u32 s36, s36, s34
  s_mul_i32 s37, s33, 393216
  s_add_u32 s37, s37, s35
  s_add_u32 m0, s38, s45
  s_mov_b64 exec, s[52:53]
  buffer_load_dwordx4 v12, s[8:11], s36 offen offset:0 sc1 lds
  s_mov_b64 exec, -1
  s_add_u32 m0, s38, s44
  s_nop 0
  buffer_load_dwordx4 v8, s[8:11], s36 offen offset:0 sc1 lds
  buffer_load_dwordx4 v9, s[8:11], s36 offen offset:1024 sc1 lds
  buffer_load_dwordx4 v10, s[8:11], s36 offen offset:2048 sc1 lds
  buffer_load_dwordx4 v11, s[8:11], s36 offen offset:3072 sc1 lds
  s_add_u32 m0, s38, s46
  s_nop 0
  buffer_load_dwordx4 v13, s[12:15], s37 offen offset:0  lds
  buffer_load_dwordx4 v14, s[12:15], s37 offen offset:1024  lds
  s_add_u32 m0, s38, s47
  s_nop 0
  buffer_load_dwordx4 v15, s[12:15], s37 offen offset:0  lds
  buffer_load_dwordx4 v16, s[12:15], s37 offen offset:1024  lds
  s_add_u32 m0, s38, s48
  s_nop 0
  buffer_load_dwordx4 v17, s[12:15], s37 offen offset:0  lds
  buffer_load_dwordx4 v18, s[12:15], s37 offen offset:1024  lds
  s_add_u32 s38, s38, 43008
  s_cmp_eq_u32 s38, 129024
  s_cselect_b32 s38, 0, s38
  global_load_dword v29, v134, s[62:63] sc0 sc1
  s_waitcnt vmcnt(11)
  s_barrier
  s_add_u32 s30, s30, 1
  s_and_b32 s30, s30, 7
  s_cselect_b32 s32, 0, 1
  s_add_u32 s31, s31, s32
  s_sub_u32 s32, s30, s7
  s_and_b32 s32, s32, 7
  s_cmp_lt_u32 s32, 2
  s_cselect_b32 s32, 1, 0
  s_add_u32 s32, s32, s31
  s_cmp_ge_u32 s32, 2
  s_cselect_b32 s32, 0, s32
  s_lshl_b32 s33, s32, 3
  s_add_u32 s33, s33, s30
  s_mul_i32 s36, s33, 128
  s_add_u32 s36, s36, s34
  s_mul_i32 s37, s33, 393216
  s_add_u32 s37, s37, s35
  s_add_u32 m0, s38, s45
  s_mov_b64 exec, s[52:53]
  buffer_load_dwordx4 v12, s[8:11], s36 offen offset:0 sc1 lds
  s_mov_b64 exec, -1
  s_add_u32 m0, s38, s44
  s_nop 0
  buffer_load_dwordx4 v8, s[8:11], s36 offen offset:0 sc1 lds
  buffer_load_dwordx4 v9, s[8:11], s36 offen offset:1024 sc1 lds
  buffer_load_dwordx4 v10, s[8:11], s36 offen offset:2048 sc1 lds
  buffer_load_dwordx4 v11, s[8:11], s36 offen offset:3072 sc1 lds
  s_add_u32 m0, s38, s46
  s_nop 0
  buffer_load_dwordx4 v13, s[12:15], s37 offen offset:0  lds
  buffer_load_dwordx4 v14, s[12:15], s37 offen offset:1024  lds
  s_add_u32 m0, s38, s47
  s_nop 0
  buffer_load_dwordx4 v15, s[12:15], s37 offen offset:0  lds
  buffer_load_dwordx4 v16, s[12:15], s37 offen offset:1024  lds
  s_add_u32 m0, s38, s48
  s_nop 0
  buffer_load_dwordx4 v17, s[12:15], s37 offen offset:0  lds
  buffer_load_dwordx4 v18, s[12:15], s37 offen offset:1024  lds
  s_add_u32 s38, s38, 43008
  s_cmp_eq_u32 s38, 129024
  s_cselect_b32 s38, 0, s38
  s_cmp_lg_u32 s3, 0
  s_cbranch_scc1 st7g
  s_waitcnt vmcnt(11)
  s_mov_b32 s61, 0
st7p:
  v_cmp_gt_u32 vcc, 64, v29
  s_add_u32 s61, s61, 1
  s_cmp_gt_u32 s61, 100000
  s_cbranch_scc1 st7g
  s_cbranch_vccz st7g
  global_load_dword v29, v134, s[62:63] sc0 sc1
  s_waitcnt vmcnt(0)
  s_branch st7p
st7g:
  buffer_load_dwordx2 v[30:31], v27, s[20:23], 0 offen sc1
  s_mov_b32 s32, 16384
  buffer_load_dwordx2 v[32:33], v27, s[20:23], s32 offen sc1
  s_mov_b32 s32, 32768
  buffer_load_dwordx2 v[34:35], v27, s[20:23], s32 offen sc1
  s_mov_b32 s32, 49152
  buffer_load_dwordx2 v[36:37], v27, s[20:23], s32 offen sc1
  s_mov_b32 s32, 65536
  buffer_load_dwordx2 v[38:39], v27, s[20:23], s32 offen sc1
  s_mov_b32 s32, 81920
  buffer_load_dwordx2 v[40:41], v27, s[20:23], s32 offen sc1
  s_mov_b32 s32, 98304
  buffer_load_dwordx2 v[42:43], v27, s[20:23], s32 offen sc1
  s_mov_b32 s32, 114688
  buffer_load_dwordx2 v[44:45], v27, s[20:23], s32 offen sc1
  s_waitcnt vmcnt(19)
  s_barrier
  s_branch L_k1t
L_k1B:
  s_nop 7
  s_nop 7
  s_mov_b32 s30, 7
  s_mov_b32 s31, -1
  s_mov_b32 s38, 0
  s_add_u32 s30, s30, 1
  s_and_b32 s30, s30, 7
  s_cselect_b32 s32, 0, 1
  s_add_u32 s31, s31, s32
  s_sub_u32 s32, s30, s7
  s_and_b32 s32, s32, 7
  s_cmp_lt_u32 s32, 2
  s_cselect_b32 s32, 1, 0
  s_add_u32 s32, s32, s31
  s_cmp_ge_u32 s32, 2
  s_cselect_b32 s32, 0, s32
  s_lshl_b32 s33, s32, 3
  s_add_u32 s33, s33, s30
  s_mul_i32 s36, s33, 128
  s_add_u32 s36, s36, s34
  s_add_u32 m0, s38, s44
  s_nop 0
  buffer_load_dwordx4 v8, s[8:11], s36 offen offset:0 sc1 lds
  buffer_load_dwordx4 v9, s[8:11], s36 offen offset:1024 sc1 lds
  buffer_load_dwordx4 v10, s[8:11], s36 offen offset:2048 sc1 lds
  buffer_load_dwordx4 v11, s[8:11], s36 offen offset:3072 sc1 lds
  s_add_u32 s38, s38, 43008
  s_cmp_eq_u32 s38, 129024
  s_cselect_b32 s38, 0, s38
  s_add_u32 s30, s30, 1
  s_and_b32 s30, s30, 7
  s_cselect_b32 s32, 0, 1
  s_add_u32 s31, s31, s32
  s_sub_u32 s32, s30, s7
  s_and_b32 s32, s32, 7
  s_cmp_lt_u32 s32, 2
  s_cselect_b32 s32, 1, 0
  s_add_u32 s32, s32, s31
  s_cmp_ge_u32 s32, 2
  s_cselect_b32 s32, 0, s32
  s_lshl_b32 s33, s32, 3
  s_add_u32 s33, s33, s30
  s_mul_i32 s36, s33, 128
  s_add_u32 s36, s36, s34
  s_add_u32 m0, s38, s44
  s_nop 0
  buffer_load_dwordx4 v8, s[8:11], s36 offen offset:0 sc1 lds
  buffer_load_dwordx4 v9, s[8:11], s36 offen offset:1024 sc1 lds
  buffer_load_dwordx4 v10, s[8:11], s36 offen offset:2048 sc1 lds
  buffer_load_dwordx4 v11, s[8:11], s36 offen offset:3072 sc1 lds
  s_add_u32 s38, s38, 43008
  s_cmp_eq_u32 s38, 129024
  s_cselect_b32 s38, 0, s38
  s_waitcnt vmcnt(4)
  s_barrier
  s_add_u32 s30, s30, 1
  s_and_b32 s30, s30, 7
  s_cselect_b32 s32, 0, 1
  s_add_u32 s31, s31, s32
  s_sub_u32 s32, s30, s7
  s_and_b32 s32, s32, 7
  s_cmp_lt_u32 s32, 2
  s_cselect_b32 s32, 1, 0
  s_add_u32 s32, s32, s31
  s_cmp_ge_u32 s32, 2
  s_cselect_b32 s32, 0, s32
  s_lshl_b32 s33, s32, 3
  s_add_u32 s33, s33, s30
  s_mul_i32 s36, s33, 128
  s_add_u32 s36, s36, s34
  s_mul_i32 s37, s33, 393216
  s_add_u32 s37, s37, s35
  s_add_u32 m0, s38, s44
  s_nop 0
  buffer_load_dwordx4 v8, s[8:11], s36 offen offset:0 sc1 lds
  buffer_load_dwordx4 v9, s[8:11], s36 offen offset:1024 sc1 lds
  buffer_load_dwordx4 v10, s[8:11], s36 offen offset:2048 sc1 lds
  buffer_load_dwordx4 v11, s[8:11], s36 offen offset:3072 sc1 lds
  s_add_u32 m0, s38, s46
  s_nop 0
  buffer_load_dwordx4 v13, s[12:15], s37 offen offset:0  lds
  buffer_load_dwordx4 v14, s[12:15], s37 offen offset:1024  lds
  s_add_u32 m0, s38, s47
  s_nop 0
  buffer_load_dwordx4 v15, s[12:15], s37 offen offset:0  lds
  buffer_load_dwordx4 v16, s[12:15], s37 offen offset:1024  lds
  s_add_u32 m0, s38, s48
  s_nop 0
  buffer_load_dwordx4 v17, s[12:15], s37 offen offset:0  lds
  buffer_load_dwordx4 v18, s[12:15], s37 offen offset:1024  lds
  s_add_u32 s38, s38, 43008
  s_cmp_eq_u32 s38, 129024
  s_cselect_b32 s38, 0, s38
  s_mov_b32 s39, 11
ll8:
  s_waitcnt vmcnt(10)
  s_barrier
  s_add_u32 s30, s30, 1
  s_and_b32 s30, s30, 7
  s_cselect_b32 s32, 0, 1
  s_add_u32 s31, s31, s32
  s_sub_u32 s32, s30, s7
  s_and_b32 s32, s32, 7
  s_cmp_lt_u32 s32, 2
  s_cselect_b32 s32, 1, 0
  s_add_u32 s32, s32, s31
  s_cmp_ge_u32 s32, 2
  s_cselect_b32 s32, 0, s32
  s_lshl_b32 s33, s32, 3
  s_add_u32 s33, s33, s30
  s_mul_i32 s36, s33, 128
  s_add_u32 s36, s36, s34
  s_mul_i32 s37, s33, 393216
  s_add_u32 s37, s37, s35
  s_add_u32 m0, s38, s44
  s_nop 0
  buffer_load_dwordx4 v8, s[8:11], s36 offen offset:0 sc1 lds
  buffer_load_dwordx4 v9, s[8:11], s36 offen offset:1024 sc1 lds
  buffer_load_dwordx4 v10, s[8:11], s36 offen offset:2048 sc1 lds
  buffer_load_dwordx4 v11, s[8:11], s36 offen offset:3072 sc1 lds
  s_add_u32 m0, s38, s46
  s_nop 0
  buffer_load_dwordx4 v13, s[12:15], s37 offen offset:0  lds
  buffer_load_dwordx4 v14, s[12:15], s37 offen offset:1024  lds
  s_add_u32 m0, s38, s47
  s_nop 0
  buffer_load_dwordx4 v15, s[12:15], s37 offen offset:0  lds
  buffer_load_dwordx4 v16, s[12:15], s37 offen offset:1024  lds
  s_add_u32 m0, s38, s48
  s_nop 0
  buffer_load_dwordx4 v17, s[12:15], s37 offen offset:0  lds
  buffer_load_dwordx4 v18, s[12:15], s37 offen offset:1024  lds
  s_add_u32 s38, s38, 43008
  s_cmp_eq_u32 s38, 129024
  s_cselect_b32 s38, 0, s38
  s_sub_u32 s39, s39, 1
  s_cmp_lg_u32 s39, 0
  s_cbranch_scc1 ll8
  s_waitcnt vmcnt(10)
  s_barrier
  s_add_u32 s30, s30, 1
  s_and_b32 s30, s30, 7
  s_cselect_b32 s32, 0, 1
  s_add_u32 s31, s31, s32
  s_sub_u32 s32, s30, s7
  s_and_b32 s32, s32, 7
  s_cmp_lt_u32 s32, 2
  s_cselect_b32 s32, 1, 0
  s_add_u32 s32, s32, s31
  s_cmp_ge_u32 s32, 2
  s_cselect_b32 s32, 0, s32
  s_lshl_b32 s33, s32, 3
  s_add_u32 s33, s33, s30
  s_mul_i32 s36, s33, 128
  s_add_u32 s36, s36, s34
  s_mul_i32 s37, s33, 393216
  s_add_u32 s37, s37, s35
  s_add_u32 m0, s38, s44
  s_nop 0
  buffer_load_dwordx4 v8, s[8:11], s36 offen offset:0 sc1 lds
  buffer_load_dwordx4 v9, s[8:11], s36 offen offset:1024 sc1 lds
  buffer_load_dwordx4 v10, s[8:11], s36 offen offset:2048 sc1 lds
  buffer_load_dwordx4 v11, s[8:11], s36 offen offset:3072 sc1 lds
  s_add_u32 m0, s38, s46
  s_nop 0
  buffer_load_dwordx4 v13, s[12:15], s37 offen offset:0  lds
  buffer_load_dwordx4 v14, s[12:15], s37 offen offset:1024  lds
  s_add_u32 m0, s38, s47
  s_nop 0
  buffer_load_dwordx4 v15, s[12:15], s37 offen offset:0  lds
  buffer_load_dwordx4 v16, s[12:15], s37 offen offset:1024  lds
  s_add_u32 m0, s38, s48
  s_nop 0
  buffer_load_dwordx4 v17, s[12:15], s37 offen offset:0  lds
  buffer_load_dwordx4 v18, s[12:15], s37 offen offset:1024  lds
  s_add_u32 s38, s38, 43008
  s_cmp_eq_u32 s38, 129024
  s_cselect_b32 s38, 0, s38
  global_load_dword v29, v134, s[62:63] sc0 sc1
  s_waitcnt vmcnt(10)
  s_barrier
  s_add_u32 s30, s30, 1
  s_and_b32 s30, s30, 7
  s_cselect_b32 s32, 0, 1
  s_add_u32 s31, s31, s32
  s_sub_u32 s32, s30, s7
  s_and_b32 s32, s32, 7
  s_cmp_lt_u32 s32, 2
  s_cselect_b32 s32, 1, 0
  s_add_u32 s32, s32, s31
  s_cmp_ge_u32 s32, 2
  s_cselect_b32 s32, 0, s32
  s_lshl_b32 s33, s32, 3
  s_add_u32 s33, s33, s30
  s_mul_i32 s36, s33, 128
  s_add_u32 s36, s36, s34
  s_mul_i32 s37, s33, 393216
  s_add_u32 s37, s37, s35
  s_add_u32 m0, s38, s44
  s_nop 0
  buffer_load_dwordx4 v8, s[8:11], s36 offen offset:0 sc1 lds
  buffer_load_dwordx4 v9, s[8:11], s36 offen offset:1024 sc1 lds
  buffer_load_dwordx4 v10, s[8:11], s36 offen offset:2048 sc1 lds
  buffer_load_dwordx4 v11, s[8:11], s36 offen offset:3072 sc1 lds
  s_add_u32 m0, s38, s46
  s_nop 0
  buffer_load_dwordx4 v13, s[12:15], s37 offen offset:0  lds
  buffer_load_dwordx4 v14, s[12:15], s37 offen offset:1024  lds
  s_add_u32 m0, s38, s47
  s_nop 0
  buffer_load_dwordx4 v15, s[12:15], s37 offen offset:0  lds
  buffer_load_dwordx4 v16, s[12:15], s37 offen offset:1024  lds
  s_add_u32 m0, s38, s48
  s_nop 0
  buffer_load_dwordx4 v17, s[12:15], s37 offen offset:0  lds
  buffer_load_dwordx4 v18, s[12:15], s37 offen offset:1024  lds
  s_add_u32 s38, s38, 43008
  s_cmp_eq_u32 s38, 129024
  s_cselect_b32 s38, 0, s38
  s_cmp_lg_u32 s3, 0
  s_cbranch_scc1 st9g
  s_waitcnt vmcnt(10)
  s_mov_b32 s61, 0
st9p:
  v_cmp_gt_u32 vcc, 64, v29
  s_add_u32 s61, s61, 1
  s_cmp_gt_u32 s61, 100000
  s_cbranch_scc1 st9g
  s_cbranch_vccz st9g
  global_load_dword v29, v134, s[62:63] sc0 sc1
  s_waitcnt vmcnt(0)
  s_branch st9p
st9g:
  buffer_load_dwordx2 v[30:31], v27, s[20:23], 0 offen sc1
  s_mov_b32 s32, 16384
  buffer_load_dwordx2 v[32:33], v27, s[20:23], s32 offen sc1
  s_mov_b32 s32, 32768
  buffer_load_dwordx2 v[34:35], v27, s[20:23], s32 offen sc1
  s_mov_b32 s32, 49152
  buffer_load_dwordx2 v[36:37], v27, s[20:23], s32 offen sc1
  s_mov_b32 s32, 65536
  buffer_load_dwordx2 v[38:39], v27, s[20:23], s32 offen sc1
  s_mov_b32 s32, 81920
  buffer_load_dwordx2 v[40:41], v27, s[20:23], s32 offen sc1
  s_mov_b32 s32, 98304
  buffer_load_dwordx2 v[42:43], v27, s[20:23], s32 offen sc1
  s_mov_b32 s32, 114688
  buffer_load_dwordx2 v[44:45], v27, s[20:23], s32 offen sc1
  s_waitcnt vmcnt(18)
  s_barrier
L_k1t:
  s_nop 7
  s_nop 7
  s_waitcnt vmcnt(0)
  v_pk_add_f32 v[30:31], v[30:31], v[32:33]
  v_pk_add_f32 v[34:35], v[34:35], v[36:37]
  v_pk_add_f32 v[38:39], v[38:39], v[40:41]
  v_pk_add_f32 v[42:43], v[42:43], v[44:45]
  v_pk_add_f32 v[30:31], v[30:31], v[34:35]
  v_pk_add_f32 v[38:39], v[38:39], v[42:43]
  v_pk_add_f32 v[30:31], v[30:31], v[38:39]
  v_mul_f32 v30, 0x3a800000, v30
  v_mul_f32 v31, 0x3a800000, v31
  v_fma_f32 v31, -v30, v30, v31
  v_max_f32 v31, 0, v31
  v_mov_b32 v32, v31
  v_cvt_pk_bf16_f32 v32, v32, v32
  v_lshlrev_b32 v32, 16, v32
  v_add_f32 v32, 0x3727c5ac, v32
  v_cvt_pk_bf16_f32 v32, v32, v32
  v_lshlrev_b32 v32, 16, v32
  v_sqrt_f32 v32, v32
  s_nop 0
  v_cvt_pk_bf16_f32 v32, v32, v32
  v_lshlrev_b32 v32, 16, v32
  v_rcp_f32 v32, v32
  v_cvt_pk_bf16_f32 v30, v30, v30
  v_lshlrev_b32 v30, 16, v30
  v_mov_b32 v31, v32
  ds_write_b64 v26, v[30:31]
  s_waitcnt lgkmcnt(0)
  s_mov_b32 s41, s57
  s_mul_i32 s32, s41, 16
  s_add_u32 s32, s32, 0
  v_lshrrev_b32 v2, 3, v0
  v_add_u32 v2, s32, v2
  v_bfe_u32 v3, v2, 1, 1
  v_bfe_u32 v4, v2, 3, 1
  v_lshl_or_b32 v3, v4, 1, v3
  v_lshlrev_b32 v3, 1, v3
  v_and_b32 v4, 7, v0
  v_xor_b32 v3, v3, v4
  v_lshlrev_b32 v3, 4, v3
  s_mov_b32 s32, 2048
  v_mul_lo_u32 v2, v2, s32
  v_add_u32 v130, v2, v3
  s_mul_i32 s32, s41, 16
  s_add_u32 s32, s32, 8
  v_lshrrev_b32 v2, 3, v0
  v_add_u32 v2, s32, v2
  v_bfe_u32 v3, v2, 1, 1
  v_bfe_u32 v4, v2, 3, 1
  v_lshl_or_b32 v3, v4, 1, v3
  v_lshlrev_b32 v3, 1, v3
  v_and_b32 v4, 7, v0
  v_xor_b32 v3, v3, v4
  v_lshlrev_b32 v3, 4, v3
  s_mov_b32 s32, 2048
  v_mul_lo_u32 v2, v2, s32
  v_add_u32 v131, v2, v3
  v_subrev_u32 v131, 1024, v131
  s_mov_b32 s12, s68
  s_mov_b32 s13, s69
  s_mov_b32 s14, 2097152
  s_mov_b32 s15, 0x20000
  s_mov_b32 s30, 7
  s_mov_b32 s31, -1
  s_lshl_b32 s52, s57, 11
  s_add_u32 s30, s30, 1
  s_and_b32 s30, s30, 7
  s_cselect_b32 s32, 0, 1
  s_add_u32 s31, s31, s32
  s_sub_u32 s32, s30, s7
  s_and_b32 s32, s32, 7
  s_cmp_lt_u32 s32, 2
  s_cselect_b32 s32, 1, 0
  s_add_u32 s32, s32, s31
  s_cmp_ge_u32 s32, 2
  s_cselect_b32 s32, 0, s32
  s_lshl_b32 s33, s32, 3
  s_add_u32 s33, s33, s30
  s_lshl_b32 s37, s33, 17
  s_add_u32 s37, s37, s35
  s_add_u32 m0, s52, 131072
  s_nop 0
  buffer_load_dwordx4 v130, s[12:15], s37 offen lds
  buffer_load_dwordx4 v131, s[12:15], s37 offen offset:1024 lds
  s_add_u32 s30, s30, 1
  s_and_b32 s30, s30, 7
  s_cselect_b32 s32, 0, 1
  s_add_u32 s31, s31, s32
  s_sub_u32 s32, s30, s7
  s_and_b32 s32, s32, 7
  s_cmp_lt_u32 s32, 2
  s_cselect_b32 s32, 1, 0
  s_add_u32 s32, s32, s31
  s_cmp_ge_u32 s32, 2
  s_cselect_b32 s32, 0, s32
  s_lshl_b32 s33, s32, 3
  s_add_u32 s33, s33, s30
  s_lshl_b32 s37, s33, 17
  s_add_u32 s37, s37, s35
  s_add_u32 m0, s52, 139264
  s_nop 0
  buffer_load_dwordx4 v130, s[12:15], s37 offen lds
  buffer_load_dwordx4 v131, s[12:15], s37 offen offset:1024 lds
  s_add_u32 s30, s30, 1
  s_and_b32 s30, s30, 7
  s_cselect_b32 s32, 0, 1
  s_add_u32 s31, s31, s32
  s_sub_u32 s32, s30, s7
  s_and_b32 s32, s32, 7
  s_cmp_lt_u32 s32, 2
  s_cselect_b32 s32, 1, 0
  s_add_u32 s32, s32, s31
  s_cmp_ge_u32 s32, 2
  s_cselect_b32 s32, 0, s32
  s_lshl_b32 s33, s32, 3
  s_add_u32 s33, s33, s30
  s_lshl_b32 s37, s33, 17
  s_add_u32 s37, s37, s35
  s_add_u32 m0, s52, 147456
  s_nop 0
  buffer_load_dwordx4 v130, s[12:15], s37 offen lds
  buffer_load_dwordx4 v131, s[12:15], s37 offen offset:1024 lds
  s_add_u32 s30, s30, 1
  s_and_b32 s30, s30, 7
  s_cselect_b32 s32, 0, 1
  s_add_u32 s31, s31, s32
  s_sub_u32 s32, s30, s7
  s_and_b32 s32, s32, 7
  s_cmp_lt_u32 s32, 2
  s_cselect_b32 s32, 1, 0
  s_add_u32 s32, s32, s31
  s_cmp_ge_u32 s32, 2
  s_cselect_b32 s32, 0, s32
  s_lshl_b32 s33, s32, 3
  s_add_u32 s33, s33, s30
  s_lshl_b32 s37, s33, 17
  s_add_u32 s37, s37, s35
  s_add_u32 m0, s52, 155648
  s_nop 0
  buffer_load_dwordx4 v130, s[12:15], s37 offen lds
  buffer_load_dwordx4 v131, s[12:15], s37 offen offset:1024 lds
  s_waitcnt vmcnt(8)
  s_barrier
  s_add_u32 s30, s30, 1
  s_and_b32 s30, s30, 7
  s_cselect_b32 s32, 0, 1
  s_add_u32 s31, s31, s32
  s_sub_u32 s32, s30, s7
  s_and_b32 s32, s32, 7
  s_cmp_lt_u32 s32, 2
  s_cselect_b32 s32, 1, 0
  s_add_u32 s32, s32, s31
  s_cmp_ge_u32 s32, 2
  s_cselect_b32 s32, 0, s32
  s_lshl_b32 s33, s32, 3
  s_add_u32 s33, s33, s30
  s_lshl_b32 s37, s33, 17
  s_add_u32 s37, s37, s35
  s_add_u32 m0, s52, 100608
  s_nop 0
  buffer_load_dwordx4 v130, s[12:15], s37 offen lds
  buffer_load_dwordx4 v131, s[12:15], s37 offen offset:1024 lds
  s_add_u32 s30, s30, 1
  s_and_b32 s30, s30, 7
  s_cselect_b32 s32, 0, 1
  s_add_u32 s31, s31, s32
  s_sub_u32 s32, s30, s7
  s_and_b32 s32, s32, 7
  s_cmp_lt_u32 s32, 2
  s_cselect_b32 s32, 1, 0
  s_add_u32 s32, s32, s31
  s_cmp_ge_u32 s32, 2
  s_cselect_b32 s32, 0, s32
  s_lshl_b32 s33, s32, 3
  s_add_u32 s33, s33, s30
  s_lshl_b32 s37, s33, 17
  s_add_u32 s37, s37, s35
  s_add_u32 m0, s52, 108800
  s_nop 0
  buffer_load_dwordx4 v130, s[12:15], s37 offen lds
  buffer_load_dwordx4 v131, s[12:15], s37 offen offset:1024 lds
  s_add_u32 s30, s30, 1
  s_and_b32 s30, s30, 7
  s_cselect_b32 s32, 0, 1
  s_add_u32 s31, s31, s32
  s_sub_u32 s32, s30, s7
  s_and_b32 s32, s32, 7
  s_cmp_lt_u32 s32, 2
  s_cselect_b32 s32, 1, 0
  s_add_u32 s32, s32, s31
  s_cmp_ge_u32 s32, 2
  s_cselect_b32 s32, 0, s32
  s_lshl_b32 s33, s32, 3
  s_add_u32 s33, s33, s30
  s_lshl_b32 s37, s33, 17
  s_add_u32 s37, s37, s35
  s_add_u32 m0, s52, 116992
  s_nop 0
  buffer_load_dwordx4 v130, s[12:15], s37 offen lds
  buffer_load_dwordx4 v131, s[12:15], s37 offen offset:1024 lds
  v_and_b32 v4, 15, v0
  v_lshrrev_b32 v5, 4, v0
  v_lshrrev_b32 v6, 2, v4
  v_and_b32 v7, 3, v0
  v_lshrrev_b32 v3, 5, v0
  v_and_b32 v2, 1, v5
  v_lshl_or_b32 v3, v2, 1, v3
  s_waitcnt lgkmcnt(0)
  s_barrier
  s_add_u32 s30, s30, 1
  s_and_b32 s30, s30, 7
  s_cselect_b32 s32, 0, 1
  s_add_u32 s31, s31, s32
  s_sub_u32 s32, s30, s7
  s_and_b32 s32, s32, 7
  s_cmp_lt_u32 s32, 2
  s_cselect_b32 s32, 1, 0
  s_add_u32 s32, s32, s31
  s_cmp_ge_u32 s32, 2
  s_cselect_b32 s32, 0, s32
  s_lshl_b32 s33, s32, 3
  s_add_u32 s33, s33, s30
  s_lshl_b32 s37, s33, 17
  s_add_u32 s37, s37, s35
  s_add_u32 m0, s52, 0
  s_nop 0
  buffer_load_dwordx4 v130, s[12:15], s37 offen lds
  buffer_load_dwordx4 v131, s[12:15], s37 offen offset:1024 lds
  s_add_u32 s30, s30, 1
  s_and_b32 s30, s30, 7
  s_cselect_b32 s32, 0, 1
  s_add_u32 s31, s31, s32
  s_sub_u32 s32, s30, s7
  s_and_b32 s32, s32, 7
  s_cmp_lt_u32 s32, 2
  s_cselect_b32 s32, 1, 0
  s_add_u32 s32, s32, s31
  s_cmp_ge_u32 s32, 2
  s_cselect_b32 s32, 0, s32
  s_lshl_b32 s33, s32, 3
  s_add_u32 s33, s33, s30
  s_lshl_b32 s37, s33, 17
  s_add_u32 s37, s37, s35
  s_add_u32 m0, s52, 8192
  s_nop 0
  buffer_load_dwordx4 v130, s[12:15], s37 offen lds
  buffer_load_dwordx4 v131, s[12:15], s37 offen offset:1024 lds
  s_add_u32 s30, s30, 1
  s_and_b32 s30, s30, 7
  s_cselect_b32 s32, 0, 1
  s_add_u32 s31, s31, s32
  s_sub_u32 s32, s30, s7
  s_and_b32 s32, s32, 7
  s_cmp_lt_u32 s32, 2
  s_cselect_b32 s32, 1, 0
  s_add_u32 s32, s32, s31
  s_cmp_ge_u32 s32, 2
  s_cselect_b32 s32, 0, s32
  s_lshl_b32 s33, s32, 3
  s_add_u32 s33, s33, s30
  s_lshl_b32 s37, s33, 17
  s_add_u32 s37, s37, s35
  s_add_u32 m0, s52, 16384
  s_nop 0
  buffer_load_dwordx4 v130, s[12:15], s37 offen lds
  buffer_load_dwordx4 v131, s[12:15], s37 offen offset:1024 lds
  s_add_u32 s30, s30, 1
  s_and_b32 s30, s30, 7
  s_cselect_b32 s32, 0, 1
  s_add_u32 s31, s31, s32
  s_sub_u32 s32, s30, s7
  s_and_b32 s32, s32, 7
  s_cmp_lt_u32 s32, 2
  s_cselect_b32 s32, 1, 0
  s_add_u32 s32, s32, s31
  s_cmp_ge_u32 s32, 2
  s_cselect_b32 s32, 0, s32
  s_lshl_b32 s33, s32, 3
  s_add_u32 s33, s33, s30
  s_lshl_b32 s37, s33, 17
  s_add_u32 s37, s37, s35
  s_add_u32 m0, s52, 24576
  s_nop 0
  buffer_load_dwordx4 v130, s[12:15], s37 offen lds
  buffer_load_dwordx4 v131, s[12:15], s37 offen offset:1024 lds
  s_add_u32 s30, s30, 1
  s_and_b32 s30, s30, 7
  s_cselect_b32 s32, 0, 1
  s_add_u32 s31, s31, s32
  s_sub_u32 s32, s30, s7
  s_and_b32 s32, s32, 7
  s_cmp_lt_u32 s32, 2
  s_cselect_b32 s32, 1, 0
  s_add_u32 s32, s32, s31
  s_cmp_ge_u32 s32, 2
  s_cselect_b32 s32, 0, s32
  s_lshl_b32 s33, s32, 3
  s_add_u32 s33, s33, s30
  s_lshl_b32 s37, s33, 17
  s_add_u32 s37, s37, s35
  s_add_u32 m0, s52, 32768
  s_nop 0
  buffer_load_dwordx4 v130, s[12:15], s37 offen lds
  buffer_load_dwordx4 v131, s[12:15], s37 offen offset:1024 lds
  s_branch attn
L_k1done:
  s_nop 7
  s_nop 7
  s_add_u32 s24, s84, 29360128
  s_addc_u32 s25, s85, 0
  s_mov_b32 s26, 262144
  s_mov_b32 s27, 0x20000
  v_mov_b32 v136, 0
  v_mov_b32 v137, 1
  s_cmp_eq_u32 s57, 0
  s_cselect_b32 s26, s26, 0
  s_waitcnt vmcnt(0)
  s_barrier
  s_mov_b64 exec, 1
  buffer_store_dword v137, v136, s[24:27], s56 offen sc0 sc1
  s_mov_b64 exec, -1
  s_add_u32 s30, s30, 1
  s_and_b32 s30, s30, 7
  s_cselect_b32 s32, 0, 1
  s_add_u32 s31, s31, s32
  s_sub_u32 s32, s30, s7
  s_and_b32 s32, s32, 7
  s_cmp_lt_u32 s32, 2
  s_cselect_b32 s32, 1, 0
  s_add_u32 s32, s32, s31
  s_cmp_ge_u32 s32, 2
  s_cselect_b32 s32, 0, s32
  s_lshl_b32 s33, s32, 3
  s_add_u32 s33, s33, s30
  s_lshl_b32 s37, s33, 17
  s_add_u32 s37, s37, s35
  s_add_u32 m0, s52, 43008
  s_nop 0
  buffer_load_dwordx4 v130, s[12:15], s37 offen lds
  buffer_load_dwordx4 v131, s[12:15], s37 offen offset:1024 lds
  s_add_u32 s30, s30, 1
  s_and_b32 s30, s30, 7
  s_cselect_b32 s32, 0, 1
  s_add_u32 s31, s31, s32
  s_sub_u32 s32, s30, s7
  s_and_b32 s32, s32, 7
  s_cmp_lt_u32 s32, 2
  s_cselect_b32 s32, 1, 0
  s_add_u32 s32, s32, s31
  s_cmp_ge_u32 s32, 2
  s_cselect_b32 s32, 0, s32
  s_lshl_b32 s33, s32, 3
  s_add_u32 s33, s33, s30
  s_lshl_b32 s37, s33, 17
  s_add_u32 s37, s37, s35
  s_add_u32 m0, s52, 51200
  s_nop 0
  buffer_load_dwordx4 v130, s[12:15], s37 offen lds
  buffer_load_dwordx4 v131, s[12:15], s37 offen offset:1024 lds
  s_add_u32 s30, s30, 1
  s_and_b32 s30, s30, 7
  s_cselect_b32 s32, 0, 1
  s_add_u32 s31, s31, s32
  s_sub_u32 s32, s30, s7
  s_and_b32 s32, s32, 7
  s_cmp_lt_u32 s32, 2
  s_cselect_b32 s32, 1, 0
  s_add_u32 s32, s32, s31
  s_cmp_ge_u32 s32, 2
  s_cselect_b32 s32, 0, s32
  s_lshl_b32 s33, s32, 3
  s_add_u32 s33, s33, s30
  s_lshl_b32 s37, s33, 17
  s_add_u32 s37, s37, s35
  s_add_u32 m0, s52, 59392
  s_nop 0
  buffer_load_dwordx4 v130, s[12:15], s37 offen lds
  buffer_load_dwordx4 v131, s[12:15], s37 offen offset:1024 lds
  s_add_u32 s30, s30, 1
  s_and_b32 s30, s30, 7
  s_cselect_b32 s32, 0, 1
  s_add_u32 s31, s31, s32
  s_sub_u32 s32, s30, s7
  s_and_b32 s32, s32, 7
  s_cmp_lt_u32 s32, 2
  s_cselect_b32 s32, 1, 0
  s_add_u32 s32, s32, s31
  s_cmp_ge_u32 s32, 2
  s_cselect_b32 s32, 0, s32
  s_lshl_b32 s33, s32, 3
  s_add_u32 s33, s33, s30
  s_lshl_b32 s37, s33, 17
  s_add_u32 s37, s37, s35
  s_add_u32 m0, s52, 67584
  s_nop 0
  buffer_load_dwordx4 v130, s[12:15], s37 offen lds
  buffer_load_dwordx4 v131, s[12:15], s37 offen offset:1024 lds
  s_lshl_b32 s56, s3, 10
  s_mul_i32 s32, s29, 16
  s_add_u32 s56, s56, s32
  s_add_u32 s56, s56, s28
  s_add_u32 s56, s56, 256
  s_lshl_b32 s56, s56, 7
  s_waitcnt vmcnt(0)
  s_barrier
  s_cmp_ge_u32 s2, 224
  s_cbranch_scc1 L_k3skip
  s_lshr_b32 s32, s2, 3
  s_mul_i32 s5, s32, 9363
  s_lshr_b32 s5, s5, 16
  s_mul_i32 s6, s5, 7
  s_sub_u32 s6, s32, s6
  s_lshl_b32 s7, s5, 1
  s_add_u32 s7, s7, s6
  s_and_b32 s7, s7, 7
  s_and_b32 s32, s2, 7
  s_lshr_b32 s28, s32, 2
  s_lshl_b32 s28, s28, 2
  s_add_u32 s28, s28, s5
  s_and_b32 s29, s32, 3
  s_mul_i32 s29, s29, 7
  s_add_u32 s29, s29, s6
  s_mov_b32 s30, 7
  s_mov_b32 s31, -1
  s_lshl_b32 s44, s57, 12
  s_add_u32 s45, s44, 16384
  v_lshlrev_b32 v8, 4, v0
  v_add_u32 v13, 63488, v8
  v_lshrrev_b32 v2, 4, v0
  v_lshlrev_b32 v3, 1, v2
  v_and_b32 v4, 15, v0
  v_xor_b32 v3, v3, v4
  v_lshlrev_b32 v3, 4, v3
  s_lshl_b32 s32, s57, 4
  v_add_u32 v2, s32, v2
  s_mov_b32 s32, 7168
  v_mul_lo_u32 v2, v2, s32
  v_add_u32 v9, v2, v3
  v_xor_b32 v3, 128, v3
  v_add_u32 v11, v2, v3
  v_add_u32 v10, 27648, v9
  v_add_u32 v12, 82944, v11
  v_add_u32 v11, 55296, v11
  s_lshl_b32 s34, s28, 2
  s_add_u32 s34, s34, s57
  s_lshl_b32 s34, s34, 17
  s_lshl_b32 s35, s29, 8
  s_add_u32 s8, s82, 8388608
  s_addc_u32 s9, s83, 0
  s_mov_b32 s10, 4194304
  s_mov_b32 s11, 0x20000
  s_mov_b32 s12, s72
  s_mov_b32 s13, s73
  s_mov_b32 s14, 14680064
  s_mov_b32 s15, 0x20000
  s_add_u32 s16, s84, 29360128
  s_addc_u32 s17, s85, 0
  s_mov_b32 s18, 262144
  s_mov_b32 s19, 0x20000
  s_lshl_b32 s32, s28, 5
  v_min_u32 v14, 31, v0
  v_add_u32 v14, s32, v14
  v_max_i32 v14, 0, v14
  v_lshlrev_b32 v14, 7, v14
  s_lshl_b32 s55, s3, 17
  s_add_u32 s55, s55, 32768
  s_barrier
  s_barrier
  s_mov_b64 exec, 1
  buffer_store_dword v137, v136, s[24:27], s56 offen sc0 sc1
  s_mov_b64 exec, -1
  s_mov_b32 s30, 7
  s_mov_b32 s31, -1
  s_mov_b32 s38, 0
  s_add_u32 s30, s30, 1
  s_and_b32 s30, s30, 7
  s_cselect_b32 s32, 0, 1
  s_add_u32 s31, s31, s32
  s_sub_u32 s32, s30, s7
  s_and_b32 s32, s32, 7
  s_cmp_lt_u32 s32, 2
  s_cselect_b32 s32, 1, 0
  s_add_u32 s32, s32, s31
  s_cmp_ge_u32 s32, 4
  s_cselect_b32 s32, 0, s32
  s_lshl_b32 s33, s32, 3
  s_add_u32 s33, s33, s30
  s_mul_i32 s37, s33, 458752
  s_add_u32 s37, s37, s35
  s_add_u32 m0, s38, s45
  s_nop 0
  buffer_load_dwordx4 v9, s[12:15], s37 offen offset:0  lds
  buffer_load_dwordx4 v10, s[12:15], s37 offen offset:1024  lds
  buffer_load_dwordx4 v11, s[12:15], s37 offen offset:2048  lds
  buffer_load_dwordx4 v12, s[12:15], s37 offen offset:3072  lds
  s_add_u32 s38, s38, 32768
  s_cmp_eq_u32 s38, 163840
  s_cselect_b32 s38, 0, s38
  s_add_u32 s30, s30, 1
  s_and_b32 s30, s30, 7
  s_cselect_b32 s32, 0, 1
  s_add_u32 s31, s31, s32
  s_sub_u32 s32, s30, s7
  s_and_b32 s32, s32, 7
  s_cmp_lt_u32 s32, 2
  s_cselect_b32 s32, 1, 0
  s_add_u32 s32, s32, s31
  s_cmp_ge_u32 s32, 4
  s_cselect_b32 s32, 0, s32
  s_lshl_b32 s33, s32, 3
  s_add_u32 s33, s33, s30
  s_mul_i32 s37, s33, 458752
  s_add_u32 s37, s37, s35
  s_add_u32 m0, s38, s45
  s_nop 0
  buffer_load_dwordx4 v9, s[12:15], s37 offen offset:0  lds
  buffer_load_dwordx4 v10, s[12:15], s37 offen offset:1024  lds
  buffer_load_dwordx4 v11, s[12:15], s37 offen offset:2048  lds
  buffer_load_dwordx4 v12, s[12:15], s37 offen offset:3072  lds
  s_add_u32 s38, s38, 32768
  s_cmp_eq_u32 s38, 163840
  s_cselect_b32 s38, 0, s38
  s_add_u32 s30, s30, 1
  s_and_b32 s30, s30, 7
  s_cselect_b32 s32, 0, 1
  s_add_u32 s31, s31, s32
  s_sub_u32 s32, s30, s7
  s_and_b32 s32, s32, 7
  s_cmp_lt_u32 s32, 2
  s_cselect_b32 s32, 1, 0
  s_add_u32 s32, s32, s31
  s_cmp_ge_u32 s32, 4
  s_cselect_b32 s32, 0, s32
  s_lshl_b32 s33, s32, 3
  s_add_u32 s33, s33, s30
  s_mul_i32 s37, s33, 458752
  s_add_u32 s37, s37, s35
  s_add_u32 m0, s38, s45
  s_nop 0
  buffer_load_dwordx4 v9, s[12:15], s37 offen offset:0  lds
  buffer_load_dwordx4 v10, s[12:15], s37 offen offset:1024  lds
  buffer_load_dwordx4 v11, s[12:15], s37 offen offset:2048  lds
  buffer_load_dwordx4 v12, s[12:15], s37 offen offset:3072  lds
  s_add_u32 s38, s38, 32768
  s_cmp_eq_u32 s38, 163840
  s_cselect_b32 s38, 0, s38
  s_lshl_b32 s56, s3, 10
  s_mul_i32 s32, s28, 32
  s_add_u32 s56, s56, s32
  s_add_u32 s56, s56, s29
  s_add_u32 s56, s56, 512
  s_lshl_b32 s56, s56, 7
  s_mov_b32 s39, 0
poll10:
  buffer_load_dword v15, v14, s[16:19], s55 offen sc0 sc1
  s_waitcnt vmcnt(0)
  v_cmp_eq_u32 vcc, 0, v15
  s_add_u32 s39, s39, 1
  s_cmp_gt_u32 s39, 100000
  s_cbranch_scc1 poll10d
  s_cbranch_vccnz poll10
poll10d:
  s_mov_b32 s30, 7
  s_mov_b32 s31, -1
  s_mov_b32 s38, 0
  s_add_u32 s30, s30, 1
  s_and_b32 s30, s30, 7
  s_cselect_b32 s32, 0, 1
  s_add_u32 s31, s31, s32
  s_sub_u32 s32, s30, s7
  s_and_b32 s32, s32, 7
  s_cmp_lt_u32 s32, 2
  s_cselect_b32 s32, 1, 0
  s_add_u32 s32, s32, s31
  s_cmp_ge_u32 s32, 4
  s_cselect_b32 s32, 0, s32
  s_lshl_b32 s33, s32, 3
  s_add_u32 s33, s33, s30
  s_mul_i32 s36, s33, 2048
  s_add_u32 s36, s36, s34
  s_add_u32 m0, s38, s44
  s_nop 0
  buffer_load_dwordx4 v8, s[8:11], s36 offen offset:0 sc1 lds
  buffer_load_dwordx4 v8, s[8:11], s36 offen offset:1024 sc1 lds
  buffer_load_dwordx4 v13, s[8:11], s36 offen offset:2048 sc1 lds
  buffer_load_dwordx4 v13, s[8:11], s36 offen offset:3072 sc1 lds
  s_add_u32 s38, s38, 32768
  s_cmp_eq_u32 s38, 163840
  s_cselect_b32 s38, 0, s38
  s_add_u32 s30, s30, 1
  s_and_b32 s30, s30, 7
  s_cselect_b32 s32, 0, 1
  s_add_u32 s31, s31, s32
  s_sub_u32 s32, s30, s7
  s_and_b32 s32, s32, 7
  s_cmp_lt_u32 s32, 2
  s_cselect_b32 s32, 1, 0
  s_add_u32 s32, s32, s31
  s_cmp_ge_u32 s32, 4
  s_cselect_b32 s32, 0, s32
  s_lshl_b32 s33, s32, 3
  s_add_u32 s33, s33, s30
  s_mul_i32 s36, s33, 2048
  s_add_u32 s36, s36, s34
  s_add_u32 m0, s38, s44
  s_nop 0
  buffer_load_dwordx4 v8, s[8:11], s36 offen offset:0 sc1 lds
  buffer_load_dwordx4 v8, s[8:11], s36 offen offset:1024 sc1 lds
  buffer_load_dwordx4 v13, s[8:11], s36 offen offset:2048 sc1 lds
  buffer_load_dwordx4 v13, s[8:11], s36 offen offset:3072 sc1 lds
  s_add_u32 s38, s38, 32768
  s_cmp_eq_u32 s38, 163840
  s_cselect_b32 s38, 0, s38
  s_add_u32 s30, s30, 1
  s_and_b32 s30, s30, 7
  s_cselect_b32 s32, 0, 1
  s_add_u32 s31, s31, s32
  s_sub_u32 s32, s30, s7
  s_and_b32 s32, s32, 7
  s_cmp_lt_u32 s32, 2
  s_cselect_b32 s32, 1, 0
  s_add_u32 s32, s32, s31
  s_cmp_ge_u32 s32, 4
  s_cselect_b32 s32, 0, s32
  s_lshl_b32 s33, s32, 3
  s_add_u32 s33, s33, s30
  s_mul_i32 s36, s33, 2048
  s_add_u32 s36, s36, s34
  s_add_u32 m0, s38, s44
  s_nop 0
  buffer_load_dwordx4 v8, s[8:11], s36 offen offset:0 sc1 lds
  buffer_load_dwordx4 v8, s[8:11], s36 offen offset:1024 sc1 lds
  buffer_load_dwordx4 v13, s[8:11], s36 offen offset:2048 sc1 lds
  buffer_load_dwordx4 v13, s[8:11], s36 offen offset:3072 sc1 lds
  s_add_u32 s38, s38, 32768
  s_cmp_eq_u32 s38, 163840
  s_cselect_b32 s38, 0, s38
  s_waitcnt vmcnt(8)
  s_barrier
  s_add_u32 s30, s30, 1
  s_and_b32 s30, s30, 7
  s_cselect_b32 s32, 0, 1
  s_add_u32 s31, s31, s32
  s_sub_u32 s32, s30, s7
  s_and_b32 s32, s32, 7
  s_cmp_lt_u32 s32, 2
  s_cselect_b32 s32, 1, 0
  s_add_u32 s32, s32, s31
  s_cmp_ge_u32 s32, 4
  s_cselect_b32 s32, 0, s32
  s_lshl_b32 s33, s32, 3
  s_add_u32 s33, s33, s30
  s_mul_i32 s36, s33, 2048
  s_add_u32 s36, s36, s34
  s_mul_i32 s37, s33, 458752
  s_add_u32 s37, s37, s35
  s_add_u32 m0, s38, s44
  s_nop 0
  buffer_load_dwordx4 v8, s[8:11], s36 offen offset:0 sc1 lds
  buffer_load_dwordx4 v8, s[8:11], s36 offen offset:1024 sc1 lds
  buffer_load_dwordx4 v13, s[8:11], s36 offen offset:2048 sc1 lds
  buffer_load_dwordx4 v13, s[8:11], s36 offen offset:3072 sc1 lds
  s_add_u32 m0, s38, s45
  s_nop 0
  buffer_load_dwordx4 v9, s[12:15], s37 offen offset:0  lds
  buffer_load_dwordx4 v10, s[12:15], s37 offen offset:1024  lds
  buffer_load_dwordx4 v11, s[12:15], s37 offen offset:2048  lds
  buffer_load_dwordx4 v12, s[12:15], s37 offen offset:3072  lds
  s_add_u32 s38, s38, 32768
  s_cmp_eq_u32 s38, 163840
  s_cselect_b32 s38, 0, s38
  s_waitcnt vmcnt(12)
  s_barrier
  s_add_u32 s30, s30, 1
  s_and_b32 s30, s30, 7
  s_cselect_b32 s32, 0, 1
  s_add_u32 s31, s31, s32
  s_sub_u32 s32, s30, s7
  s_and_b32 s32, s32, 7
  s_cmp_lt_u32 s32, 2
  s_cselect_b32 s32, 1, 0
  s_add_u32 s32, s32, s31
  s_cmp_ge_u32 s32, 4
  s_cselect_b32 s32, 0, s32
  s_lshl_b32 s33, s32, 3
  s_add_u32 s33, s33, s30
  s_mul_i32 s36, s33, 2048
  s_add_u32 s36, s36, s34
  s_mul_i32 s37, s33, 458752
  s_add_u32 s37, s37, s35
  s_add_u32 m0, s38, s44
  s_nop 0
  buffer_load_dwordx4 v8, s[8:11], s36 offen offset:0 sc1 lds
  buffer_load_dwordx4 v8, s[8:11], s36 offen offset:1024 sc1 lds
  buffer_load_dwordx4 v13, s[8:11], s36 offen offset:2048 sc1 lds
  buffer_load_dwordx4 v13, s[8:11], s36 offen offset:3072 sc1 lds
  s_add_u32 m0, s38, s45
  s_nop 0
  buffer_load_dwordx4 v9, s[12:15], s37 offen offset:0  lds
  buffer_load_dwordx4 v10, s[12:15], s37 offen offset:1024  lds
  buffer_load_dwordx4 v11, s[12:15], s37 offen offset:2048  lds
  buffer_load_dwordx4 v12, s[12:15], s37 offen offset:3072  lds
  s_add_u32 s38, s38, 32768
  s_cmp_eq_u32 s38, 163840
  s_cselect_b32 s38, 0, s38
  s_mov_b32 s39, 27
ll11:
  s_waitcnt vmcnt(16)
  s_barrier
  s_add_u32 s30, s30, 1
  s_and_b32 s30, s30, 7
  s_cselect_b32 s32, 0, 1
  s_add_u32 s31, s31, s32
  s_sub_u32 s32, s30, s7
  s_and_b32 s32, s32, 7
  s_cmp_lt_u32 s32, 2
  s_cselect_b32 s32, 1, 0
  s_add_u32 s32, s32, s31
  s_cmp_ge_u32 s32, 4
  s_cselect_b32 s32, 0, s32
  s_lshl_b32 s33, s32, 3
  s_add_u32 s33, s33, s30
  s_mul_i32 s36, s33, 2048
  s_add_u32 s36, s36, s34
  s_mul_i32 s37, s33, 458752
  s_add_u32 s37, s37, s35
  s_add_u32 m0, s38, s44
  s_nop 0
  buffer_load_dwordx4 v8, s[8:11], s36 offen offset:0 sc1 lds
  buffer_load_dwordx4 v8, s[8:11], s36 offen offset:1024 sc1 lds
  buffer_load_dwordx4 v13, s[8:11], s36 offen offset:2048 sc1 lds
  buffer_load_dwordx4 v13, s[8:11], s36 offen offset:3072 sc1 lds
  s_add_u32 m0, s38, s45
  s_nop 0
  buffer_load_dwordx4 v9, s[12:15], s37 offen offset:0  lds
  buffer_load_dwordx4 v10, s[12:15], s37 offen offset:1024  lds
  buffer_load_dwordx4 v11, s[12:15], s37 offen offset:2048  lds
  buffer_load_dwordx4 v12, s[12:15], s37 offen offset:3072  lds
  s_add_u32 s38, s38, 32768
  s_cmp_eq_u32 s38, 163840
  s_cselect_b32 s38, 0, s38
  s_sub_u32 s39, s39, 1
  s_cmp_lg_u32 s39, 0
  s_cbranch_scc1 ll11
  s_waitcnt vmcnt(16)
  s_barrier
  s_waitcnt vmcnt(8)
  s_barrier
  s_waitcnt vmcnt(0)
  s_barrier
  s_lshr_b32 s32, s2, 3
  s_lshr_b32 s5, s32, 3
  s_and_b32 s6, s32, 7
  s_lshl_b32 s7, s5, 1
  s_add_u32 s7, s7, s6
  s_and_b32 s7, s7, 7
  s_and_b32 s32, s2, 7
  s_lshr_b32 s28, s32, 2
  s_lshl_b32 s28, s28, 2
  s_add_u32 s28, s28, s5
  s_and_b32 s29, s32, 3
  s_mul_i32 s29, s29, 8
  s_add_u32 s29, s29, s6
  s_mov_b32 s30, 7
  s_mov_b32 s31, -1
  s_mov_b32 s41, s57
  s_lshl_b32 s45, s41, 11
  s_mul_i32 s32, s41, 16
  s_add_u32 s32, s32, 0
  v_lshrrev_b32 v2, 3, v0
  v_add_u32 v2, s32, v2
  v_bfe_u32 v3, v2, 1, 1
  v_bfe_u32 v4, v2, 3, 1
  v_lshl_or_b32 v3, v4, 1, v3
  v_lshlrev_b32 v3, 1, v3
  v_and_b32 v4, 7, v0
  v_xor_b32 v3, v3, v4
  v_lshlrev_b32 v3, 4, v3
  s_mov_b32 s32, 4096
  v_mul_lo_u32 v2, v2, s32
  v_add_u32 v9, v2, v3
  s_mul_i32 s32, s41, 16
  s_add_u32 s32, s32, 8
  v_lshrrev_b32 v2, 3, v0
  v_add_u32 v2, s32, v2
  v_bfe_u32 v3, v2, 1, 1
  v_bfe_u32 v4, v2, 3, 1
  v_lshl_or_b32 v3, v4, 1, v3
  v_lshlrev_b32 v3, 1, v3
  v_and_b32 v4, 7, v0
  v_xor_b32 v3, v3, v4
  v_lshlrev_b32 v3, 4, v3
  s_mov_b32 s32, 4096
  v_mul_lo_u32 v2, v2, s32
  v_add_u32 v10, v2, v3
  v_subrev_u32 v10, 1024, v10
  s_lshl_b32 s35, s29, 7
  s_mov_b32 s12, s76
  s_mov_b32 s13, s77
  s_mov_b32 s14, 14680064
  s_mov_b32 s15, 0x20000
  s_branch L_k4
L_k3skip:
  s_nop 7
  s_nop 7
  s_lshr_b32 s32, s2, 3
  s_lshr_b32 s5, s32, 3
  s_and_b32 s6, s32, 7
  s_lshl_b32 s7, s5, 1
  s_add_u32 s7, s7, s6
  s_and_b32 s7, s7, 7
  s_and_b32 s32, s2, 7
  s_lshr_b32 s28, s32, 2
  s_lshl_b32 s28, s28, 2
  s_add_u32 s28, s28, s5
  s_and_b32 s29, s32, 3
  s_mul_i32 s29, s29, 8
  s_add_u32 s29, s29, s6
  s_mov_b32 s30, 7
  s_mov_b32 s31, -1
  s_mov_b32 s41, s57
  s_lshl_b32 s45, s41, 11
  s_mul_i32 s32, s41, 16
  s_add_u32 s32, s32, 0
  v_lshrrev_b32 v2, 3, v0
  v_add_u32 v2, s32, v2
  v_bfe_u32 v3, v2, 1, 1
  v_bfe_u32 v4, v2, 3, 1
  v_lshl_or_b32 v3, v4, 1, v3
  v_lshlrev_b32 v3, 1, v3
  v_and_b32 v4, 7, v0
  v_xor_b32 v3, v3, v4
  v_lshlrev_b32 v3, 4, v3
  s_mov_b32 s32, 4096
  v_mul_lo_u32 v2, v2, s32
  v_add_u32 v9, v2, v3
  s_mul_i32 s32, s41, 16
  s_add_u32 s32, s32, 8
  v_lshrrev_b32 v2, 3, v0
  v_add_u32 v2, s32, v2
  v_bfe_u32 v3, v2, 1, 1
  v_bfe_u32 v4, v2, 3, 1
  v_lshl_or_b32 v3, v4, 1, v3
  v_lshlrev_b32 v3, 1, v3
  v_and_b32 v4, 7, v0
  v_xor_b32 v3, v3, v4
  v_lshlrev_b32 v3, 4, v3
  s_mov_b32 s32, 4096
  v_mul_lo_u32 v2, v2, s32
  v_add_u32 v10, v2, v3
  v_subrev_u32 v10, 1024, v10
  s_lshl_b32 s35, s29, 7
  s_mov_b32 s12, s76
  s_mov_b32 s13, s77
  s_mov_b32 s14, 14680064
  s_mov_b32 s15, 0x20000
  s_barrier
L_k4:
  s_nop 7
  s_nop 7
  s_mov_b32 s30, 7
  s_mov_b32 s31, -1
  s_mov_b32 s38, 98304
  s_add_u32 s30, s30, 1
  s_and_b32 s30, s30, 7
  s_cselect_b32 s32, 0, 1
  s_add_u32 s31, s31, s32
  s_sub_u32 s32, s30, s7
  s_and_b32 s32, s32, 7
  s_cmp_lt_u32 s32, 2
  s_cselect_b32 s32, 1, 0
  s_add_u32 s32, s32, s31
  s_cmp_ge_u32 s32, 7
  s_cselect_b32 s32, 0, s32
  s_lshl_b32 s33, s32, 3
  s_add_u32 s33, s33, s30
  s_mul_i32 s37, s33, 262144
  s_add_u32 s37, s37, s35
  s_add_u32 m0, s38, s45
  s_nop 0
  buffer_load_dwordx4 v9, s[12:15], s37 offen offset:0  lds
  buffer_load_dwordx4 v10, s[12:15], s37 offen offset:1024  lds
  s_add_u32 s38, s38, 8192
  s_cmp_eq_u32 s38, 163840
  s_cselect_b32 s38, 98304, s38
  s_add_u32 s30, s30, 1
  s_and_b32 s30, s30, 7
  s_cselect_b32 s32, 0, 1
  s_add_u32 s31, s31, s32
  s_sub_u32 s32, s30, s7
  s_and_b32 s32, s32, 7
  s_cmp_lt_u32 s32, 2
  s_cselect_b32 s32, 1, 0
  s_add_u32 s32, s32, s31
  s_cmp_ge_u32 s32, 7
  s_cselect_b32 s32, 0, s32
  s_lshl_b32 s33, s32, 3
  s_add_u32 s33, s33, s30
  s_mul_i32 s37, s33, 262144
  s_add_u32 s37, s37, s35
  s_add_u32 m0, s38, s45
  s_nop 0
  buffer_load_dwordx4 v9, s[12:15], s37 offen offset:0  lds
  buffer_load_dwordx4 v10, s[12:15], s37 offen offset:1024  lds
  s_add_u32 s38, s38, 8192
  s_cmp_eq_u32 s38, 163840
  s_cselect_b32 s38, 98304, s38
  s_add_u32 s30, s30, 1
  s_and_b32 s30, s30, 7
  s_cselect_b32 s32, 0, 1
  s_add_u32 s31, s31, s32
  s_sub_u32 s32, s30, s7
  s_and_b32 s32, s32, 7
  s_cmp_lt_u32 s32, 2
  s_cselect_b32 s32, 1, 0
  s_add_u32 s32, s32, s31
  s_cmp_ge_u32 s32, 7
  s_cselect_b32 s32, 0, s32
  s_lshl_b32 s33, s32, 3
  s_add_u32 s33, s33, s30
  s_mul_i32 s37, s33, 262144
  s_add_u32 s37, s37, s35
  s_add_u32 m0, s38, s45
  s_nop 0
  buffer_load_dwordx4 v9, s[12:15], s37 offen offset:0  lds
  buffer_load_dwordx4 v10, s[12:15], s37 offen offset:1024  lds
  s_add_u32 s38, s38, 8192
  s_cmp_eq_u32 s38, 163840
  s_cselect_b32 s38, 98304, s38
  s_add_u32 s30, s30, 1
  s_and_b32 s30, s30, 7
  s_cselect_b32 s32, 0, 1
  s_add_u32 s31, s31, s32
  s_sub_u32 s32, s30, s7
  s_and_b32 s32, s32, 7
  s_cmp_lt_u32 s32, 2
  s_cselect_b32 s32, 1, 0
  s_add_u32 s32, s32, s31
  s_cmp_ge_u32 s32, 7
  s_cselect_b32 s32, 0, s32
  s_lshl_b32 s33, s32, 3
  s_add_u32 s33, s33, s30
  s_mul_i32 s37, s33, 262144
  s_add_u32 s37, s37, s35
  s_add_u32 m0, s38, s45
  s_nop 0
  buffer_load_dwordx4 v9, s[12:15], s37 offen offset:0  lds
  buffer_load_dwordx4 v10, s[12:15], s37 offen offset:1024  lds
  s_add_u32 s38, s38, 8192
  s_cmp_eq_u32 s38, 163840
  s_cselect_b32 s38, 98304, s38
  s_add_u32 s30, s30, 1
  s_and_b32 s30, s30, 7
  s_cselect_b32 s32, 0, 1
  s_add_u32 s31, s31, s32
  s_sub_u32 s32, s30, s7
  s_and_b32 s32, s32, 7
  s_cmp_lt_u32 s32, 2
  s_cselect_b32 s32, 1, 0
  s_add_u32 s32, s32, s31
  s_cmp_ge_u32 s32, 7
  s_cselect_b32 s32, 0, s32
  s_lshl_b32 s33, s32, 3
  s_add_u32 s33, s33, s30
  s_mul_i32 s37, s33, 262144
  s_add_u32 s37, s37, s35
  s_add_u32 m0, s38, s45
  s_nop 0
  buffer_load_dwordx4 v9, s[12:15], s37 offen offset:0  lds
  buffer_load_dwordx4 v10, s[12:15], s37 offen offset:1024  lds
  s_add_u32 s38, s38, 8192
  s_cmp_eq_u32 s38, 163840
  s_cselect_b32 s38, 98304, s38
  s_add_u32 s30, s30, 1
  s_and_b32 s30, s30, 7
  s_cselect_b32 s32, 0, 1
  s_add_u32 s31, s31, s32
  s_sub_u32 s32, s30, s7
  s_and_b32 s32, s32, 7
  s_cmp_lt_u32 s32, 2
  s_cselect_b32 s32, 1, 0
  s_add_u32 s32, s32, s31
  s_cmp_ge_u32 s32, 7
  s_cselect_b32 s32, 0, s32
  s_lshl_b32 s33, s32, 3
  s_add_u32 s33, s33, s30
  s_mul_i32 s37, s33, 262144
  s_add_u32 s37, s37, s35
  s_add_u32 m0, s38, s45
  s_nop 0
  buffer_load_dwordx4 v9, s[12:15], s37 offen offset:0  lds
  buffer_load_dwordx4 v10, s[12:15], s37 offen offset:1024  lds
  s_add_u32 s38, s38, 8192
  s_cmp_eq_u32 s38, 163840
  s_cselect_b32 s38, 98304, s38
  s_barrier
  s_mov_b64 exec, 1
  buffer_store_dword v137, v136, s[24:27], s56 offen sc0 sc1
  s_mov_b64 exec, -1
  s_lshl_b32 s56, s3, 10
  s_mul_i32 s32, s29, 8
  s_add_u32 s56, s56, s32
  s_add_u32 s56, s56, s28
  s_add_u32 s56, s56, 768
  s_lshl_b32 s56, s56, 7
  s_mov_b32 s39, 50
ll12:
  s_waitcnt vmcnt(10)
  s_barrier
  s_add_u32 s30, s30, 1
  s_and_b32 s30, s30, 7
  s_cselect_b32 s32, 0, 1
  s_add_u32 s31, s31, s32
  s_sub_u32 s32, s30, s7
  s_and_b32 s32, s32, 7
  s_cmp_lt_u32 s32, 2
  s_cselect_b32 s32, 1, 0
  s_add_u32 s32, s32, s31
  s_cmp_ge_u32 s32, 7
  s_cselect_b32 s32, 0, s32
  s_lshl_b32 s33, s32, 3
  s_add_u32 s33, s33, s30
  s_mul_i32 s37, s33, 262144
  s_add_u32 s37, s37, s35
  s_add_u32 m0, s38, s45
  s_nop 0
  buffer_load_dwordx4 v9, s[12:15], s37 offen offset:0  lds
  buffer_load_dwordx4 v10, s[12:15], s37 offen offset:1024  lds
  s_add_u32 s38, s38, 8192
  s_cmp_eq_u32 s38, 163840
  s_cselect_b32 s38, 98304, s38
  s_sub_u32 s39, s39, 1
  s_cmp_lg_u32 s39, 0
  s_cbranch_scc1 ll12
  s_waitcnt vmcnt(10)
  s_barrier
  s_waitcnt vmcnt(8)
  s_barrier
  s_waitcnt vmcnt(6)
  s_barrier
  s_waitcnt vmcnt(4)
  s_barrier
  s_waitcnt vmcnt(2)
  s_barrier
  s_waitcnt vmcnt(0)
  s_barrier
  s_cmp_lg_u32 s3, 0
  s_cbranch_scc1 L_end
  s_lshr_b32 s32, s2, 3
  s_lshr_b32 s5, s32, 3
  s_and_b32 s6, s32, 7
  s_lshl_b32 s7, s5, 1
  s_add_u32 s7, s7, s6
  s_and_b32 s7, s7, 7
  s_and_b32 s32, s2, 7
  s_lshr_b32 s28, s32, 1
  s_lshl_b32 s28, s28, 2
  s_add_u32 s28, s28, s5
  s_and_b32 s29, s32, 1
  s_mul_i32 s29, s29, 8
  s_add_u32 s29, s29, s6
  s_mov_b32 s30, 7
  s_mov_b32 s31, -1
  s_mov_b32 s41, s57
  s_mul_i32 s32, s41, 16
  s_add_u32 s32, s32, 0
  v_lshrrev_b32 v2, 3, v0
  v_add_u32 v2, s32, v2
  v_bfe_u32 v3, v2, 1, 1
  v_bfe_u32 v4, v2, 3, 1
  v_lshl_or_b32 v3, v4, 1, v3
  v_lshlrev_b32 v3, 1, v3
  v_and_b32 v4, 7, v0
  v_xor_b32 v3, v3, v4
  v_lshlrev_b32 v3, 4, v3
  s_mov_b32 s32, 6144
  v_mul_lo_u32 v2, v2, s32
  v_add_u32 v13, v2, v3
  s_mul_i32 s32, s41, 16
  s_add_u32 s32, s32, 8
  v_lshrrev_b32 v2, 3, v0
  v_add_u32 v2, s32, v2
  v_bfe_u32 v3, v2, 1, 1
  v_bfe_u32 v4, v2, 3, 1
  v_lshl_or_b32 v3, v4, 1, v3
  v_lshlrev_b32 v3, 1, v3
  v_and_b32 v4, 7, v0
  v_xor_b32 v3, v3, v4
  v_lshlrev_b32 v3, 4, v3
  s_mov_b32 s32, 6144
  v_mul_lo_u32 v2, v2, s32
  v_add_u32 v14, v2, v3
  v_subrev_u32 v14, 1024, v14
  v_add_u32 v15, 2048, v13
  v_add_u32 v16, 2048, v14
  v_add_u32 v17, 4096, v13
  v_add_u32 v18, 4096, v14
  s_lshl_b32 s46, s41, 11
  s_add_u32 s46, s46, 18432
  s_add_u32 s47, s46, 8192
  s_add_u32 s48, s46, 16384
  s_lshl_b32 s35, s29, 7
  s_mov_b32 s12, s66
  s_mov_b32 s13, s67
  s_mov_b32 s14, 6291456
  s_mov_b32 s15, 0x20000
  s_mov_b32 s30, 7
  s_mov_b32 s31, -1
  s_mov_b32 s38, 0
  s_add_u32 s30, s30, 1
  s_and_b32 s30, s30, 7
  s_cselect_b32 s32, 0, 1
  s_add_u32 s31, s31, s32
  s_sub_u32 s32, s30, s7
  s_and_b32 s32, s32, 7
  s_cmp_lt_u32 s32, 2
  s_cselect_b32 s32, 1, 0
  s_add_u32 s32, s32, s31
  s_cmp_ge_u32 s32, 2
  s_cselect_b32 s32, 0, s32
  s_lshl_b32 s33, s32, 3
  s_add_u32 s33, s33, s30
  s_mul_i32 s37, s33, 393216
  s_add_u32 s37, s37, s35
  s_add_u32 m0, s38, s46
  s_nop 0
  buffer_load_dwordx4 v13, s[12:15], s37 offen offset:0  lds
  buffer_load_dwordx4 v14, s[12:15], s37 offen offset:1024  lds
  s_add_u32 m0, s38, s47
  s_nop 0
  buffer_load_dwordx4 v15, s[12:15], s37 offen offset:0  lds
  buffer_load_dwordx4 v16, s[12:15], s37 offen offset:1024  lds
  s_add_u32 m0, s38, s48
  s_nop 0
  buffer_load_dwordx4 v17, s[12:15], s37 offen offset:0  lds
  buffer_load_dwordx4 v18, s[12:15], s37 offen offset:1024  lds
  s_add_u32 s38, s38, 43008
  s_cmp_eq_u32 s38, 129024
  s_cselect_b32 s38, 0, s38
  s_add_u32 s30, s30, 1
  s_and_b32 s30, s30, 7
  s_cselect_b32 s32, 0, 1
  s_add_u32 s31, s31, s32
  s_sub_u32 s32, s30, s7
  s_and_b32 s32, s32, 7
  s_cmp_lt_u32 s32, 2
  s_cselect_b32 s32, 1, 0
  s_add_u32 s32, s32, s31
  s_cmp_ge_u32 s32, 2
  s_cselect_b32 s32, 0, s32
  s_lshl_b32 s33, s32, 3
  s_add_u32 s33, s33, s30
  s_mul_i32 s37, s33, 393216
  s_add_u32 s37, s37, s35
  s_add_u32 m0, s38, s46
  s_nop 0
  buffer_load_dwordx4 v13, s[12:15], s37 offen offset:0  lds
  buffer_load_dwordx4 v14, s[12:15], s37 offen offset:1024  lds
  s_add_u32 m0, s38, s47
  s_nop 0
  buffer_load_dwordx4 v15, s[12:15], s37 offen offset:0  lds
  buffer_load_dwordx4 v16, s[12:15], s37 offen offset:1024  lds
  s_add_u32 m0, s38, s48
  s_nop 0
  buffer_load_dwordx4 v17, s[12:15], s37 offen offset:0  lds
  buffer_load_dwordx4 v18, s[12:15], s37 offen offset:1024  lds
  s_add_u32 s38, s38, 43008
  s_cmp_eq_u32 s38, 129024
  s_cselect_b32 s38, 0, s38
  s_lshl_b32 s40, s28, 7
  s_sub_u32 s40, s40, 16
  s_lshl_b32 s32, s41, 5
  s_add_u32 s32, s32, 16
  v_lshrrev_b32 v2, 3, v0
  v_add_u32 v2, s32, v2
  v_bfe_u32 v3, v2, 1, 3
  v_and_b32 v4, 7, v0
  v_xor_b32 v3, v3, v4
  v_lshlrev_b32 v3, 4, v3
  v_add_u32 v2, s40, v2
  v_max_i32 v2, 0, v2
  v_lshlrev_b32 v2, 11, v2
  v_add_u32 v8, v2, v3
  v_add_u32 v10, 30720, v8
  s_lshl_b32 s32, s41, 5
  s_add_u32 s32, s32, 24
  v_lshrrev_b32 v2, 3, v0
  v_add_u32 v2, s32, v2
  v_bfe_u32 v3, v2, 1, 3
  v_and_b32 v4, 7, v0
  v_xor_b32 v3, v3, v4
  v_lshlrev_b32 v3, 4, v3
  v_add_u32 v2, s40, v2
  v_max_i32 v2, 0, v2
  v_lshlrev_b32 v2, 11, v2
  v_add_u32 v9, v2, v3
  v_subrev_u32 v9, 1024, v9
  v_add_u32 v11, 30720, v9
  s_lshl_b32 s32, s41, 3
  v_lshrrev_b32 v2, 3, v0
  v_add_u32 v2, s32, v2
  v_bfe_u32 v3, v2, 1, 3
  v_and_b32 v4, 7, v0
  v_xor_b32 v3, v3, v4
  v_lshlrev_b32 v3, 4, v3
  v_add_u32 v2, s40, v2
  v_max_i32 v2, 0, v2
  v_lshlrev_b32 v2, 11, v2
  v_add_u32 v12, v2, v3
  s_lshl_b32 s44, s41, 12
  s_add_u32 s44, s44, 2048
  s_lshl_b32 s45, s41, 10
  s_mov_b32 s34, 0
  s_cmp_eq_u32 s41, 0
  s_cselect_b32 s52, 0xffffff00, -1
  s_mov_b32 s53, -1
  v_mov_b32 v20, 0x3f803f80
  v_mov_b32 v21, v20
  v_mov_b32 v22, v20
  v_mov_b32 v23, v20
  v_lshlrev_b32 v24, 4, v0
  v_add_u32 v25, 86016, v24
  s_mov_b64 exec, 0xff
  ds_write_b128 v24, v[20:23]
  ds_write_b128 v24, v[20:23] offset:43008
  ds_write_b128 v25, v[20:23]
  s_mov_b64 exec, -1
  s_add_u32 s8, s84, 25165824
  s_addc_u32 s9, s85, 0
  s_mov_b32 s10, 4194304
  s_mov_b32 s11, 0x20000
  s_add_u32 s20, s84, 55574528
  s_addc_u32 s21, s85, 0
  s_mov_b32 s22, 131072
  s_mov_b32 s23, 0x20000
  s_lshl_b32 s32, s41, 6
  v_add_u32 v26, s32, v0
  v_min_u32 v26, 143, v26
  v_add_u32 v27, s40, v26
  v_max_i32 v27, 0, v27
  v_lshlrev_b32 v27, 3, v27
  v_lshlrev_b32 v26, 3, v26
  v_add_u32 v26, 129024, v26
  s_waitcnt lgkmcnt(0)
  s_add_u32 s16, s84, 29360128
  s_addc_u32 s17, s85, 0
  s_mov_b32 s18, 262144
  s_mov_b32 s19, 0x20000
  s_lshl_b32 s32, s28, 4
  s_sub_u32 s32, s32, 8
  v_min_u32 v28, 23, v0
  v_add_u32 v28, s32, v28
  v_max_i32 v28, 0, v28
  v_lshlrev_b32 v28, 7, v28
  s_lshl_b32 s55, s3, 17
  s_add_u32 s55, s55, 98304
  s_barrier
  s_barrier
  s_mov_b64 exec, 1
  buffer_store_dword v137, v136, s[24:27], s56 offen sc0 sc1
  s_mov_b64 exec, -1
  s_mov_b32 s39, 0
poll13:
  buffer_load_dword v29, v28, s[16:19], s55 offen sc0 sc1
  s_waitcnt vmcnt(0)
  v_cmp_eq_u32 vcc, 0, v29
  s_add_u32 s39, s39, 1
  s_cmp_gt_u32 s39, 100000
  s_cbranch_scc1 poll13d
  s_cbranch_vccnz poll13
poll13d:
  s_mov_b32 s3, 1
  s_add_u32 s82, s84, 33554432
  s_addc_u32 s83, s85, 0
  s_branch L_top
L_end:
mega_end:
  s_endpgm
.section .rodata,"a"
.p2align 6
.amdhsa_kernel interleave_layers__sliding_local_dilated__mixer_token_mlp__prompt_kernel
  .amdhsa_next_free_vgpr 256
  .amdhsa_next_free_sgpr 102
  .amdhsa_accum_offset 256
  .amdhsa_group_segment_fixed_size 0
  .amdhsa_kernarg_size 88
  .amdhsa_user_sgpr_count 2
  .amdhsa_user_sgpr_kernarg_segment_ptr 1
  .amdhsa_system_sgpr_workgroup_id_x 1
.end_amdhsa_kernel
```

```asm
; @launch grid=(256,1,1) block=(512,1,1) lds=163840
.amdgcn_target "amdgcn-amd-amdhsa--gfx950"
.text
.globl interleave_layers__sliding_local_dilated__mixer_token_mlp__prompt_kernel
.type interleave_layers__sliding_local_dilated__mixer_token_mlp__prompt_kernel,@function
.p2align 8
interleave_layers__sliding_local_dilated__mixer_token_mlp__prompt_kernel:
  s_cmp_ge_u32 s2, 256
  s_cbranch_scc1 mega_end
  s_load_dwordx16 s[64:79], s[0:1], 0
  s_load_dwordx2 s[80:81], s[0:1], 64
  s_load_dwordx2 s[84:85], s[0:1], 80
  s_load_dwordx2 s[62:63], s[0:1], 72
  v_lshrrev_b32 v1, 6, v0
  v_and_b32 v0, 63, v0
  v_readfirstlane_b32 s4, v1
  s_mov_b32 s3, 0
  v_mov_b32 v130, 0
  v_mov_b32 v131, 0
  v_mov_b32 v220, 0
  v_mov_b32 v134, 0
  s_cmp_ge_u32 s4, 4
  s_cbranch_scc1 L_start
  s_lshr_b32 s32, s2, 3
  s_lshr_b32 s5, s32, 3
  s_and_b32 s6, s32, 7
  s_lshl_b32 s7, s5, 1
  s_add_u32 s7, s7, s6
  s_and_b32 s7, s7, 7
  s_and_b32 s32, s2, 7
  s_lshr_b32 s28, s32, 1
  s_lshl_b32 s28, s28, 2
  s_add_u32 s28, s28, s5
  s_and_b32 s29, s32, 1
  s_mul_i32 s29, s29, 8
  s_add_u32 s29, s29, s6
  s_mov_b32 s30, 7
  s_mov_b32 s31, -1
  v_and_b32 v4, 15, v0
  v_lshrrev_b32 v5, 4, v0
  v_lshrrev_b32 v6, 2, v4
  v_and_b32 v7, 3, v0
  v_lshrrev_b32 v3, 5, v0
  v_and_b32 v2, 1, v5
  v_lshl_or_b32 v3, v2, 1, v3
  v_lshl_add_u32 v21, v5, 3, v6
  v_lshlrev_b32 v21, 7, v21
  v_lshl_add_u32 v21, v7, 3, v21
  v_lshrrev_b32 v22, 1, v6
  v_lshl_or_b32 v22, v2, 1, v22
  v_lshl_add_u32 v21, v22, 5, v21
  v_add_u32 v21, 18432, v21
  v_xor_b32 v8, 0, v21
  s_lshl_b32 s32, s4, 5
  v_xor_b32 v8, s32, v8
  v_lshrrev_b32 v21, 1, v4
  v_xor_b32 v21, v21, v5
  v_lshlrev_b32 v21, 4, v21
  v_lshlrev_b32 v22, 7, v4
  v_add_u32 v9, v21, v22
  v_xor_b32 v10, 64, v9
  v_and_b32 v21, 1, v4
  v_mul_u32_u24 v21, 28800, v21
  v_lshrrev_b32 v22, 1, v4
  v_mul_u32_u24 v22, 400, v22
  v_lshlrev_b32 v23, 3, v5
  v_add3_u32 v11, v21, v22, v23
  s_add_u32 s32, s32, 43008
  v_add_u32 v11, s32, v11
  v_lshlrev_b32 v12, 3, v4
  v_add_u32 v12, 129024, v12
  v_mov_b64 v[112:113], 0
  v_mov_b64 v[114:115], 0
  v_mov_b64 v[116:117], 0
  v_mov_b64 v[118:119], 0
  v_mov_b64 v[120:121], 0
  v_mov_b64 v[122:123], 0
  v_mov_b64 v[124:125], 0
  v_mov_b64 v[126:127], 0
  v_mov_b64 v[128:129], 0
  v_mov_b64 v[130:131], 0
  v_mov_b64 v[132:133], 0
  v_mov_b64 v[134:135], 0
  v_mov_b64 v[136:137], 0
  v_mov_b64 v[138:139], 0
  v_mov_b64 v[140:141], 0
  v_mov_b64 v[142:143], 0
  v_mov_b64 v[144:145], 0
  v_mov_b64 v[146:147], 0
  v_mov_b64 v[148:149], 0
  v_mov_b64 v[150:151], 0
  v_mov_b64 v[152:153], 0
  v_mov_b64 v[154:155], 0
  v_mov_b64 v[156:157], 0
  v_mov_b64 v[158:159], 0
  v_mov_b64 v[160:161], 0
  v_mov_b64 v[162:163], 0
  v_mov_b64 v[164:165], 0
  v_mov_b64 v[166:167], 0
  v_mov_b64 v[168:169], 0
  v_mov_b64 v[170:171], 0
  v_mov_b64 v[172:173], 0
  v_mov_b64 v[174:175], 0
  v_mov_b64 v[176:177], 0
  v_mov_b64 v[178:179], 0
  v_mov_b64 v[180:181], 0
  v_mov_b64 v[182:183], 0
  v_mov_b64 v[184:185], 0
  v_mov_b64 v[186:187], 0
  v_mov_b64 v[188:189], 0
  v_mov_b64 v[190:191], 0
  v_mov_b64 v[192:193], 0
  v_mov_b64 v[194:195], 0
  v_mov_b64 v[196:197], 0
  v_mov_b64 v[198:199], 0
  v_mov_b64 v[200:201], 0
  v_mov_b64 v[202:203], 0
  v_mov_b64 v[204:205], 0
  v_mov_b64 v[206:207], 0
  v_mov_b64 v[208:209], 0
  v_mov_b64 v[210:211], 0
  v_mov_b64 v[212:213], 0
  v_mov_b64 v[214:215], 0
  v_mov_b64 v[216:217], 0
  v_mov_b64 v[218:219], 0
  s_waitcnt lgkmcnt(0)
  s_mov_b32 s82, s84
  s_mov_b32 s83, s85
  s_mov_b32 s12, s84
  s_mov_b32 s13, s85
  s_mov_b32 s14, 0
  s_mov_b32 s15, 0x20000
  s_mov_b32 s20, s66
  s_mov_b32 s21, s67
  s_mov_b32 s22, 6291456
  s_mov_b32 s23, 0x20000
  s_cmp_eq_u32 s4, 3
  s_cselect_b32 s20, s68, s20
  s_cselect_b32 s21, s69, s21
  s_cselect_b32 s22, 2097152, s22
  s_cselect_b32 s47, 0, s4
  s_lshl_b32 s47, s47, 8
  s_add_u32 s47, s47, s2
  s_lshl_b32 s47, s47, 13
  v_lshlrev_b32 v13, 7, v0
  s_barrier
  s_mov_b32 s51, s4
  s_cmp_lg_u32 s51, 0
  s_cbranch_scc1 C_wm0
  buffer_load_dword v222, v13, s[20:23], s47 offen
C_wm0:
C_top:
  s_nop 7
  s_nop 7
  s_mov_b32 s43, 0
  s_mov_b32 s39, 12
  s_barrier
  ds_read_b64_tr_b16 v[16:17], v8 offset:0
  ds_read_b64_tr_b16 v[18:19], v8 offset:512
  ds_read_b128 v[28:31], v9 offset:0
  ds_read_b64_tr_b16 v[20:21], v8 offset:8192
  ds_read_b64_tr_b16 v[22:23], v8 offset:8704
  ds_read_b64_tr_b16 v[24:25], v8 offset:16384
  ds_read_b64_tr_b16 v[26:27], v8 offset:16896
  ds_read_b128 v[32:35], v9 offset:2048
  ds_read_b128 v[36:39], v9 offset:4096
  ds_read_b128 v[40:43], v9 offset:6144
  ds_read_b128 v[44:47], v9 offset:8192
  ds_read_b128 v[48:51], v9 offset:10240
  ds_read_b128 v[52:55], v9 offset:12288
  ds_read_b128 v[56:59], v9 offset:14336
  ds_read_b128 v[60:63], v9 offset:16384
  s_add_u32 s40, s43, 43008
  s_cmp_eq_u32 s40, 129024
  s_cselect_b32 s40, 0, s40
  s_sub_u32 s42, s40, s43
  s_mov_b32 s43, s40
  s_waitcnt lgkmcnt(12)
  v_mfma_f32_16x16x32_bf16 v[112:115], v[16:19], v[28:31], v[112:115]
  ds_read_b64_tr_b16 v[64:65], v8 offset:4096
  s_waitcnt lgkmcnt(11)
  v_mfma_f32_16x16x32_bf16 v[148:151], v[20:23], v[28:31], v[148:151]
  ds_read_b64_tr_b16 v[66:67], v8 offset:4608
  s_waitcnt lgkmcnt(10)
  v_mfma_f32_16x16x32_bf16 v[184:187], v[24:27], v[28:31], v[184:187]
  ds_read_b128 v[76:79], v10 offset:0
  s_waitcnt lgkmcnt(10)
  v_mfma_f32_16x16x32_bf16 v[116:119], v[16:19], v[32:35], v[116:119]
  ds_read_b64_tr_b16 v[68:69], v8 offset:12288
  v_mfma_f32_16x16x32_bf16 v[152:155], v[20:23], v[32:35], v[152:155]
  ds_read_b64_tr_b16 v[70:71], v8 offset:12800
  v_mfma_f32_16x16x32_bf16 v[188:191], v[24:27], v[32:35], v[188:191]
  ds_read_b64_tr_b16 v[72:73], v8 offset:20480
  s_waitcnt lgkmcnt(12)
  v_mfma_f32_16x16x32_bf16 v[120:123], v[16:19], v[36:39], v[120:123]
  ds_read_b64_tr_b16 v[74:75], v8 offset:20992
  v_add_u32 v8, s42, v8
  v_mfma_f32_16x16x32_bf16 v[156:159], v[20:23], v[36:39], v[156:159]
  ds_read_b128 v[80:83], v10 offset:2048
  v_mfma_f32_16x16x32_bf16 v[192:195], v[24:27], v[36:39], v[192:195]
  ds_read_b128 v[84:87], v10 offset:4096
  s_waitcnt lgkmcnt(14)
  v_mfma_f32_16x16x32_bf16 v[124:127], v[16:19], v[40:43], v[124:127]
  ds_read_b128 v[88:91], v10 offset:6144
  v_mfma_f32_16x16x32_bf16 v[160:163], v[20:23], v[40:43], v[160:163]
  ds_read_b128 v[92:95], v10 offset:8192
  v_mfma_f32_16x16x32_bf16 v[196:199], v[24:27], v[40:43], v[196:199]
  ds_read_b128 v[96:99], v10 offset:10240
  s_waitcnt lgkmcnt(15)
  v_mfma_f32_16x16x32_bf16 v[128:131], v[16:19], v[44:47], v[128:131]
  ds_read_b128 v[100:103], v10 offset:12288
  v_mfma_f32_16x16x32_bf16 v[164:167], v[20:23], v[44:47], v[164:167]
  ds_read_b128 v[104:107], v10 offset:14336
  v_mfma_f32_16x16x32_bf16 v[200:203], v[24:27], v[44:47], v[200:203]
  ds_read_b128 v[108:111], v10 offset:16384
  v_add_u32 v9, s42, v9
  v_add_u32 v10, s42, v10
  s_waitcnt lgkmcnt(15)
  v_mfma_f32_16x16x32_bf16 v[132:135], v[16:19], v[48:51], v[132:135]
  v_mfma_f32_16x16x32_bf16 v[168:171], v[20:23], v[48:51], v[168:171]
  v_mfma_f32_16x16x32_bf16 v[204:207], v[24:27], v[48:51], v[204:207]
  s_waitcnt lgkmcnt(15)
  v_mfma_f32_16x16x32_bf16 v[136:139], v[16:19], v[52:55], v[136:139]
  v_mfma_f32_16x16x32_bf16 v[172:175], v[20:23], v[52:55], v[172:175]
  v_mfma_f32_16x16x32_bf16 v[208:211], v[24:27], v[52:55], v[208:211]
  s_waitcnt lgkmcnt(15)
  v_mfma_f32_16x16x32_bf16 v[140:143], v[16:19], v[56:59], v[140:143]
  v_mfma_f32_16x16x32_bf16 v[176:179], v[20:23], v[56:59], v[176:179]
  v_mfma_f32_16x16x32_bf16 v[212:215], v[24:27], v[56:59], v[212:215]
  s_waitcnt lgkmcnt(15)
  v_mfma_f32_16x16x32_bf16 v[144:147], v[16:19], v[60:63], v[144:147]
  v_mfma_f32_16x16x32_bf16 v[180:183], v[20:23], v[60:63], v[180:183]
  v_mfma_f32_16x16x32_bf16 v[216:219], v[24:27], v[60:63], v[216:219]
  s_waitcnt lgkmcnt(0)
  s_barrier
  s_cmp_lg_u32 s51, 1
  s_cbranch_scc1 C_wm1
  buffer_load_dword v222, v13, s[20:23], s47 offen
C_wm1:
  v_mfma_f32_16x16x32_bf16 v[112:115], v[64:67], v[76:79], v[112:115]
  ds_read_b64_tr_b16 v[16:17], v8 offset:0
  s_add_u32 s40, s43, 43008
  v_mfma_f32_16x16x32_bf16 v[148:151], v[68:71], v[76:79], v[148:151]
  ds_read_b64_tr_b16 v[18:19], v8 offset:512
  s_cmp_eq_u32 s40, 129024
  v_mfma_f32_16x16x32_bf16 v[184:187], v[72:75], v[76:79], v[184:187]
  ds_read_b128 v[28:31], v9 offset:0
  s_cselect_b32 s40, 0, s40
  v_mfma_f32_16x16x32_bf16 v[116:119], v[64:67], v[80:83], v[116:119]
  ds_read_b64_tr_b16 v[20:21], v8 offset:8192
  s_sub_u32 s42, s40, s43
  v_mfma_f32_16x16x32_bf16 v[152:155], v[68:71], v[80:83], v[152:155]
  ds_read_b64_tr_b16 v[22:23], v8 offset:8704
  s_mov_b32 s43, s40
  v_mfma_f32_16x16x32_bf16 v[188:191], v[72:75], v[80:83], v[188:191]
  ds_read_b64_tr_b16 v[24:25], v8 offset:16384
  v_mfma_f32_16x16x32_bf16 v[120:123], v[64:67], v[84:87], v[120:123]
  ds_read_b64_tr_b16 v[26:27], v8 offset:16896
  v_mfma_f32_16x16x32_bf16 v[156:159], v[68:71], v[84:87], v[156:159]
  ds_read_b128 v[32:35], v9 offset:2048
  v_mfma_f32_16x16x32_bf16 v[192:195], v[72:75], v[84:87], v[192:195]
  ds_read_b128 v[36:39], v9 offset:4096
  v_mfma_f32_16x16x32_bf16 v[124:127], v[64:67], v[88:91], v[124:127]
  ds_read_b128 v[40:43], v9 offset:6144
  v_mfma_f32_16x16x32_bf16 v[160:163], v[68:71], v[88:91], v[160:163]
  ds_read_b128 v[44:47], v9 offset:8192
  v_mfma_f32_16x16x32_bf16 v[196:199], v[72:75], v[88:91], v[196:199]
  ds_read_b128 v[48:51], v9 offset:10240
  v_mfma_f32_16x16x32_bf16 v[128:131], v[64:67], v[92:95], v[128:131]
  ds_read_b128 v[52:55], v9 offset:12288
  v_mfma_f32_16x16x32_bf16 v[164:167], v[68:71], v[92:95], v[164:167]
  ds_read_b128 v[56:59], v9 offset:14336
  v_mfma_f32_16x16x32_bf16 v[200:203], v[72:75], v[92:95], v[200:203]
  ds_read_b128 v[60:63], v9 offset:16384
  v_mfma_f32_16x16x32_bf16 v[132:135], v[64:67], v[96:99], v[132:135]
  v_mfma_f32_16x16x32_bf16 v[168:171], v[68:71], v[96:99], v[168:171]
  v_mfma_f32_16x16x32_bf16 v[204:207], v[72:75], v[96:99], v[204:207]
  v_mfma_f32_16x16x32_bf16 v[136:139], v[64:67], v[100:103], v[136:139]
  v_mfma_f32_16x16x32_bf16 v[172:175], v[68:71], v[100:103], v[172:175]
  v_mfma_f32_16x16x32_bf16 v[208:211], v[72:75], v[100:103], v[208:211]
  v_mfma_f32_16x16x32_bf16 v[140:143], v[64:67], v[104:107], v[140:143]
  v_mfma_f32_16x16x32_bf16 v[176:179], v[68:71], v[104:107], v[176:179]
  v_mfma_f32_16x16x32_bf16 v[212:215], v[72:75], v[104:107], v[212:215]
  v_mfma_f32_16x16x32_bf16 v[144:147], v[64:67], v[108:111], v[144:147]
  v_mfma_f32_16x16x32_bf16 v[180:183], v[68:71], v[108:111], v[180:183]
  v_mfma_f32_16x16x32_bf16 v[216:219], v[72:75], v[108:111], v[216:219]
  s_waitcnt lgkmcnt(12)
  v_mfma_f32_16x16x32_bf16 v[112:115], v[16:19], v[28:31], v[112:115]
  ds_read_b64_tr_b16 v[64:65], v8 offset:4096
  s_waitcnt lgkmcnt(11)
  v_mfma_f32_16x16x32_bf16 v[148:151], v[20:23], v[28:31], v[148:151]
  ds_read_b64_tr_b16 v[66:67], v8 offset:4608
  s_waitcnt lgkmcnt(10)
  v_mfma_f32_16x16x32_bf16 v[184:187], v[24:27], v[28:31], v[184:187]
  ds_read_b128 v[76:79], v10 offset:0
  s_waitcnt lgkmcnt(10)
  v_mfma_f32_16x16x32_bf16 v[116:119], v[16:19], v[32:35], v[116:119]
  ds_read_b64_tr_b16 v[68:69], v8 offset:12288
  v_mfma_f32_16x16x32_bf16 v[152:155], v[20:23], v[32:35], v[152:155]
  ds_read_b64_tr_b16 v[70:71], v8 offset:12800
  v_mfma_f32_16x16x32_bf16 v[188:191], v[24:27], v[32:35], v[188:191]
  ds_read_b64_tr_b16 v[72:73], v8 offset:20480
  s_waitcnt lgkmcnt(12)
  v_mfma_f32_16x16x32_bf16 v[120:123], v[16:19], v[36:39], v[120:123]
  ds_read_b64_tr_b16 v[74:75], v8 offset:20992
  v_add_u32 v8, s42, v8
  v_mfma_f32_16x16x32_bf16 v[156:159], v[20:23], v[36:39], v[156:159]
  ds_read_b128 v[80:83], v10 offset:2048
  v_mfma_f32_16x16x32_bf16 v[192:195], v[24:27], v[36:39], v[192:195]
  ds_read_b128 v[84:87], v10 offset:4096
  s_waitcnt lgkmcnt(14)
  v_mfma_f32_16x16x32_bf16 v[124:127], v[16:19], v[40:43], v[124:127]
  ds_read_b128 v[88:91], v10 offset:6144
  v_mfma_f32_16x16x32_bf16 v[160:163], v[20:23], v[40:43], v[160:163]
  ds_read_b128 v[92:95], v10 offset:8192
  v_mfma_f32_16x16x32_bf16 v[196:199], v[24:27], v[40:43], v[196:199]
  ds_read_b128 v[96:99], v10 offset:10240
  s_waitcnt lgkmcnt(15)
  v_mfma_f32_16x16x32_bf16 v[128:131], v[16:19], v[44:47], v[128:131]
  ds_read_b128 v[100:103], v10 offset:12288
  v_mfma_f32_16x16x32_bf16 v[164:167], v[20:23], v[44:47], v[164:167]
  ds_read_b128 v[104:107], v10 offset:14336
  v_mfma_f32_16x16x32_bf16 v[200:203], v[24:27], v[44:47], v[200:203]
  ds_read_b128 v[108:111], v10 offset:16384
  v_add_u32 v9, s42, v9
  v_add_u32 v10, s42, v10
  s_waitcnt lgkmcnt(15)
  v_mfma_f32_16x16x32_bf16 v[132:135], v[16:19], v[48:51], v[132:135]
  v_mfma_f32_16x16x32_bf16 v[168:171], v[20:23], v[48:51], v[168:171]
  v_mfma_f32_16x16x32_bf16 v[204:207], v[24:27], v[48:51], v[204:207]
  s_waitcnt lgkmcnt(15)
  v_mfma_f32_16x16x32_bf16 v[136:139], v[16:19], v[52:55], v[136:139]
  v_mfma_f32_16x16x32_bf16 v[172:175], v[20:23], v[52:55], v[172:175]
  v_mfma_f32_16x16x32_bf16 v[208:211], v[24:27], v[52:55], v[208:211]
  s_waitcnt lgkmcnt(15)
  v_mfma_f32_16x16x32_bf16 v[140:143], v[16:19], v[56:59], v[140:143]
  v_mfma_f32_16x16x32_bf16 v[176:179], v[20:23], v[56:59], v[176:179]
  v_mfma_f32_16x16x32_bf16 v[212:215], v[24:27], v[56:59], v[212:215]
  s_waitcnt lgkmcnt(15)
  v_mfma_f32_16x16x32_bf16 v[144:147], v[16:19], v[60:63], v[144:147]
  v_mfma_f32_16x16x32_bf16 v[180:183], v[20:23], v[60:63], v[180:183]
  v_mfma_f32_16x16x32_bf16 v[216:219], v[24:27], v[60:63], v[216:219]
  s_waitcnt lgkmcnt(0)
  s_barrier
  s_cmp_lg_u32 s51, 2
  s_cbranch_scc1 C_wm2
  buffer_load_dword v222, v13, s[20:23], s47 offen
C_wm2:
  v_mfma_f32_16x16x32_bf16 v[112:115], v[64:67], v[76:79], v[112:115]
  ds_read_b64_tr_b16 v[16:17], v8 offset:0
  s_add_u32 s40, s43, 43008
  v_mfma_f32_16x16x32_bf16 v[148:151], v[68:71], v[76:79], v[148:151]
  ds_read_b64_tr_b16 v[18:19], v8 offset:512
  s_cmp_eq_u32 s40, 129024
  v_mfma_f32_16x16x32_bf16 v[184:187], v[72:75], v[76:79], v[184:187]
  ds_read_b128 v[28:31], v9 offset:0
  s_cselect_b32 s40, 0, s40
  v_mfma_f32_16x16x32_bf16 v[116:119], v[64:67], v[80:83], v[116:119]
  ds_read_b64_tr_b16 v[20:21], v8 offset:8192
  s_sub_u32 s42, s40, s43
  v_mfma_f32_16x16x32_bf16 v[152:155], v[68:71], v[80:83], v[152:155]
  ds_read_b64_tr_b16 v[22:23], v8 offset:8704
  s_mov_b32 s43, s40
  v_mfma_f32_16x16x32_bf16 v[188:191], v[72:75], v[80:83], v[188:191]
  ds_read_b64_tr_b16 v[24:25], v8 offset:16384
  v_mfma_f32_16x16x32_bf16 v[120:123], v[64:67], v[84:87], v[120:123]
  ds_read_b64_tr_b16 v[26:27], v8 offset:16896
  v_mfma_f32_16x16x32_bf16 v[156:159], v[68:71], v[84:87], v[156:159]
  ds_read_b128 v[32:35], v9 offset:2048
  v_mfma_f32_16x16x32_bf16 v[192:195], v[72:75], v[84:87], v[192:195]
  ds_read_b128 v[36:39], v9 offset:4096
  v_mfma_f32_16x16x32_bf16 v[124:127], v[64:67], v[88:91], v[124:127]
  ds_read_b128 v[40:43], v9 offset:6144
  v_mfma_f32_16x16x32_bf16 v[160:163], v[68:71], v[88:91], v[160:163]
  ds_read_b128 v[44:47], v9 offset:8192
  v_mfma_f32_16x16x32_bf16 v[196:199], v[72:75], v[88:91], v[196:199]
  ds_read_b128 v[48:51], v9 offset:10240
  v_mfma_f32_16x16x32_bf16 v[128:131], v[64:67], v[92:95], v[128:131]
  ds_read_b128 v[52:55], v9 offset:12288
  v_mfma_f32_16x16x32_bf16 v[164:167], v[68:71], v[92:95], v[164:167]
  ds_read_b128 v[56:59], v9 offset:14336
  v_mfma_f32_16x16x32_bf16 v[200:203], v[72:75], v[92:95], v[200:203]
  ds_read_b128 v[60:63], v9 offset:16384
  v_mfma_f32_16x16x32_bf16 v[132:135], v[64:67], v[96:99], v[132:135]
  v_mfma_f32_16x16x32_bf16 v[168:171], v[68:71], v[96:99], v[168:171]
  v_mfma_f32_16x16x32_bf16 v[204:207], v[72:75], v[96:99], v[204:207]
  v_mfma_f32_16x16x32_bf16 v[136:139], v[64:67], v[100:103], v[136:139]
  v_mfma_f32_16x16x32_bf16 v[172:175], v[68:71], v[100:103], v[172:175]
  v_mfma_f32_16x16x32_bf16 v[208:211], v[72:75], v[100:103], v[208:211]
  v_mfma_f32_16x16x32_bf16 v[140:143], v[64:67], v[104:107], v[140:143]
  v_mfma_f32_16x16x32_bf16 v[176:179], v[68:71], v[104:107], v[176:179]
  v_mfma_f32_16x16x32_bf16 v[212:215], v[72:75], v[104:107], v[212:215]
  v_mfma_f32_16x16x32_bf16 v[144:147], v[64:67], v[108:111], v[144:147]
  v_mfma_f32_16x16x32_bf16 v[180:183], v[68:71], v[108:111], v[180:183]
  v_mfma_f32_16x16x32_bf16 v[216:219], v[72:75], v[108:111], v[216:219]
  s_waitcnt lgkmcnt(12)
  v_mfma_f32_16x16x32_bf16 v[112:115], v[16:19], v[28:31], v[112:115]
  ds_read_b64_tr_b16 v[64:65], v8 offset:4096
  s_waitcnt lgkmcnt(11)
  v_mfma_f32_16x16x32_bf16 v[148:151], v[20:23], v[28:31], v[148:151]
  ds_read_b64_tr_b16 v[66:67], v8 offset:4608
  s_waitcnt lgkmcnt(10)
  v_mfma_f32_16x16x32_bf16 v[184:187], v[24:27], v[28:31], v[184:187]
  ds_read_b128 v[76:79], v10 offset:0
  s_waitcnt lgkmcnt(10)
  v_mfma_f32_16x16x32_bf16 v[116:119], v[16:19], v[32:35], v[116:119]
  ds_read_b64_tr_b16 v[68:69], v8 offset:12288
  v_mfma_f32_16x16x32_bf16 v[152:155], v[20:23], v[32:35], v[152:155]
  ds_read_b64_tr_b16 v[70:71], v8 offset:12800
  v_mfma_f32_16x16x32_bf16 v[188:191], v[24:27], v[32:35], v[188:191]
  ds_read_b64_tr_b16 v[72:73], v8 offset:20480
  s_waitcnt lgkmcnt(12)
  v_mfma_f32_16x16x32_bf16 v[120:123], v[16:19], v[36:39], v[120:123]
  ds_read_b64_tr_b16 v[74:75], v8 offset:20992
  v_add_u32 v8, s42, v8
  v_mfma_f32_16x16x32_bf16 v[156:159], v[20:23], v[36:39], v[156:159]
  ds_read_b128 v[80:83], v10 offset:2048
  v_mfma_f32_16x16x32_bf16 v[192:195], v[24:27], v[36:39], v[192:195]
  ds_read_b128 v[84:87], v10 offset:4096
  s_waitcnt lgkmcnt(14)
  v_mfma_f32_16x16x32_bf16 v[124:127], v[16:19], v[40:43], v[124:127]
  ds_read_b128 v[88:91], v10 offset:6144
  v_mfma_f32_16x16x32_bf16 v[160:163], v[20:23], v[40:43], v[160:163]
  ds_read_b128 v[92:95], v10 offset:8192
  v_mfma_f32_16x16x32_bf16 v[196:199], v[24:27], v[40:43], v[196:199]
  ds_read_b128 v[96:99], v10 offset:10240
  s_waitcnt lgkmcnt(15)
  v_mfma_f32_16x16x32_bf16 v[128:131], v[16:19], v[44:47], v[128:131]
  ds_read_b128 v[100:103], v10 offset:12288
  v_mfma_f32_16x16x32_bf16 v[164:167], v[20:23], v[44:47], v[164:167]
  ds_read_b128 v[104:107], v10 offset:14336
  v_mfma_f32_16x16x32_bf16 v[200:203], v[24:27], v[44:47], v[200:203]
  ds_read_b128 v[108:111], v10 offset:16384
  v_add_u32 v9, s42, v9
  v_add_u32 v10, s42, v10
  s_waitcnt lgkmcnt(15)
  v_mfma_f32_16x16x32_bf16 v[132:135], v[16:19], v[48:51], v[132:135]
  v_mfma_f32_16x16x32_bf16 v[168:171], v[20:23], v[48:51], v[168:171]
  v_mfma_f32_16x16x32_bf16 v[204:207], v[24:27], v[48:51], v[204:207]
  s_waitcnt lgkmcnt(15)
  v_mfma_f32_16x16x32_bf16 v[136:139], v[16:19], v[52:55], v[136:139]
  v_mfma_f32_16x16x32_bf16 v[172:175], v[20:23], v[52:55], v[172:175]
  v_mfma_f32_16x16x32_bf16 v[208:211], v[24:27], v[52:55], v[208:211]
  s_waitcnt lgkmcnt(15)
  v_mfma_f32_16x16x32_bf16 v[140:143], v[16:19], v[56:59], v[140:143]
  v_mfma_f32_16x16x32_bf16 v[176:179], v[20:23], v[56:59], v[176:179]
  v_mfma_f32_16x16x32_bf16 v[212:215], v[24:27], v[56:59], v[212:215]
  s_waitcnt lgkmcnt(15)
  v_mfma_f32_16x16x32_bf16 v[144:147], v[16:19], v[60:63], v[144:147]
  v_mfma_f32_16x16x32_bf16 v[180:183], v[20:23], v[60:63], v[180:183]
  v_mfma_f32_16x16x32_bf16 v[216:219], v[24:27], v[60:63], v[216:219]
  s_waitcnt lgkmcnt(0)
  s_barrier
  s_cmp_lg_u32 s51, 3
  s_cbranch_scc1 C_wm3
  buffer_load_dword v222, v13, s[20:23], s47 offen
C_wm3:
  v_mfma_f32_16x16x32_bf16 v[112:115], v[64:67], v[76:79], v[112:115]
  ds_read_b64_tr_b16 v[16:17], v8 offset:0
  s_add_u32 s40, s43, 43008
  v_mfma_f32_16x16x32_bf16 v[148:151], v[68:71], v[76:79], v[148:151]
  ds_read_b64_tr_b16 v[18:19], v8 offset:512
  s_cmp_eq_u32 s40, 129024
  v_mfma_f32_16x16x32_bf16 v[184:187], v[72:75], v[76:79], v[184:187]
  ds_read_b128 v[28:31], v9 offset:0
  s_cselect_b32 s40, 0, s40
  v_mfma_f32_16x16x32_bf16 v[116:119], v[64:67], v[80:83], v[116:119]
  ds_read_b64_tr_b16 v[20:21], v8 offset:8192
  s_sub_u32 s42, s40, s43
  v_mfma_f32_16x16x32_bf16 v[152:155], v[68:71], v[80:83], v[152:155]
  ds_read_b64_tr_b16 v[22:23], v8 offset:8704
  s_mov_b32 s43, s40
  v_mfma_f32_16x16x32_bf16 v[188:191], v[72:75], v[80:83], v[188:191]
  ds_read_b64_tr_b16 v[24:25], v8 offset:16384
  v_mfma_f32_16x16x32_bf16 v[120:123], v[64:67], v[84:87], v[120:123]
  ds_read_b64_tr_b16 v[26:27], v8 offset:16896
  v_mfma_f32_16x16x32_bf16 v[156:159], v[68:71], v[84:87], v[156:159]
  ds_read_b128 v[32:35], v9 offset:2048
  v_mfma_f32_16x16x32_bf16 v[192:195], v[72:75], v[84:87], v[192:195]
  ds_read_b128 v[36:39], v9 offset:4096
  v_mfma_f32_16x16x32_bf16 v[124:127], v[64:67], v[88:91], v[124:127]
  ds_read_b128 v[40:43], v9 offset:6144
  v_mfma_f32_16x16x32_bf16 v[160:163], v[68:71], v[88:91], v[160:163]
  ds_read_b128 v[44:47], v9 offset:8192
  v_mfma_f32_16x16x32_bf16 v[196:199], v[72:75], v[88:91], v[196:199]
  ds_read_b128 v[48:51], v9 offset:10240
  v_mfma_f32_16x16x32_bf16 v[128:131], v[64:67], v[92:95], v[128:131]
  ds_read_b128 v[52:55], v9 offset:12288
  v_mfma_f32_16x16x32_bf16 v[164:167], v[68:71], v[92:95], v[164:167]
  ds_read_b128 v[56:59], v9 offset:14336
  v_mfma_f32_16x16x32_bf16 v[200:203], v[72:75], v[92:95], v[200:203]
  ds_read_b128 v[60:63], v9 offset:16384
  v_mfma_f32_16x16x32_bf16 v[132:135], v[64:67], v[96:99], v[132:135]
  v_mfma_f32_16x16x32_bf16 v[168:171], v[68:71], v[96:99], v[168:171]
  v_mfma_f32_16x16x32_bf16 v[204:207], v[72:75], v[96:99], v[204:207]
  v_mfma_f32_16x16x32_bf16 v[136:139], v[64:67], v[100:103], v[136:139]
  v_mfma_f32_16x16x32_bf16 v[172:175], v[68:71], v[100:103], v[172:175]
  v_mfma_f32_16x16x32_bf16 v[208:211], v[72:75], v[100:103], v[208:211]
  v_mfma_f32_16x16x32_bf16 v[140:143], v[64:67], v[104:107], v[140:143]
  v_mfma_f32_16x16x32_bf16 v[176:179], v[68:71], v[104:107], v[176:179]
  v_mfma_f32_16x16x32_bf16 v[212:215], v[72:75], v[104:107], v[212:215]
  v_mfma_f32_16x16x32_bf16 v[144:147], v[64:67], v[108:111], v[144:147]
  v_mfma_f32_16x16x32_bf16 v[180:183], v[68:71], v[108:111], v[180:183]
  v_mfma_f32_16x16x32_bf16 v[216:219], v[72:75], v[108:111], v[216:219]
cl1:
  s_waitcnt lgkmcnt(12)
  v_mfma_f32_16x16x32_bf16 v[112:115], v[16:19], v[28:31], v[112:115]
  ds_read_b64_tr_b16 v[64:65], v8 offset:4096
  s_waitcnt lgkmcnt(11)
  v_mfma_f32_16x16x32_bf16 v[148:151], v[20:23], v[28:31], v[148:151]
  ds_read_b64_tr_b16 v[66:67], v8 offset:4608
  s_waitcnt lgkmcnt(10)
  v_mfma_f32_16x16x32_bf16 v[184:187], v[24:27], v[28:31], v[184:187]
  ds_read_b128 v[76:79], v10 offset:0
  s_waitcnt lgkmcnt(10)
  v_mfma_f32_16x16x32_bf16 v[116:119], v[16:19], v[32:35], v[116:119]
  ds_read_b64_tr_b16 v[68:69], v8 offset:12288
  v_mfma_f32_16x16x32_bf16 v[152:155], v[20:23], v[32:35], v[152:155]
  ds_read_b64_tr_b16 v[70:71], v8 offset:12800
  v_mfma_f32_16x16x32_bf16 v[188:191], v[24:27], v[32:35], v[188:191]
  ds_read_b64_tr_b16 v[72:73], v8 offset:20480
  s_waitcnt lgkmcnt(12)
  v_mfma_f32_16x16x32_bf16 v[120:123], v[16:19], v[36:39], v[120:123]
  ds_read_b64_tr_b16 v[74:75], v8 offset:20992
  v_add_u32 v8, s42, v8
  v_mfma_f32_16x16x32_bf16 v[156:159], v[20:23], v[36:39], v[156:159]
  ds_read_b128 v[80:83], v10 offset:2048
  v_mfma_f32_16x16x32_bf16 v[192:195], v[24:27], v[36:39], v[192:195]
  ds_read_b128 v[84:87], v10 offset:4096
  s_waitcnt lgkmcnt(14)
  v_mfma_f32_16x16x32_bf16 v[124:127], v[16:19], v[40:43], v[124:127]
  ds_read_b128 v[88:91], v10 offset:6144
  v_mfma_f32_16x16x32_bf16 v[160:163], v[20:23], v[40:43], v[160:163]
  ds_read_b128 v[92:95], v10 offset:8192
  v_mfma_f32_16x16x32_bf16 v[196:199], v[24:27], v[40:43], v[196:199]
  ds_read_b128 v[96:99], v10 offset:10240
  s_waitcnt lgkmcnt(15)
  v_mfma_f32_16x16x32_bf16 v[128:131], v[16:19], v[44:47], v[128:131]
  ds_read_b128 v[100:103], v10 offset:12288
  v_mfma_f32_16x16x32_bf16 v[164:167], v[20:23], v[44:47], v[164:167]
  ds_read_b128 v[104:107], v10 offset:14336
  v_mfma_f32_16x16x32_bf16 v[200:203], v[24:27], v[44:47], v[200:203]
  ds_read_b128 v[108:111], v10 offset:16384
  v_add_u32 v9, s42, v9
  v_add_u32 v10, s42, v10
  s_waitcnt lgkmcnt(15)
  v_mfma_f32_16x16x32_bf16 v[132:135], v[16:19], v[48:51], v[132:135]
  v_mfma_f32_16x16x32_bf16 v[168:171], v[20:23], v[48:51], v[168:171]
  v_mfma_f32_16x16x32_bf16 v[204:207], v[24:27], v[48:51], v[204:207]
  s_waitcnt lgkmcnt(15)
  v_mfma_f32_16x16x32_bf16 v[136:139], v[16:19], v[52:55], v[136:139]
  v_mfma_f32_16x16x32_bf16 v[172:175], v[20:23], v[52:55], v[172:175]
  v_mfma_f32_16x16x32_bf16 v[208:211], v[24:27], v[52:55], v[208:211]
  s_waitcnt lgkmcnt(15)
  v_mfma_f32_16x16x32_bf16 v[140:143], v[16:19], v[56:59], v[140:143]
  v_mfma_f32_16x16x32_bf16 v[176:179], v[20:23], v[56:59], v[176:179]
  v_mfma_f32_16x16x32_bf16 v[212:215], v[24:27], v[56:59], v[212:215]
  s_waitcnt lgkmcnt(15)
  v_mfma_f32_16x16x32_bf16 v[144:147], v[16:19], v[60:63], v[144:147]
  v_mfma_f32_16x16x32_bf16 v[180:183], v[20:23], v[60:63], v[180:183]
  v_mfma_f32_16x16x32_bf16 v[216:219], v[24:27], v[60:63], v[216:219]
  s_waitcnt lgkmcnt(0)
  s_barrier
  v_mfma_f32_16x16x32_bf16 v[112:115], v[64:67], v[76:79], v[112:115]
  ds_read_b64_tr_b16 v[16:17], v8 offset:0
  s_add_u32 s40, s43, 43008
  v_mfma_f32_16x16x32_bf16 v[148:151], v[68:71], v[76:79], v[148:151]
  ds_read_b64_tr_b16 v[18:19], v8 offset:512
  s_cmp_eq_u32 s40, 129024
  v_mfma_f32_16x16x32_bf16 v[184:187], v[72:75], v[76:79], v[184:187]
  ds_read_b128 v[28:31], v9 offset:0
  s_cselect_b32 s40, 0, s40
  v_mfma_f32_16x16x32_bf16 v[116:119], v[64:67], v[80:83], v[116:119]
  ds_read_b64_tr_b16 v[20:21], v8 offset:8192
  s_sub_u32 s42, s40, s43
  v_mfma_f32_16x16x32_bf16 v[152:155], v[68:71], v[80:83], v[152:155]
  ds_read_b64_tr_b16 v[22:23], v8 offset:8704
  s_mov_b32 s43, s40
  v_mfma_f32_16x16x32_bf16 v[188:191], v[72:75], v[80:83], v[188:191]
  ds_read_b64_tr_b16 v[24:25], v8 offset:16384
  v_mfma_f32_16x16x32_bf16 v[120:123], v[64:67], v[84:87], v[120:123]
  ds_read_b64_tr_b16 v[26:27], v8 offset:16896
  v_mfma_f32_16x16x32_bf16 v[156:159], v[68:71], v[84:87], v[156:159]
  ds_read_b128 v[32:35], v9 offset:2048
  v_mfma_f32_16x16x32_bf16 v[192:195], v[72:75], v[84:87], v[192:195]
  ds_read_b128 v[36:39], v9 offset:4096
  v_mfma_f32_16x16x32_bf16 v[124:127], v[64:67], v[88:91], v[124:127]
  ds_read_b128 v[40:43], v9 offset:6144
  v_mfma_f32_16x16x32_bf16 v[160:163], v[68:71], v[88:91], v[160:163]
  ds_read_b128 v[44:47], v9 offset:8192
  v_mfma_f32_16x16x32_bf16 v[196:199], v[72:75], v[88:91], v[196:199]
  ds_read_b128 v[48:51], v9 offset:10240
  v_mfma_f32_16x16x32_bf16 v[128:131], v[64:67], v[92:95], v[128:131]
  ds_read_b128 v[52:55], v9 offset:12288
  v_mfma_f32_16x16x32_bf16 v[164:167], v[68:71], v[92:95], v[164:167]
  ds_read_b128 v[56:59], v9 offset:14336
  v_mfma_f32_16x16x32_bf16 v[200:203], v[72:75], v[92:95], v[200:203]
  ds_read_b128 v[60:63], v9 offset:16384
  v_mfma_f32_16x16x32_bf16 v[132:135], v[64:67], v[96:99], v[132:135]
  v_mfma_f32_16x16x32_bf16 v[168:171], v[68:71], v[96:99], v[168:171]
  v_mfma_f32_16x16x32_bf16 v[204:207], v[72:75], v[96:99], v[204:207]
  v_mfma_f32_16x16x32_bf16 v[136:139], v[64:67], v[100:103], v[136:139]
  v_mfma_f32_16x16x32_bf16 v[172:175], v[68:71], v[100:103], v[172:175]
  v_mfma_f32_16x16x32_bf16 v[208:211], v[72:75], v[100:103], v[208:211]
  v_mfma_f32_16x16x32_bf16 v[140:143], v[64:67], v[104:107], v[140:143]
  v_mfma_f32_16x16x32_bf16 v[176:179], v[68:71], v[104:107], v[176:179]
  v_mfma_f32_16x16x32_bf16 v[212:215], v[72:75], v[104:107], v[212:215]
  v_mfma_f32_16x16x32_bf16 v[144:147], v[64:67], v[108:111], v[144:147]
  v_mfma_f32_16x16x32_bf16 v[180:183], v[68:71], v[108:111], v[180:183]
  v_mfma_f32_16x16x32_bf16 v[216:219], v[72:75], v[108:111], v[216:219]
  s_sub_u32 s39, s39, 1
  s_cmp_lg_u32 s39, 0
  s_cbranch_scc1 cl1
  s_waitcnt lgkmcnt(12)
  v_mfma_f32_16x16x32_bf16 v[112:115], v[16:19], v[28:31], v[112:115]
  ds_read_b64_tr_b16 v[64:65], v8 offset:4096
  s_waitcnt lgkmcnt(11)
  v_mfma_f32_16x16x32_bf16 v[148:151], v[20:23], v[28:31], v[148:151]
  ds_read_b64_tr_b16 v[66:67], v8 offset:4608
  s_waitcnt lgkmcnt(10)
  v_mfma_f32_16x16x32_bf16 v[184:187], v[24:27], v[28:31], v[184:187]
  ds_read_b128 v[76:79], v10 offset:0
  s_waitcnt lgkmcnt(10)
  v_mfma_f32_16x16x32_bf16 v[116:119], v[16:19], v[32:35], v[116:119]
  ds_read_b64_tr_b16 v[68:69], v8 offset:12288
  v_mfma_f32_16x16x32_bf16 v[152:155], v[20:23], v[32:35], v[152:155]
  ds_read_b64_tr_b16 v[70:71], v8 offset:12800
  v_mfma_f32_16x16x32_bf16 v[188:191], v[24:27], v[32:35], v[188:191]
  ds_read_b64_tr_b16 v[72:73], v8 offset:20480
  s_waitcnt lgkmcnt(12)
  v_mfma_f32_16x16x32_bf16 v[120:123], v[16:19], v[36:39], v[120:123]
  ds_read_b64_tr_b16 v[74:75], v8 offset:20992
  v_mfma_f32_16x16x32_bf16 v[156:159], v[20:23], v[36:39], v[156:159]
  ds_read_b128 v[80:83], v10 offset:2048
  v_mfma_f32_16x16x32_bf16 v[192:195], v[24:27], v[36:39], v[192:195]
  ds_read_b128 v[84:87], v10 offset:4096
  s_waitcnt lgkmcnt(14)
  v_mfma_f32_16x16x32_bf16 v[124:127], v[16:19], v[40:43], v[124:127]
  ds_read_b128 v[88:91], v10 offset:6144
  v_mfma_f32_16x16x32_bf16 v[160:163], v[20:23], v[40:43], v[160:163]
  ds_read_b128 v[92:95], v10 offset:8192
  v_mfma_f32_16x16x32_bf16 v[196:199], v[24:27], v[40:43], v[196:199]
  ds_read_b128 v[96:99], v10 offset:10240
  s_waitcnt lgkmcnt(15)
  v_mfma_f32_16x16x32_bf16 v[128:131], v[16:19], v[44:47], v[128:131]
  ds_read_b128 v[100:103], v10 offset:12288
  v_mfma_f32_16x16x32_bf16 v[164:167], v[20:23], v[44:47], v[164:167]
  ds_read_b128 v[104:107], v10 offset:14336
  v_mfma_f32_16x16x32_bf16 v[200:203], v[24:27], v[44:47], v[200:203]
  ds_read_b128 v[108:111], v10 offset:16384
  s_waitcnt lgkmcnt(15)
  v_mfma_f32_16x16x32_bf16 v[132:135], v[16:19], v[48:51], v[132:135]
  ds_read_b64 v[224:225], v12 offset:0
  v_mfma_f32_16x16x32_bf16 v[168:171], v[20:23], v[48:51], v[168:171]
  ds_read_b64 v[226:227], v12 offset:128
  v_mfma_f32_16x16x32_bf16 v[204:207], v[24:27], v[48:51], v[204:207]
  ds_read_b64 v[228:229], v12 offset:256
  s_waitcnt lgkmcnt(15)
  v_mfma_f32_16x16x32_bf16 v[136:139], v[16:19], v[52:55], v[136:139]
  ds_read_b64 v[230:231], v12 offset:384
  v_mfma_f32_16x16x32_bf16 v[172:175], v[20:23], v[52:55], v[172:175]
  ds_read_b64 v[232:233], v12 offset:512
  v_mfma_f32_16x16x32_bf16 v[208:211], v[24:27], v[52:55], v[208:211]
  ds_read_b64 v[234:235], v12 offset:640
  s_waitcnt lgkmcnt(15)
  v_mfma_f32_16x16x32_bf16 v[140:143], v[16:19], v[56:59], v[140:143]
  ds_read_b64 v[236:237], v12 offset:768
  v_mfma_f32_16x16x32_bf16 v[176:179], v[20:23], v[56:59], v[176:179]
  ds_read_b64 v[238:239], v12 offset:896
  v_mfma_f32_16x16x32_bf16 v[212:215], v[24:27], v[56:59], v[212:215]
  ds_read_b64 v[240:241], v12 offset:1024
  s_waitcnt lgkmcnt(15)
  v_mfma_f32_16x16x32_bf16 v[144:147], v[16:19], v[60:63], v[144:147]
  v_mfma_f32_16x16x32_bf16 v[180:183], v[20:23], v[60:63], v[180:183]
  v_mfma_f32_16x16x32_bf16 v[216:219], v[24:27], v[60:63], v[216:219]
  s_waitcnt lgkmcnt(0)
  v_mfma_f32_16x16x32_bf16 v[112:115], v[64:67], v[76:79], v[112:115]
  v_mfma_f32_16x16x32_bf16 v[148:151], v[68:71], v[76:79], v[148:151]
  v_mfma_f32_16x16x32_bf16 v[184:187], v[72:75], v[76:79], v[184:187]
  v_mfma_f32_16x16x32_bf16 v[116:119], v[64:67], v[80:83], v[116:119]
  s_nop 4
  v_mov_b32_dpp v242, v112 row_newbcast:0 row_mask:0xf bank_mask:0xf
  v_mov_b32_dpp v243, v113 row_newbcast:0 row_mask:0xf bank_mask:0xf
  v_mov_b32_dpp v244, v114 row_newbcast:0 row_mask:0xf bank_mask:0xf
  v_mov_b32_dpp v245, v115 row_newbcast:0 row_mask:0xf bank_mask:0xf
  v_mov_b32_dpp v246, v148 row_newbcast:0 row_mask:0xf bank_mask:0xf
  v_mov_b32_dpp v247, v149 row_newbcast:0 row_mask:0xf bank_mask:0xf
  v_mov_b32_dpp v248, v150 row_newbcast:0 row_mask:0xf bank_mask:0xf
  v_mfma_f32_16x16x32_bf16 v[152:155], v[68:71], v[80:83], v[152:155]
  v_mov_b32_dpp v249, v151 row_newbcast:0 row_mask:0xf bank_mask:0xf
  v_mov_b32_dpp v250, v184 row_newbcast:0 row_mask:0xf bank_mask:0xf
  v_mov_b32_dpp v251, v185 row_newbcast:0 row_mask:0xf bank_mask:0xf
  v_mov_b32_dpp v252, v186 row_newbcast:0 row_mask:0xf bank_mask:0xf
  v_mov_b32_dpp v253, v187 row_newbcast:0 row_mask:0xf bank_mask:0xf
  v_pk_fma_f32 v[148:149], v[246:247], v[224:225], v[148:149] op_sel_hi:[1,0,1] neg_lo:[0,1,0] neg_hi:[0,1,0]
  v_pk_fma_f32 v[150:151], v[248:249], v[224:225], v[150:151] op_sel_hi:[1,0,1] neg_lo:[0,1,0] neg_hi:[0,1,0]
  v_mfma_f32_16x16x32_bf16 v[188:191], v[72:75], v[80:83], v[188:191]
  v_pk_fma_f32 v[184:185], v[250:251], v[224:225], v[184:185] op_sel_hi:[1,0,1] neg_lo:[0,1,0] neg_hi:[0,1,0]
  v_pk_fma_f32 v[186:187], v[252:253], v[224:225], v[186:187] op_sel_hi:[1,0,1] neg_lo:[0,1,0] neg_hi:[0,1,0]
  v_pk_mul_f32 v[148:149], v[148:149], v[224:225] op_sel:[0,1] op_sel_hi:[1,1]
  v_pk_mul_f32 v[150:151], v[150:151], v[224:225] op_sel:[0,1] op_sel_hi:[1,1]
  v_pk_mul_f32 v[184:185], v[184:185], v[224:225] op_sel:[0,1] op_sel_hi:[1,1]
  v_pk_mul_f32 v[186:187], v[186:187], v[224:225] op_sel:[0,1] op_sel_hi:[1,1]
  v_cvt_pk_bf16_f32 v16, v148, v149
  v_mfma_f32_16x16x32_bf16 v[120:123], v[64:67], v[84:87], v[120:123]
  v_cvt_pk_bf16_f32 v17, v150, v151
  ds_write_b64 v11, v[16:17] offset:128
  v_cvt_pk_bf16_f32 v18, v184, v185
  v_cvt_pk_bf16_f32 v19, v186, v187
  ds_write_b64 v11, v[18:19] offset:256
  v_pk_fma_f32 v[116:117], v[242:243], v[226:227], v[116:117] op_sel_hi:[1,0,1] neg_lo:[0,1,0] neg_hi:[0,1,0]
  v_pk_fma_f32 v[118:119], v[244:245], v[226:227], v[118:119] op_sel_hi:[1,0,1] neg_lo:[0,1,0] neg_hi:[0,1,0]
  v_mfma_f32_16x16x32_bf16 v[156:159], v[68:71], v[84:87], v[156:159]
  v_pk_fma_f32 v[152:153], v[246:247], v[226:227], v[152:153] op_sel_hi:[1,0,1] neg_lo:[0,1,0] neg_hi:[0,1,0]
  v_pk_fma_f32 v[154:155], v[248:249], v[226:227], v[154:155] op_sel_hi:[1,0,1] neg_lo:[0,1,0] neg_hi:[0,1,0]
  v_pk_fma_f32 v[188:189], v[250:251], v[226:227], v[188:189] op_sel_hi:[1,0,1] neg_lo:[0,1,0] neg_hi:[0,1,0]
  v_pk_fma_f32 v[190:191], v[252:253], v[226:227], v[190:191] op_sel_hi:[1,0,1] neg_lo:[0,1,0] neg_hi:[0,1,0]
  v_pk_mul_f32 v[116:117], v[116:117], v[226:227] op_sel:[0,1] op_sel_hi:[1,1]
  v_pk_mul_f32 v[118:119], v[118:119], v[226:227] op_sel:[0,1] op_sel_hi:[1,1]
  v_pk_mul_f32 v[152:153], v[152:153], v[226:227] op_sel:[0,1] op_sel_hi:[1,1]
  v_mfma_f32_16x16x32_bf16 v[192:195], v[72:75], v[84:87], v[192:195]
  v_pk_mul_f32 v[154:155], v[154:155], v[226:227] op_sel:[0,1] op_sel_hi:[1,1]
  v_pk_mul_f32 v[188:189], v[188:189], v[226:227] op_sel:[0,1] op_sel_hi:[1,1]
  v_pk_mul_f32 v[190:191], v[190:191], v[226:227] op_sel:[0,1] op_sel_hi:[1,1]
  v_cvt_pk_bf16_f32 v22, v116, v117
  v_cvt_pk_bf16_f32 v23, v118, v119
  ds_write_b64 v11, v[22:23] offset:3200
  v_cvt_pk_bf16_f32 v24, v152, v153
  v_mfma_f32_16x16x32_bf16 v[124:127], v[64:67], v[88:91], v[124:127]
  v_cvt_pk_bf16_f32 v25, v154, v155
  ds_write_b64 v11, v[24:25] offset:3328
  v_cvt_pk_bf16_f32 v26, v188, v189
  v_cvt_pk_bf16_f32 v27, v190, v191
  ds_write_b64 v11, v[26:27] offset:3456
  v_pk_fma_f32 v[120:121], v[242:243], v[228:229], v[120:121] op_sel_hi:[1,0,1] neg_lo:[0,1,0] neg_hi:[0,1,0]
  v_pk_fma_f32 v[122:123], v[244:245], v[228:229], v[122:123] op_sel_hi:[1,0,1] neg_lo:[0,1,0] neg_hi:[0,1,0]
  v_mfma_f32_16x16x32_bf16 v[160:163], v[68:71], v[88:91], v[160:163]
  v_pk_fma_f32 v[156:157], v[246:247], v[228:229], v[156:157] op_sel_hi:[1,0,1] neg_lo:[0,1,0] neg_hi:[0,1,0]
  v_pk_fma_f32 v[158:159], v[248:249], v[228:229], v[158:159] op_sel_hi:[1,0,1] neg_lo:[0,1,0] neg_hi:[0,1,0]
  v_pk_fma_f32 v[192:193], v[250:251], v[228:229], v[192:193] op_sel_hi:[1,0,1] neg_lo:[0,1,0] neg_hi:[0,1,0]
  v_pk_fma_f32 v[194:195], v[252:253], v[228:229], v[194:195] op_sel_hi:[1,0,1] neg_lo:[0,1,0] neg_hi:[0,1,0]
  v_pk_mul_f32 v[120:121], v[120:121], v[228:229] op_sel:[0,1] op_sel_hi:[1,1]
  v_pk_mul_f32 v[122:123], v[122:123], v[228:229] op_sel:[0,1] op_sel_hi:[1,1]
  v_pk_mul_f32 v[156:157], v[156:157], v[228:229] op_sel:[0,1] op_sel_hi:[1,1]
  v_mfma_f32_16x16x32_bf16 v[196:199], v[72:75], v[88:91], v[196:199]
  v_pk_mul_f32 v[158:159], v[158:159], v[228:229] op_sel:[0,1] op_sel_hi:[1,1]
  v_pk_mul_f32 v[192:193], v[192:193], v[228:229] op_sel:[0,1] op_sel_hi:[1,1]
  v_pk_mul_f32 v[194:195], v[194:195], v[228:229] op_sel:[0,1] op_sel_hi:[1,1]
  v_cvt_pk_bf16_f32 v28, v120, v121
  v_cvt_pk_bf16_f32 v29, v122, v123
  ds_write_b64 v11, v[28:29] offset:6400
  v_cvt_pk_bf16_f32 v30, v156, v157
  v_mfma_f32_16x16x32_bf16 v[128:131], v[64:67], v[92:95], v[128:131]
  v_cvt_pk_bf16_f32 v31, v158, v159
  ds_write_b64 v11, v[30:31] offset:6528
  v_cvt_pk_bf16_f32 v32, v192, v193
  v_cvt_pk_bf16_f32 v33, v194, v195
  ds_write_b64 v11, v[32:33] offset:6656
  v_pk_fma_f32 v[124:125], v[242:243], v[230:231], v[124:125] op_sel_hi:[1,0,1] neg_lo:[0,1,0] neg_hi:[0,1,0]
  v_pk_fma_f32 v[126:127], v[244:245], v[230:231], v[126:127] op_sel_hi:[1,0,1] neg_lo:[0,1,0] neg_hi:[0,1,0]
  v_mfma_f32_16x16x32_bf16 v[164:167], v[68:71], v[92:95], v[164:167]
  v_pk_fma_f32 v[160:161], v[246:247], v[230:231], v[160:161] op_sel_hi:[1,0,1] neg_lo:[0,1,0] neg_hi:[0,1,0]
  v_pk_fma_f32 v[162:163], v[248:249], v[230:231], v[162:163] op_sel_hi:[1,0,1] neg_lo:[0,1,0] neg_hi:[0,1,0]
  v_pk_fma_f32 v[196:197], v[250:251], v[230:231], v[196:197] op_sel_hi:[1,0,1] neg_lo:[0,1,0] neg_hi:[0,1,0]
  v_pk_fma_f32 v[198:199], v[252:253], v[230:231], v[198:199] op_sel_hi:[1,0,1] neg_lo:[0,1,0] neg_hi:[0,1,0]
  v_pk_mul_f32 v[124:125], v[124:125], v[230:231] op_sel:[0,1] op_sel_hi:[1,1]
  v_pk_mul_f32 v[126:127], v[126:127], v[230:231] op_sel:[0,1] op_sel_hi:[1,1]
  v_pk_mul_f32 v[160:161], v[160:161], v[230:231] op_sel:[0,1] op_sel_hi:[1,1]
  v_mfma_f32_16x16x32_bf16 v[200:203], v[72:75], v[92:95], v[200:203]
  v_pk_mul_f32 v[162:163], v[162:163], v[230:231] op_sel:[0,1] op_sel_hi:[1,1]
  v_pk_mul_f32 v[196:197], v[196:197], v[230:231] op_sel:[0,1] op_sel_hi:[1,1]
  v_pk_mul_f32 v[198:199], v[198:199], v[230:231] op_sel:[0,1] op_sel_hi:[1,1]
  v_cvt_pk_bf16_f32 v34, v124, v125
  v_cvt_pk_bf16_f32 v35, v126, v127
  ds_write_b64 v11, v[34:35] offset:9600
  v_cvt_pk_bf16_f32 v36, v160, v161
  v_mfma_f32_16x16x32_bf16 v[132:135], v[64:67], v[96:99], v[132:135]
  v_cvt_pk_bf16_f32 v37, v162, v163
  ds_write_b64 v11, v[36:37] offset:9728
  v_cvt_pk_bf16_f32 v38, v196, v197
  v_cvt_pk_bf16_f32 v39, v198, v199
  ds_write_b64 v11, v[38:39] offset:9856
  v_pk_fma_f32 v[128:129], v[242:243], v[232:233], v[128:129] op_sel_hi:[1,0,1] neg_lo:[0,1,0] neg_hi:[0,1,0]
  v_pk_fma_f32 v[130:131], v[244:245], v[232:233], v[130:131] op_sel_hi:[1,0,1] neg_lo:[0,1,0] neg_hi:[0,1,0]
  v_mfma_f32_16x16x32_bf16 v[168:171], v[68:71], v[96:99], v[168:171]
  v_pk_fma_f32 v[164:165], v[246:247], v[232:233], v[164:165] op_sel_hi:[1,0,1] neg_lo:[0,1,0] neg_hi:[0,1,0]
  v_pk_fma_f32 v[166:167], v[248:249], v[232:233], v[166:167] op_sel_hi:[1,0,1] neg_lo:[0,1,0] neg_hi:[0,1,0]
  v_pk_fma_f32 v[200:201], v[250:251], v[232:233], v[200:201] op_sel_hi:[1,0,1] neg_lo:[0,1,0] neg_hi:[0,1,0]
  v_pk_fma_f32 v[202:203], v[252:253], v[232:233], v[202:203] op_sel_hi:[1,0,1] neg_lo:[0,1,0] neg_hi:[0,1,0]
  v_pk_mul_f32 v[128:129], v[128:129], v[232:233] op_sel:[0,1] op_sel_hi:[1,1]
  v_pk_mul_f32 v[130:131], v[130:131], v[232:233] op_sel:[0,1] op_sel_hi:[1,1]
  v_pk_mul_f32 v[164:165], v[164:165], v[232:233] op_sel:[0,1] op_sel_hi:[1,1]
  v_mfma_f32_16x16x32_bf16 v[204:207], v[72:75], v[96:99], v[204:207]
  v_pk_mul_f32 v[166:167], v[166:167], v[232:233] op_sel:[0,1] op_sel_hi:[1,1]
  v_pk_mul_f32 v[200:201], v[200:201], v[232:233] op_sel:[0,1] op_sel_hi:[1,1]
  v_pk_mul_f32 v[202:203], v[202:203], v[232:233] op_sel:[0,1] op_sel_hi:[1,1]
  v_cvt_pk_bf16_f32 v40, v128, v129
  v_cvt_pk_bf16_f32 v41, v130, v131
  ds_write_b64 v11, v[40:41] offset:12800
  v_cvt_pk_bf16_f32 v42, v164, v165
  v_mfma_f32_16x16x32_bf16 v[136:139], v[64:67], v[100:103], v[136:139]
  v_cvt_pk_bf16_f32 v43, v166, v167
  ds_write_b64 v11, v[42:43] offset:12928
  v_cvt_pk_bf16_f32 v44, v200, v201
  v_cvt_pk_bf16_f32 v45, v202, v203
  ds_write_b64 v11, v[44:45] offset:13056
  v_pk_fma_f32 v[132:133], v[242:243], v[234:235], v[132:133] op_sel_hi:[1,0,1] neg_lo:[0,1,0] neg_hi:[0,1,0]
  v_pk_fma_f32 v[134:135], v[244:245], v[234:235], v[134:135] op_sel_hi:[1,0,1] neg_lo:[0,1,0] neg_hi:[0,1,0]
  v_mfma_f32_16x16x32_bf16 v[172:175], v[68:71], v[100:103], v[172:175]
  v_pk_fma_f32 v[168:169], v[246:247], v[234:235], v[168:169] op_sel_hi:[1,0,1] neg_lo:[0,1,0] neg_hi:[0,1,0]
  v_pk_fma_f32 v[170:171], v[248:249], v[234:235], v[170:171] op_sel_hi:[1,0,1] neg_lo:[0,1,0] neg_hi:[0,1,0]
  v_pk_fma_f32 v[204:205], v[250:251], v[234:235], v[204:205] op_sel_hi:[1,0,1] neg_lo:[0,1,0] neg_hi:[0,1,0]
  v_pk_fma_f32 v[206:207], v[252:253], v[234:235], v[206:207] op_sel_hi:[1,0,1] neg_lo:[0,1,0] neg_hi:[0,1,0]
  v_pk_mul_f32 v[132:133], v[132:133], v[234:235] op_sel:[0,1] op_sel_hi:[1,1]
  v_pk_mul_f32 v[134:135], v[134:135], v[234:235] op_sel:[0,1] op_sel_hi:[1,1]
  v_pk_mul_f32 v[168:169], v[168:169], v[234:235] op_sel:[0,1] op_sel_hi:[1,1]
  v_mfma_f32_16x16x32_bf16 v[208:211], v[72:75], v[100:103], v[208:211]
  v_pk_mul_f32 v[170:171], v[170:171], v[234:235] op_sel:[0,1] op_sel_hi:[1,1]
  v_pk_mul_f32 v[204:205], v[204:205], v[234:235] op_sel:[0,1] op_sel_hi:[1,1]
  v_pk_mul_f32 v[206:207], v[206:207], v[234:235] op_sel:[0,1] op_sel_hi:[1,1]
  v_cvt_pk_bf16_f32 v46, v132, v133
  v_cvt_pk_bf16_f32 v47, v134, v135
  ds_write_b64 v11, v[46:47] offset:16000
  v_cvt_pk_bf16_f32 v48, v168, v169
  v_mfma_f32_16x16x32_bf16 v[140:143], v[64:67], v[104:107], v[140:143]
  v_cvt_pk_bf16_f32 v49, v170, v171
  ds_write_b64 v11, v[48:49] offset:16128
  v_cvt_pk_bf16_f32 v50, v204, v205
  v_cvt_pk_bf16_f32 v51, v206, v207
  ds_write_b64 v11, v[50:51] offset:16256
  v_pk_fma_f32 v[136:137], v[242:243], v[236:237], v[136:137] op_sel_hi:[1,0,1] neg_lo:[0,1,0] neg_hi:[0,1,0]
  v_pk_fma_f32 v[138:139], v[244:245], v[236:237], v[138:139] op_sel_hi:[1,0,1] neg_lo:[0,1,0] neg_hi:[0,1,0]
  v_mfma_f32_16x16x32_bf16 v[176:179], v[68:71], v[104:107], v[176:179]
  v_pk_fma_f32 v[172:173], v[246:247], v[236:237], v[172:173] op_sel_hi:[1,0,1] neg_lo:[0,1,0] neg_hi:[0,1,0]
  v_pk_fma_f32 v[174:175], v[248:249], v[236:237], v[174:175] op_sel_hi:[1,0,1] neg_lo:[0,1,0] neg_hi:[0,1,0]
  v_pk_fma_f32 v[208:209], v[250:251], v[236:237], v[208:209] op_sel_hi:[1,0,1] neg_lo:[0,1,0] neg_hi:[0,1,0]
  v_pk_fma_f32 v[210:211], v[252:253], v[236:237], v[210:211] op_sel_hi:[1,0,1] neg_lo:[0,1,0] neg_hi:[0,1,0]
  v_pk_mul_f32 v[136:137], v[136:137], v[236:237] op_sel:[0,1] op_sel_hi:[1,1]
  v_pk_mul_f32 v[138:139], v[138:139], v[236:237] op_sel:[0,1] op_sel_hi:[1,1]
  v_pk_mul_f32 v[172:173], v[172:173], v[236:237] op_sel:[0,1] op_sel_hi:[1,1]
  v_mfma_f32_16x16x32_bf16 v[212:215], v[72:75], v[104:107], v[212:215]
  v_pk_mul_f32 v[174:175], v[174:175], v[236:237] op_sel:[0,1] op_sel_hi:[1,1]
  v_pk_mul_f32 v[208:209], v[208:209], v[236:237] op_sel:[0,1] op_sel_hi:[1,1]
  v_pk_mul_f32 v[210:211], v[210:211], v[236:237] op_sel:[0,1] op_sel_hi:[1,1]
  v_cvt_pk_bf16_f32 v52, v136, v137
  v_cvt_pk_bf16_f32 v53, v138, v139
  ds_write_b64 v11, v[52:53] offset:19200
  v_cvt_pk_bf16_f32 v54, v172, v173
  v_mfma_f32_16x16x32_bf16 v[144:147], v[64:67], v[108:111], v[144:147]
  v_cvt_pk_bf16_f32 v55, v174, v175
  ds_write_b64 v11, v[54:55] offset:19328
  v_cvt_pk_bf16_f32 v56, v208, v209
  v_cvt_pk_bf16_f32 v57, v210, v211
  ds_write_b64 v11, v[56:57] offset:19456
  v_pk_fma_f32 v[140:141], v[242:243], v[238:239], v[140:141] op_sel_hi:[1,0,1] neg_lo:[0,1,0] neg_hi:[0,1,0]
  v_pk_fma_f32 v[142:143], v[244:245], v[238:239], v[142:143] op_sel_hi:[1,0,1] neg_lo:[0,1,0] neg_hi:[0,1,0]
  v_mfma_f32_16x16x32_bf16 v[180:183], v[68:71], v[108:111], v[180:183]
  v_pk_fma_f32 v[176:177], v[246:247], v[238:239], v[176:177] op_sel_hi:[1,0,1] neg_lo:[0,1,0] neg_hi:[0,1,0]
  v_pk_fma_f32 v[178:179], v[248:249], v[238:239], v[178:179] op_sel_hi:[1,0,1] neg_lo:[0,1,0] neg_hi:[0,1,0]
  v_pk_fma_f32 v[212:213], v[250:251], v[238:239], v[212:213] op_sel_hi:[1,0,1] neg_lo:[0,1,0] neg_hi:[0,1,0]
  v_pk_fma_f32 v[214:215], v[252:253], v[238:239], v[214:215] op_sel_hi:[1,0,1] neg_lo:[0,1,0] neg_hi:[0,1,0]
  v_pk_mul_f32 v[140:141], v[140:141], v[238:239] op_sel:[0,1] op_sel_hi:[1,1]
  v_pk_mul_f32 v[142:143], v[142:143], v[238:239] op_sel:[0,1] op_sel_hi:[1,1]
  v_pk_mul_f32 v[176:177], v[176:177], v[238:239] op_sel:[0,1] op_sel_hi:[1,1]
  v_mfma_f32_16x16x32_bf16 v[216:219], v[72:75], v[108:111], v[216:219]
  v_pk_mul_f32 v[178:179], v[178:179], v[238:239] op_sel:[0,1] op_sel_hi:[1,1]
  v_pk_mul_f32 v[212:213], v[212:213], v[238:239] op_sel:[0,1] op_sel_hi:[1,1]
  v_pk_mul_f32 v[214:215], v[214:215], v[238:239] op_sel:[0,1] op_sel_hi:[1,1]
  v_cvt_pk_bf16_f32 v58, v140, v141
  v_cvt_pk_bf16_f32 v59, v142, v143
  ds_write_b64 v11, v[58:59] offset:22400
  v_cvt_pk_bf16_f32 v60, v176, v177
  s_barrier
  v_cvt_pk_bf16_f32 v61, v178, v179
  ds_write_b64 v11, v[60:61] offset:22528
  v_cvt_pk_bf16_f32 v62, v212, v213
  v_cvt_pk_bf16_f32 v63, v214, v215
  ds_write_b64 v11, v[62:63] offset:22656
  v_pk_fma_f32 v[144:145], v[242:243], v[240:241], v[144:145] op_sel_hi:[1,0,1] neg_lo:[0,1,0] neg_hi:[0,1,0]
  v_pk_fma_f32 v[146:147], v[244:245], v[240:241], v[146:147] op_sel_hi:[1,0,1] neg_lo:[0,1,0] neg_hi:[0,1,0]
  v_pk_fma_f32 v[180:181], v[246:247], v[240:241], v[180:181] op_sel_hi:[1,0,1] neg_lo:[0,1,0] neg_hi:[0,1,0]
  v_pk_fma_f32 v[182:183], v[248:249], v[240:241], v[182:183] op_sel_hi:[1,0,1] neg_lo:[0,1,0] neg_hi:[0,1,0]
  v_pk_fma_f32 v[216:217], v[250:251], v[240:241], v[216:217] op_sel_hi:[1,0,1] neg_lo:[0,1,0] neg_hi:[0,1,0]
  v_pk_fma_f32 v[218:219], v[252:253], v[240:241], v[218:219] op_sel_hi:[1,0,1] neg_lo:[0,1,0] neg_hi:[0,1,0]
  v_pk_mul_f32 v[144:145], v[144:145], v[240:241] op_sel:[0,1] op_sel_hi:[1,1]
  v_pk_mul_f32 v[146:147], v[146:147], v[240:241] op_sel:[0,1] op_sel_hi:[1,1]
  v_pk_mul_f32 v[180:181], v[180:181], v[240:241] op_sel:[0,1] op_sel_hi:[1,1]
  v_pk_mul_f32 v[182:183], v[182:183], v[240:241] op_sel:[0,1] op_sel_hi:[1,1]
  v_pk_mul_f32 v[216:217], v[216:217], v[240:241] op_sel:[0,1] op_sel_hi:[1,1]
  v_pk_mul_f32 v[218:219], v[218:219], v[240:241] op_sel:[0,1] op_sel_hi:[1,1]
  v_cvt_pk_bf16_f32 v16, v144, v145
  v_cvt_pk_bf16_f32 v17, v146, v147
  ds_write_b64 v11, v[16:17] offset:25600
  v_cvt_pk_bf16_f32 v18, v180, v181
  v_cvt_pk_bf16_f32 v19, v182, v183
  ds_write_b64 v11, v[18:19] offset:25728
  v_cvt_pk_bf16_f32 v20, v216, v217
  v_cvt_pk_bf16_f32 v21, v218, v219
  ds_write_b64 v11, v[20:21] offset:25856
attn:
  s_nop 7
  s_nop 7
  s_mov_b32 s20, s82
  s_mov_b32 s21, s83
  s_mov_b32 s22, 4194304
  s_mov_b32 s23, 0x20000
  s_lshr_b32 s40, s4, 1
  s_and_b32 s41, s4, 1
  s_mul_i32 s32, s41, 28800
  s_add_u32 s32, s32, 43008
  s_lshl_b32 s49, s40, 4
  v_add_u32 v16, s49, v4
  v_lshlrev_b32 v17, 4, v5
  v_add_u32 v17, s32, v17
  v_mul_u32_u24 v18, 400, v16
  v_add_u32 v8, v18, v17
  v_add_u32 v10, 3200, v8
  v_add_u32 v8, 128, v8
  v_add_u32 v16, 16, v16
  v_min_u32 v16, 71, v16
  v_mul_u32_u24 v18, 400, v16
  v_add3_u32 v9, v18, v17, 64
  v_add_u32 v9, 64, v9
  v_lshl_add_u32 v16, v5, 2, v6
  v_add_u32 v16, s49, v16
  v_lshlrev_b32 v17, 4, v7
  v_add_u32 v17, s32, v17
  v_add_u32 v17, 256, v17
  v_mul_u32_u24 v18, 400, v16
  v_add_u32 v14, v18, v17
  v_add_u32 v16, 16, v16
  v_min_u32 v16, 71, v16
  v_mul_u32_u24 v18, 400, v16
  v_add_u32 v15, v18, v17
  v_lshlrev_b32 v13, 4, v0
  s_lshl_b32 s50, s28, 2
  s_add_u32 s50, s50, s40
  s_lshl_b32 s50, s50, 16
  s_lshl_b32 s51, s29, 12
  s_add_u32 s50, s50, s51
  s_lshl_b32 s51, s41, 10
  s_add_u32 s50, s50, s51
  v_lshlrev_b32 v16, 2, v5
  v_sub_u32 v16, v16, v4
  s_or_b32 s51, s28, s40
  s_cmp_eq_u32 s51, 0
  s_cselect_b32 s51, 0, -1
  v_add_u32 v17, -1, v16
  v_cmp_gt_u32 s[86:87], 8, v17
  v_add_u32 v17, 0, v16
  v_cmp_gt_u32 s[88:89], 8, v17
  v_add_u32 v17, 1, v16
  v_cmp_gt_u32 s[90:91], 8, v17
  v_add_u32 v17, 2, v16
  v_cmp_gt_u32 s[92:93], 8, v17
  v_add_u32 v17, 15, v16
  v_cmp_gt_u32 s[94:95], 8, v17
  v_add_u32 v17, 16, v16
  v_cmp_gt_u32 s[96:97], 8, v17
  v_add_u32 v17, 17, v16
  v_cmp_gt_u32 s[98:99], 8, v17
  v_add_u32 v17, 18, v16
  v_cmp_gt_u32 s[100:101], 8, v17
  s_and_b32 s86, s86, s51
  s_and_b32 s88, s88, s51
  s_and_b32 s90, s90, s51
  s_and_b32 s92, s92, s51
  v_mov_b32 v18, 0x3e8293ee
  v_mov_b32 v19, 0xff800000
  s_waitcnt lgkmcnt(0)
  s_barrier
  ds_read_b128 v[32:35], v10 offset:0
  ds_read_b128 v[36:39], v8 offset:0
  ds_read_b128 v[40:43], v9 offset:0
  ds_read_b128 v[80:83], v10 offset:64
  ds_read_b128 v[84:87], v8 offset:64
  ds_read_b128 v[88:91], v9 offset:64
  ds_read_b64_tr_b16 v[44:45], v14 offset:0
  ds_read_b64_tr_b16 v[46:47], v15 offset:0
  ds_read_b64_tr_b16 v[48:49], v14 offset:8
  ds_read_b64_tr_b16 v[50:51], v15 offset:8
  ds_read_b64_tr_b16 v[92:93], v14 offset:64
  ds_read_b64_tr_b16 v[94:95], v15 offset:64
  ds_read_b64_tr_b16 v[96:97], v14 offset:72
  ds_read_b64_tr_b16 v[98:99], v15 offset:72
  s_waitcnt lgkmcnt(11)
  v_mfma_f32_16x16x32_bf16 v[52:55], v[36:39], v[32:35], 0
  v_mfma_f32_16x16x32_bf16 v[56:59], v[40:43], v[32:35], 0
  s_waitcnt lgkmcnt(8)
  v_mfma_f32_16x16x32_bf16 v[100:103], v[84:87], v[80:83], 0
  v_mfma_f32_16x16x32_bf16 v[104:107], v[88:91], v[80:83], 0
  s_nop 3
  v_cndmask_b32 v52, v19, v52, s[86:87]
  s_nop 1
  v_cndmask_b32 v100, v19, v100, s[86:87]
  v_cndmask_b32 v53, v19, v53, s[88:89]
  v_cndmask_b32 v101, v19, v101, s[88:89]
  v_cndmask_b32 v54, v19, v54, s[90:91]
  v_cndmask_b32 v102, v19, v102, s[90:91]
  v_cndmask_b32 v55, v19, v55, s[92:93]
  v_cndmask_b32 v103, v19, v103, s[92:93]
  v_cndmask_b32 v56, v19, v56, s[94:95]
  v_cndmask_b32 v104, v19, v104, s[94:95]
  v_cndmask_b32 v57, v19, v57, s[96:97]
  v_cndmask_b32 v105, v19, v105, s[96:97]
  v_cndmask_b32 v58, v19, v58, s[98:99]
  v_cndmask_b32 v106, v19, v106, s[98:99]
  v_cndmask_b32 v59, v19, v59, s[100:101]
  v_cndmask_b32 v107, v19, v107, s[100:101]
  v_max3_f32 v60, v52, v53, v54
  v_max3_f32 v108, v100, v101, v102
  v_max3_f32 v61, v55, v56, v57
  v_max3_f32 v109, v103, v104, v105
  v_max3_f32 v60, v60, v58, v59
  v_max3_f32 v108, v108, v106, v107
  v_max_f32 v60, v60, v61
  v_max_f32 v108, v108, v109
  v_mov_b32 v61, v60
  v_mov_b32 v109, v108
  s_nop 0
  v_permlane16_swap_b32 v60, v61
  v_permlane16_swap_b32 v108, v109
  v_max_f32 v60, v60, v61
  v_max_f32 v108, v108, v109
  v_mov_b32 v61, v60
  v_mov_b32 v109, v108
  s_nop 0
  v_permlane32_swap_b32 v60, v61
  v_permlane32_swap_b32 v108, v109
  v_max_f32 v60, v60, v61
  v_max_f32 v108, v108, v109
  v_mul_f32 v60, v18, v60
  v_mul_f32 v108, v18, v108
  v_fma_f32 v52, v52, v18, -v60
  v_fma_f32 v100, v100, v18, -v108
  v_fma_f32 v53, v53, v18, -v60
  v_fma_f32 v101, v101, v18, -v108
  v_fma_f32 v54, v54, v18, -v60
  v_fma_f32 v102, v102, v18, -v108
  v_fma_f32 v55, v55, v18, -v60
  v_fma_f32 v103, v103, v18, -v108
  v_fma_f32 v56, v56, v18, -v60
  v_fma_f32 v104, v104, v18, -v108
  v_fma_f32 v57, v57, v18, -v60
  v_fma_f32 v105, v105, v18, -v108
  v_fma_f32 v58, v58, v18, -v60
  v_fma_f32 v106, v106, v18, -v108
  v_fma_f32 v59, v59, v18, -v60
  v_fma_f32 v107, v107, v18, -v108
  v_exp_f32 v52, v52
  v_exp_f32 v100, v100
  v_exp_f32 v53, v53
  v_exp_f32 v101, v101
  v_exp_f32 v54, v54
  v_exp_f32 v102, v102
  v_exp_f32 v55, v55
  v_exp_f32 v103, v103
  v_exp_f32 v56, v56
  v_exp_f32 v104, v104
  v_exp_f32 v57, v57
  v_exp_f32 v105, v105
  v_exp_f32 v58, v58
  v_exp_f32 v106, v106
  v_exp_f32 v59, v59
  v_exp_f32 v107, v107
  v_pk_add_f32 v[60:61], v[52:53], v[54:55]
  v_pk_add_f32 v[108:109], v[100:101], v[102:103]
  v_pk_add_f32 v[62:63], v[56:57], v[58:59]
  v_pk_add_f32 v[110:111], v[104:105], v[106:107]
  v_pk_add_f32 v[60:61], v[60:61], v[62:63]
  v_pk_add_f32 v[108:109], v[108:109], v[110:111]
  v_add_f32 v60, v60, v61
  v_add_f32 v108, v108, v109
  v_mov_b32 v61, v60
  v_mov_b32 v109, v108
  s_nop 0
  v_permlane16_swap_b32 v60, v61
  v_permlane16_swap_b32 v108, v109
  v_add_f32 v60, v60, v61
  v_add_f32 v108, v108, v109
  v_mov_b32 v61, v60
  v_mov_b32 v109, v108
  s_nop 0
  v_permlane32_swap_b32 v60, v61
  v_permlane32_swap_b32 v108, v109
  v_add_f32 v60, v60, v61
  v_add_f32 v108, v108, v109
  v_rcp_f32 v60, v60
  v_rcp_f32 v108, v108
  v_pk_mul_f32 v[52:53], v[52:53], v[60:61] op_sel_hi:[1,0]
  v_pk_mul_f32 v[100:101], v[100:101], v[108:109] op_sel_hi:[1,0]
  v_pk_mul_f32 v[54:55], v[54:55], v[60:61] op_sel_hi:[1,0]
  v_pk_mul_f32 v[102:103], v[102:103], v[108:109] op_sel_hi:[1,0]
  v_pk_mul_f32 v[56:57], v[56:57], v[60:61] op_sel_hi:[1,0]
  v_pk_mul_f32 v[104:105], v[104:105], v[108:109] op_sel_hi:[1,0]
  v_pk_mul_f32 v[58:59], v[58:59], v[60:61] op_sel_hi:[1,0]
  v_pk_mul_f32 v[106:107], v[106:107], v[108:109] op_sel_hi:[1,0]
  v_cvt_pk_bf16_f32 v64, v52, v53
  v_cvt_pk_bf16_f32 v112, v100, v101
  v_cvt_pk_bf16_f32 v65, v54, v55
  v_cvt_pk_bf16_f32 v113, v102, v103
  v_cvt_pk_bf16_f32 v66, v56, v57
  v_cvt_pk_bf16_f32 v114, v104, v105
  v_cvt_pk_bf16_f32 v67, v58, v59
  v_cvt_pk_bf16_f32 v115, v106, v107
  s_waitcnt lgkmcnt(0)
  v_mfma_f32_16x16x32_bf16 v[68:71], v[44:47], v[64:67], 0
  v_mfma_f32_16x16x32_bf16 v[116:119], v[92:95], v[112:115], 0
  v_mfma_f32_16x16x32_bf16 v[72:75], v[48:51], v[64:67], 0
  v_mfma_f32_16x16x32_bf16 v[120:123], v[96:99], v[112:115], 0
  s_nop 4
  v_cvt_pk_bf16_f32 v32, v68, v69
  v_cvt_pk_bf16_f32 v80, v116, v117
  v_cvt_pk_bf16_f32 v33, v70, v71
  v_cvt_pk_bf16_f32 v81, v118, v119
  v_cvt_pk_bf16_f32 v34, v72, v73
  v_cvt_pk_bf16_f32 v82, v120, v121
  v_cvt_pk_bf16_f32 v35, v74, v75
  v_cvt_pk_bf16_f32 v83, v122, v123
  buffer_store_dwordx4 v[32:35], v13, s[20:23], s50 offen offset:0 sc0 sc1
  buffer_store_dwordx4 v[80:83], v13, s[20:23], s50 offen offset:2048 sc0 sc1
  s_cmp_ge_u32 s4, 4
  s_cbranch_scc1 L_k1done
  s_lshl_b32 s32, s28, 2
  s_add_u32 s32, s32, s4
  s_lshl_b32 s34, s32, 16
  s_lshl_b32 s40, s32, 5
  v_lshlrev_b32 v13, 1, v4
  v_add_u32 v13, s40, v13
  v_lshlrev_b32 v12, 11, v13
  v_lshl_add_u32 v12, v3, 4, v12
  s_lshl_b32 s32, s29, 7
  v_add_u32 v12, s32, v12
  v_lshlrev_b32 v14, 4, v0
  s_mov_b32 s8, s82
  s_mov_b32 s9, s83
  s_mov_b32 s10, 4194304
  s_mov_b32 s11, 0x20000
  s_cmp_eq_u32 s3, 0
  s_cselect_b32 s16, s64, s84
  s_cselect_b32 s17, s65, s85
  s_cselect_b32 s18, 0, 25165824
  s_add_u32 s16, s16, s18
  s_addc_u32 s17, s17, 0
  s_mov_b32 s18, 4194304
  s_mov_b32 s19, 0x20000
  s_cmp_eq_u32 s3, 0
  s_cselect_b32 s12, s84, s84
  s_cselect_b32 s13, s85, s85
  s_cselect_b32 s14, 0, 33554432
  s_add_u32 s12, s12, s14
  s_addc_u32 s13, s13, 0
  s_mov_b32 s14, 0
  s_mov_b32 s15, 0x20000
  s_add_u32 s12, s12, 20971520
  s_addc_u32 s13, s13, 0
  s_mov_b32 s14, 262144
  v_lshl_add_u32 v16, v5, 3, v6
  v_lshlrev_b32 v16, 7, v16
  v_lshl_add_u32 v16, v7, 3, v16
  v_lshrrev_b32 v17, 1, v6
  v_lshl_or_b32 v17, v2, 1, v17
  v_lshl_add_u32 v16, v17, 5, v16
  v_add_u32 v16, 131072, v16
  v_xor_b32 v8, 0, v16
  v_xor_b32 v9, 32, v16
  v_xor_b32 v10, 64, v16
  v_xor_b32 v11, 96, v16
  v_add_u32 v16, v13, v2
  v_lshlrev_b32 v16, 3, v16
  s_lshl_b32 s32, s29, 14
  v_add_u32 v112, s32, v16
  v_lshrrev_b32 v17, 5, v0
  v_lshlrev_b32 v17, 17, v17
  v_add_u32 v113, v16, v17
  s_lshl_b32 s32, s4, 12
  v_lshlrev_b32 v16, 8, v4
  v_lshl_add_u32 v16, v5, 3, v16
  v_add_u32 v16, s32, v16
  v_and_b32 v17, 1, v4
  v_bfe_u32 v18, v4, 2, 1
  v_lshl_or_b32 v17, v18, 1, v17
  v_lshl_add_u32 v114, v17, 5, v16
  s_lshl_b32 s44, s29, 8
  s_lshl_b32 s40, s28, 2
  s_add_u32 s44, s44, s40
  s_add_u32 s44, s44, s4
  s_lshl_b32 s44, s44, 10
  v_lshl_add_u32 v16, v5, 3, v6
  v_lshlrev_b32 v16, 7, v16
  v_lshl_add_u32 v16, v7, 3, v16
  v_lshrrev_b32 v17, 1, v6
  v_lshl_or_b32 v17, v2, 1, v17
  v_lshl_add_u32 v16, v17, 5, v16
  v_xor_b32 v115, 0, v16
  v_add_u32 v115, s32, v115
  s_add_u32 s45, s44, 65536
  s_add_u32 s46, s44, 131072
  s_add_u32 s47, s44, 196608
  s_mov_b32 s87, 16384
  s_mov_b32 s88, 32768
  s_mov_b32 s89, 49152
  s_mov_b32 s90, 65536
  s_mov_b32 s91, 81920
  s_mov_b32 s92, 98304
  s_mov_b32 s93, 114688
  s_lshl_b32 s48, 0x303, s7
  s_lshr_b32 s48, s48, 8
  s_mov_b32 s49, s34
  s_add_u32 s50, s34, 32768
  s_add_u32 s41, s34, 65536
  s_add_u32 s24, s84, 29360128
  s_addc_u32 s25, s85, 0
  s_mov_b32 s26, 262144
  s_mov_b32 s27, 0x20000
  s_lshl_b32 s32, s28, 4
  v_min_u32 v119, 15, v0
  v_add_u32 v119, s32, v119
  v_max_i32 v119, 0, v119
  v_lshlrev_b32 v119, 7, v119
  s_lshl_b32 s55, s3, 17
  s_add_u32 s55, s55, 0
  s_waitcnt vmcnt(0)
  s_barrier
  s_mov_b32 s39, 0
  s_and_b32 s32, s4, 3
  s_cmp_lg_u32 s32, 0
  s_cbranch_scc1 poll2d
  s_sleep 8
poll2:
  buffer_load_dword v16, v119, s[24:27], s55 offen sc0 sc1
  s_waitcnt vmcnt(0)
  v_cmp_eq_u32 vcc, 0, v16
  s_add_u32 s39, s39, 1
  s_cmp_gt_u32 s39, 100000
  s_cbranch_scc1 poll2d
  s_cbranch_vccnz poll2
poll2d:
  s_barrier
  buffer_load_dwordx4 v[96:99], v12, s[16:19], 0 offen offset:0 sc1
  buffer_load_dwordx4 v[100:103], v12, s[16:19], 0 offen offset:64 sc1
  buffer_load_dwordx4 v[104:107], v12, s[16:19], 0 offen offset:2048 sc1
  buffer_load_dwordx4 v[108:111], v12, s[16:19], 0 offen offset:2112 sc1
  s_bitcmp1_b32 s48, 0
  s_cselect_b32 s36, s50, s49
  s_add_u32 s36, s36, 0
  buffer_load_dwordx4 v[120:123], v14, s[8:11], s36 offen offset:0 sc1
  buffer_load_dwordx4 v[124:127], v14, s[8:11], s36 offen offset:1024 sc1
  buffer_load_dwordx4 v[128:131], v14, s[8:11], s36 offen offset:2048 sc1
  buffer_load_dwordx4 v[132:135], v14, s[8:11], s36 offen offset:3072 sc1
  s_bitcmp1_b32 s48, 1
  s_cselect_b32 s36, s50, s49
  s_add_u32 s36, s36, 4096
  buffer_load_dwordx4 v[136:139], v14, s[8:11], s36 offen offset:0 sc1
  buffer_load_dwordx4 v[140:143], v14, s[8:11], s36 offen offset:1024 sc1
  buffer_load_dwordx4 v[144:147], v14, s[8:11], s36 offen offset:2048 sc1
  buffer_load_dwordx4 v[148:151], v14, s[8:11], s36 offen offset:3072 sc1
  s_waitcnt vmcnt(8)
  v_permlane16_swap_b32 v96, v98
  v_permlane16_swap_b32 v97, v99
  v_permlane16_swap_b32 v100, v102
  v_permlane16_swap_b32 v101, v103
  v_permlane16_swap_b32 v104, v106
  v_permlane16_swap_b32 v105, v107
  v_permlane16_swap_b32 v108, v110
  v_permlane16_swap_b32 v109, v111
  v_lshlrev_b32 v48, 16, v96
  v_and_b32 v49, 0xffff0000, v96
  v_lshlrev_b32 v50, 16, v97
  v_and_b32 v51, 0xffff0000, v97
  v_lshlrev_b32 v52, 16, v98
  v_and_b32 v53, 0xffff0000, v98
  v_lshlrev_b32 v54, 16, v99
  v_and_b32 v55, 0xffff0000, v99
  v_lshlrev_b32 v56, 16, v100
  v_and_b32 v57, 0xffff0000, v100
  v_lshlrev_b32 v58, 16, v101
  v_and_b32 v59, 0xffff0000, v101
  v_lshlrev_b32 v60, 16, v102
  v_and_b32 v61, 0xffff0000, v102
  v_lshlrev_b32 v62, 16, v103
  v_and_b32 v63, 0xffff0000, v103
  v_lshlrev_b32 v64, 16, v104
  v_and_b32 v65, 0xffff0000, v104
  v_lshlrev_b32 v66, 16, v105
  v_and_b32 v67, 0xffff0000, v105
  v_lshlrev_b32 v68, 16, v106
  v_and_b32 v69, 0xffff0000, v106
  v_lshlrev_b32 v70, 16, v107
  v_and_b32 v71, 0xffff0000, v107
  v_lshlrev_b32 v72, 16, v108
  v_and_b32 v73, 0xffff0000, v108
  v_lshlrev_b32 v74, 16, v109
  v_and_b32 v75, 0xffff0000, v109
  v_lshlrev_b32 v76, 16, v110
  v_and_b32 v77, 0xffff0000, v110
  v_lshlrev_b32 v78, 16, v111
  v_and_b32 v79, 0xffff0000, v111
  s_bitcmp1_b32 s48, 2
  s_cselect_b32 s36, s50, s49
  s_add_u32 s36, s36, 8192
  buffer_load_dwordx4 v[152:155], v14, s[8:11], s36 offen offset:0 sc1
  buffer_load_dwordx4 v[156:159], v14, s[8:11], s36 offen offset:1024 sc1
  buffer_load_dwordx4 v[160:163], v14, s[8:11], s36 offen offset:2048 sc1
  buffer_load_dwordx4 v[164:167], v14, s[8:11], s36 offen offset:3072 sc1
  s_bitcmp1_b32 s48, 3
  s_cselect_b32 s36, s50, s49
  s_add_u32 s36, s36, 12288
  buffer_load_dwordx4 v[168:171], v14, s[8:11], s36 offen offset:0 sc1
  buffer_load_dwordx4 v[172:175], v14, s[8:11], s36 offen offset:1024 sc1
  s_mov_b32 s43, 0
  s_mov_b32 s39, 1
  s_barrier
  ds_read_b64_tr_b16 v[16:17], v8 offset:0
  ds_read_b64_tr_b16 v[18:19], v8 offset:512
  ds_read_b64_tr_b16 v[20:21], v9 offset:0
  ds_read_b64_tr_b16 v[22:23], v9 offset:512
  ds_read_b64_tr_b16 v[24:25], v10 offset:0
  ds_read_b64_tr_b16 v[26:27], v10 offset:512
  ds_read_b64_tr_b16 v[28:29], v11 offset:0
  ds_read_b64_tr_b16 v[30:31], v11 offset:512
  s_waitcnt vmcnt(13) lgkmcnt(6)
  v_mfma_f32_16x16x32_bf16 v[48:51], v[16:19], v[120:123], v[48:51]
  ds_read_b64_tr_b16 v[32:33], v8 offset:4096
  s_waitcnt vmcnt(12)
  v_mfma_f32_16x16x32_bf16 v[64:67], v[16:19], v[124:127], v[64:67]
  ds_read_b64_tr_b16 v[34:35], v8 offset:4608
  v_add_u32 v8, 8192, v8
  s_waitcnt lgkmcnt(6)
  v_mfma_f32_16x16x32_bf16 v[52:55], v[20:23], v[120:123], v[52:55]
  ds_read_b64_tr_b16 v[36:37], v9 offset:4096
  buffer_load_dwordx4 v[176:179], v14, s[8:11], s36 offen offset:2048 sc1
  v_mfma_f32_16x16x32_bf16 v[68:71], v[20:23], v[124:127], v[68:71]
  ds_read_b64_tr_b16 v[38:39], v9 offset:4608
  v_add_u32 v9, 8192, v9
  s_waitcnt lgkmcnt(6)
  v_mfma_f32_16x16x32_bf16 v[56:59], v[24:27], v[120:123], v[56:59]
  ds_read_b64_tr_b16 v[40:41], v10 offset:4096
  v_mfma_f32_16x16x32_bf16 v[72:75], v[24:27], v[124:127], v[72:75]
  ds_read_b64_tr_b16 v[42:43], v10 offset:4608
  v_add_u32 v10, 8192, v10
  s_waitcnt lgkmcnt(6)
  v_mfma_f32_16x16x32_bf16 v[60:63], v[28:31], v[120:123], v[60:63]
  ds_read_b64_tr_b16 v[44:45], v11 offset:4096
  buffer_load_dwordx4 v[180:183], v14, s[8:11], s36 offen offset:3072 sc1
  v_mfma_f32_16x16x32_bf16 v[76:79], v[28:31], v[124:127], v[76:79]
  ds_read_b64_tr_b16 v[46:47], v11 offset:4608
  v_add_u32 v11, 8192, v11
  s_waitcnt vmcnt(13) lgkmcnt(6)
  v_mfma_f32_16x16x32_bf16 v[48:51], v[32:35], v[128:131], v[48:51]
  ds_read_b64_tr_b16 v[16:17], v8 offset:0
  s_bitcmp1_b32 s48, 4
  s_cselect_b32 s36, s50, s49
  s_waitcnt vmcnt(12)
  v_mfma_f32_16x16x32_bf16 v[64:67], v[32:35], v[132:135], v[64:67]
  ds_read_b64_tr_b16 v[18:19], v8 offset:512
  s_add_u32 s36, s36, 16384
  s_waitcnt lgkmcnt(6)
  v_mfma_f32_16x16x32_bf16 v[52:55], v[36:39], v[128:131], v[52:55]
  ds_read_b64_tr_b16 v[20:21], v9 offset:0
  v_mfma_f32_16x16x32_bf16 v[68:71], v[36:39], v[132:135], v[68:71]
  ds_read_b64_tr_b16 v[22:23], v9 offset:512
  s_waitcnt lgkmcnt(6)
  v_mfma_f32_16x16x32_bf16 v[56:59], v[40:43], v[128:131], v[56:59]
  ds_read_b64_tr_b16 v[24:25], v10 offset:0
  buffer_load_dwordx4 v[120:123], v14, s[8:11], s36 offen offset:0 sc1
  v_mfma_f32_16x16x32_bf16 v[72:75], v[40:43], v[132:135], v[72:75]
  ds_read_b64_tr_b16 v[26:27], v10 offset:512
  s_waitcnt lgkmcnt(6)
  v_mfma_f32_16x16x32_bf16 v[60:63], v[44:47], v[128:131], v[60:63]
  ds_read_b64_tr_b16 v[28:29], v11 offset:0
  v_mfma_f32_16x16x32_bf16 v[76:79], v[44:47], v[132:135], v[76:79]
  ds_read_b64_tr_b16 v[30:31], v11 offset:512
  buffer_load_dwordx4 v[124:127], v14, s[8:11], s36 offen offset:1024 sc1
  s_waitcnt vmcnt(13) lgkmcnt(6)
  v_mfma_f32_16x16x32_bf16 v[48:51], v[16:19], v[136:139], v[48:51]
  ds_read_b64_tr_b16 v[32:33], v8 offset:4096
  s_waitcnt vmcnt(12)
  v_mfma_f32_16x16x32_bf16 v[64:67], v[16:19], v[140:143], v[64:67]
  ds_read_b64_tr_b16 v[34:35], v8 offset:4608
  v_add_u32 v8, 8192, v8
  s_waitcnt lgkmcnt(6)
  v_mfma_f32_16x16x32_bf16 v[52:55], v[20:23], v[136:139], v[52:55]
  ds_read_b64_tr_b16 v[36:37], v9 offset:4096
  buffer_load_dwordx4 v[128:131], v14, s[8:11], s36 offen offset:2048 sc1
  v_mfma_f32_16x16x32_bf16 v[68:71], v[20:23], v[140:143], v[68:71]
  ds_read_b64_tr_b16 v[38:39], v9 offset:4608
  v_add_u32 v9, 8192, v9
  s_waitcnt lgkmcnt(6)
  v_mfma_f32_16x16x32_bf16 v[56:59], v[24:27], v[136:139], v[56:59]
  ds_read_b64_tr_b16 v[40:41], v10 offset:4096
  v_mfma_f32_16x16x32_bf16 v[72:75], v[24:27], v[140:143], v[72:75]
  ds_read_b64_tr_b16 v[42:43], v10 offset:4608
  v_add_u32 v10, 8192, v10
  s_waitcnt lgkmcnt(6)
  v_mfma_f32_16x16x32_bf16 v[60:63], v[28:31], v[136:139], v[60:63]
  ds_read_b64_tr_b16 v[44:45], v11 offset:4096
  buffer_load_dwordx4 v[132:135], v14, s[8:11], s36 offen offset:3072 sc1
  v_mfma_f32_16x16x32_bf16 v[76:79], v[28:31], v[140:143], v[76:79]
  ds_read_b64_tr_b16 v[46:47], v11 offset:4608
  v_add_u32 v11, 8192, v11
  s_waitcnt vmcnt(13) lgkmcnt(6)
  v_mfma_f32_16x16x32_bf16 v[48:51], v[32:35], v[144:147], v[48:51]
  ds_read_b64_tr_b16 v[16:17], v8 offset:0
  s_bitcmp1_b32 s48, 5
  s_cselect_b32 s36, s50, s49
  s_waitcnt vmcnt(12)
  v_mfma_f32_16x16x32_bf16 v[64:67], v[32:35], v[148:151], v[64:67]
  ds_read_b64_tr_b16 v[18:19], v8 offset:512
  s_add_u32 s36, s36, 20480
  s_waitcnt lgkmcnt(6)
  v_mfma_f32_16x16x32_bf16 v[52:55], v[36:39], v[144:147], v[52:55]
  ds_read_b64_tr_b16 v[20:21], v9 offset:0
  v_mfma_f32_16x16x32_bf16 v[68:71], v[36:39], v[148:151], v[68:71]
  ds_read_b64_tr_b16 v[22:23], v9 offset:512
  s_waitcnt lgkmcnt(6)
  v_mfma_f32_16x16x32_bf16 v[56:59], v[40:43], v[144:147], v[56:59]
  ds_read_b64_tr_b16 v[24:25], v10 offset:0
  buffer_load_dwordx4 v[136:139], v14, s[8:11], s36 offen offset:0 sc1
  v_mfma_f32_16x16x32_bf16 v[72:75], v[40:43], v[148:151], v[72:75]
  ds_read_b64_tr_b16 v[26:27], v10 offset:512
  s_waitcnt lgkmcnt(6)
  v_mfma_f32_16x16x32_bf16 v[60:63], v[44:47], v[144:147], v[60:63]
  ds_read_b64_tr_b16 v[28:29], v11 offset:0
  v_mfma_f32_16x16x32_bf16 v[76:79], v[44:47], v[148:151], v[76:79]
  ds_read_b64_tr_b16 v[30:31], v11 offset:512
  buffer_load_dwordx4 v[140:143], v14, s[8:11], s36 offen offset:1024 sc1
  s_waitcnt vmcnt(13) lgkmcnt(6)
  v_mfma_f32_16x16x32_bf16 v[48:51], v[16:19], v[152:155], v[48:51]
  ds_read_b64_tr_b16 v[32:33], v8 offset:4096
  s_waitcnt vmcnt(12)
  v_mfma_f32_16x16x32_bf16 v[64:67], v[16:19], v[156:159], v[64:67]
  ds_read_b64_tr_b16 v[34:35], v8 offset:4608
  v_add_u32 v8, 8192, v8
  s_waitcnt lgkmcnt(6)
  v_mfma_f32_16x16x32_bf16 v[52:55], v[20:23], v[152:155], v[52:55]
  ds_read_b64_tr_b16 v[36:37], v9 offset:4096
  buffer_load_dwordx4 v[144:147], v14, s[8:11], s36 offen offset:2048 sc1
  v_mfma_f32_16x16x32_bf16 v[68:71], v[20:23], v[156:159], v[68:71]
  ds_read_b64_tr_b16 v[38:39], v9 offset:4608
  v_add_u32 v9, 8192, v9
  s_waitcnt lgkmcnt(6)
  v_mfma_f32_16x16x32_bf16 v[56:59], v[24:27], v[152:155], v[56:59]
  ds_read_b64_tr_b16 v[40:41], v10 offset:4096
  v_mfma_f32_16x16x32_bf16 v[72:75], v[24:27], v[156:159], v[72:75]
  ds_read_b64_tr_b16 v[42:43], v10 offset:4608
  v_add_u32 v10, 8192, v10
  s_waitcnt lgkmcnt(6)
  v_mfma_f32_16x16x32_bf16 v[60:63], v[28:31], v[152:155], v[60:63]
  ds_read_b64_tr_b16 v[44:45], v11 offset:4096
  buffer_load_dwordx4 v[148:151], v14, s[8:11], s36 offen offset:3072 sc1
  v_mfma_f32_16x16x32_bf16 v[76:79], v[28:31], v[156:159], v[76:79]
  ds_read_b64_tr_b16 v[46:47], v11 offset:4608
  v_add_u32 v11, 8192, v11
  s_waitcnt vmcnt(13) lgkmcnt(6)
  v_mfma_f32_16x16x32_bf16 v[48:51], v[32:35], v[160:163], v[48:51]
  ds_read_b64_tr_b16 v[16:17], v8 offset:0
  s_bitcmp1_b32 s48, 6
  s_cselect_b32 s36, s50, s49
  s_waitcnt vmcnt(12)
  v_mfma_f32_16x16x32_bf16 v[64:67], v[32:35], v[164:167], v[64:67]
  ds_read_b64_tr_b16 v[18:19], v8 offset:512
  s_add_u32 s36, s36, 24576
  s_waitcnt lgkmcnt(6)
  v_mfma_f32_16x16x32_bf16 v[52:55], v[36:39], v[160:163], v[52:55]
  ds_read_b64_tr_b16 v[20:21], v9 offset:0
  v_mfma_f32_16x16x32_bf16 v[68:71], v[36:39], v[164:167], v[68:71]
  ds_read_b64_tr_b16 v[22:23], v9 offset:512
  s_waitcnt lgkmcnt(6)
  v_mfma_f32_16x16x32_bf16 v[56:59], v[40:43], v[160:163], v[56:59]
  ds_read_b64_tr_b16 v[24:25], v10 offset:0
  buffer_load_dwordx4 v[152:155], v14, s[8:11], s36 offen offset:0 sc1
  v_mfma_f32_16x16x32_bf16 v[72:75], v[40:43], v[164:167], v[72:75]
  ds_read_b64_tr_b16 v[26:27], v10 offset:512
  s_waitcnt lgkmcnt(6)
  v_mfma_f32_16x16x32_bf16 v[60:63], v[44:47], v[160:163], v[60:63]
  ds_read_b64_tr_b16 v[28:29], v11 offset:0
  v_mfma_f32_16x16x32_bf16 v[76:79], v[44:47], v[164:167], v[76:79]
  ds_read_b64_tr_b16 v[30:31], v11 offset:512
  buffer_load_dwordx4 v[156:159], v14, s[8:11], s36 offen offset:1024 sc1
  s_waitcnt vmcnt(13) lgkmcnt(6)
  v_mfma_f32_16x16x32_bf16 v[48:51], v[16:19], v[168:171], v[48:51]
  ds_read_b64_tr_b16 v[32:33], v8 offset:4096
  s_waitcnt vmcnt(12)
  v_mfma_f32_16x16x32_bf16 v[64:67], v[16:19], v[172:175], v[64:67]
  ds_read_b64_tr_b16 v[34:35], v8 offset:4608
  v_add_u32 v8, 4294912256, v8
  s_waitcnt lgkmcnt(6)
  v_mfma_f32_16x16x32_bf16 v[52:55], v[20:23], v[168:171], v[52:55]
  ds_read_b64_tr_b16 v[36:37], v9 offset:4096
  buffer_load_dwordx4 v[160:163], v14, s[8:11], s36 offen offset:2048 sc1
  v_mfma_f32_16x16x32_bf16 v[68:71], v[20:23], v[172:175], v[68:71]
  ds_read_b64_tr_b16 v[38:39], v9 offset:4608
  v_add_u32 v9, 4294912256, v9
  s_waitcnt lgkmcnt(6)
  v_mfma_f32_16x16x32_bf16 v[56:59], v[24:27], v[168:171], v[56:59]
  ds_read_b64_tr_b16 v[40:41], v10 offset:4096
  v_mfma_f32_16x16x32_bf16 v[72:75], v[24:27], v[172:175], v[72:75]
  ds_read_b64_tr_b16 v[42:43], v10 offset:4608
  v_add_u32 v10, 4294912256, v10
  s_waitcnt lgkmcnt(6)
  v_mfma_f32_16x16x32_bf16 v[60:63], v[28:31], v[168:171], v[60:63]
  ds_read_b64_tr_b16 v[44:45], v11 offset:4096
  buffer_load_dwordx4 v[164:167], v14, s[8:11], s36 offen offset:3072 sc1
  v_mfma_f32_16x16x32_bf16 v[76:79], v[28:31], v[172:175], v[76:79]
  ds_read_b64_tr_b16 v[46:47], v11 offset:4608
  v_add_u32 v11, 4294912256, v11
  s_waitcnt vmcnt(13) lgkmcnt(6)
  v_mfma_f32_16x16x32_bf16 v[48:51], v[32:35], v[176:179], v[48:51]
  ds_read_b64_tr_b16 v[16:17], v8 offset:0
  s_bitcmp1_b32 s48, 7
  s_cselect_b32 s36, s50, s49
  s_waitcnt vmcnt(12)
  v_mfma_f32_16x16x32_bf16 v[64:67], v[32:35], v[180:183], v[64:67]
  ds_read_b64_tr_b16 v[18:19], v8 offset:512
  s_add_u32 s36, s36, 28672
  s_waitcnt lgkmcnt(6)
  v_mfma_f32_16x16x32_bf16 v[52:55], v[36:39], v[176:179], v[52:55]
  ds_read_b64_tr_b16 v[20:21], v9 offset:0
  v_mfma_f32_16x16x32_bf16 v[68:71], v[36:39], v[180:183], v[68:71]
  ds_read_b64_tr_b16 v[22:23], v9 offset:512
  s_waitcnt lgkmcnt(6)
  v_mfma_f32_16x16x32_bf16 v[56:59], v[40:43], v[176:179], v[56:59]
  ds_read_b64_tr_b16 v[24:25], v10 offset:0
  buffer_load_dwordx4 v[168:171], v14, s[8:11], s36 offen offset:0 sc1
  v_mfma_f32_16x16x32_bf16 v[72:75], v[40:43], v[180:183], v[72:75]
  ds_read_b64_tr_b16 v[26:27], v10 offset:512
  s_waitcnt lgkmcnt(6)
  v_mfma_f32_16x16x32_bf16 v[60:63], v[44:47], v[176:179], v[60:63]
  ds_read_b64_tr_b16 v[28:29], v11 offset:0
  v_mfma_f32_16x16x32_bf16 v[76:79], v[44:47], v[180:183], v[76:79]
  ds_read_b64_tr_b16 v[30:31], v11 offset:512
  buffer_load_dwordx4 v[172:175], v14, s[8:11], s36 offen offset:1024 sc1
  s_waitcnt vmcnt(13) lgkmcnt(6)
  v_mfma_f32_16x16x32_bf16 v[48:51], v[16:19], v[120:123], v[48:51]
  ds_read_b64_tr_b16 v[32:33], v8 offset:4096
  s_waitcnt vmcnt(12)
  v_mfma_f32_16x16x32_bf16 v[64:67], v[16:19], v[124:127], v[64:67]
  ds_read_b64_tr_b16 v[34:35], v8 offset:4608
  v_add_u32 v8, 8192, v8
  s_waitcnt lgkmcnt(6)
  v_mfma_f32_16x16x32_bf16 v[52:55], v[20:23], v[120:123], v[52:55]
  ds_read_b64_tr_b16 v[36:37], v9 offset:4096
  buffer_load_dwordx4 v[176:179], v14, s[8:11], s36 offen offset:2048 sc1
  v_mfma_f32_16x16x32_bf16 v[68:71], v[20:23], v[124:127], v[68:71]
  ds_read_b64_tr_b16 v[38:39], v9 offset:4608
  v_add_u32 v9, 8192, v9
  s_waitcnt lgkmcnt(6)
  v_mfma_f32_16x16x32_bf16 v[56:59], v[24:27], v[120:123], v[56:59]
  ds_read_b64_tr_b16 v[40:41], v10 offset:4096
  v_mfma_f32_16x16x32_bf16 v[72:75], v[24:27], v[124:127], v[72:75]
  ds_read_b64_tr_b16 v[42:43], v10 offset:4608
  v_add_u32 v10, 8192, v10
  s_waitcnt lgkmcnt(6)
  v_mfma_f32_16x16x32_bf16 v[60:63], v[28:31], v[120:123], v[60:63]
  ds_read_b64_tr_b16 v[44:45], v11 offset:4096
  buffer_load_dwordx4 v[180:183], v14, s[8:11], s36 offen offset:3072 sc1
  v_mfma_f32_16x16x32_bf16 v[76:79], v[28:31], v[124:127], v[76:79]
  ds_read_b64_tr_b16 v[46:47], v11 offset:4608
  v_add_u32 v11, 8192, v11
  s_waitcnt vmcnt(13) lgkmcnt(6)
  v_mfma_f32_16x16x32_bf16 v[48:51], v[32:35], v[128:131], v[48:51]
  ds_read_b64_tr_b16 v[16:17], v8 offset:0
  s_mov_b32 s49, s50
  s_add_u32 s50, s50, 32768
  s_waitcnt vmcnt(12)
  v_mfma_f32_16x16x32_bf16 v[64:67], v[32:35], v[132:135], v[64:67]
  ds_read_b64_tr_b16 v[18:19], v8 offset:512
  s_cmp_eq_u32 s50, s41
  s_cselect_b32 s50, s34, s50
  s_waitcnt lgkmcnt(6)
  v_mfma_f32_16x16x32_bf16 v[52:55], v[36:39], v[128:131], v[52:55]
  ds_read_b64_tr_b16 v[20:21], v9 offset:0
  s_bitcmp1_b32 s48, 0
  s_cselect_b32 s36, s50, s49
  v_mfma_f32_16x16x32_bf16 v[68:71], v[36:39], v[132:135], v[68:71]
  ds_read_b64_tr_b16 v[22:23], v9 offset:512
  s_add_u32 s36, s36, 0
  s_waitcnt lgkmcnt(6)
  v_mfma_f32_16x16x32_bf16 v[56:59], v[40:43], v[128:131], v[56:59]
  ds_read_b64_tr_b16 v[24:25], v10 offset:0
  buffer_load_dwordx4 v[120:123], v14, s[8:11], s36 offen offset:0 sc1
  v_mfma_f32_16x16x32_bf16 v[72:75], v[40:43], v[132:135], v[72:75]
  ds_read_b64_tr_b16 v[26:27], v10 offset:512
  s_waitcnt lgkmcnt(6)
  v_mfma_f32_16x16x32_bf16 v[60:63], v[44:47], v[128:131], v[60:63]
  ds_read_b64_tr_b16 v[28:29], v11 offset:0
  v_mfma_f32_16x16x32_bf16 v[76:79], v[44:47], v[132:135], v[76:79]
  ds_read_b64_tr_b16 v[30:31], v11 offset:512
  buffer_load_dwordx4 v[124:127], v14, s[8:11], s36 offen offset:1024 sc1
  s_waitcnt vmcnt(13) lgkmcnt(6)
  v_mfma_f32_16x16x32_bf16 v[48:51], v[16:19], v[136:139], v[48:51]
  ds_read_b64_tr_b16 v[32:33], v8 offset:4096
  s_waitcnt vmcnt(12)
  v_mfma_f32_16x16x32_bf16 v[64:67], v[16:19], v[140:143], v[64:67]
  ds_read_b64_tr_b16 v[34:35], v8 offset:4608
  v_add_u32 v8, 8192, v8
  s_waitcnt lgkmcnt(6)
  v_mfma_f32_16x16x32_bf16 v[52:55], v[20:23], v[136:139], v[52:55]
  ds_read_b64_tr_b16 v[36:37], v9 offset:4096
  buffer_load_dwordx4 v[128:131], v14, s[8:11], s36 offen offset:2048 sc1
  v_mfma_f32_16x16x32_bf16 v[68:71], v[20:23], v[140:143], v[68:71]
  ds_read_b64_tr_b16 v[38:39], v9 offset:4608
  v_add_u32 v9, 8192, v9
  s_waitcnt lgkmcnt(6)
  v_mfma_f32_16x16x32_bf16 v[56:59], v[24:27], v[136:139], v[56:59]
  ds_read_b64_tr_b16 v[40:41], v10 offset:4096
  v_mfma_f32_16x16x32_bf16 v[72:75], v[24:27], v[140:143], v[72:75]
  ds_read_b64_tr_b16 v[42:43], v10 offset:4608
  v_add_u32 v10, 8192, v10
  s_waitcnt lgkmcnt(6)
  v_mfma_f32_16x16x32_bf16 v[60:63], v[28:31], v[136:139], v[60:63]
  ds_read_b64_tr_b16 v[44:45], v11 offset:4096
  buffer_load_dwordx4 v[132:135], v14, s[8:11], s36 offen offset:3072 sc1
  v_mfma_f32_16x16x32_bf16 v[76:79], v[28:31], v[140:143], v[76:79]
  ds_read_b64_tr_b16 v[46:47], v11 offset:4608
  v_add_u32 v11, 8192, v11
  s_waitcnt vmcnt(13) lgkmcnt(6)
  v_mfma_f32_16x16x32_bf16 v[48:51], v[32:35], v[144:147], v[48:51]
  ds_read_b64_tr_b16 v[16:17], v8 offset:0
  s_bitcmp1_b32 s48, 1
  s_cselect_b32 s36, s50, s49
  s_waitcnt vmcnt(12)
  v_mfma_f32_16x16x32_bf16 v[64:67], v[32:35], v[148:151], v[64:67]
  ds_read_b64_tr_b16 v[18:19], v8 offset:512
  s_add_u32 s36, s36, 4096
  s_waitcnt lgkmcnt(6)
  v_mfma_f32_16x16x32_bf16 v[52:55], v[36:39], v[144:147], v[52:55]
  ds_read_b64_tr_b16 v[20:21], v9 offset:0
  v_mfma_f32_16x16x32_bf16 v[68:71], v[36:39], v[148:151], v[68:71]
  ds_read_b64_tr_b16 v[22:23], v9 offset:512
  s_waitcnt lgkmcnt(6)
  v_mfma_f32_16x16x32_bf16 v[56:59], v[40:43], v[144:147], v[56:59]
  ds_read_b64_tr_b16 v[24:25], v10 offset:0
  buffer_load_dwordx4 v[136:139], v14, s[8:11], s36 offen offset:0 sc1
  v_mfma_f32_16x16x32_bf16 v[72:75], v[40:43], v[148:151], v[72:75]
  ds_read_b64_tr_b16 v[26:27], v10 offset:512
  s_waitcnt lgkmcnt(6)
  v_mfma_f32_16x16x32_bf16 v[60:63], v[44:47], v[144:147], v[60:63]
  ds_read_b64_tr_b16 v[28:29], v11 offset:0
  v_mfma_f32_16x16x32_bf16 v[76:79], v[44:47], v[148:151], v[76:79]
  ds_read_b64_tr_b16 v[30:31], v11 offset:512
  buffer_load_dwordx4 v[140:143], v14, s[8:11], s36 offen offset:1024 sc1
  s_waitcnt vmcnt(13) lgkmcnt(6)
  v_mfma_f32_16x16x32_bf16 v[48:51], v[16:19], v[152:155], v[48:51]
  ds_read_b64_tr_b16 v[32:33], v8 offset:4096
  s_waitcnt vmcnt(12)
  v_mfma_f32_16x16x32_bf16 v[64:67], v[16:19], v[156:159], v[64:67]
  ds_read_b64_tr_b16 v[34:35], v8 offset:4608
  v_add_u32 v8, 4294850304, v8
  s_waitcnt lgkmcnt(6)
  v_mfma_f32_16x16x32_bf16 v[52:55], v[20:23], v[152:155], v[52:55]
  ds_read_b64_tr_b16 v[36:37], v9 offset:4096
  buffer_load_dwordx4 v[144:147], v14, s[8:11], s36 offen offset:2048 sc1
  v_mfma_f32_16x16x32_bf16 v[68:71], v[20:23], v[156:159], v[68:71]
  ds_read_b64_tr_b16 v[38:39], v9 offset:4608
  v_add_u32 v9, 4294850304, v9
  s_waitcnt lgkmcnt(6)
  v_mfma_f32_16x16x32_bf16 v[56:59], v[24:27], v[152:155], v[56:59]
  ds_read_b64_tr_b16 v[40:41], v10 offset:4096
  v_mfma_f32_16x16x32_bf16 v[72:75], v[24:27], v[156:159], v[72:75]
  ds_read_b64_tr_b16 v[42:43], v10 offset:4608
  v_add_u32 v10, 4294850304, v10
  s_waitcnt lgkmcnt(6)
  v_mfma_f32_16x16x32_bf16 v[60:63], v[28:31], v[152:155], v[60:63]
  ds_read_b64_tr_b16 v[44:45], v11 offset:4096
  buffer_load_dwordx4 v[148:151], v14, s[8:11], s36 offen offset:3072 sc1
  v_mfma_f32_16x16x32_bf16 v[76:79], v[28:31], v[156:159], v[76:79]
  ds_read_b64_tr_b16 v[46:47], v11 offset:4608
  v_add_u32 v11, 4294850304, v11
  s_waitcnt vmcnt(13) lgkmcnt(6)
  v_mfma_f32_16x16x32_bf16 v[48:51], v[32:35], v[160:163], v[48:51]
  ds_read_b64_tr_b16 v[16:17], v8 offset:0
  s_bitcmp1_b32 s48, 2
  s_cselect_b32 s36, s50, s49
  s_waitcnt vmcnt(12)
  v_mfma_f32_16x16x32_bf16 v[64:67], v[32:35], v[164:167], v[64:67]
  ds_read_b64_tr_b16 v[18:19], v8 offset:512
  s_add_u32 s36, s36, 8192
  s_waitcnt lgkmcnt(6)
  v_mfma_f32_16x16x32_bf16 v[52:55], v[36:39], v[160:163], v[52:55]
  ds_read_b64_tr_b16 v[20:21], v9 offset:0
  v_mfma_f32_16x16x32_bf16 v[68:71], v[36:39], v[164:167], v[68:71]
  ds_read_b64_tr_b16 v[22:23], v9 offset:512
  s_waitcnt lgkmcnt(6)
  v_mfma_f32_16x16x32_bf16 v[56:59], v[40:43], v[160:163], v[56:59]
  ds_read_b64_tr_b16 v[24:25], v10 offset:0
  buffer_load_dwordx4 v[152:155], v14, s[8:11], s36 offen offset:0 sc1
  v_mfma_f32_16x16x32_bf16 v[72:75], v[40:43], v[164:167], v[72:75]
  ds_read_b64_tr_b16 v[26:27], v10 offset:512
  s_waitcnt lgkmcnt(6)
  v_mfma_f32_16x16x32_bf16 v[60:63], v[44:47], v[160:163], v[60:63]
  ds_read_b64_tr_b16 v[28:29], v11 offset:0
  v_mfma_f32_16x16x32_bf16 v[76:79], v[44:47], v[164:167], v[76:79]
  ds_read_b64_tr_b16 v[30:31], v11 offset:512
  buffer_load_dwordx4 v[156:159], v14, s[8:11], s36 offen offset:1024 sc1
  s_waitcnt vmcnt(13) lgkmcnt(6)
  v_mfma_f32_16x16x32_bf16 v[48:51], v[16:19], v[168:171], v[48:51]
  ds_read_b64_tr_b16 v[32:33], v8 offset:4096
  s_waitcnt vmcnt(12)
  v_mfma_f32_16x16x32_bf16 v[64:67], v[16:19], v[172:175], v[64:67]
  ds_read_b64_tr_b16 v[34:35], v8 offset:4608
  v_add_u32 v8, 8192, v8
  s_waitcnt lgkmcnt(6)
  v_mfma_f32_16x16x32_bf16 v[52:55], v[20:23], v[168:171], v[52:55]
  ds_read_b64_tr_b16 v[36:37], v9 offset:4096
  buffer_load_dwordx4 v[160:163], v14, s[8:11], s36 offen offset:2048 sc1
  v_mfma_f32_16x16x32_bf16 v[68:71], v[20:23], v[172:175], v[68:71]
  ds_read_b64_tr_b16 v[38:39], v9 offset:4608
  v_add_u32 v9, 8192, v9
  s_waitcnt lgkmcnt(6)
  v_mfma_f32_16x16x32_bf16 v[56:59], v[24:27], v[168:171], v[56:59]
  ds_read_b64_tr_b16 v[40:41], v10 offset:4096
  v_mfma_f32_16x16x32_bf16 v[72:75], v[24:27], v[172:175], v[72:75]
  ds_read_b64_tr_b16 v[42:43], v10 offset:4608
  v_add_u32 v10, 8192, v10
  s_waitcnt lgkmcnt(6)
  v_mfma_f32_16x16x32_bf16 v[60:63], v[28:31], v[168:171], v[60:63]
  ds_read_b64_tr_b16 v[44:45], v11 offset:4096
  buffer_load_dwordx4 v[164:167], v14, s[8:11], s36 offen offset:3072 sc1
  v_mfma_f32_16x16x32_bf16 v[76:79], v[28:31], v[172:175], v[76:79]
  ds_read_b64_tr_b16 v[46:47], v11 offset:4608
  v_add_u32 v11, 8192, v11
  s_waitcnt vmcnt(13) lgkmcnt(6)
  v_mfma_f32_16x16x32_bf16 v[48:51], v[32:35], v[176:179], v[48:51]
  ds_read_b64_tr_b16 v[16:17], v8 offset:0
  s_bitcmp1_b32 s48, 3
  s_cselect_b32 s36, s50, s49
  s_waitcnt vmcnt(12)
  v_mfma_f32_16x16x32_bf16 v[64:67], v[32:35], v[180:183], v[64:67]
  ds_read_b64_tr_b16 v[18:19], v8 offset:512
  s_add_u32 s36, s36, 12288
  s_waitcnt lgkmcnt(6)
  v_mfma_f32_16x16x32_bf16 v[52:55], v[36:39], v[176:179], v[52:55]
  ds_read_b64_tr_b16 v[20:21], v9 offset:0
  v_mfma_f32_16x16x32_bf16 v[68:71], v[36:39], v[180:183], v[68:71]
  ds_read_b64_tr_b16 v[22:23], v9 offset:512
  s_waitcnt lgkmcnt(6)
  v_mfma_f32_16x16x32_bf16 v[56:59], v[40:43], v[176:179], v[56:59]
  ds_read_b64_tr_b16 v[24:25], v10 offset:0
  buffer_load_dwordx4 v[168:171], v14, s[8:11], s36 offen offset:0 sc1
  v_mfma_f32_16x16x32_bf16 v[72:75], v[40:43], v[180:183], v[72:75]
  ds_read_b64_tr_b16 v[26:27], v10 offset:512
  s_waitcnt lgkmcnt(6)
  v_mfma_f32_16x16x32_bf16 v[60:63], v[44:47], v[176:179], v[60:63]
  ds_read_b64_tr_b16 v[28:29], v11 offset:0
  v_mfma_f32_16x16x32_bf16 v[76:79], v[44:47], v[180:183], v[76:79]
  ds_read_b64_tr_b16 v[30:31], v11 offset:512
  buffer_load_dwordx4 v[172:175], v14, s[8:11], s36 offen offset:1024 sc1
  s_waitcnt vmcnt(13) lgkmcnt(6)
  v_mfma_f32_16x16x32_bf16 v[48:51], v[16:19], v[120:123], v[48:51]
  ds_read_b64_tr_b16 v[32:33], v8 offset:4096
  s_waitcnt vmcnt(12)
  v_mfma_f32_16x16x32_bf16 v[64:67], v[16:19], v[124:127], v[64:67]
  ds_read_b64_tr_b16 v[34:35], v8 offset:4608
  v_add_u32 v8, 8192, v8
  s_waitcnt lgkmcnt(6)
  v_mfma_f32_16x16x32_bf16 v[52:55], v[20:23], v[120:123], v[52:55]
  ds_read_b64_tr_b16 v[36:37], v9 offset:4096
  buffer_load_dwordx4 v[176:179], v14, s[8:11], s36 offen offset:2048 sc1
  v_mfma_f32_16x16x32_bf16 v[68:71], v[20:23], v[124:127], v[68:71]
  ds_read_b64_tr_b16 v[38:39], v9 offset:4608
  v_add_u32 v9, 8192, v9
  s_waitcnt lgkmcnt(6)
  v_mfma_f32_16x16x32_bf16 v[56:59], v[24:27], v[120:123], v[56:59]
  ds_read_b64_tr_b16 v[40:41], v10 offset:4096
  v_mfma_f32_16x16x32_bf16 v[72:75], v[24:27], v[124:127], v[72:75]
  ds_read_b64_tr_b16 v[42:43], v10 offset:4608
  v_add_u32 v10, 8192, v10
  s_waitcnt lgkmcnt(6)
  v_mfma_f32_16x16x32_bf16 v[60:63], v[28:31], v[120:123], v[60:63]
  ds_read_b64_tr_b16 v[44:45], v11 offset:4096
  buffer_load_dwordx4 v[180:183], v14, s[8:11], s36 offen offset:3072 sc1
  v_mfma_f32_16x16x32_bf16 v[76:79], v[28:31], v[124:127], v[76:79]
  ds_read_b64_tr_b16 v[46:47], v11 offset:4608
  v_add_u32 v11, 8192, v11
  s_waitcnt vmcnt(13) lgkmcnt(6)
  v_mfma_f32_16x16x32_bf16 v[48:51], v[32:35], v[128:131], v[48:51]
  ds_read_b64_tr_b16 v[16:17], v8 offset:0
  s_bitcmp1_b32 s48, 4
  s_cselect_b32 s36, s50, s49
  s_waitcnt vmcnt(12)
  v_mfma_f32_16x16x32_bf16 v[64:67], v[32:35], v[132:135], v[64:67]
  ds_read_b64_tr_b16 v[18:19], v8 offset:512
  s_add_u32 s36, s36, 16384
  s_waitcnt lgkmcnt(6)
  v_mfma_f32_16x16x32_bf16 v[52:55], v[36:39], v[128:131], v[52:55]
  ds_read_b64_tr_b16 v[20:21], v9 offset:0
  v_mfma_f32_16x16x32_bf16 v[68:71], v[36:39], v[132:135], v[68:71]
  ds_read_b64_tr_b16 v[22:23], v9 offset:512
  s_waitcnt lgkmcnt(6)
  v_mfma_f32_16x16x32_bf16 v[56:59], v[40:43], v[128:131], v[56:59]
  ds_read_b64_tr_b16 v[24:25], v10 offset:0
  buffer_load_dwordx4 v[120:123], v14, s[8:11], s36 offen offset:0 sc1
  v_mfma_f32_16x16x32_bf16 v[72:75], v[40:43], v[132:135], v[72:75]
  ds_read_b64_tr_b16 v[26:27], v10 offset:512
  s_waitcnt lgkmcnt(6)
  v_mfma_f32_16x16x32_bf16 v[60:63], v[44:47], v[128:131], v[60:63]
  ds_read_b64_tr_b16 v[28:29], v11 offset:0
  v_mfma_f32_16x16x32_bf16 v[76:79], v[44:47], v[132:135], v[76:79]
  ds_read_b64_tr_b16 v[30:31], v11 offset:512
  buffer_load_dwordx4 v[124:127], v14, s[8:11], s36 offen offset:1024 sc1
  s_waitcnt vmcnt(13) lgkmcnt(6)
  v_mfma_f32_16x16x32_bf16 v[48:51], v[16:19], v[136:139], v[48:51]
  ds_read_b64_tr_b16 v[32:33], v8 offset:4096
  s_waitcnt vmcnt(12)
  v_mfma_f32_16x16x32_bf16 v[64:67], v[16:19], v[140:143], v[64:67]
  ds_read_b64_tr_b16 v[34:35], v8 offset:4608
  v_add_u32 v8, 8192, v8
  s_waitcnt lgkmcnt(6)
  v_mfma_f32_16x16x32_bf16 v[52:55], v[20:23], v[136:139], v[52:55]
  ds_read_b64_tr_b16 v[36:37], v9 offset:4096
  buffer_load_dwordx4 v[128:131], v14, s[8:11], s36 offen offset:2048 sc1
  v_mfma_f32_16x16x32_bf16 v[68:71], v[20:23], v[140:143], v[68:71]
  ds_read_b64_tr_b16 v[38:39], v9 offset:4608
  v_add_u32 v9, 8192, v9
  s_waitcnt lgkmcnt(6)
  v_mfma_f32_16x16x32_bf16 v[56:59], v[24:27], v[136:139], v[56:59]
  ds_read_b64_tr_b16 v[40:41], v10 offset:4096
  v_mfma_f32_16x16x32_bf16 v[72:75], v[24:27], v[140:143], v[72:75]
  ds_read_b64_tr_b16 v[42:43], v10 offset:4608
  v_add_u32 v10, 8192, v10
  s_waitcnt lgkmcnt(6)
  v_mfma_f32_16x16x32_bf16 v[60:63], v[28:31], v[136:139], v[60:63]
  ds_read_b64_tr_b16 v[44:45], v11 offset:4096
  buffer_load_dwordx4 v[132:135], v14, s[8:11], s36 offen offset:3072 sc1
  v_mfma_f32_16x16x32_bf16 v[76:79], v[28:31], v[140:143], v[76:79]
  ds_read_b64_tr_b16 v[46:47], v11 offset:4608
  v_add_u32 v11, 8192, v11
  s_waitcnt vmcnt(13) lgkmcnt(6)
  v_mfma_f32_16x16x32_bf16 v[48:51], v[32:35], v[144:147], v[48:51]
  ds_read_b64_tr_b16 v[16:17], v8 offset:0
  s_bitcmp1_b32 s48, 5
  s_cselect_b32 s36, s50, s49
  s_waitcnt vmcnt(12)
  v_mfma_f32_16x16x32_bf16 v[64:67], v[32:35], v[148:151], v[64:67]
  ds_read_b64_tr_b16 v[18:19], v8 offset:512
  s_add_u32 s36, s36, 20480
  s_waitcnt lgkmcnt(6)
  v_mfma_f32_16x16x32_bf16 v[52:55], v[36:39], v[144:147], v[52:55]
  ds_read_b64_tr_b16 v[20:21], v9 offset:0
  v_mfma_f32_16x16x32_bf16 v[68:71], v[36:39], v[148:151], v[68:71]
  ds_read_b64_tr_b16 v[22:23], v9 offset:512
  s_waitcnt lgkmcnt(6)
  v_mfma_f32_16x16x32_bf16 v[56:59], v[40:43], v[144:147], v[56:59]
  ds_read_b64_tr_b16 v[24:25], v10 offset:0
  buffer_load_dwordx4 v[136:139], v14, s[8:11], s36 offen offset:0 sc1
  v_mfma_f32_16x16x32_bf16 v[72:75], v[40:43], v[148:151], v[72:75]
  ds_read_b64_tr_b16 v[26:27], v10 offset:512
  s_waitcnt lgkmcnt(6)
  v_mfma_f32_16x16x32_bf16 v[60:63], v[44:47], v[144:147], v[60:63]
  ds_read_b64_tr_b16 v[28:29], v11 offset:0
  v_mfma_f32_16x16x32_bf16 v[76:79], v[44:47], v[148:151], v[76:79]
  ds_read_b64_tr_b16 v[30:31], v11 offset:512
  buffer_load_dwordx4 v[140:143], v14, s[8:11], s36 offen offset:1024 sc1
  s_waitcnt vmcnt(13) lgkmcnt(6)
  v_mfma_f32_16x16x32_bf16 v[48:51], v[16:19], v[152:155], v[48:51]
  ds_read_b64_tr_b16 v[32:33], v8 offset:4096
  s_waitcnt vmcnt(12)
  v_mfma_f32_16x16x32_bf16 v[64:67], v[16:19], v[156:159], v[64:67]
  ds_read_b64_tr_b16 v[34:35], v8 offset:4608
  v_add_u32 v8, 8192, v8
  s_waitcnt lgkmcnt(6)
  v_mfma_f32_16x16x32_bf16 v[52:55], v[20:23], v[152:155], v[52:55]
  ds_read_b64_tr_b16 v[36:37], v9 offset:4096
  buffer_load_dwordx4 v[144:147], v14, s[8:11], s36 offen offset:2048 sc1
  v_mfma_f32_16x16x32_bf16 v[68:71], v[20:23], v[156:159], v[68:71]
  ds_read_b64_tr_b16 v[38:39], v9 offset:4608
  v_add_u32 v9, 8192, v9
  s_waitcnt lgkmcnt(6)
  v_mfma_f32_16x16x32_bf16 v[56:59], v[24:27], v[152:155], v[56:59]
  ds_read_b64_tr_b16 v[40:41], v10 offset:4096
  v_mfma_f32_16x16x32_bf16 v[72:75], v[24:27], v[156:159], v[72:75]
  ds_read_b64_tr_b16 v[42:43], v10 offset:4608
  v_add_u32 v10, 8192, v10
  s_waitcnt lgkmcnt(6)
  v_mfma_f32_16x16x32_bf16 v[60:63], v[28:31], v[152:155], v[60:63]
  ds_read_b64_tr_b16 v[44:45], v11 offset:4096
  buffer_load_dwordx4 v[148:151], v14, s[8:11], s36 offen offset:3072 sc1
  v_mfma_f32_16x16x32_bf16 v[76:79], v[28:31], v[156:159], v[76:79]
  ds_read_b64_tr_b16 v[46:47], v11 offset:4608
  v_add_u32 v11, 8192, v11
  s_waitcnt vmcnt(13) lgkmcnt(6)
  v_mfma_f32_16x16x32_bf16 v[48:51], v[32:35], v[160:163], v[48:51]
  ds_read_b64_tr_b16 v[16:17], v8 offset:0
  s_bitcmp1_b32 s48, 6
  s_cselect_b32 s36, s50, s49
  s_waitcnt vmcnt(12)
  v_mfma_f32_16x16x32_bf16 v[64:67], v[32:35], v[164:167], v[64:67]
  ds_read_b64_tr_b16 v[18:19], v8 offset:512
  s_add_u32 s36, s36, 24576
  s_waitcnt lgkmcnt(6)
  v_mfma_f32_16x16x32_bf16 v[52:55], v[36:39], v[160:163], v[52:55]
  ds_read_b64_tr_b16 v[20:21], v9 offset:0
  v_mfma_f32_16x16x32_bf16 v[68:71], v[36:39], v[164:167], v[68:71]
  ds_read_b64_tr_b16 v[22:23], v9 offset:512
  s_waitcnt lgkmcnt(6)
  v_mfma_f32_16x16x32_bf16 v[56:59], v[40:43], v[160:163], v[56:59]
  ds_read_b64_tr_b16 v[24:25], v10 offset:0
  buffer_load_dwordx4 v[152:155], v14, s[8:11], s36 offen offset:0 sc1
  v_mfma_f32_16x16x32_bf16 v[72:75], v[40:43], v[164:167], v[72:75]
  ds_read_b64_tr_b16 v[26:27], v10 offset:512
  s_waitcnt lgkmcnt(6)
  v_mfma_f32_16x16x32_bf16 v[60:63], v[44:47], v[160:163], v[60:63]
  ds_read_b64_tr_b16 v[28:29], v11 offset:0
  v_mfma_f32_16x16x32_bf16 v[76:79], v[44:47], v[164:167], v[76:79]
  ds_read_b64_tr_b16 v[30:31], v11 offset:512
  buffer_load_dwordx4 v[156:159], v14, s[8:11], s36 offen offset:1024 sc1
  s_waitcnt vmcnt(13) lgkmcnt(6)
  v_mfma_f32_16x16x32_bf16 v[48:51], v[16:19], v[168:171], v[48:51]
  ds_read_b64_tr_b16 v[32:33], v8 offset:4096
  s_waitcnt vmcnt(12)
  v_mfma_f32_16x16x32_bf16 v[64:67], v[16:19], v[172:175], v[64:67]
  ds_read_b64_tr_b16 v[34:35], v8 offset:4608
  v_add_u32 v8, 10240, v8
  s_waitcnt lgkmcnt(6)
  v_mfma_f32_16x16x32_bf16 v[52:55], v[20:23], v[168:171], v[52:55]
  ds_read_b64_tr_b16 v[36:37], v9 offset:4096
  buffer_load_dwordx4 v[160:163], v14, s[8:11], s36 offen offset:2048 sc1
  v_mfma_f32_16x16x32_bf16 v[68:71], v[20:23], v[172:175], v[68:71]
  ds_read_b64_tr_b16 v[38:39], v9 offset:4608
  v_add_u32 v9, 10240, v9
  s_waitcnt lgkmcnt(6)
  v_mfma_f32_16x16x32_bf16 v[56:59], v[24:27], v[168:171], v[56:59]
  ds_read_b64_tr_b16 v[40:41], v10 offset:4096
  v_mfma_f32_16x16x32_bf16 v[72:75], v[24:27], v[172:175], v[72:75]
  ds_read_b64_tr_b16 v[42:43], v10 offset:4608
  v_add_u32 v10, 10240, v10
  s_waitcnt lgkmcnt(6)
  v_mfma_f32_16x16x32_bf16 v[60:63], v[28:31], v[168:171], v[60:63]
  ds_read_b64_tr_b16 v[44:45], v11 offset:4096
  buffer_load_dwordx4 v[164:167], v14, s[8:11], s36 offen offset:3072 sc1
  v_mfma_f32_16x16x32_bf16 v[76:79], v[28:31], v[172:175], v[76:79]
  ds_read_b64_tr_b16 v[46:47], v11 offset:4608
  v_add_u32 v11, 10240, v11
  s_waitcnt vmcnt(13) lgkmcnt(6)
  v_mfma_f32_16x16x32_bf16 v[48:51], v[32:35], v[176:179], v[48:51]
  ds_read_b64_tr_b16 v[16:17], v8 offset:0
  s_bitcmp1_b32 s48, 7
  s_cselect_b32 s36, s50, s49
  s_waitcnt vmcnt(12)
  v_mfma_f32_16x16x32_bf16 v[64:67], v[32:35], v[180:183], v[64:67]
  ds_read_b64_tr_b16 v[18:19], v8 offset:512
  s_add_u32 s36, s36, 28672
  s_waitcnt lgkmcnt(6)
  v_mfma_f32_16x16x32_bf16 v[52:55], v[36:39], v[176:179], v[52:55]
  ds_read_b64_tr_b16 v[20:21], v9 offset:0
  v_mfma_f32_16x16x32_bf16 v[68:71], v[36:39], v[180:183], v[68:71]
  ds_read_b64_tr_b16 v[22:23], v9 offset:512
  s_waitcnt lgkmcnt(6)
  v_mfma_f32_16x16x32_bf16 v[56:59], v[40:43], v[176:179], v[56:59]
  ds_read_b64_tr_b16 v[24:25], v10 offset:0
  buffer_load_dwordx4 v[168:171], v14, s[8:11], s36 offen offset:0 sc1
  v_mfma_f32_16x16x32_bf16 v[72:75], v[40:43], v[180:183], v[72:75]
  ds_read_b64_tr_b16 v[26:27], v10 offset:512
  s_waitcnt lgkmcnt(6)
  v_mfma_f32_16x16x32_bf16 v[60:63], v[44:47], v[176:179], v[60:63]
  ds_read_b64_tr_b16 v[28:29], v11 offset:0
  v_mfma_f32_16x16x32_bf16 v[76:79], v[44:47], v[180:183], v[76:79]
  ds_read_b64_tr_b16 v[30:31], v11 offset:512
  buffer_load_dwordx4 v[172:175], v14, s[8:11], s36 offen offset:1024 sc1
  s_waitcnt vmcnt(13) lgkmcnt(6)
  v_mfma_f32_16x16x32_bf16 v[48:51], v[16:19], v[120:123], v[48:51]
  ds_read_b64_tr_b16 v[32:33], v8 offset:4096
  s_waitcnt vmcnt(12)
  v_mfma_f32_16x16x32_bf16 v[64:67], v[16:19], v[124:127], v[64:67]
  ds_read_b64_tr_b16 v[34:35], v8 offset:4608
  v_add_u32 v8, 8192, v8
  s_waitcnt lgkmcnt(6)
  v_mfma_f32_16x16x32_bf16 v[52:55], v[20:23], v[120:123], v[52:55]
  ds_read_b64_tr_b16 v[36:37], v9 offset:4096
  buffer_load_dwordx4 v[176:179], v14, s[8:11], s36 offen offset:2048 sc1
  v_mfma_f32_16x16x32_bf16 v[68:71], v[20:23], v[124:127], v[68:71]
  ds_read_b64_tr_b16 v[38:39], v9 offset:4608
  v_add_u32 v9, 8192, v9
  s_waitcnt lgkmcnt(6)
  v_mfma_f32_16x16x32_bf16 v[56:59], v[24:27], v[120:123], v[56:59]
  ds_read_b64_tr_b16 v[40:41], v10 offset:4096
  v_mfma_f32_16x16x32_bf16 v[72:75], v[24:27], v[124:127], v[72:75]
  ds_read_b64_tr_b16 v[42:43], v10 offset:4608
  v_add_u32 v10, 8192, v10
  s_waitcnt lgkmcnt(6)
  v_mfma_f32_16x16x32_bf16 v[60:63], v[28:31], v[120:123], v[60:63]
  ds_read_b64_tr_b16 v[44:45], v11 offset:4096
  buffer_load_dwordx4 v[180:183], v14, s[8:11], s36 offen offset:3072 sc1
  v_mfma_f32_16x16x32_bf16 v[76:79], v[28:31], v[124:127], v[76:79]
  ds_read_b64_tr_b16 v[46:47], v11 offset:4608
  v_add_u32 v11, 8192, v11
  s_waitcnt vmcnt(13) lgkmcnt(6)
  v_mfma_f32_16x16x32_bf16 v[48:51], v[32:35], v[128:131], v[48:51]
  ds_read_b64_tr_b16 v[16:17], v8 offset:0
  s_waitcnt vmcnt(12)
  v_mfma_f32_16x16x32_bf16 v[64:67], v[32:35], v[132:135], v[64:67]
  ds_read_b64_tr_b16 v[18:19], v8 offset:512
  s_waitcnt lgkmcnt(6)
  v_mfma_f32_16x16x32_bf16 v[52:55], v[36:39], v[128:131], v[52:55]
  ds_read_b64_tr_b16 v[20:21], v9 offset:0
  v_mfma_f32_16x16x32_bf16 v[68:71], v[36:39], v[132:135], v[68:71]
  ds_read_b64_tr_b16 v[22:23], v9 offset:512
  s_waitcnt lgkmcnt(6)
  v_mfma_f32_16x16x32_bf16 v[56:59], v[40:43], v[128:131], v[56:59]
  ds_read_b64_tr_b16 v[24:25], v10 offset:0
  v_mfma_f32_16x16x32_bf16 v[72:75], v[40:43], v[132:135], v[72:75]
  ds_read_b64_tr_b16 v[26:27], v10 offset:512
  s_waitcnt lgkmcnt(6)
  v_mfma_f32_16x16x32_bf16 v[60:63], v[44:47], v[128:131], v[60:63]
  ds_read_b64_tr_b16 v[28:29], v11 offset:0
  v_mfma_f32_16x16x32_bf16 v[76:79], v[44:47], v[132:135], v[76:79]
  ds_read_b64_tr_b16 v[30:31], v11 offset:512
  s_waitcnt vmcnt(11) lgkmcnt(6)
  v_mfma_f32_16x16x32_bf16 v[48:51], v[16:19], v[136:139], v[48:51]
  ds_read_b64_tr_b16 v[32:33], v8 offset:4096
  s_waitcnt vmcnt(10)
  v_mfma_f32_16x16x32_bf16 v[64:67], v[16:19], v[140:143], v[64:67]
  ds_read_b64_tr_b16 v[34:35], v8 offset:4608
  v_add_u32 v8, 8192, v8
  s_waitcnt lgkmcnt(6)
  v_mfma_f32_16x16x32_bf16 v[52:55], v[20:23], v[136:139], v[52:55]
  ds_read_b64_tr_b16 v[36:37], v9 offset:4096
  v_mfma_f32_16x16x32_bf16 v[68:71], v[20:23], v[140:143], v[68:71]
  ds_read_b64_tr_b16 v[38:39], v9 offset:4608
  v_add_u32 v9, 8192, v9
  s_waitcnt lgkmcnt(6)
  v_mfma_f32_16x16x32_bf16 v[56:59], v[24:27], v[136:139], v[56:59]
  ds_read_b64_tr_b16 v[40:41], v10 offset:4096
  v_mfma_f32_16x16x32_bf16 v[72:75], v[24:27], v[140:143], v[72:75]
  ds_read_b64_tr_b16 v[42:43], v10 offset:4608
  v_add_u32 v10, 8192, v10
  s_waitcnt lgkmcnt(6)
  v_mfma_f32_16x16x32_bf16 v[60:63], v[28:31], v[136:139], v[60:63]
  ds_read_b64_tr_b16 v[44:45], v11 offset:4096
  v_mfma_f32_16x16x32_bf16 v[76:79], v[28:31], v[140:143], v[76:79]
  ds_read_b64_tr_b16 v[46:47], v11 offset:4608
  v_add_u32 v11, 8192, v11
  s_waitcnt vmcnt(9) lgkmcnt(6)
  v_mfma_f32_16x16x32_bf16 v[48:51], v[32:35], v[144:147], v[48:51]
  ds_read_b64_tr_b16 v[16:17], v8 offset:0
  s_waitcnt vmcnt(8)
  v_mfma_f32_16x16x32_bf16 v[64:67], v[32:35], v[148:151], v[64:67]
  ds_read_b64_tr_b16 v[18:19], v8 offset:512
  s_waitcnt lgkmcnt(6)
  v_mfma_f32_16x16x32_bf16 v[52:55], v[36:39], v[144:147], v[52:55]
  ds_read_b64_tr_b16 v[20:21], v9 offset:0
  v_mfma_f32_16x16x32_bf16 v[68:71], v[36:39], v[148:151], v[68:71]
  ds_read_b64_tr_b16 v[22:23], v9 offset:512
  s_waitcnt lgkmcnt(6)
  v_mfma_f32_16x16x32_bf16 v[56:59], v[40:43], v[144:147], v[56:59]
  ds_read_b64_tr_b16 v[24:25], v10 offset:0
  v_mfma_f32_16x16x32_bf16 v[72:75], v[40:43], v[148:151], v[72:75]
  ds_read_b64_tr_b16 v[26:27], v10 offset:512
  s_waitcnt lgkmcnt(6)
  v_mfma_f32_16x16x32_bf16 v[60:63], v[44:47], v[144:147], v[60:63]
  ds_read_b64_tr_b16 v[28:29], v11 offset:0
  v_mfma_f32_16x16x32_bf16 v[76:79], v[44:47], v[148:151], v[76:79]
  ds_read_b64_tr_b16 v[30:31], v11 offset:512
  s_waitcnt vmcnt(7) lgkmcnt(6)
  v_mfma_f32_16x16x32_bf16 v[48:51], v[16:19], v[152:155], v[48:51]
  ds_read_b64_tr_b16 v[32:33], v8 offset:4096
  s_waitcnt vmcnt(6)
  v_mfma_f32_16x16x32_bf16 v[64:67], v[16:19], v[156:159], v[64:67]
  ds_read_b64_tr_b16 v[34:35], v8 offset:4608
  v_add_u32 v8, 8192, v8
  s_waitcnt lgkmcnt(6)
  v_mfma_f32_16x16x32_bf16 v[52:55], v[20:23], v[152:155], v[52:55]
  ds_read_b64_tr_b16 v[36:37], v9 offset:4096
  v_mfma_f32_16x16x32_bf16 v[68:71], v[20:23], v[156:159], v[68:71]
  ds_read_b64_tr_b16 v[38:39], v9 offset:4608
  v_add_u32 v9, 8192, v9
  s_waitcnt lgkmcnt(6)
  v_mfma_f32_16x16x32_bf16 v[56:59], v[24:27], v[152:155], v[56:59]
  ds_read_b64_tr_b16 v[40:41], v10 offset:4096
  v_mfma_f32_16x16x32_bf16 v[72:75], v[24:27], v[156:159], v[72:75]
  ds_read_b64_tr_b16 v[42:43], v10 offset:4608
  v_add_u32 v10, 8192, v10
  s_waitcnt lgkmcnt(6)
  v_mfma_f32_16x16x32_bf16 v[60:63], v[28:31], v[152:155], v[60:63]
  ds_read_b64_tr_b16 v[44:45], v11 offset:4096
  v_mfma_f32_16x16x32_bf16 v[76:79], v[28:31], v[156:159], v[76:79]
  ds_read_b64_tr_b16 v[46:47], v11 offset:4608
  v_add_u32 v11, 8192, v11
  s_waitcnt vmcnt(5) lgkmcnt(6)
  v_mfma_f32_16x16x32_bf16 v[48:51], v[32:35], v[160:163], v[48:51]
  ds_read_b64_tr_b16 v[16:17], v8 offset:0
  s_waitcnt vmcnt(4)
  v_mfma_f32_16x16x32_bf16 v[64:67], v[32:35], v[164:167], v[64:67]
  ds_read_b64_tr_b16 v[18:19], v8 offset:512
  s_waitcnt lgkmcnt(6)
  v_mfma_f32_16x16x32_bf16 v[52:55], v[36:39], v[160:163], v[52:55]
  ds_read_b64_tr_b16 v[20:21], v9 offset:0
  v_mfma_f32_16x16x32_bf16 v[68:71], v[36:39], v[164:167], v[68:71]
  ds_read_b64_tr_b16 v[22:23], v9 offset:512
  s_waitcnt lgkmcnt(6)
  v_mfma_f32_16x16x32_bf16 v[56:59], v[40:43], v[160:163], v[56:59]
  ds_read_b64_tr_b16 v[24:25], v10 offset:0
  v_mfma_f32_16x16x32_bf16 v[72:75], v[40:43], v[164:167], v[72:75]
  ds_read_b64_tr_b16 v[26:27], v10 offset:512
  s_waitcnt lgkmcnt(6)
  v_mfma_f32_16x16x32_bf16 v[60:63], v[44:47], v[160:163], v[60:63]
  ds_read_b64_tr_b16 v[28:29], v11 offset:0
  v_mfma_f32_16x16x32_bf16 v[76:79], v[44:47], v[164:167], v[76:79]
  ds_read_b64_tr_b16 v[30:31], v11 offset:512
  s_waitcnt vmcnt(3) lgkmcnt(6)
  v_mfma_f32_16x16x32_bf16 v[48:51], v[16:19], v[168:171], v[48:51]
  ds_read_b64_tr_b16 v[32:33], v8 offset:4096
  s_waitcnt vmcnt(2)
  v_mfma_f32_16x16x32_bf16 v[64:67], v[16:19], v[172:175], v[64:67]
  ds_read_b64_tr_b16 v[34:35], v8 offset:4608
  s_waitcnt lgkmcnt(6)
  v_mfma_f32_16x16x32_bf16 v[52:55], v[20:23], v[168:171], v[52:55]
  ds_read_b64_tr_b16 v[36:37], v9 offset:4096
  v_mfma_f32_16x16x32_bf16 v[68:71], v[20:23], v[172:175], v[68:71]
  ds_read_b64_tr_b16 v[38:39], v9 offset:4608
  s_waitcnt lgkmcnt(6)
  v_mfma_f32_16x16x32_bf16 v[56:59], v[24:27], v[168:171], v[56:59]
  ds_read_b64_tr_b16 v[40:41], v10 offset:4096
  v_mfma_f32_16x16x32_bf16 v[72:75], v[24:27], v[172:175], v[72:75]
  ds_read_b64_tr_b16 v[42:43], v10 offset:4608
  s_waitcnt lgkmcnt(6)
  v_mfma_f32_16x16x32_bf16 v[60:63], v[28:31], v[168:171], v[60:63]
  ds_read_b64_tr_b16 v[44:45], v11 offset:4096
  v_mfma_f32_16x16x32_bf16 v[76:79], v[28:31], v[172:175], v[76:79]
  ds_read_b64_tr_b16 v[46:47], v11 offset:4608
  s_waitcnt vmcnt(1) lgkmcnt(6)
  v_mfma_f32_16x16x32_bf16 v[48:51], v[32:35], v[176:179], v[48:51]
  s_waitcnt vmcnt(0)
  v_mfma_f32_16x16x32_bf16 v[64:67], v[32:35], v[180:183], v[64:67]
  s_waitcnt lgkmcnt(4)
  v_mfma_f32_16x16x32_bf16 v[52:55], v[36:39], v[176:179], v[52:55]
  v_mfma_f32_16x16x32_bf16 v[68:71], v[36:39], v[180:183], v[68:71]
  s_waitcnt lgkmcnt(2)
  v_mfma_f32_16x16x32_bf16 v[56:59], v[40:43], v[176:179], v[56:59]
  v_mfma_f32_16x16x32_bf16 v[72:75], v[40:43], v[180:183], v[72:75]
  s_waitcnt lgkmcnt(0)
  v_mfma_f32_16x16x32_bf16 v[60:63], v[44:47], v[176:179], v[60:63]
  v_mfma_f32_16x16x32_bf16 v[76:79], v[44:47], v[180:183], v[76:79]
  s_waitcnt lgkmcnt(0)
  s_barrier
  s_add_u32 s20, s82, 4194304
  s_addc_u32 s21, s83, 0
  s_mov_b32 s22, 4194304
  s_mov_b32 s23, 0x20000
  s_add_u32 s24, s82, 8388608
  s_addc_u32 s25, s83, 0
  s_mov_b32 s26, 4194304
  s_mov_b32 s27, 0x20000
  v_pk_add_f32 v[16:17], v[48:49], v[50:51]
  v_pk_mul_f32 v[18:19], v[48:49], v[48:49]
  v_pk_fma_f32 v[18:19], v[50:51], v[50:51], v[18:19]
  v_pk_add_f32 v[16:17], v[16:17], v[52:53]
  v_pk_fma_f32 v[18:19], v[52:53], v[52:53], v[18:19]
  v_pk_add_f32 v[16:17], v[16:17], v[54:55]
  v_pk_fma_f32 v[18:19], v[54:55], v[54:55], v[18:19]
  v_pk_add_f32 v[16:17], v[16:17], v[56:57]
  v_pk_fma_f32 v[18:19], v[56:57], v[56:57], v[18:19]
  v_pk_add_f32 v[16:17], v[16:17], v[58:59]
  v_pk_fma_f32 v[18:19], v[58:59], v[58:59], v[18:19]
  v_pk_add_f32 v[16:17], v[16:17], v[60:61]
  v_pk_fma_f32 v[18:19], v[60:61], v[60:61], v[18:19]
  v_pk_add_f32 v[16:17], v[16:17], v[62:63]
  v_pk_fma_f32 v[18:19], v[62:63], v[62:63], v[18:19]
  v_add_f32 v24, v16, v17
  v_add_f32 v26, v18, v19
  v_pk_add_f32 v[20:21], v[64:65], v[66:67]
  v_pk_mul_f32 v[22:23], v[64:65], v[64:65]
  v_pk_fma_f32 v[22:23], v[66:67], v[66:67], v[22:23]
  v_pk_add_f32 v[20:21], v[20:21], v[68:69]
  v_pk_fma_f32 v[22:23], v[68:69], v[68:69], v[22:23]
  v_pk_add_f32 v[20:21], v[20:21], v[70:71]
  v_pk_fma_f32 v[22:23], v[70:71], v[70:71], v[22:23]
  v_pk_add_f32 v[20:21], v[20:21], v[72:73]
  v_pk_fma_f32 v[22:23], v[72:73], v[72:73], v[22:23]
  v_pk_add_f32 v[20:21], v[20:21], v[74:75]
  v_pk_fma_f32 v[22:23], v[74:75], v[74:75], v[22:23]
  v_pk_add_f32 v[20:21], v[20:21], v[76:77]
  v_pk_fma_f32 v[22:23], v[76:77], v[76:77], v[22:23]
  v_pk_add_f32 v[20:21], v[20:21], v[78:79]
  v_pk_fma_f32 v[22:23], v[78:79], v[78:79], v[22:23]
  v_add_f32 v25, v20, v21
  v_add_f32 v27, v22, v23
  s_nop 0
  v_permlane16_swap_b32 v24, v25
  v_permlane16_swap_b32 v26, v27
  v_add_f32 v28, v24, v25
  v_add_f32 v29, v26, v27
  v_mov_b32 v30, v28
  v_mov_b32 v31, v29
  s_nop 0
  v_permlane32_swap_b32 v28, v30
  v_permlane32_swap_b32 v29, v31
  v_add_f32 v28, v28, v30
  v_add_f32 v29, v29, v31
  v_and_b32 v29, 0x7fffffff, v29
  s_mov_b32 exec_hi, 0
  buffer_store_dwordx2 v[28:29], v112, s[12:15], 0 offen sc0 sc1
  s_mov_b64 exec, -1
  v_cvt_pk_bf16_f32 v96, v48, v49
  v_cvt_pk_bf16_f32 v97, v50, v51
  v_cvt_pk_bf16_f32 v98, v52, v53
  v_cvt_pk_bf16_f32 v99, v54, v55
  v_cvt_pk_bf16_f32 v100, v56, v57
  v_cvt_pk_bf16_f32 v101, v58, v59
  v_cvt_pk_bf16_f32 v102, v60, v61
  v_cvt_pk_bf16_f32 v103, v62, v63
  v_cvt_pk_bf16_f32 v104, v64, v65
  v_cvt_pk_bf16_f32 v105, v66, v67
  v_cvt_pk_bf16_f32 v106, v68, v69
  v_cvt_pk_bf16_f32 v107, v70, v71
  v_cvt_pk_bf16_f32 v108, v72, v73
  v_cvt_pk_bf16_f32 v109, v74, v75
  v_cvt_pk_bf16_f32 v110, v76, v77
  v_cvt_pk_bf16_f32 v111, v78, v79
  v_permlane16_swap_b32 v96, v98
  v_permlane16_swap_b32 v97, v99
  v_permlane16_swap_b32 v100, v102
  v_permlane16_swap_b32 v101, v103
  v_permlane16_swap_b32 v104, v106
  v_permlane16_swap_b32 v105, v107
  v_permlane16_swap_b32 v108, v110
  v_permlane16_swap_b32 v109, v111
  v_xor_b32 v116, 32, v115
  v_xor_b32 v121, 32, v114
  v_xor_b32 v117, 64, v115
  v_xor_b32 v122, 64, v114
  v_xor_b32 v118, 96, v115
  v_xor_b32 v123, 96, v114
  v_mov_b32 v120, v114
  s_mov_b32 s39, 0
k2_poll:
  buffer_load_dwordx2 v[32:33], v113, s[12:15], 0 offen sc0 sc1
  buffer_load_dwordx2 v[34:35], v113, s[12:15], s87 offen sc0 sc1
  buffer_load_dwordx2 v[36:37], v113, s[12:15], s88 offen sc0 sc1
  buffer_load_dwordx2 v[38:39], v113, s[12:15], s89 offen sc0 sc1
  buffer_load_dwordx2 v[40:41], v113, s[12:15], s90 offen sc0 sc1
  buffer_load_dwordx2 v[42:43], v113, s[12:15], s91 offen sc0 sc1
  buffer_load_dwordx2 v[44:45], v113, s[12:15], s92 offen sc0 sc1
  buffer_load_dwordx2 v[46:47], v113, s[12:15], s93 offen sc0 sc1
  s_waitcnt vmcnt(0)
  v_min3_i32 v16, v33, v35, v37
  v_min3_i32 v17, v39, v41, v43
  v_min3_i32 v16, v16, v45, v47
  v_min_i32 v16, v16, v17
  v_cmp_gt_i32 vcc, 0, v16
  s_add_u32 s39, s39, 1
  s_cmp_gt_u32 s39, 100000
  s_cbranch_scc1 k2_pdone
  s_cbranch_vccnz k2_poll
k2_pdone:
  buffer_store_dwordx4 v[96:99], v12, s[20:23], 0 offen offset:0 sc0 sc1
  buffer_store_dwordx4 v[100:103], v12, s[20:23], 0 offen offset:64 sc0 sc1
  buffer_store_dwordx4 v[104:107], v12, s[20:23], 0 offen offset:2048 sc0 sc1
  buffer_store_dwordx4 v[108:111], v12, s[20:23], 0 offen offset:2112 sc0 sc1
  v_pk_add_f32 v[32:33], v[32:33], v[34:35]
  v_pk_add_f32 v[36:37], v[36:37], v[38:39]
  v_pk_add_f32 v[40:41], v[40:41], v[42:43]
  v_pk_add_f32 v[44:45], v[44:45], v[46:47]
  v_pk_add_f32 v[32:33], v[32:33], v[36:37]
  v_pk_add_f32 v[40:41], v[40:41], v[44:45]
  v_pk_add_f32 v[32:33], v[32:33], v[40:41]
  v_mov_b32 v34, v32
  v_mov_b32 v35, v33
  s_nop 0
  v_permlane32_swap_b32 v32, v34
  v_permlane32_swap_b32 v33, v35
  v_add_f32 v32, v32, v34
  v_add_f32 v33, v33, v35
  v_mul_f32 v32, 0x3a800000, v32
  v_mul_f32 v33, 0x3a800000, v33
  v_fma_f32 v33, -v32, v32, v33
  v_max_f32 v33, 0, v33
  v_mov_b32 v36, v33
  v_cvt_pk_bf16_f32 v36, v36, v36
  v_lshlrev_b32 v36, 16, v36
  v_add_f32 v36, 0x3727c5ac, v36
  v_cvt_pk_bf16_f32 v36, v36, v36
  v_lshlrev_b32 v36, 16, v36
  v_sqrt_f32 v36, v36
  s_nop 0
  v_cvt_pk_bf16_f32 v36, v36, v36
  v_lshlrev_b32 v36, 16, v36
  v_rcp_f32 v36, v36
  s_nop 0
  v_mul_f32 v33, v33, v36
  v_mul_f32 v33, v33, v36
  v_cvt_pk_bf16_f32 v33, v33, v33
  v_lshlrev_b32 v33, 16, v33
  v_add_f32 v33, 0x3727c5ac, v33
  v_cvt_pk_bf16_f32 v33, v33, v33
  v_lshlrev_b32 v33, 16, v33
  v_sqrt_f32 v33, v33
  s_nop 0
  v_cvt_pk_bf16_f32 v33, v33, v33
  v_lshlrev_b32 v33, 16, v33
  v_rcp_f32 v33, v33
  s_nop 0
  v_mul_f32 v33, v33, v36
  v_mov_b32 v34, v32
  v_mov_b32 v35, v33
  s_nop 0
  v_permlane16_swap_b32 v32, v34
  v_permlane16_swap_b32 v33, v35
  v_pk_add_f32 v[48:49], v[48:49], v[32:33] op_sel_hi:[1,0] neg_lo:[0,1] neg_hi:[0,1]
  v_pk_add_f32 v[50:51], v[50:51], v[32:33] op_sel_hi:[1,0] neg_lo:[0,1] neg_hi:[0,1]
  v_pk_add_f32 v[52:53], v[52:53], v[32:33] op_sel_hi:[1,0] neg_lo:[0,1] neg_hi:[0,1]
  v_pk_add_f32 v[54:55], v[54:55], v[32:33] op_sel_hi:[1,0] neg_lo:[0,1] neg_hi:[0,1]
  v_pk_add_f32 v[56:57], v[56:57], v[32:33] op_sel_hi:[1,0] neg_lo:[0,1] neg_hi:[0,1]
  v_pk_add_f32 v[58:59], v[58:59], v[32:33] op_sel_hi:[1,0] neg_lo:[0,1] neg_hi:[0,1]
  v_pk_add_f32 v[60:61], v[60:61], v[32:33] op_sel_hi:[1,0] neg_lo:[0,1] neg_hi:[0,1]
  v_pk_add_f32 v[62:63], v[62:63], v[32:33] op_sel_hi:[1,0] neg_lo:[0,1] neg_hi:[0,1]
  v_pk_mul_f32 v[48:49], v[48:49], v[32:33] op_sel:[0,1] op_sel_hi:[1,1]
  v_pk_mul_f32 v[50:51], v[50:51], v[32:33] op_sel:[0,1] op_sel_hi:[1,1]
  v_pk_mul_f32 v[52:53], v[52:53], v[32:33] op_sel:[0,1] op_sel_hi:[1,1]
  v_pk_mul_f32 v[54:55], v[54:55], v[32:33] op_sel:[0,1] op_sel_hi:[1,1]
  v_pk_mul_f32 v[56:57], v[56:57], v[32:33] op_sel:[0,1] op_sel_hi:[1,1]
  v_pk_mul_f32 v[58:59], v[58:59], v[32:33] op_sel:[0,1] op_sel_hi:[1,1]
  v_pk_mul_f32 v[60:61], v[60:61], v[32:33] op_sel:[0,1] op_sel_hi:[1,1]
  v_pk_mul_f32 v[62:63], v[62:63], v[32:33] op_sel:[0,1] op_sel_hi:[1,1]
  v_cvt_pk_bf16_f32 v160, v48, v49
  v_cvt_pk_bf16_f32 v161, v50, v51
  ds_write_b64 v120, v[160:161] offset:0
  v_cvt_pk_bf16_f32 v162, v52, v53
  v_cvt_pk_bf16_f32 v163, v54, v55
  ds_write_b64 v121, v[162:163] offset:0
  v_cvt_pk_bf16_f32 v164, v56, v57
  v_cvt_pk_bf16_f32 v165, v58, v59
  ds_write_b64 v122, v[164:165] offset:0
  v_cvt_pk_bf16_f32 v166, v60, v61
  v_cvt_pk_bf16_f32 v167, v62, v63
  ds_write_b64 v123, v[166:167] offset:0
  v_pk_add_f32 v[64:65], v[64:65], v[34:35] op_sel_hi:[1,0] neg_lo:[0,1] neg_hi:[0,1]
  v_pk_add_f32 v[66:67], v[66:67], v[34:35] op_sel_hi:[1,0] neg_lo:[0,1] neg_hi:[0,1]
  v_pk_add_f32 v[68:69], v[68:69], v[34:35] op_sel_hi:[1,0] neg_lo:[0,1] neg_hi:[0,1]
  v_pk_add_f32 v[70:71], v[70:71], v[34:35] op_sel_hi:[1,0] neg_lo:[0,1] neg_hi:[0,1]
  v_pk_add_f32 v[72:73], v[72:73], v[34:35] op_sel_hi:[1,0] neg_lo:[0,1] neg_hi:[0,1]
  v_pk_add_f32 v[74:75], v[74:75], v[34:35] op_sel_hi:[1,0] neg_lo:[0,1] neg_hi:[0,1]
  v_pk_add_f32 v[76:77], v[76:77], v[34:35] op_sel_hi:[1,0] neg_lo:[0,1] neg_hi:[0,1]
  v_pk_add_f32 v[78:79], v[78:79], v[34:35] op_sel_hi:[1,0] neg_lo:[0,1] neg_hi:[0,1]
  v_pk_mul_f32 v[64:65], v[64:65], v[34:35] op_sel:[0,1] op_sel_hi:[1,1]
  v_pk_mul_f32 v[66:67], v[66:67], v[34:35] op_sel:[0,1] op_sel_hi:[1,1]
  v_pk_mul_f32 v[68:69], v[68:69], v[34:35] op_sel:[0,1] op_sel_hi:[1,1]
  v_pk_mul_f32 v[70:71], v[70:71], v[34:35] op_sel:[0,1] op_sel_hi:[1,1]
  v_pk_mul_f32 v[72:73], v[72:73], v[34:35] op_sel:[0,1] op_sel_hi:[1,1]
  v_pk_mul_f32 v[74:75], v[74:75], v[34:35] op_sel:[0,1] op_sel_hi:[1,1]
  v_pk_mul_f32 v[76:77], v[76:77], v[34:35] op_sel:[0,1] op_sel_hi:[1,1]
  v_pk_mul_f32 v[78:79], v[78:79], v[34:35] op_sel:[0,1] op_sel_hi:[1,1]
  v_cvt_pk_bf16_f32 v168, v64, v65
  v_cvt_pk_bf16_f32 v169, v66, v67
  ds_write_b64 v120, v[168:169] offset:128
  v_cvt_pk_bf16_f32 v170, v68, v69
  v_cvt_pk_bf16_f32 v171, v70, v71
  ds_write_b64 v121, v[170:171] offset:128
  v_cvt_pk_bf16_f32 v172, v72, v73
  v_cvt_pk_bf16_f32 v173, v74, v75
  ds_write_b64 v122, v[172:173] offset:128
  v_cvt_pk_bf16_f32 v174, v76, v77
  v_cvt_pk_bf16_f32 v175, v78, v79
  ds_write_b64 v123, v[174:175] offset:128
  s_waitcnt lgkmcnt(0)
  ds_read_b64_tr_b16 v[176:177], v115
  ds_read_b64_tr_b16 v[178:179], v115 offset:512
  ds_read_b64_tr_b16 v[180:181], v116
  ds_read_b64_tr_b16 v[182:183], v116 offset:512
  ds_read_b64_tr_b16 v[184:185], v117
  ds_read_b64_tr_b16 v[186:187], v117 offset:512
  ds_read_b64_tr_b16 v[188:189], v118
  ds_read_b64_tr_b16 v[190:191], v118 offset:512
  s_waitcnt lgkmcnt(6)
  buffer_store_dwordx4 v[176:179], v14, s[24:27], s44 offen sc0 sc1
  s_waitcnt lgkmcnt(4)
  buffer_store_dwordx4 v[180:183], v14, s[24:27], s45 offen sc0 sc1
  s_waitcnt lgkmcnt(2)
  buffer_store_dwordx4 v[184:187], v14, s[24:27], s46 offen sc0 sc1
  s_waitcnt lgkmcnt(0)
  buffer_store_dwordx4 v[188:191], v14, s[24:27], s47 offen sc0 sc1
  s_cmp_ge_u32 s2, 224
  s_cbranch_scc1 C_k3skip
  s_lshr_b32 s32, s2, 3
  s_mul_i32 s5, s32, 9363
  s_lshr_b32 s5, s5, 16
  s_mul_i32 s6, s5, 7
  s_sub_u32 s6, s32, s6
  s_lshl_b32 s7, s5, 1
  s_add_u32 s7, s7, s6
  s_and_b32 s7, s7, 7
  s_and_b32 s32, s2, 7
  s_lshr_b32 s28, s32, 2
  s_lshl_b32 s28, s28, 2
  s_add_u32 s28, s28, s5
  s_and_b32 s29, s32, 3
  s_mul_i32 s29, s29, 7
  s_add_u32 s29, s29, s6
  s_mov_b32 s30, 7
  s_mov_b32 s31, -1
  s_and_b32 s46, s4, 1
  s_lshr_b32 s41, s4, 1
  s_lshl_b32 s32, s29, 8
  s_lshl_b32 s44, s46, 7
  s_add_u32 s32, s32, s44
  v_lshlrev_b32 v16, 3, v5
  v_add_u32 v16, s32, v16
  s_mov_b32 s16, s74
  s_mov_b32 s17, s75
  s_mov_b32 s18, 7168
  s_mov_b32 s19, 0x20000
  buffer_load_dwordx2 v[144:145], v16, s[16:19], 0 offen offset:0
  buffer_load_dwordx2 v[146:147], v16, s[16:19], 0 offen offset:32
  buffer_load_dwordx2 v[148:149], v16, s[16:19], 0 offen offset:64
  buffer_load_dwordx2 v[150:151], v16, s[16:19], 0 offen offset:96
  s_add_u32 s20, s82, 12582912
  s_addc_u32 s21, s83, 0
  s_mov_b32 s22, 7340032
  s_mov_b32 s23, 0x20000
  v_lshl_add_u32 v17, v5, 3, v6
  v_lshlrev_b32 v17, 8, v17
  v_lshl_add_u32 v17, v7, 3, v17
  v_lshl_or_b32 v18, v2, 2, v6
  v_lshl_add_u32 v17, v18, 5, v17
  s_lshl_b32 s32, s46, 7
  s_add_u32 s32, s32, 16384
  v_xor_b32 v18, s32, v17
  s_lshl_b32 s32, s41, 13
  v_add_u32 v12, s32, v14
  v_xor_b32 v8, 0, v18
  v_xor_b32 v9, 32, v18
  v_xor_b32 v10, 64, v18
  v_xor_b32 v11, 96, v18
  v_bfe_u32 v17, v4, 2, 1
  v_lshlrev_b32 v17, 10, v17
  v_lshl_add_u32 v17, v3, 8, v17
  v_lshrrev_b32 v18, 3, v4
  v_lshl_add_u32 v17, v18, 6, v17
  v_lshl_add_u32 v152, v7, 4, v17
  v_add_u32 v153, 128, v152
  s_lshl_b32 s32, s28, 1
  s_add_u32 s32, s32, s41
  s_mul_i32 s32, s32, 224
  s_lshl_b32 s44, s29, 2
  s_add_u32 s32, s32, s44
  s_lshl_b32 s44, s46, 1
  s_add_u32 s32, s32, s44
  s_lshl_b32 s44, s32, 11
  s_add_u32 s45, s44, 229376
  s_waitcnt vmcnt(0)
  s_barrier
  v_lshlrev_b32 v80, 16, v144
  v_and_b32 v81, 0xffff0000, v144
  v_lshlrev_b32 v82, 16, v145
  v_and_b32 v83, 0xffff0000, v145
  v_mov_b64 v[96:97], v[80:81]
  v_mov_b64 v[98:99], v[82:83]
  v_mov_b64 v[112:113], v[80:81]
  v_mov_b64 v[114:115], v[82:83]
  v_mov_b64 v[128:129], v[80:81]
  v_mov_b64 v[130:131], v[82:83]
  v_lshlrev_b32 v84, 16, v146
  v_and_b32 v85, 0xffff0000, v146
  v_lshlrev_b32 v86, 16, v147
  v_and_b32 v87, 0xffff0000, v147
  v_mov_b64 v[100:101], v[84:85]
  v_mov_b64 v[102:103], v[86:87]
  v_mov_b64 v[116:117], v[84:85]
  v_mov_b64 v[118:119], v[86:87]
  v_mov_b64 v[132:133], v[84:85]
  v_mov_b64 v[134:135], v[86:87]
  v_lshlrev_b32 v88, 16, v148
  v_and_b32 v89, 0xffff0000, v148
  v_lshlrev_b32 v90, 16, v149
  v_and_b32 v91, 0xffff0000, v149
  v_mov_b64 v[104:105], v[88:89]
  v_mov_b64 v[106:107], v[90:91]
  v_mov_b64 v[120:121], v[88:89]
  v_mov_b64 v[122:123], v[90:91]
  v_mov_b64 v[136:137], v[88:89]
  v_mov_b64 v[138:139], v[90:91]
  v_lshlrev_b32 v92, 16, v150
  v_and_b32 v93, 0xffff0000, v150
  v_lshlrev_b32 v94, 16, v151
  v_and_b32 v95, 0xffff0000, v151
  v_mov_b64 v[108:109], v[92:93]
  v_mov_b64 v[110:111], v[94:95]
  v_mov_b64 v[124:125], v[92:93]
  v_mov_b64 v[126:127], v[94:95]
  v_mov_b64 v[140:141], v[92:93]
  v_mov_b64 v[142:143], v[94:95]
  s_barrier
  s_mov_b32 s43, 0
  s_mov_b32 s39, 31
  s_barrier
  ds_read_b64_tr_b16 v[16:17], v8 offset:0
  ds_read_b64_tr_b16 v[18:19], v8 offset:1024
  ds_read_b128 v[32:35], v12 offset:0
  ds_read_b64_tr_b16 v[20:21], v9 offset:0
  ds_read_b64_tr_b16 v[22:23], v9 offset:1024
  ds_read_b128 v[36:39], v12 offset:2048
  ds_read_b64_tr_b16 v[24:25], v10 offset:0
  ds_read_b64_tr_b16 v[26:27], v10 offset:1024
  ds_read_b128 v[40:43], v12 offset:4096
  ds_read_b64_tr_b16 v[28:29], v11 offset:0
  ds_read_b64_tr_b16 v[30:31], v11 offset:1024
  ds_read_b128 v[44:47], v12 offset:6144
  s_add_u32 s40, s43, 32768
  s_cmp_eq_u32 s40, 163840
  s_cselect_b32 s40, 0, s40
  s_sub_u32 s42, s40, s43
  s_mov_b32 s43, s40
cl3:
  s_waitcnt lgkmcnt(9)
  v_mfma_f32_16x16x32_bf16 v[80:83], v[16:19], v[32:35], v[80:83]
  ds_read_b64_tr_b16 v[48:49], v8 offset:8192
  s_waitcnt lgkmcnt(7)
  v_mfma_f32_16x16x32_bf16 v[96:99], v[16:19], v[36:39], v[96:99]
  ds_read_b64_tr_b16 v[50:51], v8 offset:9216
  v_add_u32 v8, s42, v8
  v_mfma_f32_16x16x32_bf16 v[84:87], v[20:23], v[32:35], v[84:87]
  ds_read_b128 v[64:67], v12 offset:1024
  v_mfma_f32_16x16x32_bf16 v[100:103], v[20:23], v[36:39], v[100:103]
  ds_read_b64_tr_b16 v[52:53], v9 offset:8192
  s_waitcnt lgkmcnt(7)
  v_mfma_f32_16x16x32_bf16 v[112:115], v[16:19], v[40:43], v[112:115]
  ds_read_b64_tr_b16 v[54:55], v9 offset:9216
  v_add_u32 v9, s42, v9
  v_mfma_f32_16x16x32_bf16 v[116:119], v[20:23], v[40:43], v[116:119]
  ds_read_b128 v[68:71], v12 offset:3072
  v_mfma_f32_16x16x32_bf16 v[88:91], v[24:27], v[32:35], v[88:91]
  ds_read_b64_tr_b16 v[56:57], v10 offset:8192
  v_mfma_f32_16x16x32_bf16 v[104:107], v[24:27], v[36:39], v[104:107]
  ds_read_b64_tr_b16 v[58:59], v10 offset:9216
  v_add_u32 v10, s42, v10
  v_mfma_f32_16x16x32_bf16 v[120:123], v[24:27], v[40:43], v[120:123]
  ds_read_b128 v[72:75], v12 offset:5120
  s_waitcnt lgkmcnt(9)
  v_mfma_f32_16x16x32_bf16 v[128:131], v[16:19], v[44:47], v[128:131]
  ds_read_b64_tr_b16 v[60:61], v11 offset:8192
  v_mfma_f32_16x16x32_bf16 v[132:135], v[20:23], v[44:47], v[132:135]
  ds_read_b64_tr_b16 v[62:63], v11 offset:9216
  v_add_u32 v11, s42, v11
  v_mfma_f32_16x16x32_bf16 v[136:139], v[24:27], v[44:47], v[136:139]
  ds_read_b128 v[76:79], v12 offset:7168
  v_add_u32 v12, s42, v12
  v_mfma_f32_16x16x32_bf16 v[92:95], v[28:31], v[32:35], v[92:95]
  v_mfma_f32_16x16x32_bf16 v[108:111], v[28:31], v[36:39], v[108:111]
  v_mfma_f32_16x16x32_bf16 v[124:127], v[28:31], v[40:43], v[124:127]
  v_mfma_f32_16x16x32_bf16 v[140:143], v[28:31], v[44:47], v[140:143]
  s_barrier
  s_waitcnt lgkmcnt(9)
  v_mfma_f32_16x16x32_bf16 v[80:83], v[48:51], v[64:67], v[80:83]
  ds_read_b64_tr_b16 v[16:17], v8 offset:0
  s_add_u32 s40, s43, 32768
  s_waitcnt lgkmcnt(7)
  v_mfma_f32_16x16x32_bf16 v[96:99], v[48:51], v[68:71], v[96:99]
  ds_read_b64_tr_b16 v[18:19], v8 offset:1024
  s_cmp_eq_u32 s40, 163840
  v_mfma_f32_16x16x32_bf16 v[84:87], v[52:55], v[64:67], v[84:87]
  ds_read_b128 v[32:35], v12 offset:0
  s_cselect_b32 s40, 0, s40
  v_mfma_f32_16x16x32_bf16 v[100:103], v[52:55], v[68:71], v[100:103]
  ds_read_b64_tr_b16 v[20:21], v9 offset:0
  s_sub_u32 s42, s40, s43
  s_waitcnt lgkmcnt(7)
  v_mfma_f32_16x16x32_bf16 v[112:115], v[48:51], v[72:75], v[112:115]
  ds_read_b64_tr_b16 v[22:23], v9 offset:1024
  s_mov_b32 s43, s40
  v_mfma_f32_16x16x32_bf16 v[116:119], v[52:55], v[72:75], v[116:119]
  ds_read_b128 v[36:39], v12 offset:2048
  v_mfma_f32_16x16x32_bf16 v[88:91], v[56:59], v[64:67], v[88:91]
  ds_read_b64_tr_b16 v[24:25], v10 offset:0
  v_mfma_f32_16x16x32_bf16 v[104:107], v[56:59], v[68:71], v[104:107]
  ds_read_b64_tr_b16 v[26:27], v10 offset:1024
  v_mfma_f32_16x16x32_bf16 v[120:123], v[56:59], v[72:75], v[120:123]
  ds_read_b128 v[40:43], v12 offset:4096
  s_waitcnt lgkmcnt(9)
  v_mfma_f32_16x16x32_bf16 v[128:131], v[48:51], v[76:79], v[128:131]
  ds_read_b64_tr_b16 v[28:29], v11 offset:0
  v_mfma_f32_16x16x32_bf16 v[132:135], v[52:55], v[76:79], v[132:135]
  ds_read_b64_tr_b16 v[30:31], v11 offset:1024
  v_mfma_f32_16x16x32_bf16 v[136:139], v[56:59], v[76:79], v[136:139]
  ds_read_b128 v[44:47], v12 offset:6144
  v_mfma_f32_16x16x32_bf16 v[92:95], v[60:63], v[64:67], v[92:95]
  v_mfma_f32_16x16x32_bf16 v[108:111], v[60:63], v[68:71], v[108:111]
  v_mfma_f32_16x16x32_bf16 v[124:127], v[60:63], v[72:75], v[124:127]
  v_mfma_f32_16x16x32_bf16 v[140:143], v[60:63], v[76:79], v[140:143]
  s_sub_u32 s39, s39, 1
  s_cmp_lg_u32 s39, 0
  s_cbranch_scc1 cl3
  s_waitcnt lgkmcnt(9)
  v_mfma_f32_16x16x32_bf16 v[80:83], v[16:19], v[32:35], v[80:83]
  ds_read_b64_tr_b16 v[48:49], v8 offset:8192
  s_waitcnt lgkmcnt(7)
  v_mfma_f32_16x16x32_bf16 v[96:99], v[16:19], v[36:39], v[96:99]
  ds_read_b64_tr_b16 v[50:51], v8 offset:9216
  v_mfma_f32_16x16x32_bf16 v[84:87], v[20:23], v[32:35], v[84:87]
  ds_read_b128 v[64:67], v12 offset:1024
  v_mfma_f32_16x16x32_bf16 v[100:103], v[20:23], v[36:39], v[100:103]
  ds_read_b64_tr_b16 v[52:53], v9 offset:8192
  s_waitcnt lgkmcnt(7)
  v_mfma_f32_16x16x32_bf16 v[112:115], v[16:19], v[40:43], v[112:115]
  ds_read_b64_tr_b16 v[54:55], v9 offset:9216
  v_mfma_f32_16x16x32_bf16 v[116:119], v[20:23], v[40:43], v[116:119]
  ds_read_b128 v[68:71], v12 offset:3072
  v_mfma_f32_16x16x32_bf16 v[88:91], v[24:27], v[32:35], v[88:91]
  ds_read_b64_tr_b16 v[56:57], v10 offset:8192
  v_mfma_f32_16x16x32_bf16 v[104:107], v[24:27], v[36:39], v[104:107]
  ds_read_b64_tr_b16 v[58:59], v10 offset:9216
  v_mfma_f32_16x16x32_bf16 v[120:123], v[24:27], v[40:43], v[120:123]
  ds_read_b128 v[72:75], v12 offset:5120
  s_waitcnt lgkmcnt(9)
  v_mfma_f32_16x16x32_bf16 v[128:131], v[16:19], v[44:47], v[128:131]
  ds_read_b64_tr_b16 v[60:61], v11 offset:8192
  v_mfma_f32_16x16x32_bf16 v[132:135], v[20:23], v[44:47], v[132:135]
  ds_read_b64_tr_b16 v[62:63], v11 offset:9216
  v_mfma_f32_16x16x32_bf16 v[136:139], v[24:27], v[44:47], v[136:139]
  ds_read_b128 v[76:79], v12 offset:7168
  v_mfma_f32_16x16x32_bf16 v[92:95], v[28:31], v[32:35], v[92:95]
  v_mfma_f32_16x16x32_bf16 v[108:111], v[28:31], v[36:39], v[108:111]
  v_mfma_f32_16x16x32_bf16 v[124:127], v[28:31], v[40:43], v[124:127]
  v_mfma_f32_16x16x32_bf16 v[140:143], v[28:31], v[44:47], v[140:143]
  s_waitcnt lgkmcnt(9)
  v_mfma_f32_16x16x32_bf16 v[80:83], v[48:51], v[64:67], v[80:83]
  s_waitcnt lgkmcnt(6)
  v_mfma_f32_16x16x32_bf16 v[96:99], v[48:51], v[68:71], v[96:99]
  v_mfma_f32_16x16x32_bf16 v[84:87], v[52:55], v[64:67], v[84:87]
  v_mfma_f32_16x16x32_bf16 v[100:103], v[52:55], v[68:71], v[100:103]
  s_waitcnt lgkmcnt(3)
  v_mfma_f32_16x16x32_bf16 v[112:115], v[48:51], v[72:75], v[112:115]
  v_mfma_f32_16x16x32_bf16 v[116:119], v[52:55], v[72:75], v[116:119]
  v_mfma_f32_16x16x32_bf16 v[88:91], v[56:59], v[64:67], v[88:91]
  v_mfma_f32_16x16x32_bf16 v[104:107], v[56:59], v[68:71], v[104:107]
  v_mfma_f32_16x16x32_bf16 v[120:123], v[56:59], v[72:75], v[120:123]
  s_waitcnt lgkmcnt(0)
  v_mfma_f32_16x16x32_bf16 v[128:131], v[48:51], v[76:79], v[128:131]
  v_mfma_f32_16x16x32_bf16 v[132:135], v[52:55], v[76:79], v[132:135]
  v_mfma_f32_16x16x32_bf16 v[136:139], v[56:59], v[76:79], v[136:139]
  v_mfma_f32_16x16x32_bf16 v[92:95], v[60:63], v[64:67], v[92:95]
  v_mfma_f32_16x16x32_bf16 v[108:111], v[60:63], v[68:71], v[108:111]
  v_mfma_f32_16x16x32_bf16 v[124:127], v[60:63], v[72:75], v[124:127]
  v_mfma_f32_16x16x32_bf16 v[140:143], v[60:63], v[76:79], v[140:143]
  s_waitcnt lgkmcnt(0)
  v_mov_b32 v16, 0xc0135761
  v_mov_b32 v17, 0xbdd2d3e8
  v_pk_mul_f32 v[24:25], v[80:81], v[80:81]
  v_pk_mul_f32 v[26:27], v[82:83], v[82:83]
  v_pk_mul_f32 v[28:29], v[84:85], v[84:85]
  v_pk_mul_f32 v[30:31], v[86:87], v[86:87]
  v_pk_fma_f32 v[24:25], v[24:25], v[16:17], v[16:17] op_sel:[0,1,0] op_sel_hi:[1,1,0]
  v_pk_fma_f32 v[26:27], v[26:27], v[16:17], v[16:17] op_sel:[0,1,0] op_sel_hi:[1,1,0]
  v_pk_fma_f32 v[28:29], v[28:29], v[16:17], v[16:17] op_sel:[0,1,0] op_sel_hi:[1,1,0]
  v_pk_fma_f32 v[30:31], v[30:31], v[16:17], v[16:17] op_sel:[0,1,0] op_sel_hi:[1,1,0]
  v_pk_mul_f32 v[24:25], v[24:25], v[80:81]
  v_pk_mul_f32 v[26:27], v[26:27], v[82:83]
  v_pk_mul_f32 v[28:29], v[28:29], v[84:85]
  v_pk_mul_f32 v[30:31], v[30:31], v[86:87]
  v_exp_f32 v24, v24
  v_exp_f32 v25, v25
  v_exp_f32 v26, v26
  v_exp_f32 v27, v27
  v_exp_f32 v28, v28
  v_exp_f32 v29, v29
  v_exp_f32 v30, v30
  v_exp_f32 v31, v31
  v_pk_add_f32 v[24:25], v[24:25], 1.0 op_sel_hi:[1,0]
  v_pk_add_f32 v[26:27], v[26:27], 1.0 op_sel_hi:[1,0]
  v_pk_add_f32 v[28:29], v[28:29], 1.0 op_sel_hi:[1,0]
  v_pk_add_f32 v[30:31], v[30:31], 1.0 op_sel_hi:[1,0]
  v_rcp_f32 v24, v24
  v_rcp_f32 v25, v25
  v_rcp_f32 v26, v26
  v_rcp_f32 v27, v27
  v_rcp_f32 v28, v28
  v_rcp_f32 v29, v29
  v_rcp_f32 v30, v30
  v_rcp_f32 v31, v31
  v_pk_mul_f32 v[24:25], v[24:25], v[80:81]
  v_pk_mul_f32 v[26:27], v[26:27], v[82:83]
  v_pk_mul_f32 v[28:29], v[28:29], v[84:85]
  v_pk_mul_f32 v[30:31], v[30:31], v[86:87]
  v_cvt_pk_bf16_f32 v164, v24, v25
  v_cvt_pk_bf16_f32 v165, v26, v27
  v_cvt_pk_bf16_f32 v166, v28, v29
  v_cvt_pk_bf16_f32 v167, v30, v31
  s_nop 0
  v_permlane16_swap_b32 v164, v166
  v_permlane16_swap_b32 v165, v167
  buffer_store_dwordx4 v[164:167], v152, s[20:23], s44 offen offset:0 sc0 sc1
  v_pk_mul_f32 v[40:41], v[88:89], v[88:89]
  v_pk_mul_f32 v[42:43], v[90:91], v[90:91]
  v_pk_mul_f32 v[44:45], v[92:93], v[92:93]
  v_pk_mul_f32 v[46:47], v[94:95], v[94:95]
  v_pk_fma_f32 v[40:41], v[40:41], v[16:17], v[16:17] op_sel:[0,1,0] op_sel_hi:[1,1,0]
  v_pk_fma_f32 v[42:43], v[42:43], v[16:17], v[16:17] op_sel:[0,1,0] op_sel_hi:[1,1,0]
  v_pk_fma_f32 v[44:45], v[44:45], v[16:17], v[16:17] op_sel:[0,1,0] op_sel_hi:[1,1,0]
  v_pk_fma_f32 v[46:47], v[46:47], v[16:17], v[16:17] op_sel:[0,1,0] op_sel_hi:[1,1,0]
  v_pk_mul_f32 v[40:41], v[40:41], v[88:89]
  v_pk_mul_f32 v[42:43], v[42:43], v[90:91]
  v_pk_mul_f32 v[44:45], v[44:45], v[92:93]
  v_pk_mul_f32 v[46:47], v[46:47], v[94:95]
  v_exp_f32 v40, v40
  v_exp_f32 v41, v41
  v_exp_f32 v42, v42
  v_exp_f32 v43, v43
  v_exp_f32 v44, v44
  v_exp_f32 v45, v45
  v_exp_f32 v46, v46
  v_exp_f32 v47, v47
  v_pk_add_f32 v[40:41], v[40:41], 1.0 op_sel_hi:[1,0]
  v_pk_add_f32 v[42:43], v[42:43], 1.0 op_sel_hi:[1,0]
  v_pk_add_f32 v[44:45], v[44:45], 1.0 op_sel_hi:[1,0]
  v_pk_add_f32 v[46:47], v[46:47], 1.0 op_sel_hi:[1,0]
  v_rcp_f32 v40, v40
  v_rcp_f32 v41, v41
  v_rcp_f32 v42, v42
  v_rcp_f32 v43, v43
  v_rcp_f32 v44, v44
  v_rcp_f32 v45, v45
  v_rcp_f32 v46, v46
  v_rcp_f32 v47, v47
  v_pk_mul_f32 v[40:41], v[40:41], v[88:89]
  v_pk_mul_f32 v[42:43], v[42:43], v[90:91]
  v_pk_mul_f32 v[44:45], v[44:45], v[92:93]
  v_pk_mul_f32 v[46:47], v[46:47], v[94:95]
  v_cvt_pk_bf16_f32 v168, v40, v41
  v_cvt_pk_bf16_f32 v169, v42, v43
  v_cvt_pk_bf16_f32 v170, v44, v45
  v_cvt_pk_bf16_f32 v171, v46, v47
  s_nop 0
  v_permlane16_swap_b32 v168, v170
  v_permlane16_swap_b32 v169, v171
  buffer_store_dwordx4 v[168:171], v152, s[20:23], s44 offen offset:2048 sc0 sc1
  v_pk_mul_f32 v[24:25], v[96:97], v[96:97]
  v_pk_mul_f32 v[26:27], v[98:99], v[98:99]
  v_pk_mul_f32 v[28:29], v[100:101], v[100:101]
  v_pk_mul_f32 v[30:31], v[102:103], v[102:103]
  v_pk_fma_f32 v[24:25], v[24:25], v[16:17], v[16:17] op_sel:[0,1,0] op_sel_hi:[1,1,0]
  v_pk_fma_f32 v[26:27], v[26:27], v[16:17], v[16:17] op_sel:[0,1,0] op_sel_hi:[1,1,0]
  v_pk_fma_f32 v[28:29], v[28:29], v[16:17], v[16:17] op_sel:[0,1,0] op_sel_hi:[1,1,0]
  v_pk_fma_f32 v[30:31], v[30:31], v[16:17], v[16:17] op_sel:[0,1,0] op_sel_hi:[1,1,0]
  v_pk_mul_f32 v[24:25], v[24:25], v[96:97]
  v_pk_mul_f32 v[26:27], v[26:27], v[98:99]
  v_pk_mul_f32 v[28:29], v[28:29], v[100:101]
  v_pk_mul_f32 v[30:31], v[30:31], v[102:103]
  v_exp_f32 v24, v24
  v_exp_f32 v25, v25
  v_exp_f32 v26, v26
  v_exp_f32 v27, v27
  v_exp_f32 v28, v28
  v_exp_f32 v29, v29
  v_exp_f32 v30, v30
  v_exp_f32 v31, v31
  v_pk_add_f32 v[24:25], v[24:25], 1.0 op_sel_hi:[1,0]
  v_pk_add_f32 v[26:27], v[26:27], 1.0 op_sel_hi:[1,0]
  v_pk_add_f32 v[28:29], v[28:29], 1.0 op_sel_hi:[1,0]
  v_pk_add_f32 v[30:31], v[30:31], 1.0 op_sel_hi:[1,0]
  v_rcp_f32 v24, v24
  v_rcp_f32 v25, v25
  v_rcp_f32 v26, v26
  v_rcp_f32 v27, v27
  v_rcp_f32 v28, v28
  v_rcp_f32 v29, v29
  v_rcp_f32 v30, v30
  v_rcp_f32 v31, v31
  v_pk_mul_f32 v[24:25], v[24:25], v[96:97]
  v_pk_mul_f32 v[26:27], v[26:27], v[98:99]
  v_pk_mul_f32 v[28:29], v[28:29], v[100:101]
  v_pk_mul_f32 v[30:31], v[30:31], v[102:103]
  v_cvt_pk_bf16_f32 v172, v24, v25
  v_cvt_pk_bf16_f32 v173, v26, v27
  v_cvt_pk_bf16_f32 v174, v28, v29
  v_cvt_pk_bf16_f32 v175, v30, v31
  s_nop 0
  v_permlane16_swap_b32 v172, v174
  v_permlane16_swap_b32 v173, v175
  buffer_store_dwordx4 v[172:175], v153, s[20:23], s44 offen offset:0 sc0 sc1
  v_pk_mul_f32 v[40:41], v[104:105], v[104:105]
  v_pk_mul_f32 v[42:43], v[106:107], v[106:107]
  v_pk_mul_f32 v[44:45], v[108:109], v[108:109]
  v_pk_mul_f32 v[46:47], v[110:111], v[110:111]
  v_pk_fma_f32 v[40:41], v[40:41], v[16:17], v[16:17] op_sel:[0,1,0] op_sel_hi:[1,1,0]
  v_pk_fma_f32 v[42:43], v[42:43], v[16:17], v[16:17] op_sel:[0,1,0] op_sel_hi:[1,1,0]
  v_pk_fma_f32 v[44:45], v[44:45], v[16:17], v[16:17] op_sel:[0,1,0] op_sel_hi:[1,1,0]
  v_pk_fma_f32 v[46:47], v[46:47], v[16:17], v[16:17] op_sel:[0,1,0] op_sel_hi:[1,1,0]
  v_pk_mul_f32 v[40:41], v[40:41], v[104:105]
  v_pk_mul_f32 v[42:43], v[42:43], v[106:107]
  v_pk_mul_f32 v[44:45], v[44:45], v[108:109]
  v_pk_mul_f32 v[46:47], v[46:47], v[110:111]
  v_exp_f32 v40, v40
  v_exp_f32 v41, v41
  v_exp_f32 v42, v42
  v_exp_f32 v43, v43
  v_exp_f32 v44, v44
  v_exp_f32 v45, v45
  v_exp_f32 v46, v46
  v_exp_f32 v47, v47
  v_pk_add_f32 v[40:41], v[40:41], 1.0 op_sel_hi:[1,0]
  v_pk_add_f32 v[42:43], v[42:43], 1.0 op_sel_hi:[1,0]
  v_pk_add_f32 v[44:45], v[44:45], 1.0 op_sel_hi:[1,0]
  v_pk_add_f32 v[46:47], v[46:47], 1.0 op_sel_hi:[1,0]
  v_rcp_f32 v40, v40
  v_rcp_f32 v41, v41
  v_rcp_f32 v42, v42
  v_rcp_f32 v43, v43
  v_rcp_f32 v44, v44
  v_rcp_f32 v45, v45
  v_rcp_f32 v46, v46
  v_rcp_f32 v47, v47
  v_pk_mul_f32 v[40:41], v[40:41], v[104:105]
  v_pk_mul_f32 v[42:43], v[42:43], v[106:107]
  v_pk_mul_f32 v[44:45], v[44:45], v[108:109]
  v_pk_mul_f32 v[46:47], v[46:47], v[110:111]
  v_cvt_pk_bf16_f32 v176, v40, v41
  v_cvt_pk_bf16_f32 v177, v42, v43
  v_cvt_pk_bf16_f32 v178, v44, v45
  v_cvt_pk_bf16_f32 v179, v46, v47
  s_nop 0
  v_permlane16_swap_b32 v176, v178
  v_permlane16_swap_b32 v177, v179
  buffer_store_dwordx4 v[176:179], v153, s[20:23], s44 offen offset:2048 sc0 sc1
  v_pk_mul_f32 v[24:25], v[112:113], v[112:113]
  v_pk_mul_f32 v[26:27], v[114:115], v[114:115]
  v_pk_mul_f32 v[28:29], v[116:117], v[116:117]
  v_pk_mul_f32 v[30:31], v[118:119], v[118:119]
  v_pk_fma_f32 v[24:25], v[24:25], v[16:17], v[16:17] op_sel:[0,1,0] op_sel_hi:[1,1,0]
  v_pk_fma_f32 v[26:27], v[26:27], v[16:17], v[16:17] op_sel:[0,1,0] op_sel_hi:[1,1,0]
  v_pk_fma_f32 v[28:29], v[28:29], v[16:17], v[16:17] op_sel:[0,1,0] op_sel_hi:[1,1,0]
  v_pk_fma_f32 v[30:31], v[30:31], v[16:17], v[16:17] op_sel:[0,1,0] op_sel_hi:[1,1,0]
  v_pk_mul_f32 v[24:25], v[24:25], v[112:113]
  v_pk_mul_f32 v[26:27], v[26:27], v[114:115]
  v_pk_mul_f32 v[28:29], v[28:29], v[116:117]
  v_pk_mul_f32 v[30:31], v[30:31], v[118:119]
  v_exp_f32 v24, v24
  v_exp_f32 v25, v25
  v_exp_f32 v26, v26
  v_exp_f32 v27, v27
  v_exp_f32 v28, v28
  v_exp_f32 v29, v29
  v_exp_f32 v30, v30
  v_exp_f32 v31, v31
  v_pk_add_f32 v[24:25], v[24:25], 1.0 op_sel_hi:[1,0]
  v_pk_add_f32 v[26:27], v[26:27], 1.0 op_sel_hi:[1,0]
  v_pk_add_f32 v[28:29], v[28:29], 1.0 op_sel_hi:[1,0]
  v_pk_add_f32 v[30:31], v[30:31], 1.0 op_sel_hi:[1,0]
  v_rcp_f32 v24, v24
  v_rcp_f32 v25, v25
  v_rcp_f32 v26, v26
  v_rcp_f32 v27, v27
  v_rcp_f32 v28, v28
  v_rcp_f32 v29, v29
  v_rcp_f32 v30, v30
  v_rcp_f32 v31, v31
  v_pk_mul_f32 v[24:25], v[24:25], v[112:113]
  v_pk_mul_f32 v[26:27], v[26:27], v[114:115]
  v_pk_mul_f32 v[28:29], v[28:29], v[116:117]
  v_pk_mul_f32 v[30:31], v[30:31], v[118:119]
  v_cvt_pk_bf16_f32 v180, v24, v25
  v_cvt_pk_bf16_f32 v181, v26, v27
  v_cvt_pk_bf16_f32 v182, v28, v29
  v_cvt_pk_bf16_f32 v183, v30, v31
  s_nop 0
  v_permlane16_swap_b32 v180, v182
  v_permlane16_swap_b32 v181, v183
  buffer_store_dwordx4 v[180:183], v152, s[20:23], s45 offen offset:0 sc0 sc1
  v_pk_mul_f32 v[40:41], v[120:121], v[120:121]
  v_pk_mul_f32 v[42:43], v[122:123], v[122:123]
  v_pk_mul_f32 v[44:45], v[124:125], v[124:125]
  v_pk_mul_f32 v[46:47], v[126:127], v[126:127]
  v_pk_fma_f32 v[40:41], v[40:41], v[16:17], v[16:17] op_sel:[0,1,0] op_sel_hi:[1,1,0]
  v_pk_fma_f32 v[42:43], v[42:43], v[16:17], v[16:17] op_sel:[0,1,0] op_sel_hi:[1,1,0]
  v_pk_fma_f32 v[44:45], v[44:45], v[16:17], v[16:17] op_sel:[0,1,0] op_sel_hi:[1,1,0]
  v_pk_fma_f32 v[46:47], v[46:47], v[16:17], v[16:17] op_sel:[0,1,0] op_sel_hi:[1,1,0]
  v_pk_mul_f32 v[40:41], v[40:41], v[120:121]
  v_pk_mul_f32 v[42:43], v[42:43], v[122:123]
  v_pk_mul_f32 v[44:45], v[44:45], v[124:125]
  v_pk_mul_f32 v[46:47], v[46:47], v[126:127]
  v_exp_f32 v40, v40
  v_exp_f32 v41, v41
  v_exp_f32 v42, v42
  v_exp_f32 v43, v43
  v_exp_f32 v44, v44
  v_exp_f32 v45, v45
  v_exp_f32 v46, v46
  v_exp_f32 v47, v47
  v_pk_add_f32 v[40:41], v[40:41], 1.0 op_sel_hi:[1,0]
  v_pk_add_f32 v[42:43], v[42:43], 1.0 op_sel_hi:[1,0]
  v_pk_add_f32 v[44:45], v[44:45], 1.0 op_sel_hi:[1,0]
  v_pk_add_f32 v[46:47], v[46:47], 1.0 op_sel_hi:[1,0]
  v_rcp_f32 v40, v40
  v_rcp_f32 v41, v41
  v_rcp_f32 v42, v42
  v_rcp_f32 v43, v43
  v_rcp_f32 v44, v44
  v_rcp_f32 v45, v45
  v_rcp_f32 v46, v46
  v_rcp_f32 v47, v47
  v_pk_mul_f32 v[40:41], v[40:41], v[120:121]
  v_pk_mul_f32 v[42:43], v[42:43], v[122:123]
  v_pk_mul_f32 v[44:45], v[44:45], v[124:125]
  v_pk_mul_f32 v[46:47], v[46:47], v[126:127]
  v_cvt_pk_bf16_f32 v184, v40, v41
  v_cvt_pk_bf16_f32 v185, v42, v43
  v_cvt_pk_bf16_f32 v186, v44, v45
  v_cvt_pk_bf16_f32 v187, v46, v47
  s_nop 0
  v_permlane16_swap_b32 v184, v186
  v_permlane16_swap_b32 v185, v187
  buffer_store_dwordx4 v[184:187], v152, s[20:23], s45 offen offset:2048 sc0 sc1
  v_pk_mul_f32 v[24:25], v[128:129], v[128:129]
  v_pk_mul_f32 v[26:27], v[130:131], v[130:131]
  v_pk_mul_f32 v[28:29], v[132:133], v[132:133]
  v_pk_mul_f32 v[30:31], v[134:135], v[134:135]
  v_pk_fma_f32 v[24:25], v[24:25], v[16:17], v[16:17] op_sel:[0,1,0] op_sel_hi:[1,1,0]
  v_pk_fma_f32 v[26:27], v[26:27], v[16:17], v[16:17] op_sel:[0,1,0] op_sel_hi:[1,1,0]
  v_pk_fma_f32 v[28:29], v[28:29], v[16:17], v[16:17] op_sel:[0,1,0] op_sel_hi:[1,1,0]
  v_pk_fma_f32 v[30:31], v[30:31], v[16:17], v[16:17] op_sel:[0,1,0] op_sel_hi:[1,1,0]
  v_pk_mul_f32 v[24:25], v[24:25], v[128:129]
  v_pk_mul_f32 v[26:27], v[26:27], v[130:131]
  v_pk_mul_f32 v[28:29], v[28:29], v[132:133]
  v_pk_mul_f32 v[30:31], v[30:31], v[134:135]
  v_exp_f32 v24, v24
  v_exp_f32 v25, v25
  v_exp_f32 v26, v26
  v_exp_f32 v27, v27
  v_exp_f32 v28, v28
  v_exp_f32 v29, v29
  v_exp_f32 v30, v30
  v_exp_f32 v31, v31
  v_pk_add_f32 v[24:25], v[24:25], 1.0 op_sel_hi:[1,0]
  v_pk_add_f32 v[26:27], v[26:27], 1.0 op_sel_hi:[1,0]
  v_pk_add_f32 v[28:29], v[28:29], 1.0 op_sel_hi:[1,0]
  v_pk_add_f32 v[30:31], v[30:31], 1.0 op_sel_hi:[1,0]
  v_rcp_f32 v24, v24
  v_rcp_f32 v25, v25
  v_rcp_f32 v26, v26
  v_rcp_f32 v27, v27
  v_rcp_f32 v28, v28
  v_rcp_f32 v29, v29
  v_rcp_f32 v30, v30
  v_rcp_f32 v31, v31
  v_pk_mul_f32 v[24:25], v[24:25], v[128:129]
  v_pk_mul_f32 v[26:27], v[26:27], v[130:131]
  v_pk_mul_f32 v[28:29], v[28:29], v[132:133]
  v_pk_mul_f32 v[30:31], v[30:31], v[134:135]
  v_cvt_pk_bf16_f32 v188, v24, v25
  v_cvt_pk_bf16_f32 v189, v26, v27
  v_cvt_pk_bf16_f32 v190, v28, v29
  v_cvt_pk_bf16_f32 v191, v30, v31
  s_nop 0
  v_permlane16_swap_b32 v188, v190
  v_permlane16_swap_b32 v189, v191
  buffer_store_dwordx4 v[188:191], v153, s[20:23], s45 offen offset:0 sc0 sc1
  v_pk_mul_f32 v[40:41], v[136:137], v[136:137]
  v_pk_mul_f32 v[42:43], v[138:139], v[138:139]
  v_pk_mul_f32 v[44:45], v[140:141], v[140:141]
  v_pk_mul_f32 v[46:47], v[142:143], v[142:143]
  v_pk_fma_f32 v[40:41], v[40:41], v[16:17], v[16:17] op_sel:[0,1,0] op_sel_hi:[1,1,0]
  v_pk_fma_f32 v[42:43], v[42:43], v[16:17], v[16:17] op_sel:[0,1,0] op_sel_hi:[1,1,0]
  v_pk_fma_f32 v[44:45], v[44:45], v[16:17], v[16:17] op_sel:[0,1,0] op_sel_hi:[1,1,0]
  v_pk_fma_f32 v[46:47], v[46:47], v[16:17], v[16:17] op_sel:[0,1,0] op_sel_hi:[1,1,0]
  v_pk_mul_f32 v[40:41], v[40:41], v[136:137]
  v_pk_mul_f32 v[42:43], v[42:43], v[138:139]
  v_pk_mul_f32 v[44:45], v[44:45], v[140:141]
  v_pk_mul_f32 v[46:47], v[46:47], v[142:143]
  v_exp_f32 v40, v40
  v_exp_f32 v41, v41
  v_exp_f32 v42, v42
  v_exp_f32 v43, v43
  v_exp_f32 v44, v44
  v_exp_f32 v45, v45
  v_exp_f32 v46, v46
  v_exp_f32 v47, v47
  v_pk_add_f32 v[40:41], v[40:41], 1.0 op_sel_hi:[1,0]
  v_pk_add_f32 v[42:43], v[42:43], 1.0 op_sel_hi:[1,0]
  v_pk_add_f32 v[44:45], v[44:45], 1.0 op_sel_hi:[1,0]
  v_pk_add_f32 v[46:47], v[46:47], 1.0 op_sel_hi:[1,0]
  v_rcp_f32 v40, v40
  v_rcp_f32 v41, v41
  v_rcp_f32 v42, v42
  v_rcp_f32 v43, v43
  v_rcp_f32 v44, v44
  v_rcp_f32 v45, v45
  v_rcp_f32 v46, v46
  v_rcp_f32 v47, v47
  v_pk_mul_f32 v[40:41], v[40:41], v[136:137]
  v_pk_mul_f32 v[42:43], v[42:43], v[138:139]
  v_pk_mul_f32 v[44:45], v[44:45], v[140:141]
  v_pk_mul_f32 v[46:47], v[46:47], v[142:143]
  v_cvt_pk_bf16_f32 v192, v40, v41
  v_cvt_pk_bf16_f32 v193, v42, v43
  v_cvt_pk_bf16_f32 v194, v44, v45
  v_cvt_pk_bf16_f32 v195, v46, v47
  s_nop 0
  v_permlane16_swap_b32 v192, v194
  v_permlane16_swap_b32 v193, v195
  buffer_store_dwordx4 v[192:195], v153, s[20:23], s45 offen offset:2048 sc0 sc1
C_k3skip:
  s_nop 7
  s_nop 7
  s_lshr_b32 s32, s2, 3
  s_lshr_b32 s5, s32, 3
  s_and_b32 s6, s32, 7
  s_lshl_b32 s7, s5, 1
  s_add_u32 s7, s7, s6
  s_and_b32 s7, s7, 7
  s_and_b32 s32, s2, 7
  s_lshr_b32 s28, s32, 2
  s_lshl_b32 s28, s28, 2
  s_add_u32 s28, s28, s5
  s_and_b32 s29, s32, 3
  s_mul_i32 s29, s29, 8
  s_add_u32 s29, s29, s6
  s_mov_b32 s30, 7
  s_mov_b32 s31, -1
  s_lshl_b32 s32, s29, 6
  v_add_u32 v13, s32, v4
  v_lshlrev_b32 v12, 11, v13
  v_lshl_add_u32 v12, v5, 4, v12
  s_lshl_b32 s32, s28, 8
  s_lshl_b32 s40, s4, 6
  s_add_u32 s32, s32, s40
  v_add_u32 v12, s32, v12
  v_lshlrev_b32 v13, 1, v13
  v_lshlrev_b32 v14, 4, v0
  s_lshl_b32 s34, s28, 2
  s_add_u32 s34, s34, s4
  s_mul_i32 s34, s34, 229376
  s_mov_b32 s45, 32768
  s_mov_b32 s46, 65536
  s_mov_b32 s47, 98304
  s_add_u32 s8, s82, 12582912
  s_addc_u32 s9, s83, 0
  s_mov_b32 s10, 7340032
  s_mov_b32 s11, 0x20000
  s_add_u32 s16, s82, 4194304
  s_addc_u32 s17, s83, 0
  s_mov_b32 s18, 4194304
  s_mov_b32 s19, 0x20000
  s_mov_b32 s12, s78
  s_mov_b32 s13, s79
  s_mov_b32 s14, 4096
  s_mov_b32 s15, 0x20000
  buffer_load_ushort v112, v13, s[12:15], 0 offen offset:0
  buffer_load_ushort v114, v13, s[12:15], 0 offen offset:32
  buffer_load_ushort v116, v13, s[12:15], 0 offen offset:64
  buffer_load_ushort v118, v13, s[12:15], 0 offen offset:96
  v_lshl_add_u32 v16, v5, 3, v6
  v_lshlrev_b32 v16, 7, v16
  v_lshl_add_u32 v16, v7, 3, v16
  v_lshrrev_b32 v17, 1, v6
  v_lshl_or_b32 v17, v2, 1, v17
  v_lshl_add_u32 v16, v17, 5, v16
  v_add_u32 v16, 98304, v16
  v_xor_b32 v8, 0, v16
  v_xor_b32 v9, 32, v16
  v_xor_b32 v10, 64, v16
  v_xor_b32 v11, 96, v16
  s_lshl_b32 s48, 0x303, s7
  s_lshr_b32 s48, s48, 8
  s_mov_b32 s49, s34
  s_add_u32 s50, s34, 32768
  s_add_u32 s41, s34, 229376
  v_lshlrev_b32 v222, 3, v0
  s_lshl_b32 s32, s4, 9
  s_add_u32 s32, s32, 90112
  v_add_u32 v223, s32, v222
  s_add_u32 s24, s84, 29360128
  s_addc_u32 s25, s85, 0
  s_mov_b32 s26, 262144
  s_mov_b32 s27, 0x20000
  s_lshl_b32 s32, s28, 5
  v_min_u32 v15, 27, v0
  v_add_u32 v15, s32, v15
  v_max_i32 v15, 0, v15
  v_lshlrev_b32 v15, 7, v15
  s_lshl_b32 s55, s3, 17
  s_add_u32 s55, s55, 65536
  s_waitcnt vmcnt(0)
  s_barrier
  s_cmp_lt_u32 s2, 224
  s_cbranch_scc1 C_nopf
  s_cmp_lg_u32 s3, 0
  s_cbranch_scc1 C_nopf
  s_mov_b32 s20, s76
  s_mov_b32 s21, s77
  s_mov_b32 s22, 14680064
  s_mov_b32 s23, 0x20000
  s_sub_u32 s32, s2, 224
  s_lshl_b32 s32, s32, 2
  s_add_u32 s32, s32, s4
  s_lshl_b32 s32, s32, 13
  v_lshlrev_b32 v17, 7, v0
  buffer_load_dword v18, v17, s[20:23], s32 offen
  s_add_u32 s32, s32, 1048576
  buffer_load_dword v18, v17, s[20:23], s32 offen
  s_add_u32 s32, s32, 1048576
  s_waitcnt vmcnt(1)
  buffer_load_dword v18, v17, s[20:23], s32 offen
  s_add_u32 s32, s32, 1048576
  s_waitcnt vmcnt(1)
  buffer_load_dword v18, v17, s[20:23], s32 offen
  s_add_u32 s32, s32, 1048576
  s_waitcnt vmcnt(1)
  buffer_load_dword v18, v17, s[20:23], s32 offen
  s_add_u32 s32, s32, 1048576
  s_waitcnt vmcnt(1)
  buffer_load_dword v18, v17, s[20:23], s32 offen
  s_add_u32 s32, s32, 1048576
  s_waitcnt vmcnt(1)
  buffer_load_dword v18, v17, s[20:23], s32 offen
  s_add_u32 s32, s32, 1048576
  s_waitcnt vmcnt(1)
  buffer_load_dword v18, v17, s[20:23], s32 offen
  s_add_u32 s32, s32, 1048576
  s_waitcnt vmcnt(1)
  buffer_load_dword v18, v17, s[20:23], s32 offen
  s_add_u32 s32, s32, 1048576
  s_waitcnt vmcnt(1)
  buffer_load_dword v18, v17, s[20:23], s32 offen
  s_add_u32 s32, s32, 1048576
  s_waitcnt vmcnt(1)
  buffer_load_dword v18, v17, s[20:23], s32 offen
  s_add_u32 s32, s32, 1048576
  s_waitcnt vmcnt(1)
  buffer_load_dword v18, v17, s[20:23], s32 offen
  s_add_u32 s32, s32, 1048576
  s_waitcnt vmcnt(1)
  buffer_load_dword v18, v17, s[20:23], s32 offen
  s_add_u32 s32, s32, 1048576
  s_waitcnt vmcnt(1)
  buffer_load_dword v18, v17, s[20:23], s32 offen
  s_add_u32 s32, s32, 1048576
  s_waitcnt vmcnt(1)
C_nopf:
  s_mov_b32 s39, 0
  s_and_b32 s32, s4, 3
  s_cmp_lg_u32 s32, 0
  s_cbranch_scc1 poll4d
  s_sleep 8
poll4:
  buffer_load_dword v16, v15, s[24:27], s55 offen sc0 sc1
  s_waitcnt vmcnt(0)
  v_cmp_eq_u32 vcc, 0, v16
  s_add_u32 s39, s39, 1
  s_cmp_gt_u32 s39, 100000
  s_cbranch_scc1 poll4d
  s_cbranch_vccnz poll4
poll4d:
  s_barrier
  buffer_load_dwordx4 v[96:99], v12, s[16:19], 0 offen sc1
  buffer_load_dwordx4 v[100:103], v12, s[16:19], s45 offen sc1
  buffer_load_dwordx4 v[104:107], v12, s[16:19], s46 offen sc1
  buffer_load_dwordx4 v[108:111], v12, s[16:19], s47 offen sc1
  s_cmp_eq_u32 s3, 0
  s_cselect_b32 s24, s84, s80
  s_cselect_b32 s25, s85, s81
  s_cselect_b32 s26, 25165824, 0
  s_add_u32 s24, s24, s26
  s_addc_u32 s25, s25, 0
  s_mov_b32 s26, 4194304
  s_mov_b32 s27, 0x20000
  s_add_u32 s12, s84, 55574528
  s_addc_u32 s13, s85, 0
  s_mov_b32 s14, 131072
  s_mov_b32 s15, 0x20000
  s_bitcmp1_b32 s48, 0
  s_cselect_b32 s36, s50, s49
  s_add_u32 s36, s36, 0
  buffer_load_dwordx4 v[120:123], v14, s[8:11], s36 offen offset:0 sc1
  buffer_load_dwordx4 v[124:127], v14, s[8:11], s36 offen offset:1024 sc1
  buffer_load_dwordx4 v[128:131], v14, s[8:11], s36 offen offset:2048 sc1
  buffer_load_dwordx4 v[132:135], v14, s[8:11], s36 offen offset:3072 sc1
  s_bitcmp1_b32 s48, 1
  s_cselect_b32 s36, s50, s49
  s_add_u32 s36, s36, 4096
  buffer_load_dwordx4 v[136:139], v14, s[8:11], s36 offen offset:0 sc1
  buffer_load_dwordx4 v[140:143], v14, s[8:11], s36 offen offset:1024 sc1
  buffer_load_dwordx4 v[144:147], v14, s[8:11], s36 offen offset:2048 sc1
  buffer_load_dwordx4 v[148:151], v14, s[8:11], s36 offen offset:3072 sc1
  s_waitcnt vmcnt(8)
  v_lshlrev_b32 v112, 16, v112
  v_lshlrev_b32 v48, 16, v96
  v_and_b32 v49, 0xffff0000, v96
  v_lshlrev_b32 v50, 16, v97
  v_and_b32 v51, 0xffff0000, v97
  v_lshlrev_b32 v52, 16, v98
  v_and_b32 v53, 0xffff0000, v98
  v_lshlrev_b32 v54, 16, v99
  v_and_b32 v55, 0xffff0000, v99
  v_pk_add_f32 v[48:49], v[48:49], v[112:113] op_sel_hi:[1,0]
  v_pk_add_f32 v[50:51], v[50:51], v[112:113] op_sel_hi:[1,0]
  v_pk_add_f32 v[52:53], v[52:53], v[112:113] op_sel_hi:[1,0]
  v_pk_add_f32 v[54:55], v[54:55], v[112:113] op_sel_hi:[1,0]
  v_lshlrev_b32 v114, 16, v114
  v_lshlrev_b32 v56, 16, v100
  v_and_b32 v57, 0xffff0000, v100
  v_lshlrev_b32 v58, 16, v101
  v_and_b32 v59, 0xffff0000, v101
  v_lshlrev_b32 v60, 16, v102
  v_and_b32 v61, 0xffff0000, v102
  v_lshlrev_b32 v62, 16, v103
  v_and_b32 v63, 0xffff0000, v103
  v_pk_add_f32 v[56:57], v[56:57], v[114:115] op_sel_hi:[1,0]
  v_pk_add_f32 v[58:59], v[58:59], v[114:115] op_sel_hi:[1,0]
  v_pk_add_f32 v[60:61], v[60:61], v[114:115] op_sel_hi:[1,0]
  v_pk_add_f32 v[62:63], v[62:63], v[114:115] op_sel_hi:[1,0]
  v_lshlrev_b32 v116, 16, v116
  v_lshlrev_b32 v64, 16, v104
  v_and_b32 v65, 0xffff0000, v104
  v_lshlrev_b32 v66, 16, v105
  v_and_b32 v67, 0xffff0000, v105
  v_lshlrev_b32 v68, 16, v106
  v_and_b32 v69, 0xffff0000, v106
  v_lshlrev_b32 v70, 16, v107
  v_and_b32 v71, 0xffff0000, v107
  v_pk_add_f32 v[64:65], v[64:65], v[116:117] op_sel_hi:[1,0]
  v_pk_add_f32 v[66:67], v[66:67], v[116:117] op_sel_hi:[1,0]
  v_pk_add_f32 v[68:69], v[68:69], v[116:117] op_sel_hi:[1,0]
  v_pk_add_f32 v[70:71], v[70:71], v[116:117] op_sel_hi:[1,0]
  v_lshlrev_b32 v118, 16, v118
  v_lshlrev_b32 v72, 16, v108
  v_and_b32 v73, 0xffff0000, v108
  v_lshlrev_b32 v74, 16, v109
  v_and_b32 v75, 0xffff0000, v109
  v_lshlrev_b32 v76, 16, v110
  v_and_b32 v77, 0xffff0000, v110
  v_lshlrev_b32 v78, 16, v111
  v_and_b32 v79, 0xffff0000, v111
  v_pk_add_f32 v[72:73], v[72:73], v[118:119] op_sel_hi:[1,0]
  v_pk_add_f32 v[74:75], v[74:75], v[118:119] op_sel_hi:[1,0]
  v_pk_add_f32 v[76:77], v[76:77], v[118:119] op_sel_hi:[1,0]
  v_pk_add_f32 v[78:79], v[78:79], v[118:119] op_sel_hi:[1,0]
  s_bitcmp1_b32 s48, 2
  s_cselect_b32 s36, s50, s49
  s_add_u32 s36, s36, 8192
  buffer_load_dwordx4 v[152:155], v14, s[8:11], s36 offen offset:0 sc1
  buffer_load_dwordx4 v[156:159], v14, s[8:11], s36 offen offset:1024 sc1
  buffer_load_dwordx4 v[160:163], v14, s[8:11], s36 offen offset:2048 sc1
  buffer_load_dwordx4 v[164:167], v14, s[8:11], s36 offen offset:3072 sc1
  s_bitcmp1_b32 s48, 3
  s_cselect_b32 s36, s50, s49
  s_add_u32 s36, s36, 12288
  buffer_load_dwordx4 v[168:171], v14, s[8:11], s36 offen offset:0 sc1
  buffer_load_dwordx4 v[172:175], v14, s[8:11], s36 offen offset:1024 sc1
  s_mov_b32 s43, 0
  s_mov_b32 s39, 6
  s_barrier
  ds_read_b64_tr_b16 v[16:17], v8 offset:0
  ds_read_b64_tr_b16 v[18:19], v8 offset:512
  ds_read_b64_tr_b16 v[20:21], v9 offset:0
  ds_read_b64_tr_b16 v[22:23], v9 offset:512
  ds_read_b64_tr_b16 v[24:25], v10 offset:0
  ds_read_b64_tr_b16 v[26:27], v10 offset:512
  ds_read_b64_tr_b16 v[28:29], v11 offset:0
  ds_read_b64_tr_b16 v[30:31], v11 offset:512
  s_add_u32 s40, s43, 8192
  s_cmp_eq_u32 s40, 65536
  s_cselect_b32 s40, 0, s40
  s_sub_u32 s42, s40, s43
  s_mov_b32 s43, s40
cd5:
  s_waitcnt vmcnt(13) lgkmcnt(6)
  v_mfma_f32_16x16x32_bf16 v[48:51], v[120:123], v[16:19], v[48:51]
  ds_read_b64_tr_b16 v[32:33], v8 offset:4096
  s_waitcnt vmcnt(12)
  v_mfma_f32_16x16x32_bf16 v[52:55], v[124:127], v[16:19], v[52:55]
  ds_read_b64_tr_b16 v[34:35], v8 offset:4608
  v_add_u32 v8, s42, v8
  s_waitcnt lgkmcnt(6)
  v_mfma_f32_16x16x32_bf16 v[56:59], v[120:123], v[20:23], v[56:59]
  ds_read_b64_tr_b16 v[36:37], v9 offset:4096
  buffer_load_dwordx4 v[176:179], v14, s[8:11], s36 offen offset:2048 sc1
  v_mfma_f32_16x16x32_bf16 v[60:63], v[124:127], v[20:23], v[60:63]
  ds_read_b64_tr_b16 v[38:39], v9 offset:4608
  v_add_u32 v9, s42, v9
  s_waitcnt lgkmcnt(6)
  v_mfma_f32_16x16x32_bf16 v[64:67], v[120:123], v[24:27], v[64:67]
  ds_read_b64_tr_b16 v[40:41], v10 offset:4096
  v_mfma_f32_16x16x32_bf16 v[68:71], v[124:127], v[24:27], v[68:71]
  ds_read_b64_tr_b16 v[42:43], v10 offset:4608
  v_add_u32 v10, s42, v10
  s_waitcnt lgkmcnt(6)
  v_mfma_f32_16x16x32_bf16 v[72:75], v[120:123], v[28:31], v[72:75]
  ds_read_b64_tr_b16 v[44:45], v11 offset:4096
  buffer_load_dwordx4 v[180:183], v14, s[8:11], s36 offen offset:3072 sc1
  v_mfma_f32_16x16x32_bf16 v[76:79], v[124:127], v[28:31], v[76:79]
  ds_read_b64_tr_b16 v[46:47], v11 offset:4608
  v_add_u32 v11, s42, v11
  s_barrier
  s_waitcnt vmcnt(13) lgkmcnt(6)
  v_mfma_f32_16x16x32_bf16 v[48:51], v[128:131], v[32:35], v[48:51]
  ds_read_b64_tr_b16 v[16:17], v8 offset:0
  s_bitcmp1_b32 s48, 4
  s_cselect_b32 s36, s50, s49
  s_waitcnt vmcnt(12)
  v_mfma_f32_16x16x32_bf16 v[52:55], v[132:135], v[32:35], v[52:55]
  ds_read_b64_tr_b16 v[18:19], v8 offset:512
  s_add_u32 s36, s36, 16384
  s_add_u32 s40, s43, 8192
  s_waitcnt lgkmcnt(6)
  v_mfma_f32_16x16x32_bf16 v[56:59], v[128:131], v[36:39], v[56:59]
  ds_read_b64_tr_b16 v[20:21], v9 offset:0
  s_cmp_eq_u32 s40, 65536
  s_cselect_b32 s40, 0, s40
  v_mfma_f32_16x16x32_bf16 v[60:63], v[132:135], v[36:39], v[60:63]
  ds_read_b64_tr_b16 v[22:23], v9 offset:512
  s_sub_u32 s42, s40, s43
  s_mov_b32 s43, s40
  s_waitcnt lgkmcnt(6)
  v_mfma_f32_16x16x32_bf16 v[64:67], v[128:131], v[40:43], v[64:67]
  ds_read_b64_tr_b16 v[24:25], v10 offset:0
  buffer_load_dwordx4 v[120:123], v14, s[8:11], s36 offen offset:0 sc1
  v_mfma_f32_16x16x32_bf16 v[68:71], v[132:135], v[40:43], v[68:71]
  ds_read_b64_tr_b16 v[26:27], v10 offset:512
  s_waitcnt lgkmcnt(6)
  v_mfma_f32_16x16x32_bf16 v[72:75], v[128:131], v[44:47], v[72:75]
  ds_read_b64_tr_b16 v[28:29], v11 offset:0
  v_mfma_f32_16x16x32_bf16 v[76:79], v[132:135], v[44:47], v[76:79]
  ds_read_b64_tr_b16 v[30:31], v11 offset:512
  buffer_load_dwordx4 v[124:127], v14, s[8:11], s36 offen offset:1024 sc1
  s_waitcnt vmcnt(13) lgkmcnt(6)
  v_mfma_f32_16x16x32_bf16 v[48:51], v[136:139], v[16:19], v[48:51]
  ds_read_b64_tr_b16 v[32:33], v8 offset:4096
  s_waitcnt vmcnt(12)
  v_mfma_f32_16x16x32_bf16 v[52:55], v[140:143], v[16:19], v[52:55]
  ds_read_b64_tr_b16 v[34:35], v8 offset:4608
  v_add_u32 v8, s42, v8
  s_waitcnt lgkmcnt(6)
  v_mfma_f32_16x16x32_bf16 v[56:59], v[136:139], v[20:23], v[56:59]
  ds_read_b64_tr_b16 v[36:37], v9 offset:4096
  buffer_load_dwordx4 v[128:131], v14, s[8:11], s36 offen offset:2048 sc1
  v_mfma_f32_16x16x32_bf16 v[60:63], v[140:143], v[20:23], v[60:63]
  ds_read_b64_tr_b16 v[38:39], v9 offset:4608
  v_add_u32 v9, s42, v9
  s_waitcnt lgkmcnt(6)
  v_mfma_f32_16x16x32_bf16 v[64:67], v[136:139], v[24:27], v[64:67]
  ds_read_b64_tr_b16 v[40:41], v10 offset:4096
  v_mfma_f32_16x16x32_bf16 v[68:71], v[140:143], v[24:27], v[68:71]
  ds_read_b64_tr_b16 v[42:43], v10 offset:4608
  v_add_u32 v10, s42, v10
  s_waitcnt lgkmcnt(6)
  v_mfma_f32_16x16x32_bf16 v[72:75], v[136:139], v[28:31], v[72:75]
  ds_read_b64_tr_b16 v[44:45], v11 offset:4096
  buffer_load_dwordx4 v[132:135], v14, s[8:11], s36 offen offset:3072 sc1
  v_mfma_f32_16x16x32_bf16 v[76:79], v[140:143], v[28:31], v[76:79]
  ds_read_b64_tr_b16 v[46:47], v11 offset:4608
  v_add_u32 v11, s42, v11
  s_barrier
  s_waitcnt vmcnt(13) lgkmcnt(6)
  v_mfma_f32_16x16x32_bf16 v[48:51], v[144:147], v[32:35], v[48:51]
  ds_read_b64_tr_b16 v[16:17], v8 offset:0
  s_bitcmp1_b32 s48, 5
  s_cselect_b32 s36, s50, s49
  s_waitcnt vmcnt(12)
  v_mfma_f32_16x16x32_bf16 v[52:55], v[148:151], v[32:35], v[52:55]
  ds_read_b64_tr_b16 v[18:19], v8 offset:512
  s_add_u32 s36, s36, 20480
  s_add_u32 s40, s43, 8192
  s_waitcnt lgkmcnt(6)
  v_mfma_f32_16x16x32_bf16 v[56:59], v[144:147], v[36:39], v[56:59]
  ds_read_b64_tr_b16 v[20:21], v9 offset:0
  s_cmp_eq_u32 s40, 65536
  s_cselect_b32 s40, 0, s40
  v_mfma_f32_16x16x32_bf16 v[60:63], v[148:151], v[36:39], v[60:63]
  ds_read_b64_tr_b16 v[22:23], v9 offset:512
  s_sub_u32 s42, s40, s43
  s_mov_b32 s43, s40
  s_waitcnt lgkmcnt(6)
  v_mfma_f32_16x16x32_bf16 v[64:67], v[144:147], v[40:43], v[64:67]
  ds_read_b64_tr_b16 v[24:25], v10 offset:0
  buffer_load_dwordx4 v[136:139], v14, s[8:11], s36 offen offset:0 sc1
  v_mfma_f32_16x16x32_bf16 v[68:71], v[148:151], v[40:43], v[68:71]
  ds_read_b64_tr_b16 v[26:27], v10 offset:512
  s_waitcnt lgkmcnt(6)
  v_mfma_f32_16x16x32_bf16 v[72:75], v[144:147], v[44:47], v[72:75]
  ds_read_b64_tr_b16 v[28:29], v11 offset:0
  v_mfma_f32_16x16x32_bf16 v[76:79], v[148:151], v[44:47], v[76:79]
  ds_read_b64_tr_b16 v[30:31], v11 offset:512
  buffer_load_dwordx4 v[140:143], v14, s[8:11], s36 offen offset:1024 sc1
  s_waitcnt vmcnt(13) lgkmcnt(6)
  v_mfma_f32_16x16x32_bf16 v[48:51], v[152:155], v[16:19], v[48:51]
  ds_read_b64_tr_b16 v[32:33], v8 offset:4096
  s_waitcnt vmcnt(12)
  v_mfma_f32_16x16x32_bf16 v[52:55], v[156:159], v[16:19], v[52:55]
  ds_read_b64_tr_b16 v[34:35], v8 offset:4608
  v_add_u32 v8, s42, v8
  s_waitcnt lgkmcnt(6)
  v_mfma_f32_16x16x32_bf16 v[56:59], v[152:155], v[20:23], v[56:59]
  ds_read_b64_tr_b16 v[36:37], v9 offset:4096
  buffer_load_dwordx4 v[144:147], v14, s[8:11], s36 offen offset:2048 sc1
  v_mfma_f32_16x16x32_bf16 v[60:63], v[156:159], v[20:23], v[60:63]
  ds_read_b64_tr_b16 v[38:39], v9 offset:4608
  v_add_u32 v9, s42, v9
  s_waitcnt lgkmcnt(6)
  v_mfma_f32_16x16x32_bf16 v[64:67], v[152:155], v[24:27], v[64:67]
  ds_read_b64_tr_b16 v[40:41], v10 offset:4096
  v_mfma_f32_16x16x32_bf16 v[68:71], v[156:159], v[24:27], v[68:71]
  ds_read_b64_tr_b16 v[42:43], v10 offset:4608
  v_add_u32 v10, s42, v10
  s_waitcnt lgkmcnt(6)
  v_mfma_f32_16x16x32_bf16 v[72:75], v[152:155], v[28:31], v[72:75]
  ds_read_b64_tr_b16 v[44:45], v11 offset:4096
  buffer_load_dwordx4 v[148:151], v14, s[8:11], s36 offen offset:3072 sc1
  v_mfma_f32_16x16x32_bf16 v[76:79], v[156:159], v[28:31], v[76:79]
  ds_read_b64_tr_b16 v[46:47], v11 offset:4608
  v_add_u32 v11, s42, v11
  s_barrier
  s_waitcnt vmcnt(13) lgkmcnt(6)
  v_mfma_f32_16x16x32_bf16 v[48:51], v[160:163], v[32:35], v[48:51]
  ds_read_b64_tr_b16 v[16:17], v8 offset:0
  s_bitcmp1_b32 s48, 6
  s_cselect_b32 s36, s50, s49
  s_waitcnt vmcnt(12)
  v_mfma_f32_16x16x32_bf16 v[52:55], v[164:167], v[32:35], v[52:55]
  ds_read_b64_tr_b16 v[18:19], v8 offset:512
  s_add_u32 s36, s36, 24576
  s_add_u32 s40, s43, 8192
  s_waitcnt lgkmcnt(6)
  v_mfma_f32_16x16x32_bf16 v[56:59], v[160:163], v[36:39], v[56:59]
  ds_read_b64_tr_b16 v[20:21], v9 offset:0
  s_cmp_eq_u32 s40, 65536
  s_cselect_b32 s40, 0, s40
  v_mfma_f32_16x16x32_bf16 v[60:63], v[164:167], v[36:39], v[60:63]
  ds_read_b64_tr_b16 v[22:23], v9 offset:512
  s_sub_u32 s42, s40, s43
  s_mov_b32 s43, s40
  s_waitcnt lgkmcnt(6)
  v_mfma_f32_16x16x32_bf16 v[64:67], v[160:163], v[40:43], v[64:67]
  ds_read_b64_tr_b16 v[24:25], v10 offset:0
  buffer_load_dwordx4 v[152:155], v14, s[8:11], s36 offen offset:0 sc1
  v_mfma_f32_16x16x32_bf16 v[68:71], v[164:167], v[40:43], v[68:71]
  ds_read_b64_tr_b16 v[26:27], v10 offset:512
  s_waitcnt lgkmcnt(6)
  v_mfma_f32_16x16x32_bf16 v[72:75], v[160:163], v[44:47], v[72:75]
  ds_read_b64_tr_b16 v[28:29], v11 offset:0
  v_mfma_f32_16x16x32_bf16 v[76:79], v[164:167], v[44:47], v[76:79]
  ds_read_b64_tr_b16 v[30:31], v11 offset:512
  buffer_load_dwordx4 v[156:159], v14, s[8:11], s36 offen offset:1024 sc1
  s_waitcnt vmcnt(13) lgkmcnt(6)
  v_mfma_f32_16x16x32_bf16 v[48:51], v[168:171], v[16:19], v[48:51]
  ds_read_b64_tr_b16 v[32:33], v8 offset:4096
  s_waitcnt vmcnt(12)
  v_mfma_f32_16x16x32_bf16 v[52:55], v[172:175], v[16:19], v[52:55]
  ds_read_b64_tr_b16 v[34:35], v8 offset:4608
  v_add_u32 v8, s42, v8
  s_waitcnt lgkmcnt(6)
  v_mfma_f32_16x16x32_bf16 v[56:59], v[168:171], v[20:23], v[56:59]
  ds_read_b64_tr_b16 v[36:37], v9 offset:4096
  buffer_load_dwordx4 v[160:163], v14, s[8:11], s36 offen offset:2048 sc1
  v_mfma_f32_16x16x32_bf16 v[60:63], v[172:175], v[20:23], v[60:63]
  ds_read_b64_tr_b16 v[38:39], v9 offset:4608
  v_add_u32 v9, s42, v9
  s_waitcnt lgkmcnt(6)
  v_mfma_f32_16x16x32_bf16 v[64:67], v[168:171], v[24:27], v[64:67]
  ds_read_b64_tr_b16 v[40:41], v10 offset:4096
  v_mfma_f32_16x16x32_bf16 v[68:71], v[172:175], v[24:27], v[68:71]
  ds_read_b64_tr_b16 v[42:43], v10 offset:4608
  v_add_u32 v10, s42, v10
  s_waitcnt lgkmcnt(6)
  v_mfma_f32_16x16x32_bf16 v[72:75], v[168:171], v[28:31], v[72:75]
  ds_read_b64_tr_b16 v[44:45], v11 offset:4096
  buffer_load_dwordx4 v[164:167], v14, s[8:11], s36 offen offset:3072 sc1
  v_mfma_f32_16x16x32_bf16 v[76:79], v[172:175], v[28:31], v[76:79]
  ds_read_b64_tr_b16 v[46:47], v11 offset:4608
  v_add_u32 v11, s42, v11
  s_barrier
  s_waitcnt vmcnt(13) lgkmcnt(6)
  v_mfma_f32_16x16x32_bf16 v[48:51], v[176:179], v[32:35], v[48:51]
  ds_read_b64_tr_b16 v[16:17], v8 offset:0
  s_bitcmp1_b32 s48, 7
  s_cselect_b32 s36, s50, s49
  s_waitcnt vmcnt(12)
  v_mfma_f32_16x16x32_bf16 v[52:55], v[180:183], v[32:35], v[52:55]
  ds_read_b64_tr_b16 v[18:19], v8 offset:512
  s_add_u32 s36, s36, 28672
  s_add_u32 s40, s43, 8192
  s_waitcnt lgkmcnt(6)
  v_mfma_f32_16x16x32_bf16 v[56:59], v[176:179], v[36:39], v[56:59]
  ds_read_b64_tr_b16 v[20:21], v9 offset:0
  s_cmp_eq_u32 s40, 65536
  s_cselect_b32 s40, 0, s40
  v_mfma_f32_16x16x32_bf16 v[60:63], v[180:183], v[36:39], v[60:63]
  ds_read_b64_tr_b16 v[22:23], v9 offset:512
  s_sub_u32 s42, s40, s43
  s_mov_b32 s43, s40
  s_waitcnt lgkmcnt(6)
  v_mfma_f32_16x16x32_bf16 v[64:67], v[176:179], v[40:43], v[64:67]
  ds_read_b64_tr_b16 v[24:25], v10 offset:0
  buffer_load_dwordx4 v[168:171], v14, s[8:11], s36 offen offset:0 sc1
  v_mfma_f32_16x16x32_bf16 v[68:71], v[180:183], v[40:43], v[68:71]
  ds_read_b64_tr_b16 v[26:27], v10 offset:512
  s_waitcnt lgkmcnt(6)
  v_mfma_f32_16x16x32_bf16 v[72:75], v[176:179], v[44:47], v[72:75]
  ds_read_b64_tr_b16 v[28:29], v11 offset:0
  v_mfma_f32_16x16x32_bf16 v[76:79], v[180:183], v[44:47], v[76:79]
  ds_read_b64_tr_b16 v[30:31], v11 offset:512
  buffer_load_dwordx4 v[172:175], v14, s[8:11], s36 offen offset:1024 sc1
  s_waitcnt vmcnt(13) lgkmcnt(6)
  v_mfma_f32_16x16x32_bf16 v[48:51], v[120:123], v[16:19], v[48:51]
  ds_read_b64_tr_b16 v[32:33], v8 offset:4096
  s_waitcnt vmcnt(12)
  v_mfma_f32_16x16x32_bf16 v[52:55], v[124:127], v[16:19], v[52:55]
  ds_read_b64_tr_b16 v[34:35], v8 offset:4608
  v_add_u32 v8, s42, v8
  s_waitcnt lgkmcnt(6)
  v_mfma_f32_16x16x32_bf16 v[56:59], v[120:123], v[20:23], v[56:59]
  ds_read_b64_tr_b16 v[36:37], v9 offset:4096
  buffer_load_dwordx4 v[176:179], v14, s[8:11], s36 offen offset:2048 sc1
  v_mfma_f32_16x16x32_bf16 v[60:63], v[124:127], v[20:23], v[60:63]
  ds_read_b64_tr_b16 v[38:39], v9 offset:4608
  v_add_u32 v9, s42, v9
  s_waitcnt lgkmcnt(6)
  v_mfma_f32_16x16x32_bf16 v[64:67], v[120:123], v[24:27], v[64:67]
  ds_read_b64_tr_b16 v[40:41], v10 offset:4096
  v_mfma_f32_16x16x32_bf16 v[68:71], v[124:127], v[24:27], v[68:71]
  ds_read_b64_tr_b16 v[42:43], v10 offset:4608
  v_add_u32 v10, s42, v10
  s_waitcnt lgkmcnt(6)
  v_mfma_f32_16x16x32_bf16 v[72:75], v[120:123], v[28:31], v[72:75]
  ds_read_b64_tr_b16 v[44:45], v11 offset:4096
  buffer_load_dwordx4 v[180:183], v14, s[8:11], s36 offen offset:3072 sc1
  v_mfma_f32_16x16x32_bf16 v[76:79], v[124:127], v[28:31], v[76:79]
  ds_read_b64_tr_b16 v[46:47], v11 offset:4608
  v_add_u32 v11, s42, v11
  s_barrier
  s_waitcnt vmcnt(13) lgkmcnt(6)
  v_mfma_f32_16x16x32_bf16 v[48:51], v[128:131], v[32:35], v[48:51]
  ds_read_b64_tr_b16 v[16:17], v8 offset:0
  s_mov_b32 s49, s50
  s_add_u32 s50, s50, 32768
  s_waitcnt vmcnt(12)
  v_mfma_f32_16x16x32_bf16 v[52:55], v[132:135], v[32:35], v[52:55]
  ds_read_b64_tr_b16 v[18:19], v8 offset:512
  s_cmp_eq_u32 s50, s41
  s_cselect_b32 s50, s34, s50
  s_waitcnt lgkmcnt(6)
  v_mfma_f32_16x16x32_bf16 v[56:59], v[128:131], v[36:39], v[56:59]
  ds_read_b64_tr_b16 v[20:21], v9 offset:0
  s_bitcmp1_b32 s48, 0
  s_cselect_b32 s36, s50, s49
  v_mfma_f32_16x16x32_bf16 v[60:63], v[132:135], v[36:39], v[60:63]
  ds_read_b64_tr_b16 v[22:23], v9 offset:512
  s_add_u32 s36, s36, 0
  s_add_u32 s40, s43, 8192
  s_waitcnt lgkmcnt(6)
  v_mfma_f32_16x16x32_bf16 v[64:67], v[128:131], v[40:43], v[64:67]
  ds_read_b64_tr_b16 v[24:25], v10 offset:0
  s_cmp_eq_u32 s40, 65536
  s_cselect_b32 s40, 0, s40
  buffer_load_dwordx4 v[120:123], v14, s[8:11], s36 offen offset:0 sc1
  v_mfma_f32_16x16x32_bf16 v[68:71], v[132:135], v[40:43], v[68:71]
  ds_read_b64_tr_b16 v[26:27], v10 offset:512
  s_sub_u32 s42, s40, s43
  s_mov_b32 s43, s40
  s_waitcnt lgkmcnt(6)
  v_mfma_f32_16x16x32_bf16 v[72:75], v[128:131], v[44:47], v[72:75]
  ds_read_b64_tr_b16 v[28:29], v11 offset:0
  v_mfma_f32_16x16x32_bf16 v[76:79], v[132:135], v[44:47], v[76:79]
  ds_read_b64_tr_b16 v[30:31], v11 offset:512
  buffer_load_dwordx4 v[124:127], v14, s[8:11], s36 offen offset:1024 sc1
  s_waitcnt vmcnt(13) lgkmcnt(6)
  v_mfma_f32_16x16x32_bf16 v[48:51], v[136:139], v[16:19], v[48:51]
  ds_read_b64_tr_b16 v[32:33], v8 offset:4096
  s_waitcnt vmcnt(12)
  v_mfma_f32_16x16x32_bf16 v[52:55], v[140:143], v[16:19], v[52:55]
  ds_read_b64_tr_b16 v[34:35], v8 offset:4608
  v_add_u32 v8, s42, v8
  s_waitcnt lgkmcnt(6)
  v_mfma_f32_16x16x32_bf16 v[56:59], v[136:139], v[20:23], v[56:59]
  ds_read_b64_tr_b16 v[36:37], v9 offset:4096
  buffer_load_dwordx4 v[128:131], v14, s[8:11], s36 offen offset:2048 sc1
  v_mfma_f32_16x16x32_bf16 v[60:63], v[140:143], v[20:23], v[60:63]
  ds_read_b64_tr_b16 v[38:39], v9 offset:4608
  v_add_u32 v9, s42, v9
  s_waitcnt lgkmcnt(6)
  v_mfma_f32_16x16x32_bf16 v[64:67], v[136:139], v[24:27], v[64:67]
  ds_read_b64_tr_b16 v[40:41], v10 offset:4096
  v_mfma_f32_16x16x32_bf16 v[68:71], v[140:143], v[24:27], v[68:71]
  ds_read_b64_tr_b16 v[42:43], v10 offset:4608
  v_add_u32 v10, s42, v10
  s_waitcnt lgkmcnt(6)
  v_mfma_f32_16x16x32_bf16 v[72:75], v[136:139], v[28:31], v[72:75]
  ds_read_b64_tr_b16 v[44:45], v11 offset:4096
  buffer_load_dwordx4 v[132:135], v14, s[8:11], s36 offen offset:3072 sc1
  v_mfma_f32_16x16x32_bf16 v[76:79], v[140:143], v[28:31], v[76:79]
  ds_read_b64_tr_b16 v[46:47], v11 offset:4608
  v_add_u32 v11, s42, v11
  s_barrier
  s_waitcnt vmcnt(13) lgkmcnt(6)
  v_mfma_f32_16x16x32_bf16 v[48:51], v[144:147], v[32:35], v[48:51]
  ds_read_b64_tr_b16 v[16:17], v8 offset:0
  s_bitcmp1_b32 s48, 1
  s_cselect_b32 s36, s50, s49
  s_waitcnt vmcnt(12)
  v_mfma_f32_16x16x32_bf16 v[52:55], v[148:151], v[32:35], v[52:55]
  ds_read_b64_tr_b16 v[18:19], v8 offset:512
  s_add_u32 s36, s36, 4096
  s_add_u32 s40, s43, 8192
  s_waitcnt lgkmcnt(6)
  v_mfma_f32_16x16x32_bf16 v[56:59], v[144:147], v[36:39], v[56:59]
  ds_read_b64_tr_b16 v[20:21], v9 offset:0
  s_cmp_eq_u32 s40, 65536
  s_cselect_b32 s40, 0, s40
  v_mfma_f32_16x16x32_bf16 v[60:63], v[148:151], v[36:39], v[60:63]
  ds_read_b64_tr_b16 v[22:23], v9 offset:512
  s_sub_u32 s42, s40, s43
  s_mov_b32 s43, s40
  s_waitcnt lgkmcnt(6)
  v_mfma_f32_16x16x32_bf16 v[64:67], v[144:147], v[40:43], v[64:67]
  ds_read_b64_tr_b16 v[24:25], v10 offset:0
  buffer_load_dwordx4 v[136:139], v14, s[8:11], s36 offen offset:0 sc1
  v_mfma_f32_16x16x32_bf16 v[68:71], v[148:151], v[40:43], v[68:71]
  ds_read_b64_tr_b16 v[26:27], v10 offset:512
  s_waitcnt lgkmcnt(6)
  v_mfma_f32_16x16x32_bf16 v[72:75], v[144:147], v[44:47], v[72:75]
  ds_read_b64_tr_b16 v[28:29], v11 offset:0
  v_mfma_f32_16x16x32_bf16 v[76:79], v[148:151], v[44:47], v[76:79]
  ds_read_b64_tr_b16 v[30:31], v11 offset:512
  buffer_load_dwordx4 v[140:143], v14, s[8:11], s36 offen offset:1024 sc1
  s_waitcnt vmcnt(13) lgkmcnt(6)
  v_mfma_f32_16x16x32_bf16 v[48:51], v[152:155], v[16:19], v[48:51]
  ds_read_b64_tr_b16 v[32:33], v8 offset:4096
  s_waitcnt vmcnt(12)
  v_mfma_f32_16x16x32_bf16 v[52:55], v[156:159], v[16:19], v[52:55]
  ds_read_b64_tr_b16 v[34:35], v8 offset:4608
  v_add_u32 v8, s42, v8
  s_waitcnt lgkmcnt(6)
  v_mfma_f32_16x16x32_bf16 v[56:59], v[152:155], v[20:23], v[56:59]
  ds_read_b64_tr_b16 v[36:37], v9 offset:4096
  buffer_load_dwordx4 v[144:147], v14, s[8:11], s36 offen offset:2048 sc1
  v_mfma_f32_16x16x32_bf16 v[60:63], v[156:159], v[20:23], v[60:63]
  ds_read_b64_tr_b16 v[38:39], v9 offset:4608
  v_add_u32 v9, s42, v9
  s_waitcnt lgkmcnt(6)
  v_mfma_f32_16x16x32_bf16 v[64:67], v[152:155], v[24:27], v[64:67]
  ds_read_b64_tr_b16 v[40:41], v10 offset:4096
  v_mfma_f32_16x16x32_bf16 v[68:71], v[156:159], v[24:27], v[68:71]
  ds_read_b64_tr_b16 v[42:43], v10 offset:4608
  v_add_u32 v10, s42, v10
  s_waitcnt lgkmcnt(6)
  v_mfma_f32_16x16x32_bf16 v[72:75], v[152:155], v[28:31], v[72:75]
  ds_read_b64_tr_b16 v[44:45], v11 offset:4096
  buffer_load_dwordx4 v[148:151], v14, s[8:11], s36 offen offset:3072 sc1
  v_mfma_f32_16x16x32_bf16 v[76:79], v[156:159], v[28:31], v[76:79]
  ds_read_b64_tr_b16 v[46:47], v11 offset:4608
  v_add_u32 v11, s42, v11
  s_barrier
  s_waitcnt vmcnt(13) lgkmcnt(6)
  v_mfma_f32_16x16x32_bf16 v[48:51], v[160:163], v[32:35], v[48:51]
  ds_read_b64_tr_b16 v[16:17], v8 offset:0
  s_bitcmp1_b32 s48, 2
  s_cselect_b32 s36, s50, s49
  s_waitcnt vmcnt(12)
  v_mfma_f32_16x16x32_bf16 v[52:55], v[164:167], v[32:35], v[52:55]
  ds_read_b64_tr_b16 v[18:19], v8 offset:512
  s_add_u32 s36, s36, 8192
  s_add_u32 s40, s43, 8192
  s_waitcnt lgkmcnt(6)
  v_mfma_f32_16x16x32_bf16 v[56:59], v[160:163], v[36:39], v[56:59]
  ds_read_b64_tr_b16 v[20:21], v9 offset:0
  s_cmp_eq_u32 s40, 65536
  s_cselect_b32 s40, 0, s40
  v_mfma_f32_16x16x32_bf16 v[60:63], v[164:167], v[36:39], v[60:63]
  ds_read_b64_tr_b16 v[22:23], v9 offset:512
  s_sub_u32 s42, s40, s43
  s_mov_b32 s43, s40
  s_waitcnt lgkmcnt(6)
  v_mfma_f32_16x16x32_bf16 v[64:67], v[160:163], v[40:43], v[64:67]
  ds_read_b64_tr_b16 v[24:25], v10 offset:0
  buffer_load_dwordx4 v[152:155], v14, s[8:11], s36 offen offset:0 sc1
  v_mfma_f32_16x16x32_bf16 v[68:71], v[164:167], v[40:43], v[68:71]
  ds_read_b64_tr_b16 v[26:27], v10 offset:512
  s_waitcnt lgkmcnt(6)
  v_mfma_f32_16x16x32_bf16 v[72:75], v[160:163], v[44:47], v[72:75]
  ds_read_b64_tr_b16 v[28:29], v11 offset:0
  v_mfma_f32_16x16x32_bf16 v[76:79], v[164:167], v[44:47], v[76:79]
  ds_read_b64_tr_b16 v[30:31], v11 offset:512
  buffer_load_dwordx4 v[156:159], v14, s[8:11], s36 offen offset:1024 sc1
  s_waitcnt vmcnt(13) lgkmcnt(6)
  v_mfma_f32_16x16x32_bf16 v[48:51], v[168:171], v[16:19], v[48:51]
  ds_read_b64_tr_b16 v[32:33], v8 offset:4096
  s_waitcnt vmcnt(12)
  v_mfma_f32_16x16x32_bf16 v[52:55], v[172:175], v[16:19], v[52:55]
  ds_read_b64_tr_b16 v[34:35], v8 offset:4608
  v_add_u32 v8, s42, v8
  s_waitcnt lgkmcnt(6)
  v_mfma_f32_16x16x32_bf16 v[56:59], v[168:171], v[20:23], v[56:59]
  ds_read_b64_tr_b16 v[36:37], v9 offset:4096
  buffer_load_dwordx4 v[160:163], v14, s[8:11], s36 offen offset:2048 sc1
  v_mfma_f32_16x16x32_bf16 v[60:63], v[172:175], v[20:23], v[60:63]
  ds_read_b64_tr_b16 v[38:39], v9 offset:4608
  v_add_u32 v9, s42, v9
  s_waitcnt lgkmcnt(6)
  v_mfma_f32_16x16x32_bf16 v[64:67], v[168:171], v[24:27], v[64:67]
  ds_read_b64_tr_b16 v[40:41], v10 offset:4096
  v_mfma_f32_16x16x32_bf16 v[68:71], v[172:175], v[24:27], v[68:71]
  ds_read_b64_tr_b16 v[42:43], v10 offset:4608
  v_add_u32 v10, s42, v10
  s_waitcnt lgkmcnt(6)
  v_mfma_f32_16x16x32_bf16 v[72:75], v[168:171], v[28:31], v[72:75]
  ds_read_b64_tr_b16 v[44:45], v11 offset:4096
  buffer_load_dwordx4 v[164:167], v14, s[8:11], s36 offen offset:3072 sc1
  v_mfma_f32_16x16x32_bf16 v[76:79], v[172:175], v[28:31], v[76:79]
  ds_read_b64_tr_b16 v[46:47], v11 offset:4608
  v_add_u32 v11, s42, v11
  s_barrier
  s_waitcnt vmcnt(13) lgkmcnt(6)
  v_mfma_f32_16x16x32_bf16 v[48:51], v[176:179], v[32:35], v[48:51]
  ds_read_b64_tr_b16 v[16:17], v8 offset:0
  s_bitcmp1_b32 s48, 3
  s_cselect_b32 s36, s50, s49
  s_waitcnt vmcnt(12)
  v_mfma_f32_16x16x32_bf16 v[52:55], v[180:183], v[32:35], v[52:55]
  ds_read_b64_tr_b16 v[18:19], v8 offset:512
  s_add_u32 s36, s36, 12288
  s_add_u32 s40, s43, 8192
  s_waitcnt lgkmcnt(6)
  v_mfma_f32_16x16x32_bf16 v[56:59], v[176:179], v[36:39], v[56:59]
  ds_read_b64_tr_b16 v[20:21], v9 offset:0
  s_cmp_eq_u32 s40, 65536
  s_cselect_b32 s40, 0, s40
  v_mfma_f32_16x16x32_bf16 v[60:63], v[180:183], v[36:39], v[60:63]
  ds_read_b64_tr_b16 v[22:23], v9 offset:512
  s_sub_u32 s42, s40, s43
  s_mov_b32 s43, s40
  s_waitcnt lgkmcnt(6)
  v_mfma_f32_16x16x32_bf16 v[64:67], v[176:179], v[40:43], v[64:67]
  ds_read_b64_tr_b16 v[24:25], v10 offset:0
  buffer_load_dwordx4 v[168:171], v14, s[8:11], s36 offen offset:0 sc1
  v_mfma_f32_16x16x32_bf16 v[68:71], v[180:183], v[40:43], v[68:71]
  ds_read_b64_tr_b16 v[26:27], v10 offset:512
  s_waitcnt lgkmcnt(6)
  v_mfma_f32_16x16x32_bf16 v[72:75], v[176:179], v[44:47], v[72:75]
  ds_read_b64_tr_b16 v[28:29], v11 offset:0
  v_mfma_f32_16x16x32_bf16 v[76:79], v[180:183], v[44:47], v[76:79]
  ds_read_b64_tr_b16 v[30:31], v11 offset:512
  buffer_load_dwordx4 v[172:175], v14, s[8:11], s36 offen offset:1024 sc1
  s_sub_u32 s39, s39, 1
  s_cmp_lg_u32 s39, 0
  s_cbranch_scc1 cd5
  s_waitcnt vmcnt(13) lgkmcnt(6)
  v_mfma_f32_16x16x32_bf16 v[48:51], v[120:123], v[16:19], v[48:51]
  ds_read_b64_tr_b16 v[32:33], v8 offset:4096
  s_waitcnt vmcnt(12)
  v_mfma_f32_16x16x32_bf16 v[52:55], v[124:127], v[16:19], v[52:55]
  ds_read_b64_tr_b16 v[34:35], v8 offset:4608
  v_add_u32 v8, s42, v8
  s_waitcnt lgkmcnt(6)
  v_mfma_f32_16x16x32_bf16 v[56:59], v[120:123], v[20:23], v[56:59]
  ds_read_b64_tr_b16 v[36:37], v9 offset:4096
  buffer_load_dwordx4 v[176:179], v14, s[8:11], s36 offen offset:2048 sc1
  v_mfma_f32_16x16x32_bf16 v[60:63], v[124:127], v[20:23], v[60:63]
  ds_read_b64_tr_b16 v[38:39], v9 offset:4608
  v_add_u32 v9, s42, v9
  s_waitcnt lgkmcnt(6)
  v_mfma_f32_16x16x32_bf16 v[64:67], v[120:123], v[24:27], v[64:67]
  ds_read_b64_tr_b16 v[40:41], v10 offset:4096
  v_mfma_f32_16x16x32_bf16 v[68:71], v[124:127], v[24:27], v[68:71]
  ds_read_b64_tr_b16 v[42:43], v10 offset:4608
  v_add_u32 v10, s42, v10
  s_waitcnt lgkmcnt(6)
  v_mfma_f32_16x16x32_bf16 v[72:75], v[120:123], v[28:31], v[72:75]
  ds_read_b64_tr_b16 v[44:45], v11 offset:4096
  buffer_load_dwordx4 v[180:183], v14, s[8:11], s36 offen offset:3072 sc1
  v_mfma_f32_16x16x32_bf16 v[76:79], v[124:127], v[28:31], v[76:79]
  ds_read_b64_tr_b16 v[46:47], v11 offset:4608
  v_add_u32 v11, s42, v11
  s_barrier
  s_waitcnt vmcnt(13) lgkmcnt(6)
  v_mfma_f32_16x16x32_bf16 v[48:51], v[128:131], v[32:35], v[48:51]
  ds_read_b64_tr_b16 v[16:17], v8 offset:0
  s_bitcmp1_b32 s48, 4
  s_cselect_b32 s36, s50, s49
  s_waitcnt vmcnt(12)
  v_mfma_f32_16x16x32_bf16 v[52:55], v[132:135], v[32:35], v[52:55]
  ds_read_b64_tr_b16 v[18:19], v8 offset:512
  s_add_u32 s36, s36, 16384
  s_add_u32 s40, s43, 8192
  s_waitcnt lgkmcnt(6)
  v_mfma_f32_16x16x32_bf16 v[56:59], v[128:131], v[36:39], v[56:59]
  ds_read_b64_tr_b16 v[20:21], v9 offset:0
  s_cmp_eq_u32 s40, 65536
  s_cselect_b32 s40, 0, s40
  v_mfma_f32_16x16x32_bf16 v[60:63], v[132:135], v[36:39], v[60:63]
  ds_read_b64_tr_b16 v[22:23], v9 offset:512
  s_sub_u32 s42, s40, s43
  s_mov_b32 s43, s40
  s_waitcnt lgkmcnt(6)
  v_mfma_f32_16x16x32_bf16 v[64:67], v[128:131], v[40:43], v[64:67]
  ds_read_b64_tr_b16 v[24:25], v10 offset:0
  buffer_load_dwordx4 v[120:123], v14, s[8:11], s36 offen offset:0 sc1
  v_mfma_f32_16x16x32_bf16 v[68:71], v[132:135], v[40:43], v[68:71]
  ds_read_b64_tr_b16 v[26:27], v10 offset:512
  s_waitcnt lgkmcnt(6)
  v_mfma_f32_16x16x32_bf16 v[72:75], v[128:131], v[44:47], v[72:75]
  ds_read_b64_tr_b16 v[28:29], v11 offset:0
  v_mfma_f32_16x16x32_bf16 v[76:79], v[132:135], v[44:47], v[76:79]
  ds_read_b64_tr_b16 v[30:31], v11 offset:512
  buffer_load_dwordx4 v[124:127], v14, s[8:11], s36 offen offset:1024 sc1
  s_waitcnt vmcnt(13) lgkmcnt(6)
  v_mfma_f32_16x16x32_bf16 v[48:51], v[136:139], v[16:19], v[48:51]
  ds_read_b64_tr_b16 v[32:33], v8 offset:4096
  s_waitcnt vmcnt(12)
  v_mfma_f32_16x16x32_bf16 v[52:55], v[140:143], v[16:19], v[52:55]
  ds_read_b64_tr_b16 v[34:35], v8 offset:4608
  v_add_u32 v8, s42, v8
  s_waitcnt lgkmcnt(6)
  v_mfma_f32_16x16x32_bf16 v[56:59], v[136:139], v[20:23], v[56:59]
  ds_read_b64_tr_b16 v[36:37], v9 offset:4096
  buffer_load_dwordx4 v[128:131], v14, s[8:11], s36 offen offset:2048 sc1
  v_mfma_f32_16x16x32_bf16 v[60:63], v[140:143], v[20:23], v[60:63]
  ds_read_b64_tr_b16 v[38:39], v9 offset:4608
  v_add_u32 v9, s42, v9
  s_waitcnt lgkmcnt(6)
  v_mfma_f32_16x16x32_bf16 v[64:67], v[136:139], v[24:27], v[64:67]
  ds_read_b64_tr_b16 v[40:41], v10 offset:4096
  v_mfma_f32_16x16x32_bf16 v[68:71], v[140:143], v[24:27], v[68:71]
  ds_read_b64_tr_b16 v[42:43], v10 offset:4608
  v_add_u32 v10, s42, v10
  s_waitcnt lgkmcnt(6)
  v_mfma_f32_16x16x32_bf16 v[72:75], v[136:139], v[28:31], v[72:75]
  ds_read_b64_tr_b16 v[44:45], v11 offset:4096
  buffer_load_dwordx4 v[132:135], v14, s[8:11], s36 offen offset:3072 sc1
  v_mfma_f32_16x16x32_bf16 v[76:79], v[140:143], v[28:31], v[76:79]
  ds_read_b64_tr_b16 v[46:47], v11 offset:4608
  v_add_u32 v11, s42, v11
  s_barrier
  s_waitcnt vmcnt(13) lgkmcnt(6)
  v_mfma_f32_16x16x32_bf16 v[48:51], v[144:147], v[32:35], v[48:51]
  ds_read_b64_tr_b16 v[16:17], v8 offset:0
  s_bitcmp1_b32 s48, 5
  s_cselect_b32 s36, s50, s49
  s_waitcnt vmcnt(12)
  v_mfma_f32_16x16x32_bf16 v[52:55], v[148:151], v[32:35], v[52:55]
  ds_read_b64_tr_b16 v[18:19], v8 offset:512
  s_add_u32 s36, s36, 20480
  s_add_u32 s40, s43, 8192
  s_waitcnt lgkmcnt(6)
  v_mfma_f32_16x16x32_bf16 v[56:59], v[144:147], v[36:39], v[56:59]
  ds_read_b64_tr_b16 v[20:21], v9 offset:0
  s_cmp_eq_u32 s40, 65536
  s_cselect_b32 s40, 0, s40
  v_mfma_f32_16x16x32_bf16 v[60:63], v[148:151], v[36:39], v[60:63]
  ds_read_b64_tr_b16 v[22:23], v9 offset:512
  s_sub_u32 s42, s40, s43
  s_mov_b32 s43, s40
  s_waitcnt lgkmcnt(6)
  v_mfma_f32_16x16x32_bf16 v[64:67], v[144:147], v[40:43], v[64:67]
  ds_read_b64_tr_b16 v[24:25], v10 offset:0
  buffer_load_dwordx4 v[136:139], v14, s[8:11], s36 offen offset:0 sc1
  v_mfma_f32_16x16x32_bf16 v[68:71], v[148:151], v[40:43], v[68:71]
  ds_read_b64_tr_b16 v[26:27], v10 offset:512
  s_waitcnt lgkmcnt(6)
  v_mfma_f32_16x16x32_bf16 v[72:75], v[144:147], v[44:47], v[72:75]
  ds_read_b64_tr_b16 v[28:29], v11 offset:0
  v_mfma_f32_16x16x32_bf16 v[76:79], v[148:151], v[44:47], v[76:79]
  ds_read_b64_tr_b16 v[30:31], v11 offset:512
  buffer_load_dwordx4 v[140:143], v14, s[8:11], s36 offen offset:1024 sc1
  s_waitcnt vmcnt(13) lgkmcnt(6)
  v_mfma_f32_16x16x32_bf16 v[48:51], v[152:155], v[16:19], v[48:51]
  ds_read_b64_tr_b16 v[32:33], v8 offset:4096
  s_waitcnt vmcnt(12)
  v_mfma_f32_16x16x32_bf16 v[52:55], v[156:159], v[16:19], v[52:55]
  ds_read_b64_tr_b16 v[34:35], v8 offset:4608
  v_add_u32 v8, s42, v8
  s_waitcnt lgkmcnt(6)
  v_mfma_f32_16x16x32_bf16 v[56:59], v[152:155], v[20:23], v[56:59]
  ds_read_b64_tr_b16 v[36:37], v9 offset:4096
  buffer_load_dwordx4 v[144:147], v14, s[8:11], s36 offen offset:2048 sc1
  v_mfma_f32_16x16x32_bf16 v[60:63], v[156:159], v[20:23], v[60:63]
  ds_read_b64_tr_b16 v[38:39], v9 offset:4608
  v_add_u32 v9, s42, v9
  s_waitcnt lgkmcnt(6)
  v_mfma_f32_16x16x32_bf16 v[64:67], v[152:155], v[24:27], v[64:67]
  ds_read_b64_tr_b16 v[40:41], v10 offset:4096
  v_mfma_f32_16x16x32_bf16 v[68:71], v[156:159], v[24:27], v[68:71]
  ds_read_b64_tr_b16 v[42:43], v10 offset:4608
  v_add_u32 v10, s42, v10
  s_waitcnt lgkmcnt(6)
  v_mfma_f32_16x16x32_bf16 v[72:75], v[152:155], v[28:31], v[72:75]
  ds_read_b64_tr_b16 v[44:45], v11 offset:4096
  buffer_load_dwordx4 v[148:151], v14, s[8:11], s36 offen offset:3072 sc1
  v_mfma_f32_16x16x32_bf16 v[76:79], v[156:159], v[28:31], v[76:79]
  ds_read_b64_tr_b16 v[46:47], v11 offset:4608
  v_add_u32 v11, s42, v11
  s_barrier
  s_waitcnt vmcnt(13) lgkmcnt(6)
  v_mfma_f32_16x16x32_bf16 v[48:51], v[160:163], v[32:35], v[48:51]
  ds_read_b64_tr_b16 v[16:17], v8 offset:0
  s_bitcmp1_b32 s48, 6
  s_cselect_b32 s36, s50, s49
  s_waitcnt vmcnt(12)
  v_mfma_f32_16x16x32_bf16 v[52:55], v[164:167], v[32:35], v[52:55]
  ds_read_b64_tr_b16 v[18:19], v8 offset:512
  s_add_u32 s36, s36, 24576
  s_add_u32 s40, s43, 8192
  s_waitcnt lgkmcnt(6)
  v_mfma_f32_16x16x32_bf16 v[56:59], v[160:163], v[36:39], v[56:59]
  ds_read_b64_tr_b16 v[20:21], v9 offset:0
  s_cmp_eq_u32 s40, 65536
  s_cselect_b32 s40, 0, s40
  v_mfma_f32_16x16x32_bf16 v[60:63], v[164:167], v[36:39], v[60:63]
  ds_read_b64_tr_b16 v[22:23], v9 offset:512
  s_sub_u32 s42, s40, s43
  s_mov_b32 s43, s40
  s_waitcnt lgkmcnt(6)
  v_mfma_f32_16x16x32_bf16 v[64:67], v[160:163], v[40:43], v[64:67]
  ds_read_b64_tr_b16 v[24:25], v10 offset:0
  buffer_load_dwordx4 v[152:155], v14, s[8:11], s36 offen offset:0 sc1
  v_mfma_f32_16x16x32_bf16 v[68:71], v[164:167], v[40:43], v[68:71]
  ds_read_b64_tr_b16 v[26:27], v10 offset:512
  s_waitcnt lgkmcnt(6)
  v_mfma_f32_16x16x32_bf16 v[72:75], v[160:163], v[44:47], v[72:75]
  ds_read_b64_tr_b16 v[28:29], v11 offset:0
  v_mfma_f32_16x16x32_bf16 v[76:79], v[164:167], v[44:47], v[76:79]
  ds_read_b64_tr_b16 v[30:31], v11 offset:512
  buffer_load_dwordx4 v[156:159], v14, s[8:11], s36 offen offset:1024 sc1
  s_waitcnt vmcnt(13) lgkmcnt(6)
  v_mfma_f32_16x16x32_bf16 v[48:51], v[168:171], v[16:19], v[48:51]
  ds_read_b64_tr_b16 v[32:33], v8 offset:4096
  s_waitcnt vmcnt(12)
  v_mfma_f32_16x16x32_bf16 v[52:55], v[172:175], v[16:19], v[52:55]
  ds_read_b64_tr_b16 v[34:35], v8 offset:4608
  v_add_u32 v8, s42, v8
  s_waitcnt lgkmcnt(6)
  v_mfma_f32_16x16x32_bf16 v[56:59], v[168:171], v[20:23], v[56:59]
  ds_read_b64_tr_b16 v[36:37], v9 offset:4096
  buffer_load_dwordx4 v[160:163], v14, s[8:11], s36 offen offset:2048 sc1
  v_mfma_f32_16x16x32_bf16 v[60:63], v[172:175], v[20:23], v[60:63]
  ds_read_b64_tr_b16 v[38:39], v9 offset:4608
  v_add_u32 v9, s42, v9
  s_waitcnt lgkmcnt(6)
  v_mfma_f32_16x16x32_bf16 v[64:67], v[168:171], v[24:27], v[64:67]
  ds_read_b64_tr_b16 v[40:41], v10 offset:4096
  v_mfma_f32_16x16x32_bf16 v[68:71], v[172:175], v[24:27], v[68:71]
  ds_read_b64_tr_b16 v[42:43], v10 offset:4608
  v_add_u32 v10, s42, v10
  s_waitcnt lgkmcnt(6)
  v_mfma_f32_16x16x32_bf16 v[72:75], v[168:171], v[28:31], v[72:75]
  ds_read_b64_tr_b16 v[44:45], v11 offset:4096
  buffer_load_dwordx4 v[164:167], v14, s[8:11], s36 offen offset:3072 sc1
  v_mfma_f32_16x16x32_bf16 v[76:79], v[172:175], v[28:31], v[76:79]
  ds_read_b64_tr_b16 v[46:47], v11 offset:4608
  v_add_u32 v11, s42, v11
  s_barrier
  s_waitcnt vmcnt(13) lgkmcnt(6)
  v_mfma_f32_16x16x32_bf16 v[48:51], v[176:179], v[32:35], v[48:51]
  ds_read_b64_tr_b16 v[16:17], v8 offset:0
  s_bitcmp1_b32 s48, 7
  s_cselect_b32 s36, s50, s49
  s_waitcnt vmcnt(12)
  v_mfma_f32_16x16x32_bf16 v[52:55], v[180:183], v[32:35], v[52:55]
  ds_read_b64_tr_b16 v[18:19], v8 offset:512
  s_add_u32 s36, s36, 28672
  s_add_u32 s40, s43, 8192
  s_waitcnt lgkmcnt(6)
  v_mfma_f32_16x16x32_bf16 v[56:59], v[176:179], v[36:39], v[56:59]
  ds_read_b64_tr_b16 v[20:21], v9 offset:0
  s_cmp_eq_u32 s40, 65536
  s_cselect_b32 s40, 0, s40
  v_mfma_f32_16x16x32_bf16 v[60:63], v[180:183], v[36:39], v[60:63]
  ds_read_b64_tr_b16 v[22:23], v9 offset:512
  s_sub_u32 s42, s40, s43
  s_mov_b32 s43, s40
  s_waitcnt lgkmcnt(6)
  v_mfma_f32_16x16x32_bf16 v[64:67], v[176:179], v[40:43], v[64:67]
  ds_read_b64_tr_b16 v[24:25], v10 offset:0
  buffer_load_dwordx4 v[168:171], v14, s[8:11], s36 offen offset:0 sc1
  v_mfma_f32_16x16x32_bf16 v[68:71], v[180:183], v[40:43], v[68:71]
  ds_read_b64_tr_b16 v[26:27], v10 offset:512
  s_waitcnt lgkmcnt(6)
  v_mfma_f32_16x16x32_bf16 v[72:75], v[176:179], v[44:47], v[72:75]
  ds_read_b64_tr_b16 v[28:29], v11 offset:0
  v_mfma_f32_16x16x32_bf16 v[76:79], v[180:183], v[44:47], v[76:79]
  ds_read_b64_tr_b16 v[30:31], v11 offset:512
  buffer_load_dwordx4 v[172:175], v14, s[8:11], s36 offen offset:1024 sc1
  s_waitcnt vmcnt(13) lgkmcnt(6)
  v_mfma_f32_16x16x32_bf16 v[48:51], v[120:123], v[16:19], v[48:51]
  ds_read_b64_tr_b16 v[32:33], v8 offset:4096
  s_waitcnt vmcnt(12)
  v_mfma_f32_16x16x32_bf16 v[52:55], v[124:127], v[16:19], v[52:55]
  ds_read_b64_tr_b16 v[34:35], v8 offset:4608
  v_add_u32 v8, s42, v8
  s_waitcnt lgkmcnt(6)
  v_mfma_f32_16x16x32_bf16 v[56:59], v[120:123], v[20:23], v[56:59]
  ds_read_b64_tr_b16 v[36:37], v9 offset:4096
  buffer_load_dwordx4 v[176:179], v14, s[8:11], s36 offen offset:2048 sc1
  v_mfma_f32_16x16x32_bf16 v[60:63], v[124:127], v[20:23], v[60:63]
  ds_read_b64_tr_b16 v[38:39], v9 offset:4608
  v_add_u32 v9, s42, v9
  s_waitcnt lgkmcnt(6)
  v_mfma_f32_16x16x32_bf16 v[64:67], v[120:123], v[24:27], v[64:67]
  ds_read_b64_tr_b16 v[40:41], v10 offset:4096
  v_mfma_f32_16x16x32_bf16 v[68:71], v[124:127], v[24:27], v[68:71]
  ds_read_b64_tr_b16 v[42:43], v10 offset:4608
  v_add_u32 v10, s42, v10
  s_waitcnt lgkmcnt(6)
  v_mfma_f32_16x16x32_bf16 v[72:75], v[120:123], v[28:31], v[72:75]
  ds_read_b64_tr_b16 v[44:45], v11 offset:4096
  buffer_load_dwordx4 v[180:183], v14, s[8:11], s36 offen offset:3072 sc1
  v_mfma_f32_16x16x32_bf16 v[76:79], v[124:127], v[28:31], v[76:79]
  ds_read_b64_tr_b16 v[46:47], v11 offset:4608
  v_add_u32 v11, s42, v11
  s_barrier
  s_waitcnt vmcnt(13) lgkmcnt(6)
  v_mfma_f32_16x16x32_bf16 v[48:51], v[128:131], v[32:35], v[48:51]
  ds_read_b64_tr_b16 v[16:17], v8 offset:0
  s_add_u32 s40, s43, 8192
  s_cmp_eq_u32 s40, 65536
  s_waitcnt vmcnt(12)
  v_mfma_f32_16x16x32_bf16 v[52:55], v[132:135], v[32:35], v[52:55]
  ds_read_b64_tr_b16 v[18:19], v8 offset:512
  s_cselect_b32 s40, 0, s40
  s_sub_u32 s42, s40, s43
  s_waitcnt lgkmcnt(6)
  v_mfma_f32_16x16x32_bf16 v[56:59], v[128:131], v[36:39], v[56:59]
  ds_read_b64_tr_b16 v[20:21], v9 offset:0
  s_mov_b32 s43, s40
  v_mfma_f32_16x16x32_bf16 v[60:63], v[132:135], v[36:39], v[60:63]
  ds_read_b64_tr_b16 v[22:23], v9 offset:512
  s_waitcnt lgkmcnt(6)
  v_mfma_f32_16x16x32_bf16 v[64:67], v[128:131], v[40:43], v[64:67]
  ds_read_b64_tr_b16 v[24:25], v10 offset:0
  v_mfma_f32_16x16x32_bf16 v[68:71], v[132:135], v[40:43], v[68:71]
  ds_read_b64_tr_b16 v[26:27], v10 offset:512
  s_waitcnt lgkmcnt(6)
  v_mfma_f32_16x16x32_bf16 v[72:75], v[128:131], v[44:47], v[72:75]
  ds_read_b64_tr_b16 v[28:29], v11 offset:0
  v_mfma_f32_16x16x32_bf16 v[76:79], v[132:135], v[44:47], v[76:79]
  ds_read_b64_tr_b16 v[30:31], v11 offset:512
  s_waitcnt vmcnt(11) lgkmcnt(6)
  v_mfma_f32_16x16x32_bf16 v[48:51], v[136:139], v[16:19], v[48:51]
  ds_read_b64_tr_b16 v[32:33], v8 offset:4096
  s_waitcnt vmcnt(10)
  v_mfma_f32_16x16x32_bf16 v[52:55], v[140:143], v[16:19], v[52:55]
  ds_read_b64_tr_b16 v[34:35], v8 offset:4608
  v_add_u32 v8, s42, v8
  s_waitcnt lgkmcnt(6)
  v_mfma_f32_16x16x32_bf16 v[56:59], v[136:139], v[20:23], v[56:59]
  ds_read_b64_tr_b16 v[36:37], v9 offset:4096
  v_mfma_f32_16x16x32_bf16 v[60:63], v[140:143], v[20:23], v[60:63]
  ds_read_b64_tr_b16 v[38:39], v9 offset:4608
  v_add_u32 v9, s42, v9
  s_waitcnt lgkmcnt(6)
  v_mfma_f32_16x16x32_bf16 v[64:67], v[136:139], v[24:27], v[64:67]
  ds_read_b64_tr_b16 v[40:41], v10 offset:4096
  v_mfma_f32_16x16x32_bf16 v[68:71], v[140:143], v[24:27], v[68:71]
  ds_read_b64_tr_b16 v[42:43], v10 offset:4608
  v_add_u32 v10, s42, v10
  s_waitcnt lgkmcnt(6)
  v_mfma_f32_16x16x32_bf16 v[72:75], v[136:139], v[28:31], v[72:75]
  ds_read_b64_tr_b16 v[44:45], v11 offset:4096
  v_mfma_f32_16x16x32_bf16 v[76:79], v[140:143], v[28:31], v[76:79]
  ds_read_b64_tr_b16 v[46:47], v11 offset:4608
  v_add_u32 v11, s42, v11
  s_barrier
  s_waitcnt vmcnt(9) lgkmcnt(6)
  v_mfma_f32_16x16x32_bf16 v[48:51], v[144:147], v[32:35], v[48:51]
  ds_read_b64_tr_b16 v[16:17], v8 offset:0
  s_add_u32 s40, s43, 8192
  s_cmp_eq_u32 s40, 65536
  s_waitcnt vmcnt(8)
  v_mfma_f32_16x16x32_bf16 v[52:55], v[148:151], v[32:35], v[52:55]
  ds_read_b64_tr_b16 v[18:19], v8 offset:512
  s_cselect_b32 s40, 0, s40
  s_sub_u32 s42, s40, s43
  s_waitcnt lgkmcnt(6)
  v_mfma_f32_16x16x32_bf16 v[56:59], v[144:147], v[36:39], v[56:59]
  ds_read_b64_tr_b16 v[20:21], v9 offset:0
  s_mov_b32 s43, s40
  v_mfma_f32_16x16x32_bf16 v[60:63], v[148:151], v[36:39], v[60:63]
  ds_read_b64_tr_b16 v[22:23], v9 offset:512
  s_waitcnt lgkmcnt(6)
  v_mfma_f32_16x16x32_bf16 v[64:67], v[144:147], v[40:43], v[64:67]
  ds_read_b64_tr_b16 v[24:25], v10 offset:0
  v_mfma_f32_16x16x32_bf16 v[68:71], v[148:151], v[40:43], v[68:71]
  ds_read_b64_tr_b16 v[26:27], v10 offset:512
  s_waitcnt lgkmcnt(6)
  v_mfma_f32_16x16x32_bf16 v[72:75], v[144:147], v[44:47], v[72:75]
  ds_read_b64_tr_b16 v[28:29], v11 offset:0
  v_mfma_f32_16x16x32_bf16 v[76:79], v[148:151], v[44:47], v[76:79]
  ds_read_b64_tr_b16 v[30:31], v11 offset:512
  s_waitcnt vmcnt(7) lgkmcnt(6)
  v_mfma_f32_16x16x32_bf16 v[48:51], v[152:155], v[16:19], v[48:51]
  ds_read_b64_tr_b16 v[32:33], v8 offset:4096
  s_waitcnt vmcnt(6)
  v_mfma_f32_16x16x32_bf16 v[52:55], v[156:159], v[16:19], v[52:55]
  ds_read_b64_tr_b16 v[34:35], v8 offset:4608
  v_add_u32 v8, s42, v8
  s_waitcnt lgkmcnt(6)
  v_mfma_f32_16x16x32_bf16 v[56:59], v[152:155], v[20:23], v[56:59]
  ds_read_b64_tr_b16 v[36:37], v9 offset:4096
  v_mfma_f32_16x16x32_bf16 v[60:63], v[156:159], v[20:23], v[60:63]
  ds_read_b64_tr_b16 v[38:39], v9 offset:4608
  v_add_u32 v9, s42, v9
  s_waitcnt lgkmcnt(6)
  v_mfma_f32_16x16x32_bf16 v[64:67], v[152:155], v[24:27], v[64:67]
  ds_read_b64_tr_b16 v[40:41], v10 offset:4096
  v_mfma_f32_16x16x32_bf16 v[68:71], v[156:159], v[24:27], v[68:71]
  ds_read_b64_tr_b16 v[42:43], v10 offset:4608
  v_add_u32 v10, s42, v10
  s_waitcnt lgkmcnt(6)
  v_mfma_f32_16x16x32_bf16 v[72:75], v[152:155], v[28:31], v[72:75]
  ds_read_b64_tr_b16 v[44:45], v11 offset:4096
  v_mfma_f32_16x16x32_bf16 v[76:79], v[156:159], v[28:31], v[76:79]
  ds_read_b64_tr_b16 v[46:47], v11 offset:4608
  v_add_u32 v11, s42, v11
  s_barrier
  s_waitcnt vmcnt(5) lgkmcnt(6)
  v_mfma_f32_16x16x32_bf16 v[48:51], v[160:163], v[32:35], v[48:51]
  ds_read_b64_tr_b16 v[16:17], v8 offset:0
  s_add_u32 s40, s43, 8192
  s_cmp_eq_u32 s40, 65536
  s_waitcnt vmcnt(4)
  v_mfma_f32_16x16x32_bf16 v[52:55], v[164:167], v[32:35], v[52:55]
  ds_read_b64_tr_b16 v[18:19], v8 offset:512
  s_cselect_b32 s40, 0, s40
  s_sub_u32 s42, s40, s43
  s_waitcnt lgkmcnt(6)
  v_mfma_f32_16x16x32_bf16 v[56:59], v[160:163], v[36:39], v[56:59]
  ds_read_b64_tr_b16 v[20:21], v9 offset:0
  s_mov_b32 s43, s40
  v_mfma_f32_16x16x32_bf16 v[60:63], v[164:167], v[36:39], v[60:63]
  ds_read_b64_tr_b16 v[22:23], v9 offset:512
  s_waitcnt lgkmcnt(6)
  v_mfma_f32_16x16x32_bf16 v[64:67], v[160:163], v[40:43], v[64:67]
  ds_read_b64_tr_b16 v[24:25], v10 offset:0
  v_mfma_f32_16x16x32_bf16 v[68:71], v[164:167], v[40:43], v[68:71]
  ds_read_b64_tr_b16 v[26:27], v10 offset:512
  s_waitcnt lgkmcnt(6)
  v_mfma_f32_16x16x32_bf16 v[72:75], v[160:163], v[44:47], v[72:75]
  ds_read_b64_tr_b16 v[28:29], v11 offset:0
  v_mfma_f32_16x16x32_bf16 v[76:79], v[164:167], v[44:47], v[76:79]
  ds_read_b64_tr_b16 v[30:31], v11 offset:512
  s_waitcnt vmcnt(3) lgkmcnt(6)
  v_mfma_f32_16x16x32_bf16 v[48:51], v[168:171], v[16:19], v[48:51]
  ds_read_b64_tr_b16 v[32:33], v8 offset:4096
  s_waitcnt vmcnt(2)
  v_mfma_f32_16x16x32_bf16 v[52:55], v[172:175], v[16:19], v[52:55]
  ds_read_b64_tr_b16 v[34:35], v8 offset:4608
  s_waitcnt lgkmcnt(6)
  v_mfma_f32_16x16x32_bf16 v[56:59], v[168:171], v[20:23], v[56:59]
  ds_read_b64_tr_b16 v[36:37], v9 offset:4096
  v_mfma_f32_16x16x32_bf16 v[60:63], v[172:175], v[20:23], v[60:63]
  ds_read_b64_tr_b16 v[38:39], v9 offset:4608
  s_waitcnt lgkmcnt(6)
  v_mfma_f32_16x16x32_bf16 v[64:67], v[168:171], v[24:27], v[64:67]
  ds_read_b64_tr_b16 v[40:41], v10 offset:4096
  v_mfma_f32_16x16x32_bf16 v[68:71], v[172:175], v[24:27], v[68:71]
  ds_read_b64_tr_b16 v[42:43], v10 offset:4608
  s_waitcnt lgkmcnt(6)
  v_mfma_f32_16x16x32_bf16 v[72:75], v[168:171], v[28:31], v[72:75]
  ds_read_b64_tr_b16 v[44:45], v11 offset:4096
  v_mfma_f32_16x16x32_bf16 v[76:79], v[172:175], v[28:31], v[76:79]
  ds_read_b64_tr_b16 v[46:47], v11 offset:4608
  s_waitcnt vmcnt(1) lgkmcnt(6)
  v_mfma_f32_16x16x32_bf16 v[48:51], v[176:179], v[32:35], v[48:51]
  s_waitcnt vmcnt(0)
  v_mfma_f32_16x16x32_bf16 v[52:55], v[180:183], v[32:35], v[52:55]
  s_waitcnt lgkmcnt(4)
  v_mfma_f32_16x16x32_bf16 v[56:59], v[176:179], v[36:39], v[56:59]
  v_mfma_f32_16x16x32_bf16 v[60:63], v[180:183], v[36:39], v[60:63]
  s_waitcnt lgkmcnt(2)
  v_mfma_f32_16x16x32_bf16 v[64:67], v[176:179], v[40:43], v[64:67]
  v_mfma_f32_16x16x32_bf16 v[68:71], v[180:183], v[40:43], v[68:71]
  s_waitcnt lgkmcnt(0)
  v_mfma_f32_16x16x32_bf16 v[72:75], v[176:179], v[44:47], v[72:75]
  v_mfma_f32_16x16x32_bf16 v[76:79], v[180:183], v[44:47], v[76:79]
  s_waitcnt lgkmcnt(0)
  s_cmp_eq_u32 s3, 0
  s_cbranch_scc1 C_st
  v_cvt_pk_bf16_f32 v96, v48, v49
  v_cvt_pk_bf16_f32 v97, v50, v51
  v_cvt_pk_bf16_f32 v98, v52, v53
  v_cvt_pk_bf16_f32 v99, v54, v55
  buffer_store_dwordx4 v[96:99], v12, s[24:27], 0 offen sc0 sc1
  v_cvt_pk_bf16_f32 v100, v56, v57
  v_cvt_pk_bf16_f32 v101, v58, v59
  v_cvt_pk_bf16_f32 v102, v60, v61
  v_cvt_pk_bf16_f32 v103, v62, v63
  buffer_store_dwordx4 v[100:103], v12, s[24:27], s45 offen sc0 sc1
  v_cvt_pk_bf16_f32 v104, v64, v65
  v_cvt_pk_bf16_f32 v105, v66, v67
  v_cvt_pk_bf16_f32 v106, v68, v69
  v_cvt_pk_bf16_f32 v107, v70, v71
  buffer_store_dwordx4 v[104:107], v12, s[24:27], s46 offen sc0 sc1
  v_cvt_pk_bf16_f32 v108, v72, v73
  v_cvt_pk_bf16_f32 v109, v74, v75
  v_cvt_pk_bf16_f32 v110, v76, v77
  v_cvt_pk_bf16_f32 v111, v78, v79
  buffer_store_dwordx4 v[108:111], v12, s[24:27], s47 offen sc0 sc1
  s_branch C_end
C_st:
  s_nop 7
  v_pk_add_f32 v[16:17], v[48:49], v[50:51]
  v_pk_mul_f32 v[18:19], v[48:49], v[48:49]
  v_pk_fma_f32 v[18:19], v[50:51], v[50:51], v[18:19]
  v_pk_add_f32 v[16:17], v[16:17], v[52:53]
  v_pk_fma_f32 v[18:19], v[52:53], v[52:53], v[18:19]
  v_pk_add_f32 v[16:17], v[16:17], v[54:55]
  v_pk_fma_f32 v[18:19], v[54:55], v[54:55], v[18:19]
  v_add_f32 v32, v16, v17
  v_add_f32 v36, v18, v19
  v_pk_add_f32 v[20:21], v[56:57], v[58:59]
  v_pk_mul_f32 v[22:23], v[56:57], v[56:57]
  v_pk_fma_f32 v[22:23], v[58:59], v[58:59], v[22:23]
  v_pk_add_f32 v[20:21], v[20:21], v[60:61]
  v_pk_fma_f32 v[22:23], v[60:61], v[60:61], v[22:23]
  v_pk_add_f32 v[20:21], v[20:21], v[62:63]
  v_pk_fma_f32 v[22:23], v[62:63], v[62:63], v[22:23]
  v_add_f32 v33, v20, v21
  v_add_f32 v37, v22, v23
  v_pk_add_f32 v[24:25], v[64:65], v[66:67]
  v_pk_mul_f32 v[26:27], v[64:65], v[64:65]
  v_pk_fma_f32 v[26:27], v[66:67], v[66:67], v[26:27]
  v_pk_add_f32 v[24:25], v[24:25], v[68:69]
  v_pk_fma_f32 v[26:27], v[68:69], v[68:69], v[26:27]
  v_pk_add_f32 v[24:25], v[24:25], v[70:71]
  v_pk_fma_f32 v[26:27], v[70:71], v[70:71], v[26:27]
  v_add_f32 v34, v24, v25
  v_add_f32 v38, v26, v27
  v_pk_add_f32 v[28:29], v[72:73], v[74:75]
  v_pk_mul_f32 v[30:31], v[72:73], v[72:73]
  v_pk_fma_f32 v[30:31], v[74:75], v[74:75], v[30:31]
  v_pk_add_f32 v[28:29], v[28:29], v[76:77]
  v_pk_fma_f32 v[30:31], v[76:77], v[76:77], v[30:31]
  v_pk_add_f32 v[28:29], v[28:29], v[78:79]
  v_pk_fma_f32 v[30:31], v[78:79], v[78:79], v[30:31]
  v_add_f32 v35, v28, v29
  v_add_f32 v39, v30, v31
  v_permlane16_swap_b32 v32, v33
  v_permlane16_swap_b32 v34, v35
  v_permlane16_swap_b32 v36, v37
  v_permlane16_swap_b32 v38, v39
  v_add_f32 v32, v32, v33
  v_add_f32 v34, v34, v35
  v_add_f32 v36, v36, v37
  v_add_f32 v38, v38, v39
  v_permlane32_swap_b32 v32, v34
  s_nop 0
  v_permlane32_swap_b32 v36, v38
  v_add_f32 v40, v32, v34
  v_add_f32 v41, v36, v38
  ds_write_b64 v223, v[40:41]
  v_cvt_pk_bf16_f32 v96, v48, v49
  v_cvt_pk_bf16_f32 v97, v50, v51
  v_cvt_pk_bf16_f32 v98, v52, v53
  v_cvt_pk_bf16_f32 v99, v54, v55
  buffer_store_dwordx4 v[96:99], v12, s[24:27], 0 offen sc0 sc1
  v_cvt_pk_bf16_f32 v100, v56, v57
  v_cvt_pk_bf16_f32 v101, v58, v59
  v_cvt_pk_bf16_f32 v102, v60, v61
  v_cvt_pk_bf16_f32 v103, v62, v63
  buffer_store_dwordx4 v[100:103], v12, s[24:27], s45 offen sc0 sc1
  v_cvt_pk_bf16_f32 v104, v64, v65
  v_cvt_pk_bf16_f32 v105, v66, v67
  v_cvt_pk_bf16_f32 v106, v68, v69
  v_cvt_pk_bf16_f32 v107, v70, v71
  buffer_store_dwordx4 v[104:107], v12, s[24:27], s46 offen sc0 sc1
  v_cvt_pk_bf16_f32 v108, v72, v73
  v_cvt_pk_bf16_f32 v109, v74, v75
  v_cvt_pk_bf16_f32 v110, v76, v77
  v_cvt_pk_bf16_f32 v111, v78, v79
  buffer_store_dwordx4 v[108:111], v12, s[24:27], s47 offen sc0 sc1
  s_waitcnt lgkmcnt(0)
  s_barrier
  s_cmp_lg_u32 s4, 0
  s_cbranch_scc1 C_nost
  ds_read_b64 v[44:45], v223 offset:512
  ds_read_b64 v[46:47], v223 offset:1024
  ds_read_b64 v[18:19], v223 offset:1536
  s_lshl_b32 s32, s28, 14
  s_lshl_b32 s40, s29, 9
  s_add_u32 s32, s32, s40
  s_waitcnt lgkmcnt(0)
  v_pk_add_f32 v[40:41], v[40:41], v[44:45]
  v_pk_add_f32 v[46:47], v[46:47], v[18:19]
  v_pk_add_f32 v[40:41], v[40:41], v[46:47]
  buffer_store_dwordx2 v[40:41], v222, s[12:15], s32 offen sc0 sc1
C_nost:
  s_nop 1
  s_lshr_b32 s32, s2, 3
  s_lshr_b32 s5, s32, 3
  s_and_b32 s6, s32, 7
  s_lshl_b32 s7, s5, 1
  s_add_u32 s7, s7, s6
  s_and_b32 s7, s7, 7
  s_and_b32 s32, s2, 7
  s_lshr_b32 s28, s32, 1
  s_lshl_b32 s28, s28, 2
  s_add_u32 s28, s28, s5
  s_and_b32 s29, s32, 1
  s_mul_i32 s29, s29, 8
  s_add_u32 s29, s29, s6
  s_mov_b32 s30, 7
  s_mov_b32 s31, -1
  v_and_b32 v4, 15, v0
  v_lshrrev_b32 v5, 4, v0
  v_lshrrev_b32 v6, 2, v4
  v_and_b32 v7, 3, v0
  v_lshrrev_b32 v3, 5, v0
  v_and_b32 v2, 1, v5
  v_lshl_or_b32 v3, v2, 1, v3
  v_lshl_add_u32 v21, v5, 3, v6
  v_lshlrev_b32 v21, 7, v21
  v_lshl_add_u32 v21, v7, 3, v21
  v_lshrrev_b32 v22, 1, v6
  v_lshl_or_b32 v22, v2, 1, v22
  v_lshl_add_u32 v21, v22, 5, v21
  v_add_u32 v21, 18432, v21
  v_xor_b32 v8, 0, v21
  s_lshl_b32 s32, s4, 5
  v_xor_b32 v8, s32, v8
  v_lshrrev_b32 v21, 1, v4
  v_xor_b32 v21, v21, v5
  v_lshlrev_b32 v21, 4, v21
  v_lshlrev_b32 v22, 7, v4
  v_add_u32 v9, v21, v22
  v_xor_b32 v10, 64, v9
  v_and_b32 v21, 1, v4
  v_mul_u32_u24 v21, 28800, v21
  v_lshrrev_b32 v22, 1, v4
  v_mul_u32_u24 v22, 400, v22
  v_lshlrev_b32 v23, 3, v5
  v_add3_u32 v11, v21, v22, v23
  s_add_u32 s32, s32, 43008
  v_add_u32 v11, s32, v11
  v_lshlrev_b32 v12, 3, v4
  v_add_u32 v12, 129024, v12
  v_mov_b64 v[112:113], 0
  v_mov_b64 v[114:115], 0
  v_mov_b64 v[116:117], 0
  v_mov_b64 v[118:119], 0
  v_mov_b64 v[120:121], 0
  v_mov_b64 v[122:123], 0
  v_mov_b64 v[124:125], 0
  v_mov_b64 v[126:127], 0
  v_mov_b64 v[128:129], 0
  v_mov_b64 v[130:131], 0
  v_mov_b64 v[132:133], 0
  v_mov_b64 v[134:135], 0
  v_mov_b64 v[136:137], 0
  v_mov_b64 v[138:139], 0
  v_mov_b64 v[140:141], 0
  v_mov_b64 v[142:143], 0
  v_mov_b64 v[144:145], 0
  v_mov_b64 v[146:147], 0
  v_mov_b64 v[148:149], 0
  v_mov_b64 v[150:151], 0
  v_mov_b64 v[152:153], 0
  v_mov_b64 v[154:155], 0
  v_mov_b64 v[156:157], 0
  v_mov_b64 v[158:159], 0
  v_mov_b64 v[160:161], 0
  v_mov_b64 v[162:163], 0
  v_mov_b64 v[164:165], 0
  v_mov_b64 v[166:167], 0
  v_mov_b64 v[168:169], 0
  v_mov_b64 v[170:171], 0
  v_mov_b64 v[172:173], 0
  v_mov_b64 v[174:175], 0
  v_mov_b64 v[176:177], 0
  v_mov_b64 v[178:179], 0
  v_mov_b64 v[180:181], 0
  v_mov_b64 v[182:183], 0
  v_mov_b64 v[184:185], 0
  v_mov_b64 v[186:187], 0
  v_mov_b64 v[188:189], 0
  v_mov_b64 v[190:191], 0
  v_mov_b64 v[192:193], 0
  v_mov_b64 v[194:195], 0
  v_mov_b64 v[196:197], 0
  v_mov_b64 v[198:199], 0
  v_mov_b64 v[200:201], 0
  v_mov_b64 v[202:203], 0
  v_mov_b64 v[204:205], 0
  v_mov_b64 v[206:207], 0
  v_mov_b64 v[208:209], 0
  v_mov_b64 v[210:211], 0
  v_mov_b64 v[212:213], 0
  v_mov_b64 v[214:215], 0
  v_mov_b64 v[216:217], 0
  v_mov_b64 v[218:219], 0
  s_waitcnt vmcnt(0)
  s_barrier
  s_barrier
  s_mov_b32 s3, 1
  s_mov_b32 s51, 9
  s_add_u32 s82, s84, 33554432
  s_addc_u32 s83, s85, 0
  s_branch C_top
C_end:
  s_endpgm
L_start:
  s_nop 7
  s_nop 7
  s_sub_u32 s57, s4, 4
  v_and_b32 v134, 3, v0
  v_lshlrev_b32 v134, 6, v134
  s_lshr_b32 s32, s2, 3
  s_lshr_b32 s5, s32, 3
  s_and_b32 s6, s32, 7
  s_lshl_b32 s7, s5, 1
  s_add_u32 s7, s7, s6
  s_and_b32 s7, s7, 7
  s_and_b32 s32, s2, 7
  s_lshr_b32 s28, s32, 1
  s_lshl_b32 s28, s28, 2
  s_add_u32 s28, s28, s5
  s_and_b32 s29, s32, 1
  s_mul_i32 s29, s29, 8
  s_add_u32 s29, s29, s6
  s_mov_b32 s30, 7
  s_mov_b32 s31, -1
  s_mov_b32 s41, s57
  s_mul_i32 s32, s41, 16
  s_add_u32 s32, s32, 0
  v_lshrrev_b32 v2, 3, v0
  v_add_u32 v2, s32, v2
  v_bfe_u32 v3, v2, 1, 1
  v_bfe_u32 v4, v2, 3, 1
  v_lshl_or_b32 v3, v4, 1, v3
  v_lshlrev_b32 v3, 1, v3
  v_and_b32 v4, 7, v0
  v_xor_b32 v3, v3, v4
  v_lshlrev_b32 v3, 4, v3
  s_mov_b32 s32, 6144
  v_mul_lo_u32 v2, v2, s32
  v_add_u32 v13, v2, v3
  s_mul_i32 s32, s41, 16
  s_add_u32 s32, s32, 8
  v_lshrrev_b32 v2, 3, v0
  v_add_u32 v2, s32, v2
  v_bfe_u32 v3, v2, 1, 1
  v_bfe_u32 v4, v2, 3, 1
  v_lshl_or_b32 v3, v4, 1, v3
  v_lshlrev_b32 v3, 1, v3
  v_and_b32 v4, 7, v0
  v_xor_b32 v3, v3, v4
  v_lshlrev_b32 v3, 4, v3
  s_mov_b32 s32, 6144
  v_mul_lo_u32 v2, v2, s32
  v_add_u32 v14, v2, v3
  v_subrev_u32 v14, 1024, v14
  v_add_u32 v15, 2048, v13
  v_add_u32 v16, 2048, v14
  v_add_u32 v17, 4096, v13
  v_add_u32 v18, 4096, v14
  s_lshl_b32 s46, s41, 11
  s_add_u32 s46, s46, 18432
  s_add_u32 s47, s46, 8192
  s_add_u32 s48, s46, 16384
  s_lshl_b32 s35, s29, 7
  s_waitcnt lgkmcnt(0)
  s_mov_b32 s12, s66
  s_mov_b32 s13, s67
  s_mov_b32 s14, 6291456
  s_mov_b32 s15, 0x20000
  s_mov_b32 s30, 7
  s_mov_b32 s31, -1
  s_mov_b32 s38, 0
  s_add_u32 s30, s30, 1
  s_and_b32 s30, s30, 7
  s_cselect_b32 s32, 0, 1
  s_add_u32 s31, s31, s32
  s_sub_u32 s32, s30, s7
  s_and_b32 s32, s32, 7
  s_cmp_lt_u32 s32, 2
  s_cselect_b32 s32, 1, 0
  s_add_u32 s32, s32, s31
  s_cmp_ge_u32 s32, 2
  s_cselect_b32 s32, 0, s32
  s_lshl_b32 s33, s32, 3
  s_add_u32 s33, s33, s30
  s_mul_i32 s37, s33, 393216
  s_add_u32 s37, s37, s35
  s_add_u32 m0, s38, s46
  s_nop 0
  buffer_load_dwordx4 v13, s[12:15], s37 offen offset:0  lds
  buffer_load_dwordx4 v14, s[12:15], s37 offen offset:1024  lds
  s_add_u32 m0, s38, s47
  s_nop 0
  buffer_load_dwordx4 v15, s[12:15], s37 offen offset:0  lds
  buffer_load_dwordx4 v16, s[12:15], s37 offen offset:1024  lds
  s_add_u32 m0, s38, s48
  s_nop 0
  buffer_load_dwordx4 v17, s[12:15], s37 offen offset:0  lds
  buffer_load_dwordx4 v18, s[12:15], s37 offen offset:1024  lds
  s_add_u32 s38, s38, 43008
  s_cmp_eq_u32 s38, 129024
  s_cselect_b32 s38, 0, s38
  s_add_u32 s30, s30, 1
  s_and_b32 s30, s30, 7
  s_cselect_b32 s32, 0, 1
  s_add_u32 s31, s31, s32
  s_sub_u32 s32, s30, s7
  s_and_b32 s32, s32, 7
  s_cmp_lt_u32 s32, 2
  s_cselect_b32 s32, 1, 0
  s_add_u32 s32, s32, s31
  s_cmp_ge_u32 s32, 2
  s_cselect_b32 s32, 0, s32
  s_lshl_b32 s33, s32, 3
  s_add_u32 s33, s33, s30
  s_mul_i32 s37, s33, 393216
  s_add_u32 s37, s37, s35
  s_add_u32 m0, s38, s46
  s_nop 0
  buffer_load_dwordx4 v13, s[12:15], s37 offen offset:0  lds
  buffer_load_dwordx4 v14, s[12:15], s37 offen offset:1024  lds
  s_add_u32 m0, s38, s47
  s_nop 0
  buffer_load_dwordx4 v15, s[12:15], s37 offen offset:0  lds
  buffer_load_dwordx4 v16, s[12:15], s37 offen offset:1024  lds
  s_add_u32 m0, s38, s48
  s_nop 0
  buffer_load_dwordx4 v17, s[12:15], s37 offen offset:0  lds
  buffer_load_dwordx4 v18, s[12:15], s37 offen offset:1024  lds
  s_add_u32 s38, s38, 43008
  s_cmp_eq_u32 s38, 129024
  s_cselect_b32 s38, 0, s38
  s_lshl_b32 s40, s28, 7
  s_sub_u32 s40, s40, 16
  s_lshl_b32 s32, s41, 5
  s_add_u32 s32, s32, 16
  v_lshrrev_b32 v2, 3, v0
  v_add_u32 v2, s32, v2
  v_bfe_u32 v3, v2, 1, 3
  v_and_b32 v4, 7, v0
  v_xor_b32 v3, v3, v4
  v_lshlrev_b32 v3, 4, v3
  v_add_u32 v2, s40, v2
  v_max_i32 v2, 0, v2
  v_lshlrev_b32 v2, 11, v2
  v_add_u32 v8, v2, v3
  v_add_u32 v10, 30720, v8
  s_lshl_b32 s32, s41, 5
  s_add_u32 s32, s32, 24
  v_lshrrev_b32 v2, 3, v0
  v_add_u32 v2, s32, v2
  v_bfe_u32 v3, v2, 1, 3
  v_and_b32 v4, 7, v0
  v_xor_b32 v3, v3, v4
  v_lshlrev_b32 v3, 4, v3
  v_add_u32 v2, s40, v2
  v_max_i32 v2, 0, v2
  v_lshlrev_b32 v2, 11, v2
  v_add_u32 v9, v2, v3
  v_subrev_u32 v9, 1024, v9
  v_add_u32 v11, 30720, v9
  s_lshl_b32 s32, s41, 3
  v_lshrrev_b32 v2, 3, v0
  v_add_u32 v2, s32, v2
  v_bfe_u32 v3, v2, 1, 3
  v_and_b32 v4, 7, v0
  v_xor_b32 v3, v3, v4
  v_lshlrev_b32 v3, 4, v3
  v_add_u32 v2, s40, v2
  v_max_i32 v2, 0, v2
  v_lshlrev_b32 v2, 11, v2
  v_add_u32 v12, v2, v3
  s_lshl_b32 s44, s41, 12
  s_add_u32 s44, s44, 2048
  s_lshl_b32 s45, s41, 10
  s_mov_b32 s34, 0
  s_cmp_eq_u32 s41, 0
  s_cselect_b32 s52, 0xffffff00, -1
  s_mov_b32 s53, -1
  v_mov_b32 v20, 0x3f803f80
  v_mov_b32 v21, v20
  v_mov_b32 v22, v20
  v_mov_b32 v23, v20
  v_lshlrev_b32 v24, 4, v0
  v_add_u32 v25, 86016, v24
  s_mov_b64 exec, 0xff
  ds_write_b128 v24, v[20:23]
  ds_write_b128 v24, v[20:23] offset:43008
  ds_write_b128 v25, v[20:23]
  s_mov_b64 exec, -1
  s_mov_b32 s8, s64
  s_mov_b32 s9, s65
  s_mov_b32 s10, 4194304
  s_mov_b32 s11, 0x20000
  s_add_u32 s20, s84, 22020096
  s_addc_u32 s21, s85, 0
  s_mov_b32 s22, 16384
  s_mov_b32 s23, 0x20000
  s_lshl_b32 s32, s41, 6
  v_add_u32 v26, s32, v0
  v_min_u32 v26, 143, v26
  v_add_u32 v27, s40, v26
  v_max_i32 v27, 0, v27
  v_lshlrev_b32 v27, 3, v27
  v_lshlrev_b32 v26, 3, v26
  v_add_u32 v26, 129024, v26
  s_waitcnt lgkmcnt(0)
  s_mov_b32 s82, s84
  s_mov_b32 s83, s85
  s_mov_b32 s16, s84
  s_mov_b32 s17, s85
  s_mov_b32 s18, 67108864
  s_mov_b32 s19, 0x20000
  s_lshl_b32 s32, s2, 3
  s_lshl_b32 s40, s57, 1
  s_add_u32 s32, s32, s40
  v_lshrrev_b32 v72, 5, v0
  v_add_u32 v72, s32, v72
  v_lshlrev_b32 v46, 11, v72
  v_and_b32 v2, 31, v0
  v_lshl_add_u32 v46, v2, 4, v46
  v_lshlrev_b32 v72, 3, v72
  v_add_u32 v72, 22020096, v72
  s_cmp_eq_u32 s57, 0
  s_cselect_b32 s58, 0, -1
  v_mov_b32 v64, s58
  v_mov_b32 v65, s58
  v_mov_b32 v66, s58
  v_mov_b32 v67, s58
  v_lshrrev_b32 v2, 3, v0
  v_lshlrev_b32 v2, 15, v2
  v_and_b32 v3, 7, v0
  v_lshl_add_u32 v2, v3, 4, v2
  v_lshlrev_b32 v3, 4, v0
  s_cselect_b64 vcc, -1, 0
  s_lshl_b32 s58, s2, 7
  s_add_u32 s58, s58, 29360128
  s_lshl_b32 s59, s2, 10
  s_add_u32 s59, s59, 20971520
  s_cmp_eq_u32 s57, 0
  s_cselect_b32 s58, s58, s59
  s_add_u32 s59, s59, 33554432
  s_cmp_eq_u32 s57, 2
  s_cselect_b32 s58, s59, s58
  s_cmp_eq_u32 s57, 3
  s_cselect_b32 s58, 134217728, s58
  v_cndmask_b32 v47, v3, v2, vcc
  s_and_b32 s59, s2, 3
  s_lshl_b32 s59, s59, 6
  v_mov_b32 v73, s59
  v_mov_b32 v74, 1
L_top:
  s_nop 7
  s_nop 7
  s_lshl_b32 s56, s3, 10
  s_mul_i32 s32, s28, 16
  s_add_u32 s56, s56, s32
  s_add_u32 s56, s56, s29
  s_add_u32 s56, s56, 0
  s_lshl_b32 s56, s56, 7
  s_mov_b32 s24, s72
  s_mov_b32 s25, s73
  s_mov_b32 s26, 14680064
  s_mov_b32 s27, 0x20000
  s_lshl_b32 s54, s2, 2
  s_add_u32 s54, s54, s57
  s_mul_i32 s54, s54, 0
  s_add_u32 s54, s54, 0
  s_cmp_ge_u32 s57, 2
  s_cbranch_scc1 L_k1B
  s_mov_b32 s30, 7
  s_mov_b32 s31, -1
  s_mov_b32 s38, 0
  s_add_u32 s30, s30, 1
  s_and_b32 s30, s30, 7
  s_cselect_b32 s32, 0, 1
  s_add_u32 s31, s31, s32
  s_sub_u32 s32, s30, s7
  s_and_b32 s32, s32, 7
  s_cmp_lt_u32 s32, 2
  s_cselect_b32 s32, 1, 0
  s_add_u32 s32, s32, s31
  s_cmp_ge_u32 s32, 2
  s_cselect_b32 s32, 0, s32
  s_lshl_b32 s33, s32, 3
  s_add_u32 s33, s33, s30
  s_mul_i32 s36, s33, 128
  s_add_u32 s36, s36, s34
  s_add_u32 m0, s38, s45
  s_mov_b64 exec, s[52:53]
  buffer_load_dwordx4 v12, s[8:11], s36 offen offset:0 sc1 lds
  s_mov_b64 exec, -1
  s_add_u32 m0, s38, s44
  s_nop 0
  buffer_load_dwordx4 v8, s[8:11], s36 offen offset:0 sc1 lds
  buffer_load_dwordx4 v9, s[8:11], s36 offen offset:1024 sc1 lds
  buffer_load_dwordx4 v10, s[8:11], s36 offen offset:2048 sc1 lds
  buffer_load_dwordx4 v11, s[8:11], s36 offen offset:3072 sc1 lds
  s_add_u32 s38, s38, 43008
  s_cmp_eq_u32 s38, 129024
  s_cselect_b32 s38, 0, s38
  s_add_u32 s30, s30, 1
  s_and_b32 s30, s30, 7
  s_cselect_b32 s32, 0, 1
  s_add_u32 s31, s31, s32
  s_sub_u32 s32, s30, s7
  s_and_b32 s32, s32, 7
  s_cmp_lt_u32 s32, 2
  s_cselect_b32 s32, 1, 0
  s_add_u32 s32, s32, s31
  s_cmp_ge_u32 s32, 2
  s_cselect_b32 s32, 0, s32
  s_lshl_b32 s33, s32, 3
  s_add_u32 s33, s33, s30
  s_mul_i32 s36, s33, 128
  s_add_u32 s36, s36, s34
  s_add_u32 m0, s38, s45
  s_mov_b64 exec, s[52:53]
  buffer_load_dwordx4 v12, s[8:11], s36 offen offset:0 sc1 lds
  s_mov_b64 exec, -1
  s_add_u32 m0, s38, s44
  s_nop 0
  buffer_load_dwordx4 v8, s[8:11], s36 offen offset:0 sc1 lds
  buffer_load_dwordx4 v9, s[8:11], s36 offen offset:1024 sc1 lds
  buffer_load_dwordx4 v10, s[8:11], s36 offen offset:2048 sc1 lds
  buffer_load_dwordx4 v11, s[8:11], s36 offen offset:3072 sc1 lds
  s_add_u32 s38, s38, 43008
  s_cmp_eq_u32 s38, 129024
  s_cselect_b32 s38, 0, s38
  s_cmp_lg_u32 s3, 0
  s_cbranch_scc1 e6
  buffer_load_dwordx4 v[48:51], v46, s[8:11], 0 offen offset:0
  buffer_load_dwordx4 v[52:55], v46, s[8:11], 0 offen offset:512
  buffer_load_dwordx4 v[56:59], v46, s[8:11], 0 offen offset:1024
  buffer_load_dwordx4 v[60:63], v46, s[8:11], 0 offen offset:1536
  buffer_store_dwordx4 v[64:67], v47, s[16:19], s58 offen sc0 sc1
  s_barrier
e6:
  s_nop 1
  s_waitcnt vmcnt(5)
  s_barrier
  s_add_u32 s30, s30, 1
  s_and_b32 s30, s30, 7
  s_cselect_b32 s32, 0, 1
  s_add_u32 s31, s31, s32
  s_sub_u32 s32, s30, s7
  s_and_b32 s32, s32, 7
  s_cmp_lt_u32 s32, 2
  s_cselect_b32 s32, 1, 0
  s_add_u32 s32, s32, s31
  s_cmp_ge_u32 s32, 2
  s_cselect_b32 s32, 0, s32
  s_lshl_b32 s33, s32, 3
  s_add_u32 s33, s33, s30
  s_mul_i32 s36, s33, 128
  s_add_u32 s36, s36, s34
  s_mul_i32 s37, s33, 393216
  s_add_u32 s37, s37, s35
  s_add_u32 m0, s38, s45
  s_mov_b64 exec, s[52:53]
  buffer_load_dwordx4 v12, s[8:11], s36 offen offset:0 sc1 lds
  s_mov_b64 exec, -1
  s_add_u32 m0, s38, s44
  s_nop 0
  buffer_load_dwordx4 v8, s[8:11], s36 offen offset:0 sc1 lds
  buffer_load_dwordx4 v9, s[8:11], s36 offen offset:1024 sc1 lds
  buffer_load_dwordx4 v10, s[8:11], s36 offen offset:2048 sc1 lds
  buffer_load_dwordx4 v11, s[8:11], s36 offen offset:3072 sc1 lds
  s_add_u32 m0, s38, s46
  s_nop 0
  buffer_load_dwordx4 v13, s[12:15], s37 offen offset:0  lds
  buffer_load_dwordx4 v14, s[12:15], s37 offen offset:1024  lds
  s_add_u32 m0, s38, s47
  s_nop 0
  buffer_load_dwordx4 v15, s[12:15], s37 offen offset:0  lds
  buffer_load_dwordx4 v16, s[12:15], s37 offen offset:1024  lds
  s_add_u32 m0, s38, s48
  s_nop 0
  buffer_load_dwordx4 v17, s[12:15], s37 offen offset:0  lds
  buffer_load_dwordx4 v18, s[12:15], s37 offen offset:1024  lds
  s_add_u32 s38, s38, 43008
  s_cmp_eq_u32 s38, 129024
  s_cselect_b32 s38, 0, s38
  s_cmp_lg_u32 s3, 0
  s_cbranch_scc1 e7
  v_mov_b32 v68, 0
  v_mov_b32 v69, 0
  v_mov_b32 v70, 0x3f803f80
  s_waitcnt vmcnt(12)
  v_dot2c_f32_bf16 v68, v70, v48
  v_dot2c_f32_bf16 v69, v48, v48
  v_dot2c_f32_bf16 v68, v70, v49
  v_dot2c_f32_bf16 v69, v49, v49
  v_dot2c_f32_bf16 v68, v70, v50
  v_dot2c_f32_bf16 v69, v50, v50
  v_dot2c_f32_bf16 v68, v70, v51
  v_dot2c_f32_bf16 v69, v51, v51
  v_dot2c_f32_bf16 v68, v70, v52
  v_dot2c_f32_bf16 v69, v52, v52
  v_dot2c_f32_bf16 v68, v70, v53
  v_dot2c_f32_bf16 v69, v53, v53
  v_dot2c_f32_bf16 v68, v70, v54
  v_dot2c_f32_bf16 v69, v54, v54
  v_dot2c_f32_bf16 v68, v70, v55
  v_dot2c_f32_bf16 v69, v55, v55
  v_dot2c_f32_bf16 v68, v70, v56
  v_dot2c_f32_bf16 v69, v56, v56
  v_dot2c_f32_bf16 v68, v70, v57
  v_dot2c_f32_bf16 v69, v57, v57
  v_dot2c_f32_bf16 v68, v70, v58
  v_dot2c_f32_bf16 v69, v58, v58
  v_dot2c_f32_bf16 v68, v70, v59
  v_dot2c_f32_bf16 v69, v59, v59
  v_dot2c_f32_bf16 v68, v70, v60
  v_dot2c_f32_bf16 v69, v60, v60
  v_dot2c_f32_bf16 v68, v70, v61
  v_dot2c_f32_bf16 v69, v61, v61
  v_dot2c_f32_bf16 v68, v70, v62
  v_dot2c_f32_bf16 v69, v62, v62
  v_dot2c_f32_bf16 v68, v70, v63
  v_dot2c_f32_bf16 v69, v63, v63
  s_nop 1
  v_add_f32_dpp v68, v68, v68 quad_perm:[1,0,3,2] row_mask:0xf bank_mask:0xf
  v_add_f32_dpp v69, v69, v69 quad_perm:[1,0,3,2] row_mask:0xf bank_mask:0xf
  s_nop 0
  v_add_f32_dpp v68, v68, v68 quad_perm:[2,3,0,1] row_mask:0xf bank_mask:0xf
  v_add_f32_dpp v69, v69, v69 quad_perm:[2,3,0,1] row_mask:0xf bank_mask:0xf
  s_nop 0
  v_add_f32_dpp v68, v68, v68 row_half_mirror row_mask:0xf bank_mask:0xf
  v_add_f32_dpp v69, v69, v69 row_half_mirror row_mask:0xf bank_mask:0xf
  s_nop 0
  v_add_f32_dpp v68, v68, v68 row_mirror row_mask:0xf bank_mask:0xf
  v_add_f32_dpp v69, v69, v69 row_mirror row_mask:0xf bank_mask:0xf
  v_mov_b32 v70, v68
  v_mov_b32 v71, v69
  s_nop 0
  v_permlane16_swap_b32 v68, v70
  v_permlane16_swap_b32 v69, v71
  v_add_f32 v68, v68, v70
  v_add_f32 v69, v69, v71
  s_mov_b32 exec_lo, 1
  s_mov_b32 exec_hi, 1
  buffer_store_dwordx2 v[68:69], v72, s[16:19], 0 offen sc0 sc1
  s_mov_b64 exec, -1
e7:
  s_nop 1
  s_waitcnt vmcnt(11)
  s_barrier
  s_add_u32 s30, s30, 1
  s_and_b32 s30, s30, 7
  s_cselect_b32 s32, 0, 1
  s_add_u32 s31, s31, s32
  s_sub_u32 s32, s30, s7
  s_and_b32 s32, s32, 7
  s_cmp_lt_u32 s32, 2
  s_cselect_b32 s32, 1, 0
  s_add_u32 s32, s32, s31
  s_cmp_ge_u32 s32, 2
  s_cselect_b32 s32, 0, s32
  s_lshl_b32 s33, s32, 3
  s_add_u32 s33, s33, s30
  s_mul_i32 s36, s33, 128
  s_add_u32 s36, s36, s34
  s_mul_i32 s37, s33, 393216
  s_add_u32 s37, s37, s35
  s_add_u32 m0, s38, s45
  s_mov_b64 exec, s[52:53]
  buffer_load_dwordx4 v12, s[8:11], s36 offen offset:0 sc1 lds
  s_mov_b64 exec, -1
  s_add_u32 m0, s38, s44
  s_nop 0
  buffer_load_dwordx4 v8, s[8:11], s36 offen offset:0 sc1 lds
  buffer_load_dwordx4 v9, s[8:11], s36 offen offset:1024 sc1 lds
  buffer_load_dwordx4 v10, s[8:11], s36 offen offset:2048 sc1 lds
  buffer_load_dwordx4 v11, s[8:11], s36 offen offset:3072 sc1 lds
  s_add_u32 m0, s38, s46
  s_nop 0
  buffer_load_dwordx4 v13, s[12:15], s37 offen offset:0  lds
  buffer_load_dwordx4 v14, s[12:15], s37 offen offset:1024  lds
  s_add_u32 m0, s38, s47
  s_nop 0
  buffer_load_dwordx4 v15, s[12:15], s37 offen offset:0  lds
  buffer_load_dwordx4 v16, s[12:15], s37 offen offset:1024  lds
  s_add_u32 m0, s38, s48
  s_nop 0
  buffer_load_dwordx4 v17, s[12:15], s37 offen offset:0  lds
  buffer_load_dwordx4 v18, s[12:15], s37 offen offset:1024  lds
  s_add_u32 s38, s38, 43008
  s_cmp_eq_u32 s38, 129024
  s_cselect_b32 s38, 0, s38
  s_waitcnt vmcnt(11)
  s_barrier
  s_add_u32 s30, s30, 1
  s_and_b32 s30, s30, 7
  s_cselect_b32 s32, 0, 1
  s_add_u32 s31, s31, s32
  s_sub_u32 s32, s30, s7
  s_and_b32 s32, s32, 7
  s_cmp_lt_u32 s32, 2
  s_cselect_b32 s32, 1, 0
  s_add_u32 s32, s32, s31
  s_cmp_ge_u32 s32, 2
  s_cselect_b32 s32, 0, s32
  s_lshl_b32 s33, s32, 3
  s_add_u32 s33, s33, s30
  s_mul_i32 s36, s33, 128
  s_add_u32 s36, s36, s34
  s_mul_i32 s37, s33, 393216
  s_add_u32 s37, s37, s35
  s_add_u32 m0, s38, s45
  s_mov_b64 exec, s[52:53]
  buffer_load_dwordx4 v12, s[8:11], s36 offen offset:0 sc1 lds
  s_mov_b64 exec, -1
  s_add_u32 m0, s38, s44
  s_nop 0
  buffer_load_dwordx4 v8, s[8:11], s36 offen offset:0 sc1 lds
  buffer_load_dwordx4 v9, s[8:11], s36 offen offset:1024 sc1 lds
  buffer_load_dwordx4 v10, s[8:11], s36 offen offset:2048 sc1 lds
  buffer_load_dwordx4 v11, s[8:11], s36 offen offset:3072 sc1 lds
  s_add_u32 m0, s38, s46
  s_nop 0
  buffer_load_dwordx4 v13, s[12:15], s37 offen offset:0  lds
  buffer_load_dwordx4 v14, s[12:15], s37 offen offset:1024  lds
  s_add_u32 m0, s38, s47
  s_nop 0
  buffer_load_dwordx4 v15, s[12:15], s37 offen offset:0  lds
  buffer_load_dwordx4 v16, s[12:15], s37 offen offset:1024  lds
  s_add_u32 m0, s38, s48
  s_nop 0
  buffer_load_dwordx4 v17, s[12:15], s37 offen offset:0  lds
  buffer_load_dwordx4 v18, s[12:15], s37 offen offset:1024  lds
  s_add_u32 s38, s38, 43008
  s_cmp_eq_u32 s38, 129024
  s_cselect_b32 s38, 0, s38
  s_cmp_lg_u32 s3, 0
  s_cbranch_scc1 e8
  s_cmp_lg_u32 s57, 0
  s_cbranch_scc1 g9
  s_mov_b64 exec, 1
  global_atomic_add v73, v74, s[62:63] sc1
  s_mov_b64 exec, -1
g9:
e8:
  s_nop 1
  s_mov_b32 s39, 9
ll10:
  s_waitcnt vmcnt(11)
  s_barrier
  s_add_u32 s30, s30, 1
  s_and_b32 s30, s30, 7
  s_cselect_b32 s32, 0, 1
  s_add_u32 s31, s31, s32
  s_sub_u32 s32, s30, s7
  s_and_b32 s32, s32, 7
  s_cmp_lt_u32 s32, 2
  s_cselect_b32 s32, 1, 0
  s_add_u32 s32, s32, s31
  s_cmp_ge_u32 s32, 2
  s_cselect_b32 s32, 0, s32
  s_lshl_b32 s33, s32, 3
  s_add_u32 s33, s33, s30
  s_mul_i32 s36, s33, 128
  s_add_u32 s36, s36, s34
  s_mul_i32 s37, s33, 393216
  s_add_u32 s37, s37, s35
  s_add_u32 m0, s38, s45
  s_mov_b64 exec, s[52:53]
  buffer_load_dwordx4 v12, s[8:11], s36 offen offset:0 sc1 lds
  s_mov_b64 exec, -1
  s_add_u32 m0, s38, s44
  s_nop 0
  buffer_load_dwordx4 v8, s[8:11], s36 offen offset:0 sc1 lds
  buffer_load_dwordx4 v9, s[8:11], s36 offen offset:1024 sc1 lds
  buffer_load_dwordx4 v10, s[8:11], s36 offen offset:2048 sc1 lds
  buffer_load_dwordx4 v11, s[8:11], s36 offen offset:3072 sc1 lds
  s_add_u32 m0, s38, s46
  s_nop 0
  buffer_load_dwordx4 v13, s[12:15], s37 offen offset:0  lds
  buffer_load_dwordx4 v14, s[12:15], s37 offen offset:1024  lds
  s_add_u32 m0, s38, s47
  s_nop 0
  buffer_load_dwordx4 v15, s[12:15], s37 offen offset:0  lds
  buffer_load_dwordx4 v16, s[12:15], s37 offen offset:1024  lds
  s_add_u32 m0, s38, s48
  s_nop 0
  buffer_load_dwordx4 v17, s[12:15], s37 offen offset:0  lds
  buffer_load_dwordx4 v18, s[12:15], s37 offen offset:1024  lds
  s_add_u32 s38, s38, 43008
  s_cmp_eq_u32 s38, 129024
  s_cselect_b32 s38, 0, s38
  s_sub_u32 s39, s39, 1
  s_cmp_lg_u32 s39, 0
  s_cbranch_scc1 ll10
  s_waitcnt vmcnt(11)
  s_barrier
  s_add_u32 s30, s30, 1
  s_and_b32 s30, s30, 7
  s_cselect_b32 s32, 0, 1
  s_add_u32 s31, s31, s32
  s_sub_u32 s32, s30, s7
  s_and_b32 s32, s32, 7
  s_cmp_lt_u32 s32, 2
  s_cselect_b32 s32, 1, 0
  s_add_u32 s32, s32, s31
  s_cmp_ge_u32 s32, 2
  s_cselect_b32 s32, 0, s32
  s_lshl_b32 s33, s32, 3
  s_add_u32 s33, s33, s30
  s_mul_i32 s36, s33, 128
  s_add_u32 s36, s36, s34
  s_mul_i32 s37, s33, 393216
  s_add_u32 s37, s37, s35
  s_add_u32 m0, s38, s45
  s_mov_b64 exec, s[52:53]
  buffer_load_dwordx4 v12, s[8:11], s36 offen offset:0 sc1 lds
  s_mov_b64 exec, -1
  s_add_u32 m0, s38, s44
  s_nop 0
  buffer_load_dwordx4 v8, s[8:11], s36 offen offset:0 sc1 lds
  buffer_load_dwordx4 v9, s[8:11], s36 offen offset:1024 sc1 lds
  buffer_load_dwordx4 v10, s[8:11], s36 offen offset:2048 sc1 lds
  buffer_load_dwordx4 v11, s[8:11], s36 offen offset:3072 sc1 lds
  s_add_u32 m0, s38, s46
  s_nop 0
  buffer_load_dwordx4 v13, s[12:15], s37 offen offset:0  lds
  buffer_load_dwordx4 v14, s[12:15], s37 offen offset:1024  lds
  s_add_u32 m0, s38, s47
  s_nop 0
  buffer_load_dwordx4 v15, s[12:15], s37 offen offset:0  lds
  buffer_load_dwordx4 v16, s[12:15], s37 offen offset:1024  lds
  s_add_u32 m0, s38, s48
  s_nop 0
  buffer_load_dwordx4 v17, s[12:15], s37 offen offset:0  lds
  buffer_load_dwordx4 v18, s[12:15], s37 offen offset:1024  lds
  s_add_u32 s38, s38, 43008
  s_cmp_eq_u32 s38, 129024
  s_cselect_b32 s38, 0, s38
  global_load_dword v29, v134, s[62:63] sc0 sc1
  s_waitcnt vmcnt(11)
  s_barrier
  s_add_u32 s30, s30, 1
  s_and_b32 s30, s30, 7
  s_cselect_b32 s32, 0, 1
  s_add_u32 s31, s31, s32
  s_sub_u32 s32, s30, s7
  s_and_b32 s32, s32, 7
  s_cmp_lt_u32 s32, 2
  s_cselect_b32 s32, 1, 0
  s_add_u32 s32, s32, s31
  s_cmp_ge_u32 s32, 2
  s_cselect_b32 s32, 0, s32
  s_lshl_b32 s33, s32, 3
  s_add_u32 s33, s33, s30
  s_mul_i32 s36, s33, 128
  s_add_u32 s36, s36, s34
  s_mul_i32 s37, s33, 393216
  s_add_u32 s37, s37, s35
  s_add_u32 m0, s38, s45
  s_mov_b64 exec, s[52:53]
  buffer_load_dwordx4 v12, s[8:11], s36 offen offset:0 sc1 lds
  s_mov_b64 exec, -1
  s_add_u32 m0, s38, s44
  s_nop 0
  buffer_load_dwordx4 v8, s[8:11], s36 offen offset:0 sc1 lds
  buffer_load_dwordx4 v9, s[8:11], s36 offen offset:1024 sc1 lds
  buffer_load_dwordx4 v10, s[8:11], s36 offen offset:2048 sc1 lds
  buffer_load_dwordx4 v11, s[8:11], s36 offen offset:3072 sc1 lds
  s_add_u32 m0, s38, s46
  s_nop 0
  buffer_load_dwordx4 v13, s[12:15], s37 offen offset:0  lds
  buffer_load_dwordx4 v14, s[12:15], s37 offen offset:1024  lds
  s_add_u32 m0, s38, s47
  s_nop 0
  buffer_load_dwordx4 v15, s[12:15], s37 offen offset:0  lds
  buffer_load_dwordx4 v16, s[12:15], s37 offen offset:1024  lds
  s_add_u32 m0, s38, s48
  s_nop 0
  buffer_load_dwordx4 v17, s[12:15], s37 offen offset:0  lds
  buffer_load_dwordx4 v18, s[12:15], s37 offen offset:1024  lds
  s_add_u32 s38, s38, 43008
  s_cmp_eq_u32 s38, 129024
  s_cselect_b32 s38, 0, s38
  s_cmp_lg_u32 s3, 0
  s_cbranch_scc1 st11g
  s_waitcnt vmcnt(11)
  s_mov_b32 s61, 0
st11p:
  v_cmp_gt_u32 vcc, 64, v29
  s_add_u32 s61, s61, 1
  s_cmp_gt_u32 s61, 100000
  s_cbranch_scc1 st11g
  s_cbranch_vccz st11g
  global_load_dword v29, v134, s[62:63] sc0 sc1
  s_waitcnt vmcnt(0)
  s_branch st11p
st11g:
  buffer_load_dwordx2 v[30:31], v27, s[20:23], 0 offen sc1
  s_mov_b32 s32, 16384
  buffer_load_dwordx2 v[32:33], v27, s[20:23], s32 offen sc1
  s_mov_b32 s32, 32768
  buffer_load_dwordx2 v[34:35], v27, s[20:23], s32 offen sc1
  s_mov_b32 s32, 49152
  buffer_load_dwordx2 v[36:37], v27, s[20:23], s32 offen sc1
  s_mov_b32 s32, 65536
  buffer_load_dwordx2 v[38:39], v27, s[20:23], s32 offen sc1
  s_mov_b32 s32, 81920
  buffer_load_dwordx2 v[40:41], v27, s[20:23], s32 offen sc1
  s_mov_b32 s32, 98304
  buffer_load_dwordx2 v[42:43], v27, s[20:23], s32 offen sc1
  s_mov_b32 s32, 114688
  buffer_load_dwordx2 v[44:45], v27, s[20:23], s32 offen sc1
  s_waitcnt vmcnt(19)
  s_barrier
  s_branch L_k1t
L_k1B:
  s_nop 7
  s_nop 7
  s_mov_b32 s30, 7
  s_mov_b32 s31, -1
  s_mov_b32 s38, 0
  s_add_u32 s30, s30, 1
  s_and_b32 s30, s30, 7
  s_cselect_b32 s32, 0, 1
  s_add_u32 s31, s31, s32
  s_sub_u32 s32, s30, s7
  s_and_b32 s32, s32, 7
  s_cmp_lt_u32 s32, 2
  s_cselect_b32 s32, 1, 0
  s_add_u32 s32, s32, s31
  s_cmp_ge_u32 s32, 2
  s_cselect_b32 s32, 0, s32
  s_lshl_b32 s33, s32, 3
  s_add_u32 s33, s33, s30
  s_mul_i32 s36, s33, 128
  s_add_u32 s36, s36, s34
  s_add_u32 m0, s38, s44
  s_nop 0
  buffer_load_dwordx4 v8, s[8:11], s36 offen offset:0 sc1 lds
  buffer_load_dwordx4 v9, s[8:11], s36 offen offset:1024 sc1 lds
  buffer_load_dwordx4 v10, s[8:11], s36 offen offset:2048 sc1 lds
  buffer_load_dwordx4 v11, s[8:11], s36 offen offset:3072 sc1 lds
  s_add_u32 s38, s38, 43008
  s_cmp_eq_u32 s38, 129024
  s_cselect_b32 s38, 0, s38
  s_add_u32 s30, s30, 1
  s_and_b32 s30, s30, 7
  s_cselect_b32 s32, 0, 1
  s_add_u32 s31, s31, s32
  s_sub_u32 s32, s30, s7
  s_and_b32 s32, s32, 7
  s_cmp_lt_u32 s32, 2
  s_cselect_b32 s32, 1, 0
  s_add_u32 s32, s32, s31
  s_cmp_ge_u32 s32, 2
  s_cselect_b32 s32, 0, s32
  s_lshl_b32 s33, s32, 3
  s_add_u32 s33, s33, s30
  s_mul_i32 s36, s33, 128
  s_add_u32 s36, s36, s34
  s_add_u32 m0, s38, s44
  s_nop 0
  buffer_load_dwordx4 v8, s[8:11], s36 offen offset:0 sc1 lds
  buffer_load_dwordx4 v9, s[8:11], s36 offen offset:1024 sc1 lds
  buffer_load_dwordx4 v10, s[8:11], s36 offen offset:2048 sc1 lds
  buffer_load_dwordx4 v11, s[8:11], s36 offen offset:3072 sc1 lds
  s_add_u32 s38, s38, 43008
  s_cmp_eq_u32 s38, 129024
  s_cselect_b32 s38, 0, s38
  s_cmp_lg_u32 s3, 0
  s_cbranch_scc1 e12
  buffer_load_dwordx4 v[48:51], v46, s[8:11], 0 offen offset:0
  buffer_load_dwordx4 v[52:55], v46, s[8:11], 0 offen offset:512
  buffer_load_dwordx4 v[56:59], v46, s[8:11], 0 offen offset:1024
  buffer_load_dwordx4 v[60:63], v46, s[8:11], 0 offen offset:1536
  buffer_store_dwordx4 v[64:67], v47, s[16:19], s58 offen sc0 sc1
  s_barrier
e12:
  s_nop 1
  s_waitcnt vmcnt(4)
  s_barrier
  s_add_u32 s30, s30, 1
  s_and_b32 s30, s30, 7
  s_cselect_b32 s32, 0, 1
  s_add_u32 s31, s31, s32
  s_sub_u32 s32, s30, s7
  s_and_b32 s32, s32, 7
  s_cmp_lt_u32 s32, 2
  s_cselect_b32 s32, 1, 0
  s_add_u32 s32, s32, s31
  s_cmp_ge_u32 s32, 2
  s_cselect_b32 s32, 0, s32
  s_lshl_b32 s33, s32, 3
  s_add_u32 s33, s33, s30
  s_mul_i32 s36, s33, 128
  s_add_u32 s36, s36, s34
  s_mul_i32 s37, s33, 393216
  s_add_u32 s37, s37, s35
  s_add_u32 m0, s38, s44
  s_nop 0
  buffer_load_dwordx4 v8, s[8:11], s36 offen offset:0 sc1 lds
  buffer_load_dwordx4 v9, s[8:11], s36 offen offset:1024 sc1 lds
  buffer_load_dwordx4 v10, s[8:11], s36 offen offset:2048 sc1 lds
  buffer_load_dwordx4 v11, s[8:11], s36 offen offset:3072 sc1 lds
  s_add_u32 m0, s38, s46
  s_nop 0
  buffer_load_dwordx4 v13, s[12:15], s37 offen offset:0  lds
  buffer_load_dwordx4 v14, s[12:15], s37 offen offset:1024  lds
  s_add_u32 m0, s38, s47
  s_nop 0
  buffer_load_dwordx4 v15, s[12:15], s37 offen offset:0  lds
  buffer_load_dwordx4 v16, s[12:15], s37 offen offset:1024  lds
  s_add_u32 m0, s38, s48
  s_nop 0
  buffer_load_dwordx4 v17, s[12:15], s37 offen offset:0  lds
  buffer_load_dwordx4 v18, s[12:15], s37 offen offset:1024  lds
  s_add_u32 s38, s38, 43008
  s_cmp_eq_u32 s38, 129024
  s_cselect_b32 s38, 0, s38
  s_cmp_lg_u32 s3, 0
  s_cbranch_scc1 e13
  v_mov_b32 v68, 0
  v_mov_b32 v69, 0
  v_mov_b32 v70, 0x3f803f80
  s_waitcnt vmcnt(11)
  v_dot2c_f32_bf16 v68, v70, v48
  v_dot2c_f32_bf16 v69, v48, v48
  v_dot2c_f32_bf16 v68, v70, v49
  v_dot2c_f32_bf16 v69, v49, v49
  v_dot2c_f32_bf16 v68, v70, v50
  v_dot2c_f32_bf16 v69, v50, v50
  v_dot2c_f32_bf16 v68, v70, v51
  v_dot2c_f32_bf16 v69, v51, v51
  v_dot2c_f32_bf16 v68, v70, v52
  v_dot2c_f32_bf16 v69, v52, v52
  v_dot2c_f32_bf16 v68, v70, v53
  v_dot2c_f32_bf16 v69, v53, v53
  v_dot2c_f32_bf16 v68, v70, v54
  v_dot2c_f32_bf16 v69, v54, v54
  v_dot2c_f32_bf16 v68, v70, v55
  v_dot2c_f32_bf16 v69, v55, v55
  v_dot2c_f32_bf16 v68, v70, v56
  v_dot2c_f32_bf16 v69, v56, v56
  v_dot2c_f32_bf16 v68, v70, v57
  v_dot2c_f32_bf16 v69, v57, v57
  v_dot2c_f32_bf16 v68, v70, v58
  v_dot2c_f32_bf16 v69, v58, v58
  v_dot2c_f32_bf16 v68, v70, v59
  v_dot2c_f32_bf16 v69, v59, v59
  v_dot2c_f32_bf16 v68, v70, v60
  v_dot2c_f32_bf16 v69, v60, v60
  v_dot2c_f32_bf16 v68, v70, v61
  v_dot2c_f32_bf16 v69, v61, v61
  v_dot2c_f32_bf16 v68, v70, v62
  v_dot2c_f32_bf16 v69, v62, v62
  v_dot2c_f32_bf16 v68, v70, v63
  v_dot2c_f32_bf16 v69, v63, v63
  s_nop 1
  v_add_f32_dpp v68, v68, v68 quad_perm:[1,0,3,2] row_mask:0xf bank_mask:0xf
  v_add_f32_dpp v69, v69, v69 quad_perm:[1,0,3,2] row_mask:0xf bank_mask:0xf
  s_nop 0
  v_add_f32_dpp v68, v68, v68 quad_perm:[2,3,0,1] row_mask:0xf bank_mask:0xf
  v_add_f32_dpp v69, v69, v69 quad_perm:[2,3,0,1] row_mask:0xf bank_mask:0xf
  s_nop 0
  v_add_f32_dpp v68, v68, v68 row_half_mirror row_mask:0xf bank_mask:0xf
  v_add_f32_dpp v69, v69, v69 row_half_mirror row_mask:0xf bank_mask:0xf
  s_nop 0
  v_add_f32_dpp v68, v68, v68 row_mirror row_mask:0xf bank_mask:0xf
  v_add_f32_dpp v69, v69, v69 row_mirror row_mask:0xf bank_mask:0xf
  v_mov_b32 v70, v68
  v_mov_b32 v71, v69
  s_nop 0
  v_permlane16_swap_b32 v68, v70
  v_permlane16_swap_b32 v69, v71
  v_add_f32 v68, v68, v70
  v_add_f32 v69, v69, v71
  s_mov_b32 exec_lo, 1
  s_mov_b32 exec_hi, 1
  buffer_store_dwordx2 v[68:69], v72, s[16:19], 0 offen sc0 sc1
  s_mov_b64 exec, -1
e13:
  s_nop 1
  s_waitcnt vmcnt(10)
  s_barrier
  s_add_u32 s30, s30, 1
  s_and_b32 s30, s30, 7
  s_cselect_b32 s32, 0, 1
  s_add_u32 s31, s31, s32
  s_sub_u32 s32, s30, s7
  s_and_b32 s32, s32, 7
  s_cmp_lt_u32 s32, 2
  s_cselect_b32 s32, 1, 0
  s_add_u32 s32, s32, s31
  s_cmp_ge_u32 s32, 2
  s_cselect_b32 s32, 0, s32
  s_lshl_b32 s33, s32, 3
  s_add_u32 s33, s33, s30
  s_mul_i32 s36, s33, 128
  s_add_u32 s36, s36, s34
  s_mul_i32 s37, s33, 393216
  s_add_u32 s37, s37, s35
  s_add_u32 m0, s38, s44
  s_nop 0
  buffer_load_dwordx4 v8, s[8:11], s36 offen offset:0 sc1 lds
  buffer_load_dwordx4 v9, s[8:11], s36 offen offset:1024 sc1 lds
  buffer_load_dwordx4 v10, s[8:11], s36 offen offset:2048 sc1 lds
  buffer_load_dwordx4 v11, s[8:11], s36 offen offset:3072 sc1 lds
  s_add_u32 m0, s38, s46
  s_nop 0
  buffer_load_dwordx4 v13, s[12:15], s37 offen offset:0  lds
  buffer_load_dwordx4 v14, s[12:15], s37 offen offset:1024  lds
  s_add_u32 m0, s38, s47
  s_nop 0
  buffer_load_dwordx4 v15, s[12:15], s37 offen offset:0  lds
  buffer_load_dwordx4 v16, s[12:15], s37 offen offset:1024  lds
  s_add_u32 m0, s38, s48
  s_nop 0
  buffer_load_dwordx4 v17, s[12:15], s37 offen offset:0  lds
  buffer_load_dwordx4 v18, s[12:15], s37 offen offset:1024  lds
  s_add_u32 s38, s38, 43008
  s_cmp_eq_u32 s38, 129024
  s_cselect_b32 s38, 0, s38
  s_waitcnt vmcnt(10)
  s_barrier
  s_add_u32 s30, s30, 1
  s_and_b32 s30, s30, 7
  s_cselect_b32 s32, 0, 1
  s_add_u32 s31, s31, s32
  s_sub_u32 s32, s30, s7
  s_and_b32 s32, s32, 7
  s_cmp_lt_u32 s32, 2
  s_cselect_b32 s32, 1, 0
  s_add_u32 s32, s32, s31
  s_cmp_ge_u32 s32, 2
  s_cselect_b32 s32, 0, s32
  s_lshl_b32 s33, s32, 3
  s_add_u32 s33, s33, s30
  s_mul_i32 s36, s33, 128
  s_add_u32 s36, s36, s34
  s_mul_i32 s37, s33, 393216
  s_add_u32 s37, s37, s35
  s_add_u32 m0, s38, s44
  s_nop 0
  buffer_load_dwordx4 v8, s[8:11], s36 offen offset:0 sc1 lds
  buffer_load_dwordx4 v9, s[8:11], s36 offen offset:1024 sc1 lds
  buffer_load_dwordx4 v10, s[8:11], s36 offen offset:2048 sc1 lds
  buffer_load_dwordx4 v11, s[8:11], s36 offen offset:3072 sc1 lds
  s_add_u32 m0, s38, s46
  s_nop 0
  buffer_load_dwordx4 v13, s[12:15], s37 offen offset:0  lds
  buffer_load_dwordx4 v14, s[12:15], s37 offen offset:1024  lds
  s_add_u32 m0, s38, s47
  s_nop 0
  buffer_load_dwordx4 v15, s[12:15], s37 offen offset:0  lds
  buffer_load_dwordx4 v16, s[12:15], s37 offen offset:1024  lds
  s_add_u32 m0, s38, s48
  s_nop 0
  buffer_load_dwordx4 v17, s[12:15], s37 offen offset:0  lds
  buffer_load_dwordx4 v18, s[12:15], s37 offen offset:1024  lds
  s_add_u32 s38, s38, 43008
  s_cmp_eq_u32 s38, 129024
  s_cselect_b32 s38, 0, s38
  s_cmp_lg_u32 s3, 0
  s_cbranch_scc1 e14
  s_cmp_lg_u32 s57, 0
  s_cbranch_scc1 g15
  s_mov_b64 exec, 1
  global_atomic_add v73, v74, s[62:63] sc1
  s_mov_b64 exec, -1
g15:
e14:
  s_nop 1
  s_mov_b32 s39, 9
ll16:
  s_waitcnt vmcnt(10)
  s_barrier
  s_add_u32 s30, s30, 1
  s_and_b32 s30, s30, 7
  s_cselect_b32 s32, 0, 1
  s_add_u32 s31, s31, s32
  s_sub_u32 s32, s30, s7
  s_and_b32 s32, s32, 7
  s_cmp_lt_u32 s32, 2
  s_cselect_b32 s32, 1, 0
  s_add_u32 s32, s32, s31
  s_cmp_ge_u32 s32, 2
  s_cselect_b32 s32, 0, s32
  s_lshl_b32 s33, s32, 3
  s_add_u32 s33, s33, s30
  s_mul_i32 s36, s33, 128
  s_add_u32 s36, s36, s34
  s_mul_i32 s37, s33, 393216
  s_add_u32 s37, s37, s35
  s_add_u32 m0, s38, s44
  s_nop 0
  buffer_load_dwordx4 v8, s[8:11], s36 offen offset:0 sc1 lds
  buffer_load_dwordx4 v9, s[8:11], s36 offen offset:1024 sc1 lds
  buffer_load_dwordx4 v10, s[8:11], s36 offen offset:2048 sc1 lds
  buffer_load_dwordx4 v11, s[8:11], s36 offen offset:3072 sc1 lds
  s_add_u32 m0, s38, s46
  s_nop 0
  buffer_load_dwordx4 v13, s[12:15], s37 offen offset:0  lds
  buffer_load_dwordx4 v14, s[12:15], s37 offen offset:1024  lds
  s_add_u32 m0, s38, s47
  s_nop 0
  buffer_load_dwordx4 v15, s[12:15], s37 offen offset:0  lds
  buffer_load_dwordx4 v16, s[12:15], s37 offen offset:1024  lds
  s_add_u32 m0, s38, s48
  s_nop 0
  buffer_load_dwordx4 v17, s[12:15], s37 offen offset:0  lds
  buffer_load_dwordx4 v18, s[12:15], s37 offen offset:1024  lds
  s_add_u32 s38, s38, 43008
  s_cmp_eq_u32 s38, 129024
  s_cselect_b32 s38, 0, s38
  s_sub_u32 s39, s39, 1
  s_cmp_lg_u32 s39, 0
  s_cbranch_scc1 ll16
  s_waitcnt vmcnt(10)
  s_barrier
  s_add_u32 s30, s30, 1
  s_and_b32 s30, s30, 7
  s_cselect_b32 s32, 0, 1
  s_add_u32 s31, s31, s32
  s_sub_u32 s32, s30, s7
  s_and_b32 s32, s32, 7
  s_cmp_lt_u32 s32, 2
  s_cselect_b32 s32, 1, 0
  s_add_u32 s32, s32, s31
  s_cmp_ge_u32 s32, 2
  s_cselect_b32 s32, 0, s32
  s_lshl_b32 s33, s32, 3
  s_add_u32 s33, s33, s30
  s_mul_i32 s36, s33, 128
  s_add_u32 s36, s36, s34
  s_mul_i32 s37, s33, 393216
  s_add_u32 s37, s37, s35
  s_add_u32 m0, s38, s44
  s_nop 0
  buffer_load_dwordx4 v8, s[8:11], s36 offen offset:0 sc1 lds
  buffer_load_dwordx4 v9, s[8:11], s36 offen offset:1024 sc1 lds
  buffer_load_dwordx4 v10, s[8:11], s36 offen offset:2048 sc1 lds
  buffer_load_dwordx4 v11, s[8:11], s36 offen offset:3072 sc1 lds
  s_add_u32 m0, s38, s46
  s_nop 0
  buffer_load_dwordx4 v13, s[12:15], s37 offen offset:0  lds
  buffer_load_dwordx4 v14, s[12:15], s37 offen offset:1024  lds
  s_add_u32 m0, s38, s47
  s_nop 0
  buffer_load_dwordx4 v15, s[12:15], s37 offen offset:0  lds
  buffer_load_dwordx4 v16, s[12:15], s37 offen offset:1024  lds
  s_add_u32 m0, s38, s48
  s_nop 0
  buffer_load_dwordx4 v17, s[12:15], s37 offen offset:0  lds
  buffer_load_dwordx4 v18, s[12:15], s37 offen offset:1024  lds
  s_add_u32 s38, s38, 43008
  s_cmp_eq_u32 s38, 129024
  s_cselect_b32 s38, 0, s38
  global_load_dword v29, v134, s[62:63] sc0 sc1
  s_waitcnt vmcnt(10)
  s_barrier
  s_add_u32 s30, s30, 1
  s_and_b32 s30, s30, 7
  s_cselect_b32 s32, 0, 1
  s_add_u32 s31, s31, s32
  s_sub_u32 s32, s30, s7
  s_and_b32 s32, s32, 7
  s_cmp_lt_u32 s32, 2
  s_cselect_b32 s32, 1, 0
  s_add_u32 s32, s32, s31
  s_cmp_ge_u32 s32, 2
  s_cselect_b32 s32, 0, s32
  s_lshl_b32 s33, s32, 3
  s_add_u32 s33, s33, s30
  s_mul_i32 s36, s33, 128
  s_add_u32 s36, s36, s34
  s_mul_i32 s37, s33, 393216
  s_add_u32 s37, s37, s35
  s_add_u32 m0, s38, s44
  s_nop 0
  buffer_load_dwordx4 v8, s[8:11], s36 offen offset:0 sc1 lds
  buffer_load_dwordx4 v9, s[8:11], s36 offen offset:1024 sc1 lds
  buffer_load_dwordx4 v10, s[8:11], s36 offen offset:2048 sc1 lds
  buffer_load_dwordx4 v11, s[8:11], s36 offen offset:3072 sc1 lds
  s_add_u32 m0, s38, s46
  s_nop 0
  buffer_load_dwordx4 v13, s[12:15], s37 offen offset:0  lds
  buffer_load_dwordx4 v14, s[12:15], s37 offen offset:1024  lds
  s_add_u32 m0, s38, s47
  s_nop 0
  buffer_load_dwordx4 v15, s[12:15], s37 offen offset:0  lds
  buffer_load_dwordx4 v16, s[12:15], s37 offen offset:1024  lds
  s_add_u32 m0, s38, s48
  s_nop 0
  buffer_load_dwordx4 v17, s[12:15], s37 offen offset:0  lds
  buffer_load_dwordx4 v18, s[12:15], s37 offen offset:1024  lds
  s_add_u32 s38, s38, 43008
  s_cmp_eq_u32 s38, 129024
  s_cselect_b32 s38, 0, s38
  s_cmp_lg_u32 s3, 0
  s_cbranch_scc1 st17g
  s_waitcnt vmcnt(10)
  s_mov_b32 s61, 0
st17p:
  v_cmp_gt_u32 vcc, 64, v29
  s_add_u32 s61, s61, 1
  s_cmp_gt_u32 s61, 100000
  s_cbranch_scc1 st17g
  s_cbranch_vccz st17g
  global_load_dword v29, v134, s[62:63] sc0 sc1
  s_waitcnt vmcnt(0)
  s_branch st17p
st17g:
  buffer_load_dwordx2 v[30:31], v27, s[20:23], 0 offen sc1
  s_mov_b32 s32, 16384
  buffer_load_dwordx2 v[32:33], v27, s[20:23], s32 offen sc1
  s_mov_b32 s32, 32768
  buffer_load_dwordx2 v[34:35], v27, s[20:23], s32 offen sc1
  s_mov_b32 s32, 49152
  buffer_load_dwordx2 v[36:37], v27, s[20:23], s32 offen sc1
  s_mov_b32 s32, 65536
  buffer_load_dwordx2 v[38:39], v27, s[20:23], s32 offen sc1
  s_mov_b32 s32, 81920
  buffer_load_dwordx2 v[40:41], v27, s[20:23], s32 offen sc1
  s_mov_b32 s32, 98304
  buffer_load_dwordx2 v[42:43], v27, s[20:23], s32 offen sc1
  s_mov_b32 s32, 114688
  buffer_load_dwordx2 v[44:45], v27, s[20:23], s32 offen sc1
  s_waitcnt vmcnt(18)
  s_barrier
L_k1t:
  s_nop 7
  s_nop 7
  s_waitcnt vmcnt(0)
  v_pk_add_f32 v[30:31], v[30:31], v[32:33]
  v_pk_add_f32 v[34:35], v[34:35], v[36:37]
  v_pk_add_f32 v[38:39], v[38:39], v[40:41]
  v_pk_add_f32 v[42:43], v[42:43], v[44:45]
  v_pk_add_f32 v[30:31], v[30:31], v[34:35]
  v_pk_add_f32 v[38:39], v[38:39], v[42:43]
  v_pk_add_f32 v[30:31], v[30:31], v[38:39]
  v_mul_f32 v30, 0x3a800000, v30
  v_mul_f32 v31, 0x3a800000, v31
  v_fma_f32 v31, -v30, v30, v31
  v_max_f32 v31, 0, v31
  v_mov_b32 v32, v31
  v_cvt_pk_bf16_f32 v32, v32, v32
  v_lshlrev_b32 v32, 16, v32
  v_add_f32 v32, 0x3727c5ac, v32
  v_cvt_pk_bf16_f32 v32, v32, v32
  v_lshlrev_b32 v32, 16, v32
  v_sqrt_f32 v32, v32
  s_nop 0
  v_cvt_pk_bf16_f32 v32, v32, v32
  v_lshlrev_b32 v32, 16, v32
  v_rcp_f32 v32, v32
  v_cvt_pk_bf16_f32 v30, v30, v30
  v_lshlrev_b32 v30, 16, v30
  v_mov_b32 v31, v32
  ds_write_b64 v26, v[30:31]
  s_waitcnt lgkmcnt(0)
  s_mov_b32 s41, s57
  s_mul_i32 s32, s41, 16
  s_add_u32 s32, s32, 0
  v_lshrrev_b32 v2, 3, v0
  v_add_u32 v2, s32, v2
  v_bfe_u32 v3, v2, 1, 1
  v_bfe_u32 v4, v2, 3, 1
  v_lshl_or_b32 v3, v4, 1, v3
  v_lshlrev_b32 v3, 1, v3
  v_and_b32 v4, 7, v0
  v_xor_b32 v3, v3, v4
  v_lshlrev_b32 v3, 4, v3
  s_mov_b32 s32, 2048
  v_mul_lo_u32 v2, v2, s32
  v_add_u32 v130, v2, v3
  s_mul_i32 s32, s41, 16
  s_add_u32 s32, s32, 8
  v_lshrrev_b32 v2, 3, v0
  v_add_u32 v2, s32, v2
  v_bfe_u32 v3, v2, 1, 1
  v_bfe_u32 v4, v2, 3, 1
  v_lshl_or_b32 v3, v4, 1, v3
  v_lshlrev_b32 v3, 1, v3
  v_and_b32 v4, 7, v0
  v_xor_b32 v3, v3, v4
  v_lshlrev_b32 v3, 4, v3
  s_mov_b32 s32, 2048
  v_mul_lo_u32 v2, v2, s32
  v_add_u32 v131, v2, v3
  v_subrev_u32 v131, 1024, v131
  s_mov_b32 s12, s68
  s_mov_b32 s13, s69
  s_mov_b32 s14, 2097152
  s_mov_b32 s15, 0x20000
  s_mov_b32 s30, 7
  s_mov_b32 s31, -1
  s_lshl_b32 s52, s57, 11
  s_add_u32 s30, s30, 1
  s_and_b32 s30, s30, 7
  s_cselect_b32 s32, 0, 1
  s_add_u32 s31, s31, s32
  s_sub_u32 s32, s30, s7
  s_and_b32 s32, s32, 7
  s_cmp_lt_u32 s32, 2
  s_cselect_b32 s32, 1, 0
  s_add_u32 s32, s32, s31
  s_cmp_ge_u32 s32, 2
  s_cselect_b32 s32, 0, s32
  s_lshl_b32 s33, s32, 3
  s_add_u32 s33, s33, s30
  s_lshl_b32 s37, s33, 17
  s_add_u32 s37, s37, s35
  s_add_u32 m0, s52, 131072
  s_nop 0
  buffer_load_dwordx4 v130, s[12:15], s37 offen lds
  buffer_load_dwordx4 v131, s[12:15], s37 offen offset:1024 lds
  s_add_u32 s30, s30, 1
  s_and_b32 s30, s30, 7
  s_cselect_b32 s32, 0, 1
  s_add_u32 s31, s31, s32
  s_sub_u32 s32, s30, s7
  s_and_b32 s32, s32, 7
  s_cmp_lt_u32 s32, 2
  s_cselect_b32 s32, 1, 0
  s_add_u32 s32, s32, s31
  s_cmp_ge_u32 s32, 2
  s_cselect_b32 s32, 0, s32
  s_lshl_b32 s33, s32, 3
  s_add_u32 s33, s33, s30
  s_lshl_b32 s37, s33, 17
  s_add_u32 s37, s37, s35
  s_add_u32 m0, s52, 139264
  s_nop 0
  buffer_load_dwordx4 v130, s[12:15], s37 offen lds
  buffer_load_dwordx4 v131, s[12:15], s37 offen offset:1024 lds
  s_add_u32 s30, s30, 1
  s_and_b32 s30, s30, 7
  s_cselect_b32 s32, 0, 1
  s_add_u32 s31, s31, s32
  s_sub_u32 s32, s30, s7
  s_and_b32 s32, s32, 7
  s_cmp_lt_u32 s32, 2
  s_cselect_b32 s32, 1, 0
  s_add_u32 s32, s32, s31
  s_cmp_ge_u32 s32, 2
  s_cselect_b32 s32, 0, s32
  s_lshl_b32 s33, s32, 3
  s_add_u32 s33, s33, s30
  s_lshl_b32 s37, s33, 17
  s_add_u32 s37, s37, s35
  s_add_u32 m0, s52, 147456
  s_nop 0
  buffer_load_dwordx4 v130, s[12:15], s37 offen lds
  buffer_load_dwordx4 v131, s[12:15], s37 offen offset:1024 lds
  s_add_u32 s30, s30, 1
  s_and_b32 s30, s30, 7
  s_cselect_b32 s32, 0, 1
  s_add_u32 s31, s31, s32
  s_sub_u32 s32, s30, s7
  s_and_b32 s32, s32, 7
  s_cmp_lt_u32 s32, 2
  s_cselect_b32 s32, 1, 0
  s_add_u32 s32, s32, s31
  s_cmp_ge_u32 s32, 2
  s_cselect_b32 s32, 0, s32
  s_lshl_b32 s33, s32, 3
  s_add_u32 s33, s33, s30
  s_lshl_b32 s37, s33, 17
  s_add_u32 s37, s37, s35
  s_add_u32 m0, s52, 155648
  s_nop 0
  buffer_load_dwordx4 v130, s[12:15], s37 offen lds
  buffer_load_dwordx4 v131, s[12:15], s37 offen offset:1024 lds
  s_waitcnt vmcnt(8)
  s_barrier
  s_add_u32 s30, s30, 1
  s_and_b32 s30, s30, 7
  s_cselect_b32 s32, 0, 1
  s_add_u32 s31, s31, s32
  s_sub_u32 s32, s30, s7
  s_and_b32 s32, s32, 7
  s_cmp_lt_u32 s32, 2
  s_cselect_b32 s32, 1, 0
  s_add_u32 s32, s32, s31
  s_cmp_ge_u32 s32, 2
  s_cselect_b32 s32, 0, s32
  s_lshl_b32 s33, s32, 3
  s_add_u32 s33, s33, s30
  s_lshl_b32 s37, s33, 17
  s_add_u32 s37, s37, s35
  s_add_u32 m0, s52, 100608
  s_nop 0
  buffer_load_dwordx4 v130, s[12:15], s37 offen lds
  buffer_load_dwordx4 v131, s[12:15], s37 offen offset:1024 lds
  s_add_u32 s30, s30, 1
  s_and_b32 s30, s30, 7
  s_cselect_b32 s32, 0, 1
  s_add_u32 s31, s31, s32
  s_sub_u32 s32, s30, s7
  s_and_b32 s32, s32, 7
  s_cmp_lt_u32 s32, 2
  s_cselect_b32 s32, 1, 0
  s_add_u32 s32, s32, s31
  s_cmp_ge_u32 s32, 2
  s_cselect_b32 s32, 0, s32
  s_lshl_b32 s33, s32, 3
  s_add_u32 s33, s33, s30
  s_lshl_b32 s37, s33, 17
  s_add_u32 s37, s37, s35
  s_add_u32 m0, s52, 108800
  s_nop 0
  buffer_load_dwordx4 v130, s[12:15], s37 offen lds
  buffer_load_dwordx4 v131, s[12:15], s37 offen offset:1024 lds
  s_add_u32 s30, s30, 1
  s_and_b32 s30, s30, 7
  s_cselect_b32 s32, 0, 1
  s_add_u32 s31, s31, s32
  s_sub_u32 s32, s30, s7
  s_and_b32 s32, s32, 7
  s_cmp_lt_u32 s32, 2
  s_cselect_b32 s32, 1, 0
  s_add_u32 s32, s32, s31
  s_cmp_ge_u32 s32, 2
  s_cselect_b32 s32, 0, s32
  s_lshl_b32 s33, s32, 3
  s_add_u32 s33, s33, s30
  s_lshl_b32 s37, s33, 17
  s_add_u32 s37, s37, s35
  s_add_u32 m0, s52, 116992
  s_nop 0
  buffer_load_dwordx4 v130, s[12:15], s37 offen lds
  buffer_load_dwordx4 v131, s[12:15], s37 offen offset:1024 lds
  v_and_b32 v4, 15, v0
  v_lshrrev_b32 v5, 4, v0
  v_lshrrev_b32 v6, 2, v4
  v_and_b32 v7, 3, v0
  v_lshrrev_b32 v3, 5, v0
  v_and_b32 v2, 1, v5
  v_lshl_or_b32 v3, v2, 1, v3
  s_waitcnt lgkmcnt(0)
  s_barrier
  s_add_u32 s30, s30, 1
  s_and_b32 s30, s30, 7
  s_cselect_b32 s32, 0, 1
  s_add_u32 s31, s31, s32
  s_sub_u32 s32, s30, s7
  s_and_b32 s32, s32, 7
  s_cmp_lt_u32 s32, 2
  s_cselect_b32 s32, 1, 0
  s_add_u32 s32, s32, s31
  s_cmp_ge_u32 s32, 2
  s_cselect_b32 s32, 0, s32
  s_lshl_b32 s33, s32, 3
  s_add_u32 s33, s33, s30
  s_lshl_b32 s37, s33, 17
  s_add_u32 s37, s37, s35
  s_add_u32 m0, s52, 0
  s_nop 0
  buffer_load_dwordx4 v130, s[12:15], s37 offen lds
  buffer_load_dwordx4 v131, s[12:15], s37 offen offset:1024 lds
  s_add_u32 s30, s30, 1
  s_and_b32 s30, s30, 7
  s_cselect_b32 s32, 0, 1
  s_add_u32 s31, s31, s32
  s_sub_u32 s32, s30, s7
  s_and_b32 s32, s32, 7
  s_cmp_lt_u32 s32, 2
  s_cselect_b32 s32, 1, 0
  s_add_u32 s32, s32, s31
  s_cmp_ge_u32 s32, 2
  s_cselect_b32 s32, 0, s32
  s_lshl_b32 s33, s32, 3
  s_add_u32 s33, s33, s30
  s_lshl_b32 s37, s33, 17
  s_add_u32 s37, s37, s35
  s_add_u32 m0, s52, 8192
  s_nop 0
  buffer_load_dwordx4 v130, s[12:15], s37 offen lds
  buffer_load_dwordx4 v131, s[12:15], s37 offen offset:1024 lds
  s_add_u32 s30, s30, 1
  s_and_b32 s30, s30, 7
  s_cselect_b32 s32, 0, 1
  s_add_u32 s31, s31, s32
  s_sub_u32 s32, s30, s7
  s_and_b32 s32, s32, 7
  s_cmp_lt_u32 s32, 2
  s_cselect_b32 s32, 1, 0
  s_add_u32 s32, s32, s31
  s_cmp_ge_u32 s32, 2
  s_cselect_b32 s32, 0, s32
  s_lshl_b32 s33, s32, 3
  s_add_u32 s33, s33, s30
  s_lshl_b32 s37, s33, 17
  s_add_u32 s37, s37, s35
  s_add_u32 m0, s52, 16384
  s_nop 0
  buffer_load_dwordx4 v130, s[12:15], s37 offen lds
  buffer_load_dwordx4 v131, s[12:15], s37 offen offset:1024 lds
  s_add_u32 s30, s30, 1
  s_and_b32 s30, s30, 7
  s_cselect_b32 s32, 0, 1
  s_add_u32 s31, s31, s32
  s_sub_u32 s32, s30, s7
  s_and_b32 s32, s32, 7
  s_cmp_lt_u32 s32, 2
  s_cselect_b32 s32, 1, 0
  s_add_u32 s32, s32, s31
  s_cmp_ge_u32 s32, 2
  s_cselect_b32 s32, 0, s32
  s_lshl_b32 s33, s32, 3
  s_add_u32 s33, s33, s30
  s_lshl_b32 s37, s33, 17
  s_add_u32 s37, s37, s35
  s_add_u32 m0, s52, 24576
  s_nop 0
  buffer_load_dwordx4 v130, s[12:15], s37 offen lds
  buffer_load_dwordx4 v131, s[12:15], s37 offen offset:1024 lds
  s_add_u32 s30, s30, 1
  s_and_b32 s30, s30, 7
  s_cselect_b32 s32, 0, 1
  s_add_u32 s31, s31, s32
  s_sub_u32 s32, s30, s7
  s_and_b32 s32, s32, 7
  s_cmp_lt_u32 s32, 2
  s_cselect_b32 s32, 1, 0
  s_add_u32 s32, s32, s31
  s_cmp_ge_u32 s32, 2
  s_cselect_b32 s32, 0, s32
  s_lshl_b32 s33, s32, 3
  s_add_u32 s33, s33, s30
  s_lshl_b32 s37, s33, 17
  s_add_u32 s37, s37, s35
  s_add_u32 m0, s52, 32768
  s_nop 0
  buffer_load_dwordx4 v130, s[12:15], s37 offen lds
  buffer_load_dwordx4 v131, s[12:15], s37 offen offset:1024 lds
  s_branch attn
L_k1done:
  s_nop 7
  s_nop 7
  s_add_u32 s24, s84, 29360128
  s_addc_u32 s25, s85, 0
  s_mov_b32 s26, 262144
  s_mov_b32 s27, 0x20000
  v_mov_b32 v136, 0
  v_mov_b32 v137, 1
  s_cmp_eq_u32 s57, 0
  s_cselect_b32 s26, s26, 0
  s_waitcnt vmcnt(0)
  s_barrier
  s_mov_b64 exec, 1
  buffer_store_dword v137, v136, s[24:27], s56 offen sc0 sc1
  s_mov_b64 exec, -1
  s_add_u32 s30, s30, 1
  s_and_b32 s30, s30, 7
  s_cselect_b32 s32, 0, 1
  s_add_u32 s31, s31, s32
  s_sub_u32 s32, s30, s7
  s_and_b32 s32, s32, 7
  s_cmp_lt_u32 s32, 2
  s_cselect_b32 s32, 1, 0
  s_add_u32 s32, s32, s31
  s_cmp_ge_u32 s32, 2
  s_cselect_b32 s32, 0, s32
  s_lshl_b32 s33, s32, 3
  s_add_u32 s33, s33, s30
  s_lshl_b32 s37, s33, 17
  s_add_u32 s37, s37, s35
  s_add_u32 m0, s52, 43008
  s_nop 0
  buffer_load_dwordx4 v130, s[12:15], s37 offen lds
  buffer_load_dwordx4 v131, s[12:15], s37 offen offset:1024 lds
  s_add_u32 s30, s30, 1
  s_and_b32 s30, s30, 7
  s_cselect_b32 s32, 0, 1
  s_add_u32 s31, s31, s32
  s_sub_u32 s32, s30, s7
  s_and_b32 s32, s32, 7
  s_cmp_lt_u32 s32, 2
  s_cselect_b32 s32, 1, 0
  s_add_u32 s32, s32, s31
  s_cmp_ge_u32 s32, 2
  s_cselect_b32 s32, 0, s32
  s_lshl_b32 s33, s32, 3
  s_add_u32 s33, s33, s30
  s_lshl_b32 s37, s33, 17
  s_add_u32 s37, s37, s35
  s_add_u32 m0, s52, 51200
  s_nop 0
  buffer_load_dwordx4 v130, s[12:15], s37 offen lds
  buffer_load_dwordx4 v131, s[12:15], s37 offen offset:1024 lds
  s_add_u32 s30, s30, 1
  s_and_b32 s30, s30, 7
  s_cselect_b32 s32, 0, 1
  s_add_u32 s31, s31, s32
  s_sub_u32 s32, s30, s7
  s_and_b32 s32, s32, 7
  s_cmp_lt_u32 s32, 2
  s_cselect_b32 s32, 1, 0
  s_add_u32 s32, s32, s31
  s_cmp_ge_u32 s32, 2
  s_cselect_b32 s32, 0, s32
  s_lshl_b32 s33, s32, 3
  s_add_u32 s33, s33, s30
  s_lshl_b32 s37, s33, 17
  s_add_u32 s37, s37, s35
  s_add_u32 m0, s52, 59392
  s_nop 0
  buffer_load_dwordx4 v130, s[12:15], s37 offen lds
  buffer_load_dwordx4 v131, s[12:15], s37 offen offset:1024 lds
  s_add_u32 s30, s30, 1
  s_and_b32 s30, s30, 7
  s_cselect_b32 s32, 0, 1
  s_add_u32 s31, s31, s32
  s_sub_u32 s32, s30, s7
  s_and_b32 s32, s32, 7
  s_cmp_lt_u32 s32, 2
  s_cselect_b32 s32, 1, 0
  s_add_u32 s32, s32, s31
  s_cmp_ge_u32 s32, 2
  s_cselect_b32 s32, 0, s32
  s_lshl_b32 s33, s32, 3
  s_add_u32 s33, s33, s30
  s_lshl_b32 s37, s33, 17
  s_add_u32 s37, s37, s35
  s_add_u32 m0, s52, 67584
  s_nop 0
  buffer_load_dwordx4 v130, s[12:15], s37 offen lds
  buffer_load_dwordx4 v131, s[12:15], s37 offen offset:1024 lds
  s_lshl_b32 s56, s3, 10
  s_mul_i32 s32, s29, 16
  s_add_u32 s56, s56, s32
  s_add_u32 s56, s56, s28
  s_add_u32 s56, s56, 256
  s_lshl_b32 s56, s56, 7
  s_barrier
  s_waitcnt vmcnt(0)
  s_barrier
  s_cmp_ge_u32 s2, 224
  s_cbranch_scc1 L_k3skip
  s_lshr_b32 s32, s2, 3
  s_mul_i32 s5, s32, 9363
  s_lshr_b32 s5, s5, 16
  s_mul_i32 s6, s5, 7
  s_sub_u32 s6, s32, s6
  s_lshl_b32 s7, s5, 1
  s_add_u32 s7, s7, s6
  s_and_b32 s7, s7, 7
  s_and_b32 s32, s2, 7
  s_lshr_b32 s28, s32, 2
  s_lshl_b32 s28, s28, 2
  s_add_u32 s28, s28, s5
  s_and_b32 s29, s32, 3
  s_mul_i32 s29, s29, 7
  s_add_u32 s29, s29, s6
  s_mov_b32 s30, 7
  s_mov_b32 s31, -1
  s_lshl_b32 s44, s57, 12
  s_add_u32 s45, s44, 16384
  v_lshlrev_b32 v8, 4, v0
  v_add_u32 v13, 63488, v8
  v_lshrrev_b32 v2, 4, v0
  v_lshlrev_b32 v3, 1, v2
  v_and_b32 v4, 15, v0
  v_xor_b32 v3, v3, v4
  v_lshlrev_b32 v3, 4, v3
  s_lshl_b32 s32, s57, 4
  v_add_u32 v2, s32, v2
  s_mov_b32 s32, 7168
  v_mul_lo_u32 v2, v2, s32
  v_add_u32 v9, v2, v3
  v_xor_b32 v3, 128, v3
  v_add_u32 v11, v2, v3
  v_add_u32 v10, 27648, v9
  v_add_u32 v12, 82944, v11
  v_add_u32 v11, 55296, v11
  s_lshl_b32 s34, s28, 2
  s_add_u32 s34, s34, s57
  s_lshl_b32 s34, s34, 17
  s_lshl_b32 s35, s29, 8
  s_add_u32 s8, s82, 8388608
  s_addc_u32 s9, s83, 0
  s_mov_b32 s10, 4194304
  s_mov_b32 s11, 0x20000
  s_mov_b32 s12, s72
  s_mov_b32 s13, s73
  s_mov_b32 s14, 14680064
  s_mov_b32 s15, 0x20000
  s_add_u32 s16, s84, 29360128
  s_addc_u32 s17, s85, 0
  s_mov_b32 s18, 262144
  s_mov_b32 s19, 0x20000
  s_lshl_b32 s32, s28, 5
  v_min_u32 v14, 31, v0
  v_add_u32 v14, s32, v14
  v_max_i32 v14, 0, v14
  v_lshlrev_b32 v14, 7, v14
  s_lshl_b32 s55, s3, 17
  s_add_u32 s55, s55, 32768
  s_lshr_b32 s32, s2, 3
  s_add_u32 s32, s32, 0
  s_lshl_b32 s32, s32, 2
  s_add_u32 s32, s32, s57
  s_lshl_b32 s32, s32, 6
  v_add_u32 v2, s32, v0
  v_mul_u32_u24 v3, 74899, v2
  v_lshrrev_b32 v3, 20, v3
  v_mul_u32_u24 v4, 14, v3
  v_sub_u32 v4, v2, v4
  v_add_u32 v3, 192, v3
  v_mul_u32_u24 v3, 7168, v3
  v_lshl_add_u32 v3, v4, 7, v3
  s_and_b32 s32, s2, 3
  s_mul_i32 s32, s32, 1792
  s_lshl_b32 s40, s3, 30
  s_add_u32 s32, s32, s40
  v_add_u32 v16, s32, v3
  s_barrier
  s_barrier
  s_mov_b64 exec, 1
  buffer_store_dword v137, v136, s[24:27], s56 offen sc0 sc1
  s_mov_b64 exec, -1
  s_mov_b32 s30, 7
  s_mov_b32 s31, -1
  s_mov_b32 s38, 0
  s_add_u32 s30, s30, 1
  s_and_b32 s30, s30, 7
  s_cselect_b32 s32, 0, 1
  s_add_u32 s31, s31, s32
  s_sub_u32 s32, s30, s7
  s_and_b32 s32, s32, 7
  s_cmp_lt_u32 s32, 2
  s_cselect_b32 s32, 1, 0
  s_add_u32 s32, s32, s31
  s_cmp_ge_u32 s32, 4
  s_cselect_b32 s32, 0, s32
  s_lshl_b32 s33, s32, 3
  s_add_u32 s33, s33, s30
  s_mul_i32 s37, s33, 458752
  s_add_u32 s37, s37, s35
  s_add_u32 m0, s38, s45
  s_nop 0
  buffer_load_dwordx4 v9, s[12:15], s37 offen offset:0  lds
  buffer_load_dwordx4 v10, s[12:15], s37 offen offset:1024  lds
  buffer_load_dwordx4 v11, s[12:15], s37 offen offset:2048  lds
  buffer_load_dwordx4 v12, s[12:15], s37 offen offset:3072  lds
  s_add_u32 s38, s38, 32768
  s_cmp_eq_u32 s38, 163840
  s_cselect_b32 s38, 0, s38
  s_add_u32 s30, s30, 1
  s_and_b32 s30, s30, 7
  s_cselect_b32 s32, 0, 1
  s_add_u32 s31, s31, s32
  s_sub_u32 s32, s30, s7
  s_and_b32 s32, s32, 7
  s_cmp_lt_u32 s32, 2
  s_cselect_b32 s32, 1, 0
  s_add_u32 s32, s32, s31
  s_cmp_ge_u32 s32, 4
  s_cselect_b32 s32, 0, s32
  s_lshl_b32 s33, s32, 3
  s_add_u32 s33, s33, s30
  s_mul_i32 s37, s33, 458752
  s_add_u32 s37, s37, s35
  s_add_u32 m0, s38, s45
  s_nop 0
  buffer_load_dwordx4 v9, s[12:15], s37 offen offset:0  lds
  buffer_load_dwordx4 v10, s[12:15], s37 offen offset:1024  lds
  buffer_load_dwordx4 v11, s[12:15], s37 offen offset:2048  lds
  buffer_load_dwordx4 v12, s[12:15], s37 offen offset:3072  lds
  s_add_u32 s38, s38, 32768
  s_cmp_eq_u32 s38, 163840
  s_cselect_b32 s38, 0, s38
  s_add_u32 s30, s30, 1
  s_and_b32 s30, s30, 7
  s_cselect_b32 s32, 0, 1
  s_add_u32 s31, s31, s32
  s_sub_u32 s32, s30, s7
  s_and_b32 s32, s32, 7
  s_cmp_lt_u32 s32, 2
  s_cselect_b32 s32, 1, 0
  s_add_u32 s32, s32, s31
  s_cmp_ge_u32 s32, 4
  s_cselect_b32 s32, 0, s32
  s_lshl_b32 s33, s32, 3
  s_add_u32 s33, s33, s30
  s_mul_i32 s37, s33, 458752
  s_add_u32 s37, s37, s35
  s_add_u32 m0, s38, s45
  s_nop 0
  buffer_load_dwordx4 v9, s[12:15], s37 offen offset:0  lds
  buffer_load_dwordx4 v10, s[12:15], s37 offen offset:1024  lds
  buffer_load_dwordx4 v11, s[12:15], s37 offen offset:2048  lds
  buffer_load_dwordx4 v12, s[12:15], s37 offen offset:3072  lds
  s_add_u32 s38, s38, 32768
  s_cmp_eq_u32 s38, 163840
  s_cselect_b32 s38, 0, s38
  buffer_load_dword v223, v16, s[12:15], 0 offen
  s_lshl_b32 s56, s3, 10
  s_mul_i32 s32, s28, 32
  s_add_u32 s56, s56, s32
  s_add_u32 s56, s56, s29
  s_add_u32 s56, s56, 512
  s_lshl_b32 s56, s56, 7
  s_mov_b32 s39, 0
  s_and_b32 s32, s4, 3
  s_cmp_lg_u32 s32, 0
  s_cbranch_scc1 poll18d
  s_sleep 8
poll18:
  buffer_load_dword v15, v14, s[16:19], s55 offen sc0 sc1
  s_waitcnt vmcnt(0)
  v_cmp_eq_u32 vcc, 0, v15
  s_add_u32 s39, s39, 1
  s_cmp_gt_u32 s39, 100000
  s_cbranch_scc1 poll18d
  s_cbranch_vccnz poll18
poll18d:
  s_barrier
  s_mov_b32 s30, 7
  s_mov_b32 s31, -1
  s_mov_b32 s38, 0
  s_add_u32 s30, s30, 1
  s_and_b32 s30, s30, 7
  s_cselect_b32 s32, 0, 1
  s_add_u32 s31, s31, s32
  s_sub_u32 s32, s30, s7
  s_and_b32 s32, s32, 7
  s_cmp_lt_u32 s32, 2
  s_cselect_b32 s32, 1, 0
  s_add_u32 s32, s32, s31
  s_cmp_ge_u32 s32, 4
  s_cselect_b32 s32, 0, s32
  s_lshl_b32 s33, s32, 3
  s_add_u32 s33, s33, s30
  s_mul_i32 s36, s33, 2048
  s_add_u32 s36, s36, s34
  s_add_u32 m0, s38, s44
  s_nop 0
  buffer_load_dwordx4 v8, s[8:11], s36 offen offset:0 sc1 lds
  buffer_load_dwordx4 v8, s[8:11], s36 offen offset:1024 sc1 lds
  buffer_load_dwordx4 v13, s[8:11], s36 offen offset:2048 sc1 lds
  buffer_load_dwordx4 v13, s[8:11], s36 offen offset:3072 sc1 lds
  s_add_u32 s38, s38, 32768
  s_cmp_eq_u32 s38, 163840
  s_cselect_b32 s38, 0, s38
  s_add_u32 s30, s30, 1
  s_and_b32 s30, s30, 7
  s_cselect_b32 s32, 0, 1
  s_add_u32 s31, s31, s32
  s_sub_u32 s32, s30, s7
  s_and_b32 s32, s32, 7
  s_cmp_lt_u32 s32, 2
  s_cselect_b32 s32, 1, 0
  s_add_u32 s32, s32, s31
  s_cmp_ge_u32 s32, 4
  s_cselect_b32 s32, 0, s32
  s_lshl_b32 s33, s32, 3
  s_add_u32 s33, s33, s30
  s_mul_i32 s36, s33, 2048
  s_add_u32 s36, s36, s34
  s_add_u32 m0, s38, s44
  s_nop 0
  buffer_load_dwordx4 v8, s[8:11], s36 offen offset:0 sc1 lds
  buffer_load_dwordx4 v8, s[8:11], s36 offen offset:1024 sc1 lds
  buffer_load_dwordx4 v13, s[8:11], s36 offen offset:2048 sc1 lds
  buffer_load_dwordx4 v13, s[8:11], s36 offen offset:3072 sc1 lds
  s_add_u32 s38, s38, 32768
  s_cmp_eq_u32 s38, 163840
  s_cselect_b32 s38, 0, s38
  s_add_u32 s30, s30, 1
  s_and_b32 s30, s30, 7
  s_cselect_b32 s32, 0, 1
  s_add_u32 s31, s31, s32
  s_sub_u32 s32, s30, s7
  s_and_b32 s32, s32, 7
  s_cmp_lt_u32 s32, 2
  s_cselect_b32 s32, 1, 0
  s_add_u32 s32, s32, s31
  s_cmp_ge_u32 s32, 4
  s_cselect_b32 s32, 0, s32
  s_lshl_b32 s33, s32, 3
  s_add_u32 s33, s33, s30
  s_mul_i32 s36, s33, 2048
  s_add_u32 s36, s36, s34
  s_add_u32 m0, s38, s44
  s_nop 0
  buffer_load_dwordx4 v8, s[8:11], s36 offen offset:0 sc1 lds
  buffer_load_dwordx4 v8, s[8:11], s36 offen offset:1024 sc1 lds
  buffer_load_dwordx4 v13, s[8:11], s36 offen offset:2048 sc1 lds
  buffer_load_dwordx4 v13, s[8:11], s36 offen offset:3072 sc1 lds
  s_add_u32 s38, s38, 32768
  s_cmp_eq_u32 s38, 163840
  s_cselect_b32 s38, 0, s38
  s_waitcnt vmcnt(8)
  s_barrier
  s_add_u32 s30, s30, 1
  s_and_b32 s30, s30, 7
  s_cselect_b32 s32, 0, 1
  s_add_u32 s31, s31, s32
  s_sub_u32 s32, s30, s7
  s_and_b32 s32, s32, 7
  s_cmp_lt_u32 s32, 2
  s_cselect_b32 s32, 1, 0
  s_add_u32 s32, s32, s31
  s_cmp_ge_u32 s32, 4
  s_cselect_b32 s32, 0, s32
  s_lshl_b32 s33, s32, 3
  s_add_u32 s33, s33, s30
  s_mul_i32 s36, s33, 2048
  s_add_u32 s36, s36, s34
  s_mul_i32 s37, s33, 458752
  s_add_u32 s37, s37, s35
  s_add_u32 m0, s38, s44
  s_nop 0
  buffer_load_dwordx4 v8, s[8:11], s36 offen offset:0 sc1 lds
  buffer_load_dwordx4 v8, s[8:11], s36 offen offset:1024 sc1 lds
  buffer_load_dwordx4 v13, s[8:11], s36 offen offset:2048 sc1 lds
  buffer_load_dwordx4 v13, s[8:11], s36 offen offset:3072 sc1 lds
  s_add_u32 m0, s38, s45
  s_nop 0
  buffer_load_dwordx4 v9, s[12:15], s37 offen offset:0  lds
  buffer_load_dwordx4 v10, s[12:15], s37 offen offset:1024  lds
  buffer_load_dwordx4 v11, s[12:15], s37 offen offset:2048  lds
  buffer_load_dwordx4 v12, s[12:15], s37 offen offset:3072  lds
  s_add_u32 s38, s38, 32768
  s_cmp_eq_u32 s38, 163840
  s_cselect_b32 s38, 0, s38
  s_waitcnt vmcnt(12)
  s_barrier
  s_add_u32 s30, s30, 1
  s_and_b32 s30, s30, 7
  s_cselect_b32 s32, 0, 1
  s_add_u32 s31, s31, s32
  s_sub_u32 s32, s30, s7
  s_and_b32 s32, s32, 7
  s_cmp_lt_u32 s32, 2
  s_cselect_b32 s32, 1, 0
  s_add_u32 s32, s32, s31
  s_cmp_ge_u32 s32, 4
  s_cselect_b32 s32, 0, s32
  s_lshl_b32 s33, s32, 3
  s_add_u32 s33, s33, s30
  s_mul_i32 s36, s33, 2048
  s_add_u32 s36, s36, s34
  s_mul_i32 s37, s33, 458752
  s_add_u32 s37, s37, s35
  s_add_u32 m0, s38, s44
  s_nop 0
  buffer_load_dwordx4 v8, s[8:11], s36 offen offset:0 sc1 lds
  buffer_load_dwordx4 v8, s[8:11], s36 offen offset:1024 sc1 lds
  buffer_load_dwordx4 v13, s[8:11], s36 offen offset:2048 sc1 lds
  buffer_load_dwordx4 v13, s[8:11], s36 offen offset:3072 sc1 lds
  s_add_u32 m0, s38, s45
  s_nop 0
  buffer_load_dwordx4 v9, s[12:15], s37 offen offset:0  lds
  buffer_load_dwordx4 v10, s[12:15], s37 offen offset:1024  lds
  buffer_load_dwordx4 v11, s[12:15], s37 offen offset:2048  lds
  buffer_load_dwordx4 v12, s[12:15], s37 offen offset:3072  lds
  s_add_u32 s38, s38, 32768
  s_cmp_eq_u32 s38, 163840
  s_cselect_b32 s38, 0, s38
  s_mov_b32 s39, 27
ll19:
  s_waitcnt vmcnt(16)
  s_barrier
  s_add_u32 s30, s30, 1
  s_and_b32 s30, s30, 7
  s_cselect_b32 s32, 0, 1
  s_add_u32 s31, s31, s32
  s_sub_u32 s32, s30, s7
  s_and_b32 s32, s32, 7
  s_cmp_lt_u32 s32, 2
  s_cselect_b32 s32, 1, 0
  s_add_u32 s32, s32, s31
  s_cmp_ge_u32 s32, 4
  s_cselect_b32 s32, 0, s32
  s_lshl_b32 s33, s32, 3
  s_add_u32 s33, s33, s30
  s_mul_i32 s36, s33, 2048
  s_add_u32 s36, s36, s34
  s_mul_i32 s37, s33, 458752
  s_add_u32 s37, s37, s35
  s_add_u32 m0, s38, s44
  s_nop 0
  buffer_load_dwordx4 v8, s[8:11], s36 offen offset:0 sc1 lds
  buffer_load_dwordx4 v8, s[8:11], s36 offen offset:1024 sc1 lds
  buffer_load_dwordx4 v13, s[8:11], s36 offen offset:2048 sc1 lds
  buffer_load_dwordx4 v13, s[8:11], s36 offen offset:3072 sc1 lds
  s_add_u32 m0, s38, s45
  s_nop 0
  buffer_load_dwordx4 v9, s[12:15], s37 offen offset:0  lds
  buffer_load_dwordx4 v10, s[12:15], s37 offen offset:1024  lds
  buffer_load_dwordx4 v11, s[12:15], s37 offen offset:2048  lds
  buffer_load_dwordx4 v12, s[12:15], s37 offen offset:3072  lds
  s_add_u32 s38, s38, 32768
  s_cmp_eq_u32 s38, 163840
  s_cselect_b32 s38, 0, s38
  s_sub_u32 s39, s39, 1
  s_cmp_lg_u32 s39, 0
  s_cbranch_scc1 ll19
  s_waitcnt vmcnt(16)
  s_barrier
  s_waitcnt vmcnt(8)
  s_barrier
  s_waitcnt vmcnt(0)
  s_barrier
  s_lshr_b32 s32, s2, 3
  s_lshr_b32 s5, s32, 3
  s_and_b32 s6, s32, 7
  s_lshl_b32 s7, s5, 1
  s_add_u32 s7, s7, s6
  s_and_b32 s7, s7, 7
  s_and_b32 s32, s2, 7
  s_lshr_b32 s28, s32, 2
  s_lshl_b32 s28, s28, 2
  s_add_u32 s28, s28, s5
  s_and_b32 s29, s32, 3
  s_mul_i32 s29, s29, 8
  s_add_u32 s29, s29, s6
  s_mov_b32 s30, 7
  s_mov_b32 s31, -1
  s_mov_b32 s41, s57
  s_lshl_b32 s45, s41, 11
  s_mul_i32 s32, s41, 16
  s_add_u32 s32, s32, 0
  v_lshrrev_b32 v2, 3, v0
  v_add_u32 v2, s32, v2
  v_bfe_u32 v3, v2, 1, 1
  v_bfe_u32 v4, v2, 3, 1
  v_lshl_or_b32 v3, v4, 1, v3
  v_lshlrev_b32 v3, 1, v3
  v_and_b32 v4, 7, v0
  v_xor_b32 v3, v3, v4
  v_lshlrev_b32 v3, 4, v3
  s_mov_b32 s32, 4096
  v_mul_lo_u32 v2, v2, s32
  v_add_u32 v9, v2, v3
  s_mul_i32 s32, s41, 16
  s_add_u32 s32, s32, 8
  v_lshrrev_b32 v2, 3, v0
  v_add_u32 v2, s32, v2
  v_bfe_u32 v3, v2, 1, 1
  v_bfe_u32 v4, v2, 3, 1
  v_lshl_or_b32 v3, v4, 1, v3
  v_lshlrev_b32 v3, 1, v3
  v_and_b32 v4, 7, v0
  v_xor_b32 v3, v3, v4
  v_lshlrev_b32 v3, 4, v3
  s_mov_b32 s32, 4096
  v_mul_lo_u32 v2, v2, s32
  v_add_u32 v10, v2, v3
  v_subrev_u32 v10, 1024, v10
  s_lshl_b32 s35, s29, 7
  s_mov_b32 s12, s76
  s_mov_b32 s13, s77
  s_mov_b32 s14, 14680064
  s_mov_b32 s15, 0x20000
  s_branch L_k4
L_k3skip:
  s_nop 7
  s_nop 7
  s_lshr_b32 s32, s2, 3
  s_lshr_b32 s5, s32, 3
  s_and_b32 s6, s32, 7
  s_lshl_b32 s7, s5, 1
  s_add_u32 s7, s7, s6
  s_and_b32 s7, s7, 7
  s_and_b32 s32, s2, 7
  s_lshr_b32 s28, s32, 2
  s_lshl_b32 s28, s28, 2
  s_add_u32 s28, s28, s5
  s_and_b32 s29, s32, 3
  s_mul_i32 s29, s29, 8
  s_add_u32 s29, s29, s6
  s_mov_b32 s30, 7
  s_mov_b32 s31, -1
  s_mov_b32 s41, s57
  s_lshl_b32 s45, s41, 11
  s_mul_i32 s32, s41, 16
  s_add_u32 s32, s32, 0
  v_lshrrev_b32 v2, 3, v0
  v_add_u32 v2, s32, v2
  v_bfe_u32 v3, v2, 1, 1
  v_bfe_u32 v4, v2, 3, 1
  v_lshl_or_b32 v3, v4, 1, v3
  v_lshlrev_b32 v3, 1, v3
  v_and_b32 v4, 7, v0
  v_xor_b32 v3, v3, v4
  v_lshlrev_b32 v3, 4, v3
  s_mov_b32 s32, 4096
  v_mul_lo_u32 v2, v2, s32
  v_add_u32 v9, v2, v3
  s_mul_i32 s32, s41, 16
  s_add_u32 s32, s32, 8
  v_lshrrev_b32 v2, 3, v0
  v_add_u32 v2, s32, v2
  v_bfe_u32 v3, v2, 1, 1
  v_bfe_u32 v4, v2, 3, 1
  v_lshl_or_b32 v3, v4, 1, v3
  v_lshlrev_b32 v3, 1, v3
  v_and_b32 v4, 7, v0
  v_xor_b32 v3, v3, v4
  v_lshlrev_b32 v3, 4, v3
  s_mov_b32 s32, 4096
  v_mul_lo_u32 v2, v2, s32
  v_add_u32 v10, v2, v3
  v_subrev_u32 v10, 1024, v10
  s_lshl_b32 s35, s29, 7
  s_mov_b32 s12, s76
  s_mov_b32 s13, s77
  s_mov_b32 s14, 14680064
  s_mov_b32 s15, 0x20000
  s_barrier
L_k4:
  s_nop 7
  s_nop 7
  s_mov_b32 s30, 7
  s_mov_b32 s31, -1
  s_mov_b32 s38, 98304
  s_add_u32 s30, s30, 1
  s_and_b32 s30, s30, 7
  s_cselect_b32 s32, 0, 1
  s_add_u32 s31, s31, s32
  s_sub_u32 s32, s30, s7
  s_and_b32 s32, s32, 7
  s_cmp_lt_u32 s32, 2
  s_cselect_b32 s32, 1, 0
  s_add_u32 s32, s32, s31
  s_cmp_ge_u32 s32, 7
  s_cselect_b32 s32, 0, s32
  s_lshl_b32 s33, s32, 3
  s_add_u32 s33, s33, s30
  s_mul_i32 s37, s33, 262144
  s_add_u32 s37, s37, s35
  s_add_u32 m0, s38, s45
  s_nop 0
  buffer_load_dwordx4 v9, s[12:15], s37 offen offset:0  lds
  buffer_load_dwordx4 v10, s[12:15], s37 offen offset:1024  lds
  s_add_u32 s38, s38, 8192
  s_cmp_eq_u32 s38, 163840
  s_cselect_b32 s38, 98304, s38
  s_add_u32 s30, s30, 1
  s_and_b32 s30, s30, 7
  s_cselect_b32 s32, 0, 1
  s_add_u32 s31, s31, s32
  s_sub_u32 s32, s30, s7
  s_and_b32 s32, s32, 7
  s_cmp_lt_u32 s32, 2
  s_cselect_b32 s32, 1, 0
  s_add_u32 s32, s32, s31
  s_cmp_ge_u32 s32, 7
  s_cselect_b32 s32, 0, s32
  s_lshl_b32 s33, s32, 3
  s_add_u32 s33, s33, s30
  s_mul_i32 s37, s33, 262144
  s_add_u32 s37, s37, s35
  s_add_u32 m0, s38, s45
  s_nop 0
  buffer_load_dwordx4 v9, s[12:15], s37 offen offset:0  lds
  buffer_load_dwordx4 v10, s[12:15], s37 offen offset:1024  lds
  s_add_u32 s38, s38, 8192
  s_cmp_eq_u32 s38, 163840
  s_cselect_b32 s38, 98304, s38
  s_add_u32 s30, s30, 1
  s_and_b32 s30, s30, 7
  s_cselect_b32 s32, 0, 1
  s_add_u32 s31, s31, s32
  s_sub_u32 s32, s30, s7
  s_and_b32 s32, s32, 7
  s_cmp_lt_u32 s32, 2
  s_cselect_b32 s32, 1, 0
  s_add_u32 s32, s32, s31
  s_cmp_ge_u32 s32, 7
  s_cselect_b32 s32, 0, s32
  s_lshl_b32 s33, s32, 3
  s_add_u32 s33, s33, s30
  s_mul_i32 s37, s33, 262144
  s_add_u32 s37, s37, s35
  s_add_u32 m0, s38, s45
  s_nop 0
  buffer_load_dwordx4 v9, s[12:15], s37 offen offset:0  lds
  buffer_load_dwordx4 v10, s[12:15], s37 offen offset:1024  lds
  s_add_u32 s38, s38, 8192
  s_cmp_eq_u32 s38, 163840
  s_cselect_b32 s38, 98304, s38
  s_add_u32 s30, s30, 1
  s_and_b32 s30, s30, 7
  s_cselect_b32 s32, 0, 1
  s_add_u32 s31, s31, s32
  s_sub_u32 s32, s30, s7
  s_and_b32 s32, s32, 7
  s_cmp_lt_u32 s32, 2
  s_cselect_b32 s32, 1, 0
  s_add_u32 s32, s32, s31
  s_cmp_ge_u32 s32, 7
  s_cselect_b32 s32, 0, s32
  s_lshl_b32 s33, s32, 3
  s_add_u32 s33, s33, s30
  s_mul_i32 s37, s33, 262144
  s_add_u32 s37, s37, s35
  s_add_u32 m0, s38, s45
  s_nop 0
  buffer_load_dwordx4 v9, s[12:15], s37 offen offset:0  lds
  buffer_load_dwordx4 v10, s[12:15], s37 offen offset:1024  lds
  s_add_u32 s38, s38, 8192
  s_cmp_eq_u32 s38, 163840
  s_cselect_b32 s38, 98304, s38
  s_add_u32 s30, s30, 1
  s_and_b32 s30, s30, 7
  s_cselect_b32 s32, 0, 1
  s_add_u32 s31, s31, s32
  s_sub_u32 s32, s30, s7
  s_and_b32 s32, s32, 7
  s_cmp_lt_u32 s32, 2
  s_cselect_b32 s32, 1, 0
  s_add_u32 s32, s32, s31
  s_cmp_ge_u32 s32, 7
  s_cselect_b32 s32, 0, s32
  s_lshl_b32 s33, s32, 3
  s_add_u32 s33, s33, s30
  s_mul_i32 s37, s33, 262144
  s_add_u32 s37, s37, s35
  s_add_u32 m0, s38, s45
  s_nop 0
  buffer_load_dwordx4 v9, s[12:15], s37 offen offset:0  lds
  buffer_load_dwordx4 v10, s[12:15], s37 offen offset:1024  lds
  s_add_u32 s38, s38, 8192
  s_cmp_eq_u32 s38, 163840
  s_cselect_b32 s38, 98304, s38
  s_add_u32 s30, s30, 1
  s_and_b32 s30, s30, 7
  s_cselect_b32 s32, 0, 1
  s_add_u32 s31, s31, s32
  s_sub_u32 s32, s30, s7
  s_and_b32 s32, s32, 7
  s_cmp_lt_u32 s32, 2
  s_cselect_b32 s32, 1, 0
  s_add_u32 s32, s32, s31
  s_cmp_ge_u32 s32, 7
  s_cselect_b32 s32, 0, s32
  s_lshl_b32 s33, s32, 3
  s_add_u32 s33, s33, s30
  s_mul_i32 s37, s33, 262144
  s_add_u32 s37, s37, s35
  s_add_u32 m0, s38, s45
  s_nop 0
  buffer_load_dwordx4 v9, s[12:15], s37 offen offset:0  lds
  buffer_load_dwordx4 v10, s[12:15], s37 offen offset:1024  lds
  s_add_u32 s38, s38, 8192
  s_cmp_eq_u32 s38, 163840
  s_cselect_b32 s38, 98304, s38
  s_barrier
  s_mov_b64 exec, 1
  buffer_store_dword v137, v136, s[24:27], s56 offen sc0 sc1
  s_mov_b64 exec, -1
  s_lshl_b32 s56, s3, 10
  s_mul_i32 s32, s29, 8
  s_add_u32 s56, s56, s32
  s_add_u32 s56, s56, s28
  s_add_u32 s56, s56, 768
  s_lshl_b32 s56, s56, 7
  s_barrier
  s_mov_b32 s39, 50
ll20:
  s_waitcnt vmcnt(10)
  s_barrier
  s_add_u32 s30, s30, 1
  s_and_b32 s30, s30, 7
  s_cselect_b32 s32, 0, 1
  s_add_u32 s31, s31, s32
  s_sub_u32 s32, s30, s7
  s_and_b32 s32, s32, 7
  s_cmp_lt_u32 s32, 2
  s_cselect_b32 s32, 1, 0
  s_add_u32 s32, s32, s31
  s_cmp_ge_u32 s32, 7
  s_cselect_b32 s32, 0, s32
  s_lshl_b32 s33, s32, 3
  s_add_u32 s33, s33, s30
  s_mul_i32 s37, s33, 262144
  s_add_u32 s37, s37, s35
  s_add_u32 m0, s38, s45
  s_nop 0
  buffer_load_dwordx4 v9, s[12:15], s37 offen offset:0  lds
  buffer_load_dwordx4 v10, s[12:15], s37 offen offset:1024  lds
  s_add_u32 s38, s38, 8192
  s_cmp_eq_u32 s38, 163840
  s_cselect_b32 s38, 98304, s38
  s_sub_u32 s39, s39, 1
  s_cmp_lg_u32 s39, 0
  s_cbranch_scc1 ll20
  s_waitcnt vmcnt(10)
  s_barrier
  s_waitcnt vmcnt(8)
  s_barrier
  s_waitcnt vmcnt(6)
  s_barrier
  s_waitcnt vmcnt(4)
  s_barrier
  s_waitcnt vmcnt(2)
  s_barrier
  s_waitcnt vmcnt(0)
  s_barrier
  s_cmp_lg_u32 s3, 0
  s_cbranch_scc1 L_end
  s_lshr_b32 s32, s2, 3
  s_lshr_b32 s5, s32, 3
  s_and_b32 s6, s32, 7
  s_lshl_b32 s7, s5, 1
  s_add_u32 s7, s7, s6
  s_and_b32 s7, s7, 7
  s_and_b32 s32, s2, 7
  s_lshr_b32 s28, s32, 1
  s_lshl_b32 s28, s28, 2
  s_add_u32 s28, s28, s5
  s_and_b32 s29, s32, 1
  s_mul_i32 s29, s29, 8
  s_add_u32 s29, s29, s6
  s_mov_b32 s30, 7
  s_mov_b32 s31, -1
  s_mov_b32 s41, s57
  s_mul_i32 s32, s41, 16
  s_add_u32 s32, s32, 0
  v_lshrrev_b32 v2, 3, v0
  v_add_u32 v2, s32, v2
  v_bfe_u32 v3, v2, 1, 1
  v_bfe_u32 v4, v2, 3, 1
  v_lshl_or_b32 v3, v4, 1, v3
  v_lshlrev_b32 v3, 1, v3
  v_and_b32 v4, 7, v0
  v_xor_b32 v3, v3, v4
  v_lshlrev_b32 v3, 4, v3
  s_mov_b32 s32, 6144
  v_mul_lo_u32 v2, v2, s32
  v_add_u32 v13, v2, v3
  s_mul_i32 s32, s41, 16
  s_add_u32 s32, s32, 8
  v_lshrrev_b32 v2, 3, v0
  v_add_u32 v2, s32, v2
  v_bfe_u32 v3, v2, 1, 1
  v_bfe_u32 v4, v2, 3, 1
  v_lshl_or_b32 v3, v4, 1, v3
  v_lshlrev_b32 v3, 1, v3
  v_and_b32 v4, 7, v0
  v_xor_b32 v3, v3, v4
  v_lshlrev_b32 v3, 4, v3
  s_mov_b32 s32, 6144
  v_mul_lo_u32 v2, v2, s32
  v_add_u32 v14, v2, v3
  v_subrev_u32 v14, 1024, v14
  v_add_u32 v15, 2048, v13
  v_add_u32 v16, 2048, v14
  v_add_u32 v17, 4096, v13
  v_add_u32 v18, 4096, v14
  s_lshl_b32 s46, s41, 11
  s_add_u32 s46, s46, 18432
  s_add_u32 s47, s46, 8192
  s_add_u32 s48, s46, 16384
  s_lshl_b32 s35, s29, 7
  s_mov_b32 s12, s66
  s_mov_b32 s13, s67
  s_mov_b32 s14, 6291456
  s_mov_b32 s15, 0x20000
  s_mov_b32 s30, 7
  s_mov_b32 s31, -1
  s_mov_b32 s38, 0
  s_add_u32 s30, s30, 1
  s_and_b32 s30, s30, 7
  s_cselect_b32 s32, 0, 1
  s_add_u32 s31, s31, s32
  s_sub_u32 s32, s30, s7
  s_and_b32 s32, s32, 7
  s_cmp_lt_u32 s32, 2
  s_cselect_b32 s32, 1, 0
  s_add_u32 s32, s32, s31
  s_cmp_ge_u32 s32, 2
  s_cselect_b32 s32, 0, s32
  s_lshl_b32 s33, s32, 3
  s_add_u32 s33, s33, s30
  s_mul_i32 s37, s33, 393216
  s_add_u32 s37, s37, s35
  s_add_u32 m0, s38, s46
  s_nop 0
  buffer_load_dwordx4 v13, s[12:15], s37 offen offset:0  lds
  buffer_load_dwordx4 v14, s[12:15], s37 offen offset:1024  lds
  s_add_u32 m0, s38, s47
  s_nop 0
  buffer_load_dwordx4 v15, s[12:15], s37 offen offset:0  lds
  buffer_load_dwordx4 v16, s[12:15], s37 offen offset:1024  lds
  s_add_u32 m0, s38, s48
  s_nop 0
  buffer_load_dwordx4 v17, s[12:15], s37 offen offset:0  lds
  buffer_load_dwordx4 v18, s[12:15], s37 offen offset:1024  lds
  s_add_u32 s38, s38, 43008
  s_cmp_eq_u32 s38, 129024
  s_cselect_b32 s38, 0, s38
  s_add_u32 s30, s30, 1
  s_and_b32 s30, s30, 7
  s_cselect_b32 s32, 0, 1
  s_add_u32 s31, s31, s32
  s_sub_u32 s32, s30, s7
  s_and_b32 s32, s32, 7
  s_cmp_lt_u32 s32, 2
  s_cselect_b32 s32, 1, 0
  s_add_u32 s32, s32, s31
  s_cmp_ge_u32 s32, 2
  s_cselect_b32 s32, 0, s32
  s_lshl_b32 s33, s32, 3
  s_add_u32 s33, s33, s30
  s_mul_i32 s37, s33, 393216
  s_add_u32 s37, s37, s35
  s_add_u32 m0, s38, s46
  s_nop 0
  buffer_load_dwordx4 v13, s[12:15], s37 offen offset:0  lds
  buffer_load_dwordx4 v14, s[12:15], s37 offen offset:1024  lds
  s_add_u32 m0, s38, s47
  s_nop 0
  buffer_load_dwordx4 v15, s[12:15], s37 offen offset:0  lds
  buffer_load_dwordx4 v16, s[12:15], s37 offen offset:1024  lds
  s_add_u32 m0, s38, s48
  s_nop 0
  buffer_load_dwordx4 v17, s[12:15], s37 offen offset:0  lds
  buffer_load_dwordx4 v18, s[12:15], s37 offen offset:1024  lds
  s_add_u32 s38, s38, 43008
  s_cmp_eq_u32 s38, 129024
  s_cselect_b32 s38, 0, s38
  s_lshl_b32 s40, s28, 7
  s_sub_u32 s40, s40, 16
  s_lshl_b32 s32, s41, 5
  s_add_u32 s32, s32, 16
  v_lshrrev_b32 v2, 3, v0
  v_add_u32 v2, s32, v2
  v_bfe_u32 v3, v2, 1, 3
  v_and_b32 v4, 7, v0
  v_xor_b32 v3, v3, v4
  v_lshlrev_b32 v3, 4, v3
  v_add_u32 v2, s40, v2
  v_max_i32 v2, 0, v2
  v_lshlrev_b32 v2, 11, v2
  v_add_u32 v8, v2, v3
  v_add_u32 v10, 30720, v8
  s_lshl_b32 s32, s41, 5
  s_add_u32 s32, s32, 24
  v_lshrrev_b32 v2, 3, v0
  v_add_u32 v2, s32, v2
  v_bfe_u32 v3, v2, 1, 3
  v_and_b32 v4, 7, v0
  v_xor_b32 v3, v3, v4
  v_lshlrev_b32 v3, 4, v3
  v_add_u32 v2, s40, v2
  v_max_i32 v2, 0, v2
  v_lshlrev_b32 v2, 11, v2
  v_add_u32 v9, v2, v3
  v_subrev_u32 v9, 1024, v9
  v_add_u32 v11, 30720, v9
  s_lshl_b32 s32, s41, 3
  v_lshrrev_b32 v2, 3, v0
  v_add_u32 v2, s32, v2
  v_bfe_u32 v3, v2, 1, 3
  v_and_b32 v4, 7, v0
  v_xor_b32 v3, v3, v4
  v_lshlrev_b32 v3, 4, v3
  v_add_u32 v2, s40, v2
  v_max_i32 v2, 0, v2
  v_lshlrev_b32 v2, 11, v2
  v_add_u32 v12, v2, v3
  s_lshl_b32 s44, s41, 12
  s_add_u32 s44, s44, 2048
  s_lshl_b32 s45, s41, 10
  s_mov_b32 s34, 0
  s_cmp_eq_u32 s41, 0
  s_cselect_b32 s52, 0xffffff00, -1
  s_mov_b32 s53, -1
  v_mov_b32 v20, 0x3f803f80
  v_mov_b32 v21, v20
  v_mov_b32 v22, v20
  v_mov_b32 v23, v20
  v_lshlrev_b32 v24, 4, v0
  v_add_u32 v25, 86016, v24
  s_mov_b64 exec, 0xff
  ds_write_b128 v24, v[20:23]
  ds_write_b128 v24, v[20:23] offset:43008
  ds_write_b128 v25, v[20:23]
  s_mov_b64 exec, -1
  s_add_u32 s8, s84, 25165824
  s_addc_u32 s9, s85, 0
  s_mov_b32 s10, 4194304
  s_mov_b32 s11, 0x20000
  s_add_u32 s20, s84, 55574528
  s_addc_u32 s21, s85, 0
  s_mov_b32 s22, 131072
  s_mov_b32 s23, 0x20000
  s_lshl_b32 s32, s41, 6
  v_add_u32 v26, s32, v0
  v_min_u32 v26, 143, v26
  v_add_u32 v27, s40, v26
  v_max_i32 v27, 0, v27
  v_lshlrev_b32 v27, 3, v27
  v_lshlrev_b32 v26, 3, v26
  v_add_u32 v26, 129024, v26
  s_waitcnt lgkmcnt(0)
  s_add_u32 s16, s84, 29360128
  s_addc_u32 s17, s85, 0
  s_mov_b32 s18, 262144
  s_mov_b32 s19, 0x20000
  s_lshl_b32 s32, s28, 4
  s_sub_u32 s32, s32, 8
  v_min_u32 v28, 23, v0
  v_add_u32 v28, s32, v28
  v_max_i32 v28, 0, v28
  v_lshlrev_b32 v28, 7, v28
  s_lshl_b32 s55, s3, 17
  s_add_u32 s55, s55, 98304
  s_barrier
  s_barrier
  s_mov_b64 exec, 1
  buffer_store_dword v137, v136, s[24:27], s56 offen sc0 sc1
  s_mov_b64 exec, -1
  s_mov_b32 s39, 0
  s_and_b32 s32, s4, 3
  s_cmp_lg_u32 s32, 0
  s_cbranch_scc1 poll21d
  s_sleep 8
poll21:
  buffer_load_dword v29, v28, s[16:19], s55 offen sc0 sc1
  s_waitcnt vmcnt(0)
  v_cmp_eq_u32 vcc, 0, v29
  s_add_u32 s39, s39, 1
  s_cmp_gt_u32 s39, 100000
  s_cbranch_scc1 poll21d
  s_cbranch_vccnz poll21
poll21d:
  s_barrier
  s_mov_b32 s3, 1
  s_add_u32 s82, s84, 33554432
  s_addc_u32 s83, s85, 0
  s_branch L_top
L_end:
mega_end:
  s_endpgm
.section .rodata,"a"
.p2align 6
.amdhsa_kernel interleave_layers__sliding_local_dilated__mixer_token_mlp__prompt_kernel
  .amdhsa_next_free_vgpr 256
  .amdhsa_next_free_sgpr 102
  .amdhsa_accum_offset 256
  .amdhsa_group_segment_fixed_size 0
  .amdhsa_kernarg_size 88
  .amdhsa_user_sgpr_count 2
  .amdhsa_user_sgpr_kernarg_segment_ptr 1
  .amdhsa_system_sgpr_workgroup_id_x 1
.end_amdhsa_kernel
```

```asm
; @launch grid=(256,1,1) block=(512,1,1) lds=163840
.amdgcn_target "amdgcn-amd-amdhsa--gfx950"
.text
.globl interleave_layers__sliding_local_dilated__mixer_token_mlp__prompt_kernel
.type interleave_layers__sliding_local_dilated__mixer_token_mlp__prompt_kernel,@function
.p2align 8
interleave_layers__sliding_local_dilated__mixer_token_mlp__prompt_kernel:
  s_cmp_ge_u32 s2, 256
  s_cbranch_scc1 mega_end
  s_load_dwordx16 s[64:79], s[0:1], 0
  s_load_dwordx2 s[80:81], s[0:1], 64
  s_load_dwordx2 s[84:85], s[0:1], 80
  s_load_dwordx2 s[62:63], s[0:1], 72
  v_lshrrev_b32 v1, 6, v0
  v_and_b32 v0, 63, v0
  v_readfirstlane_b32 s4, v1
  s_mov_b32 s3, 0
  v_mov_b32 v130, 0
  v_mov_b32 v131, 0
  v_mov_b32 v220, 0
  v_mov_b32 v134, 0
  s_cmp_ge_u32 s4, 4
  s_cbranch_scc1 L_start
  s_lshr_b32 s32, s2, 3
  s_lshr_b32 s5, s32, 3
  s_and_b32 s6, s32, 7
  s_lshl_b32 s7, s5, 1
  s_add_u32 s7, s7, s6
  s_and_b32 s7, s7, 7
  s_and_b32 s32, s2, 7
  s_lshr_b32 s28, s32, 1
  s_lshl_b32 s28, s28, 2
  s_add_u32 s28, s28, s5
  s_and_b32 s29, s32, 1
  s_mul_i32 s29, s29, 8
  s_add_u32 s29, s29, s6
  s_mov_b32 s30, 7
  s_mov_b32 s31, -1
  v_and_b32 v4, 15, v0
  v_lshrrev_b32 v5, 4, v0
  v_lshrrev_b32 v6, 2, v4
  v_and_b32 v7, 3, v0
  v_lshrrev_b32 v3, 5, v0
  v_and_b32 v2, 1, v5
  v_lshl_or_b32 v3, v2, 1, v3
  v_lshl_add_u32 v21, v5, 3, v6
  v_lshlrev_b32 v21, 7, v21
  v_lshl_add_u32 v21, v7, 3, v21
  v_lshrrev_b32 v22, 1, v6
  v_lshl_or_b32 v22, v2, 1, v22
  v_lshl_add_u32 v21, v22, 5, v21
  v_add_u32 v21, 18432, v21
  v_xor_b32 v8, 0, v21
  s_lshl_b32 s32, s4, 5
  v_xor_b32 v8, s32, v8
  v_lshrrev_b32 v21, 1, v4
  v_xor_b32 v21, v21, v5
  v_lshlrev_b32 v21, 4, v21
  v_lshlrev_b32 v22, 7, v4
  v_add_u32 v9, v21, v22
  v_xor_b32 v10, 64, v9
  v_and_b32 v21, 1, v4
  v_mul_u32_u24 v21, 28800, v21
  v_lshrrev_b32 v22, 1, v4
  v_mul_u32_u24 v22, 400, v22
  v_lshlrev_b32 v23, 3, v5
  v_add3_u32 v11, v21, v22, v23
  s_add_u32 s32, s32, 43008
  v_add_u32 v11, s32, v11
  v_lshlrev_b32 v12, 3, v4
  v_add_u32 v12, 129024, v12
  v_mov_b64 v[112:113], 0
  v_mov_b64 v[114:115], 0
  v_mov_b64 v[116:117], 0
  v_mov_b64 v[118:119], 0
  v_mov_b64 v[120:121], 0
  v_mov_b64 v[122:123], 0
  v_mov_b64 v[124:125], 0
  v_mov_b64 v[126:127], 0
  v_mov_b64 v[128:129], 0
  v_mov_b64 v[130:131], 0
  v_mov_b64 v[132:133], 0
  v_mov_b64 v[134:135], 0
  v_mov_b64 v[136:137], 0
  v_mov_b64 v[138:139], 0
  v_mov_b64 v[140:141], 0
  v_mov_b64 v[142:143], 0
  v_mov_b64 v[144:145], 0
  v_mov_b64 v[146:147], 0
  v_mov_b64 v[148:149], 0
  v_mov_b64 v[150:151], 0
  v_mov_b64 v[152:153], 0
  v_mov_b64 v[154:155], 0
  v_mov_b64 v[156:157], 0
  v_mov_b64 v[158:159], 0
  v_mov_b64 v[160:161], 0
  v_mov_b64 v[162:163], 0
  v_mov_b64 v[164:165], 0
  v_mov_b64 v[166:167], 0
  v_mov_b64 v[168:169], 0
  v_mov_b64 v[170:171], 0
  v_mov_b64 v[172:173], 0
  v_mov_b64 v[174:175], 0
  v_mov_b64 v[176:177], 0
  v_mov_b64 v[178:179], 0
  v_mov_b64 v[180:181], 0
  v_mov_b64 v[182:183], 0
  v_mov_b64 v[184:185], 0
  v_mov_b64 v[186:187], 0
  v_mov_b64 v[188:189], 0
  v_mov_b64 v[190:191], 0
  v_mov_b64 v[192:193], 0
  v_mov_b64 v[194:195], 0
  v_mov_b64 v[196:197], 0
  v_mov_b64 v[198:199], 0
  v_mov_b64 v[200:201], 0
  v_mov_b64 v[202:203], 0
  v_mov_b64 v[204:205], 0
  v_mov_b64 v[206:207], 0
  v_mov_b64 v[208:209], 0
  v_mov_b64 v[210:211], 0
  v_mov_b64 v[212:213], 0
  v_mov_b64 v[214:215], 0
  v_mov_b64 v[216:217], 0
  v_mov_b64 v[218:219], 0
  s_waitcnt lgkmcnt(0)
  s_mov_b32 s82, s84
  s_mov_b32 s83, s85
  s_mov_b32 s12, s84
  s_mov_b32 s13, s85
  s_mov_b32 s14, 0
  s_mov_b32 s15, 0x20000
  s_mov_b32 s20, s66
  s_mov_b32 s21, s67
  s_mov_b32 s22, 6291456
  s_mov_b32 s23, 0x20000
  s_cmp_eq_u32 s4, 3
  s_cselect_b32 s20, s68, s20
  s_cselect_b32 s21, s69, s21
  s_cselect_b32 s22, 2097152, s22
  s_cselect_b32 s47, 0, s4
  s_lshl_b32 s47, s47, 8
  s_add_u32 s47, s47, s2
  s_lshl_b32 s47, s47, 13
  v_lshlrev_b32 v13, 7, v0
  s_barrier
  s_mov_b32 s51, s4
  s_cmp_lg_u32 s51, 0
  s_cbranch_scc1 C_wm0
  buffer_load_dword v222, v13, s[20:23], s47 offen
C_wm0:
C_top:
  s_nop 7
  s_nop 7
  s_mov_b32 s43, 0
  s_mov_b32 s39, 12
  s_barrier
  ds_read_b64_tr_b16 v[16:17], v8 offset:0
  ds_read_b64_tr_b16 v[18:19], v8 offset:512
  ds_read_b128 v[28:31], v9 offset:0
  ds_read_b64_tr_b16 v[20:21], v8 offset:8192
  ds_read_b64_tr_b16 v[22:23], v8 offset:8704
  ds_read_b64_tr_b16 v[24:25], v8 offset:16384
  ds_read_b64_tr_b16 v[26:27], v8 offset:16896
  ds_read_b128 v[32:35], v9 offset:2048
  ds_read_b128 v[36:39], v9 offset:4096
  ds_read_b128 v[40:43], v9 offset:6144
  ds_read_b128 v[44:47], v9 offset:8192
  ds_read_b128 v[48:51], v9 offset:10240
  ds_read_b128 v[52:55], v9 offset:12288
  ds_read_b128 v[56:59], v9 offset:14336
  ds_read_b128 v[60:63], v9 offset:16384
  s_add_u32 s40, s43, 43008
  s_cmp_eq_u32 s40, 129024
  s_cselect_b32 s40, 0, s40
  s_sub_u32 s42, s40, s43
  s_mov_b32 s43, s40
  s_waitcnt lgkmcnt(12)
  v_mfma_f32_16x16x32_bf16 v[112:115], v[16:19], v[28:31], v[112:115]
  ds_read_b64_tr_b16 v[64:65], v8 offset:4096
  s_waitcnt lgkmcnt(11)
  v_mfma_f32_16x16x32_bf16 v[148:151], v[20:23], v[28:31], v[148:151]
  ds_read_b64_tr_b16 v[66:67], v8 offset:4608
  s_waitcnt lgkmcnt(10)
  v_mfma_f32_16x16x32_bf16 v[184:187], v[24:27], v[28:31], v[184:187]
  ds_read_b128 v[76:79], v10 offset:0
  s_waitcnt lgkmcnt(10)
  v_mfma_f32_16x16x32_bf16 v[188:191], v[24:27], v[32:35], v[188:191]
  ds_read_b64_tr_b16 v[68:69], v8 offset:12288
  v_mfma_f32_16x16x32_bf16 v[152:155], v[20:23], v[32:35], v[152:155]
  ds_read_b64_tr_b16 v[70:71], v8 offset:12800
  v_mfma_f32_16x16x32_bf16 v[116:119], v[16:19], v[32:35], v[116:119]
  ds_read_b64_tr_b16 v[72:73], v8 offset:20480
  s_waitcnt lgkmcnt(12)
  v_mfma_f32_16x16x32_bf16 v[120:123], v[16:19], v[36:39], v[120:123]
  ds_read_b64_tr_b16 v[74:75], v8 offset:20992
  v_add_u32 v8, s42, v8
  v_mfma_f32_16x16x32_bf16 v[156:159], v[20:23], v[36:39], v[156:159]
  ds_read_b128 v[80:83], v10 offset:2048
  v_mfma_f32_16x16x32_bf16 v[192:195], v[24:27], v[36:39], v[192:195]
  ds_read_b128 v[84:87], v10 offset:4096
  s_waitcnt lgkmcnt(14)
  v_mfma_f32_16x16x32_bf16 v[196:199], v[24:27], v[40:43], v[196:199]
  ds_read_b128 v[88:91], v10 offset:6144
  v_mfma_f32_16x16x32_bf16 v[160:163], v[20:23], v[40:43], v[160:163]
  ds_read_b128 v[92:95], v10 offset:8192
  v_mfma_f32_16x16x32_bf16 v[124:127], v[16:19], v[40:43], v[124:127]
  ds_read_b128 v[96:99], v10 offset:10240
  s_waitcnt lgkmcnt(15)
  v_mfma_f32_16x16x32_bf16 v[128:131], v[16:19], v[44:47], v[128:131]
  ds_read_b128 v[100:103], v10 offset:12288
  v_mfma_f32_16x16x32_bf16 v[164:167], v[20:23], v[44:47], v[164:167]
  ds_read_b128 v[104:107], v10 offset:14336
  v_mfma_f32_16x16x32_bf16 v[200:203], v[24:27], v[44:47], v[200:203]
  ds_read_b128 v[108:111], v10 offset:16384
  v_add_u32 v9, s42, v9
  v_add_u32 v10, s42, v10
  s_waitcnt lgkmcnt(15)
  v_mfma_f32_16x16x32_bf16 v[204:207], v[24:27], v[48:51], v[204:207]
  v_mfma_f32_16x16x32_bf16 v[168:171], v[20:23], v[48:51], v[168:171]
  v_mfma_f32_16x16x32_bf16 v[132:135], v[16:19], v[48:51], v[132:135]
  s_waitcnt lgkmcnt(15)
  v_mfma_f32_16x16x32_bf16 v[136:139], v[16:19], v[52:55], v[136:139]
  v_mfma_f32_16x16x32_bf16 v[172:175], v[20:23], v[52:55], v[172:175]
  v_mfma_f32_16x16x32_bf16 v[208:211], v[24:27], v[52:55], v[208:211]
  s_waitcnt lgkmcnt(15)
  v_mfma_f32_16x16x32_bf16 v[212:215], v[24:27], v[56:59], v[212:215]
  v_mfma_f32_16x16x32_bf16 v[176:179], v[20:23], v[56:59], v[176:179]
  v_mfma_f32_16x16x32_bf16 v[140:143], v[16:19], v[56:59], v[140:143]
  s_waitcnt lgkmcnt(15)
  v_mfma_f32_16x16x32_bf16 v[144:147], v[16:19], v[60:63], v[144:147]
  v_mfma_f32_16x16x32_bf16 v[180:183], v[20:23], v[60:63], v[180:183]
  v_mfma_f32_16x16x32_bf16 v[216:219], v[24:27], v[60:63], v[216:219]
  s_waitcnt lgkmcnt(0)
  s_barrier
  s_cmp_lg_u32 s51, 1
  s_cbranch_scc1 C_wm1
  buffer_load_dword v222, v13, s[20:23], s47 offen
C_wm1:
  v_mfma_f32_16x16x32_bf16 v[112:115], v[64:67], v[76:79], v[112:115]
  ds_read_b64_tr_b16 v[16:17], v8 offset:0
  s_add_u32 s40, s43, 43008
  v_mfma_f32_16x16x32_bf16 v[148:151], v[68:71], v[76:79], v[148:151]
  ds_read_b64_tr_b16 v[18:19], v8 offset:512
  s_cmp_eq_u32 s40, 129024
  v_mfma_f32_16x16x32_bf16 v[184:187], v[72:75], v[76:79], v[184:187]
  ds_read_b128 v[28:31], v9 offset:0
  s_cselect_b32 s40, 0, s40
  v_mfma_f32_16x16x32_bf16 v[188:191], v[72:75], v[80:83], v[188:191]
  ds_read_b64_tr_b16 v[20:21], v8 offset:8192
  s_sub_u32 s42, s40, s43
  v_mfma_f32_16x16x32_bf16 v[152:155], v[68:71], v[80:83], v[152:155]
  ds_read_b64_tr_b16 v[22:23], v8 offset:8704
  s_mov_b32 s43, s40
  v_mfma_f32_16x16x32_bf16 v[116:119], v[64:67], v[80:83], v[116:119]
  ds_read_b64_tr_b16 v[24:25], v8 offset:16384
  v_mfma_f32_16x16x32_bf16 v[120:123], v[64:67], v[84:87], v[120:123]
  ds_read_b64_tr_b16 v[26:27], v8 offset:16896
  v_mfma_f32_16x16x32_bf16 v[156:159], v[68:71], v[84:87], v[156:159]
  ds_read_b128 v[32:35], v9 offset:2048
  v_mfma_f32_16x16x32_bf16 v[192:195], v[72:75], v[84:87], v[192:195]
  ds_read_b128 v[36:39], v9 offset:4096
  v_mfma_f32_16x16x32_bf16 v[196:199], v[72:75], v[88:91], v[196:199]
  ds_read_b128 v[40:43], v9 offset:6144
  v_mfma_f32_16x16x32_bf16 v[160:163], v[68:71], v[88:91], v[160:163]
  ds_read_b128 v[44:47], v9 offset:8192
  v_mfma_f32_16x16x32_bf16 v[124:127], v[64:67], v[88:91], v[124:127]
  ds_read_b128 v[48:51], v9 offset:10240
  v_mfma_f32_16x16x32_bf16 v[128:131], v[64:67], v[92:95], v[128:131]
  ds_read_b128 v[52:55], v9 offset:12288
  v_mfma_f32_16x16x32_bf16 v[164:167], v[68:71], v[92:95], v[164:167]
  ds_read_b128 v[56:59], v9 offset:14336
  v_mfma_f32_16x16x32_bf16 v[200:203], v[72:75], v[92:95], v[200:203]
  ds_read_b128 v[60:63], v9 offset:16384
  v_mfma_f32_16x16x32_bf16 v[204:207], v[72:75], v[96:99], v[204:207]
  v_mfma_f32_16x16x32_bf16 v[168:171], v[68:71], v[96:99], v[168:171]
  v_mfma_f32_16x16x32_bf16 v[132:135], v[64:67], v[96:99], v[132:135]
  v_mfma_f32_16x16x32_bf16 v[136:139], v[64:67], v[100:103], v[136:139]
  v_mfma_f32_16x16x32_bf16 v[172:175], v[68:71], v[100:103], v[172:175]
  v_mfma_f32_16x16x32_bf16 v[208:211], v[72:75], v[100:103], v[208:211]
  v_mfma_f32_16x16x32_bf16 v[212:215], v[72:75], v[104:107], v[212:215]
  v_mfma_f32_16x16x32_bf16 v[176:179], v[68:71], v[104:107], v[176:179]
  v_mfma_f32_16x16x32_bf16 v[140:143], v[64:67], v[104:107], v[140:143]
  v_mfma_f32_16x16x32_bf16 v[144:147], v[64:67], v[108:111], v[144:147]
  v_mfma_f32_16x16x32_bf16 v[180:183], v[68:71], v[108:111], v[180:183]
  v_mfma_f32_16x16x32_bf16 v[216:219], v[72:75], v[108:111], v[216:219]
  s_waitcnt lgkmcnt(12)
  v_mfma_f32_16x16x32_bf16 v[112:115], v[16:19], v[28:31], v[112:115]
  ds_read_b64_tr_b16 v[64:65], v8 offset:4096
  s_waitcnt lgkmcnt(11)
  v_mfma_f32_16x16x32_bf16 v[148:151], v[20:23], v[28:31], v[148:151]
  ds_read_b64_tr_b16 v[66:67], v8 offset:4608
  s_waitcnt lgkmcnt(10)
  v_mfma_f32_16x16x32_bf16 v[184:187], v[24:27], v[28:31], v[184:187]
  ds_read_b128 v[76:79], v10 offset:0
  s_waitcnt lgkmcnt(10)
  v_mfma_f32_16x16x32_bf16 v[188:191], v[24:27], v[32:35], v[188:191]
  ds_read_b64_tr_b16 v[68:69], v8 offset:12288
  v_mfma_f32_16x16x32_bf16 v[152:155], v[20:23], v[32:35], v[152:155]
  ds_read_b64_tr_b16 v[70:71], v8 offset:12800
  v_mfma_f32_16x16x32_bf16 v[116:119], v[16:19], v[32:35], v[116:119]
  ds_read_b64_tr_b16 v[72:73], v8 offset:20480
  s_waitcnt lgkmcnt(12)
  v_mfma_f32_16x16x32_bf16 v[120:123], v[16:19], v[36:39], v[120:123]
  ds_read_b64_tr_b16 v[74:75], v8 offset:20992
  v_add_u32 v8, s42, v8
  v_mfma_f32_16x16x32_bf16 v[156:159], v[20:23], v[36:39], v[156:159]
  ds_read_b128 v[80:83], v10 offset:2048
  v_mfma_f32_16x16x32_bf16 v[192:195], v[24:27], v[36:39], v[192:195]
  ds_read_b128 v[84:87], v10 offset:4096
  s_waitcnt lgkmcnt(14)
  v_mfma_f32_16x16x32_bf16 v[196:199], v[24:27], v[40:43], v[196:199]
  ds_read_b128 v[88:91], v10 offset:6144
  v_mfma_f32_16x16x32_bf16 v[160:163], v[20:23], v[40:43], v[160:163]
  ds_read_b128 v[92:95], v10 offset:8192
  v_mfma_f32_16x16x32_bf16 v[124:127], v[16:19], v[40:43], v[124:127]
  ds_read_b128 v[96:99], v10 offset:10240
  s_waitcnt lgkmcnt(15)
  v_mfma_f32_16x16x32_bf16 v[128:131], v[16:19], v[44:47], v[128:131]
  ds_read_b128 v[100:103], v10 offset:12288
  v_mfma_f32_16x16x32_bf16 v[164:167], v[20:23], v[44:47], v[164:167]
  ds_read_b128 v[104:107], v10 offset:14336
  v_mfma_f32_16x16x32_bf16 v[200:203], v[24:27], v[44:47], v[200:203]
  ds_read_b128 v[108:111], v10 offset:16384
  v_add_u32 v9, s42, v9
  v_add_u32 v10, s42, v10
  s_waitcnt lgkmcnt(15)
  v_mfma_f32_16x16x32_bf16 v[204:207], v[24:27], v[48:51], v[204:207]
  v_mfma_f32_16x16x32_bf16 v[168:171], v[20:23], v[48:51], v[168:171]
  v_mfma_f32_16x16x32_bf16 v[132:135], v[16:19], v[48:51], v[132:135]
  s_waitcnt lgkmcnt(15)
  v_mfma_f32_16x16x32_bf16 v[136:139], v[16:19], v[52:55], v[136:139]
  v_mfma_f32_16x16x32_bf16 v[172:175], v[20:23], v[52:55], v[172:175]
  v_mfma_f32_16x16x32_bf16 v[208:211], v[24:27], v[52:55], v[208:211]
  s_waitcnt lgkmcnt(15)
  v_mfma_f32_16x16x32_bf16 v[212:215], v[24:27], v[56:59], v[212:215]
  v_mfma_f32_16x16x32_bf16 v[176:179], v[20:23], v[56:59], v[176:179]
  v_mfma_f32_16x16x32_bf16 v[140:143], v[16:19], v[56:59], v[140:143]
  s_waitcnt lgkmcnt(15)
  v_mfma_f32_16x16x32_bf16 v[144:147], v[16:19], v[60:63], v[144:147]
  v_mfma_f32_16x16x32_bf16 v[180:183], v[20:23], v[60:63], v[180:183]
  v_mfma_f32_16x16x32_bf16 v[216:219], v[24:27], v[60:63], v[216:219]
  s_waitcnt lgkmcnt(0)
  s_barrier
  s_cmp_lg_u32 s51, 2
  s_cbranch_scc1 C_wm2
  buffer_load_dword v222, v13, s[20:23], s47 offen
C_wm2:
  v_mfma_f32_16x16x32_bf16 v[112:115], v[64:67], v[76:79], v[112:115]
  ds_read_b64_tr_b16 v[16:17], v8 offset:0
  s_add_u32 s40, s43, 43008
  v_mfma_f32_16x16x32_bf16 v[148:151], v[68:71], v[76:79], v[148:151]
  ds_read_b64_tr_b16 v[18:19], v8 offset:512
  s_cmp_eq_u32 s40, 129024
  v_mfma_f32_16x16x32_bf16 v[184:187], v[72:75], v[76:79], v[184:187]
  ds_read_b128 v[28:31], v9 offset:0
  s_cselect_b32 s40, 0, s40
  v_mfma_f32_16x16x32_bf16 v[188:191], v[72:75], v[80:83], v[188:191]
  ds_read_b64_tr_b16 v[20:21], v8 offset:8192
  s_sub_u32 s42, s40, s43
  v_mfma_f32_16x16x32_bf16 v[152:155], v[68:71], v[80:83], v[152:155]
  ds_read_b64_tr_b16 v[22:23], v8 offset:8704
  s_mov_b32 s43, s40
  v_mfma_f32_16x16x32_bf16 v[116:119], v[64:67], v[80:83], v[116:119]
  ds_read_b64_tr_b16 v[24:25], v8 offset:16384
  v_mfma_f32_16x16x32_bf16 v[120:123], v[64:67], v[84:87], v[120:123]
  ds_read_b64_tr_b16 v[26:27], v8 offset:16896
  v_mfma_f32_16x16x32_bf16 v[156:159], v[68:71], v[84:87], v[156:159]
  ds_read_b128 v[32:35], v9 offset:2048
  v_mfma_f32_16x16x32_bf16 v[192:195], v[72:75], v[84:87], v[192:195]
  ds_read_b128 v[36:39], v9 offset:4096
  v_mfma_f32_16x16x32_bf16 v[196:199], v[72:75], v[88:91], v[196:199]
  ds_read_b128 v[40:43], v9 offset:6144
  v_mfma_f32_16x16x32_bf16 v[160:163], v[68:71], v[88:91], v[160:163]
  ds_read_b128 v[44:47], v9 offset:8192
  v_mfma_f32_16x16x32_bf16 v[124:127], v[64:67], v[88:91], v[124:127]
  ds_read_b128 v[48:51], v9 offset:10240
  v_mfma_f32_16x16x32_bf16 v[128:131], v[64:67], v[92:95], v[128:131]
  ds_read_b128 v[52:55], v9 offset:12288
  v_mfma_f32_16x16x32_bf16 v[164:167], v[68:71], v[92:95], v[164:167]
  ds_read_b128 v[56:59], v9 offset:14336
  v_mfma_f32_16x16x32_bf16 v[200:203], v[72:75], v[92:95], v[200:203]
  ds_read_b128 v[60:63], v9 offset:16384
  v_mfma_f32_16x16x32_bf16 v[204:207], v[72:75], v[96:99], v[204:207]
  v_mfma_f32_16x16x32_bf16 v[168:171], v[68:71], v[96:99], v[168:171]
  v_mfma_f32_16x16x32_bf16 v[132:135], v[64:67], v[96:99], v[132:135]
  v_mfma_f32_16x16x32_bf16 v[136:139], v[64:67], v[100:103], v[136:139]
  v_mfma_f32_16x16x32_bf16 v[172:175], v[68:71], v[100:103], v[172:175]
  v_mfma_f32_16x16x32_bf16 v[208:211], v[72:75], v[100:103], v[208:211]
  v_mfma_f32_16x16x32_bf16 v[212:215], v[72:75], v[104:107], v[212:215]
  v_mfma_f32_16x16x32_bf16 v[176:179], v[68:71], v[104:107], v[176:179]
  v_mfma_f32_16x16x32_bf16 v[140:143], v[64:67], v[104:107], v[140:143]
  v_mfma_f32_16x16x32_bf16 v[144:147], v[64:67], v[108:111], v[144:147]
  v_mfma_f32_16x16x32_bf16 v[180:183], v[68:71], v[108:111], v[180:183]
  v_mfma_f32_16x16x32_bf16 v[216:219], v[72:75], v[108:111], v[216:219]
  s_waitcnt lgkmcnt(12)
  v_mfma_f32_16x16x32_bf16 v[112:115], v[16:19], v[28:31], v[112:115]
  ds_read_b64_tr_b16 v[64:65], v8 offset:4096
  s_waitcnt lgkmcnt(11)
  v_mfma_f32_16x16x32_bf16 v[148:151], v[20:23], v[28:31], v[148:151]
  ds_read_b64_tr_b16 v[66:67], v8 offset:4608
  s_waitcnt lgkmcnt(10)
  v_mfma_f32_16x16x32_bf16 v[184:187], v[24:27], v[28:31], v[184:187]
  ds_read_b128 v[76:79], v10 offset:0
  s_waitcnt lgkmcnt(10)
  v_mfma_f32_16x16x32_bf16 v[188:191], v[24:27], v[32:35], v[188:191]
  ds_read_b64_tr_b16 v[68:69], v8 offset:12288
  v_mfma_f32_16x16x32_bf16 v[152:155], v[20:23], v[32:35], v[152:155]
  ds_read_b64_tr_b16 v[70:71], v8 offset:12800
  v_mfma_f32_16x16x32_bf16 v[116:119], v[16:19], v[32:35], v[116:119]
  ds_read_b64_tr_b16 v[72:73], v8 offset:20480
  s_waitcnt lgkmcnt(12)
  v_mfma_f32_16x16x32_bf16 v[120:123], v[16:19], v[36:39], v[120:123]
  ds_read_b64_tr_b16 v[74:75], v8 offset:20992
  v_add_u32 v8, s42, v8
  v_mfma_f32_16x16x32_bf16 v[156:159], v[20:23], v[36:39], v[156:159]
  ds_read_b128 v[80:83], v10 offset:2048
  v_mfma_f32_16x16x32_bf16 v[192:195], v[24:27], v[36:39], v[192:195]
  ds_read_b128 v[84:87], v10 offset:4096
  s_waitcnt lgkmcnt(14)
  v_mfma_f32_16x16x32_bf16 v[196:199], v[24:27], v[40:43], v[196:199]
  ds_read_b128 v[88:91], v10 offset:6144
  v_mfma_f32_16x16x32_bf16 v[160:163], v[20:23], v[40:43], v[160:163]
  ds_read_b128 v[92:95], v10 offset:8192
  v_mfma_f32_16x16x32_bf16 v[124:127], v[16:19], v[40:43], v[124:127]
  ds_read_b128 v[96:99], v10 offset:10240
  s_waitcnt lgkmcnt(15)
  v_mfma_f32_16x16x32_bf16 v[128:131], v[16:19], v[44:47], v[128:131]
  ds_read_b128 v[100:103], v10 offset:12288
  v_mfma_f32_16x16x32_bf16 v[164:167], v[20:23], v[44:47], v[164:167]
  ds_read_b128 v[104:107], v10 offset:14336
  v_mfma_f32_16x16x32_bf16 v[200:203], v[24:27], v[44:47], v[200:203]
  ds_read_b128 v[108:111], v10 offset:16384
  v_add_u32 v9, s42, v9
  v_add_u32 v10, s42, v10
  s_waitcnt lgkmcnt(15)
  v_mfma_f32_16x16x32_bf16 v[204:207], v[24:27], v[48:51], v[204:207]
  v_mfma_f32_16x16x32_bf16 v[168:171], v[20:23], v[48:51], v[168:171]
  v_mfma_f32_16x16x32_bf16 v[132:135], v[16:19], v[48:51], v[132:135]
  s_waitcnt lgkmcnt(15)
  v_mfma_f32_16x16x32_bf16 v[136:139], v[16:19], v[52:55], v[136:139]
  v_mfma_f32_16x16x32_bf16 v[172:175], v[20:23], v[52:55], v[172:175]
  v_mfma_f32_16x16x32_bf16 v[208:211], v[24:27], v[52:55], v[208:211]
  s_waitcnt lgkmcnt(15)
  v_mfma_f32_16x16x32_bf16 v[212:215], v[24:27], v[56:59], v[212:215]
  v_mfma_f32_16x16x32_bf16 v[176:179], v[20:23], v[56:59], v[176:179]
  v_mfma_f32_16x16x32_bf16 v[140:143], v[16:19], v[56:59], v[140:143]
  s_waitcnt lgkmcnt(15)
  v_mfma_f32_16x16x32_bf16 v[144:147], v[16:19], v[60:63], v[144:147]
  v_mfma_f32_16x16x32_bf16 v[180:183], v[20:23], v[60:63], v[180:183]
  v_mfma_f32_16x16x32_bf16 v[216:219], v[24:27], v[60:63], v[216:219]
  s_waitcnt lgkmcnt(0)
  s_barrier
  s_cmp_lg_u32 s51, 3
  s_cbranch_scc1 C_wm3
  buffer_load_dword v222, v13, s[20:23], s47 offen
C_wm3:
  v_mfma_f32_16x16x32_bf16 v[112:115], v[64:67], v[76:79], v[112:115]
  ds_read_b64_tr_b16 v[16:17], v8 offset:0
  s_add_u32 s40, s43, 43008
  v_mfma_f32_16x16x32_bf16 v[148:151], v[68:71], v[76:79], v[148:151]
  ds_read_b64_tr_b16 v[18:19], v8 offset:512
  s_cmp_eq_u32 s40, 129024
  v_mfma_f32_16x16x32_bf16 v[184:187], v[72:75], v[76:79], v[184:187]
  ds_read_b128 v[28:31], v9 offset:0
  s_cselect_b32 s40, 0, s40
  v_mfma_f32_16x16x32_bf16 v[188:191], v[72:75], v[80:83], v[188:191]
  ds_read_b64_tr_b16 v[20:21], v8 offset:8192
  s_sub_u32 s42, s40, s43
  v_mfma_f32_16x16x32_bf16 v[152:155], v[68:71], v[80:83], v[152:155]
  ds_read_b64_tr_b16 v[22:23], v8 offset:8704
  s_mov_b32 s43, s40
  v_mfma_f32_16x16x32_bf16 v[116:119], v[64:67], v[80:83], v[116:119]
  ds_read_b64_tr_b16 v[24:25], v8 offset:16384
  v_mfma_f32_16x16x32_bf16 v[120:123], v[64:67], v[84:87], v[120:123]
  ds_read_b64_tr_b16 v[26:27], v8 offset:16896
  v_mfma_f32_16x16x32_bf16 v[156:159], v[68:71], v[84:87], v[156:159]
  ds_read_b128 v[32:35], v9 offset:2048
  v_mfma_f32_16x16x32_bf16 v[192:195], v[72:75], v[84:87], v[192:195]
  ds_read_b128 v[36:39], v9 offset:4096
  v_mfma_f32_16x16x32_bf16 v[196:199], v[72:75], v[88:91], v[196:199]
  ds_read_b128 v[40:43], v9 offset:6144
  v_mfma_f32_16x16x32_bf16 v[160:163], v[68:71], v[88:91], v[160:163]
  ds_read_b128 v[44:47], v9 offset:8192
  v_mfma_f32_16x16x32_bf16 v[124:127], v[64:67], v[88:91], v[124:127]
  ds_read_b128 v[48:51], v9 offset:10240
  v_mfma_f32_16x16x32_bf16 v[128:131], v[64:67], v[92:95], v[128:131]
  ds_read_b128 v[52:55], v9 offset:12288
  v_mfma_f32_16x16x32_bf16 v[164:167], v[68:71], v[92:95], v[164:167]
  ds_read_b128 v[56:59], v9 offset:14336
  v_mfma_f32_16x16x32_bf16 v[200:203], v[72:75], v[92:95], v[200:203]
  ds_read_b128 v[60:63], v9 offset:16384
  v_mfma_f32_16x16x32_bf16 v[204:207], v[72:75], v[96:99], v[204:207]
  v_mfma_f32_16x16x32_bf16 v[168:171], v[68:71], v[96:99], v[168:171]
  v_mfma_f32_16x16x32_bf16 v[132:135], v[64:67], v[96:99], v[132:135]
  v_mfma_f32_16x16x32_bf16 v[136:139], v[64:67], v[100:103], v[136:139]
  v_mfma_f32_16x16x32_bf16 v[172:175], v[68:71], v[100:103], v[172:175]
  v_mfma_f32_16x16x32_bf16 v[208:211], v[72:75], v[100:103], v[208:211]
  v_mfma_f32_16x16x32_bf16 v[212:215], v[72:75], v[104:107], v[212:215]
  v_mfma_f32_16x16x32_bf16 v[176:179], v[68:71], v[104:107], v[176:179]
  v_mfma_f32_16x16x32_bf16 v[140:143], v[64:67], v[104:107], v[140:143]
  v_mfma_f32_16x16x32_bf16 v[144:147], v[64:67], v[108:111], v[144:147]
  v_mfma_f32_16x16x32_bf16 v[180:183], v[68:71], v[108:111], v[180:183]
  v_mfma_f32_16x16x32_bf16 v[216:219], v[72:75], v[108:111], v[216:219]
cl1:
  s_waitcnt lgkmcnt(12)
  v_mfma_f32_16x16x32_bf16 v[112:115], v[16:19], v[28:31], v[112:115]
  ds_read_b64_tr_b16 v[64:65], v8 offset:4096
  s_waitcnt lgkmcnt(11)
  v_mfma_f32_16x16x32_bf16 v[148:151], v[20:23], v[28:31], v[148:151]
  ds_read_b64_tr_b16 v[66:67], v8 offset:4608
  s_waitcnt lgkmcnt(10)
  v_mfma_f32_16x16x32_bf16 v[184:187], v[24:27], v[28:31], v[184:187]
  ds_read_b128 v[76:79], v10 offset:0
  s_waitcnt lgkmcnt(10)
  v_mfma_f32_16x16x32_bf16 v[188:191], v[24:27], v[32:35], v[188:191]
  ds_read_b64_tr_b16 v[68:69], v8 offset:12288
  v_mfma_f32_16x16x32_bf16 v[152:155], v[20:23], v[32:35], v[152:155]
  ds_read_b64_tr_b16 v[70:71], v8 offset:12800
  v_mfma_f32_16x16x32_bf16 v[116:119], v[16:19], v[32:35], v[116:119]
  ds_read_b64_tr_b16 v[72:73], v8 offset:20480
  s_waitcnt lgkmcnt(12)
  v_mfma_f32_16x16x32_bf16 v[120:123], v[16:19], v[36:39], v[120:123]
  ds_read_b64_tr_b16 v[74:75], v8 offset:20992
  v_add_u32 v8, s42, v8
  v_mfma_f32_16x16x32_bf16 v[156:159], v[20:23], v[36:39], v[156:159]
  ds_read_b128 v[80:83], v10 offset:2048
  v_mfma_f32_16x16x32_bf16 v[192:195], v[24:27], v[36:39], v[192:195]
  ds_read_b128 v[84:87], v10 offset:4096
  s_waitcnt lgkmcnt(14)
  v_mfma_f32_16x16x32_bf16 v[196:199], v[24:27], v[40:43], v[196:199]
  ds_read_b128 v[88:91], v10 offset:6144
  v_mfma_f32_16x16x32_bf16 v[160:163], v[20:23], v[40:43], v[160:163]
  ds_read_b128 v[92:95], v10 offset:8192
  v_mfma_f32_16x16x32_bf16 v[124:127], v[16:19], v[40:43], v[124:127]
  ds_read_b128 v[96:99], v10 offset:10240
  s_waitcnt lgkmcnt(15)
  v_mfma_f32_16x16x32_bf16 v[128:131], v[16:19], v[44:47], v[128:131]
  ds_read_b128 v[100:103], v10 offset:12288
  v_mfma_f32_16x16x32_bf16 v[164:167], v[20:23], v[44:47], v[164:167]
  ds_read_b128 v[104:107], v10 offset:14336
  v_mfma_f32_16x16x32_bf16 v[200:203], v[24:27], v[44:47], v[200:203]
  ds_read_b128 v[108:111], v10 offset:16384
  v_add_u32 v9, s42, v9
  v_add_u32 v10, s42, v10
  s_waitcnt lgkmcnt(15)
  v_mfma_f32_16x16x32_bf16 v[204:207], v[24:27], v[48:51], v[204:207]
  v_mfma_f32_16x16x32_bf16 v[168:171], v[20:23], v[48:51], v[168:171]
  v_mfma_f32_16x16x32_bf16 v[132:135], v[16:19], v[48:51], v[132:135]
  s_waitcnt lgkmcnt(15)
  v_mfma_f32_16x16x32_bf16 v[136:139], v[16:19], v[52:55], v[136:139]
  v_mfma_f32_16x16x32_bf16 v[172:175], v[20:23], v[52:55], v[172:175]
  v_mfma_f32_16x16x32_bf16 v[208:211], v[24:27], v[52:55], v[208:211]
  s_waitcnt lgkmcnt(15)
  v_mfma_f32_16x16x32_bf16 v[212:215], v[24:27], v[56:59], v[212:215]
  v_mfma_f32_16x16x32_bf16 v[176:179], v[20:23], v[56:59], v[176:179]
  v_mfma_f32_16x16x32_bf16 v[140:143], v[16:19], v[56:59], v[140:143]
  s_waitcnt lgkmcnt(15)
  v_mfma_f32_16x16x32_bf16 v[144:147], v[16:19], v[60:63], v[144:147]
  v_mfma_f32_16x16x32_bf16 v[180:183], v[20:23], v[60:63], v[180:183]
  v_mfma_f32_16x16x32_bf16 v[216:219], v[24:27], v[60:63], v[216:219]
  s_waitcnt lgkmcnt(0)
  s_barrier
  v_mfma_f32_16x16x32_bf16 v[112:115], v[64:67], v[76:79], v[112:115]
  ds_read_b64_tr_b16 v[16:17], v8 offset:0
  s_add_u32 s40, s43, 43008
  v_mfma_f32_16x16x32_bf16 v[148:151], v[68:71], v[76:79], v[148:151]
  ds_read_b64_tr_b16 v[18:19], v8 offset:512
  s_cmp_eq_u32 s40, 129024
  v_mfma_f32_16x16x32_bf16 v[184:187], v[72:75], v[76:79], v[184:187]
  ds_read_b128 v[28:31], v9 offset:0
  s_cselect_b32 s40, 0, s40
  v_mfma_f32_16x16x32_bf16 v[188:191], v[72:75], v[80:83], v[188:191]
  ds_read_b64_tr_b16 v[20:21], v8 offset:8192
  s_sub_u32 s42, s40, s43
  v_mfma_f32_16x16x32_bf16 v[152:155], v[68:71], v[80:83], v[152:155]
  ds_read_b64_tr_b16 v[22:23], v8 offset:8704
  s_mov_b32 s43, s40
  v_mfma_f32_16x16x32_bf16 v[116:119], v[64:67], v[80:83], v[116:119]
  ds_read_b64_tr_b16 v[24:25], v8 offset:16384
  v_mfma_f32_16x16x32_bf16 v[120:123], v[64:67], v[84:87], v[120:123]
  ds_read_b64_tr_b16 v[26:27], v8 offset:16896
  v_mfma_f32_16x16x32_bf16 v[156:159], v[68:71], v[84:87], v[156:159]
  ds_read_b128 v[32:35], v9 offset:2048
  v_mfma_f32_16x16x32_bf16 v[192:195], v[72:75], v[84:87], v[192:195]
  ds_read_b128 v[36:39], v9 offset:4096
  v_mfma_f32_16x16x32_bf16 v[196:199], v[72:75], v[88:91], v[196:199]
  ds_read_b128 v[40:43], v9 offset:6144
  v_mfma_f32_16x16x32_bf16 v[160:163], v[68:71], v[88:91], v[160:163]
  ds_read_b128 v[44:47], v9 offset:8192
  v_mfma_f32_16x16x32_bf16 v[124:127], v[64:67], v[88:91], v[124:127]
  ds_read_b128 v[48:51], v9 offset:10240
  v_mfma_f32_16x16x32_bf16 v[128:131], v[64:67], v[92:95], v[128:131]
  ds_read_b128 v[52:55], v9 offset:12288
  v_mfma_f32_16x16x32_bf16 v[164:167], v[68:71], v[92:95], v[164:167]
  ds_read_b128 v[56:59], v9 offset:14336
  v_mfma_f32_16x16x32_bf16 v[200:203], v[72:75], v[92:95], v[200:203]
  ds_read_b128 v[60:63], v9 offset:16384
  v_mfma_f32_16x16x32_bf16 v[204:207], v[72:75], v[96:99], v[204:207]
  v_mfma_f32_16x16x32_bf16 v[168:171], v[68:71], v[96:99], v[168:171]
  v_mfma_f32_16x16x32_bf16 v[132:135], v[64:67], v[96:99], v[132:135]
  v_mfma_f32_16x16x32_bf16 v[136:139], v[64:67], v[100:103], v[136:139]
  v_mfma_f32_16x16x32_bf16 v[172:175], v[68:71], v[100:103], v[172:175]
  v_mfma_f32_16x16x32_bf16 v[208:211], v[72:75], v[100:103], v[208:211]
  v_mfma_f32_16x16x32_bf16 v[212:215], v[72:75], v[104:107], v[212:215]
  v_mfma_f32_16x16x32_bf16 v[176:179], v[68:71], v[104:107], v[176:179]
  v_mfma_f32_16x16x32_bf16 v[140:143], v[64:67], v[104:107], v[140:143]
  v_mfma_f32_16x16x32_bf16 v[144:147], v[64:67], v[108:111], v[144:147]
  v_mfma_f32_16x16x32_bf16 v[180:183], v[68:71], v[108:111], v[180:183]
  v_mfma_f32_16x16x32_bf16 v[216:219], v[72:75], v[108:111], v[216:219]
  s_sub_u32 s39, s39, 1
  s_cmp_lg_u32 s39, 0
  s_cbranch_scc1 cl1
  s_waitcnt lgkmcnt(12)
  v_mfma_f32_16x16x32_bf16 v[112:115], v[16:19], v[28:31], v[112:115]
  ds_read_b64_tr_b16 v[64:65], v8 offset:4096
  s_waitcnt lgkmcnt(11)
  v_mfma_f32_16x16x32_bf16 v[148:151], v[20:23], v[28:31], v[148:151]
  ds_read_b64_tr_b16 v[66:67], v8 offset:4608
  s_waitcnt lgkmcnt(10)
  v_mfma_f32_16x16x32_bf16 v[184:187], v[24:27], v[28:31], v[184:187]
  ds_read_b128 v[76:79], v10 offset:0
  s_waitcnt lgkmcnt(10)
  v_mfma_f32_16x16x32_bf16 v[188:191], v[24:27], v[32:35], v[188:191]
  ds_read_b64_tr_b16 v[68:69], v8 offset:12288
  v_mfma_f32_16x16x32_bf16 v[152:155], v[20:23], v[32:35], v[152:155]
  ds_read_b64_tr_b16 v[70:71], v8 offset:12800
  v_mfma_f32_16x16x32_bf16 v[116:119], v[16:19], v[32:35], v[116:119]
  ds_read_b64_tr_b16 v[72:73], v8 offset:20480
  s_waitcnt lgkmcnt(12)
  v_mfma_f32_16x16x32_bf16 v[120:123], v[16:19], v[36:39], v[120:123]
  ds_read_b64_tr_b16 v[74:75], v8 offset:20992
  v_mfma_f32_16x16x32_bf16 v[156:159], v[20:23], v[36:39], v[156:159]
  ds_read_b128 v[80:83], v10 offset:2048
  v_mfma_f32_16x16x32_bf16 v[192:195], v[24:27], v[36:39], v[192:195]
  ds_read_b128 v[84:87], v10 offset:4096
  s_waitcnt lgkmcnt(14)
  v_mfma_f32_16x16x32_bf16 v[196:199], v[24:27], v[40:43], v[196:199]
  ds_read_b128 v[88:91], v10 offset:6144
  v_mfma_f32_16x16x32_bf16 v[160:163], v[20:23], v[40:43], v[160:163]
  ds_read_b128 v[92:95], v10 offset:8192
  v_mfma_f32_16x16x32_bf16 v[124:127], v[16:19], v[40:43], v[124:127]
  ds_read_b128 v[96:99], v10 offset:10240
  s_waitcnt lgkmcnt(15)
  v_mfma_f32_16x16x32_bf16 v[128:131], v[16:19], v[44:47], v[128:131]
  ds_read_b128 v[100:103], v10 offset:12288
  v_mfma_f32_16x16x32_bf16 v[164:167], v[20:23], v[44:47], v[164:167]
  ds_read_b128 v[104:107], v10 offset:14336
  v_mfma_f32_16x16x32_bf16 v[200:203], v[24:27], v[44:47], v[200:203]
  ds_read_b128 v[108:111], v10 offset:16384
  s_waitcnt lgkmcnt(15)
  v_mfma_f32_16x16x32_bf16 v[204:207], v[24:27], v[48:51], v[204:207]
  ds_read_b64 v[224:225], v12 offset:0
  v_mfma_f32_16x16x32_bf16 v[168:171], v[20:23], v[48:51], v[168:171]
  ds_read_b64 v[226:227], v12 offset:128
  v_mfma_f32_16x16x32_bf16 v[132:135], v[16:19], v[48:51], v[132:135]
  ds_read_b64 v[228:229], v12 offset:256
  s_waitcnt lgkmcnt(15)
  v_mfma_f32_16x16x32_bf16 v[136:139], v[16:19], v[52:55], v[136:139]
  ds_read_b64 v[230:231], v12 offset:384
  v_mfma_f32_16x16x32_bf16 v[172:175], v[20:23], v[52:55], v[172:175]
  ds_read_b64 v[232:233], v12 offset:512
  v_mfma_f32_16x16x32_bf16 v[208:211], v[24:27], v[52:55], v[208:211]
  ds_read_b64 v[234:235], v12 offset:640
  s_waitcnt lgkmcnt(15)
  v_mfma_f32_16x16x32_bf16 v[212:215], v[24:27], v[56:59], v[212:215]
  ds_read_b64 v[236:237], v12 offset:768
  v_mfma_f32_16x16x32_bf16 v[176:179], v[20:23], v[56:59], v[176:179]
  ds_read_b64 v[238:239], v12 offset:896
  v_mfma_f32_16x16x32_bf16 v[140:143], v[16:19], v[56:59], v[140:143]
  ds_read_b64 v[240:241], v12 offset:1024
  s_waitcnt lgkmcnt(15)
  v_mfma_f32_16x16x32_bf16 v[144:147], v[16:19], v[60:63], v[144:147]
  v_mfma_f32_16x16x32_bf16 v[180:183], v[20:23], v[60:63], v[180:183]
  v_mfma_f32_16x16x32_bf16 v[216:219], v[24:27], v[60:63], v[216:219]
  s_waitcnt lgkmcnt(0)
  v_mfma_f32_16x16x32_bf16 v[112:115], v[64:67], v[76:79], v[112:115]
  v_mfma_f32_16x16x32_bf16 v[148:151], v[68:71], v[76:79], v[148:151]
  v_mfma_f32_16x16x32_bf16 v[184:187], v[72:75], v[76:79], v[184:187]
  v_mfma_f32_16x16x32_bf16 v[188:191], v[72:75], v[80:83], v[188:191]
  s_nop 4
  v_mov_b32_dpp v242, v112 row_newbcast:0 row_mask:0xf bank_mask:0xf
  v_mov_b32_dpp v243, v113 row_newbcast:0 row_mask:0xf bank_mask:0xf
  v_mov_b32_dpp v244, v114 row_newbcast:0 row_mask:0xf bank_mask:0xf
  v_mov_b32_dpp v245, v115 row_newbcast:0 row_mask:0xf bank_mask:0xf
  v_mov_b32_dpp v246, v148 row_newbcast:0 row_mask:0xf bank_mask:0xf
  v_mov_b32_dpp v247, v149 row_newbcast:0 row_mask:0xf bank_mask:0xf
  v_mov_b32_dpp v248, v150 row_newbcast:0 row_mask:0xf bank_mask:0xf
  v_mfma_f32_16x16x32_bf16 v[152:155], v[68:71], v[80:83], v[152:155]
  v_mov_b32_dpp v249, v151 row_newbcast:0 row_mask:0xf bank_mask:0xf
  v_mov_b32_dpp v250, v184 row_newbcast:0 row_mask:0xf bank_mask:0xf
  v_mov_b32_dpp v251, v185 row_newbcast:0 row_mask:0xf bank_mask:0xf
  v_mov_b32_dpp v252, v186 row_newbcast:0 row_mask:0xf bank_mask:0xf
  v_mov_b32_dpp v253, v187 row_newbcast:0 row_mask:0xf bank_mask:0xf
  v_pk_fma_f32 v[148:149], v[246:247], v[224:225], v[148:149] op_sel_hi:[1,0,1] neg_lo:[0,1,0] neg_hi:[0,1,0]
  v_pk_fma_f32 v[150:151], v[248:249], v[224:225], v[150:151] op_sel_hi:[1,0,1] neg_lo:[0,1,0] neg_hi:[0,1,0]
  v_mfma_f32_16x16x32_bf16 v[116:119], v[64:67], v[80:83], v[116:119]
  v_pk_fma_f32 v[184:185], v[250:251], v[224:225], v[184:185] op_sel_hi:[1,0,1] neg_lo:[0,1,0] neg_hi:[0,1,0]
  v_pk_fma_f32 v[186:187], v[252:253], v[224:225], v[186:187] op_sel_hi:[1,0,1] neg_lo:[0,1,0] neg_hi:[0,1,0]
  v_pk_mul_f32 v[148:149], v[148:149], v[224:225] op_sel:[0,1] op_sel_hi:[1,1]
  v_pk_mul_f32 v[150:151], v[150:151], v[224:225] op_sel:[0,1] op_sel_hi:[1,1]
  v_pk_mul_f32 v[184:185], v[184:185], v[224:225] op_sel:[0,1] op_sel_hi:[1,1]
  v_pk_mul_f32 v[186:187], v[186:187], v[224:225] op_sel:[0,1] op_sel_hi:[1,1]
  v_cvt_pk_bf16_f32 v16, v148, v149
  v_mfma_f32_16x16x32_bf16 v[120:123], v[64:67], v[84:87], v[120:123]
  v_cvt_pk_bf16_f32 v17, v150, v151
  ds_write_b64 v11, v[16:17] offset:128
  v_cvt_pk_bf16_f32 v18, v184, v185
  v_cvt_pk_bf16_f32 v19, v186, v187
  ds_write_b64 v11, v[18:19] offset:256
  v_pk_fma_f32 v[116:117], v[242:243], v[226:227], v[116:117] op_sel_hi:[1,0,1] neg_lo:[0,1,0] neg_hi:[0,1,0]
  v_pk_fma_f32 v[118:119], v[244:245], v[226:227], v[118:119] op_sel_hi:[1,0,1] neg_lo:[0,1,0] neg_hi:[0,1,0]
  v_mfma_f32_16x16x32_bf16 v[156:159], v[68:71], v[84:87], v[156:159]
  v_pk_fma_f32 v[152:153], v[246:247], v[226:227], v[152:153] op_sel_hi:[1,0,1] neg_lo:[0,1,0] neg_hi:[0,1,0]
  v_pk_fma_f32 v[154:155], v[248:249], v[226:227], v[154:155] op_sel_hi:[1,0,1] neg_lo:[0,1,0] neg_hi:[0,1,0]
  v_pk_fma_f32 v[188:189], v[250:251], v[226:227], v[188:189] op_sel_hi:[1,0,1] neg_lo:[0,1,0] neg_hi:[0,1,0]
  v_pk_fma_f32 v[190:191], v[252:253], v[226:227], v[190:191] op_sel_hi:[1,0,1] neg_lo:[0,1,0] neg_hi:[0,1,0]
  v_pk_mul_f32 v[116:117], v[116:117], v[226:227] op_sel:[0,1] op_sel_hi:[1,1]
  v_pk_mul_f32 v[118:119], v[118:119], v[226:227] op_sel:[0,1] op_sel_hi:[1,1]
  v_pk_mul_f32 v[152:153], v[152:153], v[226:227] op_sel:[0,1] op_sel_hi:[1,1]
  v_mfma_f32_16x16x32_bf16 v[192:195], v[72:75], v[84:87], v[192:195]
  v_pk_mul_f32 v[154:155], v[154:155], v[226:227] op_sel:[0,1] op_sel_hi:[1,1]
  v_pk_mul_f32 v[188:189], v[188:189], v[226:227] op_sel:[0,1] op_sel_hi:[1,1]
  v_pk_mul_f32 v[190:191], v[190:191], v[226:227] op_sel:[0,1] op_sel_hi:[1,1]
  v_cvt_pk_bf16_f32 v22, v116, v117
  v_cvt_pk_bf16_f32 v23, v118, v119
  ds_write_b64 v11, v[22:23] offset:3200
  v_cvt_pk_bf16_f32 v24, v152, v153
  v_mfma_f32_16x16x32_bf16 v[196:199], v[72:75], v[88:91], v[196:199]
  v_cvt_pk_bf16_f32 v25, v154, v155
  ds_write_b64 v11, v[24:25] offset:3328
  v_cvt_pk_bf16_f32 v26, v188, v189
  v_cvt_pk_bf16_f32 v27, v190, v191
  ds_write_b64 v11, v[26:27] offset:3456
  v_pk_fma_f32 v[120:121], v[242:243], v[228:229], v[120:121] op_sel_hi:[1,0,1] neg_lo:[0,1,0] neg_hi:[0,1,0]
  v_pk_fma_f32 v[122:123], v[244:245], v[228:229], v[122:123] op_sel_hi:[1,0,1] neg_lo:[0,1,0] neg_hi:[0,1,0]
  v_mfma_f32_16x16x32_bf16 v[160:163], v[68:71], v[88:91], v[160:163]
  v_pk_fma_f32 v[156:157], v[246:247], v[228:229], v[156:157] op_sel_hi:[1,0,1] neg_lo:[0,1,0] neg_hi:[0,1,0]
  v_pk_fma_f32 v[158:159], v[248:249], v[228:229], v[158:159] op_sel_hi:[1,0,1] neg_lo:[0,1,0] neg_hi:[0,1,0]
  v_pk_fma_f32 v[192:193], v[250:251], v[228:229], v[192:193] op_sel_hi:[1,0,1] neg_lo:[0,1,0] neg_hi:[0,1,0]
  v_pk_fma_f32 v[194:195], v[252:253], v[228:229], v[194:195] op_sel_hi:[1,0,1] neg_lo:[0,1,0] neg_hi:[0,1,0]
  v_pk_mul_f32 v[120:121], v[120:121], v[228:229] op_sel:[0,1] op_sel_hi:[1,1]
  v_pk_mul_f32 v[122:123], v[122:123], v[228:229] op_sel:[0,1] op_sel_hi:[1,1]
  v_pk_mul_f32 v[156:157], v[156:157], v[228:229] op_sel:[0,1] op_sel_hi:[1,1]
  v_mfma_f32_16x16x32_bf16 v[124:127], v[64:67], v[88:91], v[124:127]
  v_pk_mul_f32 v[158:159], v[158:159], v[228:229] op_sel:[0,1] op_sel_hi:[1,1]
  v_pk_mul_f32 v[192:193], v[192:193], v[228:229] op_sel:[0,1] op_sel_hi:[1,1]
  v_pk_mul_f32 v[194:195], v[194:195], v[228:229] op_sel:[0,1] op_sel_hi:[1,1]
  v_cvt_pk_bf16_f32 v28, v120, v121
  v_cvt_pk_bf16_f32 v29, v122, v123
  ds_write_b64 v11, v[28:29] offset:6400
  v_cvt_pk_bf16_f32 v30, v156, v157
  v_mfma_f32_16x16x32_bf16 v[128:131], v[64:67], v[92:95], v[128:131]
  v_cvt_pk_bf16_f32 v31, v158, v159
  ds_write_b64 v11, v[30:31] offset:6528
  v_cvt_pk_bf16_f32 v32, v192, v193
  v_cvt_pk_bf16_f32 v33, v194, v195
  ds_write_b64 v11, v[32:33] offset:6656
  v_pk_fma_f32 v[124:125], v[242:243], v[230:231], v[124:125] op_sel_hi:[1,0,1] neg_lo:[0,1,0] neg_hi:[0,1,0]
  v_pk_fma_f32 v[126:127], v[244:245], v[230:231], v[126:127] op_sel_hi:[1,0,1] neg_lo:[0,1,0] neg_hi:[0,1,0]
  v_mfma_f32_16x16x32_bf16 v[164:167], v[68:71], v[92:95], v[164:167]
  v_pk_fma_f32 v[160:161], v[246:247], v[230:231], v[160:161] op_sel_hi:[1,0,1] neg_lo:[0,1,0] neg_hi:[0,1,0]
  v_pk_fma_f32 v[162:163], v[248:249], v[230:231], v[162:163] op_sel_hi:[1,0,1] neg_lo:[0,1,0] neg_hi:[0,1,0]
  v_pk_fma_f32 v[196:197], v[250:251], v[230:231], v[196:197] op_sel_hi:[1,0,1] neg_lo:[0,1,0] neg_hi:[0,1,0]
  v_pk_fma_f32 v[198:199], v[252:253], v[230:231], v[198:199] op_sel_hi:[1,0,1] neg_lo:[0,1,0] neg_hi:[0,1,0]
  v_pk_mul_f32 v[124:125], v[124:125], v[230:231] op_sel:[0,1] op_sel_hi:[1,1]
  v_pk_mul_f32 v[126:127], v[126:127], v[230:231] op_sel:[0,1] op_sel_hi:[1,1]
  v_pk_mul_f32 v[160:161], v[160:161], v[230:231] op_sel:[0,1] op_sel_hi:[1,1]
  v_mfma_f32_16x16x32_bf16 v[200:203], v[72:75], v[92:95], v[200:203]
  v_pk_mul_f32 v[162:163], v[162:163], v[230:231] op_sel:[0,1] op_sel_hi:[1,1]
  v_pk_mul_f32 v[196:197], v[196:197], v[230:231] op_sel:[0,1] op_sel_hi:[1,1]
  v_pk_mul_f32 v[198:199], v[198:199], v[230:231] op_sel:[0,1] op_sel_hi:[1,1]
  v_cvt_pk_bf16_f32 v34, v124, v125
  v_cvt_pk_bf16_f32 v35, v126, v127
  ds_write_b64 v11, v[34:35] offset:9600
  v_cvt_pk_bf16_f32 v36, v160, v161
  v_mfma_f32_16x16x32_bf16 v[204:207], v[72:75], v[96:99], v[204:207]
  v_cvt_pk_bf16_f32 v37, v162, v163
  ds_write_b64 v11, v[36:37] offset:9728
  v_cvt_pk_bf16_f32 v38, v196, v197
  v_cvt_pk_bf16_f32 v39, v198, v199
  ds_write_b64 v11, v[38:39] offset:9856
  v_pk_fma_f32 v[128:129], v[242:243], v[232:233], v[128:129] op_sel_hi:[1,0,1] neg_lo:[0,1,0] neg_hi:[0,1,0]
  v_pk_fma_f32 v[130:131], v[244:245], v[232:233], v[130:131] op_sel_hi:[1,0,1] neg_lo:[0,1,0] neg_hi:[0,1,0]
  v_mfma_f32_16x16x32_bf16 v[168:171], v[68:71], v[96:99], v[168:171]
  v_pk_fma_f32 v[164:165], v[246:247], v[232:233], v[164:165] op_sel_hi:[1,0,1] neg_lo:[0,1,0] neg_hi:[0,1,0]
  v_pk_fma_f32 v[166:167], v[248:249], v[232:233], v[166:167] op_sel_hi:[1,0,1] neg_lo:[0,1,0] neg_hi:[0,1,0]
  v_pk_fma_f32 v[200:201], v[250:251], v[232:233], v[200:201] op_sel_hi:[1,0,1] neg_lo:[0,1,0] neg_hi:[0,1,0]
  v_pk_fma_f32 v[202:203], v[252:253], v[232:233], v[202:203] op_sel_hi:[1,0,1] neg_lo:[0,1,0] neg_hi:[0,1,0]
  v_pk_mul_f32 v[128:129], v[128:129], v[232:233] op_sel:[0,1] op_sel_hi:[1,1]
  v_pk_mul_f32 v[130:131], v[130:131], v[232:233] op_sel:[0,1] op_sel_hi:[1,1]
  v_pk_mul_f32 v[164:165], v[164:165], v[232:233] op_sel:[0,1] op_sel_hi:[1,1]
  v_mfma_f32_16x16x32_bf16 v[132:135], v[64:67], v[96:99], v[132:135]
  v_pk_mul_f32 v[166:167], v[166:167], v[232:233] op_sel:[0,1] op_sel_hi:[1,1]
  v_pk_mul_f32 v[200:201], v[200:201], v[232:233] op_sel:[0,1] op_sel_hi:[1,1]
  v_pk_mul_f32 v[202:203], v[202:203], v[232:233] op_sel:[0,1] op_sel_hi:[1,1]
  v_cvt_pk_bf16_f32 v40, v128, v129
  v_cvt_pk_bf16_f32 v41, v130, v131
  ds_write_b64 v11, v[40:41] offset:12800
  v_cvt_pk_bf16_f32 v42, v164, v165
  v_mfma_f32_16x16x32_bf16 v[136:139], v[64:67], v[100:103], v[136:139]
  v_cvt_pk_bf16_f32 v43, v166, v167
  ds_write_b64 v11, v[42:43] offset:12928
  v_cvt_pk_bf16_f32 v44, v200, v201
  v_cvt_pk_bf16_f32 v45, v202, v203
  ds_write_b64 v11, v[44:45] offset:13056
  v_pk_fma_f32 v[132:133], v[242:243], v[234:235], v[132:133] op_sel_hi:[1,0,1] neg_lo:[0,1,0] neg_hi:[0,1,0]
  v_pk_fma_f32 v[134:135], v[244:245], v[234:235], v[134:135] op_sel_hi:[1,0,1] neg_lo:[0,1,0] neg_hi:[0,1,0]
  v_mfma_f32_16x16x32_bf16 v[172:175], v[68:71], v[100:103], v[172:175]
  v_pk_fma_f32 v[168:169], v[246:247], v[234:235], v[168:169] op_sel_hi:[1,0,1] neg_lo:[0,1,0] neg_hi:[0,1,0]
  v_pk_fma_f32 v[170:171], v[248:249], v[234:235], v[170:171] op_sel_hi:[1,0,1] neg_lo:[0,1,0] neg_hi:[0,1,0]
  v_pk_fma_f32 v[204:205], v[250:251], v[234:235], v[204:205] op_sel_hi:[1,0,1] neg_lo:[0,1,0] neg_hi:[0,1,0]
  v_pk_fma_f32 v[206:207], v[252:253], v[234:235], v[206:207] op_sel_hi:[1,0,1] neg_lo:[0,1,0] neg_hi:[0,1,0]
  v_pk_mul_f32 v[132:133], v[132:133], v[234:235] op_sel:[0,1] op_sel_hi:[1,1]
  v_pk_mul_f32 v[134:135], v[134:135], v[234:235] op_sel:[0,1] op_sel_hi:[1,1]
  v_pk_mul_f32 v[168:169], v[168:169], v[234:235] op_sel:[0,1] op_sel_hi:[1,1]
  v_mfma_f32_16x16x32_bf16 v[208:211], v[72:75], v[100:103], v[208:211]
  v_pk_mul_f32 v[170:171], v[170:171], v[234:235] op_sel:[0,1] op_sel_hi:[1,1]
  v_pk_mul_f32 v[204:205], v[204:205], v[234:235] op_sel:[0,1] op_sel_hi:[1,1]
  v_pk_mul_f32 v[206:207], v[206:207], v[234:235] op_sel:[0,1] op_sel_hi:[1,1]
  v_cvt_pk_bf16_f32 v46, v132, v133
  v_cvt_pk_bf16_f32 v47, v134, v135
  ds_write_b64 v11, v[46:47] offset:16000
  v_cvt_pk_bf16_f32 v48, v168, v169
  v_mfma_f32_16x16x32_bf16 v[212:215], v[72:75], v[104:107], v[212:215]
  v_cvt_pk_bf16_f32 v49, v170, v171
  ds_write_b64 v11, v[48:49] offset:16128
  v_cvt_pk_bf16_f32 v50, v204, v205
  v_cvt_pk_bf16_f32 v51, v206, v207
  ds_write_b64 v11, v[50:51] offset:16256
  v_pk_fma_f32 v[136:137], v[242:243], v[236:237], v[136:137] op_sel_hi:[1,0,1] neg_lo:[0,1,0] neg_hi:[0,1,0]
  v_pk_fma_f32 v[138:139], v[244:245], v[236:237], v[138:139] op_sel_hi:[1,0,1] neg_lo:[0,1,0] neg_hi:[0,1,0]
  v_mfma_f32_16x16x32_bf16 v[176:179], v[68:71], v[104:107], v[176:179]
  v_pk_fma_f32 v[172:173], v[246:247], v[236:237], v[172:173] op_sel_hi:[1,0,1] neg_lo:[0,1,0] neg_hi:[0,1,0]
  v_pk_fma_f32 v[174:175], v[248:249], v[236:237], v[174:175] op_sel_hi:[1,0,1] neg_lo:[0,1,0] neg_hi:[0,1,0]
  v_pk_fma_f32 v[208:209], v[250:251], v[236:237], v[208:209] op_sel_hi:[1,0,1] neg_lo:[0,1,0] neg_hi:[0,1,0]
  v_pk_fma_f32 v[210:211], v[252:253], v[236:237], v[210:211] op_sel_hi:[1,0,1] neg_lo:[0,1,0] neg_hi:[0,1,0]
  v_pk_mul_f32 v[136:137], v[136:137], v[236:237] op_sel:[0,1] op_sel_hi:[1,1]
  v_pk_mul_f32 v[138:139], v[138:139], v[236:237] op_sel:[0,1] op_sel_hi:[1,1]
  v_pk_mul_f32 v[172:173], v[172:173], v[236:237] op_sel:[0,1] op_sel_hi:[1,1]
  v_mfma_f32_16x16x32_bf16 v[140:143], v[64:67], v[104:107], v[140:143]
  v_pk_mul_f32 v[174:175], v[174:175], v[236:237] op_sel:[0,1] op_sel_hi:[1,1]
  v_pk_mul_f32 v[208:209], v[208:209], v[236:237] op_sel:[0,1] op_sel_hi:[1,1]
  v_pk_mul_f32 v[210:211], v[210:211], v[236:237] op_sel:[0,1] op_sel_hi:[1,1]
  v_cvt_pk_bf16_f32 v52, v136, v137
  v_cvt_pk_bf16_f32 v53, v138, v139
  ds_write_b64 v11, v[52:53] offset:19200
  v_cvt_pk_bf16_f32 v54, v172, v173
  v_mfma_f32_16x16x32_bf16 v[144:147], v[64:67], v[108:111], v[144:147]
  v_cvt_pk_bf16_f32 v55, v174, v175
  ds_write_b64 v11, v[54:55] offset:19328
  v_cvt_pk_bf16_f32 v56, v208, v209
  v_cvt_pk_bf16_f32 v57, v210, v211
  ds_write_b64 v11, v[56:57] offset:19456
  v_pk_fma_f32 v[140:141], v[242:243], v[238:239], v[140:141] op_sel_hi:[1,0,1] neg_lo:[0,1,0] neg_hi:[0,1,0]
  v_pk_fma_f32 v[142:143], v[244:245], v[238:239], v[142:143] op_sel_hi:[1,0,1] neg_lo:[0,1,0] neg_hi:[0,1,0]
  v_mfma_f32_16x16x32_bf16 v[180:183], v[68:71], v[108:111], v[180:183]
  v_pk_fma_f32 v[176:177], v[246:247], v[238:239], v[176:177] op_sel_hi:[1,0,1] neg_lo:[0,1,0] neg_hi:[0,1,0]
  v_pk_fma_f32 v[178:179], v[248:249], v[238:239], v[178:179] op_sel_hi:[1,0,1] neg_lo:[0,1,0] neg_hi:[0,1,0]
  v_pk_fma_f32 v[212:213], v[250:251], v[238:239], v[212:213] op_sel_hi:[1,0,1] neg_lo:[0,1,0] neg_hi:[0,1,0]
  v_pk_fma_f32 v[214:215], v[252:253], v[238:239], v[214:215] op_sel_hi:[1,0,1] neg_lo:[0,1,0] neg_hi:[0,1,0]
  v_pk_mul_f32 v[140:141], v[140:141], v[238:239] op_sel:[0,1] op_sel_hi:[1,1]
  v_pk_mul_f32 v[142:143], v[142:143], v[238:239] op_sel:[0,1] op_sel_hi:[1,1]
  v_pk_mul_f32 v[176:177], v[176:177], v[238:239] op_sel:[0,1] op_sel_hi:[1,1]
  v_mfma_f32_16x16x32_bf16 v[216:219], v[72:75], v[108:111], v[216:219]
  v_pk_mul_f32 v[178:179], v[178:179], v[238:239] op_sel:[0,1] op_sel_hi:[1,1]
  v_pk_mul_f32 v[212:213], v[212:213], v[238:239] op_sel:[0,1] op_sel_hi:[1,1]
  v_pk_mul_f32 v[214:215], v[214:215], v[238:239] op_sel:[0,1] op_sel_hi:[1,1]
  v_cvt_pk_bf16_f32 v58, v140, v141
  v_cvt_pk_bf16_f32 v59, v142, v143
  ds_write_b64 v11, v[58:59] offset:22400
  v_cvt_pk_bf16_f32 v60, v176, v177
  s_barrier
  v_cvt_pk_bf16_f32 v61, v178, v179
  ds_write_b64 v11, v[60:61] offset:22528
  v_cvt_pk_bf16_f32 v62, v212, v213
  v_cvt_pk_bf16_f32 v63, v214, v215
  ds_write_b64 v11, v[62:63] offset:22656
  v_pk_fma_f32 v[144:145], v[242:243], v[240:241], v[144:145] op_sel_hi:[1,0,1] neg_lo:[0,1,0] neg_hi:[0,1,0]
  v_pk_fma_f32 v[146:147], v[244:245], v[240:241], v[146:147] op_sel_hi:[1,0,1] neg_lo:[0,1,0] neg_hi:[0,1,0]
  v_pk_fma_f32 v[180:181], v[246:247], v[240:241], v[180:181] op_sel_hi:[1,0,1] neg_lo:[0,1,0] neg_hi:[0,1,0]
  v_pk_fma_f32 v[182:183], v[248:249], v[240:241], v[182:183] op_sel_hi:[1,0,1] neg_lo:[0,1,0] neg_hi:[0,1,0]
  v_pk_fma_f32 v[216:217], v[250:251], v[240:241], v[216:217] op_sel_hi:[1,0,1] neg_lo:[0,1,0] neg_hi:[0,1,0]
  v_pk_fma_f32 v[218:219], v[252:253], v[240:241], v[218:219] op_sel_hi:[1,0,1] neg_lo:[0,1,0] neg_hi:[0,1,0]
  v_pk_mul_f32 v[144:145], v[144:145], v[240:241] op_sel:[0,1] op_sel_hi:[1,1]
  v_pk_mul_f32 v[146:147], v[146:147], v[240:241] op_sel:[0,1] op_sel_hi:[1,1]
  v_pk_mul_f32 v[180:181], v[180:181], v[240:241] op_sel:[0,1] op_sel_hi:[1,1]
  v_pk_mul_f32 v[182:183], v[182:183], v[240:241] op_sel:[0,1] op_sel_hi:[1,1]
  v_pk_mul_f32 v[216:217], v[216:217], v[240:241] op_sel:[0,1] op_sel_hi:[1,1]
  v_pk_mul_f32 v[218:219], v[218:219], v[240:241] op_sel:[0,1] op_sel_hi:[1,1]
  v_cvt_pk_bf16_f32 v16, v144, v145
  v_cvt_pk_bf16_f32 v17, v146, v147
  ds_write_b64 v11, v[16:17] offset:25600
  v_cvt_pk_bf16_f32 v18, v180, v181
  v_cvt_pk_bf16_f32 v19, v182, v183
  ds_write_b64 v11, v[18:19] offset:25728
  v_cvt_pk_bf16_f32 v20, v216, v217
  v_cvt_pk_bf16_f32 v21, v218, v219
  ds_write_b64 v11, v[20:21] offset:25856
attn:
  s_nop 7
  s_nop 7
  s_mov_b32 s20, s82
  s_mov_b32 s21, s83
  s_mov_b32 s22, 4194304
  s_mov_b32 s23, 0x20000
  s_lshr_b32 s40, s4, 1
  s_and_b32 s41, s4, 1
  s_mul_i32 s32, s41, 28800
  s_add_u32 s32, s32, 43008
  s_lshl_b32 s49, s40, 4
  v_add_u32 v16, s49, v4
  v_lshlrev_b32 v17, 4, v5
  v_add_u32 v17, s32, v17
  v_mul_u32_u24 v18, 400, v16
  v_add_u32 v8, v18, v17
  v_add_u32 v10, 3200, v8
  v_add_u32 v8, 128, v8
  v_add_u32 v16, 16, v16
  v_min_u32 v16, 71, v16
  v_mul_u32_u24 v18, 400, v16
  v_add3_u32 v9, v18, v17, 64
  v_add_u32 v9, 64, v9
  v_lshl_add_u32 v16, v5, 2, v6
  v_add_u32 v16, s49, v16
  v_lshlrev_b32 v17, 4, v7
  v_add_u32 v17, s32, v17
  v_add_u32 v17, 256, v17
  v_mul_u32_u24 v18, 400, v16
  v_add_u32 v14, v18, v17
  v_add_u32 v16, 16, v16
  v_min_u32 v16, 71, v16
  v_mul_u32_u24 v18, 400, v16
  v_add_u32 v15, v18, v17
  v_lshlrev_b32 v13, 4, v0
  s_lshl_b32 s50, s28, 2
  s_add_u32 s50, s50, s40
  s_lshl_b32 s50, s50, 16
  s_lshl_b32 s51, s29, 12
  s_add_u32 s50, s50, s51
  s_lshl_b32 s51, s41, 10
  s_add_u32 s50, s50, s51
  v_lshlrev_b32 v16, 2, v5
  v_sub_u32 v16, v16, v4
  s_or_b32 s51, s28, s40
  s_cmp_eq_u32 s51, 0
  s_cselect_b32 s51, 0, -1
  v_add_u32 v17, -1, v16
  v_cmp_gt_u32 s[86:87], 8, v17
  v_add_u32 v17, 0, v16
  v_cmp_gt_u32 s[88:89], 8, v17
  v_add_u32 v17, 1, v16
  v_cmp_gt_u32 s[90:91], 8, v17
  v_add_u32 v17, 2, v16
  v_cmp_gt_u32 s[92:93], 8, v17
  v_add_u32 v17, 15, v16
  v_cmp_gt_u32 s[94:95], 8, v17
  v_add_u32 v17, 16, v16
  v_cmp_gt_u32 s[96:97], 8, v17
  v_add_u32 v17, 17, v16
  v_cmp_gt_u32 s[98:99], 8, v17
  v_add_u32 v17, 18, v16
  v_cmp_gt_u32 s[100:101], 8, v17
  s_and_b32 s86, s86, s51
  s_and_b32 s88, s88, s51
  s_and_b32 s90, s90, s51
  s_and_b32 s92, s92, s51
  v_mov_b32 v18, 0x3e8293ee
  v_mov_b32 v19, 0xff800000
  s_waitcnt lgkmcnt(0)
  s_barrier
  ds_read_b128 v[32:35], v10 offset:0
  ds_read_b128 v[36:39], v8 offset:0
  ds_read_b128 v[40:43], v9 offset:0
  ds_read_b128 v[80:83], v10 offset:64
  ds_read_b128 v[84:87], v8 offset:64
  ds_read_b128 v[88:91], v9 offset:64
  ds_read_b64_tr_b16 v[44:45], v14 offset:0
  ds_read_b64_tr_b16 v[46:47], v15 offset:0
  ds_read_b64_tr_b16 v[48:49], v14 offset:8
  ds_read_b64_tr_b16 v[50:51], v15 offset:8
  ds_read_b64_tr_b16 v[92:93], v14 offset:64
  ds_read_b64_tr_b16 v[94:95], v15 offset:64
  ds_read_b64_tr_b16 v[96:97], v14 offset:72
  ds_read_b64_tr_b16 v[98:99], v15 offset:72
  s_waitcnt lgkmcnt(11)
  v_mfma_f32_16x16x32_bf16 v[52:55], v[36:39], v[32:35], 0
  v_mfma_f32_16x16x32_bf16 v[56:59], v[40:43], v[32:35], 0
  s_waitcnt lgkmcnt(8)
  v_mfma_f32_16x16x32_bf16 v[100:103], v[84:87], v[80:83], 0
  v_mfma_f32_16x16x32_bf16 v[104:107], v[88:91], v[80:83], 0
  s_nop 3
  v_cndmask_b32 v52, v19, v52, s[86:87]
  s_nop 1
  v_cndmask_b32 v100, v19, v100, s[86:87]
  v_cndmask_b32 v53, v19, v53, s[88:89]
  v_cndmask_b32 v101, v19, v101, s[88:89]
  v_cndmask_b32 v54, v19, v54, s[90:91]
  v_cndmask_b32 v102, v19, v102, s[90:91]
  v_cndmask_b32 v55, v19, v55, s[92:93]
  v_cndmask_b32 v103, v19, v103, s[92:93]
  v_cndmask_b32 v56, v19, v56, s[94:95]
  v_cndmask_b32 v104, v19, v104, s[94:95]
  v_cndmask_b32 v57, v19, v57, s[96:97]
  v_cndmask_b32 v105, v19, v105, s[96:97]
  v_cndmask_b32 v58, v19, v58, s[98:99]
  v_cndmask_b32 v106, v19, v106, s[98:99]
  v_cndmask_b32 v59, v19, v59, s[100:101]
  v_cndmask_b32 v107, v19, v107, s[100:101]
  v_max3_f32 v60, v52, v53, v54
  v_max3_f32 v108, v100, v101, v102
  v_max3_f32 v61, v55, v56, v57
  v_max3_f32 v109, v103, v104, v105
  v_max3_f32 v60, v60, v58, v59
  v_max3_f32 v108, v108, v106, v107
  v_max_f32 v60, v60, v61
  v_max_f32 v108, v108, v109
  v_mov_b32 v61, v60
  v_mov_b32 v109, v108
  s_nop 0
  v_permlane16_swap_b32 v60, v61
  v_permlane16_swap_b32 v108, v109
  v_max_f32 v60, v60, v61
  v_max_f32 v108, v108, v109
  v_mov_b32 v61, v60
  v_mov_b32 v109, v108
  s_nop 0
  v_permlane32_swap_b32 v60, v61
  v_permlane32_swap_b32 v108, v109
  v_max_f32 v60, v60, v61
  v_max_f32 v108, v108, v109
  v_mul_f32 v60, v18, v60
  v_mul_f32 v108, v18, v108
  v_fma_f32 v52, v52, v18, -v60
  v_fma_f32 v100, v100, v18, -v108
  v_fma_f32 v53, v53, v18, -v60
  v_fma_f32 v101, v101, v18, -v108
  v_fma_f32 v54, v54, v18, -v60
  v_fma_f32 v102, v102, v18, -v108
  v_fma_f32 v55, v55, v18, -v60
  v_fma_f32 v103, v103, v18, -v108
  v_fma_f32 v56, v56, v18, -v60
  v_fma_f32 v104, v104, v18, -v108
  v_fma_f32 v57, v57, v18, -v60
  v_fma_f32 v105, v105, v18, -v108
  v_fma_f32 v58, v58, v18, -v60
  v_fma_f32 v106, v106, v18, -v108
  v_fma_f32 v59, v59, v18, -v60
  v_fma_f32 v107, v107, v18, -v108
  v_exp_f32 v52, v52
  v_exp_f32 v100, v100
  v_exp_f32 v53, v53
  v_exp_f32 v101, v101
  v_exp_f32 v54, v54
  v_exp_f32 v102, v102
  v_exp_f32 v55, v55
  v_exp_f32 v103, v103
  v_exp_f32 v56, v56
  v_exp_f32 v104, v104
  v_exp_f32 v57, v57
  v_exp_f32 v105, v105
  v_exp_f32 v58, v58
  v_exp_f32 v106, v106
  v_exp_f32 v59, v59
  v_exp_f32 v107, v107
  v_pk_add_f32 v[60:61], v[52:53], v[54:55]
  v_pk_add_f32 v[108:109], v[100:101], v[102:103]
  v_pk_add_f32 v[62:63], v[56:57], v[58:59]
  v_pk_add_f32 v[110:111], v[104:105], v[106:107]
  v_pk_add_f32 v[60:61], v[60:61], v[62:63]
  v_pk_add_f32 v[108:109], v[108:109], v[110:111]
  v_add_f32 v60, v60, v61
  v_add_f32 v108, v108, v109
  v_mov_b32 v61, v60
  v_mov_b32 v109, v108
  s_nop 0
  v_permlane16_swap_b32 v60, v61
  v_permlane16_swap_b32 v108, v109
  v_add_f32 v60, v60, v61
  v_add_f32 v108, v108, v109
  v_mov_b32 v61, v60
  v_mov_b32 v109, v108
  s_nop 0
  v_permlane32_swap_b32 v60, v61
  v_permlane32_swap_b32 v108, v109
  v_add_f32 v60, v60, v61
  v_add_f32 v108, v108, v109
  v_rcp_f32 v60, v60
  v_rcp_f32 v108, v108
  v_pk_mul_f32 v[52:53], v[52:53], v[60:61] op_sel_hi:[1,0]
  v_pk_mul_f32 v[100:101], v[100:101], v[108:109] op_sel_hi:[1,0]
  v_pk_mul_f32 v[54:55], v[54:55], v[60:61] op_sel_hi:[1,0]
  v_pk_mul_f32 v[102:103], v[102:103], v[108:109] op_sel_hi:[1,0]
  v_pk_mul_f32 v[56:57], v[56:57], v[60:61] op_sel_hi:[1,0]
  v_pk_mul_f32 v[104:105], v[104:105], v[108:109] op_sel_hi:[1,0]
  v_pk_mul_f32 v[58:59], v[58:59], v[60:61] op_sel_hi:[1,0]
  v_pk_mul_f32 v[106:107], v[106:107], v[108:109] op_sel_hi:[1,0]
  v_cvt_pk_bf16_f32 v64, v52, v53
  v_cvt_pk_bf16_f32 v112, v100, v101
  v_cvt_pk_bf16_f32 v65, v54, v55
  v_cvt_pk_bf16_f32 v113, v102, v103
  v_cvt_pk_bf16_f32 v66, v56, v57
  v_cvt_pk_bf16_f32 v114, v104, v105
  v_cvt_pk_bf16_f32 v67, v58, v59
  v_cvt_pk_bf16_f32 v115, v106, v107
  s_waitcnt lgkmcnt(0)
  v_mfma_f32_16x16x32_bf16 v[68:71], v[44:47], v[64:67], 0
  v_mfma_f32_16x16x32_bf16 v[116:119], v[92:95], v[112:115], 0
  v_mfma_f32_16x16x32_bf16 v[72:75], v[48:51], v[64:67], 0
  v_mfma_f32_16x16x32_bf16 v[120:123], v[96:99], v[112:115], 0
  s_nop 4
  v_cvt_pk_bf16_f32 v32, v68, v69
  v_cvt_pk_bf16_f32 v80, v116, v117
  v_cvt_pk_bf16_f32 v33, v70, v71
  v_cvt_pk_bf16_f32 v81, v118, v119
  v_cvt_pk_bf16_f32 v34, v72, v73
  v_cvt_pk_bf16_f32 v82, v120, v121
  v_cvt_pk_bf16_f32 v35, v74, v75
  v_cvt_pk_bf16_f32 v83, v122, v123
  buffer_store_dwordx4 v[32:35], v13, s[20:23], s50 offen offset:0 sc0 sc1
  buffer_store_dwordx4 v[80:83], v13, s[20:23], s50 offen offset:2048 sc0 sc1
  s_cmp_ge_u32 s4, 4
  s_cbranch_scc1 L_k1done
  s_lshl_b32 s32, s28, 2
  s_add_u32 s32, s32, s4
  s_lshl_b32 s34, s32, 16
  s_lshl_b32 s40, s32, 5
  v_lshlrev_b32 v13, 1, v4
  v_add_u32 v13, s40, v13
  v_lshlrev_b32 v12, 11, v13
  v_lshl_add_u32 v12, v3, 4, v12
  s_lshl_b32 s32, s29, 7
  v_add_u32 v12, s32, v12
  v_lshlrev_b32 v14, 4, v0
  s_mov_b32 s8, s82
  s_mov_b32 s9, s83
  s_mov_b32 s10, 4194304
  s_mov_b32 s11, 0x20000
  s_cmp_eq_u32 s3, 0
  s_cselect_b32 s16, s64, s84
  s_cselect_b32 s17, s65, s85
  s_cselect_b32 s18, 0, 25165824
  s_add_u32 s16, s16, s18
  s_addc_u32 s17, s17, 0
  s_mov_b32 s18, 4194304
  s_mov_b32 s19, 0x20000
  s_cmp_eq_u32 s3, 0
  s_cselect_b32 s12, s84, s84
  s_cselect_b32 s13, s85, s85
  s_cselect_b32 s14, 0, 33554432
  s_add_u32 s12, s12, s14
  s_addc_u32 s13, s13, 0
  s_mov_b32 s14, 0
  s_mov_b32 s15, 0x20000
  s_add_u32 s12, s12, 20971520
  s_addc_u32 s13, s13, 0
  s_mov_b32 s14, 262144
  v_lshl_add_u32 v16, v5, 3, v6
  v_lshlrev_b32 v16, 7, v16
  v_lshl_add_u32 v16, v7, 3, v16
  v_lshrrev_b32 v17, 1, v6
  v_lshl_or_b32 v17, v2, 1, v17
  v_lshl_add_u32 v16, v17, 5, v16
  v_add_u32 v16, 131072, v16
  v_xor_b32 v8, 0, v16
  v_xor_b32 v9, 32, v16
  v_xor_b32 v10, 64, v16
  v_xor_b32 v11, 96, v16
  v_add_u32 v16, v13, v2
  v_lshlrev_b32 v16, 3, v16
  s_lshl_b32 s32, s29, 14
  v_add_u32 v112, s32, v16
  v_lshrrev_b32 v17, 5, v0
  v_lshlrev_b32 v17, 17, v17
  v_add_u32 v113, v16, v17
  s_lshl_b32 s32, s4, 12
  v_lshlrev_b32 v16, 8, v4
  v_lshl_add_u32 v16, v5, 3, v16
  v_add_u32 v16, s32, v16
  v_and_b32 v17, 1, v4
  v_bfe_u32 v18, v4, 2, 1
  v_lshl_or_b32 v17, v18, 1, v17
  v_lshl_add_u32 v114, v17, 5, v16
  s_lshl_b32 s44, s29, 8
  s_lshl_b32 s40, s28, 2
  s_add_u32 s44, s44, s40
  s_add_u32 s44, s44, s4
  s_lshl_b32 s44, s44, 10
  v_lshl_add_u32 v16, v5, 3, v6
  v_lshlrev_b32 v16, 7, v16
  v_lshl_add_u32 v16, v7, 3, v16
  v_lshrrev_b32 v17, 1, v6
  v_lshl_or_b32 v17, v2, 1, v17
  v_lshl_add_u32 v16, v17, 5, v16
  v_xor_b32 v115, 0, v16
  v_add_u32 v115, s32, v115
  s_add_u32 s45, s44, 65536
  s_add_u32 s46, s44, 131072
  s_add_u32 s47, s44, 196608
  s_mov_b32 s87, 16384
  s_mov_b32 s88, 32768
  s_mov_b32 s89, 49152
  s_mov_b32 s90, 65536
  s_mov_b32 s91, 81920
  s_mov_b32 s92, 98304
  s_mov_b32 s93, 114688
  s_lshl_b32 s48, 0x303, s7
  s_lshr_b32 s48, s48, 8
  s_mov_b32 s49, s34
  s_add_u32 s50, s34, 32768
  s_add_u32 s41, s34, 65536
  s_add_u32 s24, s84, 29360128
  s_addc_u32 s25, s85, 0
  s_mov_b32 s26, 262144
  s_mov_b32 s27, 0x20000
  s_lshl_b32 s32, s28, 4
  v_min_u32 v119, 15, v0
  v_add_u32 v119, s32, v119
  v_max_i32 v119, 0, v119
  v_lshlrev_b32 v119, 7, v119
  s_lshl_b32 s55, s3, 17
  s_add_u32 s55, s55, 0
  s_waitcnt vmcnt(0)
  s_barrier
  s_mov_b32 s39, 0
  s_and_b32 s32, s4, 3
  s_cmp_lg_u32 s32, 0
  s_cbranch_scc1 poll2d
  s_sleep 8
poll2:
  buffer_load_dword v16, v119, s[24:27], s55 offen sc0 sc1
  s_waitcnt vmcnt(0)
  v_cmp_eq_u32 vcc, 0, v16
  s_add_u32 s39, s39, 1
  s_cmp_gt_u32 s39, 100000
  s_cbranch_scc1 poll2d
  s_cbranch_vccnz poll2
poll2d:
  s_barrier
  buffer_load_dwordx4 v[96:99], v12, s[16:19], 0 offen offset:0 sc1
  buffer_load_dwordx4 v[100:103], v12, s[16:19], 0 offen offset:64 sc1
  buffer_load_dwordx4 v[104:107], v12, s[16:19], 0 offen offset:2048 sc1
  buffer_load_dwordx4 v[108:111], v12, s[16:19], 0 offen offset:2112 sc1
  s_bitcmp1_b32 s48, 0
  s_cselect_b32 s36, s50, s49
  s_add_u32 s36, s36, 0
  buffer_load_dwordx4 v[120:123], v14, s[8:11], s36 offen offset:0 sc1
  buffer_load_dwordx4 v[124:127], v14, s[8:11], s36 offen offset:1024 sc1
  buffer_load_dwordx4 v[128:131], v14, s[8:11], s36 offen offset:2048 sc1
  buffer_load_dwordx4 v[132:135], v14, s[8:11], s36 offen offset:3072 sc1
  s_bitcmp1_b32 s48, 1
  s_cselect_b32 s36, s50, s49
  s_add_u32 s36, s36, 4096
  buffer_load_dwordx4 v[136:139], v14, s[8:11], s36 offen offset:0 sc1
  buffer_load_dwordx4 v[140:143], v14, s[8:11], s36 offen offset:1024 sc1
  buffer_load_dwordx4 v[144:147], v14, s[8:11], s36 offen offset:2048 sc1
  buffer_load_dwordx4 v[148:151], v14, s[8:11], s36 offen offset:3072 sc1
  s_waitcnt vmcnt(8)
  v_permlane16_swap_b32 v96, v98
  v_permlane16_swap_b32 v97, v99
  v_permlane16_swap_b32 v100, v102
  v_permlane16_swap_b32 v101, v103
  v_permlane16_swap_b32 v104, v106
  v_permlane16_swap_b32 v105, v107
  v_permlane16_swap_b32 v108, v110
  v_permlane16_swap_b32 v109, v111
  v_lshlrev_b32 v48, 16, v96
  v_and_b32 v49, 0xffff0000, v96
  v_lshlrev_b32 v50, 16, v97
  v_and_b32 v51, 0xffff0000, v97
  v_lshlrev_b32 v52, 16, v98
  v_and_b32 v53, 0xffff0000, v98
  v_lshlrev_b32 v54, 16, v99
  v_and_b32 v55, 0xffff0000, v99
  v_lshlrev_b32 v56, 16, v100
  v_and_b32 v57, 0xffff0000, v100
  v_lshlrev_b32 v58, 16, v101
  v_and_b32 v59, 0xffff0000, v101
  v_lshlrev_b32 v60, 16, v102
  v_and_b32 v61, 0xffff0000, v102
  v_lshlrev_b32 v62, 16, v103
  v_and_b32 v63, 0xffff0000, v103
  v_lshlrev_b32 v64, 16, v104
  v_and_b32 v65, 0xffff0000, v104
  v_lshlrev_b32 v66, 16, v105
  v_and_b32 v67, 0xffff0000, v105
  v_lshlrev_b32 v68, 16, v106
  v_and_b32 v69, 0xffff0000, v106
  v_lshlrev_b32 v70, 16, v107
  v_and_b32 v71, 0xffff0000, v107
  v_lshlrev_b32 v72, 16, v108
  v_and_b32 v73, 0xffff0000, v108
  v_lshlrev_b32 v74, 16, v109
  v_and_b32 v75, 0xffff0000, v109
  v_lshlrev_b32 v76, 16, v110
  v_and_b32 v77, 0xffff0000, v110
  v_lshlrev_b32 v78, 16, v111
  v_and_b32 v79, 0xffff0000, v111
  s_bitcmp1_b32 s48, 2
  s_cselect_b32 s36, s50, s49
  s_add_u32 s36, s36, 8192
  buffer_load_dwordx4 v[152:155], v14, s[8:11], s36 offen offset:0 sc1
  buffer_load_dwordx4 v[156:159], v14, s[8:11], s36 offen offset:1024 sc1
  buffer_load_dwordx4 v[160:163], v14, s[8:11], s36 offen offset:2048 sc1
  buffer_load_dwordx4 v[164:167], v14, s[8:11], s36 offen offset:3072 sc1
  s_bitcmp1_b32 s48, 3
  s_cselect_b32 s36, s50, s49
  s_add_u32 s36, s36, 12288
  buffer_load_dwordx4 v[168:171], v14, s[8:11], s36 offen offset:0 sc1
  buffer_load_dwordx4 v[172:175], v14, s[8:11], s36 offen offset:1024 sc1
  s_mov_b32 s43, 0
  s_mov_b32 s39, 1
  s_barrier
  ds_read_b64_tr_b16 v[16:17], v8 offset:0
  ds_read_b64_tr_b16 v[18:19], v8 offset:512
  ds_read_b64_tr_b16 v[20:21], v9 offset:0
  ds_read_b64_tr_b16 v[22:23], v9 offset:512
  ds_read_b64_tr_b16 v[24:25], v10 offset:0
  ds_read_b64_tr_b16 v[26:27], v10 offset:512
  ds_read_b64_tr_b16 v[28:29], v11 offset:0
  ds_read_b64_tr_b16 v[30:31], v11 offset:512
  s_waitcnt vmcnt(13) lgkmcnt(6)
  v_mfma_f32_16x16x32_bf16 v[48:51], v[16:19], v[120:123], v[48:51]
  ds_read_b64_tr_b16 v[32:33], v8 offset:4096
  s_waitcnt vmcnt(12)
  v_mfma_f32_16x16x32_bf16 v[64:67], v[16:19], v[124:127], v[64:67]
  ds_read_b64_tr_b16 v[34:35], v8 offset:4608
  v_add_u32 v8, 8192, v8
  s_waitcnt lgkmcnt(6)
  v_mfma_f32_16x16x32_bf16 v[68:71], v[20:23], v[124:127], v[68:71]
  ds_read_b64_tr_b16 v[36:37], v9 offset:4096
  buffer_load_dwordx4 v[176:179], v14, s[8:11], s36 offen offset:2048 sc1
  v_mfma_f32_16x16x32_bf16 v[52:55], v[20:23], v[120:123], v[52:55]
  ds_read_b64_tr_b16 v[38:39], v9 offset:4608
  v_add_u32 v9, 8192, v9
  s_waitcnt lgkmcnt(6)
  v_mfma_f32_16x16x32_bf16 v[56:59], v[24:27], v[120:123], v[56:59]
  ds_read_b64_tr_b16 v[40:41], v10 offset:4096
  v_mfma_f32_16x16x32_bf16 v[72:75], v[24:27], v[124:127], v[72:75]
  ds_read_b64_tr_b16 v[42:43], v10 offset:4608
  v_add_u32 v10, 8192, v10
  s_waitcnt lgkmcnt(6)
  v_mfma_f32_16x16x32_bf16 v[76:79], v[28:31], v[124:127], v[76:79]
  ds_read_b64_tr_b16 v[44:45], v11 offset:4096
  buffer_load_dwordx4 v[180:183], v14, s[8:11], s36 offen offset:3072 sc1
  v_mfma_f32_16x16x32_bf16 v[60:63], v[28:31], v[120:123], v[60:63]
  ds_read_b64_tr_b16 v[46:47], v11 offset:4608
  v_add_u32 v11, 8192, v11
  s_waitcnt vmcnt(13) lgkmcnt(6)
  v_mfma_f32_16x16x32_bf16 v[48:51], v[32:35], v[128:131], v[48:51]
  ds_read_b64_tr_b16 v[16:17], v8 offset:0
  s_bitcmp1_b32 s48, 4
  s_cselect_b32 s36, s50, s49
  s_waitcnt vmcnt(12)
  v_mfma_f32_16x16x32_bf16 v[64:67], v[32:35], v[132:135], v[64:67]
  ds_read_b64_tr_b16 v[18:19], v8 offset:512
  s_add_u32 s36, s36, 16384
  s_waitcnt lgkmcnt(6)
  v_mfma_f32_16x16x32_bf16 v[68:71], v[36:39], v[132:135], v[68:71]
  ds_read_b64_tr_b16 v[20:21], v9 offset:0
  v_mfma_f32_16x16x32_bf16 v[52:55], v[36:39], v[128:131], v[52:55]
  ds_read_b64_tr_b16 v[22:23], v9 offset:512
  s_waitcnt lgkmcnt(6)
  v_mfma_f32_16x16x32_bf16 v[56:59], v[40:43], v[128:131], v[56:59]
  ds_read_b64_tr_b16 v[24:25], v10 offset:0
  buffer_load_dwordx4 v[120:123], v14, s[8:11], s36 offen offset:0 sc1
  v_mfma_f32_16x16x32_bf16 v[72:75], v[40:43], v[132:135], v[72:75]
  ds_read_b64_tr_b16 v[26:27], v10 offset:512
  s_waitcnt lgkmcnt(6)
  v_mfma_f32_16x16x32_bf16 v[76:79], v[44:47], v[132:135], v[76:79]
  ds_read_b64_tr_b16 v[28:29], v11 offset:0
  v_mfma_f32_16x16x32_bf16 v[60:63], v[44:47], v[128:131], v[60:63]
  ds_read_b64_tr_b16 v[30:31], v11 offset:512
  buffer_load_dwordx4 v[124:127], v14, s[8:11], s36 offen offset:1024 sc1
  s_waitcnt vmcnt(13) lgkmcnt(6)
  v_mfma_f32_16x16x32_bf16 v[48:51], v[16:19], v[136:139], v[48:51]
  ds_read_b64_tr_b16 v[32:33], v8 offset:4096
  s_waitcnt vmcnt(12)
  v_mfma_f32_16x16x32_bf16 v[64:67], v[16:19], v[140:143], v[64:67]
  ds_read_b64_tr_b16 v[34:35], v8 offset:4608
  v_add_u32 v8, 8192, v8
  s_waitcnt lgkmcnt(6)
  v_mfma_f32_16x16x32_bf16 v[68:71], v[20:23], v[140:143], v[68:71]
  ds_read_b64_tr_b16 v[36:37], v9 offset:4096
  buffer_load_dwordx4 v[128:131], v14, s[8:11], s36 offen offset:2048 sc1
  v_mfma_f32_16x16x32_bf16 v[52:55], v[20:23], v[136:139], v[52:55]
  ds_read_b64_tr_b16 v[38:39], v9 offset:4608
  v_add_u32 v9, 8192, v9
  s_waitcnt lgkmcnt(6)
  v_mfma_f32_16x16x32_bf16 v[56:59], v[24:27], v[136:139], v[56:59]
  ds_read_b64_tr_b16 v[40:41], v10 offset:4096
  v_mfma_f32_16x16x32_bf16 v[72:75], v[24:27], v[140:143], v[72:75]
  ds_read_b64_tr_b16 v[42:43], v10 offset:4608
  v_add_u32 v10, 8192, v10
  s_waitcnt lgkmcnt(6)
  v_mfma_f32_16x16x32_bf16 v[76:79], v[28:31], v[140:143], v[76:79]
  ds_read_b64_tr_b16 v[44:45], v11 offset:4096
  buffer_load_dwordx4 v[132:135], v14, s[8:11], s36 offen offset:3072 sc1
  v_mfma_f32_16x16x32_bf16 v[60:63], v[28:31], v[136:139], v[60:63]
  ds_read_b64_tr_b16 v[46:47], v11 offset:4608
  v_add_u32 v11, 8192, v11
  s_waitcnt vmcnt(13) lgkmcnt(6)
  v_mfma_f32_16x16x32_bf16 v[48:51], v[32:35], v[144:147], v[48:51]
  ds_read_b64_tr_b16 v[16:17], v8 offset:0
  s_bitcmp1_b32 s48, 5
  s_cselect_b32 s36, s50, s49
  s_waitcnt vmcnt(12)
  v_mfma_f32_16x16x32_bf16 v[64:67], v[32:35], v[148:151], v[64:67]
  ds_read_b64_tr_b16 v[18:19], v8 offset:512
  s_add_u32 s36, s36, 20480
  s_waitcnt lgkmcnt(6)
  v_mfma_f32_16x16x32_bf16 v[68:71], v[36:39], v[148:151], v[68:71]
  ds_read_b64_tr_b16 v[20:21], v9 offset:0
  v_mfma_f32_16x16x32_bf16 v[52:55], v[36:39], v[144:147], v[52:55]
  ds_read_b64_tr_b16 v[22:23], v9 offset:512
  s_waitcnt lgkmcnt(6)
  v_mfma_f32_16x16x32_bf16 v[56:59], v[40:43], v[144:147], v[56:59]
  ds_read_b64_tr_b16 v[24:25], v10 offset:0
  buffer_load_dwordx4 v[136:139], v14, s[8:11], s36 offen offset:0 sc1
  v_mfma_f32_16x16x32_bf16 v[72:75], v[40:43], v[148:151], v[72:75]
  ds_read_b64_tr_b16 v[26:27], v10 offset:512
  s_waitcnt lgkmcnt(6)
  v_mfma_f32_16x16x32_bf16 v[76:79], v[44:47], v[148:151], v[76:79]
  ds_read_b64_tr_b16 v[28:29], v11 offset:0
  v_mfma_f32_16x16x32_bf16 v[60:63], v[44:47], v[144:147], v[60:63]
  ds_read_b64_tr_b16 v[30:31], v11 offset:512
  buffer_load_dwordx4 v[140:143], v14, s[8:11], s36 offen offset:1024 sc1
  s_waitcnt vmcnt(13) lgkmcnt(6)
  v_mfma_f32_16x16x32_bf16 v[48:51], v[16:19], v[152:155], v[48:51]
  ds_read_b64_tr_b16 v[32:33], v8 offset:4096
  s_waitcnt vmcnt(12)
  v_mfma_f32_16x16x32_bf16 v[64:67], v[16:19], v[156:159], v[64:67]
  ds_read_b64_tr_b16 v[34:35], v8 offset:4608
  v_add_u32 v8, 8192, v8
  s_waitcnt lgkmcnt(6)
  v_mfma_f32_16x16x32_bf16 v[68:71], v[20:23], v[156:159], v[68:71]
  ds_read_b64_tr_b16 v[36:37], v9 offset:4096
  buffer_load_dwordx4 v[144:147], v14, s[8:11], s36 offen offset:2048 sc1
  v_mfma_f32_16x16x32_bf16 v[52:55], v[20:23], v[152:155], v[52:55]
  ds_read_b64_tr_b16 v[38:39], v9 offset:4608
  v_add_u32 v9, 8192, v9
  s_waitcnt lgkmcnt(6)
  v_mfma_f32_16x16x32_bf16 v[56:59], v[24:27], v[152:155], v[56:59]
  ds_read_b64_tr_b16 v[40:41], v10 offset:4096
  v_mfma_f32_16x16x32_bf16 v[72:75], v[24:27], v[156:159], v[72:75]
  ds_read_b64_tr_b16 v[42:43], v10 offset:4608
  v_add_u32 v10, 8192, v10
  s_waitcnt lgkmcnt(6)
  v_mfma_f32_16x16x32_bf16 v[76:79], v[28:31], v[156:159], v[76:79]
  ds_read_b64_tr_b16 v[44:45], v11 offset:4096
  buffer_load_dwordx4 v[148:151], v14, s[8:11], s36 offen offset:3072 sc1
  v_mfma_f32_16x16x32_bf16 v[60:63], v[28:31], v[152:155], v[60:63]
  ds_read_b64_tr_b16 v[46:47], v11 offset:4608
  v_add_u32 v11, 8192, v11
  s_waitcnt vmcnt(13) lgkmcnt(6)
  v_mfma_f32_16x16x32_bf16 v[48:51], v[32:35], v[160:163], v[48:51]
  ds_read_b64_tr_b16 v[16:17], v8 offset:0
  s_bitcmp1_b32 s48, 6
  s_cselect_b32 s36, s50, s49
  s_waitcnt vmcnt(12)
  v_mfma_f32_16x16x32_bf16 v[64:67], v[32:35], v[164:167], v[64:67]
  ds_read_b64_tr_b16 v[18:19], v8 offset:512
  s_add_u32 s36, s36, 24576
  s_waitcnt lgkmcnt(6)
  v_mfma_f32_16x16x32_bf16 v[68:71], v[36:39], v[164:167], v[68:71]
  ds_read_b64_tr_b16 v[20:21], v9 offset:0
  v_mfma_f32_16x16x32_bf16 v[52:55], v[36:39], v[160:163], v[52:55]
  ds_read_b64_tr_b16 v[22:23], v9 offset:512
  s_waitcnt lgkmcnt(6)
  v_mfma_f32_16x16x32_bf16 v[56:59], v[40:43], v[160:163], v[56:59]
  ds_read_b64_tr_b16 v[24:25], v10 offset:0
  buffer_load_dwordx4 v[152:155], v14, s[8:11], s36 offen offset:0 sc1
  v_mfma_f32_16x16x32_bf16 v[72:75], v[40:43], v[164:167], v[72:75]
  ds_read_b64_tr_b16 v[26:27], v10 offset:512
  s_waitcnt lgkmcnt(6)
  v_mfma_f32_16x16x32_bf16 v[76:79], v[44:47], v[164:167], v[76:79]
  ds_read_b64_tr_b16 v[28:29], v11 offset:0
  v_mfma_f32_16x16x32_bf16 v[60:63], v[44:47], v[160:163], v[60:63]
  ds_read_b64_tr_b16 v[30:31], v11 offset:512
  buffer_load_dwordx4 v[156:159], v14, s[8:11], s36 offen offset:1024 sc1
  s_waitcnt vmcnt(13) lgkmcnt(6)
  v_mfma_f32_16x16x32_bf16 v[48:51], v[16:19], v[168:171], v[48:51]
  ds_read_b64_tr_b16 v[32:33], v8 offset:4096
  s_waitcnt vmcnt(12)
  v_mfma_f32_16x16x32_bf16 v[64:67], v[16:19], v[172:175], v[64:67]
  ds_read_b64_tr_b16 v[34:35], v8 offset:4608
  v_add_u32 v8, 4294912256, v8
  s_waitcnt lgkmcnt(6)
  v_mfma_f32_16x16x32_bf16 v[68:71], v[20:23], v[172:175], v[68:71]
  ds_read_b64_tr_b16 v[36:37], v9 offset:4096
  buffer_load_dwordx4 v[160:163], v14, s[8:11], s36 offen offset:2048 sc1
  v_mfma_f32_16x16x32_bf16 v[52:55], v[20:23], v[168:171], v[52:55]
  ds_read_b64_tr_b16 v[38:39], v9 offset:4608
  v_add_u32 v9, 4294912256, v9
  s_waitcnt lgkmcnt(6)
  v_mfma_f32_16x16x32_bf16 v[56:59], v[24:27], v[168:171], v[56:59]
  ds_read_b64_tr_b16 v[40:41], v10 offset:4096
  v_mfma_f32_16x16x32_bf16 v[72:75], v[24:27], v[172:175], v[72:75]
  ds_read_b64_tr_b16 v[42:43], v10 offset:4608
  v_add_u32 v10, 4294912256, v10
  s_waitcnt lgkmcnt(6)
  v_mfma_f32_16x16x32_bf16 v[76:79], v[28:31], v[172:175], v[76:79]
  ds_read_b64_tr_b16 v[44:45], v11 offset:4096
  buffer_load_dwordx4 v[164:167], v14, s[8:11], s36 offen offset:3072 sc1
  v_mfma_f32_16x16x32_bf16 v[60:63], v[28:31], v[168:171], v[60:63]
  ds_read_b64_tr_b16 v[46:47], v11 offset:4608
  v_add_u32 v11, 4294912256, v11
  s_waitcnt vmcnt(13) lgkmcnt(6)
  v_mfma_f32_16x16x32_bf16 v[48:51], v[32:35], v[176:179], v[48:51]
  ds_read_b64_tr_b16 v[16:17], v8 offset:0
  s_bitcmp1_b32 s48, 7
  s_cselect_b32 s36, s50, s49
  s_waitcnt vmcnt(12)
  v_mfma_f32_16x16x32_bf16 v[64:67], v[32:35], v[180:183], v[64:67]
  ds_read_b64_tr_b16 v[18:19], v8 offset:512
  s_add_u32 s36, s36, 28672
  s_waitcnt lgkmcnt(6)
  v_mfma_f32_16x16x32_bf16 v[68:71], v[36:39], v[180:183], v[68:71]
  ds_read_b64_tr_b16 v[20:21], v9 offset:0
  v_mfma_f32_16x16x32_bf16 v[52:55], v[36:39], v[176:179], v[52:55]
  ds_read_b64_tr_b16 v[22:23], v9 offset:512
  s_waitcnt lgkmcnt(6)
  v_mfma_f32_16x16x32_bf16 v[56:59], v[40:43], v[176:179], v[56:59]
  ds_read_b64_tr_b16 v[24:25], v10 offset:0
  buffer_load_dwordx4 v[168:171], v14, s[8:11], s36 offen offset:0 sc1
  v_mfma_f32_16x16x32_bf16 v[72:75], v[40:43], v[180:183], v[72:75]
  ds_read_b64_tr_b16 v[26:27], v10 offset:512
  s_waitcnt lgkmcnt(6)
  v_mfma_f32_16x16x32_bf16 v[76:79], v[44:47], v[180:183], v[76:79]
  ds_read_b64_tr_b16 v[28:29], v11 offset:0
  v_mfma_f32_16x16x32_bf16 v[60:63], v[44:47], v[176:179], v[60:63]
  ds_read_b64_tr_b16 v[30:31], v11 offset:512
  buffer_load_dwordx4 v[172:175], v14, s[8:11], s36 offen offset:1024 sc1
  s_waitcnt vmcnt(13) lgkmcnt(6)
  v_mfma_f32_16x16x32_bf16 v[48:51], v[16:19], v[120:123], v[48:51]
  ds_read_b64_tr_b16 v[32:33], v8 offset:4096
  s_waitcnt vmcnt(12)
  v_mfma_f32_16x16x32_bf16 v[64:67], v[16:19], v[124:127], v[64:67]
  ds_read_b64_tr_b16 v[34:35], v8 offset:4608
  v_add_u32 v8, 8192, v8
  s_waitcnt lgkmcnt(6)
  v_mfma_f32_16x16x32_bf16 v[68:71], v[20:23], v[124:127], v[68:71]
  ds_read_b64_tr_b16 v[36:37], v9 offset:4096
  buffer_load_dwordx4 v[176:179], v14, s[8:11], s36 offen offset:2048 sc1
  v_mfma_f32_16x16x32_bf16 v[52:55], v[20:23], v[120:123], v[52:55]
  ds_read_b64_tr_b16 v[38:39], v9 offset:4608
  v_add_u32 v9, 8192, v9
  s_waitcnt lgkmcnt(6)
  v_mfma_f32_16x16x32_bf16 v[56:59], v[24:27], v[120:123], v[56:59]
  ds_read_b64_tr_b16 v[40:41], v10 offset:4096
  v_mfma_f32_16x16x32_bf16 v[72:75], v[24:27], v[124:127], v[72:75]
  ds_read_b64_tr_b16 v[42:43], v10 offset:4608
  v_add_u32 v10, 8192, v10
  s_waitcnt lgkmcnt(6)
  v_mfma_f32_16x16x32_bf16 v[76:79], v[28:31], v[124:127], v[76:79]
  ds_read_b64_tr_b16 v[44:45], v11 offset:4096
  buffer_load_dwordx4 v[180:183], v14, s[8:11], s36 offen offset:3072 sc1
  v_mfma_f32_16x16x32_bf16 v[60:63], v[28:31], v[120:123], v[60:63]
  ds_read_b64_tr_b16 v[46:47], v11 offset:4608
  v_add_u32 v11, 8192, v11
  s_waitcnt vmcnt(13) lgkmcnt(6)
  v_mfma_f32_16x16x32_bf16 v[48:51], v[32:35], v[128:131], v[48:51]
  ds_read_b64_tr_b16 v[16:17], v8 offset:0
  s_mov_b32 s49, s50
  s_add_u32 s50, s50, 32768
  s_waitcnt vmcnt(12)
  v_mfma_f32_16x16x32_bf16 v[64:67], v[32:35], v[132:135], v[64:67]
  ds_read_b64_tr_b16 v[18:19], v8 offset:512
  s_cmp_eq_u32 s50, s41
  s_cselect_b32 s50, s34, s50
  s_waitcnt lgkmcnt(6)
  v_mfma_f32_16x16x32_bf16 v[68:71], v[36:39], v[132:135], v[68:71]
  ds_read_b64_tr_b16 v[20:21], v9 offset:0
  s_bitcmp1_b32 s48, 0
  s_cselect_b32 s36, s50, s49
  v_mfma_f32_16x16x32_bf16 v[52:55], v[36:39], v[128:131], v[52:55]
  ds_read_b64_tr_b16 v[22:23], v9 offset:512
  s_add_u32 s36, s36, 0
  s_waitcnt lgkmcnt(6)
  v_mfma_f32_16x16x32_bf16 v[56:59], v[40:43], v[128:131], v[56:59]
  ds_read_b64_tr_b16 v[24:25], v10 offset:0
  buffer_load_dwordx4 v[120:123], v14, s[8:11], s36 offen offset:0 sc1
  v_mfma_f32_16x16x32_bf16 v[72:75], v[40:43], v[132:135], v[72:75]
  ds_read_b64_tr_b16 v[26:27], v10 offset:512
  s_waitcnt lgkmcnt(6)
  v_mfma_f32_16x16x32_bf16 v[76:79], v[44:47], v[132:135], v[76:79]
  ds_read_b64_tr_b16 v[28:29], v11 offset:0
  v_mfma_f32_16x16x32_bf16 v[60:63], v[44:47], v[128:131], v[60:63]
  ds_read_b64_tr_b16 v[30:31], v11 offset:512
  buffer_load_dwordx4 v[124:127], v14, s[8:11], s36 offen offset:1024 sc1
  s_waitcnt vmcnt(13) lgkmcnt(6)
  v_mfma_f32_16x16x32_bf16 v[48:51], v[16:19], v[136:139], v[48:51]
  ds_read_b64_tr_b16 v[32:33], v8 offset:4096
  s_waitcnt vmcnt(12)
  v_mfma_f32_16x16x32_bf16 v[64:67], v[16:19], v[140:143], v[64:67]
  ds_read_b64_tr_b16 v[34:35], v8 offset:4608
  v_add_u32 v8, 8192, v8
  s_waitcnt lgkmcnt(6)
  v_mfma_f32_16x16x32_bf16 v[68:71], v[20:23], v[140:143], v[68:71]
  ds_read_b64_tr_b16 v[36:37], v9 offset:4096
  buffer_load_dwordx4 v[128:131], v14, s[8:11], s36 offen offset:2048 sc1
  v_mfma_f32_16x16x32_bf16 v[52:55], v[20:23], v[136:139], v[52:55]
  ds_read_b64_tr_b16 v[38:39], v9 offset:4608
  v_add_u32 v9, 8192, v9
  s_waitcnt lgkmcnt(6)
  v_mfma_f32_16x16x32_bf16 v[56:59], v[24:27], v[136:139], v[56:59]
  ds_read_b64_tr_b16 v[40:41], v10 offset:4096
  v_mfma_f32_16x16x32_bf16 v[72:75], v[24:27], v[140:143], v[72:75]
  ds_read_b64_tr_b16 v[42:43], v10 offset:4608
  v_add_u32 v10, 8192, v10
  s_waitcnt lgkmcnt(6)
  v_mfma_f32_16x16x32_bf16 v[76:79], v[28:31], v[140:143], v[76:79]
  ds_read_b64_tr_b16 v[44:45], v11 offset:4096
  buffer_load_dwordx4 v[132:135], v14, s[8:11], s36 offen offset:3072 sc1
  v_mfma_f32_16x16x32_bf16 v[60:63], v[28:31], v[136:139], v[60:63]
  ds_read_b64_tr_b16 v[46:47], v11 offset:4608
  v_add_u32 v11, 8192, v11
  s_waitcnt vmcnt(13) lgkmcnt(6)
  v_mfma_f32_16x16x32_bf16 v[48:51], v[32:35], v[144:147], v[48:51]
  ds_read_b64_tr_b16 v[16:17], v8 offset:0
  s_bitcmp1_b32 s48, 1
  s_cselect_b32 s36, s50, s49
  s_waitcnt vmcnt(12)
  v_mfma_f32_16x16x32_bf16 v[64:67], v[32:35], v[148:151], v[64:67]
  ds_read_b64_tr_b16 v[18:19], v8 offset:512
  s_add_u32 s36, s36, 4096
  s_waitcnt lgkmcnt(6)
  v_mfma_f32_16x16x32_bf16 v[68:71], v[36:39], v[148:151], v[68:71]
  ds_read_b64_tr_b16 v[20:21], v9 offset:0
  v_mfma_f32_16x16x32_bf16 v[52:55], v[36:39], v[144:147], v[52:55]
  ds_read_b64_tr_b16 v[22:23], v9 offset:512
  s_waitcnt lgkmcnt(6)
  v_mfma_f32_16x16x32_bf16 v[56:59], v[40:43], v[144:147], v[56:59]
  ds_read_b64_tr_b16 v[24:25], v10 offset:0
  buffer_load_dwordx4 v[136:139], v14, s[8:11], s36 offen offset:0 sc1
  v_mfma_f32_16x16x32_bf16 v[72:75], v[40:43], v[148:151], v[72:75]
  ds_read_b64_tr_b16 v[26:27], v10 offset:512
  s_waitcnt lgkmcnt(6)
  v_mfma_f32_16x16x32_bf16 v[76:79], v[44:47], v[148:151], v[76:79]
  ds_read_b64_tr_b16 v[28:29], v11 offset:0
  v_mfma_f32_16x16x32_bf16 v[60:63], v[44:47], v[144:147], v[60:63]
  ds_read_b64_tr_b16 v[30:31], v11 offset:512
  buffer_load_dwordx4 v[140:143], v14, s[8:11], s36 offen offset:1024 sc1
  s_waitcnt vmcnt(13) lgkmcnt(6)
  v_mfma_f32_16x16x32_bf16 v[48:51], v[16:19], v[152:155], v[48:51]
  ds_read_b64_tr_b16 v[32:33], v8 offset:4096
  s_waitcnt vmcnt(12)
  v_mfma_f32_16x16x32_bf16 v[64:67], v[16:19], v[156:159], v[64:67]
  ds_read_b64_tr_b16 v[34:35], v8 offset:4608
  v_add_u32 v8, 4294850304, v8
  s_waitcnt lgkmcnt(6)
  v_mfma_f32_16x16x32_bf16 v[68:71], v[20:23], v[156:159], v[68:71]
  ds_read_b64_tr_b16 v[36:37], v9 offset:4096
  buffer_load_dwordx4 v[144:147], v14, s[8:11], s36 offen offset:2048 sc1
  v_mfma_f32_16x16x32_bf16 v[52:55], v[20:23], v[152:155], v[52:55]
  ds_read_b64_tr_b16 v[38:39], v9 offset:4608
  v_add_u32 v9, 4294850304, v9
  s_waitcnt lgkmcnt(6)
  v_mfma_f32_16x16x32_bf16 v[56:59], v[24:27], v[152:155], v[56:59]
  ds_read_b64_tr_b16 v[40:41], v10 offset:4096
  v_mfma_f32_16x16x32_bf16 v[72:75], v[24:27], v[156:159], v[72:75]
  ds_read_b64_tr_b16 v[42:43], v10 offset:4608
  v_add_u32 v10, 4294850304, v10
  s_waitcnt lgkmcnt(6)
  v_mfma_f32_16x16x32_bf16 v[76:79], v[28:31], v[156:159], v[76:79]
  ds_read_b64_tr_b16 v[44:45], v11 offset:4096
  buffer_load_dwordx4 v[148:151], v14, s[8:11], s36 offen offset:3072 sc1
  v_mfma_f32_16x16x32_bf16 v[60:63], v[28:31], v[152:155], v[60:63]
  ds_read_b64_tr_b16 v[46:47], v11 offset:4608
  v_add_u32 v11, 4294850304, v11
  s_waitcnt vmcnt(13) lgkmcnt(6)
  v_mfma_f32_16x16x32_bf16 v[48:51], v[32:35], v[160:163], v[48:51]
  ds_read_b64_tr_b16 v[16:17], v8 offset:0
  s_bitcmp1_b32 s48, 2
  s_cselect_b32 s36, s50, s49
  s_waitcnt vmcnt(12)
  v_mfma_f32_16x16x32_bf16 v[64:67], v[32:35], v[164:167], v[64:67]
  ds_read_b64_tr_b16 v[18:19], v8 offset:512
  s_add_u32 s36, s36, 8192
  s_waitcnt lgkmcnt(6)
  v_mfma_f32_16x16x32_bf16 v[68:71], v[36:39], v[164:167], v[68:71]
  ds_read_b64_tr_b16 v[20:21], v9 offset:0
  v_mfma_f32_16x16x32_bf16 v[52:55], v[36:39], v[160:163], v[52:55]
  ds_read_b64_tr_b16 v[22:23], v9 offset:512
  s_waitcnt lgkmcnt(6)
  v_mfma_f32_16x16x32_bf16 v[56:59], v[40:43], v[160:163], v[56:59]
  ds_read_b64_tr_b16 v[24:25], v10 offset:0
  buffer_load_dwordx4 v[152:155], v14, s[8:11], s36 offen offset:0 sc1
  v_mfma_f32_16x16x32_bf16 v[72:75], v[40:43], v[164:167], v[72:75]
  ds_read_b64_tr_b16 v[26:27], v10 offset:512
  s_waitcnt lgkmcnt(6)
  v_mfma_f32_16x16x32_bf16 v[76:79], v[44:47], v[164:167], v[76:79]
  ds_read_b64_tr_b16 v[28:29], v11 offset:0
  v_mfma_f32_16x16x32_bf16 v[60:63], v[44:47], v[160:163], v[60:63]
  ds_read_b64_tr_b16 v[30:31], v11 offset:512
  buffer_load_dwordx4 v[156:159], v14, s[8:11], s36 offen offset:1024 sc1
  s_waitcnt vmcnt(13) lgkmcnt(6)
  v_mfma_f32_16x16x32_bf16 v[48:51], v[16:19], v[168:171], v[48:51]
  ds_read_b64_tr_b16 v[32:33], v8 offset:4096
  s_waitcnt vmcnt(12)
  v_mfma_f32_16x16x32_bf16 v[64:67], v[16:19], v[172:175], v[64:67]
  ds_read_b64_tr_b16 v[34:35], v8 offset:4608
  v_add_u32 v8, 8192, v8
  s_waitcnt lgkmcnt(6)
  v_mfma_f32_16x16x32_bf16 v[68:71], v[20:23], v[172:175], v[68:71]
  ds_read_b64_tr_b16 v[36:37], v9 offset:4096
  buffer_load_dwordx4 v[160:163], v14, s[8:11], s36 offen offset:2048 sc1
  v_mfma_f32_16x16x32_bf16 v[52:55], v[20:23], v[168:171], v[52:55]
  ds_read_b64_tr_b16 v[38:39], v9 offset:4608
  v_add_u32 v9, 8192, v9
  s_waitcnt lgkmcnt(6)
  v_mfma_f32_16x16x32_bf16 v[56:59], v[24:27], v[168:171], v[56:59]
  ds_read_b64_tr_b16 v[40:41], v10 offset:4096
  v_mfma_f32_16x16x32_bf16 v[72:75], v[24:27], v[172:175], v[72:75]
  ds_read_b64_tr_b16 v[42:43], v10 offset:4608
  v_add_u32 v10, 8192, v10
  s_waitcnt lgkmcnt(6)
  v_mfma_f32_16x16x32_bf16 v[76:79], v[28:31], v[172:175], v[76:79]
  ds_read_b64_tr_b16 v[44:45], v11 offset:4096
  buffer_load_dwordx4 v[164:167], v14, s[8:11], s36 offen offset:3072 sc1
  v_mfma_f32_16x16x32_bf16 v[60:63], v[28:31], v[168:171], v[60:63]
  ds_read_b64_tr_b16 v[46:47], v11 offset:4608
  v_add_u32 v11, 8192, v11
  s_waitcnt vmcnt(13) lgkmcnt(6)
  v_mfma_f32_16x16x32_bf16 v[48:51], v[32:35], v[176:179], v[48:51]
  ds_read_b64_tr_b16 v[16:17], v8 offset:0
  s_bitcmp1_b32 s48, 3
  s_cselect_b32 s36, s50, s49
  s_waitcnt vmcnt(12)
  v_mfma_f32_16x16x32_bf16 v[64:67], v[32:35], v[180:183], v[64:67]
  ds_read_b64_tr_b16 v[18:19], v8 offset:512
  s_add_u32 s36, s36, 12288
  s_waitcnt lgkmcnt(6)
  v_mfma_f32_16x16x32_bf16 v[68:71], v[36:39], v[180:183], v[68:71]
  ds_read_b64_tr_b16 v[20:21], v9 offset:0
  v_mfma_f32_16x16x32_bf16 v[52:55], v[36:39], v[176:179], v[52:55]
  ds_read_b64_tr_b16 v[22:23], v9 offset:512
  s_waitcnt lgkmcnt(6)
  v_mfma_f32_16x16x32_bf16 v[56:59], v[40:43], v[176:179], v[56:59]
  ds_read_b64_tr_b16 v[24:25], v10 offset:0
  buffer_load_dwordx4 v[168:171], v14, s[8:11], s36 offen offset:0 sc1
  v_mfma_f32_16x16x32_bf16 v[72:75], v[40:43], v[180:183], v[72:75]
  ds_read_b64_tr_b16 v[26:27], v10 offset:512
  s_waitcnt lgkmcnt(6)
  v_mfma_f32_16x16x32_bf16 v[76:79], v[44:47], v[180:183], v[76:79]
  ds_read_b64_tr_b16 v[28:29], v11 offset:0
  v_mfma_f32_16x16x32_bf16 v[60:63], v[44:47], v[176:179], v[60:63]
  ds_read_b64_tr_b16 v[30:31], v11 offset:512
  buffer_load_dwordx4 v[172:175], v14, s[8:11], s36 offen offset:1024 sc1
  s_waitcnt vmcnt(13) lgkmcnt(6)
  v_mfma_f32_16x16x32_bf16 v[48:51], v[16:19], v[120:123], v[48:51]
  ds_read_b64_tr_b16 v[32:33], v8 offset:4096
  s_waitcnt vmcnt(12)
  v_mfma_f32_16x16x32_bf16 v[64:67], v[16:19], v[124:127], v[64:67]
  ds_read_b64_tr_b16 v[34:35], v8 offset:4608
  v_add_u32 v8, 8192, v8
  s_waitcnt lgkmcnt(6)
  v_mfma_f32_16x16x32_bf16 v[68:71], v[20:23], v[124:127], v[68:71]
  ds_read_b64_tr_b16 v[36:37], v9 offset:4096
  buffer_load_dwordx4 v[176:179], v14, s[8:11], s36 offen offset:2048 sc1
  v_mfma_f32_16x16x32_bf16 v[52:55], v[20:23], v[120:123], v[52:55]
  ds_read_b64_tr_b16 v[38:39], v9 offset:4608
  v_add_u32 v9, 8192, v9
  s_waitcnt lgkmcnt(6)
  v_mfma_f32_16x16x32_bf16 v[56:59], v[24:27], v[120:123], v[56:59]
  ds_read_b64_tr_b16 v[40:41], v10 offset:4096
  v_mfma_f32_16x16x32_bf16 v[72:75], v[24:27], v[124:127], v[72:75]
  ds_read_b64_tr_b16 v[42:43], v10 offset:4608
  v_add_u32 v10, 8192, v10
  s_waitcnt lgkmcnt(6)
  v_mfma_f32_16x16x32_bf16 v[76:79], v[28:31], v[124:127], v[76:79]
  ds_read_b64_tr_b16 v[44:45], v11 offset:4096
  buffer_load_dwordx4 v[180:183], v14, s[8:11], s36 offen offset:3072 sc1
  v_mfma_f32_16x16x32_bf16 v[60:63], v[28:31], v[120:123], v[60:63]
  ds_read_b64_tr_b16 v[46:47], v11 offset:4608
  v_add_u32 v11, 8192, v11
  s_waitcnt vmcnt(13) lgkmcnt(6)
  v_mfma_f32_16x16x32_bf16 v[48:51], v[32:35], v[128:131], v[48:51]
  ds_read_b64_tr_b16 v[16:17], v8 offset:0
  s_bitcmp1_b32 s48, 4
  s_cselect_b32 s36, s50, s49
  s_waitcnt vmcnt(12)
  v_mfma_f32_16x16x32_bf16 v[64:67], v[32:35], v[132:135], v[64:67]
  ds_read_b64_tr_b16 v[18:19], v8 offset:512
  s_add_u32 s36, s36, 16384
  s_waitcnt lgkmcnt(6)
  v_mfma_f32_16x16x32_bf16 v[68:71], v[36:39], v[132:135], v[68:71]
  ds_read_b64_tr_b16 v[20:21], v9 offset:0
  v_mfma_f32_16x16x32_bf16 v[52:55], v[36:39], v[128:131], v[52:55]
  ds_read_b64_tr_b16 v[22:23], v9 offset:512
  s_waitcnt lgkmcnt(6)
  v_mfma_f32_16x16x32_bf16 v[56:59], v[40:43], v[128:131], v[56:59]
  ds_read_b64_tr_b16 v[24:25], v10 offset:0
  buffer_load_dwordx4 v[120:123], v14, s[8:11], s36 offen offset:0 sc1
  v_mfma_f32_16x16x32_bf16 v[72:75], v[40:43], v[132:135], v[72:75]
  ds_read_b64_tr_b16 v[26:27], v10 offset:512
  s_waitcnt lgkmcnt(6)
  v_mfma_f32_16x16x32_bf16 v[76:79], v[44:47], v[132:135], v[76:79]
  ds_read_b64_tr_b16 v[28:29], v11 offset:0
  v_mfma_f32_16x16x32_bf16 v[60:63], v[44:47], v[128:131], v[60:63]
  ds_read_b64_tr_b16 v[30:31], v11 offset:512
  buffer_load_dwordx4 v[124:127], v14, s[8:11], s36 offen offset:1024 sc1
  s_waitcnt vmcnt(13) lgkmcnt(6)
  v_mfma_f32_16x16x32_bf16 v[48:51], v[16:19], v[136:139], v[48:51]
  ds_read_b64_tr_b16 v[32:33], v8 offset:4096
  s_waitcnt vmcnt(12)
  v_mfma_f32_16x16x32_bf16 v[64:67], v[16:19], v[140:143], v[64:67]
  ds_read_b64_tr_b16 v[34:35], v8 offset:4608
  v_add_u32 v8, 8192, v8
  s_waitcnt lgkmcnt(6)
  v_mfma_f32_16x16x32_bf16 v[68:71], v[20:23], v[140:143], v[68:71]
  ds_read_b64_tr_b16 v[36:37], v9 offset:4096
  buffer_load_dwordx4 v[128:131], v14, s[8:11], s36 offen offset:2048 sc1
  v_mfma_f32_16x16x32_bf16 v[52:55], v[20:23], v[136:139], v[52:55]
  ds_read_b64_tr_b16 v[38:39], v9 offset:4608
  v_add_u32 v9, 8192, v9
  s_waitcnt lgkmcnt(6)
  v_mfma_f32_16x16x32_bf16 v[56:59], v[24:27], v[136:139], v[56:59]
  ds_read_b64_tr_b16 v[40:41], v10 offset:4096
  v_mfma_f32_16x16x32_bf16 v[72:75], v[24:27], v[140:143], v[72:75]
  ds_read_b64_tr_b16 v[42:43], v10 offset:4608
  v_add_u32 v10, 8192, v10
  s_waitcnt lgkmcnt(6)
  v_mfma_f32_16x16x32_bf16 v[76:79], v[28:31], v[140:143], v[76:79]
  ds_read_b64_tr_b16 v[44:45], v11 offset:4096
  buffer_load_dwordx4 v[132:135], v14, s[8:11], s36 offen offset:3072 sc1
  v_mfma_f32_16x16x32_bf16 v[60:63], v[28:31], v[136:139], v[60:63]
  ds_read_b64_tr_b16 v[46:47], v11 offset:4608
  v_add_u32 v11, 8192, v11
  s_waitcnt vmcnt(13) lgkmcnt(6)
  v_mfma_f32_16x16x32_bf16 v[48:51], v[32:35], v[144:147], v[48:51]
  ds_read_b64_tr_b16 v[16:17], v8 offset:0
  s_bitcmp1_b32 s48, 5
  s_cselect_b32 s36, s50, s49
  s_waitcnt vmcnt(12)
  v_mfma_f32_16x16x32_bf16 v[64:67], v[32:35], v[148:151], v[64:67]
  ds_read_b64_tr_b16 v[18:19], v8 offset:512
  s_add_u32 s36, s36, 20480
  s_waitcnt lgkmcnt(6)
  v_mfma_f32_16x16x32_bf16 v[68:71], v[36:39], v[148:151], v[68:71]
  ds_read_b64_tr_b16 v[20:21], v9 offset:0
  v_mfma_f32_16x16x32_bf16 v[52:55], v[36:39], v[144:147], v[52:55]
  ds_read_b64_tr_b16 v[22:23], v9 offset:512
  s_waitcnt lgkmcnt(6)
  v_mfma_f32_16x16x32_bf16 v[56:59], v[40:43], v[144:147], v[56:59]
  ds_read_b64_tr_b16 v[24:25], v10 offset:0
  buffer_load_dwordx4 v[136:139], v14, s[8:11], s36 offen offset:0 sc1
  v_mfma_f32_16x16x32_bf16 v[72:75], v[40:43], v[148:151], v[72:75]
  ds_read_b64_tr_b16 v[26:27], v10 offset:512
  s_waitcnt lgkmcnt(6)
  v_mfma_f32_16x16x32_bf16 v[76:79], v[44:47], v[148:151], v[76:79]
  ds_read_b64_tr_b16 v[28:29], v11 offset:0
  v_mfma_f32_16x16x32_bf16 v[60:63], v[44:47], v[144:147], v[60:63]
  ds_read_b64_tr_b16 v[30:31], v11 offset:512
  buffer_load_dwordx4 v[140:143], v14, s[8:11], s36 offen offset:1024 sc1
  s_waitcnt vmcnt(13) lgkmcnt(6)
  v_mfma_f32_16x16x32_bf16 v[48:51], v[16:19], v[152:155], v[48:51]
  ds_read_b64_tr_b16 v[32:33], v8 offset:4096
  s_waitcnt vmcnt(12)
  v_mfma_f32_16x16x32_bf16 v[64:67], v[16:19], v[156:159], v[64:67]
  ds_read_b64_tr_b16 v[34:35], v8 offset:4608
  v_add_u32 v8, 8192, v8
  s_waitcnt lgkmcnt(6)
  v_mfma_f32_16x16x32_bf16 v[68:71], v[20:23], v[156:159], v[68:71]
  ds_read_b64_tr_b16 v[36:37], v9 offset:4096
  buffer_load_dwordx4 v[144:147], v14, s[8:11], s36 offen offset:2048 sc1
  v_mfma_f32_16x16x32_bf16 v[52:55], v[20:23], v[152:155], v[52:55]
  ds_read_b64_tr_b16 v[38:39], v9 offset:4608
  v_add_u32 v9, 8192, v9
  s_waitcnt lgkmcnt(6)
  v_mfma_f32_16x16x32_bf16 v[56:59], v[24:27], v[152:155], v[56:59]
  ds_read_b64_tr_b16 v[40:41], v10 offset:4096
  v_mfma_f32_16x16x32_bf16 v[72:75], v[24:27], v[156:159], v[72:75]
  ds_read_b64_tr_b16 v[42:43], v10 offset:4608
  v_add_u32 v10, 8192, v10
  s_waitcnt lgkmcnt(6)
  v_mfma_f32_16x16x32_bf16 v[76:79], v[28:31], v[156:159], v[76:79]
  ds_read_b64_tr_b16 v[44:45], v11 offset:4096
  buffer_load_dwordx4 v[148:151], v14, s[8:11], s36 offen offset:3072 sc1
  v_mfma_f32_16x16x32_bf16 v[60:63], v[28:31], v[152:155], v[60:63]
  ds_read_b64_tr_b16 v[46:47], v11 offset:4608
  v_add_u32 v11, 8192, v11
  s_waitcnt vmcnt(13) lgkmcnt(6)
  v_mfma_f32_16x16x32_bf16 v[48:51], v[32:35], v[160:163], v[48:51]
  ds_read_b64_tr_b16 v[16:17], v8 offset:0
  s_bitcmp1_b32 s48, 6
  s_cselect_b32 s36, s50, s49
  s_waitcnt vmcnt(12)
  v_mfma_f32_16x16x32_bf16 v[64:67], v[32:35], v[164:167], v[64:67]
  ds_read_b64_tr_b16 v[18:19], v8 offset:512
  s_add_u32 s36, s36, 24576
  s_waitcnt lgkmcnt(6)
  v_mfma_f32_16x16x32_bf16 v[68:71], v[36:39], v[164:167], v[68:71]
  ds_read_b64_tr_b16 v[20:21], v9 offset:0
  v_mfma_f32_16x16x32_bf16 v[52:55], v[36:39], v[160:163], v[52:55]
  ds_read_b64_tr_b16 v[22:23], v9 offset:512
  s_waitcnt lgkmcnt(6)
  v_mfma_f32_16x16x32_bf16 v[56:59], v[40:43], v[160:163], v[56:59]
  ds_read_b64_tr_b16 v[24:25], v10 offset:0
  buffer_load_dwordx4 v[152:155], v14, s[8:11], s36 offen offset:0 sc1
  v_mfma_f32_16x16x32_bf16 v[72:75], v[40:43], v[164:167], v[72:75]
  ds_read_b64_tr_b16 v[26:27], v10 offset:512
  s_waitcnt lgkmcnt(6)
  v_mfma_f32_16x16x32_bf16 v[76:79], v[44:47], v[164:167], v[76:79]
  ds_read_b64_tr_b16 v[28:29], v11 offset:0
  v_mfma_f32_16x16x32_bf16 v[60:63], v[44:47], v[160:163], v[60:63]
  ds_read_b64_tr_b16 v[30:31], v11 offset:512
  buffer_load_dwordx4 v[156:159], v14, s[8:11], s36 offen offset:1024 sc1
  s_waitcnt vmcnt(13) lgkmcnt(6)
  v_mfma_f32_16x16x32_bf16 v[48:51], v[16:19], v[168:171], v[48:51]
  ds_read_b64_tr_b16 v[32:33], v8 offset:4096
  s_waitcnt vmcnt(12)
  v_mfma_f32_16x16x32_bf16 v[64:67], v[16:19], v[172:175], v[64:67]
  ds_read_b64_tr_b16 v[34:35], v8 offset:4608
  v_add_u32 v8, 10240, v8
  s_waitcnt lgkmcnt(6)
  v_mfma_f32_16x16x32_bf16 v[68:71], v[20:23], v[172:175], v[68:71]
  ds_read_b64_tr_b16 v[36:37], v9 offset:4096
  buffer_load_dwordx4 v[160:163], v14, s[8:11], s36 offen offset:2048 sc1
  v_mfma_f32_16x16x32_bf16 v[52:55], v[20:23], v[168:171], v[52:55]
  ds_read_b64_tr_b16 v[38:39], v9 offset:4608
  v_add_u32 v9, 10240, v9
  s_waitcnt lgkmcnt(6)
  v_mfma_f32_16x16x32_bf16 v[56:59], v[24:27], v[168:171], v[56:59]
  ds_read_b64_tr_b16 v[40:41], v10 offset:4096
  v_mfma_f32_16x16x32_bf16 v[72:75], v[24:27], v[172:175], v[72:75]
  ds_read_b64_tr_b16 v[42:43], v10 offset:4608
  v_add_u32 v10, 10240, v10
  s_waitcnt lgkmcnt(6)
  v_mfma_f32_16x16x32_bf16 v[76:79], v[28:31], v[172:175], v[76:79]
  ds_read_b64_tr_b16 v[44:45], v11 offset:4096
  buffer_load_dwordx4 v[164:167], v14, s[8:11], s36 offen offset:3072 sc1
  v_mfma_f32_16x16x32_bf16 v[60:63], v[28:31], v[168:171], v[60:63]
  ds_read_b64_tr_b16 v[46:47], v11 offset:4608
  v_add_u32 v11, 10240, v11
  s_waitcnt vmcnt(13) lgkmcnt(6)
  v_mfma_f32_16x16x32_bf16 v[48:51], v[32:35], v[176:179], v[48:51]
  ds_read_b64_tr_b16 v[16:17], v8 offset:0
  s_bitcmp1_b32 s48, 7
  s_cselect_b32 s36, s50, s49
  s_waitcnt vmcnt(12)
  v_mfma_f32_16x16x32_bf16 v[64:67], v[32:35], v[180:183], v[64:67]
  ds_read_b64_tr_b16 v[18:19], v8 offset:512
  s_add_u32 s36, s36, 28672
  s_waitcnt lgkmcnt(6)
  v_mfma_f32_16x16x32_bf16 v[68:71], v[36:39], v[180:183], v[68:71]
  ds_read_b64_tr_b16 v[20:21], v9 offset:0
  v_mfma_f32_16x16x32_bf16 v[52:55], v[36:39], v[176:179], v[52:55]
  ds_read_b64_tr_b16 v[22:23], v9 offset:512
  s_waitcnt lgkmcnt(6)
  v_mfma_f32_16x16x32_bf16 v[56:59], v[40:43], v[176:179], v[56:59]
  ds_read_b64_tr_b16 v[24:25], v10 offset:0
  buffer_load_dwordx4 v[168:171], v14, s[8:11], s36 offen offset:0 sc1
  v_mfma_f32_16x16x32_bf16 v[72:75], v[40:43], v[180:183], v[72:75]
  ds_read_b64_tr_b16 v[26:27], v10 offset:512
  s_waitcnt lgkmcnt(6)
  v_mfma_f32_16x16x32_bf16 v[76:79], v[44:47], v[180:183], v[76:79]
  ds_read_b64_tr_b16 v[28:29], v11 offset:0
  v_mfma_f32_16x16x32_bf16 v[60:63], v[44:47], v[176:179], v[60:63]
  ds_read_b64_tr_b16 v[30:31], v11 offset:512
  buffer_load_dwordx4 v[172:175], v14, s[8:11], s36 offen offset:1024 sc1
  s_waitcnt vmcnt(13) lgkmcnt(6)
  v_mfma_f32_16x16x32_bf16 v[48:51], v[16:19], v[120:123], v[48:51]
  ds_read_b64_tr_b16 v[32:33], v8 offset:4096
  s_waitcnt vmcnt(12)
  v_mfma_f32_16x16x32_bf16 v[64:67], v[16:19], v[124:127], v[64:67]
  ds_read_b64_tr_b16 v[34:35], v8 offset:4608
  v_add_u32 v8, 8192, v8
  s_waitcnt lgkmcnt(6)
  v_mfma_f32_16x16x32_bf16 v[68:71], v[20:23], v[124:127], v[68:71]
  ds_read_b64_tr_b16 v[36:37], v9 offset:4096
  buffer_load_dwordx4 v[176:179], v14, s[8:11], s36 offen offset:2048 sc1
  v_mfma_f32_16x16x32_bf16 v[52:55], v[20:23], v[120:123], v[52:55]
  ds_read_b64_tr_b16 v[38:39], v9 offset:4608
  v_add_u32 v9, 8192, v9
  s_waitcnt lgkmcnt(6)
  v_mfma_f32_16x16x32_bf16 v[56:59], v[24:27], v[120:123], v[56:59]
  ds_read_b64_tr_b16 v[40:41], v10 offset:4096
  v_mfma_f32_16x16x32_bf16 v[72:75], v[24:27], v[124:127], v[72:75]
  ds_read_b64_tr_b16 v[42:43], v10 offset:4608
  v_add_u32 v10, 8192, v10
  s_waitcnt lgkmcnt(6)
  v_mfma_f32_16x16x32_bf16 v[76:79], v[28:31], v[124:127], v[76:79]
  ds_read_b64_tr_b16 v[44:45], v11 offset:4096
  buffer_load_dwordx4 v[180:183], v14, s[8:11], s36 offen offset:3072 sc1
  v_mfma_f32_16x16x32_bf16 v[60:63], v[28:31], v[120:123], v[60:63]
  ds_read_b64_tr_b16 v[46:47], v11 offset:4608
  v_add_u32 v11, 8192, v11
  s_waitcnt vmcnt(13) lgkmcnt(6)
  v_mfma_f32_16x16x32_bf16 v[48:51], v[32:35], v[128:131], v[48:51]
  ds_read_b64_tr_b16 v[16:17], v8 offset:0
  s_waitcnt vmcnt(12)
  v_mfma_f32_16x16x32_bf16 v[64:67], v[32:35], v[132:135], v[64:67]
  ds_read_b64_tr_b16 v[18:19], v8 offset:512
  s_waitcnt lgkmcnt(6)
  v_mfma_f32_16x16x32_bf16 v[68:71], v[36:39], v[132:135], v[68:71]
  ds_read_b64_tr_b16 v[20:21], v9 offset:0
  v_mfma_f32_16x16x32_bf16 v[52:55], v[36:39], v[128:131], v[52:55]
  ds_read_b64_tr_b16 v[22:23], v9 offset:512
  s_waitcnt lgkmcnt(6)
  v_mfma_f32_16x16x32_bf16 v[56:59], v[40:43], v[128:131], v[56:59]
  ds_read_b64_tr_b16 v[24:25], v10 offset:0
  v_mfma_f32_16x16x32_bf16 v[72:75], v[40:43], v[132:135], v[72:75]
  ds_read_b64_tr_b16 v[26:27], v10 offset:512
  s_waitcnt lgkmcnt(6)
  v_mfma_f32_16x16x32_bf16 v[76:79], v[44:47], v[132:135], v[76:79]
  ds_read_b64_tr_b16 v[28:29], v11 offset:0
  v_mfma_f32_16x16x32_bf16 v[60:63], v[44:47], v[128:131], v[60:63]
  ds_read_b64_tr_b16 v[30:31], v11 offset:512
  s_waitcnt vmcnt(11) lgkmcnt(6)
  v_mfma_f32_16x16x32_bf16 v[48:51], v[16:19], v[136:139], v[48:51]
  ds_read_b64_tr_b16 v[32:33], v8 offset:4096
  s_waitcnt vmcnt(10)
  v_mfma_f32_16x16x32_bf16 v[64:67], v[16:19], v[140:143], v[64:67]
  ds_read_b64_tr_b16 v[34:35], v8 offset:4608
  v_add_u32 v8, 8192, v8
  s_waitcnt lgkmcnt(6)
  v_mfma_f32_16x16x32_bf16 v[68:71], v[20:23], v[140:143], v[68:71]
  ds_read_b64_tr_b16 v[36:37], v9 offset:4096
  v_mfma_f32_16x16x32_bf16 v[52:55], v[20:23], v[136:139], v[52:55]
  ds_read_b64_tr_b16 v[38:39], v9 offset:4608
  v_add_u32 v9, 8192, v9
  s_waitcnt lgkmcnt(6)
  v_mfma_f32_16x16x32_bf16 v[56:59], v[24:27], v[136:139], v[56:59]
  ds_read_b64_tr_b16 v[40:41], v10 offset:4096
  v_mfma_f32_16x16x32_bf16 v[72:75], v[24:27], v[140:143], v[72:75]
  ds_read_b64_tr_b16 v[42:43], v10 offset:4608
  v_add_u32 v10, 8192, v10
  s_waitcnt lgkmcnt(6)
  v_mfma_f32_16x16x32_bf16 v[76:79], v[28:31], v[140:143], v[76:79]
  ds_read_b64_tr_b16 v[44:45], v11 offset:4096
  v_mfma_f32_16x16x32_bf16 v[60:63], v[28:31], v[136:139], v[60:63]
  ds_read_b64_tr_b16 v[46:47], v11 offset:4608
  v_add_u32 v11, 8192, v11
  s_waitcnt vmcnt(9) lgkmcnt(6)
  v_mfma_f32_16x16x32_bf16 v[48:51], v[32:35], v[144:147], v[48:51]
  ds_read_b64_tr_b16 v[16:17], v8 offset:0
  s_waitcnt vmcnt(8)
  v_mfma_f32_16x16x32_bf16 v[64:67], v[32:35], v[148:151], v[64:67]
  ds_read_b64_tr_b16 v[18:19], v8 offset:512
  s_waitcnt lgkmcnt(6)
  v_mfma_f32_16x16x32_bf16 v[68:71], v[36:39], v[148:151], v[68:71]
  ds_read_b64_tr_b16 v[20:21], v9 offset:0
  v_mfma_f32_16x16x32_bf16 v[52:55], v[36:39], v[144:147], v[52:55]
  ds_read_b64_tr_b16 v[22:23], v9 offset:512
  s_waitcnt lgkmcnt(6)
  v_mfma_f32_16x16x32_bf16 v[56:59], v[40:43], v[144:147], v[56:59]
  ds_read_b64_tr_b16 v[24:25], v10 offset:0
  v_mfma_f32_16x16x32_bf16 v[72:75], v[40:43], v[148:151], v[72:75]
  ds_read_b64_tr_b16 v[26:27], v10 offset:512
  s_waitcnt lgkmcnt(6)
  v_mfma_f32_16x16x32_bf16 v[76:79], v[44:47], v[148:151], v[76:79]
  ds_read_b64_tr_b16 v[28:29], v11 offset:0
  v_mfma_f32_16x16x32_bf16 v[60:63], v[44:47], v[144:147], v[60:63]
  ds_read_b64_tr_b16 v[30:31], v11 offset:512
  s_waitcnt vmcnt(7) lgkmcnt(6)
  v_mfma_f32_16x16x32_bf16 v[48:51], v[16:19], v[152:155], v[48:51]
  ds_read_b64_tr_b16 v[32:33], v8 offset:4096
  s_waitcnt vmcnt(6)
  v_mfma_f32_16x16x32_bf16 v[64:67], v[16:19], v[156:159], v[64:67]
  ds_read_b64_tr_b16 v[34:35], v8 offset:4608
  v_add_u32 v8, 8192, v8
  s_waitcnt lgkmcnt(6)
  v_mfma_f32_16x16x32_bf16 v[68:71], v[20:23], v[156:159], v[68:71]
  ds_read_b64_tr_b16 v[36:37], v9 offset:4096
  v_mfma_f32_16x16x32_bf16 v[52:55], v[20:23], v[152:155], v[52:55]
  ds_read_b64_tr_b16 v[38:39], v9 offset:4608
  v_add_u32 v9, 8192, v9
  s_waitcnt lgkmcnt(6)
  v_mfma_f32_16x16x32_bf16 v[56:59], v[24:27], v[152:155], v[56:59]
  ds_read_b64_tr_b16 v[40:41], v10 offset:4096
  v_mfma_f32_16x16x32_bf16 v[72:75], v[24:27], v[156:159], v[72:75]
  ds_read_b64_tr_b16 v[42:43], v10 offset:4608
  v_add_u32 v10, 8192, v10
  s_waitcnt lgkmcnt(6)
  v_mfma_f32_16x16x32_bf16 v[76:79], v[28:31], v[156:159], v[76:79]
  ds_read_b64_tr_b16 v[44:45], v11 offset:4096
  v_mfma_f32_16x16x32_bf16 v[60:63], v[28:31], v[152:155], v[60:63]
  ds_read_b64_tr_b16 v[46:47], v11 offset:4608
  v_add_u32 v11, 8192, v11
  s_waitcnt vmcnt(5) lgkmcnt(6)
  v_mfma_f32_16x16x32_bf16 v[48:51], v[32:35], v[160:163], v[48:51]
  ds_read_b64_tr_b16 v[16:17], v8 offset:0
  s_waitcnt vmcnt(4)
  v_mfma_f32_16x16x32_bf16 v[64:67], v[32:35], v[164:167], v[64:67]
  ds_read_b64_tr_b16 v[18:19], v8 offset:512
  s_waitcnt lgkmcnt(6)
  v_mfma_f32_16x16x32_bf16 v[68:71], v[36:39], v[164:167], v[68:71]
  ds_read_b64_tr_b16 v[20:21], v9 offset:0
  v_mfma_f32_16x16x32_bf16 v[52:55], v[36:39], v[160:163], v[52:55]
  ds_read_b64_tr_b16 v[22:23], v9 offset:512
  s_waitcnt lgkmcnt(6)
  v_mfma_f32_16x16x32_bf16 v[56:59], v[40:43], v[160:163], v[56:59]
  ds_read_b64_tr_b16 v[24:25], v10 offset:0
  v_mfma_f32_16x16x32_bf16 v[72:75], v[40:43], v[164:167], v[72:75]
  ds_read_b64_tr_b16 v[26:27], v10 offset:512
  s_waitcnt lgkmcnt(6)
  v_mfma_f32_16x16x32_bf16 v[76:79], v[44:47], v[164:167], v[76:79]
  ds_read_b64_tr_b16 v[28:29], v11 offset:0
  v_mfma_f32_16x16x32_bf16 v[60:63], v[44:47], v[160:163], v[60:63]
  ds_read_b64_tr_b16 v[30:31], v11 offset:512
  s_waitcnt vmcnt(3) lgkmcnt(6)
  v_mfma_f32_16x16x32_bf16 v[48:51], v[16:19], v[168:171], v[48:51]
  ds_read_b64_tr_b16 v[32:33], v8 offset:4096
  s_waitcnt vmcnt(2)
  v_mfma_f32_16x16x32_bf16 v[64:67], v[16:19], v[172:175], v[64:67]
  ds_read_b64_tr_b16 v[34:35], v8 offset:4608
  s_waitcnt lgkmcnt(6)
  v_mfma_f32_16x16x32_bf16 v[68:71], v[20:23], v[172:175], v[68:71]
  ds_read_b64_tr_b16 v[36:37], v9 offset:4096
  v_mfma_f32_16x16x32_bf16 v[52:55], v[20:23], v[168:171], v[52:55]
  ds_read_b64_tr_b16 v[38:39], v9 offset:4608
  s_waitcnt lgkmcnt(6)
  v_mfma_f32_16x16x32_bf16 v[56:59], v[24:27], v[168:171], v[56:59]
  ds_read_b64_tr_b16 v[40:41], v10 offset:4096
  v_mfma_f32_16x16x32_bf16 v[72:75], v[24:27], v[172:175], v[72:75]
  ds_read_b64_tr_b16 v[42:43], v10 offset:4608
  s_waitcnt lgkmcnt(6)
  v_mfma_f32_16x16x32_bf16 v[76:79], v[28:31], v[172:175], v[76:79]
  ds_read_b64_tr_b16 v[44:45], v11 offset:4096
  v_mfma_f32_16x16x32_bf16 v[60:63], v[28:31], v[168:171], v[60:63]
  ds_read_b64_tr_b16 v[46:47], v11 offset:4608
  s_waitcnt vmcnt(1) lgkmcnt(6)
  v_mfma_f32_16x16x32_bf16 v[48:51], v[32:35], v[176:179], v[48:51]
  s_waitcnt vmcnt(0)
  v_mfma_f32_16x16x32_bf16 v[64:67], v[32:35], v[180:183], v[64:67]
  s_waitcnt lgkmcnt(4)
  v_mfma_f32_16x16x32_bf16 v[68:71], v[36:39], v[180:183], v[68:71]
  v_mfma_f32_16x16x32_bf16 v[52:55], v[36:39], v[176:179], v[52:55]
  s_waitcnt lgkmcnt(2)
  v_mfma_f32_16x16x32_bf16 v[56:59], v[40:43], v[176:179], v[56:59]
  v_mfma_f32_16x16x32_bf16 v[72:75], v[40:43], v[180:183], v[72:75]
  s_waitcnt lgkmcnt(0)
  v_mfma_f32_16x16x32_bf16 v[76:79], v[44:47], v[180:183], v[76:79]
  v_mfma_f32_16x16x32_bf16 v[60:63], v[44:47], v[176:179], v[60:63]
  s_waitcnt lgkmcnt(0)
  s_barrier
  s_add_u32 s20, s82, 4194304
  s_addc_u32 s21, s83, 0
  s_mov_b32 s22, 4194304
  s_mov_b32 s23, 0x20000
  s_add_u32 s24, s82, 8388608
  s_addc_u32 s25, s83, 0
  s_mov_b32 s26, 4194304
  s_mov_b32 s27, 0x20000
  v_pk_add_f32 v[16:17], v[48:49], v[50:51]
  v_pk_mul_f32 v[18:19], v[48:49], v[48:49]
  v_pk_fma_f32 v[18:19], v[50:51], v[50:51], v[18:19]
  v_pk_add_f32 v[16:17], v[16:17], v[52:53]
  v_pk_fma_f32 v[18:19], v[52:53], v[52:53], v[18:19]
  v_pk_add_f32 v[16:17], v[16:17], v[54:55]
  v_pk_fma_f32 v[18:19], v[54:55], v[54:55], v[18:19]
  v_pk_add_f32 v[16:17], v[16:17], v[56:57]
  v_pk_fma_f32 v[18:19], v[56:57], v[56:57], v[18:19]
  v_pk_add_f32 v[16:17], v[16:17], v[58:59]
  v_pk_fma_f32 v[18:19], v[58:59], v[58:59], v[18:19]
  v_pk_add_f32 v[16:17], v[16:17], v[60:61]
  v_pk_fma_f32 v[18:19], v[60:61], v[60:61], v[18:19]
  v_pk_add_f32 v[16:17], v[16:17], v[62:63]
  v_pk_fma_f32 v[18:19], v[62:63], v[62:63], v[18:19]
  v_add_f32 v24, v16, v17
  v_add_f32 v26, v18, v19
  v_pk_add_f32 v[20:21], v[64:65], v[66:67]
  v_pk_mul_f32 v[22:23], v[64:65], v[64:65]
  v_pk_fma_f32 v[22:23], v[66:67], v[66:67], v[22:23]
  v_pk_add_f32 v[20:21], v[20:21], v[68:69]
  v_pk_fma_f32 v[22:23], v[68:69], v[68:69], v[22:23]
  v_pk_add_f32 v[20:21], v[20:21], v[70:71]
  v_pk_fma_f32 v[22:23], v[70:71], v[70:71], v[22:23]
  v_pk_add_f32 v[20:21], v[20:21], v[72:73]
  v_pk_fma_f32 v[22:23], v[72:73], v[72:73], v[22:23]
  v_pk_add_f32 v[20:21], v[20:21], v[74:75]
  v_pk_fma_f32 v[22:23], v[74:75], v[74:75], v[22:23]
  v_pk_add_f32 v[20:21], v[20:21], v[76:77]
  v_pk_fma_f32 v[22:23], v[76:77], v[76:77], v[22:23]
  v_pk_add_f32 v[20:21], v[20:21], v[78:79]
  v_pk_fma_f32 v[22:23], v[78:79], v[78:79], v[22:23]
  v_add_f32 v25, v20, v21
  v_add_f32 v27, v22, v23
  s_nop 0
  v_permlane16_swap_b32 v24, v25
  v_permlane16_swap_b32 v26, v27
  v_add_f32 v28, v24, v25
  v_add_f32 v29, v26, v27
  v_mov_b32 v30, v28
  v_mov_b32 v31, v29
  s_nop 0
  v_permlane32_swap_b32 v28, v30
  v_permlane32_swap_b32 v29, v31
  v_add_f32 v28, v28, v30
  v_add_f32 v29, v29, v31
  v_and_b32 v29, 0x7fffffff, v29
  s_mov_b32 exec_hi, 0
  buffer_store_dwordx2 v[28:29], v112, s[12:15], 0 offen sc0 sc1
  s_mov_b64 exec, -1
  v_cvt_pk_bf16_f32 v96, v48, v49
  v_cvt_pk_bf16_f32 v97, v50, v51
  v_cvt_pk_bf16_f32 v98, v52, v53
  v_cvt_pk_bf16_f32 v99, v54, v55
  v_cvt_pk_bf16_f32 v100, v56, v57
  v_cvt_pk_bf16_f32 v101, v58, v59
  v_cvt_pk_bf16_f32 v102, v60, v61
  v_cvt_pk_bf16_f32 v103, v62, v63
  v_cvt_pk_bf16_f32 v104, v64, v65
  v_cvt_pk_bf16_f32 v105, v66, v67
  v_cvt_pk_bf16_f32 v106, v68, v69
  v_cvt_pk_bf16_f32 v107, v70, v71
  v_cvt_pk_bf16_f32 v108, v72, v73
  v_cvt_pk_bf16_f32 v109, v74, v75
  v_cvt_pk_bf16_f32 v110, v76, v77
  v_cvt_pk_bf16_f32 v111, v78, v79
  v_permlane16_swap_b32 v96, v98
  v_permlane16_swap_b32 v97, v99
  v_permlane16_swap_b32 v100, v102
  v_permlane16_swap_b32 v101, v103
  v_permlane16_swap_b32 v104, v106
  v_permlane16_swap_b32 v105, v107
  v_permlane16_swap_b32 v108, v110
  v_permlane16_swap_b32 v109, v111
  v_xor_b32 v116, 32, v115
  v_xor_b32 v121, 32, v114
  v_xor_b32 v117, 64, v115
  v_xor_b32 v122, 64, v114
  v_xor_b32 v118, 96, v115
  v_xor_b32 v123, 96, v114
  v_mov_b32 v120, v114
  s_mov_b32 s39, 0
k2_poll:
  buffer_load_dwordx2 v[32:33], v113, s[12:15], 0 offen sc0 sc1
  buffer_load_dwordx2 v[34:35], v113, s[12:15], s87 offen sc0 sc1
  buffer_load_dwordx2 v[36:37], v113, s[12:15], s88 offen sc0 sc1
  buffer_load_dwordx2 v[38:39], v113, s[12:15], s89 offen sc0 sc1
  buffer_load_dwordx2 v[40:41], v113, s[12:15], s90 offen sc0 sc1
  buffer_load_dwordx2 v[42:43], v113, s[12:15], s91 offen sc0 sc1
  buffer_load_dwordx2 v[44:45], v113, s[12:15], s92 offen sc0 sc1
  buffer_load_dwordx2 v[46:47], v113, s[12:15], s93 offen sc0 sc1
  s_waitcnt vmcnt(0)
  v_min3_i32 v16, v33, v35, v37
  v_min3_i32 v17, v39, v41, v43
  v_min3_i32 v16, v16, v45, v47
  v_min_i32 v16, v16, v17
  v_cmp_gt_i32 vcc, 0, v16
  s_add_u32 s39, s39, 1
  s_cmp_gt_u32 s39, 100000
  s_cbranch_scc1 k2_pdone
  s_cbranch_vccnz k2_poll
k2_pdone:
  buffer_store_dwordx4 v[96:99], v12, s[20:23], 0 offen offset:0 sc0 sc1
  buffer_store_dwordx4 v[100:103], v12, s[20:23], 0 offen offset:64 sc0 sc1
  buffer_store_dwordx4 v[104:107], v12, s[20:23], 0 offen offset:2048 sc0 sc1
  buffer_store_dwordx4 v[108:111], v12, s[20:23], 0 offen offset:2112 sc0 sc1
  v_pk_add_f32 v[32:33], v[32:33], v[34:35]
  v_pk_add_f32 v[36:37], v[36:37], v[38:39]
  v_pk_add_f32 v[40:41], v[40:41], v[42:43]
  v_pk_add_f32 v[44:45], v[44:45], v[46:47]
  v_pk_add_f32 v[32:33], v[32:33], v[36:37]
  v_pk_add_f32 v[40:41], v[40:41], v[44:45]
  v_pk_add_f32 v[32:33], v[32:33], v[40:41]
  v_mov_b32 v34, v32
  v_mov_b32 v35, v33
  s_nop 0
  v_permlane32_swap_b32 v32, v34
  v_permlane32_swap_b32 v33, v35
  v_add_f32 v32, v32, v34
  v_add_f32 v33, v33, v35
  v_mul_f32 v32, 0x3a800000, v32
  v_mul_f32 v33, 0x3a800000, v33
  v_fma_f32 v33, -v32, v32, v33
  v_max_f32 v33, 0, v33
  v_mov_b32 v36, v33
  v_cvt_pk_bf16_f32 v36, v36, v36
  v_lshlrev_b32 v36, 16, v36
  v_add_f32 v36, 0x3727c5ac, v36
  v_cvt_pk_bf16_f32 v36, v36, v36
  v_lshlrev_b32 v36, 16, v36
  v_sqrt_f32 v36, v36
  s_nop 0
  v_cvt_pk_bf16_f32 v36, v36, v36
  v_lshlrev_b32 v36, 16, v36
  v_rcp_f32 v36, v36
  s_nop 0
  v_mul_f32 v33, v33, v36
  v_mul_f32 v33, v33, v36
  v_cvt_pk_bf16_f32 v33, v33, v33
  v_lshlrev_b32 v33, 16, v33
  v_add_f32 v33, 0x3727c5ac, v33
  v_cvt_pk_bf16_f32 v33, v33, v33
  v_lshlrev_b32 v33, 16, v33
  v_sqrt_f32 v33, v33
  s_nop 0
  v_cvt_pk_bf16_f32 v33, v33, v33
  v_lshlrev_b32 v33, 16, v33
  v_rcp_f32 v33, v33
  s_nop 0
  v_mul_f32 v33, v33, v36
  v_mov_b32 v34, v32
  v_mov_b32 v35, v33
  s_nop 0
  v_permlane16_swap_b32 v32, v34
  v_permlane16_swap_b32 v33, v35
  v_pk_add_f32 v[48:49], v[48:49], v[32:33] op_sel_hi:[1,0] neg_lo:[0,1] neg_hi:[0,1]
  v_pk_add_f32 v[50:51], v[50:51], v[32:33] op_sel_hi:[1,0] neg_lo:[0,1] neg_hi:[0,1]
  v_pk_add_f32 v[52:53], v[52:53], v[32:33] op_sel_hi:[1,0] neg_lo:[0,1] neg_hi:[0,1]
  v_pk_add_f32 v[54:55], v[54:55], v[32:33] op_sel_hi:[1,0] neg_lo:[0,1] neg_hi:[0,1]
  v_pk_add_f32 v[56:57], v[56:57], v[32:33] op_sel_hi:[1,0] neg_lo:[0,1] neg_hi:[0,1]
  v_pk_add_f32 v[58:59], v[58:59], v[32:33] op_sel_hi:[1,0] neg_lo:[0,1] neg_hi:[0,1]
  v_pk_add_f32 v[60:61], v[60:61], v[32:33] op_sel_hi:[1,0] neg_lo:[0,1] neg_hi:[0,1]
  v_pk_add_f32 v[62:63], v[62:63], v[32:33] op_sel_hi:[1,0] neg_lo:[0,1] neg_hi:[0,1]
  v_pk_mul_f32 v[48:49], v[48:49], v[32:33] op_sel:[0,1] op_sel_hi:[1,1]
  v_pk_mul_f32 v[50:51], v[50:51], v[32:33] op_sel:[0,1] op_sel_hi:[1,1]
  v_pk_mul_f32 v[52:53], v[52:53], v[32:33] op_sel:[0,1] op_sel_hi:[1,1]
  v_pk_mul_f32 v[54:55], v[54:55], v[32:33] op_sel:[0,1] op_sel_hi:[1,1]
  v_pk_mul_f32 v[56:57], v[56:57], v[32:33] op_sel:[0,1] op_sel_hi:[1,1]
  v_pk_mul_f32 v[58:59], v[58:59], v[32:33] op_sel:[0,1] op_sel_hi:[1,1]
  v_pk_mul_f32 v[60:61], v[60:61], v[32:33] op_sel:[0,1] op_sel_hi:[1,1]
  v_pk_mul_f32 v[62:63], v[62:63], v[32:33] op_sel:[0,1] op_sel_hi:[1,1]
  v_cvt_pk_bf16_f32 v160, v48, v49
  v_cvt_pk_bf16_f32 v161, v50, v51
  ds_write_b64 v120, v[160:161] offset:0
  v_cvt_pk_bf16_f32 v162, v52, v53
  v_cvt_pk_bf16_f32 v163, v54, v55
  ds_write_b64 v121, v[162:163] offset:0
  v_cvt_pk_bf16_f32 v164, v56, v57
  v_cvt_pk_bf16_f32 v165, v58, v59
  ds_write_b64 v122, v[164:165] offset:0
  v_cvt_pk_bf16_f32 v166, v60, v61
  v_cvt_pk_bf16_f32 v167, v62, v63
  ds_write_b64 v123, v[166:167] offset:0
  v_pk_add_f32 v[64:65], v[64:65], v[34:35] op_sel_hi:[1,0] neg_lo:[0,1] neg_hi:[0,1]
  v_pk_add_f32 v[66:67], v[66:67], v[34:35] op_sel_hi:[1,0] neg_lo:[0,1] neg_hi:[0,1]
  v_pk_add_f32 v[68:69], v[68:69], v[34:35] op_sel_hi:[1,0] neg_lo:[0,1] neg_hi:[0,1]
  v_pk_add_f32 v[70:71], v[70:71], v[34:35] op_sel_hi:[1,0] neg_lo:[0,1] neg_hi:[0,1]
  v_pk_add_f32 v[72:73], v[72:73], v[34:35] op_sel_hi:[1,0] neg_lo:[0,1] neg_hi:[0,1]
  v_pk_add_f32 v[74:75], v[74:75], v[34:35] op_sel_hi:[1,0] neg_lo:[0,1] neg_hi:[0,1]
  v_pk_add_f32 v[76:77], v[76:77], v[34:35] op_sel_hi:[1,0] neg_lo:[0,1] neg_hi:[0,1]
  v_pk_add_f32 v[78:79], v[78:79], v[34:35] op_sel_hi:[1,0] neg_lo:[0,1] neg_hi:[0,1]
  v_pk_mul_f32 v[64:65], v[64:65], v[34:35] op_sel:[0,1] op_sel_hi:[1,1]
  v_pk_mul_f32 v[66:67], v[66:67], v[34:35] op_sel:[0,1] op_sel_hi:[1,1]
  v_pk_mul_f32 v[68:69], v[68:69], v[34:35] op_sel:[0,1] op_sel_hi:[1,1]
  v_pk_mul_f32 v[70:71], v[70:71], v[34:35] op_sel:[0,1] op_sel_hi:[1,1]
  v_pk_mul_f32 v[72:73], v[72:73], v[34:35] op_sel:[0,1] op_sel_hi:[1,1]
  v_pk_mul_f32 v[74:75], v[74:75], v[34:35] op_sel:[0,1] op_sel_hi:[1,1]
  v_pk_mul_f32 v[76:77], v[76:77], v[34:35] op_sel:[0,1] op_sel_hi:[1,1]
  v_pk_mul_f32 v[78:79], v[78:79], v[34:35] op_sel:[0,1] op_sel_hi:[1,1]
  v_cvt_pk_bf16_f32 v168, v64, v65
  v_cvt_pk_bf16_f32 v169, v66, v67
  ds_write_b64 v120, v[168:169] offset:128
  v_cvt_pk_bf16_f32 v170, v68, v69
  v_cvt_pk_bf16_f32 v171, v70, v71
  ds_write_b64 v121, v[170:171] offset:128
  v_cvt_pk_bf16_f32 v172, v72, v73
  v_cvt_pk_bf16_f32 v173, v74, v75
  ds_write_b64 v122, v[172:173] offset:128
  v_cvt_pk_bf16_f32 v174, v76, v77
  v_cvt_pk_bf16_f32 v175, v78, v79
  ds_write_b64 v123, v[174:175] offset:128
  s_waitcnt lgkmcnt(0)
  ds_read_b64_tr_b16 v[176:177], v115
  ds_read_b64_tr_b16 v[178:179], v115 offset:512
  ds_read_b64_tr_b16 v[180:181], v116
  ds_read_b64_tr_b16 v[182:183], v116 offset:512
  ds_read_b64_tr_b16 v[184:185], v117
  ds_read_b64_tr_b16 v[186:187], v117 offset:512
  ds_read_b64_tr_b16 v[188:189], v118
  ds_read_b64_tr_b16 v[190:191], v118 offset:512
  s_waitcnt lgkmcnt(6)
  buffer_store_dwordx4 v[176:179], v14, s[24:27], s44 offen sc0 sc1
  s_waitcnt lgkmcnt(4)
  buffer_store_dwordx4 v[180:183], v14, s[24:27], s45 offen sc0 sc1
  s_waitcnt lgkmcnt(2)
  buffer_store_dwordx4 v[184:187], v14, s[24:27], s46 offen sc0 sc1
  s_waitcnt lgkmcnt(0)
  buffer_store_dwordx4 v[188:191], v14, s[24:27], s47 offen sc0 sc1
  s_cmp_ge_u32 s2, 224
  s_cbranch_scc1 C_k3skip
  s_lshr_b32 s32, s2, 3
  s_mul_i32 s5, s32, 9363
  s_lshr_b32 s5, s5, 16
  s_mul_i32 s6, s5, 7
  s_sub_u32 s6, s32, s6
  s_lshl_b32 s7, s5, 1
  s_add_u32 s7, s7, s6
  s_and_b32 s7, s7, 7
  s_and_b32 s32, s2, 7
  s_lshr_b32 s28, s32, 2
  s_lshl_b32 s28, s28, 2
  s_add_u32 s28, s28, s5
  s_and_b32 s29, s32, 3
  s_mul_i32 s29, s29, 7
  s_add_u32 s29, s29, s6
  s_mov_b32 s30, 7
  s_mov_b32 s31, -1
  s_and_b32 s46, s4, 1
  s_lshr_b32 s41, s4, 1
  s_lshl_b32 s32, s29, 8
  s_lshl_b32 s44, s46, 7
  s_add_u32 s32, s32, s44
  v_lshlrev_b32 v16, 3, v5
  v_add_u32 v16, s32, v16
  s_mov_b32 s16, s74
  s_mov_b32 s17, s75
  s_mov_b32 s18, 7168
  s_mov_b32 s19, 0x20000
  buffer_load_dwordx2 v[144:145], v16, s[16:19], 0 offen offset:0
  buffer_load_dwordx2 v[146:147], v16, s[16:19], 0 offen offset:32
  buffer_load_dwordx2 v[148:149], v16, s[16:19], 0 offen offset:64
  buffer_load_dwordx2 v[150:151], v16, s[16:19], 0 offen offset:96
  s_add_u32 s20, s82, 12582912
  s_addc_u32 s21, s83, 0
  s_mov_b32 s22, 7340032
  s_mov_b32 s23, 0x20000
  v_lshl_add_u32 v17, v5, 3, v6
  v_lshlrev_b32 v17, 8, v17
  v_lshl_add_u32 v17, v7, 3, v17
  v_lshl_or_b32 v18, v2, 2, v6
  v_lshl_add_u32 v17, v18, 5, v17
  s_lshl_b32 s32, s46, 7
  s_add_u32 s32, s32, 16384
  v_xor_b32 v18, s32, v17
  s_lshl_b32 s32, s41, 13
  v_add_u32 v12, s32, v14
  v_xor_b32 v8, 0, v18
  v_xor_b32 v9, 32, v18
  v_xor_b32 v10, 64, v18
  v_xor_b32 v11, 96, v18
  v_bfe_u32 v17, v4, 2, 1
  v_lshlrev_b32 v17, 10, v17
  v_lshl_add_u32 v17, v3, 8, v17
  v_lshrrev_b32 v18, 3, v4
  v_lshl_add_u32 v17, v18, 6, v17
  v_lshl_add_u32 v152, v7, 4, v17
  v_add_u32 v153, 128, v152
  s_lshl_b32 s32, s28, 1
  s_add_u32 s32, s32, s41
  s_mul_i32 s32, s32, 224
  s_lshl_b32 s44, s29, 2
  s_add_u32 s32, s32, s44
  s_lshl_b32 s44, s46, 1
  s_add_u32 s32, s32, s44
  s_lshl_b32 s44, s32, 11
  s_add_u32 s45, s44, 229376
  s_waitcnt vmcnt(0)
  s_barrier
  v_lshlrev_b32 v80, 16, v144
  v_and_b32 v81, 0xffff0000, v144
  v_lshlrev_b32 v82, 16, v145
  v_and_b32 v83, 0xffff0000, v145
  v_mov_b64 v[96:97], v[80:81]
  v_mov_b64 v[98:99], v[82:83]
  v_mov_b64 v[112:113], v[80:81]
  v_mov_b64 v[114:115], v[82:83]
  v_mov_b64 v[128:129], v[80:81]
  v_mov_b64 v[130:131], v[82:83]
  v_lshlrev_b32 v84, 16, v146
  v_and_b32 v85, 0xffff0000, v146
  v_lshlrev_b32 v86, 16, v147
  v_and_b32 v87, 0xffff0000, v147
  v_mov_b64 v[100:101], v[84:85]
  v_mov_b64 v[102:103], v[86:87]
  v_mov_b64 v[116:117], v[84:85]
  v_mov_b64 v[118:119], v[86:87]
  v_mov_b64 v[132:133], v[84:85]
  v_mov_b64 v[134:135], v[86:87]
  v_lshlrev_b32 v88, 16, v148
  v_and_b32 v89, 0xffff0000, v148
  v_lshlrev_b32 v90, 16, v149
  v_and_b32 v91, 0xffff0000, v149
  v_mov_b64 v[104:105], v[88:89]
  v_mov_b64 v[106:107], v[90:91]
  v_mov_b64 v[120:121], v[88:89]
  v_mov_b64 v[122:123], v[90:91]
  v_mov_b64 v[136:137], v[88:89]
  v_mov_b64 v[138:139], v[90:91]
  v_lshlrev_b32 v92, 16, v150
  v_and_b32 v93, 0xffff0000, v150
  v_lshlrev_b32 v94, 16, v151
  v_and_b32 v95, 0xffff0000, v151
  v_mov_b64 v[108:109], v[92:93]
  v_mov_b64 v[110:111], v[94:95]
  v_mov_b64 v[124:125], v[92:93]
  v_mov_b64 v[126:127], v[94:95]
  v_mov_b64 v[140:141], v[92:93]
  v_mov_b64 v[142:143], v[94:95]
  s_barrier
  s_mov_b32 s43, 0
  s_mov_b32 s39, 31
  s_barrier
  ds_read_b64_tr_b16 v[16:17], v8 offset:0
  ds_read_b64_tr_b16 v[18:19], v8 offset:1024
  ds_read_b128 v[32:35], v12 offset:0
  ds_read_b128 v[36:39], v12 offset:2048
  ds_read_b64_tr_b16 v[20:21], v9 offset:0
  ds_read_b64_tr_b16 v[22:23], v9 offset:1024
  ds_read_b64_tr_b16 v[24:25], v10 offset:0
  ds_read_b64_tr_b16 v[26:27], v10 offset:1024
  ds_read_b128 v[40:43], v12 offset:4096
  ds_read_b128 v[44:47], v12 offset:6144
  ds_read_b64_tr_b16 v[28:29], v11 offset:0
  ds_read_b64_tr_b16 v[30:31], v11 offset:1024
  s_add_u32 s40, s43, 32768
  s_cmp_eq_u32 s40, 163840
  s_cselect_b32 s40, 0, s40
  s_sub_u32 s42, s40, s43
  s_mov_b32 s43, s40
cl3:
  s_waitcnt lgkmcnt(9)
  v_mfma_f32_16x16x32_bf16 v[80:83], v[16:19], v[32:35], v[80:83]
  ds_read_b64_tr_b16 v[48:49], v8 offset:8192
  s_waitcnt lgkmcnt(9)
  v_mfma_f32_16x16x32_bf16 v[96:99], v[16:19], v[36:39], v[96:99]
  ds_read_b64_tr_b16 v[50:51], v8 offset:9216
  v_add_u32 v8, s42, v8
  s_waitcnt lgkmcnt(8)
  v_mfma_f32_16x16x32_bf16 v[100:103], v[20:23], v[36:39], v[100:103]
  ds_read_b128 v[64:67], v12 offset:1024
  v_mfma_f32_16x16x32_bf16 v[84:87], v[20:23], v[32:35], v[84:87]
  ds_read_b128 v[68:71], v12 offset:3072
  s_waitcnt lgkmcnt(8)
  v_mfma_f32_16x16x32_bf16 v[88:91], v[24:27], v[32:35], v[88:91]
  ds_read_b64_tr_b16 v[52:53], v9 offset:8192
  v_mfma_f32_16x16x32_bf16 v[104:107], v[24:27], v[36:39], v[104:107]
  ds_read_b64_tr_b16 v[54:55], v9 offset:9216
  v_add_u32 v9, s42, v9
  s_waitcnt lgkmcnt(9)
  v_mfma_f32_16x16x32_bf16 v[120:123], v[24:27], v[40:43], v[120:123]
  ds_read_b64_tr_b16 v[56:57], v10 offset:8192
  v_mfma_f32_16x16x32_bf16 v[116:119], v[20:23], v[40:43], v[116:119]
  ds_read_b64_tr_b16 v[58:59], v10 offset:9216
  v_add_u32 v10, s42, v10
  v_mfma_f32_16x16x32_bf16 v[112:115], v[16:19], v[40:43], v[112:115]
  ds_read_b128 v[72:75], v12 offset:5120
  s_waitcnt lgkmcnt(11)
  v_mfma_f32_16x16x32_bf16 v[128:131], v[16:19], v[44:47], v[128:131]
  ds_read_b128 v[76:79], v12 offset:7168
  v_add_u32 v12, s42, v12
  v_mfma_f32_16x16x32_bf16 v[132:135], v[20:23], v[44:47], v[132:135]
  ds_read_b64_tr_b16 v[60:61], v11 offset:8192
  v_mfma_f32_16x16x32_bf16 v[136:139], v[24:27], v[44:47], v[136:139]
  ds_read_b64_tr_b16 v[62:63], v11 offset:9216
  v_add_u32 v11, s42, v11
  s_waitcnt lgkmcnt(12)
  v_mfma_f32_16x16x32_bf16 v[140:143], v[28:31], v[44:47], v[140:143]
  v_mfma_f32_16x16x32_bf16 v[124:127], v[28:31], v[40:43], v[124:127]
  v_mfma_f32_16x16x32_bf16 v[108:111], v[28:31], v[36:39], v[108:111]
  v_mfma_f32_16x16x32_bf16 v[92:95], v[28:31], v[32:35], v[92:95]
  s_barrier
  s_waitcnt lgkmcnt(9)
  v_mfma_f32_16x16x32_bf16 v[80:83], v[48:51], v[64:67], v[80:83]
  ds_read_b64_tr_b16 v[16:17], v8 offset:0
  s_add_u32 s40, s43, 32768
  s_waitcnt lgkmcnt(9)
  v_mfma_f32_16x16x32_bf16 v[96:99], v[48:51], v[68:71], v[96:99]
  ds_read_b64_tr_b16 v[18:19], v8 offset:1024
  s_cmp_eq_u32 s40, 163840
  s_waitcnt lgkmcnt(8)
  v_mfma_f32_16x16x32_bf16 v[100:103], v[52:55], v[68:71], v[100:103]
  ds_read_b128 v[32:35], v12 offset:0
  s_cselect_b32 s40, 0, s40
  v_mfma_f32_16x16x32_bf16 v[84:87], v[52:55], v[64:67], v[84:87]
  ds_read_b128 v[36:39], v12 offset:2048
  s_sub_u32 s42, s40, s43
  s_waitcnt lgkmcnt(8)
  v_mfma_f32_16x16x32_bf16 v[88:91], v[56:59], v[64:67], v[88:91]
  ds_read_b64_tr_b16 v[20:21], v9 offset:0
  s_mov_b32 s43, s40
  v_mfma_f32_16x16x32_bf16 v[104:107], v[56:59], v[68:71], v[104:107]
  ds_read_b64_tr_b16 v[22:23], v9 offset:1024
  s_waitcnt lgkmcnt(9)
  v_mfma_f32_16x16x32_bf16 v[120:123], v[56:59], v[72:75], v[120:123]
  ds_read_b64_tr_b16 v[24:25], v10 offset:0
  v_mfma_f32_16x16x32_bf16 v[116:119], v[52:55], v[72:75], v[116:119]
  ds_read_b64_tr_b16 v[26:27], v10 offset:1024
  v_mfma_f32_16x16x32_bf16 v[112:115], v[48:51], v[72:75], v[112:115]
  ds_read_b128 v[40:43], v12 offset:4096
  s_waitcnt lgkmcnt(11)
  v_mfma_f32_16x16x32_bf16 v[128:131], v[48:51], v[76:79], v[128:131]
  ds_read_b128 v[44:47], v12 offset:6144
  v_mfma_f32_16x16x32_bf16 v[132:135], v[52:55], v[76:79], v[132:135]
  ds_read_b64_tr_b16 v[28:29], v11 offset:0
  v_mfma_f32_16x16x32_bf16 v[136:139], v[56:59], v[76:79], v[136:139]
  ds_read_b64_tr_b16 v[30:31], v11 offset:1024
  s_waitcnt lgkmcnt(12)
  v_mfma_f32_16x16x32_bf16 v[140:143], v[60:63], v[76:79], v[140:143]
  v_mfma_f32_16x16x32_bf16 v[124:127], v[60:63], v[72:75], v[124:127]
  v_mfma_f32_16x16x32_bf16 v[108:111], v[60:63], v[68:71], v[108:111]
  v_mfma_f32_16x16x32_bf16 v[92:95], v[60:63], v[64:67], v[92:95]
  s_sub_u32 s39, s39, 1
  s_cmp_lg_u32 s39, 0
  s_cbranch_scc1 cl3
  s_waitcnt lgkmcnt(9)
  v_mfma_f32_16x16x32_bf16 v[80:83], v[16:19], v[32:35], v[80:83]
  ds_read_b64_tr_b16 v[48:49], v8 offset:8192
  s_waitcnt lgkmcnt(9)
  v_mfma_f32_16x16x32_bf16 v[96:99], v[16:19], v[36:39], v[96:99]
  ds_read_b64_tr_b16 v[50:51], v8 offset:9216
  s_waitcnt lgkmcnt(8)
  v_mfma_f32_16x16x32_bf16 v[100:103], v[20:23], v[36:39], v[100:103]
  ds_read_b128 v[64:67], v12 offset:1024
  v_mfma_f32_16x16x32_bf16 v[84:87], v[20:23], v[32:35], v[84:87]
  ds_read_b128 v[68:71], v12 offset:3072
  s_waitcnt lgkmcnt(8)
  v_mfma_f32_16x16x32_bf16 v[88:91], v[24:27], v[32:35], v[88:91]
  ds_read_b64_tr_b16 v[52:53], v9 offset:8192
  v_mfma_f32_16x16x32_bf16 v[104:107], v[24:27], v[36:39], v[104:107]
  ds_read_b64_tr_b16 v[54:55], v9 offset:9216
  s_waitcnt lgkmcnt(9)
  v_mfma_f32_16x16x32_bf16 v[120:123], v[24:27], v[40:43], v[120:123]
  ds_read_b64_tr_b16 v[56:57], v10 offset:8192
  v_mfma_f32_16x16x32_bf16 v[116:119], v[20:23], v[40:43], v[116:119]
  ds_read_b64_tr_b16 v[58:59], v10 offset:9216
  v_mfma_f32_16x16x32_bf16 v[112:115], v[16:19], v[40:43], v[112:115]
  ds_read_b128 v[72:75], v12 offset:5120
  s_waitcnt lgkmcnt(11)
  v_mfma_f32_16x16x32_bf16 v[128:131], v[16:19], v[44:47], v[128:131]
  ds_read_b128 v[76:79], v12 offset:7168
  v_mfma_f32_16x16x32_bf16 v[132:135], v[20:23], v[44:47], v[132:135]
  ds_read_b64_tr_b16 v[60:61], v11 offset:8192
  v_mfma_f32_16x16x32_bf16 v[136:139], v[24:27], v[44:47], v[136:139]
  ds_read_b64_tr_b16 v[62:63], v11 offset:9216
  s_waitcnt lgkmcnt(12)
  v_mfma_f32_16x16x32_bf16 v[140:143], v[28:31], v[44:47], v[140:143]
  v_mfma_f32_16x16x32_bf16 v[124:127], v[28:31], v[40:43], v[124:127]
  v_mfma_f32_16x16x32_bf16 v[108:111], v[28:31], v[36:39], v[108:111]
  v_mfma_f32_16x16x32_bf16 v[92:95], v[28:31], v[32:35], v[92:95]
  s_waitcnt lgkmcnt(9)
  v_mfma_f32_16x16x32_bf16 v[80:83], v[48:51], v[64:67], v[80:83]
  s_waitcnt lgkmcnt(8)
  v_mfma_f32_16x16x32_bf16 v[96:99], v[48:51], v[68:71], v[96:99]
  s_waitcnt lgkmcnt(6)
  v_mfma_f32_16x16x32_bf16 v[100:103], v[52:55], v[68:71], v[100:103]
  v_mfma_f32_16x16x32_bf16 v[84:87], v[52:55], v[64:67], v[84:87]
  s_waitcnt lgkmcnt(4)
  v_mfma_f32_16x16x32_bf16 v[88:91], v[56:59], v[64:67], v[88:91]
  v_mfma_f32_16x16x32_bf16 v[104:107], v[56:59], v[68:71], v[104:107]
  s_waitcnt lgkmcnt(3)
  v_mfma_f32_16x16x32_bf16 v[120:123], v[56:59], v[72:75], v[120:123]
  v_mfma_f32_16x16x32_bf16 v[116:119], v[52:55], v[72:75], v[116:119]
  v_mfma_f32_16x16x32_bf16 v[112:115], v[48:51], v[72:75], v[112:115]
  s_waitcnt lgkmcnt(2)
  v_mfma_f32_16x16x32_bf16 v[128:131], v[48:51], v[76:79], v[128:131]
  v_mfma_f32_16x16x32_bf16 v[132:135], v[52:55], v[76:79], v[132:135]
  v_mfma_f32_16x16x32_bf16 v[136:139], v[56:59], v[76:79], v[136:139]
  s_waitcnt lgkmcnt(0)
  v_mfma_f32_16x16x32_bf16 v[140:143], v[60:63], v[76:79], v[140:143]
  v_mfma_f32_16x16x32_bf16 v[124:127], v[60:63], v[72:75], v[124:127]
  v_mfma_f32_16x16x32_bf16 v[108:111], v[60:63], v[68:71], v[108:111]
  v_mfma_f32_16x16x32_bf16 v[92:95], v[60:63], v[64:67], v[92:95]
  s_waitcnt lgkmcnt(0)
  v_mov_b32 v16, 0xc0135761
  v_mov_b32 v17, 0xbdd2d3e8
  v_pk_mul_f32 v[24:25], v[80:81], v[80:81]
  v_pk_mul_f32 v[26:27], v[82:83], v[82:83]
  v_pk_mul_f32 v[28:29], v[84:85], v[84:85]
  v_pk_mul_f32 v[30:31], v[86:87], v[86:87]
  v_pk_fma_f32 v[24:25], v[24:25], v[16:17], v[16:17] op_sel:[0,1,0] op_sel_hi:[1,1,0]
  v_pk_fma_f32 v[26:27], v[26:27], v[16:17], v[16:17] op_sel:[0,1,0] op_sel_hi:[1,1,0]
  v_pk_fma_f32 v[28:29], v[28:29], v[16:17], v[16:17] op_sel:[0,1,0] op_sel_hi:[1,1,0]
  v_pk_fma_f32 v[30:31], v[30:31], v[16:17], v[16:17] op_sel:[0,1,0] op_sel_hi:[1,1,0]
  v_pk_mul_f32 v[24:25], v[24:25], v[80:81]
  v_pk_mul_f32 v[26:27], v[26:27], v[82:83]
  v_pk_mul_f32 v[28:29], v[28:29], v[84:85]
  v_pk_mul_f32 v[30:31], v[30:31], v[86:87]
  v_exp_f32 v24, v24
  v_exp_f32 v25, v25
  v_exp_f32 v26, v26
  v_exp_f32 v27, v27
  v_exp_f32 v28, v28
  v_exp_f32 v29, v29
  v_exp_f32 v30, v30
  v_exp_f32 v31, v31
  v_pk_add_f32 v[24:25], v[24:25], 1.0 op_sel_hi:[1,0]
  v_pk_add_f32 v[26:27], v[26:27], 1.0 op_sel_hi:[1,0]
  v_pk_add_f32 v[28:29], v[28:29], 1.0 op_sel_hi:[1,0]
  v_pk_add_f32 v[30:31], v[30:31], 1.0 op_sel_hi:[1,0]
  v_rcp_f32 v24, v24
  v_rcp_f32 v25, v25
  v_rcp_f32 v26, v26
  v_rcp_f32 v27, v27
  v_rcp_f32 v28, v28
  v_rcp_f32 v29, v29
  v_rcp_f32 v30, v30
  v_rcp_f32 v31, v31
  v_pk_mul_f32 v[24:25], v[24:25], v[80:81]
  v_pk_mul_f32 v[26:27], v[26:27], v[82:83]
  v_pk_mul_f32 v[28:29], v[28:29], v[84:85]
  v_pk_mul_f32 v[30:31], v[30:31], v[86:87]
  v_cvt_pk_bf16_f32 v164, v24, v25
  v_cvt_pk_bf16_f32 v165, v26, v27
  v_cvt_pk_bf16_f32 v166, v28, v29
  v_cvt_pk_bf16_f32 v167, v30, v31
  s_nop 0
  v_permlane16_swap_b32 v164, v166
  v_permlane16_swap_b32 v165, v167
  buffer_store_dwordx4 v[164:167], v152, s[20:23], s44 offen offset:0 sc0 sc1
  v_pk_mul_f32 v[40:41], v[88:89], v[88:89]
  v_pk_mul_f32 v[42:43], v[90:91], v[90:91]
  v_pk_mul_f32 v[44:45], v[92:93], v[92:93]
  v_pk_mul_f32 v[46:47], v[94:95], v[94:95]
  v_pk_fma_f32 v[40:41], v[40:41], v[16:17], v[16:17] op_sel:[0,1,0] op_sel_hi:[1,1,0]
  v_pk_fma_f32 v[42:43], v[42:43], v[16:17], v[16:17] op_sel:[0,1,0] op_sel_hi:[1,1,0]
  v_pk_fma_f32 v[44:45], v[44:45], v[16:17], v[16:17] op_sel:[0,1,0] op_sel_hi:[1,1,0]
  v_pk_fma_f32 v[46:47], v[46:47], v[16:17], v[16:17] op_sel:[0,1,0] op_sel_hi:[1,1,0]
  v_pk_mul_f32 v[40:41], v[40:41], v[88:89]
  v_pk_mul_f32 v[42:43], v[42:43], v[90:91]
  v_pk_mul_f32 v[44:45], v[44:45], v[92:93]
  v_pk_mul_f32 v[46:47], v[46:47], v[94:95]
  v_exp_f32 v40, v40
  v_exp_f32 v41, v41
  v_exp_f32 v42, v42
  v_exp_f32 v43, v43
  v_exp_f32 v44, v44
  v_exp_f32 v45, v45
  v_exp_f32 v46, v46
  v_exp_f32 v47, v47
  v_pk_add_f32 v[40:41], v[40:41], 1.0 op_sel_hi:[1,0]
  v_pk_add_f32 v[42:43], v[42:43], 1.0 op_sel_hi:[1,0]
  v_pk_add_f32 v[44:45], v[44:45], 1.0 op_sel_hi:[1,0]
  v_pk_add_f32 v[46:47], v[46:47], 1.0 op_sel_hi:[1,0]
  v_rcp_f32 v40, v40
  v_rcp_f32 v41, v41
  v_rcp_f32 v42, v42
  v_rcp_f32 v43, v43
  v_rcp_f32 v44, v44
  v_rcp_f32 v45, v45
  v_rcp_f32 v46, v46
  v_rcp_f32 v47, v47
  v_pk_mul_f32 v[40:41], v[40:41], v[88:89]
  v_pk_mul_f32 v[42:43], v[42:43], v[90:91]
  v_pk_mul_f32 v[44:45], v[44:45], v[92:93]
  v_pk_mul_f32 v[46:47], v[46:47], v[94:95]
  v_cvt_pk_bf16_f32 v168, v40, v41
  v_cvt_pk_bf16_f32 v169, v42, v43
  v_cvt_pk_bf16_f32 v170, v44, v45
  v_cvt_pk_bf16_f32 v171, v46, v47
  s_nop 0
  v_permlane16_swap_b32 v168, v170
  v_permlane16_swap_b32 v169, v171
  buffer_store_dwordx4 v[168:171], v152, s[20:23], s44 offen offset:2048 sc0 sc1
  v_pk_mul_f32 v[24:25], v[96:97], v[96:97]
  v_pk_mul_f32 v[26:27], v[98:99], v[98:99]
  v_pk_mul_f32 v[28:29], v[100:101], v[100:101]
  v_pk_mul_f32 v[30:31], v[102:103], v[102:103]
  v_pk_fma_f32 v[24:25], v[24:25], v[16:17], v[16:17] op_sel:[0,1,0] op_sel_hi:[1,1,0]
  v_pk_fma_f32 v[26:27], v[26:27], v[16:17], v[16:17] op_sel:[0,1,0] op_sel_hi:[1,1,0]
  v_pk_fma_f32 v[28:29], v[28:29], v[16:17], v[16:17] op_sel:[0,1,0] op_sel_hi:[1,1,0]
  v_pk_fma_f32 v[30:31], v[30:31], v[16:17], v[16:17] op_sel:[0,1,0] op_sel_hi:[1,1,0]
  v_pk_mul_f32 v[24:25], v[24:25], v[96:97]
  v_pk_mul_f32 v[26:27], v[26:27], v[98:99]
  v_pk_mul_f32 v[28:29], v[28:29], v[100:101]
  v_pk_mul_f32 v[30:31], v[30:31], v[102:103]
  v_exp_f32 v24, v24
  v_exp_f32 v25, v25
  v_exp_f32 v26, v26
  v_exp_f32 v27, v27
  v_exp_f32 v28, v28
  v_exp_f32 v29, v29
  v_exp_f32 v30, v30
  v_exp_f32 v31, v31
  v_pk_add_f32 v[24:25], v[24:25], 1.0 op_sel_hi:[1,0]
  v_pk_add_f32 v[26:27], v[26:27], 1.0 op_sel_hi:[1,0]
  v_pk_add_f32 v[28:29], v[28:29], 1.0 op_sel_hi:[1,0]
  v_pk_add_f32 v[30:31], v[30:31], 1.0 op_sel_hi:[1,0]
  v_rcp_f32 v24, v24
  v_rcp_f32 v25, v25
  v_rcp_f32 v26, v26
  v_rcp_f32 v27, v27
  v_rcp_f32 v28, v28
  v_rcp_f32 v29, v29
  v_rcp_f32 v30, v30
  v_rcp_f32 v31, v31
  v_pk_mul_f32 v[24:25], v[24:25], v[96:97]
  v_pk_mul_f32 v[26:27], v[26:27], v[98:99]
  v_pk_mul_f32 v[28:29], v[28:29], v[100:101]
  v_pk_mul_f32 v[30:31], v[30:31], v[102:103]
  v_cvt_pk_bf16_f32 v172, v24, v25
  v_cvt_pk_bf16_f32 v173, v26, v27
  v_cvt_pk_bf16_f32 v174, v28, v29
  v_cvt_pk_bf16_f32 v175, v30, v31
  s_nop 0
  v_permlane16_swap_b32 v172, v174
  v_permlane16_swap_b32 v173, v175
  buffer_store_dwordx4 v[172:175], v153, s[20:23], s44 offen offset:0 sc0 sc1
  v_pk_mul_f32 v[40:41], v[104:105], v[104:105]
  v_pk_mul_f32 v[42:43], v[106:107], v[106:107]
  v_pk_mul_f32 v[44:45], v[108:109], v[108:109]
  v_pk_mul_f32 v[46:47], v[110:111], v[110:111]
  v_pk_fma_f32 v[40:41], v[40:41], v[16:17], v[16:17] op_sel:[0,1,0] op_sel_hi:[1,1,0]
  v_pk_fma_f32 v[42:43], v[42:43], v[16:17], v[16:17] op_sel:[0,1,0] op_sel_hi:[1,1,0]
  v_pk_fma_f32 v[44:45], v[44:45], v[16:17], v[16:17] op_sel:[0,1,0] op_sel_hi:[1,1,0]
  v_pk_fma_f32 v[46:47], v[46:47], v[16:17], v[16:17] op_sel:[0,1,0] op_sel_hi:[1,1,0]
  v_pk_mul_f32 v[40:41], v[40:41], v[104:105]
  v_pk_mul_f32 v[42:43], v[42:43], v[106:107]
  v_pk_mul_f32 v[44:45], v[44:45], v[108:109]
  v_pk_mul_f32 v[46:47], v[46:47], v[110:111]
  v_exp_f32 v40, v40
  v_exp_f32 v41, v41
  v_exp_f32 v42, v42
  v_exp_f32 v43, v43
  v_exp_f32 v44, v44
  v_exp_f32 v45, v45
  v_exp_f32 v46, v46
  v_exp_f32 v47, v47
  v_pk_add_f32 v[40:41], v[40:41], 1.0 op_sel_hi:[1,0]
  v_pk_add_f32 v[42:43], v[42:43], 1.0 op_sel_hi:[1,0]
  v_pk_add_f32 v[44:45], v[44:45], 1.0 op_sel_hi:[1,0]
  v_pk_add_f32 v[46:47], v[46:47], 1.0 op_sel_hi:[1,0]
  v_rcp_f32 v40, v40
  v_rcp_f32 v41, v41
  v_rcp_f32 v42, v42
  v_rcp_f32 v43, v43
  v_rcp_f32 v44, v44
  v_rcp_f32 v45, v45
  v_rcp_f32 v46, v46
  v_rcp_f32 v47, v47
  v_pk_mul_f32 v[40:41], v[40:41], v[104:105]
  v_pk_mul_f32 v[42:43], v[42:43], v[106:107]
  v_pk_mul_f32 v[44:45], v[44:45], v[108:109]
  v_pk_mul_f32 v[46:47], v[46:47], v[110:111]
  v_cvt_pk_bf16_f32 v176, v40, v41
  v_cvt_pk_bf16_f32 v177, v42, v43
  v_cvt_pk_bf16_f32 v178, v44, v45
  v_cvt_pk_bf16_f32 v179, v46, v47
  s_nop 0
  v_permlane16_swap_b32 v176, v178
  v_permlane16_swap_b32 v177, v179
  buffer_store_dwordx4 v[176:179], v153, s[20:23], s44 offen offset:2048 sc0 sc1
  v_pk_mul_f32 v[24:25], v[112:113], v[112:113]
  v_pk_mul_f32 v[26:27], v[114:115], v[114:115]
  v_pk_mul_f32 v[28:29], v[116:117], v[116:117]
  v_pk_mul_f32 v[30:31], v[118:119], v[118:119]
  v_pk_fma_f32 v[24:25], v[24:25], v[16:17], v[16:17] op_sel:[0,1,0] op_sel_hi:[1,1,0]
  v_pk_fma_f32 v[26:27], v[26:27], v[16:17], v[16:17] op_sel:[0,1,0] op_sel_hi:[1,1,0]
  v_pk_fma_f32 v[28:29], v[28:29], v[16:17], v[16:17] op_sel:[0,1,0] op_sel_hi:[1,1,0]
  v_pk_fma_f32 v[30:31], v[30:31], v[16:17], v[16:17] op_sel:[0,1,0] op_sel_hi:[1,1,0]
  v_pk_mul_f32 v[24:25], v[24:25], v[112:113]
  v_pk_mul_f32 v[26:27], v[26:27], v[114:115]
  v_pk_mul_f32 v[28:29], v[28:29], v[116:117]
  v_pk_mul_f32 v[30:31], v[30:31], v[118:119]
  v_exp_f32 v24, v24
  v_exp_f32 v25, v25
  v_exp_f32 v26, v26
  v_exp_f32 v27, v27
  v_exp_f32 v28, v28
  v_exp_f32 v29, v29
  v_exp_f32 v30, v30
  v_exp_f32 v31, v31
  v_pk_add_f32 v[24:25], v[24:25], 1.0 op_sel_hi:[1,0]
  v_pk_add_f32 v[26:27], v[26:27], 1.0 op_sel_hi:[1,0]
  v_pk_add_f32 v[28:29], v[28:29], 1.0 op_sel_hi:[1,0]
  v_pk_add_f32 v[30:31], v[30:31], 1.0 op_sel_hi:[1,0]
  v_rcp_f32 v24, v24
  v_rcp_f32 v25, v25
  v_rcp_f32 v26, v26
  v_rcp_f32 v27, v27
  v_rcp_f32 v28, v28
  v_rcp_f32 v29, v29
  v_rcp_f32 v30, v30
  v_rcp_f32 v31, v31
  v_pk_mul_f32 v[24:25], v[24:25], v[112:113]
  v_pk_mul_f32 v[26:27], v[26:27], v[114:115]
  v_pk_mul_f32 v[28:29], v[28:29], v[116:117]
  v_pk_mul_f32 v[30:31], v[30:31], v[118:119]
  v_cvt_pk_bf16_f32 v180, v24, v25
  v_cvt_pk_bf16_f32 v181, v26, v27
  v_cvt_pk_bf16_f32 v182, v28, v29
  v_cvt_pk_bf16_f32 v183, v30, v31
  s_nop 0
  v_permlane16_swap_b32 v180, v182
  v_permlane16_swap_b32 v181, v183
  buffer_store_dwordx4 v[180:183], v152, s[20:23], s45 offen offset:0 sc0 sc1
  v_pk_mul_f32 v[40:41], v[120:121], v[120:121]
  v_pk_mul_f32 v[42:43], v[122:123], v[122:123]
  v_pk_mul_f32 v[44:45], v[124:125], v[124:125]
  v_pk_mul_f32 v[46:47], v[126:127], v[126:127]
  v_pk_fma_f32 v[40:41], v[40:41], v[16:17], v[16:17] op_sel:[0,1,0] op_sel_hi:[1,1,0]
  v_pk_fma_f32 v[42:43], v[42:43], v[16:17], v[16:17] op_sel:[0,1,0] op_sel_hi:[1,1,0]
  v_pk_fma_f32 v[44:45], v[44:45], v[16:17], v[16:17] op_sel:[0,1,0] op_sel_hi:[1,1,0]
  v_pk_fma_f32 v[46:47], v[46:47], v[16:17], v[16:17] op_sel:[0,1,0] op_sel_hi:[1,1,0]
  v_pk_mul_f32 v[40:41], v[40:41], v[120:121]
  v_pk_mul_f32 v[42:43], v[42:43], v[122:123]
  v_pk_mul_f32 v[44:45], v[44:45], v[124:125]
  v_pk_mul_f32 v[46:47], v[46:47], v[126:127]
  v_exp_f32 v40, v40
  v_exp_f32 v41, v41
  v_exp_f32 v42, v42
  v_exp_f32 v43, v43
  v_exp_f32 v44, v44
  v_exp_f32 v45, v45
  v_exp_f32 v46, v46
  v_exp_f32 v47, v47
  v_pk_add_f32 v[40:41], v[40:41], 1.0 op_sel_hi:[1,0]
  v_pk_add_f32 v[42:43], v[42:43], 1.0 op_sel_hi:[1,0]
  v_pk_add_f32 v[44:45], v[44:45], 1.0 op_sel_hi:[1,0]
  v_pk_add_f32 v[46:47], v[46:47], 1.0 op_sel_hi:[1,0]
  v_rcp_f32 v40, v40
  v_rcp_f32 v41, v41
  v_rcp_f32 v42, v42
  v_rcp_f32 v43, v43
  v_rcp_f32 v44, v44
  v_rcp_f32 v45, v45
  v_rcp_f32 v46, v46
  v_rcp_f32 v47, v47
  v_pk_mul_f32 v[40:41], v[40:41], v[120:121]
  v_pk_mul_f32 v[42:43], v[42:43], v[122:123]
  v_pk_mul_f32 v[44:45], v[44:45], v[124:125]
  v_pk_mul_f32 v[46:47], v[46:47], v[126:127]
  v_cvt_pk_bf16_f32 v184, v40, v41
  v_cvt_pk_bf16_f32 v185, v42, v43
  v_cvt_pk_bf16_f32 v186, v44, v45
  v_cvt_pk_bf16_f32 v187, v46, v47
  s_nop 0
  v_permlane16_swap_b32 v184, v186
  v_permlane16_swap_b32 v185, v187
  buffer_store_dwordx4 v[184:187], v152, s[20:23], s45 offen offset:2048 sc0 sc1
  v_pk_mul_f32 v[24:25], v[128:129], v[128:129]
  v_pk_mul_f32 v[26:27], v[130:131], v[130:131]
  v_pk_mul_f32 v[28:29], v[132:133], v[132:133]
  v_pk_mul_f32 v[30:31], v[134:135], v[134:135]
  v_pk_fma_f32 v[24:25], v[24:25], v[16:17], v[16:17] op_sel:[0,1,0] op_sel_hi:[1,1,0]
  v_pk_fma_f32 v[26:27], v[26:27], v[16:17], v[16:17] op_sel:[0,1,0] op_sel_hi:[1,1,0]
  v_pk_fma_f32 v[28:29], v[28:29], v[16:17], v[16:17] op_sel:[0,1,0] op_sel_hi:[1,1,0]
  v_pk_fma_f32 v[30:31], v[30:31], v[16:17], v[16:17] op_sel:[0,1,0] op_sel_hi:[1,1,0]
  v_pk_mul_f32 v[24:25], v[24:25], v[128:129]
  v_pk_mul_f32 v[26:27], v[26:27], v[130:131]
  v_pk_mul_f32 v[28:29], v[28:29], v[132:133]
  v_pk_mul_f32 v[30:31], v[30:31], v[134:135]
  v_exp_f32 v24, v24
  v_exp_f32 v25, v25
  v_exp_f32 v26, v26
  v_exp_f32 v27, v27
  v_exp_f32 v28, v28
  v_exp_f32 v29, v29
  v_exp_f32 v30, v30
  v_exp_f32 v31, v31
  v_pk_add_f32 v[24:25], v[24:25], 1.0 op_sel_hi:[1,0]
  v_pk_add_f32 v[26:27], v[26:27], 1.0 op_sel_hi:[1,0]
  v_pk_add_f32 v[28:29], v[28:29], 1.0 op_sel_hi:[1,0]
  v_pk_add_f32 v[30:31], v[30:31], 1.0 op_sel_hi:[1,0]
  v_rcp_f32 v24, v24
  v_rcp_f32 v25, v25
  v_rcp_f32 v26, v26
  v_rcp_f32 v27, v27
  v_rcp_f32 v28, v28
  v_rcp_f32 v29, v29
  v_rcp_f32 v30, v30
  v_rcp_f32 v31, v31
  v_pk_mul_f32 v[24:25], v[24:25], v[128:129]
  v_pk_mul_f32 v[26:27], v[26:27], v[130:131]
  v_pk_mul_f32 v[28:29], v[28:29], v[132:133]
  v_pk_mul_f32 v[30:31], v[30:31], v[134:135]
  v_cvt_pk_bf16_f32 v188, v24, v25
  v_cvt_pk_bf16_f32 v189, v26, v27
  v_cvt_pk_bf16_f32 v190, v28, v29
  v_cvt_pk_bf16_f32 v191, v30, v31
  s_nop 0
  v_permlane16_swap_b32 v188, v190
  v_permlane16_swap_b32 v189, v191
  buffer_store_dwordx4 v[188:191], v153, s[20:23], s45 offen offset:0 sc0 sc1
  v_pk_mul_f32 v[40:41], v[136:137], v[136:137]
  v_pk_mul_f32 v[42:43], v[138:139], v[138:139]
  v_pk_mul_f32 v[44:45], v[140:141], v[140:141]
  v_pk_mul_f32 v[46:47], v[142:143], v[142:143]
  v_pk_fma_f32 v[40:41], v[40:41], v[16:17], v[16:17] op_sel:[0,1,0] op_sel_hi:[1,1,0]
  v_pk_fma_f32 v[42:43], v[42:43], v[16:17], v[16:17] op_sel:[0,1,0] op_sel_hi:[1,1,0]
  v_pk_fma_f32 v[44:45], v[44:45], v[16:17], v[16:17] op_sel:[0,1,0] op_sel_hi:[1,1,0]
  v_pk_fma_f32 v[46:47], v[46:47], v[16:17], v[16:17] op_sel:[0,1,0] op_sel_hi:[1,1,0]
  v_pk_mul_f32 v[40:41], v[40:41], v[136:137]
  v_pk_mul_f32 v[42:43], v[42:43], v[138:139]
  v_pk_mul_f32 v[44:45], v[44:45], v[140:141]
  v_pk_mul_f32 v[46:47], v[46:47], v[142:143]
  v_exp_f32 v40, v40
  v_exp_f32 v41, v41
  v_exp_f32 v42, v42
  v_exp_f32 v43, v43
  v_exp_f32 v44, v44
  v_exp_f32 v45, v45
  v_exp_f32 v46, v46
  v_exp_f32 v47, v47
  v_pk_add_f32 v[40:41], v[40:41], 1.0 op_sel_hi:[1,0]
  v_pk_add_f32 v[42:43], v[42:43], 1.0 op_sel_hi:[1,0]
  v_pk_add_f32 v[44:45], v[44:45], 1.0 op_sel_hi:[1,0]
  v_pk_add_f32 v[46:47], v[46:47], 1.0 op_sel_hi:[1,0]
  v_rcp_f32 v40, v40
  v_rcp_f32 v41, v41
  v_rcp_f32 v42, v42
  v_rcp_f32 v43, v43
  v_rcp_f32 v44, v44
  v_rcp_f32 v45, v45
  v_rcp_f32 v46, v46
  v_rcp_f32 v47, v47
  v_pk_mul_f32 v[40:41], v[40:41], v[136:137]
  v_pk_mul_f32 v[42:43], v[42:43], v[138:139]
  v_pk_mul_f32 v[44:45], v[44:45], v[140:141]
  v_pk_mul_f32 v[46:47], v[46:47], v[142:143]
  v_cvt_pk_bf16_f32 v192, v40, v41
  v_cvt_pk_bf16_f32 v193, v42, v43
  v_cvt_pk_bf16_f32 v194, v44, v45
  v_cvt_pk_bf16_f32 v195, v46, v47
  s_nop 0
  v_permlane16_swap_b32 v192, v194
  v_permlane16_swap_b32 v193, v195
  buffer_store_dwordx4 v[192:195], v153, s[20:23], s45 offen offset:2048 sc0 sc1
C_k3skip:
  s_nop 7
  s_nop 7
  s_lshr_b32 s32, s2, 3
  s_lshr_b32 s5, s32, 3
  s_and_b32 s6, s32, 7
  s_lshl_b32 s7, s5, 1
  s_add_u32 s7, s7, s6
  s_and_b32 s7, s7, 7
  s_and_b32 s32, s2, 7
  s_lshr_b32 s28, s32, 2
  s_lshl_b32 s28, s28, 2
  s_add_u32 s28, s28, s5
  s_and_b32 s29, s32, 3
  s_mul_i32 s29, s29, 8
  s_add_u32 s29, s29, s6
  s_mov_b32 s30, 7
  s_mov_b32 s31, -1
  s_lshl_b32 s32, s29, 6
  v_add_u32 v13, s32, v4
  v_lshlrev_b32 v12, 11, v13
  v_lshl_add_u32 v12, v5, 4, v12
  s_lshl_b32 s32, s28, 8
  s_lshl_b32 s40, s4, 6
  s_add_u32 s32, s32, s40
  v_add_u32 v12, s32, v12
  v_lshlrev_b32 v13, 1, v13
  v_lshlrev_b32 v14, 4, v0
  s_lshl_b32 s34, s28, 2
  s_add_u32 s34, s34, s4
  s_mul_i32 s34, s34, 229376
  s_mov_b32 s45, 32768
  s_mov_b32 s46, 65536
  s_mov_b32 s47, 98304
  s_add_u32 s8, s82, 12582912
  s_addc_u32 s9, s83, 0
  s_mov_b32 s10, 7340032
  s_mov_b32 s11, 0x20000
  s_add_u32 s16, s82, 4194304
  s_addc_u32 s17, s83, 0
  s_mov_b32 s18, 4194304
  s_mov_b32 s19, 0x20000
  s_mov_b32 s12, s78
  s_mov_b32 s13, s79
  s_mov_b32 s14, 4096
  s_mov_b32 s15, 0x20000
  buffer_load_ushort v112, v13, s[12:15], 0 offen offset:0
  buffer_load_ushort v114, v13, s[12:15], 0 offen offset:32
  buffer_load_ushort v116, v13, s[12:15], 0 offen offset:64
  buffer_load_ushort v118, v13, s[12:15], 0 offen offset:96
  v_lshl_add_u32 v16, v5, 3, v6
  v_lshlrev_b32 v16, 7, v16
  v_lshl_add_u32 v16, v7, 3, v16
  v_lshrrev_b32 v17, 1, v6
  v_lshl_or_b32 v17, v2, 1, v17
  v_lshl_add_u32 v16, v17, 5, v16
  v_add_u32 v16, 98304, v16
  v_xor_b32 v8, 0, v16
  v_xor_b32 v9, 32, v16
  v_xor_b32 v10, 64, v16
  v_xor_b32 v11, 96, v16
  s_lshl_b32 s48, 0x303, s7
  s_lshr_b32 s48, s48, 8
  s_mov_b32 s49, s34
  s_add_u32 s50, s34, 32768
  s_add_u32 s41, s34, 229376
  v_lshlrev_b32 v222, 3, v0
  s_lshl_b32 s32, s4, 9
  s_add_u32 s32, s32, 90112
  v_add_u32 v223, s32, v222
  s_add_u32 s24, s84, 29360128
  s_addc_u32 s25, s85, 0
  s_mov_b32 s26, 262144
  s_mov_b32 s27, 0x20000
  s_lshl_b32 s32, s28, 5
  v_min_u32 v15, 27, v0
  v_add_u32 v15, s32, v15
  v_max_i32 v15, 0, v15
  v_lshlrev_b32 v15, 7, v15
  s_lshl_b32 s55, s3, 17
  s_add_u32 s55, s55, 65536
  s_waitcnt vmcnt(0)
  s_barrier
  s_cmp_lt_u32 s2, 224
  s_cbranch_scc1 C_nopf
  s_cmp_lg_u32 s3, 0
  s_cbranch_scc1 C_nopf
  s_mov_b32 s20, s76
  s_mov_b32 s21, s77
  s_mov_b32 s22, 14680064
  s_mov_b32 s23, 0x20000
  s_sub_u32 s32, s2, 224
  s_lshl_b32 s32, s32, 2
  s_add_u32 s32, s32, s4
  s_lshl_b32 s32, s32, 13
  v_lshlrev_b32 v17, 7, v0
  buffer_load_dword v18, v17, s[20:23], s32 offen
  s_add_u32 s32, s32, 1048576
  buffer_load_dword v18, v17, s[20:23], s32 offen
  s_add_u32 s32, s32, 1048576
  s_waitcnt vmcnt(1)
  buffer_load_dword v18, v17, s[20:23], s32 offen
  s_add_u32 s32, s32, 1048576
  s_waitcnt vmcnt(1)
  buffer_load_dword v18, v17, s[20:23], s32 offen
  s_add_u32 s32, s32, 1048576
  s_waitcnt vmcnt(1)
  buffer_load_dword v18, v17, s[20:23], s32 offen
  s_add_u32 s32, s32, 1048576
  s_waitcnt vmcnt(1)
  buffer_load_dword v18, v17, s[20:23], s32 offen
  s_add_u32 s32, s32, 1048576
  s_waitcnt vmcnt(1)
  buffer_load_dword v18, v17, s[20:23], s32 offen
  s_add_u32 s32, s32, 1048576
  s_waitcnt vmcnt(1)
  buffer_load_dword v18, v17, s[20:23], s32 offen
  s_add_u32 s32, s32, 1048576
  s_waitcnt vmcnt(1)
  buffer_load_dword v18, v17, s[20:23], s32 offen
  s_add_u32 s32, s32, 1048576
  s_waitcnt vmcnt(1)
  buffer_load_dword v18, v17, s[20:23], s32 offen
  s_add_u32 s32, s32, 1048576
  s_waitcnt vmcnt(1)
  buffer_load_dword v18, v17, s[20:23], s32 offen
  s_add_u32 s32, s32, 1048576
  s_waitcnt vmcnt(1)
  buffer_load_dword v18, v17, s[20:23], s32 offen
  s_add_u32 s32, s32, 1048576
  s_waitcnt vmcnt(1)
  buffer_load_dword v18, v17, s[20:23], s32 offen
  s_add_u32 s32, s32, 1048576
  s_waitcnt vmcnt(1)
  buffer_load_dword v18, v17, s[20:23], s32 offen
  s_add_u32 s32, s32, 1048576
  s_waitcnt vmcnt(1)
C_nopf:
  s_mov_b32 s39, 0
  s_and_b32 s32, s4, 3
  s_cmp_lg_u32 s32, 0
  s_cbranch_scc1 poll4d
  s_sleep 8
poll4:
  buffer_load_dword v16, v15, s[24:27], s55 offen sc0 sc1
  s_waitcnt vmcnt(0)
  v_cmp_eq_u32 vcc, 0, v16
  s_add_u32 s39, s39, 1
  s_cmp_gt_u32 s39, 100000
  s_cbranch_scc1 poll4d
  s_cbranch_vccnz poll4
poll4d:
  s_barrier
  buffer_load_dwordx4 v[96:99], v12, s[16:19], 0 offen sc1
  buffer_load_dwordx4 v[100:103], v12, s[16:19], s45 offen sc1
  buffer_load_dwordx4 v[104:107], v12, s[16:19], s46 offen sc1
  buffer_load_dwordx4 v[108:111], v12, s[16:19], s47 offen sc1
  s_cmp_eq_u32 s3, 0
  s_cselect_b32 s24, s84, s80
  s_cselect_b32 s25, s85, s81
  s_cselect_b32 s26, 25165824, 0
  s_add_u32 s24, s24, s26
  s_addc_u32 s25, s25, 0
  s_mov_b32 s26, 4194304
  s_mov_b32 s27, 0x20000
  s_add_u32 s12, s84, 55574528
  s_addc_u32 s13, s85, 0
  s_mov_b32 s14, 131072
  s_mov_b32 s15, 0x20000
  s_bitcmp1_b32 s48, 0
  s_cselect_b32 s36, s50, s49
  s_add_u32 s36, s36, 0
  buffer_load_dwordx4 v[120:123], v14, s[8:11], s36 offen offset:0 sc1
  buffer_load_dwordx4 v[124:127], v14, s[8:11], s36 offen offset:1024 sc1
  buffer_load_dwordx4 v[128:131], v14, s[8:11], s36 offen offset:2048 sc1
  buffer_load_dwordx4 v[132:135], v14, s[8:11], s36 offen offset:3072 sc1
  s_bitcmp1_b32 s48, 1
  s_cselect_b32 s36, s50, s49
  s_add_u32 s36, s36, 4096
  buffer_load_dwordx4 v[136:139], v14, s[8:11], s36 offen offset:0 sc1
  buffer_load_dwordx4 v[140:143], v14, s[8:11], s36 offen offset:1024 sc1
  buffer_load_dwordx4 v[144:147], v14, s[8:11], s36 offen offset:2048 sc1
  buffer_load_dwordx4 v[148:151], v14, s[8:11], s36 offen offset:3072 sc1
  s_waitcnt vmcnt(8)
  v_lshlrev_b32 v112, 16, v112
  v_lshlrev_b32 v48, 16, v96
  v_and_b32 v49, 0xffff0000, v96
  v_lshlrev_b32 v50, 16, v97
  v_and_b32 v51, 0xffff0000, v97
  v_lshlrev_b32 v52, 16, v98
  v_and_b32 v53, 0xffff0000, v98
  v_lshlrev_b32 v54, 16, v99
  v_and_b32 v55, 0xffff0000, v99
  v_pk_add_f32 v[48:49], v[48:49], v[112:113] op_sel_hi:[1,0]
  v_pk_add_f32 v[50:51], v[50:51], v[112:113] op_sel_hi:[1,0]
  v_pk_add_f32 v[52:53], v[52:53], v[112:113] op_sel_hi:[1,0]
  v_pk_add_f32 v[54:55], v[54:55], v[112:113] op_sel_hi:[1,0]
  v_lshlrev_b32 v114, 16, v114
  v_lshlrev_b32 v56, 16, v100
  v_and_b32 v57, 0xffff0000, v100
  v_lshlrev_b32 v58, 16, v101
  v_and_b32 v59, 0xffff0000, v101
  v_lshlrev_b32 v60, 16, v102
  v_and_b32 v61, 0xffff0000, v102
  v_lshlrev_b32 v62, 16, v103
  v_and_b32 v63, 0xffff0000, v103
  v_pk_add_f32 v[56:57], v[56:57], v[114:115] op_sel_hi:[1,0]
  v_pk_add_f32 v[58:59], v[58:59], v[114:115] op_sel_hi:[1,0]
  v_pk_add_f32 v[60:61], v[60:61], v[114:115] op_sel_hi:[1,0]
  v_pk_add_f32 v[62:63], v[62:63], v[114:115] op_sel_hi:[1,0]
  v_lshlrev_b32 v116, 16, v116
  v_lshlrev_b32 v64, 16, v104
  v_and_b32 v65, 0xffff0000, v104
  v_lshlrev_b32 v66, 16, v105
  v_and_b32 v67, 0xffff0000, v105
  v_lshlrev_b32 v68, 16, v106
  v_and_b32 v69, 0xffff0000, v106
  v_lshlrev_b32 v70, 16, v107
  v_and_b32 v71, 0xffff0000, v107
  v_pk_add_f32 v[64:65], v[64:65], v[116:117] op_sel_hi:[1,0]
  v_pk_add_f32 v[66:67], v[66:67], v[116:117] op_sel_hi:[1,0]
  v_pk_add_f32 v[68:69], v[68:69], v[116:117] op_sel_hi:[1,0]
  v_pk_add_f32 v[70:71], v[70:71], v[116:117] op_sel_hi:[1,0]
  v_lshlrev_b32 v118, 16, v118
  v_lshlrev_b32 v72, 16, v108
  v_and_b32 v73, 0xffff0000, v108
  v_lshlrev_b32 v74, 16, v109
  v_and_b32 v75, 0xffff0000, v109
  v_lshlrev_b32 v76, 16, v110
  v_and_b32 v77, 0xffff0000, v110
  v_lshlrev_b32 v78, 16, v111
  v_and_b32 v79, 0xffff0000, v111
  v_pk_add_f32 v[72:73], v[72:73], v[118:119] op_sel_hi:[1,0]
  v_pk_add_f32 v[74:75], v[74:75], v[118:119] op_sel_hi:[1,0]
  v_pk_add_f32 v[76:77], v[76:77], v[118:119] op_sel_hi:[1,0]
  v_pk_add_f32 v[78:79], v[78:79], v[118:119] op_sel_hi:[1,0]
  s_bitcmp1_b32 s48, 2
  s_cselect_b32 s36, s50, s49
  s_add_u32 s36, s36, 8192
  buffer_load_dwordx4 v[152:155], v14, s[8:11], s36 offen offset:0 sc1
  buffer_load_dwordx4 v[156:159], v14, s[8:11], s36 offen offset:1024 sc1
  buffer_load_dwordx4 v[160:163], v14, s[8:11], s36 offen offset:2048 sc1
  buffer_load_dwordx4 v[164:167], v14, s[8:11], s36 offen offset:3072 sc1
  s_bitcmp1_b32 s48, 3
  s_cselect_b32 s36, s50, s49
  s_add_u32 s36, s36, 12288
  buffer_load_dwordx4 v[168:171], v14, s[8:11], s36 offen offset:0 sc1
  buffer_load_dwordx4 v[172:175], v14, s[8:11], s36 offen offset:1024 sc1
  s_mov_b32 s43, 0
  s_mov_b32 s39, 6
  s_barrier
  ds_read_b64_tr_b16 v[16:17], v8 offset:0
  ds_read_b64_tr_b16 v[18:19], v8 offset:512
  ds_read_b64_tr_b16 v[20:21], v9 offset:0
  ds_read_b64_tr_b16 v[22:23], v9 offset:512
  ds_read_b64_tr_b16 v[24:25], v10 offset:0
  ds_read_b64_tr_b16 v[26:27], v10 offset:512
  ds_read_b64_tr_b16 v[28:29], v11 offset:0
  ds_read_b64_tr_b16 v[30:31], v11 offset:512
  s_add_u32 s40, s43, 8192
  s_cmp_eq_u32 s40, 65536
  s_cselect_b32 s40, 0, s40
  s_sub_u32 s42, s40, s43
  s_mov_b32 s43, s40
cd5:
  s_waitcnt vmcnt(13) lgkmcnt(6)
  v_mfma_f32_16x16x32_bf16 v[48:51], v[120:123], v[16:19], v[48:51]
  ds_read_b64_tr_b16 v[32:33], v8 offset:4096
  s_waitcnt vmcnt(12)
  v_mfma_f32_16x16x32_bf16 v[52:55], v[124:127], v[16:19], v[52:55]
  ds_read_b64_tr_b16 v[34:35], v8 offset:4608
  v_add_u32 v8, s42, v8
  s_waitcnt lgkmcnt(6)
  v_mfma_f32_16x16x32_bf16 v[60:63], v[124:127], v[20:23], v[60:63]
  ds_read_b64_tr_b16 v[36:37], v9 offset:4096
  buffer_load_dwordx4 v[176:179], v14, s[8:11], s36 offen offset:2048 sc1
  v_mfma_f32_16x16x32_bf16 v[56:59], v[120:123], v[20:23], v[56:59]
  ds_read_b64_tr_b16 v[38:39], v9 offset:4608
  v_add_u32 v9, s42, v9
  s_waitcnt lgkmcnt(6)
  v_mfma_f32_16x16x32_bf16 v[64:67], v[120:123], v[24:27], v[64:67]
  ds_read_b64_tr_b16 v[40:41], v10 offset:4096
  v_mfma_f32_16x16x32_bf16 v[68:71], v[124:127], v[24:27], v[68:71]
  ds_read_b64_tr_b16 v[42:43], v10 offset:4608
  v_add_u32 v10, s42, v10
  s_waitcnt lgkmcnt(6)
  v_mfma_f32_16x16x32_bf16 v[76:79], v[124:127], v[28:31], v[76:79]
  ds_read_b64_tr_b16 v[44:45], v11 offset:4096
  buffer_load_dwordx4 v[180:183], v14, s[8:11], s36 offen offset:3072 sc1
  v_mfma_f32_16x16x32_bf16 v[72:75], v[120:123], v[28:31], v[72:75]
  ds_read_b64_tr_b16 v[46:47], v11 offset:4608
  v_add_u32 v11, s42, v11
  s_barrier
  s_waitcnt vmcnt(13) lgkmcnt(6)
  v_mfma_f32_16x16x32_bf16 v[48:51], v[128:131], v[32:35], v[48:51]
  ds_read_b64_tr_b16 v[16:17], v8 offset:0
  s_bitcmp1_b32 s48, 4
  s_cselect_b32 s36, s50, s49
  s_waitcnt vmcnt(12)
  v_mfma_f32_16x16x32_bf16 v[52:55], v[132:135], v[32:35], v[52:55]
  ds_read_b64_tr_b16 v[18:19], v8 offset:512
  s_add_u32 s36, s36, 16384
  s_add_u32 s40, s43, 8192
  s_waitcnt lgkmcnt(6)
  v_mfma_f32_16x16x32_bf16 v[60:63], v[132:135], v[36:39], v[60:63]
  ds_read_b64_tr_b16 v[20:21], v9 offset:0
  s_cmp_eq_u32 s40, 65536
  s_cselect_b32 s40, 0, s40
  v_mfma_f32_16x16x32_bf16 v[56:59], v[128:131], v[36:39], v[56:59]
  ds_read_b64_tr_b16 v[22:23], v9 offset:512
  s_sub_u32 s42, s40, s43
  s_mov_b32 s43, s40
  s_waitcnt lgkmcnt(6)
  v_mfma_f32_16x16x32_bf16 v[64:67], v[128:131], v[40:43], v[64:67]
  ds_read_b64_tr_b16 v[24:25], v10 offset:0
  buffer_load_dwordx4 v[120:123], v14, s[8:11], s36 offen offset:0 sc1
  v_mfma_f32_16x16x32_bf16 v[68:71], v[132:135], v[40:43], v[68:71]
  ds_read_b64_tr_b16 v[26:27], v10 offset:512
  s_waitcnt lgkmcnt(6)
  v_mfma_f32_16x16x32_bf16 v[76:79], v[132:135], v[44:47], v[76:79]
  ds_read_b64_tr_b16 v[28:29], v11 offset:0
  v_mfma_f32_16x16x32_bf16 v[72:75], v[128:131], v[44:47], v[72:75]
  ds_read_b64_tr_b16 v[30:31], v11 offset:512
  buffer_load_dwordx4 v[124:127], v14, s[8:11], s36 offen offset:1024 sc1
  s_waitcnt vmcnt(13) lgkmcnt(6)
  v_mfma_f32_16x16x32_bf16 v[48:51], v[136:139], v[16:19], v[48:51]
  ds_read_b64_tr_b16 v[32:33], v8 offset:4096
  s_waitcnt vmcnt(12)
  v_mfma_f32_16x16x32_bf16 v[52:55], v[140:143], v[16:19], v[52:55]
  ds_read_b64_tr_b16 v[34:35], v8 offset:4608
  v_add_u32 v8, s42, v8
  s_waitcnt lgkmcnt(6)
  v_mfma_f32_16x16x32_bf16 v[60:63], v[140:143], v[20:23], v[60:63]
  ds_read_b64_tr_b16 v[36:37], v9 offset:4096
  buffer_load_dwordx4 v[128:131], v14, s[8:11], s36 offen offset:2048 sc1
  v_mfma_f32_16x16x32_bf16 v[56:59], v[136:139], v[20:23], v[56:59]
  ds_read_b64_tr_b16 v[38:39], v9 offset:4608
  v_add_u32 v9, s42, v9
  s_waitcnt lgkmcnt(6)
  v_mfma_f32_16x16x32_bf16 v[64:67], v[136:139], v[24:27], v[64:67]
  ds_read_b64_tr_b16 v[40:41], v10 offset:4096
  v_mfma_f32_16x16x32_bf16 v[68:71], v[140:143], v[24:27], v[68:71]
  ds_read_b64_tr_b16 v[42:43], v10 offset:4608
  v_add_u32 v10, s42, v10
  s_waitcnt lgkmcnt(6)
  v_mfma_f32_16x16x32_bf16 v[76:79], v[140:143], v[28:31], v[76:79]
  ds_read_b64_tr_b16 v[44:45], v11 offset:4096
  buffer_load_dwordx4 v[132:135], v14, s[8:11], s36 offen offset:3072 sc1
  v_mfma_f32_16x16x32_bf16 v[72:75], v[136:139], v[28:31], v[72:75]
  ds_read_b64_tr_b16 v[46:47], v11 offset:4608
  v_add_u32 v11, s42, v11
  s_barrier
  s_waitcnt vmcnt(13) lgkmcnt(6)
  v_mfma_f32_16x16x32_bf16 v[48:51], v[144:147], v[32:35], v[48:51]
  ds_read_b64_tr_b16 v[16:17], v8 offset:0
  s_bitcmp1_b32 s48, 5
  s_cselect_b32 s36, s50, s49
  s_waitcnt vmcnt(12)
  v_mfma_f32_16x16x32_bf16 v[52:55], v[148:151], v[32:35], v[52:55]
  ds_read_b64_tr_b16 v[18:19], v8 offset:512
  s_add_u32 s36, s36, 20480
  s_add_u32 s40, s43, 8192
  s_waitcnt lgkmcnt(6)
  v_mfma_f32_16x16x32_bf16 v[60:63], v[148:151], v[36:39], v[60:63]
  ds_read_b64_tr_b16 v[20:21], v9 offset:0
  s_cmp_eq_u32 s40, 65536
  s_cselect_b32 s40, 0, s40
  v_mfma_f32_16x16x32_bf16 v[56:59], v[144:147], v[36:39], v[56:59]
  ds_read_b64_tr_b16 v[22:23], v9 offset:512
  s_sub_u32 s42, s40, s43
  s_mov_b32 s43, s40
  s_waitcnt lgkmcnt(6)
  v_mfma_f32_16x16x32_bf16 v[64:67], v[144:147], v[40:43], v[64:67]
  ds_read_b64_tr_b16 v[24:25], v10 offset:0
  buffer_load_dwordx4 v[136:139], v14, s[8:11], s36 offen offset:0 sc1
  v_mfma_f32_16x16x32_bf16 v[68:71], v[148:151], v[40:43], v[68:71]
  ds_read_b64_tr_b16 v[26:27], v10 offset:512
  s_waitcnt lgkmcnt(6)
  v_mfma_f32_16x16x32_bf16 v[76:79], v[148:151], v[44:47], v[76:79]
  ds_read_b64_tr_b16 v[28:29], v11 offset:0
  v_mfma_f32_16x16x32_bf16 v[72:75], v[144:147], v[44:47], v[72:75]
  ds_read_b64_tr_b16 v[30:31], v11 offset:512
  buffer_load_dwordx4 v[140:143], v14, s[8:11], s36 offen offset:1024 sc1
  s_waitcnt vmcnt(13) lgkmcnt(6)
  v_mfma_f32_16x16x32_bf16 v[48:51], v[152:155], v[16:19], v[48:51]
  ds_read_b64_tr_b16 v[32:33], v8 offset:4096
  s_waitcnt vmcnt(12)
  v_mfma_f32_16x16x32_bf16 v[52:55], v[156:159], v[16:19], v[52:55]
  ds_read_b64_tr_b16 v[34:35], v8 offset:4608
  v_add_u32 v8, s42, v8
  s_waitcnt lgkmcnt(6)
  v_mfma_f32_16x16x32_bf16 v[60:63], v[156:159], v[20:23], v[60:63]
  ds_read_b64_tr_b16 v[36:37], v9 offset:4096
  buffer_load_dwordx4 v[144:147], v14, s[8:11], s36 offen offset:2048 sc1
  v_mfma_f32_16x16x32_bf16 v[56:59], v[152:155], v[20:23], v[56:59]
  ds_read_b64_tr_b16 v[38:39], v9 offset:4608
  v_add_u32 v9, s42, v9
  s_waitcnt lgkmcnt(6)
  v_mfma_f32_16x16x32_bf16 v[64:67], v[152:155], v[24:27], v[64:67]
  ds_read_b64_tr_b16 v[40:41], v10 offset:4096
  v_mfma_f32_16x16x32_bf16 v[68:71], v[156:159], v[24:27], v[68:71]
  ds_read_b64_tr_b16 v[42:43], v10 offset:4608
  v_add_u32 v10, s42, v10
  s_waitcnt lgkmcnt(6)
  v_mfma_f32_16x16x32_bf16 v[76:79], v[156:159], v[28:31], v[76:79]
  ds_read_b64_tr_b16 v[44:45], v11 offset:4096
  buffer_load_dwordx4 v[148:151], v14, s[8:11], s36 offen offset:3072 sc1
  v_mfma_f32_16x16x32_bf16 v[72:75], v[152:155], v[28:31], v[72:75]
  ds_read_b64_tr_b16 v[46:47], v11 offset:4608
  v_add_u32 v11, s42, v11
  s_barrier
  s_waitcnt vmcnt(13) lgkmcnt(6)
  v_mfma_f32_16x16x32_bf16 v[48:51], v[160:163], v[32:35], v[48:51]
  ds_read_b64_tr_b16 v[16:17], v8 offset:0
  s_bitcmp1_b32 s48, 6
  s_cselect_b32 s36, s50, s49
  s_waitcnt vmcnt(12)
  v_mfma_f32_16x16x32_bf16 v[52:55], v[164:167], v[32:35], v[52:55]
  ds_read_b64_tr_b16 v[18:19], v8 offset:512
  s_add_u32 s36, s36, 24576
  s_add_u32 s40, s43, 8192
  s_waitcnt lgkmcnt(6)
  v_mfma_f32_16x16x32_bf16 v[60:63], v[164:167], v[36:39], v[60:63]
  ds_read_b64_tr_b16 v[20:21], v9 offset:0
  s_cmp_eq_u32 s40, 65536
  s_cselect_b32 s40, 0, s40
  v_mfma_f32_16x16x32_bf16 v[56:59], v[160:163], v[36:39], v[56:59]
  ds_read_b64_tr_b16 v[22:23], v9 offset:512
  s_sub_u32 s42, s40, s43
  s_mov_b32 s43, s40
  s_waitcnt lgkmcnt(6)
  v_mfma_f32_16x16x32_bf16 v[64:67], v[160:163], v[40:43], v[64:67]
  ds_read_b64_tr_b16 v[24:25], v10 offset:0
  buffer_load_dwordx4 v[152:155], v14, s[8:11], s36 offen offset:0 sc1
  v_mfma_f32_16x16x32_bf16 v[68:71], v[164:167], v[40:43], v[68:71]
  ds_read_b64_tr_b16 v[26:27], v10 offset:512
  s_waitcnt lgkmcnt(6)
  v_mfma_f32_16x16x32_bf16 v[76:79], v[164:167], v[44:47], v[76:79]
  ds_read_b64_tr_b16 v[28:29], v11 offset:0
  v_mfma_f32_16x16x32_bf16 v[72:75], v[160:163], v[44:47], v[72:75]
  ds_read_b64_tr_b16 v[30:31], v11 offset:512
  buffer_load_dwordx4 v[156:159], v14, s[8:11], s36 offen offset:1024 sc1
  s_waitcnt vmcnt(13) lgkmcnt(6)
  v_mfma_f32_16x16x32_bf16 v[48:51], v[168:171], v[16:19], v[48:51]
  ds_read_b64_tr_b16 v[32:33], v8 offset:4096
  s_waitcnt vmcnt(12)
  v_mfma_f32_16x16x32_bf16 v[52:55], v[172:175], v[16:19], v[52:55]
  ds_read_b64_tr_b16 v[34:35], v8 offset:4608
  v_add_u32 v8, s42, v8
  s_waitcnt lgkmcnt(6)
  v_mfma_f32_16x16x32_bf16 v[60:63], v[172:175], v[20:23], v[60:63]
  ds_read_b64_tr_b16 v[36:37], v9 offset:4096
  buffer_load_dwordx4 v[160:163], v14, s[8:11], s36 offen offset:2048 sc1
  v_mfma_f32_16x16x32_bf16 v[56:59], v[168:171], v[20:23], v[56:59]
  ds_read_b64_tr_b16 v[38:39], v9 offset:4608
  v_add_u32 v9, s42, v9
  s_waitcnt lgkmcnt(6)
  v_mfma_f32_16x16x32_bf16 v[64:67], v[168:171], v[24:27], v[64:67]
  ds_read_b64_tr_b16 v[40:41], v10 offset:4096
  v_mfma_f32_16x16x32_bf16 v[68:71], v[172:175], v[24:27], v[68:71]
  ds_read_b64_tr_b16 v[42:43], v10 offset:4608
  v_add_u32 v10, s42, v10
  s_waitcnt lgkmcnt(6)
  v_mfma_f32_16x16x32_bf16 v[76:79], v[172:175], v[28:31], v[76:79]
  ds_read_b64_tr_b16 v[44:45], v11 offset:4096
  buffer_load_dwordx4 v[164:167], v14, s[8:11], s36 offen offset:3072 sc1
  v_mfma_f32_16x16x32_bf16 v[72:75], v[168:171], v[28:31], v[72:75]
  ds_read_b64_tr_b16 v[46:47], v11 offset:4608
  v_add_u32 v11, s42, v11
  s_barrier
  s_waitcnt vmcnt(13) lgkmcnt(6)
  v_mfma_f32_16x16x32_bf16 v[48:51], v[176:179], v[32:35], v[48:51]
  ds_read_b64_tr_b16 v[16:17], v8 offset:0
  s_bitcmp1_b32 s48, 7
  s_cselect_b32 s36, s50, s49
  s_waitcnt vmcnt(12)
  v_mfma_f32_16x16x32_bf16 v[52:55], v[180:183], v[32:35], v[52:55]
  ds_read_b64_tr_b16 v[18:19], v8 offset:512
  s_add_u32 s36, s36, 28672
  s_add_u32 s40, s43, 8192
  s_waitcnt lgkmcnt(6)
  v_mfma_f32_16x16x32_bf16 v[60:63], v[180:183], v[36:39], v[60:63]
  ds_read_b64_tr_b16 v[20:21], v9 offset:0
  s_cmp_eq_u32 s40, 65536
  s_cselect_b32 s40, 0, s40
  v_mfma_f32_16x16x32_bf16 v[56:59], v[176:179], v[36:39], v[56:59]
  ds_read_b64_tr_b16 v[22:23], v9 offset:512
  s_sub_u32 s42, s40, s43
  s_mov_b32 s43, s40
  s_waitcnt lgkmcnt(6)
  v_mfma_f32_16x16x32_bf16 v[64:67], v[176:179], v[40:43], v[64:67]
  ds_read_b64_tr_b16 v[24:25], v10 offset:0
  buffer_load_dwordx4 v[168:171], v14, s[8:11], s36 offen offset:0 sc1
  v_mfma_f32_16x16x32_bf16 v[68:71], v[180:183], v[40:43], v[68:71]
  ds_read_b64_tr_b16 v[26:27], v10 offset:512
  s_waitcnt lgkmcnt(6)
  v_mfma_f32_16x16x32_bf16 v[76:79], v[180:183], v[44:47], v[76:79]
  ds_read_b64_tr_b16 v[28:29], v11 offset:0
  v_mfma_f32_16x16x32_bf16 v[72:75], v[176:179], v[44:47], v[72:75]
  ds_read_b64_tr_b16 v[30:31], v11 offset:512
  buffer_load_dwordx4 v[172:175], v14, s[8:11], s36 offen offset:1024 sc1
  s_waitcnt vmcnt(13) lgkmcnt(6)
  v_mfma_f32_16x16x32_bf16 v[48:51], v[120:123], v[16:19], v[48:51]
  ds_read_b64_tr_b16 v[32:33], v8 offset:4096
  s_waitcnt vmcnt(12)
  v_mfma_f32_16x16x32_bf16 v[52:55], v[124:127], v[16:19], v[52:55]
  ds_read_b64_tr_b16 v[34:35], v8 offset:4608
  v_add_u32 v8, s42, v8
  s_waitcnt lgkmcnt(6)
  v_mfma_f32_16x16x32_bf16 v[60:63], v[124:127], v[20:23], v[60:63]
  ds_read_b64_tr_b16 v[36:37], v9 offset:4096
  buffer_load_dwordx4 v[176:179], v14, s[8:11], s36 offen offset:2048 sc1
  v_mfma_f32_16x16x32_bf16 v[56:59], v[120:123], v[20:23], v[56:59]
  ds_read_b64_tr_b16 v[38:39], v9 offset:4608
  v_add_u32 v9, s42, v9
  s_waitcnt lgkmcnt(6)
  v_mfma_f32_16x16x32_bf16 v[64:67], v[120:123], v[24:27], v[64:67]
  ds_read_b64_tr_b16 v[40:41], v10 offset:4096
  v_mfma_f32_16x16x32_bf16 v[68:71], v[124:127], v[24:27], v[68:71]
  ds_read_b64_tr_b16 v[42:43], v10 offset:4608
  v_add_u32 v10, s42, v10
  s_waitcnt lgkmcnt(6)
  v_mfma_f32_16x16x32_bf16 v[76:79], v[124:127], v[28:31], v[76:79]
  ds_read_b64_tr_b16 v[44:45], v11 offset:4096
  buffer_load_dwordx4 v[180:183], v14, s[8:11], s36 offen offset:3072 sc1
  v_mfma_f32_16x16x32_bf16 v[72:75], v[120:123], v[28:31], v[72:75]
  ds_read_b64_tr_b16 v[46:47], v11 offset:4608
  v_add_u32 v11, s42, v11
  s_barrier
  s_waitcnt vmcnt(13) lgkmcnt(6)
  v_mfma_f32_16x16x32_bf16 v[48:51], v[128:131], v[32:35], v[48:51]
  ds_read_b64_tr_b16 v[16:17], v8 offset:0
  s_mov_b32 s49, s50
  s_add_u32 s50, s50, 32768
  s_waitcnt vmcnt(12)
  v_mfma_f32_16x16x32_bf16 v[52:55], v[132:135], v[32:35], v[52:55]
  ds_read_b64_tr_b16 v[18:19], v8 offset:512
  s_cmp_eq_u32 s50, s41
  s_cselect_b32 s50, s34, s50
  s_waitcnt lgkmcnt(6)
  v_mfma_f32_16x16x32_bf16 v[60:63], v[132:135], v[36:39], v[60:63]
  ds_read_b64_tr_b16 v[20:21], v9 offset:0
  s_bitcmp1_b32 s48, 0
  s_cselect_b32 s36, s50, s49
  v_mfma_f32_16x16x32_bf16 v[56:59], v[128:131], v[36:39], v[56:59]
  ds_read_b64_tr_b16 v[22:23], v9 offset:512
  s_add_u32 s36, s36, 0
  s_add_u32 s40, s43, 8192
  s_waitcnt lgkmcnt(6)
  v_mfma_f32_16x16x32_bf16 v[64:67], v[128:131], v[40:43], v[64:67]
  ds_read_b64_tr_b16 v[24:25], v10 offset:0
  s_cmp_eq_u32 s40, 65536
  s_cselect_b32 s40, 0, s40
  buffer_load_dwordx4 v[120:123], v14, s[8:11], s36 offen offset:0 sc1
  v_mfma_f32_16x16x32_bf16 v[68:71], v[132:135], v[40:43], v[68:71]
  ds_read_b64_tr_b16 v[26:27], v10 offset:512
  s_sub_u32 s42, s40, s43
  s_mov_b32 s43, s40
  s_waitcnt lgkmcnt(6)
  v_mfma_f32_16x16x32_bf16 v[76:79], v[132:135], v[44:47], v[76:79]
  ds_read_b64_tr_b16 v[28:29], v11 offset:0
  v_mfma_f32_16x16x32_bf16 v[72:75], v[128:131], v[44:47], v[72:75]
  ds_read_b64_tr_b16 v[30:31], v11 offset:512
  buffer_load_dwordx4 v[124:127], v14, s[8:11], s36 offen offset:1024 sc1
  s_waitcnt vmcnt(13) lgkmcnt(6)
  v_mfma_f32_16x16x32_bf16 v[48:51], v[136:139], v[16:19], v[48:51]
  ds_read_b64_tr_b16 v[32:33], v8 offset:4096
  s_waitcnt vmcnt(12)
  v_mfma_f32_16x16x32_bf16 v[52:55], v[140:143], v[16:19], v[52:55]
  ds_read_b64_tr_b16 v[34:35], v8 offset:4608
  v_add_u32 v8, s42, v8
  s_waitcnt lgkmcnt(6)
  v_mfma_f32_16x16x32_bf16 v[60:63], v[140:143], v[20:23], v[60:63]
  ds_read_b64_tr_b16 v[36:37], v9 offset:4096
  buffer_load_dwordx4 v[128:131], v14, s[8:11], s36 offen offset:2048 sc1
  v_mfma_f32_16x16x32_bf16 v[56:59], v[136:139], v[20:23], v[56:59]
  ds_read_b64_tr_b16 v[38:39], v9 offset:4608
  v_add_u32 v9, s42, v9
  s_waitcnt lgkmcnt(6)
  v_mfma_f32_16x16x32_bf16 v[64:67], v[136:139], v[24:27], v[64:67]
  ds_read_b64_tr_b16 v[40:41], v10 offset:4096
  v_mfma_f32_16x16x32_bf16 v[68:71], v[140:143], v[24:27], v[68:71]
  ds_read_b64_tr_b16 v[42:43], v10 offset:4608
  v_add_u32 v10, s42, v10
  s_waitcnt lgkmcnt(6)
  v_mfma_f32_16x16x32_bf16 v[76:79], v[140:143], v[28:31], v[76:79]
  ds_read_b64_tr_b16 v[44:45], v11 offset:4096
  buffer_load_dwordx4 v[132:135], v14, s[8:11], s36 offen offset:3072 sc1
  v_mfma_f32_16x16x32_bf16 v[72:75], v[136:139], v[28:31], v[72:75]
  ds_read_b64_tr_b16 v[46:47], v11 offset:4608
  v_add_u32 v11, s42, v11
  s_barrier
  s_waitcnt vmcnt(13) lgkmcnt(6)
  v_mfma_f32_16x16x32_bf16 v[48:51], v[144:147], v[32:35], v[48:51]
  ds_read_b64_tr_b16 v[16:17], v8 offset:0
  s_bitcmp1_b32 s48, 1
  s_cselect_b32 s36, s50, s49
  s_waitcnt vmcnt(12)
  v_mfma_f32_16x16x32_bf16 v[52:55], v[148:151], v[32:35], v[52:55]
  ds_read_b64_tr_b16 v[18:19], v8 offset:512
  s_add_u32 s36, s36, 4096
  s_add_u32 s40, s43, 8192
  s_waitcnt lgkmcnt(6)
  v_mfma_f32_16x16x32_bf16 v[60:63], v[148:151], v[36:39], v[60:63]
  ds_read_b64_tr_b16 v[20:21], v9 offset:0
  s_cmp_eq_u32 s40, 65536
  s_cselect_b32 s40, 0, s40
  v_mfma_f32_16x16x32_bf16 v[56:59], v[144:147], v[36:39], v[56:59]
  ds_read_b64_tr_b16 v[22:23], v9 offset:512
  s_sub_u32 s42, s40, s43
  s_mov_b32 s43, s40
  s_waitcnt lgkmcnt(6)
  v_mfma_f32_16x16x32_bf16 v[64:67], v[144:147], v[40:43], v[64:67]
  ds_read_b64_tr_b16 v[24:25], v10 offset:0
  buffer_load_dwordx4 v[136:139], v14, s[8:11], s36 offen offset:0 sc1
  v_mfma_f32_16x16x32_bf16 v[68:71], v[148:151], v[40:43], v[68:71]
  ds_read_b64_tr_b16 v[26:27], v10 offset:512
  s_waitcnt lgkmcnt(6)
  v_mfma_f32_16x16x32_bf16 v[76:79], v[148:151], v[44:47], v[76:79]
  ds_read_b64_tr_b16 v[28:29], v11 offset:0
  v_mfma_f32_16x16x32_bf16 v[72:75], v[144:147], v[44:47], v[72:75]
  ds_read_b64_tr_b16 v[30:31], v11 offset:512
  buffer_load_dwordx4 v[140:143], v14, s[8:11], s36 offen offset:1024 sc1
  s_waitcnt vmcnt(13) lgkmcnt(6)
  v_mfma_f32_16x16x32_bf16 v[48:51], v[152:155], v[16:19], v[48:51]
  ds_read_b64_tr_b16 v[32:33], v8 offset:4096
  s_waitcnt vmcnt(12)
  v_mfma_f32_16x16x32_bf16 v[52:55], v[156:159], v[16:19], v[52:55]
  ds_read_b64_tr_b16 v[34:35], v8 offset:4608
  v_add_u32 v8, s42, v8
  s_waitcnt lgkmcnt(6)
  v_mfma_f32_16x16x32_bf16 v[60:63], v[156:159], v[20:23], v[60:63]
  ds_read_b64_tr_b16 v[36:37], v9 offset:4096
  buffer_load_dwordx4 v[144:147], v14, s[8:11], s36 offen offset:2048 sc1
  v_mfma_f32_16x16x32_bf16 v[56:59], v[152:155], v[20:23], v[56:59]
  ds_read_b64_tr_b16 v[38:39], v9 offset:4608
  v_add_u32 v9, s42, v9
  s_waitcnt lgkmcnt(6)
  v_mfma_f32_16x16x32_bf16 v[64:67], v[152:155], v[24:27], v[64:67]
  ds_read_b64_tr_b16 v[40:41], v10 offset:4096
  v_mfma_f32_16x16x32_bf16 v[68:71], v[156:159], v[24:27], v[68:71]
  ds_read_b64_tr_b16 v[42:43], v10 offset:4608
  v_add_u32 v10, s42, v10
  s_waitcnt lgkmcnt(6)
  v_mfma_f32_16x16x32_bf16 v[76:79], v[156:159], v[28:31], v[76:79]
  ds_read_b64_tr_b16 v[44:45], v11 offset:4096
  buffer_load_dwordx4 v[148:151], v14, s[8:11], s36 offen offset:3072 sc1
  v_mfma_f32_16x16x32_bf16 v[72:75], v[152:155], v[28:31], v[72:75]
  ds_read_b64_tr_b16 v[46:47], v11 offset:4608
  v_add_u32 v11, s42, v11
  s_barrier
  s_waitcnt vmcnt(13) lgkmcnt(6)
  v_mfma_f32_16x16x32_bf16 v[48:51], v[160:163], v[32:35], v[48:51]
  ds_read_b64_tr_b16 v[16:17], v8 offset:0
  s_bitcmp1_b32 s48, 2
  s_cselect_b32 s36, s50, s49
  s_waitcnt vmcnt(12)
  v_mfma_f32_16x16x32_bf16 v[52:55], v[164:167], v[32:35], v[52:55]
  ds_read_b64_tr_b16 v[18:19], v8 offset:512
  s_add_u32 s36, s36, 8192
  s_add_u32 s40, s43, 8192
  s_waitcnt lgkmcnt(6)
  v_mfma_f32_16x16x32_bf16 v[60:63], v[164:167], v[36:39], v[60:63]
  ds_read_b64_tr_b16 v[20:21], v9 offset:0
  s_cmp_eq_u32 s40, 65536
  s_cselect_b32 s40, 0, s40
  v_mfma_f32_16x16x32_bf16 v[56:59], v[160:163], v[36:39], v[56:59]
  ds_read_b64_tr_b16 v[22:23], v9 offset:512
  s_sub_u32 s42, s40, s43
  s_mov_b32 s43, s40
  s_waitcnt lgkmcnt(6)
  v_mfma_f32_16x16x32_bf16 v[64:67], v[160:163], v[40:43], v[64:67]
  ds_read_b64_tr_b16 v[24:25], v10 offset:0
  buffer_load_dwordx4 v[152:155], v14, s[8:11], s36 offen offset:0 sc1
  v_mfma_f32_16x16x32_bf16 v[68:71], v[164:167], v[40:43], v[68:71]
  ds_read_b64_tr_b16 v[26:27], v10 offset:512
  s_waitcnt lgkmcnt(6)
  v_mfma_f32_16x16x32_bf16 v[76:79], v[164:167], v[44:47], v[76:79]
  ds_read_b64_tr_b16 v[28:29], v11 offset:0
  v_mfma_f32_16x16x32_bf16 v[72:75], v[160:163], v[44:47], v[72:75]
  ds_read_b64_tr_b16 v[30:31], v11 offset:512
  buffer_load_dwordx4 v[156:159], v14, s[8:11], s36 offen offset:1024 sc1
  s_waitcnt vmcnt(13) lgkmcnt(6)
  v_mfma_f32_16x16x32_bf16 v[48:51], v[168:171], v[16:19], v[48:51]
  ds_read_b64_tr_b16 v[32:33], v8 offset:4096
  s_waitcnt vmcnt(12)
  v_mfma_f32_16x16x32_bf16 v[52:55], v[172:175], v[16:19], v[52:55]
  ds_read_b64_tr_b16 v[34:35], v8 offset:4608
  v_add_u32 v8, s42, v8
  s_waitcnt lgkmcnt(6)
  v_mfma_f32_16x16x32_bf16 v[60:63], v[172:175], v[20:23], v[60:63]
  ds_read_b64_tr_b16 v[36:37], v9 offset:4096
  buffer_load_dwordx4 v[160:163], v14, s[8:11], s36 offen offset:2048 sc1
  v_mfma_f32_16x16x32_bf16 v[56:59], v[168:171], v[20:23], v[56:59]
  ds_read_b64_tr_b16 v[38:39], v9 offset:4608
  v_add_u32 v9, s42, v9
  s_waitcnt lgkmcnt(6)
  v_mfma_f32_16x16x32_bf16 v[64:67], v[168:171], v[24:27], v[64:67]
  ds_read_b64_tr_b16 v[40:41], v10 offset:4096
  v_mfma_f32_16x16x32_bf16 v[68:71], v[172:175], v[24:27], v[68:71]
  ds_read_b64_tr_b16 v[42:43], v10 offset:4608
  v_add_u32 v10, s42, v10
  s_waitcnt lgkmcnt(6)
  v_mfma_f32_16x16x32_bf16 v[76:79], v[172:175], v[28:31], v[76:79]
  ds_read_b64_tr_b16 v[44:45], v11 offset:4096
  buffer_load_dwordx4 v[164:167], v14, s[8:11], s36 offen offset:3072 sc1
  v_mfma_f32_16x16x32_bf16 v[72:75], v[168:171], v[28:31], v[72:75]
  ds_read_b64_tr_b16 v[46:47], v11 offset:4608
  v_add_u32 v11, s42, v11
  s_barrier
  s_waitcnt vmcnt(13) lgkmcnt(6)
  v_mfma_f32_16x16x32_bf16 v[48:51], v[176:179], v[32:35], v[48:51]
  ds_read_b64_tr_b16 v[16:17], v8 offset:0
  s_bitcmp1_b32 s48, 3
  s_cselect_b32 s36, s50, s49
  s_waitcnt vmcnt(12)
  v_mfma_f32_16x16x32_bf16 v[52:55], v[180:183], v[32:35], v[52:55]
  ds_read_b64_tr_b16 v[18:19], v8 offset:512
  s_add_u32 s36, s36, 12288
  s_add_u32 s40, s43, 8192
  s_waitcnt lgkmcnt(6)
  v_mfma_f32_16x16x32_bf16 v[60:63], v[180:183], v[36:39], v[60:63]
  ds_read_b64_tr_b16 v[20:21], v9 offset:0
  s_cmp_eq_u32 s40, 65536
  s_cselect_b32 s40, 0, s40
  v_mfma_f32_16x16x32_bf16 v[56:59], v[176:179], v[36:39], v[56:59]
  ds_read_b64_tr_b16 v[22:23], v9 offset:512
  s_sub_u32 s42, s40, s43
  s_mov_b32 s43, s40
  s_waitcnt lgkmcnt(6)
  v_mfma_f32_16x16x32_bf16 v[64:67], v[176:179], v[40:43], v[64:67]
  ds_read_b64_tr_b16 v[24:25], v10 offset:0
  buffer_load_dwordx4 v[168:171], v14, s[8:11], s36 offen offset:0 sc1
  v_mfma_f32_16x16x32_bf16 v[68:71], v[180:183], v[40:43], v[68:71]
  ds_read_b64_tr_b16 v[26:27], v10 offset:512
  s_waitcnt lgkmcnt(6)
  v_mfma_f32_16x16x32_bf16 v[76:79], v[180:183], v[44:47], v[76:79]
  ds_read_b64_tr_b16 v[28:29], v11 offset:0
  v_mfma_f32_16x16x32_bf16 v[72:75], v[176:179], v[44:47], v[72:75]
  ds_read_b64_tr_b16 v[30:31], v11 offset:512
  buffer_load_dwordx4 v[172:175], v14, s[8:11], s36 offen offset:1024 sc1
  s_sub_u32 s39, s39, 1
  s_cmp_lg_u32 s39, 0
  s_cbranch_scc1 cd5
  s_waitcnt vmcnt(13) lgkmcnt(6)
  v_mfma_f32_16x16x32_bf16 v[48:51], v[120:123], v[16:19], v[48:51]
  ds_read_b64_tr_b16 v[32:33], v8 offset:4096
  s_waitcnt vmcnt(12)
  v_mfma_f32_16x16x32_bf16 v[52:55], v[124:127], v[16:19], v[52:55]
  ds_read_b64_tr_b16 v[34:35], v8 offset:4608
  v_add_u32 v8, s42, v8
  s_waitcnt lgkmcnt(6)
  v_mfma_f32_16x16x32_bf16 v[60:63], v[124:127], v[20:23], v[60:63]
  ds_read_b64_tr_b16 v[36:37], v9 offset:4096
  buffer_load_dwordx4 v[176:179], v14, s[8:11], s36 offen offset:2048 sc1
  v_mfma_f32_16x16x32_bf16 v[56:59], v[120:123], v[20:23], v[56:59]
  ds_read_b64_tr_b16 v[38:39], v9 offset:4608
  v_add_u32 v9, s42, v9
  s_waitcnt lgkmcnt(6)
  v_mfma_f32_16x16x32_bf16 v[64:67], v[120:123], v[24:27], v[64:67]
  ds_read_b64_tr_b16 v[40:41], v10 offset:4096
  v_mfma_f32_16x16x32_bf16 v[68:71], v[124:127], v[24:27], v[68:71]
  ds_read_b64_tr_b16 v[42:43], v10 offset:4608
  v_add_u32 v10, s42, v10
  s_waitcnt lgkmcnt(6)
  v_mfma_f32_16x16x32_bf16 v[76:79], v[124:127], v[28:31], v[76:79]
  ds_read_b64_tr_b16 v[44:45], v11 offset:4096
  buffer_load_dwordx4 v[180:183], v14, s[8:11], s36 offen offset:3072 sc1
  v_mfma_f32_16x16x32_bf16 v[72:75], v[120:123], v[28:31], v[72:75]
  ds_read_b64_tr_b16 v[46:47], v11 offset:4608
  v_add_u32 v11, s42, v11
  s_barrier
  s_waitcnt vmcnt(13) lgkmcnt(6)
  v_mfma_f32_16x16x32_bf16 v[48:51], v[128:131], v[32:35], v[48:51]
  ds_read_b64_tr_b16 v[16:17], v8 offset:0
  s_bitcmp1_b32 s48, 4
  s_cselect_b32 s36, s50, s49
  s_waitcnt vmcnt(12)
  v_mfma_f32_16x16x32_bf16 v[52:55], v[132:135], v[32:35], v[52:55]
  ds_read_b64_tr_b16 v[18:19], v8 offset:512
  s_add_u32 s36, s36, 16384
  s_add_u32 s40, s43, 8192
  s_waitcnt lgkmcnt(6)
  v_mfma_f32_16x16x32_bf16 v[60:63], v[132:135], v[36:39], v[60:63]
  ds_read_b64_tr_b16 v[20:21], v9 offset:0
  s_cmp_eq_u32 s40, 65536
  s_cselect_b32 s40, 0, s40
  v_mfma_f32_16x16x32_bf16 v[56:59], v[128:131], v[36:39], v[56:59]
  ds_read_b64_tr_b16 v[22:23], v9 offset:512
  s_sub_u32 s42, s40, s43
  s_mov_b32 s43, s40
  s_waitcnt lgkmcnt(6)
  v_mfma_f32_16x16x32_bf16 v[64:67], v[128:131], v[40:43], v[64:67]
  ds_read_b64_tr_b16 v[24:25], v10 offset:0
  buffer_load_dwordx4 v[120:123], v14, s[8:11], s36 offen offset:0 sc1
  v_mfma_f32_16x16x32_bf16 v[68:71], v[132:135], v[40:43], v[68:71]
  ds_read_b64_tr_b16 v[26:27], v10 offset:512
  s_waitcnt lgkmcnt(6)
  v_mfma_f32_16x16x32_bf16 v[76:79], v[132:135], v[44:47], v[76:79]
  ds_read_b64_tr_b16 v[28:29], v11 offset:0
  v_mfma_f32_16x16x32_bf16 v[72:75], v[128:131], v[44:47], v[72:75]
  ds_read_b64_tr_b16 v[30:31], v11 offset:512
  buffer_load_dwordx4 v[124:127], v14, s[8:11], s36 offen offset:1024 sc1
  s_waitcnt vmcnt(13) lgkmcnt(6)
  v_mfma_f32_16x16x32_bf16 v[48:51], v[136:139], v[16:19], v[48:51]
  ds_read_b64_tr_b16 v[32:33], v8 offset:4096
  s_waitcnt vmcnt(12)
  v_mfma_f32_16x16x32_bf16 v[52:55], v[140:143], v[16:19], v[52:55]
  ds_read_b64_tr_b16 v[34:35], v8 offset:4608
  v_add_u32 v8, s42, v8
  s_waitcnt lgkmcnt(6)
  v_mfma_f32_16x16x32_bf16 v[60:63], v[140:143], v[20:23], v[60:63]
  ds_read_b64_tr_b16 v[36:37], v9 offset:4096
  buffer_load_dwordx4 v[128:131], v14, s[8:11], s36 offen offset:2048 sc1
  v_mfma_f32_16x16x32_bf16 v[56:59], v[136:139], v[20:23], v[56:59]
  ds_read_b64_tr_b16 v[38:39], v9 offset:4608
  v_add_u32 v9, s42, v9
  s_waitcnt lgkmcnt(6)
  v_mfma_f32_16x16x32_bf16 v[64:67], v[136:139], v[24:27], v[64:67]
  ds_read_b64_tr_b16 v[40:41], v10 offset:4096
  v_mfma_f32_16x16x32_bf16 v[68:71], v[140:143], v[24:27], v[68:71]
  ds_read_b64_tr_b16 v[42:43], v10 offset:4608
  v_add_u32 v10, s42, v10
  s_waitcnt lgkmcnt(6)
  v_mfma_f32_16x16x32_bf16 v[76:79], v[140:143], v[28:31], v[76:79]
  ds_read_b64_tr_b16 v[44:45], v11 offset:4096
  buffer_load_dwordx4 v[132:135], v14, s[8:11], s36 offen offset:3072 sc1
  v_mfma_f32_16x16x32_bf16 v[72:75], v[136:139], v[28:31], v[72:75]
  ds_read_b64_tr_b16 v[46:47], v11 offset:4608
  v_add_u32 v11, s42, v11
  s_barrier
  s_waitcnt vmcnt(13) lgkmcnt(6)
  v_mfma_f32_16x16x32_bf16 v[48:51], v[144:147], v[32:35], v[48:51]
  ds_read_b64_tr_b16 v[16:17], v8 offset:0
  s_bitcmp1_b32 s48, 5
  s_cselect_b32 s36, s50, s49
  s_waitcnt vmcnt(12)
  v_mfma_f32_16x16x32_bf16 v[52:55], v[148:151], v[32:35], v[52:55]
  ds_read_b64_tr_b16 v[18:19], v8 offset:512
  s_add_u32 s36, s36, 20480
  s_add_u32 s40, s43, 8192
  s_waitcnt lgkmcnt(6)
  v_mfma_f32_16x16x32_bf16 v[60:63], v[148:151], v[36:39], v[60:63]
  ds_read_b64_tr_b16 v[20:21], v9 offset:0
  s_cmp_eq_u32 s40, 65536
  s_cselect_b32 s40, 0, s40
  v_mfma_f32_16x16x32_bf16 v[56:59], v[144:147], v[36:39], v[56:59]
  ds_read_b64_tr_b16 v[22:23], v9 offset:512
  s_sub_u32 s42, s40, s43
  s_mov_b32 s43, s40
  s_waitcnt lgkmcnt(6)
  v_mfma_f32_16x16x32_bf16 v[64:67], v[144:147], v[40:43], v[64:67]
  ds_read_b64_tr_b16 v[24:25], v10 offset:0
  buffer_load_dwordx4 v[136:139], v14, s[8:11], s36 offen offset:0 sc1
  v_mfma_f32_16x16x32_bf16 v[68:71], v[148:151], v[40:43], v[68:71]
  ds_read_b64_tr_b16 v[26:27], v10 offset:512
  s_waitcnt lgkmcnt(6)
  v_mfma_f32_16x16x32_bf16 v[76:79], v[148:151], v[44:47], v[76:79]
  ds_read_b64_tr_b16 v[28:29], v11 offset:0
  v_mfma_f32_16x16x32_bf16 v[72:75], v[144:147], v[44:47], v[72:75]
  ds_read_b64_tr_b16 v[30:31], v11 offset:512
  buffer_load_dwordx4 v[140:143], v14, s[8:11], s36 offen offset:1024 sc1
  s_waitcnt vmcnt(13) lgkmcnt(6)
  v_mfma_f32_16x16x32_bf16 v[48:51], v[152:155], v[16:19], v[48:51]
  ds_read_b64_tr_b16 v[32:33], v8 offset:4096
  s_waitcnt vmcnt(12)
  v_mfma_f32_16x16x32_bf16 v[52:55], v[156:159], v[16:19], v[52:55]
  ds_read_b64_tr_b16 v[34:35], v8 offset:4608
  v_add_u32 v8, s42, v8
  s_waitcnt lgkmcnt(6)
  v_mfma_f32_16x16x32_bf16 v[60:63], v[156:159], v[20:23], v[60:63]
  ds_read_b64_tr_b16 v[36:37], v9 offset:4096
  buffer_load_dwordx4 v[144:147], v14, s[8:11], s36 offen offset:2048 sc1
  v_mfma_f32_16x16x32_bf16 v[56:59], v[152:155], v[20:23], v[56:59]
  ds_read_b64_tr_b16 v[38:39], v9 offset:4608
  v_add_u32 v9, s42, v9
  s_waitcnt lgkmcnt(6)
  v_mfma_f32_16x16x32_bf16 v[64:67], v[152:155], v[24:27], v[64:67]
  ds_read_b64_tr_b16 v[40:41], v10 offset:4096
  v_mfma_f32_16x16x32_bf16 v[68:71], v[156:159], v[24:27], v[68:71]
  ds_read_b64_tr_b16 v[42:43], v10 offset:4608
  v_add_u32 v10, s42, v10
  s_waitcnt lgkmcnt(6)
  v_mfma_f32_16x16x32_bf16 v[76:79], v[156:159], v[28:31], v[76:79]
  ds_read_b64_tr_b16 v[44:45], v11 offset:4096
  buffer_load_dwordx4 v[148:151], v14, s[8:11], s36 offen offset:3072 sc1
  v_mfma_f32_16x16x32_bf16 v[72:75], v[152:155], v[28:31], v[72:75]
  ds_read_b64_tr_b16 v[46:47], v11 offset:4608
  v_add_u32 v11, s42, v11
  s_barrier
  s_waitcnt vmcnt(13) lgkmcnt(6)
  v_mfma_f32_16x16x32_bf16 v[48:51], v[160:163], v[32:35], v[48:51]
  ds_read_b64_tr_b16 v[16:17], v8 offset:0
  s_bitcmp1_b32 s48, 6
  s_cselect_b32 s36, s50, s49
  s_waitcnt vmcnt(12)
  v_mfma_f32_16x16x32_bf16 v[52:55], v[164:167], v[32:35], v[52:55]
  ds_read_b64_tr_b16 v[18:19], v8 offset:512
  s_add_u32 s36, s36, 24576
  s_add_u32 s40, s43, 8192
  s_waitcnt lgkmcnt(6)
  v_mfma_f32_16x16x32_bf16 v[60:63], v[164:167], v[36:39], v[60:63]
  ds_read_b64_tr_b16 v[20:21], v9 offset:0
  s_cmp_eq_u32 s40, 65536
  s_cselect_b32 s40, 0, s40
  v_mfma_f32_16x16x32_bf16 v[56:59], v[160:163], v[36:39], v[56:59]
  ds_read_b64_tr_b16 v[22:23], v9 offset:512
  s_sub_u32 s42, s40, s43
  s_mov_b32 s43, s40
  s_waitcnt lgkmcnt(6)
  v_mfma_f32_16x16x32_bf16 v[64:67], v[160:163], v[40:43], v[64:67]
  ds_read_b64_tr_b16 v[24:25], v10 offset:0
  buffer_load_dwordx4 v[152:155], v14, s[8:11], s36 offen offset:0 sc1
  v_mfma_f32_16x16x32_bf16 v[68:71], v[164:167], v[40:43], v[68:71]
  ds_read_b64_tr_b16 v[26:27], v10 offset:512
  s_waitcnt lgkmcnt(6)
  v_mfma_f32_16x16x32_bf16 v[76:79], v[164:167], v[44:47], v[76:79]
  ds_read_b64_tr_b16 v[28:29], v11 offset:0
  v_mfma_f32_16x16x32_bf16 v[72:75], v[160:163], v[44:47], v[72:75]
  ds_read_b64_tr_b16 v[30:31], v11 offset:512
  buffer_load_dwordx4 v[156:159], v14, s[8:11], s36 offen offset:1024 sc1
  s_waitcnt vmcnt(13) lgkmcnt(6)
  v_mfma_f32_16x16x32_bf16 v[48:51], v[168:171], v[16:19], v[48:51]
  ds_read_b64_tr_b16 v[32:33], v8 offset:4096
  s_waitcnt vmcnt(12)
  v_mfma_f32_16x16x32_bf16 v[52:55], v[172:175], v[16:19], v[52:55]
  ds_read_b64_tr_b16 v[34:35], v8 offset:4608
  v_add_u32 v8, s42, v8
  s_waitcnt lgkmcnt(6)
  v_mfma_f32_16x16x32_bf16 v[60:63], v[172:175], v[20:23], v[60:63]
  ds_read_b64_tr_b16 v[36:37], v9 offset:4096
  buffer_load_dwordx4 v[160:163], v14, s[8:11], s36 offen offset:2048 sc1
  v_mfma_f32_16x16x32_bf16 v[56:59], v[168:171], v[20:23], v[56:59]
  ds_read_b64_tr_b16 v[38:39], v9 offset:4608
  v_add_u32 v9, s42, v9
  s_waitcnt lgkmcnt(6)
  v_mfma_f32_16x16x32_bf16 v[64:67], v[168:171], v[24:27], v[64:67]
  ds_read_b64_tr_b16 v[40:41], v10 offset:4096
  v_mfma_f32_16x16x32_bf16 v[68:71], v[172:175], v[24:27], v[68:71]
  ds_read_b64_tr_b16 v[42:43], v10 offset:4608
  v_add_u32 v10, s42, v10
  s_waitcnt lgkmcnt(6)
  v_mfma_f32_16x16x32_bf16 v[76:79], v[172:175], v[28:31], v[76:79]
  ds_read_b64_tr_b16 v[44:45], v11 offset:4096
  buffer_load_dwordx4 v[164:167], v14, s[8:11], s36 offen offset:3072 sc1
  v_mfma_f32_16x16x32_bf16 v[72:75], v[168:171], v[28:31], v[72:75]
  ds_read_b64_tr_b16 v[46:47], v11 offset:4608
  v_add_u32 v11, s42, v11
  s_barrier
  s_waitcnt vmcnt(13) lgkmcnt(6)
  v_mfma_f32_16x16x32_bf16 v[48:51], v[176:179], v[32:35], v[48:51]
  ds_read_b64_tr_b16 v[16:17], v8 offset:0
  s_bitcmp1_b32 s48, 7
  s_cselect_b32 s36, s50, s49
  s_waitcnt vmcnt(12)
  v_mfma_f32_16x16x32_bf16 v[52:55], v[180:183], v[32:35], v[52:55]
  ds_read_b64_tr_b16 v[18:19], v8 offset:512
  s_add_u32 s36, s36, 28672
  s_add_u32 s40, s43, 8192
  s_waitcnt lgkmcnt(6)
  v_mfma_f32_16x16x32_bf16 v[60:63], v[180:183], v[36:39], v[60:63]
  ds_read_b64_tr_b16 v[20:21], v9 offset:0
  s_cmp_eq_u32 s40, 65536
  s_cselect_b32 s40, 0, s40
  v_mfma_f32_16x16x32_bf16 v[56:59], v[176:179], v[36:39], v[56:59]
  ds_read_b64_tr_b16 v[22:23], v9 offset:512
  s_sub_u32 s42, s40, s43
  s_mov_b32 s43, s40
  s_waitcnt lgkmcnt(6)
  v_mfma_f32_16x16x32_bf16 v[64:67], v[176:179], v[40:43], v[64:67]
  ds_read_b64_tr_b16 v[24:25], v10 offset:0
  buffer_load_dwordx4 v[168:171], v14, s[8:11], s36 offen offset:0 sc1
  v_mfma_f32_16x16x32_bf16 v[68:71], v[180:183], v[40:43], v[68:71]
  ds_read_b64_tr_b16 v[26:27], v10 offset:512
  s_waitcnt lgkmcnt(6)
  v_mfma_f32_16x16x32_bf16 v[76:79], v[180:183], v[44:47], v[76:79]
  ds_read_b64_tr_b16 v[28:29], v11 offset:0
  v_mfma_f32_16x16x32_bf16 v[72:75], v[176:179], v[44:47], v[72:75]
  ds_read_b64_tr_b16 v[30:31], v11 offset:512
  buffer_load_dwordx4 v[172:175], v14, s[8:11], s36 offen offset:1024 sc1
  s_waitcnt vmcnt(13) lgkmcnt(6)
  v_mfma_f32_16x16x32_bf16 v[48:51], v[120:123], v[16:19], v[48:51]
  ds_read_b64_tr_b16 v[32:33], v8 offset:4096
  s_waitcnt vmcnt(12)
  v_mfma_f32_16x16x32_bf16 v[52:55], v[124:127], v[16:19], v[52:55]
  ds_read_b64_tr_b16 v[34:35], v8 offset:4608
  v_add_u32 v8, s42, v8
  s_waitcnt lgkmcnt(6)
  v_mfma_f32_16x16x32_bf16 v[60:63], v[124:127], v[20:23], v[60:63]
  ds_read_b64_tr_b16 v[36:37], v9 offset:4096
  buffer_load_dwordx4 v[176:179], v14, s[8:11], s36 offen offset:2048 sc1
  v_mfma_f32_16x16x32_bf16 v[56:59], v[120:123], v[20:23], v[56:59]
  ds_read_b64_tr_b16 v[38:39], v9 offset:4608
  v_add_u32 v9, s42, v9
  s_waitcnt lgkmcnt(6)
  v_mfma_f32_16x16x32_bf16 v[64:67], v[120:123], v[24:27], v[64:67]
  ds_read_b64_tr_b16 v[40:41], v10 offset:4096
  v_mfma_f32_16x16x32_bf16 v[68:71], v[124:127], v[24:27], v[68:71]
  ds_read_b64_tr_b16 v[42:43], v10 offset:4608
  v_add_u32 v10, s42, v10
  s_waitcnt lgkmcnt(6)
  v_mfma_f32_16x16x32_bf16 v[76:79], v[124:127], v[28:31], v[76:79]
  ds_read_b64_tr_b16 v[44:45], v11 offset:4096
  buffer_load_dwordx4 v[180:183], v14, s[8:11], s36 offen offset:3072 sc1
  v_mfma_f32_16x16x32_bf16 v[72:75], v[120:123], v[28:31], v[72:75]
  ds_read_b64_tr_b16 v[46:47], v11 offset:4608
  v_add_u32 v11, s42, v11
  s_barrier
  s_waitcnt vmcnt(13) lgkmcnt(6)
  v_mfma_f32_16x16x32_bf16 v[48:51], v[128:131], v[32:35], v[48:51]
  ds_read_b64_tr_b16 v[16:17], v8 offset:0
  s_add_u32 s40, s43, 8192
  s_cmp_eq_u32 s40, 65536
  s_waitcnt vmcnt(12)
  v_mfma_f32_16x16x32_bf16 v[52:55], v[132:135], v[32:35], v[52:55]
  ds_read_b64_tr_b16 v[18:19], v8 offset:512
  s_cselect_b32 s40, 0, s40
  s_sub_u32 s42, s40, s43
  s_waitcnt lgkmcnt(6)
  v_mfma_f32_16x16x32_bf16 v[60:63], v[132:135], v[36:39], v[60:63]
  ds_read_b64_tr_b16 v[20:21], v9 offset:0
  s_mov_b32 s43, s40
  v_mfma_f32_16x16x32_bf16 v[56:59], v[128:131], v[36:39], v[56:59]
  ds_read_b64_tr_b16 v[22:23], v9 offset:512
  s_waitcnt lgkmcnt(6)
  v_mfma_f32_16x16x32_bf16 v[64:67], v[128:131], v[40:43], v[64:67]
  ds_read_b64_tr_b16 v[24:25], v10 offset:0
  v_mfma_f32_16x16x32_bf16 v[68:71], v[132:135], v[40:43], v[68:71]
  ds_read_b64_tr_b16 v[26:27], v10 offset:512
  s_waitcnt lgkmcnt(6)
  v_mfma_f32_16x16x32_bf16 v[76:79], v[132:135], v[44:47], v[76:79]
  ds_read_b64_tr_b16 v[28:29], v11 offset:0
  v_mfma_f32_16x16x32_bf16 v[72:75], v[128:131], v[44:47], v[72:75]
  ds_read_b64_tr_b16 v[30:31], v11 offset:512
  s_waitcnt vmcnt(11) lgkmcnt(6)
  v_mfma_f32_16x16x32_bf16 v[48:51], v[136:139], v[16:19], v[48:51]
  ds_read_b64_tr_b16 v[32:33], v8 offset:4096
  s_waitcnt vmcnt(10)
  v_mfma_f32_16x16x32_bf16 v[52:55], v[140:143], v[16:19], v[52:55]
  ds_read_b64_tr_b16 v[34:35], v8 offset:4608
  v_add_u32 v8, s42, v8
  s_waitcnt lgkmcnt(6)
  v_mfma_f32_16x16x32_bf16 v[60:63], v[140:143], v[20:23], v[60:63]
  ds_read_b64_tr_b16 v[36:37], v9 offset:4096
  v_mfma_f32_16x16x32_bf16 v[56:59], v[136:139], v[20:23], v[56:59]
  ds_read_b64_tr_b16 v[38:39], v9 offset:4608
  v_add_u32 v9, s42, v9
  s_waitcnt lgkmcnt(6)
  v_mfma_f32_16x16x32_bf16 v[64:67], v[136:139], v[24:27], v[64:67]
  ds_read_b64_tr_b16 v[40:41], v10 offset:4096
  v_mfma_f32_16x16x32_bf16 v[68:71], v[140:143], v[24:27], v[68:71]
  ds_read_b64_tr_b16 v[42:43], v10 offset:4608
  v_add_u32 v10, s42, v10
  s_waitcnt lgkmcnt(6)
  v_mfma_f32_16x16x32_bf16 v[76:79], v[140:143], v[28:31], v[76:79]
  ds_read_b64_tr_b16 v[44:45], v11 offset:4096
  v_mfma_f32_16x16x32_bf16 v[72:75], v[136:139], v[28:31], v[72:75]
  ds_read_b64_tr_b16 v[46:47], v11 offset:4608
  v_add_u32 v11, s42, v11
  s_barrier
  s_waitcnt vmcnt(9) lgkmcnt(6)
  v_mfma_f32_16x16x32_bf16 v[48:51], v[144:147], v[32:35], v[48:51]
  ds_read_b64_tr_b16 v[16:17], v8 offset:0
  s_add_u32 s40, s43, 8192
  s_cmp_eq_u32 s40, 65536
  s_waitcnt vmcnt(8)
  v_mfma_f32_16x16x32_bf16 v[52:55], v[148:151], v[32:35], v[52:55]
  ds_read_b64_tr_b16 v[18:19], v8 offset:512
  s_cselect_b32 s40, 0, s40
  s_sub_u32 s42, s40, s43
  s_waitcnt lgkmcnt(6)
  v_mfma_f32_16x16x32_bf16 v[60:63], v[148:151], v[36:39], v[60:63]
  ds_read_b64_tr_b16 v[20:21], v9 offset:0
  s_mov_b32 s43, s40
  v_mfma_f32_16x16x32_bf16 v[56:59], v[144:147], v[36:39], v[56:59]
  ds_read_b64_tr_b16 v[22:23], v9 offset:512
  s_waitcnt lgkmcnt(6)
  v_mfma_f32_16x16x32_bf16 v[64:67], v[144:147], v[40:43], v[64:67]
  ds_read_b64_tr_b16 v[24:25], v10 offset:0
  v_mfma_f32_16x16x32_bf16 v[68:71], v[148:151], v[40:43], v[68:71]
  ds_read_b64_tr_b16 v[26:27], v10 offset:512
  s_waitcnt lgkmcnt(6)
  v_mfma_f32_16x16x32_bf16 v[76:79], v[148:151], v[44:47], v[76:79]
  ds_read_b64_tr_b16 v[28:29], v11 offset:0
  v_mfma_f32_16x16x32_bf16 v[72:75], v[144:147], v[44:47], v[72:75]
  ds_read_b64_tr_b16 v[30:31], v11 offset:512
  s_waitcnt vmcnt(7) lgkmcnt(6)
  v_mfma_f32_16x16x32_bf16 v[48:51], v[152:155], v[16:19], v[48:51]
  ds_read_b64_tr_b16 v[32:33], v8 offset:4096
  s_waitcnt vmcnt(6)
  v_mfma_f32_16x16x32_bf16 v[52:55], v[156:159], v[16:19], v[52:55]
  ds_read_b64_tr_b16 v[34:35], v8 offset:4608
  v_add_u32 v8, s42, v8
  s_waitcnt lgkmcnt(6)
  v_mfma_f32_16x16x32_bf16 v[60:63], v[156:159], v[20:23], v[60:63]
  ds_read_b64_tr_b16 v[36:37], v9 offset:4096
  v_mfma_f32_16x16x32_bf16 v[56:59], v[152:155], v[20:23], v[56:59]
  ds_read_b64_tr_b16 v[38:39], v9 offset:4608
  v_add_u32 v9, s42, v9
  s_waitcnt lgkmcnt(6)
  v_mfma_f32_16x16x32_bf16 v[64:67], v[152:155], v[24:27], v[64:67]
  ds_read_b64_tr_b16 v[40:41], v10 offset:4096
  v_mfma_f32_16x16x32_bf16 v[68:71], v[156:159], v[24:27], v[68:71]
  ds_read_b64_tr_b16 v[42:43], v10 offset:4608
  v_add_u32 v10, s42, v10
  s_waitcnt lgkmcnt(6)
  v_mfma_f32_16x16x32_bf16 v[76:79], v[156:159], v[28:31], v[76:79]
  ds_read_b64_tr_b16 v[44:45], v11 offset:4096
  v_mfma_f32_16x16x32_bf16 v[72:75], v[152:155], v[28:31], v[72:75]
  ds_read_b64_tr_b16 v[46:47], v11 offset:4608
  v_add_u32 v11, s42, v11
  s_barrier
  s_waitcnt vmcnt(5) lgkmcnt(6)
  v_mfma_f32_16x16x32_bf16 v[48:51], v[160:163], v[32:35], v[48:51]
  ds_read_b64_tr_b16 v[16:17], v8 offset:0
  s_add_u32 s40, s43, 8192
  s_cmp_eq_u32 s40, 65536
  s_waitcnt vmcnt(4)
  v_mfma_f32_16x16x32_bf16 v[52:55], v[164:167], v[32:35], v[52:55]
  ds_read_b64_tr_b16 v[18:19], v8 offset:512
  s_cselect_b32 s40, 0, s40
  s_sub_u32 s42, s40, s43
  s_waitcnt lgkmcnt(6)
  v_mfma_f32_16x16x32_bf16 v[60:63], v[164:167], v[36:39], v[60:63]
  ds_read_b64_tr_b16 v[20:21], v9 offset:0
  s_mov_b32 s43, s40
  v_mfma_f32_16x16x32_bf16 v[56:59], v[160:163], v[36:39], v[56:59]
  ds_read_b64_tr_b16 v[22:23], v9 offset:512
  s_waitcnt lgkmcnt(6)
  v_mfma_f32_16x16x32_bf16 v[64:67], v[160:163], v[40:43], v[64:67]
  ds_read_b64_tr_b16 v[24:25], v10 offset:0
  v_mfma_f32_16x16x32_bf16 v[68:71], v[164:167], v[40:43], v[68:71]
  ds_read_b64_tr_b16 v[26:27], v10 offset:512
  s_waitcnt lgkmcnt(6)
  v_mfma_f32_16x16x32_bf16 v[76:79], v[164:167], v[44:47], v[76:79]
  ds_read_b64_tr_b16 v[28:29], v11 offset:0
  v_mfma_f32_16x16x32_bf16 v[72:75], v[160:163], v[44:47], v[72:75]
  ds_read_b64_tr_b16 v[30:31], v11 offset:512
  s_waitcnt vmcnt(3) lgkmcnt(6)
  v_mfma_f32_16x16x32_bf16 v[48:51], v[168:171], v[16:19], v[48:51]
  ds_read_b64_tr_b16 v[32:33], v8 offset:4096
  s_waitcnt vmcnt(2)
  v_mfma_f32_16x16x32_bf16 v[52:55], v[172:175], v[16:19], v[52:55]
  ds_read_b64_tr_b16 v[34:35], v8 offset:4608
  s_waitcnt lgkmcnt(6)
  v_mfma_f32_16x16x32_bf16 v[60:63], v[172:175], v[20:23], v[60:63]
  ds_read_b64_tr_b16 v[36:37], v9 offset:4096
  v_mfma_f32_16x16x32_bf16 v[56:59], v[168:171], v[20:23], v[56:59]
  ds_read_b64_tr_b16 v[38:39], v9 offset:4608
  s_waitcnt lgkmcnt(6)
  v_mfma_f32_16x16x32_bf16 v[64:67], v[168:171], v[24:27], v[64:67]
  ds_read_b64_tr_b16 v[40:41], v10 offset:4096
  v_mfma_f32_16x16x32_bf16 v[68:71], v[172:175], v[24:27], v[68:71]
  ds_read_b64_tr_b16 v[42:43], v10 offset:4608
  s_waitcnt lgkmcnt(6)
  v_mfma_f32_16x16x32_bf16 v[76:79], v[172:175], v[28:31], v[76:79]
  ds_read_b64_tr_b16 v[44:45], v11 offset:4096
  v_mfma_f32_16x16x32_bf16 v[72:75], v[168:171], v[28:31], v[72:75]
  ds_read_b64_tr_b16 v[46:47], v11 offset:4608
  s_waitcnt vmcnt(1) lgkmcnt(6)
  v_mfma_f32_16x16x32_bf16 v[48:51], v[176:179], v[32:35], v[48:51]
  s_waitcnt vmcnt(0)
  v_mfma_f32_16x16x32_bf16 v[52:55], v[180:183], v[32:35], v[52:55]
  s_waitcnt lgkmcnt(4)
  v_mfma_f32_16x16x32_bf16 v[60:63], v[180:183], v[36:39], v[60:63]
  v_mfma_f32_16x16x32_bf16 v[56:59], v[176:179], v[36:39], v[56:59]
  s_waitcnt lgkmcnt(2)
  v_mfma_f32_16x16x32_bf16 v[64:67], v[176:179], v[40:43], v[64:67]
  v_mfma_f32_16x16x32_bf16 v[68:71], v[180:183], v[40:43], v[68:71]
  s_waitcnt lgkmcnt(0)
  v_mfma_f32_16x16x32_bf16 v[76:79], v[180:183], v[44:47], v[76:79]
  v_mfma_f32_16x16x32_bf16 v[72:75], v[176:179], v[44:47], v[72:75]
  s_waitcnt lgkmcnt(0)
  s_cmp_eq_u32 s3, 0
  s_cbranch_scc1 C_st
  v_cvt_pk_bf16_f32 v96, v48, v49
  v_cvt_pk_bf16_f32 v97, v50, v51
  v_cvt_pk_bf16_f32 v98, v52, v53
  v_cvt_pk_bf16_f32 v99, v54, v55
  buffer_store_dwordx4 v[96:99], v12, s[24:27], 0 offen sc0 sc1
  v_cvt_pk_bf16_f32 v100, v56, v57
  v_cvt_pk_bf16_f32 v101, v58, v59
  v_cvt_pk_bf16_f32 v102, v60, v61
  v_cvt_pk_bf16_f32 v103, v62, v63
  buffer_store_dwordx4 v[100:103], v12, s[24:27], s45 offen sc0 sc1
  v_cvt_pk_bf16_f32 v104, v64, v65
  v_cvt_pk_bf16_f32 v105, v66, v67
  v_cvt_pk_bf16_f32 v106, v68, v69
  v_cvt_pk_bf16_f32 v107, v70, v71
  buffer_store_dwordx4 v[104:107], v12, s[24:27], s46 offen sc0 sc1
  v_cvt_pk_bf16_f32 v108, v72, v73
  v_cvt_pk_bf16_f32 v109, v74, v75
  v_cvt_pk_bf16_f32 v110, v76, v77
  v_cvt_pk_bf16_f32 v111, v78, v79
  buffer_store_dwordx4 v[108:111], v12, s[24:27], s47 offen sc0 sc1
  s_branch C_end
C_st:
  s_nop 7
  v_pk_add_f32 v[16:17], v[48:49], v[50:51]
  v_pk_mul_f32 v[18:19], v[48:49], v[48:49]
  v_pk_fma_f32 v[18:19], v[50:51], v[50:51], v[18:19]
  v_pk_add_f32 v[16:17], v[16:17], v[52:53]
  v_pk_fma_f32 v[18:19], v[52:53], v[52:53], v[18:19]
  v_pk_add_f32 v[16:17], v[16:17], v[54:55]
  v_pk_fma_f32 v[18:19], v[54:55], v[54:55], v[18:19]
  v_add_f32 v32, v16, v17
  v_add_f32 v36, v18, v19
  v_pk_add_f32 v[20:21], v[56:57], v[58:59]
  v_pk_mul_f32 v[22:23], v[56:57], v[56:57]
  v_pk_fma_f32 v[22:23], v[58:59], v[58:59], v[22:23]
  v_pk_add_f32 v[20:21], v[20:21], v[60:61]
  v_pk_fma_f32 v[22:23], v[60:61], v[60:61], v[22:23]
  v_pk_add_f32 v[20:21], v[20:21], v[62:63]
  v_pk_fma_f32 v[22:23], v[62:63], v[62:63], v[22:23]
  v_add_f32 v33, v20, v21
  v_add_f32 v37, v22, v23
  v_pk_add_f32 v[24:25], v[64:65], v[66:67]
  v_pk_mul_f32 v[26:27], v[64:65], v[64:65]
  v_pk_fma_f32 v[26:27], v[66:67], v[66:67], v[26:27]
  v_pk_add_f32 v[24:25], v[24:25], v[68:69]
  v_pk_fma_f32 v[26:27], v[68:69], v[68:69], v[26:27]
  v_pk_add_f32 v[24:25], v[24:25], v[70:71]
  v_pk_fma_f32 v[26:27], v[70:71], v[70:71], v[26:27]
  v_add_f32 v34, v24, v25
  v_add_f32 v38, v26, v27
  v_pk_add_f32 v[28:29], v[72:73], v[74:75]
  v_pk_mul_f32 v[30:31], v[72:73], v[72:73]
  v_pk_fma_f32 v[30:31], v[74:75], v[74:75], v[30:31]
  v_pk_add_f32 v[28:29], v[28:29], v[76:77]
  v_pk_fma_f32 v[30:31], v[76:77], v[76:77], v[30:31]
  v_pk_add_f32 v[28:29], v[28:29], v[78:79]
  v_pk_fma_f32 v[30:31], v[78:79], v[78:79], v[30:31]
  v_add_f32 v35, v28, v29
  v_add_f32 v39, v30, v31
  v_permlane16_swap_b32 v32, v33
  v_permlane16_swap_b32 v34, v35
  v_permlane16_swap_b32 v36, v37
  v_permlane16_swap_b32 v38, v39
  v_add_f32 v32, v32, v33
  v_add_f32 v34, v34, v35
  v_add_f32 v36, v36, v37
  v_add_f32 v38, v38, v39
  v_permlane32_swap_b32 v32, v34
  s_nop 0
  v_permlane32_swap_b32 v36, v38
  v_add_f32 v40, v32, v34
  v_add_f32 v41, v36, v38
  ds_write_b64 v223, v[40:41]
  v_cvt_pk_bf16_f32 v96, v48, v49
  v_cvt_pk_bf16_f32 v97, v50, v51
  v_cvt_pk_bf16_f32 v98, v52, v53
  v_cvt_pk_bf16_f32 v99, v54, v55
  buffer_store_dwordx4 v[96:99], v12, s[24:27], 0 offen sc0 sc1
  v_cvt_pk_bf16_f32 v100, v56, v57
  v_cvt_pk_bf16_f32 v101, v58, v59
  v_cvt_pk_bf16_f32 v102, v60, v61
  v_cvt_pk_bf16_f32 v103, v62, v63
  buffer_store_dwordx4 v[100:103], v12, s[24:27], s45 offen sc0 sc1
  v_cvt_pk_bf16_f32 v104, v64, v65
  v_cvt_pk_bf16_f32 v105, v66, v67
  v_cvt_pk_bf16_f32 v106, v68, v69
  v_cvt_pk_bf16_f32 v107, v70, v71
  buffer_store_dwordx4 v[104:107], v12, s[24:27], s46 offen sc0 sc1
  v_cvt_pk_bf16_f32 v108, v72, v73
  v_cvt_pk_bf16_f32 v109, v74, v75
  v_cvt_pk_bf16_f32 v110, v76, v77
  v_cvt_pk_bf16_f32 v111, v78, v79
  buffer_store_dwordx4 v[108:111], v12, s[24:27], s47 offen sc0 sc1
  s_waitcnt lgkmcnt(0)
  s_barrier
  s_cmp_lg_u32 s4, 0
  s_cbranch_scc1 C_nost
  ds_read_b64 v[44:45], v223 offset:512
  ds_read_b64 v[46:47], v223 offset:1024
  ds_read_b64 v[18:19], v223 offset:1536
  s_lshl_b32 s32, s28, 14
  s_lshl_b32 s40, s29, 9
  s_add_u32 s32, s32, s40
  s_waitcnt lgkmcnt(0)
  v_pk_add_f32 v[40:41], v[40:41], v[44:45]
  v_pk_add_f32 v[46:47], v[46:47], v[18:19]
  v_pk_add_f32 v[40:41], v[40:41], v[46:47]
  buffer_store_dwordx2 v[40:41], v222, s[12:15], s32 offen sc0 sc1
C_nost:
  s_nop 1
  s_lshr_b32 s32, s2, 3
  s_lshr_b32 s5, s32, 3
  s_and_b32 s6, s32, 7
  s_lshl_b32 s7, s5, 1
  s_add_u32 s7, s7, s6
  s_and_b32 s7, s7, 7
  s_and_b32 s32, s2, 7
  s_lshr_b32 s28, s32, 1
  s_lshl_b32 s28, s28, 2
  s_add_u32 s28, s28, s5
  s_and_b32 s29, s32, 1
  s_mul_i32 s29, s29, 8
  s_add_u32 s29, s29, s6
  s_mov_b32 s30, 7
  s_mov_b32 s31, -1
  v_and_b32 v4, 15, v0
  v_lshrrev_b32 v5, 4, v0
  v_lshrrev_b32 v6, 2, v4
  v_and_b32 v7, 3, v0
  v_lshrrev_b32 v3, 5, v0
  v_and_b32 v2, 1, v5
  v_lshl_or_b32 v3, v2, 1, v3
  v_lshl_add_u32 v21, v5, 3, v6
  v_lshlrev_b32 v21, 7, v21
  v_lshl_add_u32 v21, v7, 3, v21
  v_lshrrev_b32 v22, 1, v6
  v_lshl_or_b32 v22, v2, 1, v22
  v_lshl_add_u32 v21, v22, 5, v21
  v_add_u32 v21, 18432, v21
  v_xor_b32 v8, 0, v21
  s_lshl_b32 s32, s4, 5
  v_xor_b32 v8, s32, v8
  v_lshrrev_b32 v21, 1, v4
  v_xor_b32 v21, v21, v5
  v_lshlrev_b32 v21, 4, v21
  v_lshlrev_b32 v22, 7, v4
  v_add_u32 v9, v21, v22
  v_xor_b32 v10, 64, v9
  v_and_b32 v21, 1, v4
  v_mul_u32_u24 v21, 28800, v21
  v_lshrrev_b32 v22, 1, v4
  v_mul_u32_u24 v22, 400, v22
  v_lshlrev_b32 v23, 3, v5
  v_add3_u32 v11, v21, v22, v23
  s_add_u32 s32, s32, 43008
  v_add_u32 v11, s32, v11
  v_lshlrev_b32 v12, 3, v4
  v_add_u32 v12, 129024, v12
  v_mov_b64 v[112:113], 0
  v_mov_b64 v[114:115], 0
  v_mov_b64 v[116:117], 0
  v_mov_b64 v[118:119], 0
  v_mov_b64 v[120:121], 0
  v_mov_b64 v[122:123], 0
  v_mov_b64 v[124:125], 0
  v_mov_b64 v[126:127], 0
  v_mov_b64 v[128:129], 0
  v_mov_b64 v[130:131], 0
  v_mov_b64 v[132:133], 0
  v_mov_b64 v[134:135], 0
  v_mov_b64 v[136:137], 0
  v_mov_b64 v[138:139], 0
  v_mov_b64 v[140:141], 0
  v_mov_b64 v[142:143], 0
  v_mov_b64 v[144:145], 0
  v_mov_b64 v[146:147], 0
  v_mov_b64 v[148:149], 0
  v_mov_b64 v[150:151], 0
  v_mov_b64 v[152:153], 0
  v_mov_b64 v[154:155], 0
  v_mov_b64 v[156:157], 0
  v_mov_b64 v[158:159], 0
  v_mov_b64 v[160:161], 0
  v_mov_b64 v[162:163], 0
  v_mov_b64 v[164:165], 0
  v_mov_b64 v[166:167], 0
  v_mov_b64 v[168:169], 0
  v_mov_b64 v[170:171], 0
  v_mov_b64 v[172:173], 0
  v_mov_b64 v[174:175], 0
  v_mov_b64 v[176:177], 0
  v_mov_b64 v[178:179], 0
  v_mov_b64 v[180:181], 0
  v_mov_b64 v[182:183], 0
  v_mov_b64 v[184:185], 0
  v_mov_b64 v[186:187], 0
  v_mov_b64 v[188:189], 0
  v_mov_b64 v[190:191], 0
  v_mov_b64 v[192:193], 0
  v_mov_b64 v[194:195], 0
  v_mov_b64 v[196:197], 0
  v_mov_b64 v[198:199], 0
  v_mov_b64 v[200:201], 0
  v_mov_b64 v[202:203], 0
  v_mov_b64 v[204:205], 0
  v_mov_b64 v[206:207], 0
  v_mov_b64 v[208:209], 0
  v_mov_b64 v[210:211], 0
  v_mov_b64 v[212:213], 0
  v_mov_b64 v[214:215], 0
  v_mov_b64 v[216:217], 0
  v_mov_b64 v[218:219], 0
  s_waitcnt vmcnt(0)
  s_barrier
  s_barrier
  s_mov_b32 s3, 1
  s_mov_b32 s51, 9
  s_add_u32 s82, s84, 33554432
  s_addc_u32 s83, s85, 0
  s_branch C_top
C_end:
  s_endpgm
L_start:
  s_nop 7
  s_nop 7
  s_sub_u32 s57, s4, 4
  v_and_b32 v134, 3, v0
  v_lshlrev_b32 v134, 6, v134
  s_lshr_b32 s32, s2, 3
  s_lshr_b32 s5, s32, 3
  s_and_b32 s6, s32, 7
  s_lshl_b32 s7, s5, 1
  s_add_u32 s7, s7, s6
  s_and_b32 s7, s7, 7
  s_and_b32 s32, s2, 7
  s_lshr_b32 s28, s32, 1
  s_lshl_b32 s28, s28, 2
  s_add_u32 s28, s28, s5
  s_and_b32 s29, s32, 1
  s_mul_i32 s29, s29, 8
  s_add_u32 s29, s29, s6
  s_mov_b32 s30, 7
  s_mov_b32 s31, -1
  s_mov_b32 s41, s57
  s_mul_i32 s32, s41, 16
  s_add_u32 s32, s32, 0
  v_lshrrev_b32 v2, 3, v0
  v_add_u32 v2, s32, v2
  v_bfe_u32 v3, v2, 1, 1
  v_bfe_u32 v4, v2, 3, 1
  v_lshl_or_b32 v3, v4, 1, v3
  v_lshlrev_b32 v3, 1, v3
  v_and_b32 v4, 7, v0
  v_xor_b32 v3, v3, v4
  v_lshlrev_b32 v3, 4, v3
  s_mov_b32 s32, 6144
  v_mul_lo_u32 v2, v2, s32
  v_add_u32 v13, v2, v3
  s_mul_i32 s32, s41, 16
  s_add_u32 s32, s32, 8
  v_lshrrev_b32 v2, 3, v0
  v_add_u32 v2, s32, v2
  v_bfe_u32 v3, v2, 1, 1
  v_bfe_u32 v4, v2, 3, 1
  v_lshl_or_b32 v3, v4, 1, v3
  v_lshlrev_b32 v3, 1, v3
  v_and_b32 v4, 7, v0
  v_xor_b32 v3, v3, v4
  v_lshlrev_b32 v3, 4, v3
  s_mov_b32 s32, 6144
  v_mul_lo_u32 v2, v2, s32
  v_add_u32 v14, v2, v3
  v_subrev_u32 v14, 1024, v14
  v_add_u32 v15, 2048, v13
  v_add_u32 v16, 2048, v14
  v_add_u32 v17, 4096, v13
  v_add_u32 v18, 4096, v14
  s_lshl_b32 s46, s41, 11
  s_add_u32 s46, s46, 18432
  s_add_u32 s47, s46, 8192
  s_add_u32 s48, s46, 16384
  s_lshl_b32 s35, s29, 7
  s_lshl_b32 s40, s28, 7
  s_sub_u32 s40, s40, 16
  s_lshl_b32 s32, s41, 5
  s_add_u32 s32, s32, 16
  v_lshrrev_b32 v2, 3, v0
  v_add_u32 v2, s32, v2
  v_bfe_u32 v3, v2, 1, 3
  v_and_b32 v4, 7, v0
  v_xor_b32 v3, v3, v4
  v_lshlrev_b32 v3, 4, v3
  v_add_u32 v2, s40, v2
  v_max_i32 v2, 0, v2
  v_lshlrev_b32 v2, 11, v2
  v_add_u32 v8, v2, v3
  v_add_u32 v10, 30720, v8
  s_lshl_b32 s32, s41, 5
  s_add_u32 s32, s32, 24
  v_lshrrev_b32 v2, 3, v0
  v_add_u32 v2, s32, v2
  v_bfe_u32 v3, v2, 1, 3
  v_and_b32 v4, 7, v0
  v_xor_b32 v3, v3, v4
  v_lshlrev_b32 v3, 4, v3
  v_add_u32 v2, s40, v2
  v_max_i32 v2, 0, v2
  v_lshlrev_b32 v2, 11, v2
  v_add_u32 v9, v2, v3
  v_subrev_u32 v9, 1024, v9
  v_add_u32 v11, 30720, v9
  s_lshl_b32 s32, s41, 3
  v_lshrrev_b32 v2, 3, v0
  v_add_u32 v2, s32, v2
  v_bfe_u32 v3, v2, 1, 3
  v_and_b32 v4, 7, v0
  v_xor_b32 v3, v3, v4
  v_lshlrev_b32 v3, 4, v3
  v_add_u32 v2, s40, v2
  v_max_i32 v2, 0, v2
  v_lshlrev_b32 v2, 11, v2
  v_add_u32 v12, v2, v3
  s_lshl_b32 s44, s41, 12
  s_add_u32 s44, s44, 2048
  s_lshl_b32 s45, s41, 10
  s_mov_b32 s34, 0
  s_cmp_eq_u32 s41, 0
  s_cselect_b32 s52, 0xffffff00, -1
  s_mov_b32 s53, -1
  v_mov_b32 v20, 0x3f803f80
  v_mov_b32 v21, v20
  v_mov_b32 v22, v20
  v_mov_b32 v23, v20
  v_lshlrev_b32 v24, 4, v0
  v_add_u32 v25, 86016, v24
  s_mov_b64 exec, 0xff
  ds_write_b128 v24, v[20:23]
  ds_write_b128 v24, v[20:23] offset:43008
  ds_write_b128 v25, v[20:23]
  s_mov_b64 exec, -1
  s_lshl_b32 s32, s41, 6
  v_add_u32 v26, s32, v0
  v_min_u32 v26, 143, v26
  v_add_u32 v27, s40, v26
  v_max_i32 v27, 0, v27
  v_lshlrev_b32 v27, 3, v27
  v_lshlrev_b32 v26, 3, v26
  v_add_u32 v26, 129024, v26
  s_lshl_b32 s32, s2, 3
  s_lshl_b32 s40, s57, 1
  s_add_u32 s32, s32, s40
  v_lshrrev_b32 v72, 5, v0
  v_add_u32 v72, s32, v72
  v_lshlrev_b32 v46, 11, v72
  v_and_b32 v2, 31, v0
  v_lshl_add_u32 v46, v2, 4, v46
  v_lshlrev_b32 v72, 3, v72
  v_add_u32 v72, 22020096, v72
  s_cmp_eq_u32 s57, 0
  s_cselect_b32 s58, 0, -1
  v_mov_b32 v64, s58
  v_mov_b32 v65, s58
  v_mov_b32 v66, s58
  v_mov_b32 v67, s58
  v_lshrrev_b32 v2, 3, v0
  v_lshlrev_b32 v2, 15, v2
  v_and_b32 v3, 7, v0
  v_lshl_add_u32 v2, v3, 4, v2
  v_lshlrev_b32 v3, 4, v0
  s_cselect_b64 vcc, -1, 0
  s_lshl_b32 s58, s2, 7
  s_add_u32 s58, s58, 29360128
  s_lshl_b32 s59, s2, 10
  s_add_u32 s59, s59, 20971520
  s_cmp_eq_u32 s57, 0
  s_cselect_b32 s58, s58, s59
  s_add_u32 s59, s59, 33554432
  s_cmp_eq_u32 s57, 2
  s_cselect_b32 s58, s59, s58
  s_cmp_eq_u32 s57, 3
  s_cselect_b32 s58, 134217728, s58
  v_cndmask_b32 v47, v3, v2, vcc
  s_and_b32 s59, s2, 3
  s_lshl_b32 s59, s59, 6
  v_mov_b32 v73, s59
  v_mov_b32 v74, 1
  s_lshl_b32 s56, s3, 10
  s_mul_i32 s32, s28, 16
  s_add_u32 s56, s56, s32
  s_add_u32 s56, s56, s29
  s_add_u32 s56, s56, 0
  s_lshl_b32 s56, s56, 7
  s_mov_b32 s38, 0
  s_waitcnt lgkmcnt(0)
  s_mov_b32 s8, s64
  s_mov_b32 s9, s65
  s_mov_b32 s10, 4194304
  s_mov_b32 s11, 0x20000
  s_mov_b32 s12, s66
  s_mov_b32 s13, s67
  s_mov_b32 s14, 6291456
  s_mov_b32 s15, 0x20000
  s_branch L_first
L_top:
  s_nop 7
  s_nop 7
  s_lshl_b32 s56, s3, 10
  s_mul_i32 s32, s28, 16
  s_add_u32 s56, s56, s32
  s_add_u32 s56, s56, s29
  s_add_u32 s56, s56, 0
  s_lshl_b32 s56, s56, 7
  s_mov_b32 s24, s72
  s_mov_b32 s25, s73
  s_mov_b32 s26, 14680064
  s_mov_b32 s27, 0x20000
  s_lshl_b32 s54, s2, 2
  s_add_u32 s54, s54, s57
  s_mul_i32 s54, s54, 0
  s_add_u32 s54, s54, 0
  s_cmp_ge_u32 s57, 2
  s_cbranch_scc1 L_k1B
  s_mov_b32 s30, 7
  s_mov_b32 s31, -1
  s_mov_b32 s38, 0
  s_add_u32 s30, s30, 1
  s_and_b32 s30, s30, 7
  s_cselect_b32 s32, 0, 1
  s_add_u32 s31, s31, s32
  s_sub_u32 s32, s30, s7
  s_and_b32 s32, s32, 7
  s_cmp_lt_u32 s32, 2
  s_cselect_b32 s32, 1, 0
  s_add_u32 s32, s32, s31
  s_cmp_ge_u32 s32, 2
  s_cselect_b32 s32, 0, s32
  s_lshl_b32 s33, s32, 3
  s_add_u32 s33, s33, s30
  s_mul_i32 s36, s33, 128
  s_add_u32 s36, s36, s34
  s_add_u32 m0, s38, s45
  s_mov_b64 exec, s[52:53]
  buffer_load_dwordx4 v12, s[8:11], s36 offen offset:0 sc1 lds
  s_mov_b64 exec, -1
  s_add_u32 m0, s38, s44
  s_nop 0
  buffer_load_dwordx4 v8, s[8:11], s36 offen offset:0 sc1 lds
  buffer_load_dwordx4 v9, s[8:11], s36 offen offset:1024 sc1 lds
  buffer_load_dwordx4 v10, s[8:11], s36 offen offset:2048 sc1 lds
  buffer_load_dwordx4 v11, s[8:11], s36 offen offset:3072 sc1 lds
  s_add_u32 s38, s38, 43008
  s_cmp_eq_u32 s38, 129024
  s_cselect_b32 s38, 0, s38
  s_add_u32 s30, s30, 1
  s_and_b32 s30, s30, 7
  s_cselect_b32 s32, 0, 1
  s_add_u32 s31, s31, s32
  s_sub_u32 s32, s30, s7
  s_and_b32 s32, s32, 7
  s_cmp_lt_u32 s32, 2
  s_cselect_b32 s32, 1, 0
  s_add_u32 s32, s32, s31
  s_cmp_ge_u32 s32, 2
  s_cselect_b32 s32, 0, s32
  s_lshl_b32 s33, s32, 3
  s_add_u32 s33, s33, s30
  s_mul_i32 s36, s33, 128
  s_add_u32 s36, s36, s34
  s_add_u32 m0, s38, s45
  s_mov_b64 exec, s[52:53]
  buffer_load_dwordx4 v12, s[8:11], s36 offen offset:0 sc1 lds
  s_mov_b64 exec, -1
  s_add_u32 m0, s38, s44
  s_nop 0
  buffer_load_dwordx4 v8, s[8:11], s36 offen offset:0 sc1 lds
  buffer_load_dwordx4 v9, s[8:11], s36 offen offset:1024 sc1 lds
  buffer_load_dwordx4 v10, s[8:11], s36 offen offset:2048 sc1 lds
  buffer_load_dwordx4 v11, s[8:11], s36 offen offset:3072 sc1 lds
  s_add_u32 s38, s38, 43008
  s_cmp_eq_u32 s38, 129024
  s_cselect_b32 s38, 0, s38
  s_waitcnt vmcnt(5)
  s_barrier
  s_add_u32 s30, s30, 1
  s_and_b32 s30, s30, 7
  s_cselect_b32 s32, 0, 1
  s_add_u32 s31, s31, s32
  s_sub_u32 s32, s30, s7
  s_and_b32 s32, s32, 7
  s_cmp_lt_u32 s32, 2
  s_cselect_b32 s32, 1, 0
  s_add_u32 s32, s32, s31
  s_cmp_ge_u32 s32, 2
  s_cselect_b32 s32, 0, s32
  s_lshl_b32 s33, s32, 3
  s_add_u32 s33, s33, s30
  s_mul_i32 s36, s33, 128
  s_add_u32 s36, s36, s34
  s_mul_i32 s37, s33, 393216
  s_add_u32 s37, s37, s35
  s_add_u32 m0, s38, s45
  s_mov_b64 exec, s[52:53]
  buffer_load_dwordx4 v12, s[8:11], s36 offen offset:0 sc1 lds
  s_mov_b64 exec, -1
  s_add_u32 m0, s38, s44
  s_nop 0
  buffer_load_dwordx4 v8, s[8:11], s36 offen offset:0 sc1 lds
  buffer_load_dwordx4 v9, s[8:11], s36 offen offset:1024 sc1 lds
  buffer_load_dwordx4 v10, s[8:11], s36 offen offset:2048 sc1 lds
  buffer_load_dwordx4 v11, s[8:11], s36 offen offset:3072 sc1 lds
  s_add_u32 m0, s38, s46
  s_nop 0
  buffer_load_dwordx4 v13, s[12:15], s37 offen offset:0  lds
  buffer_load_dwordx4 v14, s[12:15], s37 offen offset:1024  lds
  s_add_u32 m0, s38, s47
  s_nop 0
  buffer_load_dwordx4 v15, s[12:15], s37 offen offset:0  lds
  buffer_load_dwordx4 v16, s[12:15], s37 offen offset:1024  lds
  s_add_u32 m0, s38, s48
  s_nop 0
  buffer_load_dwordx4 v17, s[12:15], s37 offen offset:0  lds
  buffer_load_dwordx4 v18, s[12:15], s37 offen offset:1024  lds
  s_add_u32 s38, s38, 43008
  s_cmp_eq_u32 s38, 129024
  s_cselect_b32 s38, 0, s38
L_jA:
  s_nop 1
  s_waitcnt vmcnt(11)
  s_barrier
  s_add_u32 s30, s30, 1
  s_and_b32 s30, s30, 7
  s_cselect_b32 s32, 0, 1
  s_add_u32 s31, s31, s32
  s_sub_u32 s32, s30, s7
  s_and_b32 s32, s32, 7
  s_cmp_lt_u32 s32, 2
  s_cselect_b32 s32, 1, 0
  s_add_u32 s32, s32, s31
  s_cmp_ge_u32 s32, 2
  s_cselect_b32 s32, 0, s32
  s_lshl_b32 s33, s32, 3
  s_add_u32 s33, s33, s30
  s_mul_i32 s36, s33, 128
  s_add_u32 s36, s36, s34
  s_mul_i32 s37, s33, 393216
  s_add_u32 s37, s37, s35
  s_add_u32 m0, s38, s45
  s_mov_b64 exec, s[52:53]
  buffer_load_dwordx4 v12, s[8:11], s36 offen offset:0 sc1 lds
  s_mov_b64 exec, -1
  s_add_u32 m0, s38, s44
  s_nop 0
  buffer_load_dwordx4 v8, s[8:11], s36 offen offset:0 sc1 lds
  buffer_load_dwordx4 v9, s[8:11], s36 offen offset:1024 sc1 lds
  buffer_load_dwordx4 v10, s[8:11], s36 offen offset:2048 sc1 lds
  buffer_load_dwordx4 v11, s[8:11], s36 offen offset:3072 sc1 lds
  s_add_u32 m0, s38, s46
  s_nop 0
  buffer_load_dwordx4 v13, s[12:15], s37 offen offset:0  lds
  buffer_load_dwordx4 v14, s[12:15], s37 offen offset:1024  lds
  s_add_u32 m0, s38, s47
  s_nop 0
  buffer_load_dwordx4 v15, s[12:15], s37 offen offset:0  lds
  buffer_load_dwordx4 v16, s[12:15], s37 offen offset:1024  lds
  s_add_u32 m0, s38, s48
  s_nop 0
  buffer_load_dwordx4 v17, s[12:15], s37 offen offset:0  lds
  buffer_load_dwordx4 v18, s[12:15], s37 offen offset:1024  lds
  s_add_u32 s38, s38, 43008
  s_cmp_eq_u32 s38, 129024
  s_cselect_b32 s38, 0, s38
  s_waitcnt vmcnt(11)
  s_barrier
  s_add_u32 s30, s30, 1
  s_and_b32 s30, s30, 7
  s_cselect_b32 s32, 0, 1
  s_add_u32 s31, s31, s32
  s_sub_u32 s32, s30, s7
  s_and_b32 s32, s32, 7
  s_cmp_lt_u32 s32, 2
  s_cselect_b32 s32, 1, 0
  s_add_u32 s32, s32, s31
  s_cmp_ge_u32 s32, 2
  s_cselect_b32 s32, 0, s32
  s_lshl_b32 s33, s32, 3
  s_add_u32 s33, s33, s30
  s_mul_i32 s36, s33, 128
  s_add_u32 s36, s36, s34
  s_mul_i32 s37, s33, 393216
  s_add_u32 s37, s37, s35
  s_add_u32 m0, s38, s45
  s_mov_b64 exec, s[52:53]
  buffer_load_dwordx4 v12, s[8:11], s36 offen offset:0 sc1 lds
  s_mov_b64 exec, -1
  s_add_u32 m0, s38, s44
  s_nop 0
  buffer_load_dwordx4 v8, s[8:11], s36 offen offset:0 sc1 lds
  buffer_load_dwordx4 v9, s[8:11], s36 offen offset:1024 sc1 lds
  buffer_load_dwordx4 v10, s[8:11], s36 offen offset:2048 sc1 lds
  buffer_load_dwordx4 v11, s[8:11], s36 offen offset:3072 sc1 lds
  s_add_u32 m0, s38, s46
  s_nop 0
  buffer_load_dwordx4 v13, s[12:15], s37 offen offset:0  lds
  buffer_load_dwordx4 v14, s[12:15], s37 offen offset:1024  lds
  s_add_u32 m0, s38, s47
  s_nop 0
  buffer_load_dwordx4 v15, s[12:15], s37 offen offset:0  lds
  buffer_load_dwordx4 v16, s[12:15], s37 offen offset:1024  lds
  s_add_u32 m0, s38, s48
  s_nop 0
  buffer_load_dwordx4 v17, s[12:15], s37 offen offset:0  lds
  buffer_load_dwordx4 v18, s[12:15], s37 offen offset:1024  lds
  s_add_u32 s38, s38, 43008
  s_cmp_eq_u32 s38, 129024
  s_cselect_b32 s38, 0, s38
  s_cmp_lg_u32 s3, 0
  s_cbranch_scc1 e6
  s_cmp_lg_u32 s57, 0
  s_cbranch_scc1 g7
  s_mov_b64 exec, 1
  global_atomic_add v73, v74, s[62:63] sc1
  s_mov_b64 exec, -1
g7:
e6:
  s_nop 1
  s_mov_b32 s39, 9
ll8:
  s_waitcnt vmcnt(11)
  s_barrier
  s_add_u32 s30, s30, 1
  s_and_b32 s30, s30, 7
  s_cselect_b32 s32, 0, 1
  s_add_u32 s31, s31, s32
  s_sub_u32 s32, s30, s7
  s_and_b32 s32, s32, 7
  s_cmp_lt_u32 s32, 2
  s_cselect_b32 s32, 1, 0
  s_add_u32 s32, s32, s31
  s_cmp_ge_u32 s32, 2
  s_cselect_b32 s32, 0, s32
  s_lshl_b32 s33, s32, 3
  s_add_u32 s33, s33, s30
  s_mul_i32 s36, s33, 128
  s_add_u32 s36, s36, s34
  s_mul_i32 s37, s33, 393216
  s_add_u32 s37, s37, s35
  s_add_u32 m0, s38, s45
  s_mov_b64 exec, s[52:53]
  buffer_load_dwordx4 v12, s[8:11], s36 offen offset:0 sc1 lds
  s_mov_b64 exec, -1
  s_add_u32 m0, s38, s44
  s_nop 0
  buffer_load_dwordx4 v8, s[8:11], s36 offen offset:0 sc1 lds
  buffer_load_dwordx4 v9, s[8:11], s36 offen offset:1024 sc1 lds
  buffer_load_dwordx4 v10, s[8:11], s36 offen offset:2048 sc1 lds
  buffer_load_dwordx4 v11, s[8:11], s36 offen offset:3072 sc1 lds
  s_add_u32 m0, s38, s46
  s_nop 0
  buffer_load_dwordx4 v13, s[12:15], s37 offen offset:0  lds
  buffer_load_dwordx4 v14, s[12:15], s37 offen offset:1024  lds
  s_add_u32 m0, s38, s47
  s_nop 0
  buffer_load_dwordx4 v15, s[12:15], s37 offen offset:0  lds
  buffer_load_dwordx4 v16, s[12:15], s37 offen offset:1024  lds
  s_add_u32 m0, s38, s48
  s_nop 0
  buffer_load_dwordx4 v17, s[12:15], s37 offen offset:0  lds
  buffer_load_dwordx4 v18, s[12:15], s37 offen offset:1024  lds
  s_add_u32 s38, s38, 43008
  s_cmp_eq_u32 s38, 129024
  s_cselect_b32 s38, 0, s38
  s_sub_u32 s39, s39, 1
  s_cmp_lg_u32 s39, 0
  s_cbranch_scc1 ll8
  s_waitcnt vmcnt(11)
  s_barrier
  s_add_u32 s30, s30, 1
  s_and_b32 s30, s30, 7
  s_cselect_b32 s32, 0, 1
  s_add_u32 s31, s31, s32
  s_sub_u32 s32, s30, s7
  s_and_b32 s32, s32, 7
  s_cmp_lt_u32 s32, 2
  s_cselect_b32 s32, 1, 0
  s_add_u32 s32, s32, s31
  s_cmp_ge_u32 s32, 2
  s_cselect_b32 s32, 0, s32
  s_lshl_b32 s33, s32, 3
  s_add_u32 s33, s33, s30
  s_mul_i32 s36, s33, 128
  s_add_u32 s36, s36, s34
  s_mul_i32 s37, s33, 393216
  s_add_u32 s37, s37, s35
  s_add_u32 m0, s38, s45
  s_mov_b64 exec, s[52:53]
  buffer_load_dwordx4 v12, s[8:11], s36 offen offset:0 sc1 lds
  s_mov_b64 exec, -1
  s_add_u32 m0, s38, s44
  s_nop 0
  buffer_load_dwordx4 v8, s[8:11], s36 offen offset:0 sc1 lds
  buffer_load_dwordx4 v9, s[8:11], s36 offen offset:1024 sc1 lds
  buffer_load_dwordx4 v10, s[8:11], s36 offen offset:2048 sc1 lds
  buffer_load_dwordx4 v11, s[8:11], s36 offen offset:3072 sc1 lds
  s_add_u32 m0, s38, s46
  s_nop 0
  buffer_load_dwordx4 v13, s[12:15], s37 offen offset:0  lds
  buffer_load_dwordx4 v14, s[12:15], s37 offen offset:1024  lds
  s_add_u32 m0, s38, s47
  s_nop 0
  buffer_load_dwordx4 v15, s[12:15], s37 offen offset:0  lds
  buffer_load_dwordx4 v16, s[12:15], s37 offen offset:1024  lds
  s_add_u32 m0, s38, s48
  s_nop 0
  buffer_load_dwordx4 v17, s[12:15], s37 offen offset:0  lds
  buffer_load_dwordx4 v18, s[12:15], s37 offen offset:1024  lds
  s_add_u32 s38, s38, 43008
  s_cmp_eq_u32 s38, 129024
  s_cselect_b32 s38, 0, s38
  global_load_dword v29, v134, s[62:63] sc0 sc1
  s_waitcnt vmcnt(11)
  s_barrier
  s_add_u32 s30, s30, 1
  s_and_b32 s30, s30, 7
  s_cselect_b32 s32, 0, 1
  s_add_u32 s31, s31, s32
  s_sub_u32 s32, s30, s7
  s_and_b32 s32, s32, 7
  s_cmp_lt_u32 s32, 2
  s_cselect_b32 s32, 1, 0
  s_add_u32 s32, s32, s31
  s_cmp_ge_u32 s32, 2
  s_cselect_b32 s32, 0, s32
  s_lshl_b32 s33, s32, 3
  s_add_u32 s33, s33, s30
  s_mul_i32 s36, s33, 128
  s_add_u32 s36, s36, s34
  s_mul_i32 s37, s33, 393216
  s_add_u32 s37, s37, s35
  s_add_u32 m0, s38, s45
  s_mov_b64 exec, s[52:53]
  buffer_load_dwordx4 v12, s[8:11], s36 offen offset:0 sc1 lds
  s_mov_b64 exec, -1
  s_add_u32 m0, s38, s44
  s_nop 0
  buffer_load_dwordx4 v8, s[8:11], s36 offen offset:0 sc1 lds
  buffer_load_dwordx4 v9, s[8:11], s36 offen offset:1024 sc1 lds
  buffer_load_dwordx4 v10, s[8:11], s36 offen offset:2048 sc1 lds
  buffer_load_dwordx4 v11, s[8:11], s36 offen offset:3072 sc1 lds
  s_add_u32 m0, s38, s46
  s_nop 0
  buffer_load_dwordx4 v13, s[12:15], s37 offen offset:0  lds
  buffer_load_dwordx4 v14, s[12:15], s37 offen offset:1024  lds
  s_add_u32 m0, s38, s47
  s_nop 0
  buffer_load_dwordx4 v15, s[12:15], s37 offen offset:0  lds
  buffer_load_dwordx4 v16, s[12:15], s37 offen offset:1024  lds
  s_add_u32 m0, s38, s48
  s_nop 0
  buffer_load_dwordx4 v17, s[12:15], s37 offen offset:0  lds
  buffer_load_dwordx4 v18, s[12:15], s37 offen offset:1024  lds
  s_add_u32 s38, s38, 43008
  s_cmp_eq_u32 s38, 129024
  s_cselect_b32 s38, 0, s38
  s_cmp_lg_u32 s3, 0
  s_cbranch_scc1 st9g
  s_waitcnt vmcnt(11)
  s_mov_b32 s61, 0
st9p:
  v_cmp_gt_u32 vcc, 64, v29
  s_add_u32 s61, s61, 1
  s_cmp_gt_u32 s61, 100000
  s_cbranch_scc1 st9g
  s_cbranch_vccz st9g
  global_load_dword v29, v134, s[62:63] sc0 sc1
  s_waitcnt vmcnt(0)
  s_branch st9p
st9g:
  buffer_load_dwordx2 v[30:31], v27, s[20:23], 0 offen sc1
  s_mov_b32 s32, 16384
  buffer_load_dwordx2 v[32:33], v27, s[20:23], s32 offen sc1
  s_mov_b32 s32, 32768
  buffer_load_dwordx2 v[34:35], v27, s[20:23], s32 offen sc1
  s_mov_b32 s32, 49152
  buffer_load_dwordx2 v[36:37], v27, s[20:23], s32 offen sc1
  s_mov_b32 s32, 65536
  buffer_load_dwordx2 v[38:39], v27, s[20:23], s32 offen sc1
  s_mov_b32 s32, 81920
  buffer_load_dwordx2 v[40:41], v27, s[20:23], s32 offen sc1
  s_mov_b32 s32, 98304
  buffer_load_dwordx2 v[42:43], v27, s[20:23], s32 offen sc1
  s_mov_b32 s32, 114688
  buffer_load_dwordx2 v[44:45], v27, s[20:23], s32 offen sc1
  s_waitcnt vmcnt(19)
  s_barrier
  s_branch L_k1t
L_k1B:
  s_nop 7
  s_nop 7
  s_mov_b32 s30, 7
  s_mov_b32 s31, -1
  s_mov_b32 s38, 0
  s_add_u32 s30, s30, 1
  s_and_b32 s30, s30, 7
  s_cselect_b32 s32, 0, 1
  s_add_u32 s31, s31, s32
  s_sub_u32 s32, s30, s7
  s_and_b32 s32, s32, 7
  s_cmp_lt_u32 s32, 2
  s_cselect_b32 s32, 1, 0
  s_add_u32 s32, s32, s31
  s_cmp_ge_u32 s32, 2
  s_cselect_b32 s32, 0, s32
  s_lshl_b32 s33, s32, 3
  s_add_u32 s33, s33, s30
  s_mul_i32 s36, s33, 128
  s_add_u32 s36, s36, s34
  s_add_u32 m0, s38, s44
  s_nop 0
  buffer_load_dwordx4 v8, s[8:11], s36 offen offset:0 sc1 lds
  buffer_load_dwordx4 v9, s[8:11], s36 offen offset:1024 sc1 lds
  buffer_load_dwordx4 v10, s[8:11], s36 offen offset:2048 sc1 lds
  buffer_load_dwordx4 v11, s[8:11], s36 offen offset:3072 sc1 lds
  s_add_u32 s38, s38, 43008
  s_cmp_eq_u32 s38, 129024
  s_cselect_b32 s38, 0, s38
  s_add_u32 s30, s30, 1
  s_and_b32 s30, s30, 7
  s_cselect_b32 s32, 0, 1
  s_add_u32 s31, s31, s32
  s_sub_u32 s32, s30, s7
  s_and_b32 s32, s32, 7
  s_cmp_lt_u32 s32, 2
  s_cselect_b32 s32, 1, 0
  s_add_u32 s32, s32, s31
  s_cmp_ge_u32 s32, 2
  s_cselect_b32 s32, 0, s32
  s_lshl_b32 s33, s32, 3
  s_add_u32 s33, s33, s30
  s_mul_i32 s36, s33, 128
  s_add_u32 s36, s36, s34
  s_add_u32 m0, s38, s44
  s_nop 0
  buffer_load_dwordx4 v8, s[8:11], s36 offen offset:0 sc1 lds
  buffer_load_dwordx4 v9, s[8:11], s36 offen offset:1024 sc1 lds
  buffer_load_dwordx4 v10, s[8:11], s36 offen offset:2048 sc1 lds
  buffer_load_dwordx4 v11, s[8:11], s36 offen offset:3072 sc1 lds
  s_add_u32 s38, s38, 43008
  s_cmp_eq_u32 s38, 129024
  s_cselect_b32 s38, 0, s38
  s_waitcnt vmcnt(4)
  s_barrier
  s_add_u32 s30, s30, 1
  s_and_b32 s30, s30, 7
  s_cselect_b32 s32, 0, 1
  s_add_u32 s31, s31, s32
  s_sub_u32 s32, s30, s7
  s_and_b32 s32, s32, 7
  s_cmp_lt_u32 s32, 2
  s_cselect_b32 s32, 1, 0
  s_add_u32 s32, s32, s31
  s_cmp_ge_u32 s32, 2
  s_cselect_b32 s32, 0, s32
  s_lshl_b32 s33, s32, 3
  s_add_u32 s33, s33, s30
  s_mul_i32 s36, s33, 128
  s_add_u32 s36, s36, s34
  s_mul_i32 s37, s33, 393216
  s_add_u32 s37, s37, s35
  s_add_u32 m0, s38, s44
  s_nop 0
  buffer_load_dwordx4 v8, s[8:11], s36 offen offset:0 sc1 lds
  buffer_load_dwordx4 v9, s[8:11], s36 offen offset:1024 sc1 lds
  buffer_load_dwordx4 v10, s[8:11], s36 offen offset:2048 sc1 lds
  buffer_load_dwordx4 v11, s[8:11], s36 offen offset:3072 sc1 lds
  s_add_u32 m0, s38, s46
  s_nop 0
  buffer_load_dwordx4 v13, s[12:15], s37 offen offset:0  lds
  buffer_load_dwordx4 v14, s[12:15], s37 offen offset:1024  lds
  s_add_u32 m0, s38, s47
  s_nop 0
  buffer_load_dwordx4 v15, s[12:15], s37 offen offset:0  lds
  buffer_load_dwordx4 v16, s[12:15], s37 offen offset:1024  lds
  s_add_u32 m0, s38, s48
  s_nop 0
  buffer_load_dwordx4 v17, s[12:15], s37 offen offset:0  lds
  buffer_load_dwordx4 v18, s[12:15], s37 offen offset:1024  lds
  s_add_u32 s38, s38, 43008
  s_cmp_eq_u32 s38, 129024
  s_cselect_b32 s38, 0, s38
L_jB:
  s_nop 1
  s_waitcnt vmcnt(10)
  s_barrier
  s_add_u32 s30, s30, 1
  s_and_b32 s30, s30, 7
  s_cselect_b32 s32, 0, 1
  s_add_u32 s31, s31, s32
  s_sub_u32 s32, s30, s7
  s_and_b32 s32, s32, 7
  s_cmp_lt_u32 s32, 2
  s_cselect_b32 s32, 1, 0
  s_add_u32 s32, s32, s31
  s_cmp_ge_u32 s32, 2
  s_cselect_b32 s32, 0, s32
  s_lshl_b32 s33, s32, 3
  s_add_u32 s33, s33, s30
  s_mul_i32 s36, s33, 128
  s_add_u32 s36, s36, s34
  s_mul_i32 s37, s33, 393216
  s_add_u32 s37, s37, s35
  s_add_u32 m0, s38, s44
  s_nop 0
  buffer_load_dwordx4 v8, s[8:11], s36 offen offset:0 sc1 lds
  buffer_load_dwordx4 v9, s[8:11], s36 offen offset:1024 sc1 lds
  buffer_load_dwordx4 v10, s[8:11], s36 offen offset:2048 sc1 lds
  buffer_load_dwordx4 v11, s[8:11], s36 offen offset:3072 sc1 lds
  s_add_u32 m0, s38, s46
  s_nop 0
  buffer_load_dwordx4 v13, s[12:15], s37 offen offset:0  lds
  buffer_load_dwordx4 v14, s[12:15], s37 offen offset:1024  lds
  s_add_u32 m0, s38, s47
  s_nop 0
  buffer_load_dwordx4 v15, s[12:15], s37 offen offset:0  lds
  buffer_load_dwordx4 v16, s[12:15], s37 offen offset:1024  lds
  s_add_u32 m0, s38, s48
  s_nop 0
  buffer_load_dwordx4 v17, s[12:15], s37 offen offset:0  lds
  buffer_load_dwordx4 v18, s[12:15], s37 offen offset:1024  lds
  s_add_u32 s38, s38, 43008
  s_cmp_eq_u32 s38, 129024
  s_cselect_b32 s38, 0, s38
  s_waitcnt vmcnt(10)
  s_barrier
  s_add_u32 s30, s30, 1
  s_and_b32 s30, s30, 7
  s_cselect_b32 s32, 0, 1
  s_add_u32 s31, s31, s32
  s_sub_u32 s32, s30, s7
  s_and_b32 s32, s32, 7
  s_cmp_lt_u32 s32, 2
  s_cselect_b32 s32, 1, 0
  s_add_u32 s32, s32, s31
  s_cmp_ge_u32 s32, 2
  s_cselect_b32 s32, 0, s32
  s_lshl_b32 s33, s32, 3
  s_add_u32 s33, s33, s30
  s_mul_i32 s36, s33, 128
  s_add_u32 s36, s36, s34
  s_mul_i32 s37, s33, 393216
  s_add_u32 s37, s37, s35
  s_add_u32 m0, s38, s44
  s_nop 0
  buffer_load_dwordx4 v8, s[8:11], s36 offen offset:0 sc1 lds
  buffer_load_dwordx4 v9, s[8:11], s36 offen offset:1024 sc1 lds
  buffer_load_dwordx4 v10, s[8:11], s36 offen offset:2048 sc1 lds
  buffer_load_dwordx4 v11, s[8:11], s36 offen offset:3072 sc1 lds
  s_add_u32 m0, s38, s46
  s_nop 0
  buffer_load_dwordx4 v13, s[12:15], s37 offen offset:0  lds
  buffer_load_dwordx4 v14, s[12:15], s37 offen offset:1024  lds
  s_add_u32 m0, s38, s47
  s_nop 0
  buffer_load_dwordx4 v15, s[12:15], s37 offen offset:0  lds
  buffer_load_dwordx4 v16, s[12:15], s37 offen offset:1024  lds
  s_add_u32 m0, s38, s48
  s_nop 0
  buffer_load_dwordx4 v17, s[12:15], s37 offen offset:0  lds
  buffer_load_dwordx4 v18, s[12:15], s37 offen offset:1024  lds
  s_add_u32 s38, s38, 43008
  s_cmp_eq_u32 s38, 129024
  s_cselect_b32 s38, 0, s38
  s_cmp_lg_u32 s3, 0
  s_cbranch_scc1 e10
  s_cmp_lg_u32 s57, 0
  s_cbranch_scc1 g11
  s_mov_b64 exec, 1
  global_atomic_add v73, v74, s[62:63] sc1
  s_mov_b64 exec, -1
g11:
e10:
  s_nop 1
  s_mov_b32 s39, 9
ll12:
  s_waitcnt vmcnt(10)
  s_barrier
  s_add_u32 s30, s30, 1
  s_and_b32 s30, s30, 7
  s_cselect_b32 s32, 0, 1
  s_add_u32 s31, s31, s32
  s_sub_u32 s32, s30, s7
  s_and_b32 s32, s32, 7
  s_cmp_lt_u32 s32, 2
  s_cselect_b32 s32, 1, 0
  s_add_u32 s32, s32, s31
  s_cmp_ge_u32 s32, 2
  s_cselect_b32 s32, 0, s32
  s_lshl_b32 s33, s32, 3
  s_add_u32 s33, s33, s30
  s_mul_i32 s36, s33, 128
  s_add_u32 s36, s36, s34
  s_mul_i32 s37, s33, 393216
  s_add_u32 s37, s37, s35
  s_add_u32 m0, s38, s44
  s_nop 0
  buffer_load_dwordx4 v8, s[8:11], s36 offen offset:0 sc1 lds
  buffer_load_dwordx4 v9, s[8:11], s36 offen offset:1024 sc1 lds
  buffer_load_dwordx4 v10, s[8:11], s36 offen offset:2048 sc1 lds
  buffer_load_dwordx4 v11, s[8:11], s36 offen offset:3072 sc1 lds
  s_add_u32 m0, s38, s46
  s_nop 0
  buffer_load_dwordx4 v13, s[12:15], s37 offen offset:0  lds
  buffer_load_dwordx4 v14, s[12:15], s37 offen offset:1024  lds
  s_add_u32 m0, s38, s47
  s_nop 0
  buffer_load_dwordx4 v15, s[12:15], s37 offen offset:0  lds
  buffer_load_dwordx4 v16, s[12:15], s37 offen offset:1024  lds
  s_add_u32 m0, s38, s48
  s_nop 0
  buffer_load_dwordx4 v17, s[12:15], s37 offen offset:0  lds
  buffer_load_dwordx4 v18, s[12:15], s37 offen offset:1024  lds
  s_add_u32 s38, s38, 43008
  s_cmp_eq_u32 s38, 129024
  s_cselect_b32 s38, 0, s38
  s_sub_u32 s39, s39, 1
  s_cmp_lg_u32 s39, 0
  s_cbranch_scc1 ll12
  s_waitcnt vmcnt(10)
  s_barrier
  s_add_u32 s30, s30, 1
  s_and_b32 s30, s30, 7
  s_cselect_b32 s32, 0, 1
  s_add_u32 s31, s31, s32
  s_sub_u32 s32, s30, s7
  s_and_b32 s32, s32, 7
  s_cmp_lt_u32 s32, 2
  s_cselect_b32 s32, 1, 0
  s_add_u32 s32, s32, s31
  s_cmp_ge_u32 s32, 2
  s_cselect_b32 s32, 0, s32
  s_lshl_b32 s33, s32, 3
  s_add_u32 s33, s33, s30
  s_mul_i32 s36, s33, 128
  s_add_u32 s36, s36, s34
  s_mul_i32 s37, s33, 393216
  s_add_u32 s37, s37, s35
  s_add_u32 m0, s38, s44
  s_nop 0
  buffer_load_dwordx4 v8, s[8:11], s36 offen offset:0 sc1 lds
  buffer_load_dwordx4 v9, s[8:11], s36 offen offset:1024 sc1 lds
  buffer_load_dwordx4 v10, s[8:11], s36 offen offset:2048 sc1 lds
  buffer_load_dwordx4 v11, s[8:11], s36 offen offset:3072 sc1 lds
  s_add_u32 m0, s38, s46
  s_nop 0
  buffer_load_dwordx4 v13, s[12:15], s37 offen offset:0  lds
  buffer_load_dwordx4 v14, s[12:15], s37 offen offset:1024  lds
  s_add_u32 m0, s38, s47
  s_nop 0
  buffer_load_dwordx4 v15, s[12:15], s37 offen offset:0  lds
  buffer_load_dwordx4 v16, s[12:15], s37 offen offset:1024  lds
  s_add_u32 m0, s38, s48
  s_nop 0
  buffer_load_dwordx4 v17, s[12:15], s37 offen offset:0  lds
  buffer_load_dwordx4 v18, s[12:15], s37 offen offset:1024  lds
  s_add_u32 s38, s38, 43008
  s_cmp_eq_u32 s38, 129024
  s_cselect_b32 s38, 0, s38
  global_load_dword v29, v134, s[62:63] sc0 sc1
  s_waitcnt vmcnt(10)
  s_barrier
  s_add_u32 s30, s30, 1
  s_and_b32 s30, s30, 7
  s_cselect_b32 s32, 0, 1
  s_add_u32 s31, s31, s32
  s_sub_u32 s32, s30, s7
  s_and_b32 s32, s32, 7
  s_cmp_lt_u32 s32, 2
  s_cselect_b32 s32, 1, 0
  s_add_u32 s32, s32, s31
  s_cmp_ge_u32 s32, 2
  s_cselect_b32 s32, 0, s32
  s_lshl_b32 s33, s32, 3
  s_add_u32 s33, s33, s30
  s_mul_i32 s36, s33, 128
  s_add_u32 s36, s36, s34
  s_mul_i32 s37, s33, 393216
  s_add_u32 s37, s37, s35
  s_add_u32 m0, s38, s44
  s_nop 0
  buffer_load_dwordx4 v8, s[8:11], s36 offen offset:0 sc1 lds
  buffer_load_dwordx4 v9, s[8:11], s36 offen offset:1024 sc1 lds
  buffer_load_dwordx4 v10, s[8:11], s36 offen offset:2048 sc1 lds
  buffer_load_dwordx4 v11, s[8:11], s36 offen offset:3072 sc1 lds
  s_add_u32 m0, s38, s46
  s_nop 0
  buffer_load_dwordx4 v13, s[12:15], s37 offen offset:0  lds
  buffer_load_dwordx4 v14, s[12:15], s37 offen offset:1024  lds
  s_add_u32 m0, s38, s47
  s_nop 0
  buffer_load_dwordx4 v15, s[12:15], s37 offen offset:0  lds
  buffer_load_dwordx4 v16, s[12:15], s37 offen offset:1024  lds
  s_add_u32 m0, s38, s48
  s_nop 0
  buffer_load_dwordx4 v17, s[12:15], s37 offen offset:0  lds
  buffer_load_dwordx4 v18, s[12:15], s37 offen offset:1024  lds
  s_add_u32 s38, s38, 43008
  s_cmp_eq_u32 s38, 129024
  s_cselect_b32 s38, 0, s38
  s_cmp_lg_u32 s3, 0
  s_cbranch_scc1 st13g
  s_waitcnt vmcnt(10)
  s_mov_b32 s61, 0
st13p:
  v_cmp_gt_u32 vcc, 64, v29
  s_add_u32 s61, s61, 1
  s_cmp_gt_u32 s61, 100000
  s_cbranch_scc1 st13g
  s_cbranch_vccz st13g
  global_load_dword v29, v134, s[62:63] sc0 sc1
  s_waitcnt vmcnt(0)
  s_branch st13p
st13g:
  buffer_load_dwordx2 v[30:31], v27, s[20:23], 0 offen sc1
  s_mov_b32 s32, 16384
  buffer_load_dwordx2 v[32:33], v27, s[20:23], s32 offen sc1
  s_mov_b32 s32, 32768
  buffer_load_dwordx2 v[34:35], v27, s[20:23], s32 offen sc1
  s_mov_b32 s32, 49152
  buffer_load_dwordx2 v[36:37], v27, s[20:23], s32 offen sc1
  s_mov_b32 s32, 65536
  buffer_load_dwordx2 v[38:39], v27, s[20:23], s32 offen sc1
  s_mov_b32 s32, 81920
  buffer_load_dwordx2 v[40:41], v27, s[20:23], s32 offen sc1
  s_mov_b32 s32, 98304
  buffer_load_dwordx2 v[42:43], v27, s[20:23], s32 offen sc1
  s_mov_b32 s32, 114688
  buffer_load_dwordx2 v[44:45], v27, s[20:23], s32 offen sc1
  s_waitcnt vmcnt(18)
  s_barrier
  s_branch L_k1t
L_first:
  s_nop 7
  s_nop 7
  s_cmp_ge_u32 s57, 2
  s_cbranch_scc1 L_firstB
  s_add_u32 s30, s30, 1
  s_and_b32 s30, s30, 7
  s_cselect_b32 s32, 0, 1
  s_add_u32 s31, s31, s32
  s_sub_u32 s32, s30, s7
  s_and_b32 s32, s32, 7
  s_cmp_lt_u32 s32, 2
  s_cselect_b32 s32, 1, 0
  s_add_u32 s32, s32, s31
  s_cmp_ge_u32 s32, 2
  s_cselect_b32 s32, 0, s32
  s_lshl_b32 s33, s32, 3
  s_add_u32 s33, s33, s30
  s_mul_i32 s36, s33, 128
  s_add_u32 s36, s36, s34
  s_mul_i32 s37, s33, 393216
  s_add_u32 s37, s37, s35
  s_add_u32 m0, s38, s45
  s_mov_b64 exec, s[52:53]
  buffer_load_dwordx4 v12, s[8:11], s36 offen offset:0 sc1 lds
  s_mov_b64 exec, -1
  s_add_u32 m0, s38, s44
  s_nop 0
  buffer_load_dwordx4 v8, s[8:11], s36 offen offset:0 sc1 lds
  buffer_load_dwordx4 v9, s[8:11], s36 offen offset:1024 sc1 lds
  buffer_load_dwordx4 v10, s[8:11], s36 offen offset:2048 sc1 lds
  buffer_load_dwordx4 v11, s[8:11], s36 offen offset:3072 sc1 lds
  s_add_u32 m0, s38, s46
  s_nop 0
  buffer_load_dwordx4 v13, s[12:15], s37 offen offset:0  lds
  buffer_load_dwordx4 v14, s[12:15], s37 offen offset:1024  lds
  s_add_u32 m0, s38, s47
  s_nop 0
  buffer_load_dwordx4 v15, s[12:15], s37 offen offset:0  lds
  buffer_load_dwordx4 v16, s[12:15], s37 offen offset:1024  lds
  s_add_u32 m0, s38, s48
  s_nop 0
  buffer_load_dwordx4 v17, s[12:15], s37 offen offset:0  lds
  buffer_load_dwordx4 v18, s[12:15], s37 offen offset:1024  lds
  s_add_u32 s38, s38, 43008
  s_cmp_eq_u32 s38, 129024
  s_cselect_b32 s38, 0, s38
  s_mov_b32 s16, s84
  s_mov_b32 s17, s85
  s_mov_b32 s18, 67108864
  s_mov_b32 s19, 0x20000
  s_add_u32 s20, s84, 22020096
  s_addc_u32 s21, s85, 0
  s_mov_b32 s22, 16384
  s_mov_b32 s23, 0x20000
  s_mov_b32 s82, s84
  s_mov_b32 s83, s85
  s_add_u32 s30, s30, 1
  s_and_b32 s30, s30, 7
  s_cselect_b32 s32, 0, 1
  s_add_u32 s31, s31, s32
  s_sub_u32 s32, s30, s7
  s_and_b32 s32, s32, 7
  s_cmp_lt_u32 s32, 2
  s_cselect_b32 s32, 1, 0
  s_add_u32 s32, s32, s31
  s_cmp_ge_u32 s32, 2
  s_cselect_b32 s32, 0, s32
  s_lshl_b32 s33, s32, 3
  s_add_u32 s33, s33, s30
  s_mul_i32 s36, s33, 128
  s_add_u32 s36, s36, s34
  s_mul_i32 s37, s33, 393216
  s_add_u32 s37, s37, s35
  s_add_u32 m0, s38, s45
  s_mov_b64 exec, s[52:53]
  buffer_load_dwordx4 v12, s[8:11], s36 offen offset:0 sc1 lds
  s_mov_b64 exec, -1
  s_add_u32 m0, s38, s44
  s_nop 0
  buffer_load_dwordx4 v8, s[8:11], s36 offen offset:0 sc1 lds
  buffer_load_dwordx4 v9, s[8:11], s36 offen offset:1024 sc1 lds
  buffer_load_dwordx4 v10, s[8:11], s36 offen offset:2048 sc1 lds
  buffer_load_dwordx4 v11, s[8:11], s36 offen offset:3072 sc1 lds
  s_add_u32 m0, s38, s46
  s_nop 0
  buffer_load_dwordx4 v13, s[12:15], s37 offen offset:0  lds
  buffer_load_dwordx4 v14, s[12:15], s37 offen offset:1024  lds
  s_add_u32 m0, s38, s47
  s_nop 0
  buffer_load_dwordx4 v15, s[12:15], s37 offen offset:0  lds
  buffer_load_dwordx4 v16, s[12:15], s37 offen offset:1024  lds
  s_add_u32 m0, s38, s48
  s_nop 0
  buffer_load_dwordx4 v17, s[12:15], s37 offen offset:0  lds
  buffer_load_dwordx4 v18, s[12:15], s37 offen offset:1024  lds
  s_add_u32 s38, s38, 43008
  s_cmp_eq_u32 s38, 129024
  s_cselect_b32 s38, 0, s38
  buffer_load_dwordx4 v[48:51], v46, s[8:11], 0 offen offset:0
  buffer_load_dwordx4 v[52:55], v46, s[8:11], 0 offen offset:512
  buffer_load_dwordx4 v[56:59], v46, s[8:11], 0 offen offset:1024
  buffer_load_dwordx4 v[60:63], v46, s[8:11], 0 offen offset:1536
  buffer_store_dwordx4 v[64:67], v47, s[16:19], s58 offen sc0 sc1
  s_barrier
  s_waitcnt vmcnt(16)
  s_barrier
  s_add_u32 s30, s30, 1
  s_and_b32 s30, s30, 7
  s_cselect_b32 s32, 0, 1
  s_add_u32 s31, s31, s32
  s_sub_u32 s32, s30, s7
  s_and_b32 s32, s32, 7
  s_cmp_lt_u32 s32, 2
  s_cselect_b32 s32, 1, 0
  s_add_u32 s32, s32, s31
  s_cmp_ge_u32 s32, 2
  s_cselect_b32 s32, 0, s32
  s_lshl_b32 s33, s32, 3
  s_add_u32 s33, s33, s30
  s_mul_i32 s36, s33, 128
  s_add_u32 s36, s36, s34
  s_mul_i32 s37, s33, 393216
  s_add_u32 s37, s37, s35
  s_add_u32 m0, s38, s45
  s_mov_b64 exec, s[52:53]
  buffer_load_dwordx4 v12, s[8:11], s36 offen offset:0 sc1 lds
  s_mov_b64 exec, -1
  s_add_u32 m0, s38, s44
  s_nop 0
  buffer_load_dwordx4 v8, s[8:11], s36 offen offset:0 sc1 lds
  buffer_load_dwordx4 v9, s[8:11], s36 offen offset:1024 sc1 lds
  buffer_load_dwordx4 v10, s[8:11], s36 offen offset:2048 sc1 lds
  buffer_load_dwordx4 v11, s[8:11], s36 offen offset:3072 sc1 lds
  s_add_u32 m0, s38, s46
  s_nop 0
  buffer_load_dwordx4 v13, s[12:15], s37 offen offset:0  lds
  buffer_load_dwordx4 v14, s[12:15], s37 offen offset:1024  lds
  s_add_u32 m0, s38, s47
  s_nop 0
  buffer_load_dwordx4 v15, s[12:15], s37 offen offset:0  lds
  buffer_load_dwordx4 v16, s[12:15], s37 offen offset:1024  lds
  s_add_u32 m0, s38, s48
  s_nop 0
  buffer_load_dwordx4 v17, s[12:15], s37 offen offset:0  lds
  buffer_load_dwordx4 v18, s[12:15], s37 offen offset:1024  lds
  s_add_u32 s38, s38, 43008
  s_cmp_eq_u32 s38, 129024
  s_cselect_b32 s38, 0, s38
  v_mov_b32 v68, 0
  v_mov_b32 v69, 0
  v_mov_b32 v70, 0x3f803f80
  s_waitcnt vmcnt(12)
  v_dot2c_f32_bf16 v68, v70, v48
  v_dot2c_f32_bf16 v69, v48, v48
  v_dot2c_f32_bf16 v68, v70, v49
  v_dot2c_f32_bf16 v69, v49, v49
  v_dot2c_f32_bf16 v68, v70, v50
  v_dot2c_f32_bf16 v69, v50, v50
  v_dot2c_f32_bf16 v68, v70, v51
  v_dot2c_f32_bf16 v69, v51, v51
  v_dot2c_f32_bf16 v68, v70, v52
  v_dot2c_f32_bf16 v69, v52, v52
  v_dot2c_f32_bf16 v68, v70, v53
  v_dot2c_f32_bf16 v69, v53, v53
  v_dot2c_f32_bf16 v68, v70, v54
  v_dot2c_f32_bf16 v69, v54, v54
  v_dot2c_f32_bf16 v68, v70, v55
  v_dot2c_f32_bf16 v69, v55, v55
  v_dot2c_f32_bf16 v68, v70, v56
  v_dot2c_f32_bf16 v69, v56, v56
  v_dot2c_f32_bf16 v68, v70, v57
  v_dot2c_f32_bf16 v69, v57, v57
  v_dot2c_f32_bf16 v68, v70, v58
  v_dot2c_f32_bf16 v69, v58, v58
  v_dot2c_f32_bf16 v68, v70, v59
  v_dot2c_f32_bf16 v69, v59, v59
  v_dot2c_f32_bf16 v68, v70, v60
  v_dot2c_f32_bf16 v69, v60, v60
  v_dot2c_f32_bf16 v68, v70, v61
  v_dot2c_f32_bf16 v69, v61, v61
  v_dot2c_f32_bf16 v68, v70, v62
  v_dot2c_f32_bf16 v69, v62, v62
  v_dot2c_f32_bf16 v68, v70, v63
  v_dot2c_f32_bf16 v69, v63, v63
  s_nop 1
  v_add_f32_dpp v68, v68, v68 quad_perm:[1,0,3,2] row_mask:0xf bank_mask:0xf
  v_add_f32_dpp v69, v69, v69 quad_perm:[1,0,3,2] row_mask:0xf bank_mask:0xf
  s_nop 0
  v_add_f32_dpp v68, v68, v68 quad_perm:[2,3,0,1] row_mask:0xf bank_mask:0xf
  v_add_f32_dpp v69, v69, v69 quad_perm:[2,3,0,1] row_mask:0xf bank_mask:0xf
  s_nop 0
  v_add_f32_dpp v68, v68, v68 row_half_mirror row_mask:0xf bank_mask:0xf
  v_add_f32_dpp v69, v69, v69 row_half_mirror row_mask:0xf bank_mask:0xf
  s_nop 0
  v_add_f32_dpp v68, v68, v68 row_mirror row_mask:0xf bank_mask:0xf
  v_add_f32_dpp v69, v69, v69 row_mirror row_mask:0xf bank_mask:0xf
  v_mov_b32 v70, v68
  v_mov_b32 v71, v69
  s_nop 0
  v_permlane16_swap_b32 v68, v70
  v_permlane16_swap_b32 v69, v71
  v_add_f32 v68, v68, v70
  v_add_f32 v69, v69, v71
  s_mov_b32 exec_lo, 1
  s_mov_b32 exec_hi, 1
  buffer_store_dwordx2 v[68:69], v72, s[16:19], 0 offen sc0 sc1
  s_mov_b64 exec, -1
  s_branch L_jA
L_firstB:
  s_nop 7
  s_nop 7
  s_add_u32 s30, s30, 1
  s_and_b32 s30, s30, 7
  s_cselect_b32 s32, 0, 1
  s_add_u32 s31, s31, s32
  s_sub_u32 s32, s30, s7
  s_and_b32 s32, s32, 7
  s_cmp_lt_u32 s32, 2
  s_cselect_b32 s32, 1, 0
  s_add_u32 s32, s32, s31
  s_cmp_ge_u32 s32, 2
  s_cselect_b32 s32, 0, s32
  s_lshl_b32 s33, s32, 3
  s_add_u32 s33, s33, s30
  s_mul_i32 s36, s33, 128
  s_add_u32 s36, s36, s34
  s_mul_i32 s37, s33, 393216
  s_add_u32 s37, s37, s35
  s_add_u32 m0, s38, s44
  s_nop 0
  buffer_load_dwordx4 v8, s[8:11], s36 offen offset:0 sc1 lds
  buffer_load_dwordx4 v9, s[8:11], s36 offen offset:1024 sc1 lds
  buffer_load_dwordx4 v10, s[8:11], s36 offen offset:2048 sc1 lds
  buffer_load_dwordx4 v11, s[8:11], s36 offen offset:3072 sc1 lds
  s_add_u32 m0, s38, s46
  s_nop 0
  buffer_load_dwordx4 v13, s[12:15], s37 offen offset:0  lds
  buffer_load_dwordx4 v14, s[12:15], s37 offen offset:1024  lds
  s_add_u32 m0, s38, s47
  s_nop 0
  buffer_load_dwordx4 v15, s[12:15], s37 offen offset:0  lds
  buffer_load_dwordx4 v16, s[12:15], s37 offen offset:1024  lds
  s_add_u32 m0, s38, s48
  s_nop 0
  buffer_load_dwordx4 v17, s[12:15], s37 offen offset:0  lds
  buffer_load_dwordx4 v18, s[12:15], s37 offen offset:1024  lds
  s_add_u32 s38, s38, 43008
  s_cmp_eq_u32 s38, 129024
  s_cselect_b32 s38, 0, s38
  s_mov_b32 s16, s84
  s_mov_b32 s17, s85
  s_mov_b32 s18, 67108864
  s_mov_b32 s19, 0x20000
  s_add_u32 s20, s84, 22020096
  s_addc_u32 s21, s85, 0
  s_mov_b32 s22, 16384
  s_mov_b32 s23, 0x20000
  s_mov_b32 s82, s84
  s_mov_b32 s83, s85
  s_add_u32 s30, s30, 1
  s_and_b32 s30, s30, 7
  s_cselect_b32 s32, 0, 1
  s_add_u32 s31, s31, s32
  s_sub_u32 s32, s30, s7
  s_and_b32 s32, s32, 7
  s_cmp_lt_u32 s32, 2
  s_cselect_b32 s32, 1, 0
  s_add_u32 s32, s32, s31
  s_cmp_ge_u32 s32, 2
  s_cselect_b32 s32, 0, s32
  s_lshl_b32 s33, s32, 3
  s_add_u32 s33, s33, s30
  s_mul_i32 s36, s33, 128
  s_add_u32 s36, s36, s34
  s_mul_i32 s37, s33, 393216
  s_add_u32 s37, s37, s35
  s_add_u32 m0, s38, s44
  s_nop 0
  buffer_load_dwordx4 v8, s[8:11], s36 offen offset:0 sc1 lds
  buffer_load_dwordx4 v9, s[8:11], s36 offen offset:1024 sc1 lds
  buffer_load_dwordx4 v10, s[8:11], s36 offen offset:2048 sc1 lds
  buffer_load_dwordx4 v11, s[8:11], s36 offen offset:3072 sc1 lds
  s_add_u32 m0, s38, s46
  s_nop 0
  buffer_load_dwordx4 v13, s[12:15], s37 offen offset:0  lds
  buffer_load_dwordx4 v14, s[12:15], s37 offen offset:1024  lds
  s_add_u32 m0, s38, s47
  s_nop 0
  buffer_load_dwordx4 v15, s[12:15], s37 offen offset:0  lds
  buffer_load_dwordx4 v16, s[12:15], s37 offen offset:1024  lds
  s_add_u32 m0, s38, s48
  s_nop 0
  buffer_load_dwordx4 v17, s[12:15], s37 offen offset:0  lds
  buffer_load_dwordx4 v18, s[12:15], s37 offen offset:1024  lds
  s_add_u32 s38, s38, 43008
  s_cmp_eq_u32 s38, 129024
  s_cselect_b32 s38, 0, s38
  buffer_load_dwordx4 v[48:51], v46, s[8:11], 0 offen offset:0
  buffer_load_dwordx4 v[52:55], v46, s[8:11], 0 offen offset:512
  buffer_load_dwordx4 v[56:59], v46, s[8:11], 0 offen offset:1024
  buffer_load_dwordx4 v[60:63], v46, s[8:11], 0 offen offset:1536
  buffer_store_dwordx4 v[64:67], v47, s[16:19], s58 offen sc0 sc1
  s_barrier
  s_waitcnt vmcnt(15)
  s_barrier
  s_add_u32 s30, s30, 1
  s_and_b32 s30, s30, 7
  s_cselect_b32 s32, 0, 1
  s_add_u32 s31, s31, s32
  s_sub_u32 s32, s30, s7
  s_and_b32 s32, s32, 7
  s_cmp_lt_u32 s32, 2
  s_cselect_b32 s32, 1, 0
  s_add_u32 s32, s32, s31
  s_cmp_ge_u32 s32, 2
  s_cselect_b32 s32, 0, s32
  s_lshl_b32 s33, s32, 3
  s_add_u32 s33, s33, s30
  s_mul_i32 s36, s33, 128
  s_add_u32 s36, s36, s34
  s_mul_i32 s37, s33, 393216
  s_add_u32 s37, s37, s35
  s_add_u32 m0, s38, s44
  s_nop 0
  buffer_load_dwordx4 v8, s[8:11], s36 offen offset:0 sc1 lds
  buffer_load_dwordx4 v9, s[8:11], s36 offen offset:1024 sc1 lds
  buffer_load_dwordx4 v10, s[8:11], s36 offen offset:2048 sc1 lds
  buffer_load_dwordx4 v11, s[8:11], s36 offen offset:3072 sc1 lds
  s_add_u32 m0, s38, s46
  s_nop 0
  buffer_load_dwordx4 v13, s[12:15], s37 offen offset:0  lds
  buffer_load_dwordx4 v14, s[12:15], s37 offen offset:1024  lds
  s_add_u32 m0, s38, s47
  s_nop 0
  buffer_load_dwordx4 v15, s[12:15], s37 offen offset:0  lds
  buffer_load_dwordx4 v16, s[12:15], s37 offen offset:1024  lds
  s_add_u32 m0, s38, s48
  s_nop 0
  buffer_load_dwordx4 v17, s[12:15], s37 offen offset:0  lds
  buffer_load_dwordx4 v18, s[12:15], s37 offen offset:1024  lds
  s_add_u32 s38, s38, 43008
  s_cmp_eq_u32 s38, 129024
  s_cselect_b32 s38, 0, s38
  v_mov_b32 v68, 0
  v_mov_b32 v69, 0
  v_mov_b32 v70, 0x3f803f80
  s_waitcnt vmcnt(11)
  v_dot2c_f32_bf16 v68, v70, v48
  v_dot2c_f32_bf16 v69, v48, v48
  v_dot2c_f32_bf16 v68, v70, v49
  v_dot2c_f32_bf16 v69, v49, v49
  v_dot2c_f32_bf16 v68, v70, v50
  v_dot2c_f32_bf16 v69, v50, v50
  v_dot2c_f32_bf16 v68, v70, v51
  v_dot2c_f32_bf16 v69, v51, v51
  v_dot2c_f32_bf16 v68, v70, v52
  v_dot2c_f32_bf16 v69, v52, v52
  v_dot2c_f32_bf16 v68, v70, v53
  v_dot2c_f32_bf16 v69, v53, v53
  v_dot2c_f32_bf16 v68, v70, v54
  v_dot2c_f32_bf16 v69, v54, v54
  v_dot2c_f32_bf16 v68, v70, v55
  v_dot2c_f32_bf16 v69, v55, v55
  v_dot2c_f32_bf16 v68, v70, v56
  v_dot2c_f32_bf16 v69, v56, v56
  v_dot2c_f32_bf16 v68, v70, v57
  v_dot2c_f32_bf16 v69, v57, v57
  v_dot2c_f32_bf16 v68, v70, v58
  v_dot2c_f32_bf16 v69, v58, v58
  v_dot2c_f32_bf16 v68, v70, v59
  v_dot2c_f32_bf16 v69, v59, v59
  v_dot2c_f32_bf16 v68, v70, v60
  v_dot2c_f32_bf16 v69, v60, v60
  v_dot2c_f32_bf16 v68, v70, v61
  v_dot2c_f32_bf16 v69, v61, v61
  v_dot2c_f32_bf16 v68, v70, v62
  v_dot2c_f32_bf16 v69, v62, v62
  v_dot2c_f32_bf16 v68, v70, v63
  v_dot2c_f32_bf16 v69, v63, v63
  s_nop 1
  v_add_f32_dpp v68, v68, v68 quad_perm:[1,0,3,2] row_mask:0xf bank_mask:0xf
  v_add_f32_dpp v69, v69, v69 quad_perm:[1,0,3,2] row_mask:0xf bank_mask:0xf
  s_nop 0
  v_add_f32_dpp v68, v68, v68 quad_perm:[2,3,0,1] row_mask:0xf bank_mask:0xf
  v_add_f32_dpp v69, v69, v69 quad_perm:[2,3,0,1] row_mask:0xf bank_mask:0xf
  s_nop 0
  v_add_f32_dpp v68, v68, v68 row_half_mirror row_mask:0xf bank_mask:0xf
  v_add_f32_dpp v69, v69, v69 row_half_mirror row_mask:0xf bank_mask:0xf
  s_nop 0
  v_add_f32_dpp v68, v68, v68 row_mirror row_mask:0xf bank_mask:0xf
  v_add_f32_dpp v69, v69, v69 row_mirror row_mask:0xf bank_mask:0xf
  v_mov_b32 v70, v68
  v_mov_b32 v71, v69
  s_nop 0
  v_permlane16_swap_b32 v68, v70
  v_permlane16_swap_b32 v69, v71
  v_add_f32 v68, v68, v70
  v_add_f32 v69, v69, v71
  s_mov_b32 exec_lo, 1
  s_mov_b32 exec_hi, 1
  buffer_store_dwordx2 v[68:69], v72, s[16:19], 0 offen sc0 sc1
  s_mov_b64 exec, -1
  s_branch L_jB
L_k1t:
  s_nop 7
  s_nop 7
  s_waitcnt vmcnt(0)
  v_pk_add_f32 v[30:31], v[30:31], v[32:33]
  v_pk_add_f32 v[34:35], v[34:35], v[36:37]
  v_pk_add_f32 v[38:39], v[38:39], v[40:41]
  v_pk_add_f32 v[42:43], v[42:43], v[44:45]
  v_pk_add_f32 v[30:31], v[30:31], v[34:35]
  v_pk_add_f32 v[38:39], v[38:39], v[42:43]
  v_pk_add_f32 v[30:31], v[30:31], v[38:39]
  v_mul_f32 v30, 0x3a800000, v30
  v_mul_f32 v31, 0x3a800000, v31
  v_fma_f32 v31, -v30, v30, v31
  v_max_f32 v31, 0, v31
  v_mov_b32 v32, v31
  v_cvt_pk_bf16_f32 v32, v32, v32
  v_lshlrev_b32 v32, 16, v32
  v_add_f32 v32, 0x3727c5ac, v32
  v_cvt_pk_bf16_f32 v32, v32, v32
  v_lshlrev_b32 v32, 16, v32
  v_sqrt_f32 v32, v32
  s_nop 0
  v_cvt_pk_bf16_f32 v32, v32, v32
  v_lshlrev_b32 v32, 16, v32
  v_rcp_f32 v32, v32
  v_cvt_pk_bf16_f32 v30, v30, v30
  v_lshlrev_b32 v30, 16, v30
  v_mov_b32 v31, v32
  ds_write_b64 v26, v[30:31]
  s_waitcnt lgkmcnt(0)
  s_mov_b32 s41, s57
  s_mul_i32 s32, s41, 16
  s_add_u32 s32, s32, 0
  v_lshrrev_b32 v2, 3, v0
  v_add_u32 v2, s32, v2
  v_bfe_u32 v3, v2, 1, 1
  v_bfe_u32 v4, v2, 3, 1
  v_lshl_or_b32 v3, v4, 1, v3
  v_lshlrev_b32 v3, 1, v3
  v_and_b32 v4, 7, v0
  v_xor_b32 v3, v3, v4
  v_lshlrev_b32 v3, 4, v3
  s_mov_b32 s32, 2048
  v_mul_lo_u32 v2, v2, s32
  v_add_u32 v130, v2, v3
  s_mul_i32 s32, s41, 16
  s_add_u32 s32, s32, 8
  v_lshrrev_b32 v2, 3, v0
  v_add_u32 v2, s32, v2
  v_bfe_u32 v3, v2, 1, 1
  v_bfe_u32 v4, v2, 3, 1
  v_lshl_or_b32 v3, v4, 1, v3
  v_lshlrev_b32 v3, 1, v3
  v_and_b32 v4, 7, v0
  v_xor_b32 v3, v3, v4
  v_lshlrev_b32 v3, 4, v3
  s_mov_b32 s32, 2048
  v_mul_lo_u32 v2, v2, s32
  v_add_u32 v131, v2, v3
  v_subrev_u32 v131, 1024, v131
  s_mov_b32 s12, s68
  s_mov_b32 s13, s69
  s_mov_b32 s14, 2097152
  s_mov_b32 s15, 0x20000
  s_mov_b32 s30, 7
  s_mov_b32 s31, -1
  s_lshl_b32 s52, s57, 11
  s_add_u32 s30, s30, 1
  s_and_b32 s30, s30, 7
  s_cselect_b32 s32, 0, 1
  s_add_u32 s31, s31, s32
  s_sub_u32 s32, s30, s7
  s_and_b32 s32, s32, 7
  s_cmp_lt_u32 s32, 2
  s_cselect_b32 s32, 1, 0
  s_add_u32 s32, s32, s31
  s_cmp_ge_u32 s32, 2
  s_cselect_b32 s32, 0, s32
  s_lshl_b32 s33, s32, 3
  s_add_u32 s33, s33, s30
  s_lshl_b32 s37, s33, 17
  s_add_u32 s37, s37, s35
  s_add_u32 m0, s52, 131072
  s_nop 0
  buffer_load_dwordx4 v130, s[12:15], s37 offen lds
  buffer_load_dwordx4 v131, s[12:15], s37 offen offset:1024 lds
  s_add_u32 s30, s30, 1
  s_and_b32 s30, s30, 7
  s_cselect_b32 s32, 0, 1
  s_add_u32 s31, s31, s32
  s_sub_u32 s32, s30, s7
  s_and_b32 s32, s32, 7
  s_cmp_lt_u32 s32, 2
  s_cselect_b32 s32, 1, 0
  s_add_u32 s32, s32, s31
  s_cmp_ge_u32 s32, 2
  s_cselect_b32 s32, 0, s32
  s_lshl_b32 s33, s32, 3
  s_add_u32 s33, s33, s30
  s_lshl_b32 s37, s33, 17
  s_add_u32 s37, s37, s35
  s_add_u32 m0, s52, 139264
  s_nop 0
  buffer_load_dwordx4 v130, s[12:15], s37 offen lds
  buffer_load_dwordx4 v131, s[12:15], s37 offen offset:1024 lds
  s_add_u32 s30, s30, 1
  s_and_b32 s30, s30, 7
  s_cselect_b32 s32, 0, 1
  s_add_u32 s31, s31, s32
  s_sub_u32 s32, s30, s7
  s_and_b32 s32, s32, 7
  s_cmp_lt_u32 s32, 2
  s_cselect_b32 s32, 1, 0
  s_add_u32 s32, s32, s31
  s_cmp_ge_u32 s32, 2
  s_cselect_b32 s32, 0, s32
  s_lshl_b32 s33, s32, 3
  s_add_u32 s33, s33, s30
  s_lshl_b32 s37, s33, 17
  s_add_u32 s37, s37, s35
  s_add_u32 m0, s52, 147456
  s_nop 0
  buffer_load_dwordx4 v130, s[12:15], s37 offen lds
  buffer_load_dwordx4 v131, s[12:15], s37 offen offset:1024 lds
  s_add_u32 s30, s30, 1
  s_and_b32 s30, s30, 7
  s_cselect_b32 s32, 0, 1
  s_add_u32 s31, s31, s32
  s_sub_u32 s32, s30, s7
  s_and_b32 s32, s32, 7
  s_cmp_lt_u32 s32, 2
  s_cselect_b32 s32, 1, 0
  s_add_u32 s32, s32, s31
  s_cmp_ge_u32 s32, 2
  s_cselect_b32 s32, 0, s32
  s_lshl_b32 s33, s32, 3
  s_add_u32 s33, s33, s30
  s_lshl_b32 s37, s33, 17
  s_add_u32 s37, s37, s35
  s_add_u32 m0, s52, 155648
  s_nop 0
  buffer_load_dwordx4 v130, s[12:15], s37 offen lds
  buffer_load_dwordx4 v131, s[12:15], s37 offen offset:1024 lds
  s_waitcnt vmcnt(8)
  s_barrier
  s_add_u32 s30, s30, 1
  s_and_b32 s30, s30, 7
  s_cselect_b32 s32, 0, 1
  s_add_u32 s31, s31, s32
  s_sub_u32 s32, s30, s7
  s_and_b32 s32, s32, 7
  s_cmp_lt_u32 s32, 2
  s_cselect_b32 s32, 1, 0
  s_add_u32 s32, s32, s31
  s_cmp_ge_u32 s32, 2
  s_cselect_b32 s32, 0, s32
  s_lshl_b32 s33, s32, 3
  s_add_u32 s33, s33, s30
  s_lshl_b32 s37, s33, 17
  s_add_u32 s37, s37, s35
  s_add_u32 m0, s52, 100608
  s_nop 0
  buffer_load_dwordx4 v130, s[12:15], s37 offen lds
  buffer_load_dwordx4 v131, s[12:15], s37 offen offset:1024 lds
  s_add_u32 s30, s30, 1
  s_and_b32 s30, s30, 7
  s_cselect_b32 s32, 0, 1
  s_add_u32 s31, s31, s32
  s_sub_u32 s32, s30, s7
  s_and_b32 s32, s32, 7
  s_cmp_lt_u32 s32, 2
  s_cselect_b32 s32, 1, 0
  s_add_u32 s32, s32, s31
  s_cmp_ge_u32 s32, 2
  s_cselect_b32 s32, 0, s32
  s_lshl_b32 s33, s32, 3
  s_add_u32 s33, s33, s30
  s_lshl_b32 s37, s33, 17
  s_add_u32 s37, s37, s35
  s_add_u32 m0, s52, 108800
  s_nop 0
  buffer_load_dwordx4 v130, s[12:15], s37 offen lds
  buffer_load_dwordx4 v131, s[12:15], s37 offen offset:1024 lds
  s_add_u32 s30, s30, 1
  s_and_b32 s30, s30, 7
  s_cselect_b32 s32, 0, 1
  s_add_u32 s31, s31, s32
  s_sub_u32 s32, s30, s7
  s_and_b32 s32, s32, 7
  s_cmp_lt_u32 s32, 2
  s_cselect_b32 s32, 1, 0
  s_add_u32 s32, s32, s31
  s_cmp_ge_u32 s32, 2
  s_cselect_b32 s32, 0, s32
  s_lshl_b32 s33, s32, 3
  s_add_u32 s33, s33, s30
  s_lshl_b32 s37, s33, 17
  s_add_u32 s37, s37, s35
  s_add_u32 m0, s52, 116992
  s_nop 0
  buffer_load_dwordx4 v130, s[12:15], s37 offen lds
  buffer_load_dwordx4 v131, s[12:15], s37 offen offset:1024 lds
  v_and_b32 v4, 15, v0
  v_lshrrev_b32 v5, 4, v0
  v_lshrrev_b32 v6, 2, v4
  v_and_b32 v7, 3, v0
  v_lshrrev_b32 v3, 5, v0
  v_and_b32 v2, 1, v5
  v_lshl_or_b32 v3, v2, 1, v3
  s_waitcnt lgkmcnt(0)
  s_barrier
  s_add_u32 s30, s30, 1
  s_and_b32 s30, s30, 7
  s_cselect_b32 s32, 0, 1
  s_add_u32 s31, s31, s32
  s_sub_u32 s32, s30, s7
  s_and_b32 s32, s32, 7
  s_cmp_lt_u32 s32, 2
  s_cselect_b32 s32, 1, 0
  s_add_u32 s32, s32, s31
  s_cmp_ge_u32 s32, 2
  s_cselect_b32 s32, 0, s32
  s_lshl_b32 s33, s32, 3
  s_add_u32 s33, s33, s30
  s_lshl_b32 s37, s33, 17
  s_add_u32 s37, s37, s35
  s_add_u32 m0, s52, 0
  s_nop 0
  buffer_load_dwordx4 v130, s[12:15], s37 offen lds
  buffer_load_dwordx4 v131, s[12:15], s37 offen offset:1024 lds
  s_add_u32 s30, s30, 1
  s_and_b32 s30, s30, 7
  s_cselect_b32 s32, 0, 1
  s_add_u32 s31, s31, s32
  s_sub_u32 s32, s30, s7
  s_and_b32 s32, s32, 7
  s_cmp_lt_u32 s32, 2
  s_cselect_b32 s32, 1, 0
  s_add_u32 s32, s32, s31
  s_cmp_ge_u32 s32, 2
  s_cselect_b32 s32, 0, s32
  s_lshl_b32 s33, s32, 3
  s_add_u32 s33, s33, s30
  s_lshl_b32 s37, s33, 17
  s_add_u32 s37, s37, s35
  s_add_u32 m0, s52, 8192
  s_nop 0
  buffer_load_dwordx4 v130, s[12:15], s37 offen lds
  buffer_load_dwordx4 v131, s[12:15], s37 offen offset:1024 lds
  s_add_u32 s30, s30, 1
  s_and_b32 s30, s30, 7
  s_cselect_b32 s32, 0, 1
  s_add_u32 s31, s31, s32
  s_sub_u32 s32, s30, s7
  s_and_b32 s32, s32, 7
  s_cmp_lt_u32 s32, 2
  s_cselect_b32 s32, 1, 0
  s_add_u32 s32, s32, s31
  s_cmp_ge_u32 s32, 2
  s_cselect_b32 s32, 0, s32
  s_lshl_b32 s33, s32, 3
  s_add_u32 s33, s33, s30
  s_lshl_b32 s37, s33, 17
  s_add_u32 s37, s37, s35
  s_add_u32 m0, s52, 16384
  s_nop 0
  buffer_load_dwordx4 v130, s[12:15], s37 offen lds
  buffer_load_dwordx4 v131, s[12:15], s37 offen offset:1024 lds
  s_add_u32 s30, s30, 1
  s_and_b32 s30, s30, 7
  s_cselect_b32 s32, 0, 1
  s_add_u32 s31, s31, s32
  s_sub_u32 s32, s30, s7
  s_and_b32 s32, s32, 7
  s_cmp_lt_u32 s32, 2
  s_cselect_b32 s32, 1, 0
  s_add_u32 s32, s32, s31
  s_cmp_ge_u32 s32, 2
  s_cselect_b32 s32, 0, s32
  s_lshl_b32 s33, s32, 3
  s_add_u32 s33, s33, s30
  s_lshl_b32 s37, s33, 17
  s_add_u32 s37, s37, s35
  s_add_u32 m0, s52, 24576
  s_nop 0
  buffer_load_dwordx4 v130, s[12:15], s37 offen lds
  buffer_load_dwordx4 v131, s[12:15], s37 offen offset:1024 lds
  s_add_u32 s30, s30, 1
  s_and_b32 s30, s30, 7
  s_cselect_b32 s32, 0, 1
  s_add_u32 s31, s31, s32
  s_sub_u32 s32, s30, s7
  s_and_b32 s32, s32, 7
  s_cmp_lt_u32 s32, 2
  s_cselect_b32 s32, 1, 0
  s_add_u32 s32, s32, s31
  s_cmp_ge_u32 s32, 2
  s_cselect_b32 s32, 0, s32
  s_lshl_b32 s33, s32, 3
  s_add_u32 s33, s33, s30
  s_lshl_b32 s37, s33, 17
  s_add_u32 s37, s37, s35
  s_add_u32 m0, s52, 32768
  s_nop 0
  buffer_load_dwordx4 v130, s[12:15], s37 offen lds
  buffer_load_dwordx4 v131, s[12:15], s37 offen offset:1024 lds
  s_branch attn
L_k1done:
  s_nop 7
  s_nop 7
  s_add_u32 s24, s84, 29360128
  s_addc_u32 s25, s85, 0
  s_mov_b32 s26, 262144
  s_mov_b32 s27, 0x20000
  v_mov_b32 v136, 0
  v_mov_b32 v137, 1
  s_cmp_eq_u32 s57, 0
  s_cselect_b32 s26, s26, 0
  s_waitcnt vmcnt(0)
  s_barrier
  s_mov_b64 exec, 1
  buffer_store_dword v137, v136, s[24:27], s56 offen sc0 sc1
  s_mov_b64 exec, -1
  s_add_u32 s30, s30, 1
  s_and_b32 s30, s30, 7
  s_cselect_b32 s32, 0, 1
  s_add_u32 s31, s31, s32
  s_sub_u32 s32, s30, s7
  s_and_b32 s32, s32, 7
  s_cmp_lt_u32 s32, 2
  s_cselect_b32 s32, 1, 0
  s_add_u32 s32, s32, s31
  s_cmp_ge_u32 s32, 2
  s_cselect_b32 s32, 0, s32
  s_lshl_b32 s33, s32, 3
  s_add_u32 s33, s33, s30
  s_lshl_b32 s37, s33, 17
  s_add_u32 s37, s37, s35
  s_add_u32 m0, s52, 43008
  s_nop 0
  buffer_load_dwordx4 v130, s[12:15], s37 offen lds
  buffer_load_dwordx4 v131, s[12:15], s37 offen offset:1024 lds
  s_add_u32 s30, s30, 1
  s_and_b32 s30, s30, 7
  s_cselect_b32 s32, 0, 1
  s_add_u32 s31, s31, s32
  s_sub_u32 s32, s30, s7
  s_and_b32 s32, s32, 7
  s_cmp_lt_u32 s32, 2
  s_cselect_b32 s32, 1, 0
  s_add_u32 s32, s32, s31
  s_cmp_ge_u32 s32, 2
  s_cselect_b32 s32, 0, s32
  s_lshl_b32 s33, s32, 3
  s_add_u32 s33, s33, s30
  s_lshl_b32 s37, s33, 17
  s_add_u32 s37, s37, s35
  s_add_u32 m0, s52, 51200
  s_nop 0
  buffer_load_dwordx4 v130, s[12:15], s37 offen lds
  buffer_load_dwordx4 v131, s[12:15], s37 offen offset:1024 lds
  s_add_u32 s30, s30, 1
  s_and_b32 s30, s30, 7
  s_cselect_b32 s32, 0, 1
  s_add_u32 s31, s31, s32
  s_sub_u32 s32, s30, s7
  s_and_b32 s32, s32, 7
  s_cmp_lt_u32 s32, 2
  s_cselect_b32 s32, 1, 0
  s_add_u32 s32, s32, s31
  s_cmp_ge_u32 s32, 2
  s_cselect_b32 s32, 0, s32
  s_lshl_b32 s33, s32, 3
  s_add_u32 s33, s33, s30
  s_lshl_b32 s37, s33, 17
  s_add_u32 s37, s37, s35
  s_add_u32 m0, s52, 59392
  s_nop 0
  buffer_load_dwordx4 v130, s[12:15], s37 offen lds
  buffer_load_dwordx4 v131, s[12:15], s37 offen offset:1024 lds
  s_add_u32 s30, s30, 1
  s_and_b32 s30, s30, 7
  s_cselect_b32 s32, 0, 1
  s_add_u32 s31, s31, s32
  s_sub_u32 s32, s30, s7
  s_and_b32 s32, s32, 7
  s_cmp_lt_u32 s32, 2
  s_cselect_b32 s32, 1, 0
  s_add_u32 s32, s32, s31
  s_cmp_ge_u32 s32, 2
  s_cselect_b32 s32, 0, s32
  s_lshl_b32 s33, s32, 3
  s_add_u32 s33, s33, s30
  s_lshl_b32 s37, s33, 17
  s_add_u32 s37, s37, s35
  s_add_u32 m0, s52, 67584
  s_nop 0
  buffer_load_dwordx4 v130, s[12:15], s37 offen lds
  buffer_load_dwordx4 v131, s[12:15], s37 offen offset:1024 lds
  s_lshl_b32 s56, s3, 10
  s_mul_i32 s32, s29, 16
  s_add_u32 s56, s56, s32
  s_add_u32 s56, s56, s28
  s_add_u32 s56, s56, 256
  s_lshl_b32 s56, s56, 7
  s_barrier
  s_waitcnt vmcnt(0)
  s_barrier
  s_cmp_ge_u32 s2, 224
  s_cbranch_scc1 L_k3skip
  s_lshr_b32 s32, s2, 3
  s_mul_i32 s5, s32, 9363
  s_lshr_b32 s5, s5, 16
  s_mul_i32 s6, s5, 7
  s_sub_u32 s6, s32, s6
  s_lshl_b32 s7, s5, 1
  s_add_u32 s7, s7, s6
  s_and_b32 s7, s7, 7
  s_and_b32 s32, s2, 7
  s_lshr_b32 s28, s32, 2
  s_lshl_b32 s28, s28, 2
  s_add_u32 s28, s28, s5
  s_and_b32 s29, s32, 3
  s_mul_i32 s29, s29, 7
  s_add_u32 s29, s29, s6
  s_mov_b32 s30, 7
  s_mov_b32 s31, -1
  s_lshl_b32 s44, s57, 12
  s_add_u32 s45, s44, 16384
  v_lshlrev_b32 v8, 4, v0
  v_add_u32 v13, 63488, v8
  v_lshrrev_b32 v2, 4, v0
  v_lshlrev_b32 v3, 1, v2
  v_and_b32 v4, 15, v0
  v_xor_b32 v3, v3, v4
  v_lshlrev_b32 v3, 4, v3
  s_lshl_b32 s32, s57, 4
  v_add_u32 v2, s32, v2
  s_mov_b32 s32, 7168
  v_mul_lo_u32 v2, v2, s32
  v_add_u32 v9, v2, v3
  v_xor_b32 v3, 128, v3
  v_add_u32 v11, v2, v3
  v_add_u32 v10, 27648, v9
  v_add_u32 v12, 82944, v11
  v_add_u32 v11, 55296, v11
  s_lshl_b32 s34, s28, 2
  s_add_u32 s34, s34, s57
  s_lshl_b32 s34, s34, 17
  s_lshl_b32 s35, s29, 8
  s_add_u32 s8, s82, 8388608
  s_addc_u32 s9, s83, 0
  s_mov_b32 s10, 4194304
  s_mov_b32 s11, 0x20000
  s_mov_b32 s12, s72
  s_mov_b32 s13, s73
  s_mov_b32 s14, 14680064
  s_mov_b32 s15, 0x20000
  s_add_u32 s16, s84, 29360128
  s_addc_u32 s17, s85, 0
  s_mov_b32 s18, 262144
  s_mov_b32 s19, 0x20000
  s_lshl_b32 s32, s28, 5
  v_min_u32 v14, 31, v0
  v_add_u32 v14, s32, v14
  v_max_i32 v14, 0, v14
  v_lshlrev_b32 v14, 7, v14
  s_lshl_b32 s55, s3, 17
  s_add_u32 s55, s55, 32768
  s_lshr_b32 s32, s2, 3
  s_add_u32 s32, s32, 0
  s_lshl_b32 s32, s32, 2
  s_add_u32 s32, s32, s57
  s_lshl_b32 s32, s32, 6
  v_add_u32 v2, s32, v0
  v_mul_u32_u24 v3, 74899, v2
  v_lshrrev_b32 v3, 20, v3
  v_mul_u32_u24 v4, 14, v3
  v_sub_u32 v4, v2, v4
  v_add_u32 v3, 192, v3
  v_mul_u32_u24 v3, 7168, v3
  v_lshl_add_u32 v3, v4, 7, v3
  s_and_b32 s32, s2, 3
  s_mul_i32 s32, s32, 1792
  s_lshl_b32 s40, s3, 30
  s_add_u32 s32, s32, s40
  v_add_u32 v16, s32, v3
  s_barrier
  s_barrier
  s_mov_b64 exec, 1
  buffer_store_dword v137, v136, s[24:27], s56 offen sc0 sc1
  s_mov_b64 exec, -1
  s_mov_b32 s30, 7
  s_mov_b32 s31, -1
  s_mov_b32 s38, 0
  s_add_u32 s30, s30, 1
  s_and_b32 s30, s30, 7
  s_cselect_b32 s32, 0, 1
  s_add_u32 s31, s31, s32
  s_sub_u32 s32, s30, s7
  s_and_b32 s32, s32, 7
  s_cmp_lt_u32 s32, 2
  s_cselect_b32 s32, 1, 0
  s_add_u32 s32, s32, s31
  s_cmp_ge_u32 s32, 4
  s_cselect_b32 s32, 0, s32
  s_lshl_b32 s33, s32, 3
  s_add_u32 s33, s33, s30
  s_mul_i32 s37, s33, 458752
  s_add_u32 s37, s37, s35
  s_add_u32 m0, s38, s45
  s_nop 0
  buffer_load_dwordx4 v9, s[12:15], s37 offen offset:0  lds
  buffer_load_dwordx4 v10, s[12:15], s37 offen offset:1024  lds
  buffer_load_dwordx4 v11, s[12:15], s37 offen offset:2048  lds
  buffer_load_dwordx4 v12, s[12:15], s37 offen offset:3072  lds
  s_add_u32 s38, s38, 32768
  s_cmp_eq_u32 s38, 163840
  s_cselect_b32 s38, 0, s38
  s_add_u32 s30, s30, 1
  s_and_b32 s30, s30, 7
  s_cselect_b32 s32, 0, 1
  s_add_u32 s31, s31, s32
  s_sub_u32 s32, s30, s7
  s_and_b32 s32, s32, 7
  s_cmp_lt_u32 s32, 2
  s_cselect_b32 s32, 1, 0
  s_add_u32 s32, s32, s31
  s_cmp_ge_u32 s32, 4
  s_cselect_b32 s32, 0, s32
  s_lshl_b32 s33, s32, 3
  s_add_u32 s33, s33, s30
  s_mul_i32 s37, s33, 458752
  s_add_u32 s37, s37, s35
  s_add_u32 m0, s38, s45
  s_nop 0
  buffer_load_dwordx4 v9, s[12:15], s37 offen offset:0  lds
  buffer_load_dwordx4 v10, s[12:15], s37 offen offset:1024  lds
  buffer_load_dwordx4 v11, s[12:15], s37 offen offset:2048  lds
  buffer_load_dwordx4 v12, s[12:15], s37 offen offset:3072  lds
  s_add_u32 s38, s38, 32768
  s_cmp_eq_u32 s38, 163840
  s_cselect_b32 s38, 0, s38
  s_add_u32 s30, s30, 1
  s_and_b32 s30, s30, 7
  s_cselect_b32 s32, 0, 1
  s_add_u32 s31, s31, s32
  s_sub_u32 s32, s30, s7
  s_and_b32 s32, s32, 7
  s_cmp_lt_u32 s32, 2
  s_cselect_b32 s32, 1, 0
  s_add_u32 s32, s32, s31
  s_cmp_ge_u32 s32, 4
  s_cselect_b32 s32, 0, s32
  s_lshl_b32 s33, s32, 3
  s_add_u32 s33, s33, s30
  s_mul_i32 s37, s33, 458752
  s_add_u32 s37, s37, s35
  s_add_u32 m0, s38, s45
  s_nop 0
  buffer_load_dwordx4 v9, s[12:15], s37 offen offset:0  lds
  buffer_load_dwordx4 v10, s[12:15], s37 offen offset:1024  lds
  buffer_load_dwordx4 v11, s[12:15], s37 offen offset:2048  lds
  buffer_load_dwordx4 v12, s[12:15], s37 offen offset:3072  lds
  s_add_u32 s38, s38, 32768
  s_cmp_eq_u32 s38, 163840
  s_cselect_b32 s38, 0, s38
  buffer_load_dword v223, v16, s[12:15], 0 offen
  s_lshl_b32 s56, s3, 10
  s_mul_i32 s32, s28, 32
  s_add_u32 s56, s56, s32
  s_add_u32 s56, s56, s29
  s_add_u32 s56, s56, 512
  s_lshl_b32 s56, s56, 7
  s_mov_b32 s39, 0
  s_and_b32 s32, s4, 3
  s_cmp_lg_u32 s32, 0
  s_cbranch_scc1 poll14d
  s_sleep 8
poll14:
  buffer_load_dword v15, v14, s[16:19], s55 offen sc0 sc1
  s_waitcnt vmcnt(0)
  v_cmp_eq_u32 vcc, 0, v15
  s_add_u32 s39, s39, 1
  s_cmp_gt_u32 s39, 100000
  s_cbranch_scc1 poll14d
  s_cbranch_vccnz poll14
poll14d:
  s_barrier
  s_mov_b32 s30, 7
  s_mov_b32 s31, -1
  s_mov_b32 s38, 0
  s_add_u32 s30, s30, 1
  s_and_b32 s30, s30, 7
  s_cselect_b32 s32, 0, 1
  s_add_u32 s31, s31, s32
  s_sub_u32 s32, s30, s7
  s_and_b32 s32, s32, 7
  s_cmp_lt_u32 s32, 2
  s_cselect_b32 s32, 1, 0
  s_add_u32 s32, s32, s31
  s_cmp_ge_u32 s32, 4
  s_cselect_b32 s32, 0, s32
  s_lshl_b32 s33, s32, 3
  s_add_u32 s33, s33, s30
  s_mul_i32 s36, s33, 2048
  s_add_u32 s36, s36, s34
  s_add_u32 m0, s38, s44
  s_nop 0
  buffer_load_dwordx4 v8, s[8:11], s36 offen offset:0 sc1 lds
  buffer_load_dwordx4 v8, s[8:11], s36 offen offset:1024 sc1 lds
  buffer_load_dwordx4 v13, s[8:11], s36 offen offset:2048 sc1 lds
  buffer_load_dwordx4 v13, s[8:11], s36 offen offset:3072 sc1 lds
  s_add_u32 s38, s38, 32768
  s_cmp_eq_u32 s38, 163840
  s_cselect_b32 s38, 0, s38
  s_add_u32 s30, s30, 1
  s_and_b32 s30, s30, 7
  s_cselect_b32 s32, 0, 1
  s_add_u32 s31, s31, s32
  s_sub_u32 s32, s30, s7
  s_and_b32 s32, s32, 7
  s_cmp_lt_u32 s32, 2
  s_cselect_b32 s32, 1, 0
  s_add_u32 s32, s32, s31
  s_cmp_ge_u32 s32, 4
  s_cselect_b32 s32, 0, s32
  s_lshl_b32 s33, s32, 3
  s_add_u32 s33, s33, s30
  s_mul_i32 s36, s33, 2048
  s_add_u32 s36, s36, s34
  s_add_u32 m0, s38, s44
  s_nop 0
  buffer_load_dwordx4 v8, s[8:11], s36 offen offset:0 sc1 lds
  buffer_load_dwordx4 v8, s[8:11], s36 offen offset:1024 sc1 lds
  buffer_load_dwordx4 v13, s[8:11], s36 offen offset:2048 sc1 lds
  buffer_load_dwordx4 v13, s[8:11], s36 offen offset:3072 sc1 lds
  s_add_u32 s38, s38, 32768
  s_cmp_eq_u32 s38, 163840
  s_cselect_b32 s38, 0, s38
  s_add_u32 s30, s30, 1
  s_and_b32 s30, s30, 7
  s_cselect_b32 s32, 0, 1
  s_add_u32 s31, s31, s32
  s_sub_u32 s32, s30, s7
  s_and_b32 s32, s32, 7
  s_cmp_lt_u32 s32, 2
  s_cselect_b32 s32, 1, 0
  s_add_u32 s32, s32, s31
  s_cmp_ge_u32 s32, 4
  s_cselect_b32 s32, 0, s32
  s_lshl_b32 s33, s32, 3
  s_add_u32 s33, s33, s30
  s_mul_i32 s36, s33, 2048
  s_add_u32 s36, s36, s34
  s_add_u32 m0, s38, s44
  s_nop 0
  buffer_load_dwordx4 v8, s[8:11], s36 offen offset:0 sc1 lds
  buffer_load_dwordx4 v8, s[8:11], s36 offen offset:1024 sc1 lds
  buffer_load_dwordx4 v13, s[8:11], s36 offen offset:2048 sc1 lds
  buffer_load_dwordx4 v13, s[8:11], s36 offen offset:3072 sc1 lds
  s_add_u32 s38, s38, 32768
  s_cmp_eq_u32 s38, 163840
  s_cselect_b32 s38, 0, s38
  s_waitcnt vmcnt(8)
  s_barrier
  s_add_u32 s30, s30, 1
  s_and_b32 s30, s30, 7
  s_cselect_b32 s32, 0, 1
  s_add_u32 s31, s31, s32
  s_sub_u32 s32, s30, s7
  s_and_b32 s32, s32, 7
  s_cmp_lt_u32 s32, 2
  s_cselect_b32 s32, 1, 0
  s_add_u32 s32, s32, s31
  s_cmp_ge_u32 s32, 4
  s_cselect_b32 s32, 0, s32
  s_lshl_b32 s33, s32, 3
  s_add_u32 s33, s33, s30
  s_mul_i32 s36, s33, 2048
  s_add_u32 s36, s36, s34
  s_mul_i32 s37, s33, 458752
  s_add_u32 s37, s37, s35
  s_add_u32 m0, s38, s44
  s_nop 0
  buffer_load_dwordx4 v8, s[8:11], s36 offen offset:0 sc1 lds
  buffer_load_dwordx4 v8, s[8:11], s36 offen offset:1024 sc1 lds
  buffer_load_dwordx4 v13, s[8:11], s36 offen offset:2048 sc1 lds
  buffer_load_dwordx4 v13, s[8:11], s36 offen offset:3072 sc1 lds
  s_add_u32 m0, s38, s45
  s_nop 0
  buffer_load_dwordx4 v9, s[12:15], s37 offen offset:0  lds
  buffer_load_dwordx4 v10, s[12:15], s37 offen offset:1024  lds
  buffer_load_dwordx4 v11, s[12:15], s37 offen offset:2048  lds
  buffer_load_dwordx4 v12, s[12:15], s37 offen offset:3072  lds
  s_add_u32 s38, s38, 32768
  s_cmp_eq_u32 s38, 163840
  s_cselect_b32 s38, 0, s38
  s_waitcnt vmcnt(12)
  s_barrier
  s_add_u32 s30, s30, 1
  s_and_b32 s30, s30, 7
  s_cselect_b32 s32, 0, 1
  s_add_u32 s31, s31, s32
  s_sub_u32 s32, s30, s7
  s_and_b32 s32, s32, 7
  s_cmp_lt_u32 s32, 2
  s_cselect_b32 s32, 1, 0
  s_add_u32 s32, s32, s31
  s_cmp_ge_u32 s32, 4
  s_cselect_b32 s32, 0, s32
  s_lshl_b32 s33, s32, 3
  s_add_u32 s33, s33, s30
  s_mul_i32 s36, s33, 2048
  s_add_u32 s36, s36, s34
  s_mul_i32 s37, s33, 458752
  s_add_u32 s37, s37, s35
  s_add_u32 m0, s38, s44
  s_nop 0
  buffer_load_dwordx4 v8, s[8:11], s36 offen offset:0 sc1 lds
  buffer_load_dwordx4 v8, s[8:11], s36 offen offset:1024 sc1 lds
  buffer_load_dwordx4 v13, s[8:11], s36 offen offset:2048 sc1 lds
  buffer_load_dwordx4 v13, s[8:11], s36 offen offset:3072 sc1 lds
  s_add_u32 m0, s38, s45
  s_nop 0
  buffer_load_dwordx4 v9, s[12:15], s37 offen offset:0  lds
  buffer_load_dwordx4 v10, s[12:15], s37 offen offset:1024  lds
  buffer_load_dwordx4 v11, s[12:15], s37 offen offset:2048  lds
  buffer_load_dwordx4 v12, s[12:15], s37 offen offset:3072  lds
  s_add_u32 s38, s38, 32768
  s_cmp_eq_u32 s38, 163840
  s_cselect_b32 s38, 0, s38
  s_mov_b32 s39, 27
ll15:
  s_waitcnt vmcnt(16)
  s_barrier
  s_add_u32 s30, s30, 1
  s_and_b32 s30, s30, 7
  s_cselect_b32 s32, 0, 1
  s_add_u32 s31, s31, s32
  s_sub_u32 s32, s30, s7
  s_and_b32 s32, s32, 7
  s_cmp_lt_u32 s32, 2
  s_cselect_b32 s32, 1, 0
  s_add_u32 s32, s32, s31
  s_cmp_ge_u32 s32, 4
  s_cselect_b32 s32, 0, s32
  s_lshl_b32 s33, s32, 3
  s_add_u32 s33, s33, s30
  s_mul_i32 s36, s33, 2048
  s_add_u32 s36, s36, s34
  s_mul_i32 s37, s33, 458752
  s_add_u32 s37, s37, s35
  s_add_u32 m0, s38, s44
  s_nop 0
  buffer_load_dwordx4 v8, s[8:11], s36 offen offset:0 sc1 lds
  buffer_load_dwordx4 v8, s[8:11], s36 offen offset:1024 sc1 lds
  buffer_load_dwordx4 v13, s[8:11], s36 offen offset:2048 sc1 lds
  buffer_load_dwordx4 v13, s[8:11], s36 offen offset:3072 sc1 lds
  s_add_u32 m0, s38, s45
  s_nop 0
  buffer_load_dwordx4 v9, s[12:15], s37 offen offset:0  lds
  buffer_load_dwordx4 v10, s[12:15], s37 offen offset:1024  lds
  buffer_load_dwordx4 v11, s[12:15], s37 offen offset:2048  lds
  buffer_load_dwordx4 v12, s[12:15], s37 offen offset:3072  lds
  s_add_u32 s38, s38, 32768
  s_cmp_eq_u32 s38, 163840
  s_cselect_b32 s38, 0, s38
  s_sub_u32 s39, s39, 1
  s_cmp_lg_u32 s39, 0
  s_cbranch_scc1 ll15
  s_waitcnt vmcnt(16)
  s_barrier
  s_waitcnt vmcnt(8)
  s_barrier
  s_waitcnt vmcnt(0)
  s_barrier
  s_lshr_b32 s32, s2, 3
  s_lshr_b32 s5, s32, 3
  s_and_b32 s6, s32, 7
  s_lshl_b32 s7, s5, 1
  s_add_u32 s7, s7, s6
  s_and_b32 s7, s7, 7
  s_and_b32 s32, s2, 7
  s_lshr_b32 s28, s32, 2
  s_lshl_b32 s28, s28, 2
  s_add_u32 s28, s28, s5
  s_and_b32 s29, s32, 3
  s_mul_i32 s29, s29, 8
  s_add_u32 s29, s29, s6
  s_mov_b32 s30, 7
  s_mov_b32 s31, -1
  s_mov_b32 s41, s57
  s_lshl_b32 s45, s41, 11
  s_mul_i32 s32, s41, 16
  s_add_u32 s32, s32, 0
  v_lshrrev_b32 v2, 3, v0
  v_add_u32 v2, s32, v2
  v_bfe_u32 v3, v2, 1, 1
  v_bfe_u32 v4, v2, 3, 1
  v_lshl_or_b32 v3, v4, 1, v3
  v_lshlrev_b32 v3, 1, v3
  v_and_b32 v4, 7, v0
  v_xor_b32 v3, v3, v4
  v_lshlrev_b32 v3, 4, v3
  s_mov_b32 s32, 4096
  v_mul_lo_u32 v2, v2, s32
  v_add_u32 v9, v2, v3
  s_mul_i32 s32, s41, 16
  s_add_u32 s32, s32, 8
  v_lshrrev_b32 v2, 3, v0
  v_add_u32 v2, s32, v2
  v_bfe_u32 v3, v2, 1, 1
  v_bfe_u32 v4, v2, 3, 1
  v_lshl_or_b32 v3, v4, 1, v3
  v_lshlrev_b32 v3, 1, v3
  v_and_b32 v4, 7, v0
  v_xor_b32 v3, v3, v4
  v_lshlrev_b32 v3, 4, v3
  s_mov_b32 s32, 4096
  v_mul_lo_u32 v2, v2, s32
  v_add_u32 v10, v2, v3
  v_subrev_u32 v10, 1024, v10
  s_lshl_b32 s35, s29, 7
  s_mov_b32 s12, s76
  s_mov_b32 s13, s77
  s_mov_b32 s14, 14680064
  s_mov_b32 s15, 0x20000
  s_branch L_k4
L_k3skip:
  s_nop 7
  s_nop 7
  s_lshr_b32 s32, s2, 3
  s_lshr_b32 s5, s32, 3
  s_and_b32 s6, s32, 7
  s_lshl_b32 s7, s5, 1
  s_add_u32 s7, s7, s6
  s_and_b32 s7, s7, 7
  s_and_b32 s32, s2, 7
  s_lshr_b32 s28, s32, 2
  s_lshl_b32 s28, s28, 2
  s_add_u32 s28, s28, s5
  s_and_b32 s29, s32, 3
  s_mul_i32 s29, s29, 8
  s_add_u32 s29, s29, s6
  s_mov_b32 s30, 7
  s_mov_b32 s31, -1
  s_mov_b32 s41, s57
  s_lshl_b32 s45, s41, 11
  s_mul_i32 s32, s41, 16
  s_add_u32 s32, s32, 0
  v_lshrrev_b32 v2, 3, v0
  v_add_u32 v2, s32, v2
  v_bfe_u32 v3, v2, 1, 1
  v_bfe_u32 v4, v2, 3, 1
  v_lshl_or_b32 v3, v4, 1, v3
  v_lshlrev_b32 v3, 1, v3
  v_and_b32 v4, 7, v0
  v_xor_b32 v3, v3, v4
  v_lshlrev_b32 v3, 4, v3
  s_mov_b32 s32, 4096
  v_mul_lo_u32 v2, v2, s32
  v_add_u32 v9, v2, v3
  s_mul_i32 s32, s41, 16
  s_add_u32 s32, s32, 8
  v_lshrrev_b32 v2, 3, v0
  v_add_u32 v2, s32, v2
  v_bfe_u32 v3, v2, 1, 1
  v_bfe_u32 v4, v2, 3, 1
  v_lshl_or_b32 v3, v4, 1, v3
  v_lshlrev_b32 v3, 1, v3
  v_and_b32 v4, 7, v0
  v_xor_b32 v3, v3, v4
  v_lshlrev_b32 v3, 4, v3
  s_mov_b32 s32, 4096
  v_mul_lo_u32 v2, v2, s32
  v_add_u32 v10, v2, v3
  v_subrev_u32 v10, 1024, v10
  s_lshl_b32 s35, s29, 7
  s_mov_b32 s12, s76
  s_mov_b32 s13, s77
  s_mov_b32 s14, 14680064
  s_mov_b32 s15, 0x20000
  s_barrier
L_k4:
  s_nop 7
  s_nop 7
  s_mov_b32 s30, 7
  s_mov_b32 s31, -1
  s_mov_b32 s38, 98304
  s_add_u32 s30, s30, 1
  s_and_b32 s30, s30, 7
  s_cselect_b32 s32, 0, 1
  s_add_u32 s31, s31, s32
  s_sub_u32 s32, s30, s7
  s_and_b32 s32, s32, 7
  s_cmp_lt_u32 s32, 2
  s_cselect_b32 s32, 1, 0
  s_add_u32 s32, s32, s31
  s_cmp_ge_u32 s32, 7
  s_cselect_b32 s32, 0, s32
  s_lshl_b32 s33, s32, 3
  s_add_u32 s33, s33, s30
  s_mul_i32 s37, s33, 262144
  s_add_u32 s37, s37, s35
  s_add_u32 m0, s38, s45
  s_nop 0
  buffer_load_dwordx4 v9, s[12:15], s37 offen offset:0  lds
  buffer_load_dwordx4 v10, s[12:15], s37 offen offset:1024  lds
  s_add_u32 s38, s38, 8192
  s_cmp_eq_u32 s38, 163840
  s_cselect_b32 s38, 98304, s38
  s_add_u32 s30, s30, 1
  s_and_b32 s30, s30, 7
  s_cselect_b32 s32, 0, 1
  s_add_u32 s31, s31, s32
  s_sub_u32 s32, s30, s7
  s_and_b32 s32, s32, 7
  s_cmp_lt_u32 s32, 2
  s_cselect_b32 s32, 1, 0
  s_add_u32 s32, s32, s31
  s_cmp_ge_u32 s32, 7
  s_cselect_b32 s32, 0, s32
  s_lshl_b32 s33, s32, 3
  s_add_u32 s33, s33, s30
  s_mul_i32 s37, s33, 262144
  s_add_u32 s37, s37, s35
  s_add_u32 m0, s38, s45
  s_nop 0
  buffer_load_dwordx4 v9, s[12:15], s37 offen offset:0  lds
  buffer_load_dwordx4 v10, s[12:15], s37 offen offset:1024  lds
  s_add_u32 s38, s38, 8192
  s_cmp_eq_u32 s38, 163840
  s_cselect_b32 s38, 98304, s38
  s_add_u32 s30, s30, 1
  s_and_b32 s30, s30, 7
  s_cselect_b32 s32, 0, 1
  s_add_u32 s31, s31, s32
  s_sub_u32 s32, s30, s7
  s_and_b32 s32, s32, 7
  s_cmp_lt_u32 s32, 2
  s_cselect_b32 s32, 1, 0
  s_add_u32 s32, s32, s31
  s_cmp_ge_u32 s32, 7
  s_cselect_b32 s32, 0, s32
  s_lshl_b32 s33, s32, 3
  s_add_u32 s33, s33, s30
  s_mul_i32 s37, s33, 262144
  s_add_u32 s37, s37, s35
  s_add_u32 m0, s38, s45
  s_nop 0
  buffer_load_dwordx4 v9, s[12:15], s37 offen offset:0  lds
  buffer_load_dwordx4 v10, s[12:15], s37 offen offset:1024  lds
  s_add_u32 s38, s38, 8192
  s_cmp_eq_u32 s38, 163840
  s_cselect_b32 s38, 98304, s38
  s_add_u32 s30, s30, 1
  s_and_b32 s30, s30, 7
  s_cselect_b32 s32, 0, 1
  s_add_u32 s31, s31, s32
  s_sub_u32 s32, s30, s7
  s_and_b32 s32, s32, 7
  s_cmp_lt_u32 s32, 2
  s_cselect_b32 s32, 1, 0
  s_add_u32 s32, s32, s31
  s_cmp_ge_u32 s32, 7
  s_cselect_b32 s32, 0, s32
  s_lshl_b32 s33, s32, 3
  s_add_u32 s33, s33, s30
  s_mul_i32 s37, s33, 262144
  s_add_u32 s37, s37, s35
  s_add_u32 m0, s38, s45
  s_nop 0
  buffer_load_dwordx4 v9, s[12:15], s37 offen offset:0  lds
  buffer_load_dwordx4 v10, s[12:15], s37 offen offset:1024  lds
  s_add_u32 s38, s38, 8192
  s_cmp_eq_u32 s38, 163840
  s_cselect_b32 s38, 98304, s38
  s_add_u32 s30, s30, 1
  s_and_b32 s30, s30, 7
  s_cselect_b32 s32, 0, 1
  s_add_u32 s31, s31, s32
  s_sub_u32 s32, s30, s7
  s_and_b32 s32, s32, 7
  s_cmp_lt_u32 s32, 2
  s_cselect_b32 s32, 1, 0
  s_add_u32 s32, s32, s31
  s_cmp_ge_u32 s32, 7
  s_cselect_b32 s32, 0, s32
  s_lshl_b32 s33, s32, 3
  s_add_u32 s33, s33, s30
  s_mul_i32 s37, s33, 262144
  s_add_u32 s37, s37, s35
  s_add_u32 m0, s38, s45
  s_nop 0
  buffer_load_dwordx4 v9, s[12:15], s37 offen offset:0  lds
  buffer_load_dwordx4 v10, s[12:15], s37 offen offset:1024  lds
  s_add_u32 s38, s38, 8192
  s_cmp_eq_u32 s38, 163840
  s_cselect_b32 s38, 98304, s38
  s_add_u32 s30, s30, 1
  s_and_b32 s30, s30, 7
  s_cselect_b32 s32, 0, 1
  s_add_u32 s31, s31, s32
  s_sub_u32 s32, s30, s7
  s_and_b32 s32, s32, 7
  s_cmp_lt_u32 s32, 2
  s_cselect_b32 s32, 1, 0
  s_add_u32 s32, s32, s31
  s_cmp_ge_u32 s32, 7
  s_cselect_b32 s32, 0, s32
  s_lshl_b32 s33, s32, 3
  s_add_u32 s33, s33, s30
  s_mul_i32 s37, s33, 262144
  s_add_u32 s37, s37, s35
  s_add_u32 m0, s38, s45
  s_nop 0
  buffer_load_dwordx4 v9, s[12:15], s37 offen offset:0  lds
  buffer_load_dwordx4 v10, s[12:15], s37 offen offset:1024  lds
  s_add_u32 s38, s38, 8192
  s_cmp_eq_u32 s38, 163840
  s_cselect_b32 s38, 98304, s38
  s_barrier
  s_mov_b64 exec, 1
  buffer_store_dword v137, v136, s[24:27], s56 offen sc0 sc1
  s_mov_b64 exec, -1
  s_lshl_b32 s56, s3, 10
  s_mul_i32 s32, s29, 8
  s_add_u32 s56, s56, s32
  s_add_u32 s56, s56, s28
  s_add_u32 s56, s56, 768
  s_lshl_b32 s56, s56, 7
  s_barrier
  s_mov_b32 s39, 50
ll16:
  s_waitcnt vmcnt(10)
  s_barrier
  s_add_u32 s30, s30, 1
  s_and_b32 s30, s30, 7
  s_cselect_b32 s32, 0, 1
  s_add_u32 s31, s31, s32
  s_sub_u32 s32, s30, s7
  s_and_b32 s32, s32, 7
  s_cmp_lt_u32 s32, 2
  s_cselect_b32 s32, 1, 0
  s_add_u32 s32, s32, s31
  s_cmp_ge_u32 s32, 7
  s_cselect_b32 s32, 0, s32
  s_lshl_b32 s33, s32, 3
  s_add_u32 s33, s33, s30
  s_mul_i32 s37, s33, 262144
  s_add_u32 s37, s37, s35
  s_add_u32 m0, s38, s45
  s_nop 0
  buffer_load_dwordx4 v9, s[12:15], s37 offen offset:0  lds
  buffer_load_dwordx4 v10, s[12:15], s37 offen offset:1024  lds
  s_add_u32 s38, s38, 8192
  s_cmp_eq_u32 s38, 163840
  s_cselect_b32 s38, 98304, s38
  s_sub_u32 s39, s39, 1
  s_cmp_lg_u32 s39, 0
  s_cbranch_scc1 ll16
  s_waitcnt vmcnt(10)
  s_barrier
  s_waitcnt vmcnt(8)
  s_barrier
  s_waitcnt vmcnt(6)
  s_barrier
  s_waitcnt vmcnt(4)
  s_barrier
  s_waitcnt vmcnt(2)
  s_barrier
  s_waitcnt vmcnt(0)
  s_barrier
  s_cmp_lg_u32 s3, 0
  s_cbranch_scc1 L_end
  s_lshr_b32 s32, s2, 3
  s_lshr_b32 s5, s32, 3
  s_and_b32 s6, s32, 7
  s_lshl_b32 s7, s5, 1
  s_add_u32 s7, s7, s6
  s_and_b32 s7, s7, 7
  s_and_b32 s32, s2, 7
  s_lshr_b32 s28, s32, 1
  s_lshl_b32 s28, s28, 2
  s_add_u32 s28, s28, s5
  s_and_b32 s29, s32, 1
  s_mul_i32 s29, s29, 8
  s_add_u32 s29, s29, s6
  s_mov_b32 s30, 7
  s_mov_b32 s31, -1
  s_mov_b32 s41, s57
  s_mul_i32 s32, s41, 16
  s_add_u32 s32, s32, 0
  v_lshrrev_b32 v2, 3, v0
  v_add_u32 v2, s32, v2
  v_bfe_u32 v3, v2, 1, 1
  v_bfe_u32 v4, v2, 3, 1
  v_lshl_or_b32 v3, v4, 1, v3
  v_lshlrev_b32 v3, 1, v3
  v_and_b32 v4, 7, v0
  v_xor_b32 v3, v3, v4
  v_lshlrev_b32 v3, 4, v3
  s_mov_b32 s32, 6144
  v_mul_lo_u32 v2, v2, s32
  v_add_u32 v13, v2, v3
  s_mul_i32 s32, s41, 16
  s_add_u32 s32, s32, 8
  v_lshrrev_b32 v2, 3, v0
  v_add_u32 v2, s32, v2
  v_bfe_u32 v3, v2, 1, 1
  v_bfe_u32 v4, v2, 3, 1
  v_lshl_or_b32 v3, v4, 1, v3
  v_lshlrev_b32 v3, 1, v3
  v_and_b32 v4, 7, v0
  v_xor_b32 v3, v3, v4
  v_lshlrev_b32 v3, 4, v3
  s_mov_b32 s32, 6144
  v_mul_lo_u32 v2, v2, s32
  v_add_u32 v14, v2, v3
  v_subrev_u32 v14, 1024, v14
  v_add_u32 v15, 2048, v13
  v_add_u32 v16, 2048, v14
  v_add_u32 v17, 4096, v13
  v_add_u32 v18, 4096, v14
  s_lshl_b32 s46, s41, 11
  s_add_u32 s46, s46, 18432
  s_add_u32 s47, s46, 8192
  s_add_u32 s48, s46, 16384
  s_lshl_b32 s35, s29, 7
  s_mov_b32 s12, s66
  s_mov_b32 s13, s67
  s_mov_b32 s14, 6291456
  s_mov_b32 s15, 0x20000
  s_mov_b32 s30, 7
  s_mov_b32 s31, -1
  s_mov_b32 s38, 0
  s_add_u32 s30, s30, 1
  s_and_b32 s30, s30, 7
  s_cselect_b32 s32, 0, 1
  s_add_u32 s31, s31, s32
  s_sub_u32 s32, s30, s7
  s_and_b32 s32, s32, 7
  s_cmp_lt_u32 s32, 2
  s_cselect_b32 s32, 1, 0
  s_add_u32 s32, s32, s31
  s_cmp_ge_u32 s32, 2
  s_cselect_b32 s32, 0, s32
  s_lshl_b32 s33, s32, 3
  s_add_u32 s33, s33, s30
  s_mul_i32 s37, s33, 393216
  s_add_u32 s37, s37, s35
  s_add_u32 m0, s38, s46
  s_nop 0
  buffer_load_dwordx4 v13, s[12:15], s37 offen offset:0  lds
  buffer_load_dwordx4 v14, s[12:15], s37 offen offset:1024  lds
  s_add_u32 m0, s38, s47
  s_nop 0
  buffer_load_dwordx4 v15, s[12:15], s37 offen offset:0  lds
  buffer_load_dwordx4 v16, s[12:15], s37 offen offset:1024  lds
  s_add_u32 m0, s38, s48
  s_nop 0
  buffer_load_dwordx4 v17, s[12:15], s37 offen offset:0  lds
  buffer_load_dwordx4 v18, s[12:15], s37 offen offset:1024  lds
  s_add_u32 s38, s38, 43008
  s_cmp_eq_u32 s38, 129024
  s_cselect_b32 s38, 0, s38
  s_add_u32 s30, s30, 1
  s_and_b32 s30, s30, 7
  s_cselect_b32 s32, 0, 1
  s_add_u32 s31, s31, s32
  s_sub_u32 s32, s30, s7
  s_and_b32 s32, s32, 7
  s_cmp_lt_u32 s32, 2
  s_cselect_b32 s32, 1, 0
  s_add_u32 s32, s32, s31
  s_cmp_ge_u32 s32, 2
  s_cselect_b32 s32, 0, s32
  s_lshl_b32 s33, s32, 3
  s_add_u32 s33, s33, s30
  s_mul_i32 s37, s33, 393216
  s_add_u32 s37, s37, s35
  s_add_u32 m0, s38, s46
  s_nop 0
  buffer_load_dwordx4 v13, s[12:15], s37 offen offset:0  lds
  buffer_load_dwordx4 v14, s[12:15], s37 offen offset:1024  lds
  s_add_u32 m0, s38, s47
  s_nop 0
  buffer_load_dwordx4 v15, s[12:15], s37 offen offset:0  lds
  buffer_load_dwordx4 v16, s[12:15], s37 offen offset:1024  lds
  s_add_u32 m0, s38, s48
  s_nop 0
  buffer_load_dwordx4 v17, s[12:15], s37 offen offset:0  lds
  buffer_load_dwordx4 v18, s[12:15], s37 offen offset:1024  lds
  s_add_u32 s38, s38, 43008
  s_cmp_eq_u32 s38, 129024
  s_cselect_b32 s38, 0, s38
  s_lshl_b32 s40, s28, 7
  s_sub_u32 s40, s40, 16
  s_lshl_b32 s32, s41, 5
  s_add_u32 s32, s32, 16
  v_lshrrev_b32 v2, 3, v0
  v_add_u32 v2, s32, v2
  v_bfe_u32 v3, v2, 1, 3
  v_and_b32 v4, 7, v0
  v_xor_b32 v3, v3, v4
  v_lshlrev_b32 v3, 4, v3
  v_add_u32 v2, s40, v2
  v_max_i32 v2, 0, v2
  v_lshlrev_b32 v2, 11, v2
  v_add_u32 v8, v2, v3
  v_add_u32 v10, 30720, v8
  s_lshl_b32 s32, s41, 5
  s_add_u32 s32, s32, 24
  v_lshrrev_b32 v2, 3, v0
  v_add_u32 v2, s32, v2
  v_bfe_u32 v3, v2, 1, 3
  v_and_b32 v4, 7, v0
  v_xor_b32 v3, v3, v4
  v_lshlrev_b32 v3, 4, v3
  v_add_u32 v2, s40, v2
  v_max_i32 v2, 0, v2
  v_lshlrev_b32 v2, 11, v2
  v_add_u32 v9, v2, v3
  v_subrev_u32 v9, 1024, v9
  v_add_u32 v11, 30720, v9
  s_lshl_b32 s32, s41, 3
  v_lshrrev_b32 v2, 3, v0
  v_add_u32 v2, s32, v2
  v_bfe_u32 v3, v2, 1, 3
  v_and_b32 v4, 7, v0
  v_xor_b32 v3, v3, v4
  v_lshlrev_b32 v3, 4, v3
  v_add_u32 v2, s40, v2
  v_max_i32 v2, 0, v2
  v_lshlrev_b32 v2, 11, v2
  v_add_u32 v12, v2, v3
  s_lshl_b32 s44, s41, 12
  s_add_u32 s44, s44, 2048
  s_lshl_b32 s45, s41, 10
  s_mov_b32 s34, 0
  s_cmp_eq_u32 s41, 0
  s_cselect_b32 s52, 0xffffff00, -1
  s_mov_b32 s53, -1
  v_mov_b32 v20, 0x3f803f80
  v_mov_b32 v21, v20
  v_mov_b32 v22, v20
  v_mov_b32 v23, v20
  v_lshlrev_b32 v24, 4, v0
  v_add_u32 v25, 86016, v24
  s_mov_b64 exec, 0xff
  ds_write_b128 v24, v[20:23]
  ds_write_b128 v24, v[20:23] offset:43008
  ds_write_b128 v25, v[20:23]
  s_mov_b64 exec, -1
  s_lshl_b32 s32, s41, 6
  v_add_u32 v26, s32, v0
  v_min_u32 v26, 143, v26
  v_add_u32 v27, s40, v26
  v_max_i32 v27, 0, v27
  v_lshlrev_b32 v27, 3, v27
  v_lshlrev_b32 v26, 3, v26
  v_add_u32 v26, 129024, v26
  s_add_u32 s8, s84, 25165824
  s_addc_u32 s9, s85, 0
  s_mov_b32 s10, 4194304
  s_mov_b32 s11, 0x20000
  s_add_u32 s20, s84, 55574528
  s_addc_u32 s21, s85, 0
  s_mov_b32 s22, 131072
  s_mov_b32 s23, 0x20000
  s_waitcnt lgkmcnt(0)
  s_add_u32 s16, s84, 29360128
  s_addc_u32 s17, s85, 0
  s_mov_b32 s18, 262144
  s_mov_b32 s19, 0x20000
  s_lshl_b32 s32, s28, 4
  s_sub_u32 s32, s32, 8
  v_min_u32 v28, 23, v0
  v_add_u32 v28, s32, v28
  v_max_i32 v28, 0, v28
  v_lshlrev_b32 v28, 7, v28
  s_lshl_b32 s55, s3, 17
  s_add_u32 s55, s55, 98304
  s_barrier
  s_barrier
  s_mov_b64 exec, 1
  buffer_store_dword v137, v136, s[24:27], s56 offen sc0 sc1
  s_mov_b64 exec, -1
  s_mov_b32 s39, 0
  s_and_b32 s32, s4, 3
  s_cmp_lg_u32 s32, 0
  s_cbranch_scc1 poll17d
  s_sleep 8
poll17:
  buffer_load_dword v29, v28, s[16:19], s55 offen sc0 sc1
  s_waitcnt vmcnt(0)
  v_cmp_eq_u32 vcc, 0, v29
  s_add_u32 s39, s39, 1
  s_cmp_gt_u32 s39, 100000
  s_cbranch_scc1 poll17d
  s_cbranch_vccnz poll17
poll17d:
  s_barrier
  s_mov_b32 s3, 1
  s_add_u32 s82, s84, 33554432
  s_addc_u32 s83, s85, 0
  s_branch L_top
L_end:
mega_end:
  s_endpgm
.section .rodata,"a"
.p2align 6
.amdhsa_kernel interleave_layers__sliding_local_dilated__mixer_token_mlp__prompt_kernel
  .amdhsa_next_free_vgpr 256
  .amdhsa_next_free_sgpr 102
  .amdhsa_accum_offset 256
  .amdhsa_group_segment_fixed_size 0
  .amdhsa_kernarg_size 88
  .amdhsa_user_sgpr_count 2
  .amdhsa_user_sgpr_kernarg_segment_ptr 1
  .amdhsa_system_sgpr_workgroup_id_x 1
.end_amdhsa_kernel
```

```asm
; @launch grid=(256,1,1) block=(512,1,1) lds=163840
.amdgcn_target "amdgcn-amd-amdhsa--gfx950"
.text
.globl interleave_layers__sliding_local_dilated__mixer_token_mlp__prompt_kernel
.type interleave_layers__sliding_local_dilated__mixer_token_mlp__prompt_kernel,@function
.p2align 8
interleave_layers__sliding_local_dilated__mixer_token_mlp__prompt_kernel:
  s_cmp_ge_u32 s2, 256
  s_cbranch_scc1 mega_end
  s_load_dwordx16 s[64:79], s[0:1], 0
  s_load_dwordx2 s[80:81], s[0:1], 64
  s_load_dwordx2 s[84:85], s[0:1], 80
  s_load_dwordx2 s[62:63], s[0:1], 72
  v_lshrrev_b32 v1, 6, v0
  v_and_b32 v0, 63, v0
  v_readfirstlane_b32 s4, v1
  s_mov_b32 s3, 0
  v_mov_b32 v130, 0
  v_mov_b32 v131, 0
  v_mov_b32 v134, 0
  s_cmp_ge_u32 s4, 4
  s_cbranch_scc1 L_start
  s_lshr_b32 s32, s2, 3
  s_lshr_b32 s5, s32, 3
  s_and_b32 s6, s32, 7
  s_lshl_b32 s7, s5, 1
  s_add_u32 s7, s7, s6
  s_and_b32 s7, s7, 7
  s_and_b32 s32, s2, 7
  s_lshr_b32 s28, s32, 1
  s_lshl_b32 s28, s28, 2
  s_add_u32 s28, s28, s5
  s_and_b32 s29, s32, 1
  s_mul_i32 s29, s29, 8
  s_add_u32 s29, s29, s6
  s_mov_b32 s30, 7
  s_mov_b32 s31, -1
  v_and_b32 v4, 15, v0
  v_lshrrev_b32 v5, 4, v0
  v_lshrrev_b32 v6, 2, v4
  v_and_b32 v7, 3, v0
  v_lshrrev_b32 v3, 5, v0
  v_and_b32 v2, 1, v5
  v_lshl_or_b32 v3, v2, 1, v3
  v_lshl_add_u32 v21, v5, 3, v6
  v_lshlrev_b32 v21, 7, v21
  v_lshl_add_u32 v21, v7, 3, v21
  v_lshrrev_b32 v22, 1, v6
  v_lshl_or_b32 v22, v2, 1, v22
  v_lshl_add_u32 v21, v22, 5, v21
  v_add_u32 v21, 18432, v21
  v_xor_b32 v8, 0, v21
  s_lshl_b32 s32, s4, 5
  v_xor_b32 v8, s32, v8
  v_lshrrev_b32 v21, 1, v4
  v_xor_b32 v21, v21, v5
  v_lshlrev_b32 v21, 4, v21
  v_lshlrev_b32 v22, 7, v4
  v_add_u32 v9, v21, v22
  v_xor_b32 v10, 64, v9
  v_and_b32 v21, 1, v4
  v_mul_u32_u24 v21, 28800, v21
  v_lshrrev_b32 v22, 1, v4
  v_mul_u32_u24 v22, 400, v22
  v_lshlrev_b32 v23, 3, v5
  v_add3_u32 v11, v21, v22, v23
  s_add_u32 s32, s32, 43008
  v_add_u32 v11, s32, v11
  v_lshlrev_b32 v12, 3, v4
  v_add_u32 v12, 129024, v12
  v_mov_b64 v[112:113], 0
  v_mov_b64 v[114:115], 0
  v_mov_b64 v[116:117], 0
  v_mov_b64 v[118:119], 0
  v_mov_b64 v[120:121], 0
  v_mov_b64 v[122:123], 0
  v_mov_b64 v[124:125], 0
  v_mov_b64 v[126:127], 0
  v_mov_b64 v[128:129], 0
  v_mov_b64 v[130:131], 0
  v_mov_b64 v[132:133], 0
  v_mov_b64 v[134:135], 0
  v_mov_b64 v[136:137], 0
  v_mov_b64 v[138:139], 0
  v_mov_b64 v[140:141], 0
  v_mov_b64 v[142:143], 0
  v_mov_b64 v[144:145], 0
  v_mov_b64 v[146:147], 0
  v_mov_b64 v[148:149], 0
  v_mov_b64 v[150:151], 0
  v_mov_b64 v[152:153], 0
  v_mov_b64 v[154:155], 0
  v_mov_b64 v[156:157], 0
  v_mov_b64 v[158:159], 0
  v_mov_b64 v[160:161], 0
  v_mov_b64 v[162:163], 0
  v_mov_b64 v[164:165], 0
  v_mov_b64 v[166:167], 0
  v_mov_b64 v[168:169], 0
  v_mov_b64 v[170:171], 0
  v_mov_b64 v[172:173], 0
  v_mov_b64 v[174:175], 0
  v_mov_b64 v[176:177], 0
  v_mov_b64 v[178:179], 0
  v_mov_b64 v[180:181], 0
  v_mov_b64 v[182:183], 0
  v_mov_b64 v[184:185], 0
  v_mov_b64 v[186:187], 0
  v_mov_b64 v[188:189], 0
  v_mov_b64 v[190:191], 0
  v_mov_b64 v[192:193], 0
  v_mov_b64 v[194:195], 0
  v_mov_b64 v[196:197], 0
  v_mov_b64 v[198:199], 0
  v_mov_b64 v[200:201], 0
  v_mov_b64 v[202:203], 0
  v_mov_b64 v[204:205], 0
  v_mov_b64 v[206:207], 0
  v_mov_b64 v[208:209], 0
  v_mov_b64 v[210:211], 0
  v_mov_b64 v[212:213], 0
  v_mov_b64 v[214:215], 0
  v_mov_b64 v[216:217], 0
  v_mov_b64 v[218:219], 0
  s_lshr_b32 s40, s4, 1
  s_and_b32 s41, s4, 1
  s_mul_i32 s32, s41, 28800
  s_add_u32 s32, s32, 43008
  s_lshl_b32 s49, s40, 4
  v_add_u32 v76, s49, v4
  v_lshlrev_b32 v77, 4, v5
  v_add_u32 v77, s32, v77
  v_mul_u32_u24 v78, 400, v76
  v_add_u32 v220, v78, v77
  v_add_u32 v223, 3200, v220
  v_add_u32 v220, 128, v220
  v_add_u32 v76, 16, v76
  v_min_u32 v76, 71, v76
  v_mul_u32_u24 v78, 400, v76
  v_add3_u32 v221, v78, v77, 64
  v_add_u32 v221, 64, v221
  v_lshl_add_u32 v76, v5, 2, v6
  v_add_u32 v76, s49, v76
  v_lshlrev_b32 v77, 4, v7
  v_add_u32 v77, s32, v77
  v_add_u32 v77, 256, v77
  v_mul_u32_u24 v78, 400, v76
  v_add_u32 v222, v78, v77
  v_add_u32 v76, 16, v76
  v_min_u32 v76, 71, v76
  v_mul_u32_u24 v78, 400, v76
  v_add_u32 v254, v78, v77
  s_lshl_b32 s50, s28, 2
  s_add_u32 s50, s50, s40
  s_lshl_b32 s50, s50, 16
  s_lshl_b32 s51, s29, 12
  s_add_u32 s50, s50, s51
  s_lshl_b32 s51, s41, 10
  s_add_u32 s50, s50, s51
  v_lshlrev_b32 v1, 4, v0
  v_add_u32 v1, s50, v1
  v_lshlrev_b32 v76, 2, v5
  v_sub_u32 v76, v76, v4
  s_or_b32 s51, s28, s40
  s_cmp_eq_u32 s51, 0
  s_cselect_b32 s51, 0, -1
  v_add_u32 v77, -1, v76
  v_cmp_gt_u32 s[86:87], 8, v77
  v_add_u32 v77, 0, v76
  v_cmp_gt_u32 s[88:89], 8, v77
  v_add_u32 v77, 1, v76
  v_cmp_gt_u32 s[90:91], 8, v77
  v_add_u32 v77, 2, v76
  v_cmp_gt_u32 s[92:93], 8, v77
  v_add_u32 v77, 15, v76
  v_cmp_gt_u32 s[94:95], 8, v77
  v_add_u32 v77, 16, v76
  v_cmp_gt_u32 s[96:97], 8, v77
  v_add_u32 v77, 17, v76
  v_cmp_gt_u32 s[98:99], 8, v77
  v_add_u32 v77, 18, v76
  v_cmp_gt_u32 s[100:101], 8, v77
  s_and_b32 s86, s86, s51
  s_and_b32 s88, s88, s51
  s_and_b32 s90, s90, s51
  s_and_b32 s92, s92, s51
  s_waitcnt lgkmcnt(0)
  s_mov_b32 s82, s84
  s_mov_b32 s83, s85
  s_mov_b32 s12, s84
  s_mov_b32 s13, s85
  s_mov_b32 s14, 0
  s_mov_b32 s15, 0x20000
  s_mov_b32 s20, s66
  s_mov_b32 s21, s67
  s_mov_b32 s22, 6291456
  s_mov_b32 s23, 0x20000
  s_cmp_eq_u32 s4, 3
  s_cselect_b32 s20, s68, s20
  s_cselect_b32 s21, s69, s21
  s_cselect_b32 s22, 2097152, s22
  s_cselect_b32 s47, 0, s4
  s_lshl_b32 s47, s47, 8
  s_add_u32 s47, s47, s2
  s_lshl_b32 s47, s47, 13
  v_lshlrev_b32 v13, 7, v0
  s_barrier
  s_mov_b32 s51, s4
  s_cmp_lg_u32 s51, 0
  s_cbranch_scc1 C_wm0
  buffer_load_dword v15, v13, s[20:23], s47 offen
C_wm0:
C_top:
  s_nop 7
  s_nop 7
  s_mov_b32 s43, 0
  s_mov_b32 s39, 12
  s_barrier
  ds_read_b64_tr_b16 v[16:17], v8 offset:0
  ds_read_b64_tr_b16 v[18:19], v8 offset:512
  ds_read_b128 v[28:31], v9 offset:0
  ds_read_b64_tr_b16 v[20:21], v8 offset:8192
  ds_read_b64_tr_b16 v[22:23], v8 offset:8704
  ds_read_b64_tr_b16 v[24:25], v8 offset:16384
  ds_read_b64_tr_b16 v[26:27], v8 offset:16896
  ds_read_b128 v[32:35], v9 offset:2048
  ds_read_b128 v[36:39], v9 offset:4096
  ds_read_b128 v[40:43], v9 offset:6144
  ds_read_b128 v[44:47], v9 offset:8192
  ds_read_b128 v[48:51], v9 offset:10240
  ds_read_b128 v[52:55], v9 offset:12288
  ds_read_b128 v[56:59], v9 offset:14336
  ds_read_b128 v[60:63], v9 offset:16384
  s_add_u32 s40, s43, 43008
  s_cmp_eq_u32 s40, 129024
  s_cselect_b32 s40, 0, s40
  s_sub_u32 s42, s40, s43
  s_mov_b32 s43, s40
  s_waitcnt lgkmcnt(12)
  v_mfma_f32_16x16x32_bf16 v[112:115], v[16:19], v[28:31], v[112:115]
  ds_read_b64_tr_b16 v[64:65], v8 offset:4096
  s_waitcnt lgkmcnt(11)
  v_mfma_f32_16x16x32_bf16 v[148:151], v[20:23], v[28:31], v[148:151]
  ds_read_b64_tr_b16 v[66:67], v8 offset:4608
  s_waitcnt lgkmcnt(10)
  v_mfma_f32_16x16x32_bf16 v[184:187], v[24:27], v[28:31], v[184:187]
  ds_read_b128 v[76:79], v10 offset:0
  s_waitcnt lgkmcnt(10)
  v_mfma_f32_16x16x32_bf16 v[188:191], v[24:27], v[32:35], v[188:191]
  ds_read_b64_tr_b16 v[68:69], v8 offset:12288
  v_mfma_f32_16x16x32_bf16 v[152:155], v[20:23], v[32:35], v[152:155]
  ds_read_b64_tr_b16 v[70:71], v8 offset:12800
  v_mfma_f32_16x16x32_bf16 v[116:119], v[16:19], v[32:35], v[116:119]
  ds_read_b64_tr_b16 v[72:73], v8 offset:20480
  s_waitcnt lgkmcnt(12)
  v_mfma_f32_16x16x32_bf16 v[120:123], v[16:19], v[36:39], v[120:123]
  ds_read_b64_tr_b16 v[74:75], v8 offset:20992
  v_add_u32 v8, s42, v8
  v_mfma_f32_16x16x32_bf16 v[156:159], v[20:23], v[36:39], v[156:159]
  ds_read_b128 v[80:83], v10 offset:2048
  v_mfma_f32_16x16x32_bf16 v[192:195], v[24:27], v[36:39], v[192:195]
  ds_read_b128 v[84:87], v10 offset:4096
  s_waitcnt lgkmcnt(14)
  v_mfma_f32_16x16x32_bf16 v[196:199], v[24:27], v[40:43], v[196:199]
  ds_read_b128 v[88:91], v10 offset:6144
  v_mfma_f32_16x16x32_bf16 v[160:163], v[20:23], v[40:43], v[160:163]
  ds_read_b128 v[92:95], v10 offset:8192
  v_mfma_f32_16x16x32_bf16 v[124:127], v[16:19], v[40:43], v[124:127]
  ds_read_b128 v[96:99], v10 offset:10240
  s_waitcnt lgkmcnt(15)
  v_mfma_f32_16x16x32_bf16 v[128:131], v[16:19], v[44:47], v[128:131]
  ds_read_b128 v[100:103], v10 offset:12288
  v_mfma_f32_16x16x32_bf16 v[164:167], v[20:23], v[44:47], v[164:167]
  ds_read_b128 v[104:107], v10 offset:14336
  v_mfma_f32_16x16x32_bf16 v[200:203], v[24:27], v[44:47], v[200:203]
  ds_read_b128 v[108:111], v10 offset:16384
  v_add_u32 v9, s42, v9
  v_add_u32 v10, s42, v10
  s_waitcnt lgkmcnt(15)
  v_mfma_f32_16x16x32_bf16 v[204:207], v[24:27], v[48:51], v[204:207]
  v_mfma_f32_16x16x32_bf16 v[168:171], v[20:23], v[48:51], v[168:171]
  v_mfma_f32_16x16x32_bf16 v[132:135], v[16:19], v[48:51], v[132:135]
  s_waitcnt lgkmcnt(15)
  v_mfma_f32_16x16x32_bf16 v[136:139], v[16:19], v[52:55], v[136:139]
  v_mfma_f32_16x16x32_bf16 v[172:175], v[20:23], v[52:55], v[172:175]
  v_mfma_f32_16x16x32_bf16 v[208:211], v[24:27], v[52:55], v[208:211]
  s_waitcnt lgkmcnt(15)
  v_mfma_f32_16x16x32_bf16 v[212:215], v[24:27], v[56:59], v[212:215]
  v_mfma_f32_16x16x32_bf16 v[176:179], v[20:23], v[56:59], v[176:179]
  v_mfma_f32_16x16x32_bf16 v[140:143], v[16:19], v[56:59], v[140:143]
  s_waitcnt lgkmcnt(15)
  v_mfma_f32_16x16x32_bf16 v[144:147], v[16:19], v[60:63], v[144:147]
  v_mfma_f32_16x16x32_bf16 v[180:183], v[20:23], v[60:63], v[180:183]
  v_mfma_f32_16x16x32_bf16 v[216:219], v[24:27], v[60:63], v[216:219]
  s_waitcnt lgkmcnt(0)
  s_barrier
  s_cmp_lg_u32 s51, 1
  s_cbranch_scc1 C_wm1
  buffer_load_dword v15, v13, s[20:23], s47 offen
C_wm1:
  v_mfma_f32_16x16x32_bf16 v[112:115], v[64:67], v[76:79], v[112:115]
  ds_read_b64_tr_b16 v[16:17], v8 offset:0
  s_add_u32 s40, s43, 43008
  v_mfma_f32_16x16x32_bf16 v[148:151], v[68:71], v[76:79], v[148:151]
  ds_read_b64_tr_b16 v[18:19], v8 offset:512
  s_cmp_eq_u32 s40, 129024
  v_mfma_f32_16x16x32_bf16 v[184:187], v[72:75], v[76:79], v[184:187]
  ds_read_b128 v[28:31], v9 offset:0
  s_cselect_b32 s40, 0, s40
  v_mfma_f32_16x16x32_bf16 v[188:191], v[72:75], v[80:83], v[188:191]
  ds_read_b64_tr_b16 v[20:21], v8 offset:8192
  s_sub_u32 s42, s40, s43
  v_mfma_f32_16x16x32_bf16 v[152:155], v[68:71], v[80:83], v[152:155]
  ds_read_b64_tr_b16 v[22:23], v8 offset:8704
  s_mov_b32 s43, s40
  v_mfma_f32_16x16x32_bf16 v[116:119], v[64:67], v[80:83], v[116:119]
  ds_read_b64_tr_b16 v[24:25], v8 offset:16384
  v_mfma_f32_16x16x32_bf16 v[120:123], v[64:67], v[84:87], v[120:123]
  ds_read_b64_tr_b16 v[26:27], v8 offset:16896
  v_mfma_f32_16x16x32_bf16 v[156:159], v[68:71], v[84:87], v[156:159]
  ds_read_b128 v[32:35], v9 offset:2048
  v_mfma_f32_16x16x32_bf16 v[192:195], v[72:75], v[84:87], v[192:195]
  ds_read_b128 v[36:39], v9 offset:4096
  v_mfma_f32_16x16x32_bf16 v[196:199], v[72:75], v[88:91], v[196:199]
  ds_read_b128 v[40:43], v9 offset:6144
  v_mfma_f32_16x16x32_bf16 v[160:163], v[68:71], v[88:91], v[160:163]
  ds_read_b128 v[44:47], v9 offset:8192
  v_mfma_f32_16x16x32_bf16 v[124:127], v[64:67], v[88:91], v[124:127]
  ds_read_b128 v[48:51], v9 offset:10240
  v_mfma_f32_16x16x32_bf16 v[128:131], v[64:67], v[92:95], v[128:131]
  ds_read_b128 v[52:55], v9 offset:12288
  v_mfma_f32_16x16x32_bf16 v[164:167], v[68:71], v[92:95], v[164:167]
  ds_read_b128 v[56:59], v9 offset:14336
  v_mfma_f32_16x16x32_bf16 v[200:203], v[72:75], v[92:95], v[200:203]
  ds_read_b128 v[60:63], v9 offset:16384
  v_mfma_f32_16x16x32_bf16 v[204:207], v[72:75], v[96:99], v[204:207]
  v_mfma_f32_16x16x32_bf16 v[168:171], v[68:71], v[96:99], v[168:171]
  v_mfma_f32_16x16x32_bf16 v[132:135], v[64:67], v[96:99], v[132:135]
  v_mfma_f32_16x16x32_bf16 v[136:139], v[64:67], v[100:103], v[136:139]
  v_mfma_f32_16x16x32_bf16 v[172:175], v[68:71], v[100:103], v[172:175]
  v_mfma_f32_16x16x32_bf16 v[208:211], v[72:75], v[100:103], v[208:211]
  v_mfma_f32_16x16x32_bf16 v[212:215], v[72:75], v[104:107], v[212:215]
  v_mfma_f32_16x16x32_bf16 v[176:179], v[68:71], v[104:107], v[176:179]
  v_mfma_f32_16x16x32_bf16 v[140:143], v[64:67], v[104:107], v[140:143]
  v_mfma_f32_16x16x32_bf16 v[144:147], v[64:67], v[108:111], v[144:147]
  v_mfma_f32_16x16x32_bf16 v[180:183], v[68:71], v[108:111], v[180:183]
  v_mfma_f32_16x16x32_bf16 v[216:219], v[72:75], v[108:111], v[216:219]
  s_waitcnt lgkmcnt(12)
  v_mfma_f32_16x16x32_bf16 v[112:115], v[16:19], v[28:31], v[112:115]
  ds_read_b64_tr_b16 v[64:65], v8 offset:4096
  s_waitcnt lgkmcnt(11)
  v_mfma_f32_16x16x32_bf16 v[148:151], v[20:23], v[28:31], v[148:151]
  ds_read_b64_tr_b16 v[66:67], v8 offset:4608
  s_waitcnt lgkmcnt(10)
  v_mfma_f32_16x16x32_bf16 v[184:187], v[24:27], v[28:31], v[184:187]
  ds_read_b128 v[76:79], v10 offset:0
  s_waitcnt lgkmcnt(10)
  v_mfma_f32_16x16x32_bf16 v[188:191], v[24:27], v[32:35], v[188:191]
  ds_read_b64_tr_b16 v[68:69], v8 offset:12288
  v_mfma_f32_16x16x32_bf16 v[152:155], v[20:23], v[32:35], v[152:155]
  ds_read_b64_tr_b16 v[70:71], v8 offset:12800
  v_mfma_f32_16x16x32_bf16 v[116:119], v[16:19], v[32:35], v[116:119]
  ds_read_b64_tr_b16 v[72:73], v8 offset:20480
  s_waitcnt lgkmcnt(12)
  v_mfma_f32_16x16x32_bf16 v[120:123], v[16:19], v[36:39], v[120:123]
  ds_read_b64_tr_b16 v[74:75], v8 offset:20992
  v_add_u32 v8, s42, v8
  v_mfma_f32_16x16x32_bf16 v[156:159], v[20:23], v[36:39], v[156:159]
  ds_read_b128 v[80:83], v10 offset:2048
  v_mfma_f32_16x16x32_bf16 v[192:195], v[24:27], v[36:39], v[192:195]
  ds_read_b128 v[84:87], v10 offset:4096
  s_waitcnt lgkmcnt(14)
  v_mfma_f32_16x16x32_bf16 v[196:199], v[24:27], v[40:43], v[196:199]
  ds_read_b128 v[88:91], v10 offset:6144
  v_mfma_f32_16x16x32_bf16 v[160:163], v[20:23], v[40:43], v[160:163]
  ds_read_b128 v[92:95], v10 offset:8192
  v_mfma_f32_16x16x32_bf16 v[124:127], v[16:19], v[40:43], v[124:127]
  ds_read_b128 v[96:99], v10 offset:10240
  s_waitcnt lgkmcnt(15)
  v_mfma_f32_16x16x32_bf16 v[128:131], v[16:19], v[44:47], v[128:131]
  ds_read_b128 v[100:103], v10 offset:12288
  v_mfma_f32_16x16x32_bf16 v[164:167], v[20:23], v[44:47], v[164:167]
  ds_read_b128 v[104:107], v10 offset:14336
  v_mfma_f32_16x16x32_bf16 v[200:203], v[24:27], v[44:47], v[200:203]
  ds_read_b128 v[108:111], v10 offset:16384
  v_add_u32 v9, s42, v9
  v_add_u32 v10, s42, v10
  s_waitcnt lgkmcnt(15)
  v_mfma_f32_16x16x32_bf16 v[204:207], v[24:27], v[48:51], v[204:207]
  v_mfma_f32_16x16x32_bf16 v[168:171], v[20:23], v[48:51], v[168:171]
  v_mfma_f32_16x16x32_bf16 v[132:135], v[16:19], v[48:51], v[132:135]
  s_waitcnt lgkmcnt(15)
  v_mfma_f32_16x16x32_bf16 v[136:139], v[16:19], v[52:55], v[136:139]
  v_mfma_f32_16x16x32_bf16 v[172:175], v[20:23], v[52:55], v[172:175]
  v_mfma_f32_16x16x32_bf16 v[208:211], v[24:27], v[52:55], v[208:211]
  s_waitcnt lgkmcnt(15)
  v_mfma_f32_16x16x32_bf16 v[212:215], v[24:27], v[56:59], v[212:215]
  v_mfma_f32_16x16x32_bf16 v[176:179], v[20:23], v[56:59], v[176:179]
  v_mfma_f32_16x16x32_bf16 v[140:143], v[16:19], v[56:59], v[140:143]
  s_waitcnt lgkmcnt(15)
  v_mfma_f32_16x16x32_bf16 v[144:147], v[16:19], v[60:63], v[144:147]
  v_mfma_f32_16x16x32_bf16 v[180:183], v[20:23], v[60:63], v[180:183]
  v_mfma_f32_16x16x32_bf16 v[216:219], v[24:27], v[60:63], v[216:219]
  s_waitcnt lgkmcnt(0)
  s_barrier
  s_cmp_lg_u32 s51, 2
  s_cbranch_scc1 C_wm2
  buffer_load_dword v15, v13, s[20:23], s47 offen
C_wm2:
  v_mfma_f32_16x16x32_bf16 v[112:115], v[64:67], v[76:79], v[112:115]
  ds_read_b64_tr_b16 v[16:17], v8 offset:0
  s_add_u32 s40, s43, 43008
  v_mfma_f32_16x16x32_bf16 v[148:151], v[68:71], v[76:79], v[148:151]
  ds_read_b64_tr_b16 v[18:19], v8 offset:512
  s_cmp_eq_u32 s40, 129024
  v_mfma_f32_16x16x32_bf16 v[184:187], v[72:75], v[76:79], v[184:187]
  ds_read_b128 v[28:31], v9 offset:0
  s_cselect_b32 s40, 0, s40
  v_mfma_f32_16x16x32_bf16 v[188:191], v[72:75], v[80:83], v[188:191]
  ds_read_b64_tr_b16 v[20:21], v8 offset:8192
  s_sub_u32 s42, s40, s43
  v_mfma_f32_16x16x32_bf16 v[152:155], v[68:71], v[80:83], v[152:155]
  ds_read_b64_tr_b16 v[22:23], v8 offset:8704
  s_mov_b32 s43, s40
  v_mfma_f32_16x16x32_bf16 v[116:119], v[64:67], v[80:83], v[116:119]
  ds_read_b64_tr_b16 v[24:25], v8 offset:16384
  v_mfma_f32_16x16x32_bf16 v[120:123], v[64:67], v[84:87], v[120:123]
  ds_read_b64_tr_b16 v[26:27], v8 offset:16896
  v_mfma_f32_16x16x32_bf16 v[156:159], v[68:71], v[84:87], v[156:159]
  ds_read_b128 v[32:35], v9 offset:2048
  v_mfma_f32_16x16x32_bf16 v[192:195], v[72:75], v[84:87], v[192:195]
  ds_read_b128 v[36:39], v9 offset:4096
  v_mfma_f32_16x16x32_bf16 v[196:199], v[72:75], v[88:91], v[196:199]
  ds_read_b128 v[40:43], v9 offset:6144
  v_mfma_f32_16x16x32_bf16 v[160:163], v[68:71], v[88:91], v[160:163]
  ds_read_b128 v[44:47], v9 offset:8192
  v_mfma_f32_16x16x32_bf16 v[124:127], v[64:67], v[88:91], v[124:127]
  ds_read_b128 v[48:51], v9 offset:10240
  v_mfma_f32_16x16x32_bf16 v[128:131], v[64:67], v[92:95], v[128:131]
  ds_read_b128 v[52:55], v9 offset:12288
  v_mfma_f32_16x16x32_bf16 v[164:167], v[68:71], v[92:95], v[164:167]
  ds_read_b128 v[56:59], v9 offset:14336
  v_mfma_f32_16x16x32_bf16 v[200:203], v[72:75], v[92:95], v[200:203]
  ds_read_b128 v[60:63], v9 offset:16384
  v_mfma_f32_16x16x32_bf16 v[204:207], v[72:75], v[96:99], v[204:207]
  v_mfma_f32_16x16x32_bf16 v[168:171], v[68:71], v[96:99], v[168:171]
  v_mfma_f32_16x16x32_bf16 v[132:135], v[64:67], v[96:99], v[132:135]
  v_mfma_f32_16x16x32_bf16 v[136:139], v[64:67], v[100:103], v[136:139]
  v_mfma_f32_16x16x32_bf16 v[172:175], v[68:71], v[100:103], v[172:175]
  v_mfma_f32_16x16x32_bf16 v[208:211], v[72:75], v[100:103], v[208:211]
  v_mfma_f32_16x16x32_bf16 v[212:215], v[72:75], v[104:107], v[212:215]
  v_mfma_f32_16x16x32_bf16 v[176:179], v[68:71], v[104:107], v[176:179]
  v_mfma_f32_16x16x32_bf16 v[140:143], v[64:67], v[104:107], v[140:143]
  v_mfma_f32_16x16x32_bf16 v[144:147], v[64:67], v[108:111], v[144:147]
  v_mfma_f32_16x16x32_bf16 v[180:183], v[68:71], v[108:111], v[180:183]
  v_mfma_f32_16x16x32_bf16 v[216:219], v[72:75], v[108:111], v[216:219]
  s_waitcnt lgkmcnt(12)
  v_mfma_f32_16x16x32_bf16 v[112:115], v[16:19], v[28:31], v[112:115]
  ds_read_b64_tr_b16 v[64:65], v8 offset:4096
  s_waitcnt lgkmcnt(11)
  v_mfma_f32_16x16x32_bf16 v[148:151], v[20:23], v[28:31], v[148:151]
  ds_read_b64_tr_b16 v[66:67], v8 offset:4608
  s_waitcnt lgkmcnt(10)
  v_mfma_f32_16x16x32_bf16 v[184:187], v[24:27], v[28:31], v[184:187]
  ds_read_b128 v[76:79], v10 offset:0
  s_waitcnt lgkmcnt(10)
  v_mfma_f32_16x16x32_bf16 v[188:191], v[24:27], v[32:35], v[188:191]
  ds_read_b64_tr_b16 v[68:69], v8 offset:12288
  v_mfma_f32_16x16x32_bf16 v[152:155], v[20:23], v[32:35], v[152:155]
  ds_read_b64_tr_b16 v[70:71], v8 offset:12800
  v_mfma_f32_16x16x32_bf16 v[116:119], v[16:19], v[32:35], v[116:119]
  ds_read_b64_tr_b16 v[72:73], v8 offset:20480
  s_waitcnt lgkmcnt(12)
  v_mfma_f32_16x16x32_bf16 v[120:123], v[16:19], v[36:39], v[120:123]
  ds_read_b64_tr_b16 v[74:75], v8 offset:20992
  v_add_u32 v8, s42, v8
  v_mfma_f32_16x16x32_bf16 v[156:159], v[20:23], v[36:39], v[156:159]
  ds_read_b128 v[80:83], v10 offset:2048
  v_mfma_f32_16x16x32_bf16 v[192:195], v[24:27], v[36:39], v[192:195]
  ds_read_b128 v[84:87], v10 offset:4096
  s_waitcnt lgkmcnt(14)
  v_mfma_f32_16x16x32_bf16 v[196:199], v[24:27], v[40:43], v[196:199]
  ds_read_b128 v[88:91], v10 offset:6144
  v_mfma_f32_16x16x32_bf16 v[160:163], v[20:23], v[40:43], v[160:163]
  ds_read_b128 v[92:95], v10 offset:8192
  v_mfma_f32_16x16x32_bf16 v[124:127], v[16:19], v[40:43], v[124:127]
  ds_read_b128 v[96:99], v10 offset:10240
  s_waitcnt lgkmcnt(15)
  v_mfma_f32_16x16x32_bf16 v[128:131], v[16:19], v[44:47], v[128:131]
  ds_read_b128 v[100:103], v10 offset:12288
  v_mfma_f32_16x16x32_bf16 v[164:167], v[20:23], v[44:47], v[164:167]
  ds_read_b128 v[104:107], v10 offset:14336
  v_mfma_f32_16x16x32_bf16 v[200:203], v[24:27], v[44:47], v[200:203]
  ds_read_b128 v[108:111], v10 offset:16384
  v_add_u32 v9, s42, v9
  v_add_u32 v10, s42, v10
  s_waitcnt lgkmcnt(15)
  v_mfma_f32_16x16x32_bf16 v[204:207], v[24:27], v[48:51], v[204:207]
  v_mfma_f32_16x16x32_bf16 v[168:171], v[20:23], v[48:51], v[168:171]
  v_mfma_f32_16x16x32_bf16 v[132:135], v[16:19], v[48:51], v[132:135]
  s_waitcnt lgkmcnt(15)
  v_mfma_f32_16x16x32_bf16 v[136:139], v[16:19], v[52:55], v[136:139]
  v_mfma_f32_16x16x32_bf16 v[172:175], v[20:23], v[52:55], v[172:175]
  v_mfma_f32_16x16x32_bf16 v[208:211], v[24:27], v[52:55], v[208:211]
  s_waitcnt lgkmcnt(15)
  v_mfma_f32_16x16x32_bf16 v[212:215], v[24:27], v[56:59], v[212:215]
  v_mfma_f32_16x16x32_bf16 v[176:179], v[20:23], v[56:59], v[176:179]
  v_mfma_f32_16x16x32_bf16 v[140:143], v[16:19], v[56:59], v[140:143]
  s_waitcnt lgkmcnt(15)
  v_mfma_f32_16x16x32_bf16 v[144:147], v[16:19], v[60:63], v[144:147]
  v_mfma_f32_16x16x32_bf16 v[180:183], v[20:23], v[60:63], v[180:183]
  v_mfma_f32_16x16x32_bf16 v[216:219], v[24:27], v[60:63], v[216:219]
  s_waitcnt lgkmcnt(0)
  s_barrier
  s_cmp_lg_u32 s51, 3
  s_cbranch_scc1 C_wm3
  buffer_load_dword v15, v13, s[20:23], s47 offen
C_wm3:
  v_mfma_f32_16x16x32_bf16 v[112:115], v[64:67], v[76:79], v[112:115]
  ds_read_b64_tr_b16 v[16:17], v8 offset:0
  s_add_u32 s40, s43, 43008
  v_mfma_f32_16x16x32_bf16 v[148:151], v[68:71], v[76:79], v[148:151]
  ds_read_b64_tr_b16 v[18:19], v8 offset:512
  s_cmp_eq_u32 s40, 129024
  v_mfma_f32_16x16x32_bf16 v[184:187], v[72:75], v[76:79], v[184:187]
  ds_read_b128 v[28:31], v9 offset:0
  s_cselect_b32 s40, 0, s40
  v_mfma_f32_16x16x32_bf16 v[188:191], v[72:75], v[80:83], v[188:191]
  ds_read_b64_tr_b16 v[20:21], v8 offset:8192
  s_sub_u32 s42, s40, s43
  v_mfma_f32_16x16x32_bf16 v[152:155], v[68:71], v[80:83], v[152:155]
  ds_read_b64_tr_b16 v[22:23], v8 offset:8704
  s_mov_b32 s43, s40
  v_mfma_f32_16x16x32_bf16 v[116:119], v[64:67], v[80:83], v[116:119]
  ds_read_b64_tr_b16 v[24:25], v8 offset:16384
  v_mfma_f32_16x16x32_bf16 v[120:123], v[64:67], v[84:87], v[120:123]
  ds_read_b64_tr_b16 v[26:27], v8 offset:16896
  v_mfma_f32_16x16x32_bf16 v[156:159], v[68:71], v[84:87], v[156:159]
  ds_read_b128 v[32:35], v9 offset:2048
  v_mfma_f32_16x16x32_bf16 v[192:195], v[72:75], v[84:87], v[192:195]
  ds_read_b128 v[36:39], v9 offset:4096
  v_mfma_f32_16x16x32_bf16 v[196:199], v[72:75], v[88:91], v[196:199]
  ds_read_b128 v[40:43], v9 offset:6144
  v_mfma_f32_16x16x32_bf16 v[160:163], v[68:71], v[88:91], v[160:163]
  ds_read_b128 v[44:47], v9 offset:8192
  v_mfma_f32_16x16x32_bf16 v[124:127], v[64:67], v[88:91], v[124:127]
  ds_read_b128 v[48:51], v9 offset:10240
  v_mfma_f32_16x16x32_bf16 v[128:131], v[64:67], v[92:95], v[128:131]
  ds_read_b128 v[52:55], v9 offset:12288
  v_mfma_f32_16x16x32_bf16 v[164:167], v[68:71], v[92:95], v[164:167]
  ds_read_b128 v[56:59], v9 offset:14336
  v_mfma_f32_16x16x32_bf16 v[200:203], v[72:75], v[92:95], v[200:203]
  ds_read_b128 v[60:63], v9 offset:16384
  v_mfma_f32_16x16x32_bf16 v[204:207], v[72:75], v[96:99], v[204:207]
  v_mfma_f32_16x16x32_bf16 v[168:171], v[68:71], v[96:99], v[168:171]
  v_mfma_f32_16x16x32_bf16 v[132:135], v[64:67], v[96:99], v[132:135]
  v_mfma_f32_16x16x32_bf16 v[136:139], v[64:67], v[100:103], v[136:139]
  v_mfma_f32_16x16x32_bf16 v[172:175], v[68:71], v[100:103], v[172:175]
  v_mfma_f32_16x16x32_bf16 v[208:211], v[72:75], v[100:103], v[208:211]
  v_mfma_f32_16x16x32_bf16 v[212:215], v[72:75], v[104:107], v[212:215]
  v_mfma_f32_16x16x32_bf16 v[176:179], v[68:71], v[104:107], v[176:179]
  v_mfma_f32_16x16x32_bf16 v[140:143], v[64:67], v[104:107], v[140:143]
  v_mfma_f32_16x16x32_bf16 v[144:147], v[64:67], v[108:111], v[144:147]
  v_mfma_f32_16x16x32_bf16 v[180:183], v[68:71], v[108:111], v[180:183]
  v_mfma_f32_16x16x32_bf16 v[216:219], v[72:75], v[108:111], v[216:219]
cl1:
  s_waitcnt lgkmcnt(12)
  v_mfma_f32_16x16x32_bf16 v[112:115], v[16:19], v[28:31], v[112:115]
  ds_read_b64_tr_b16 v[64:65], v8 offset:4096
  s_waitcnt lgkmcnt(11)
  v_mfma_f32_16x16x32_bf16 v[148:151], v[20:23], v[28:31], v[148:151]
  ds_read_b64_tr_b16 v[66:67], v8 offset:4608
  s_waitcnt lgkmcnt(10)
  v_mfma_f32_16x16x32_bf16 v[184:187], v[24:27], v[28:31], v[184:187]
  ds_read_b128 v[76:79], v10 offset:0
  s_waitcnt lgkmcnt(10)
  v_mfma_f32_16x16x32_bf16 v[188:191], v[24:27], v[32:35], v[188:191]
  ds_read_b64_tr_b16 v[68:69], v8 offset:12288
  v_mfma_f32_16x16x32_bf16 v[152:155], v[20:23], v[32:35], v[152:155]
  ds_read_b64_tr_b16 v[70:71], v8 offset:12800
  v_mfma_f32_16x16x32_bf16 v[116:119], v[16:19], v[32:35], v[116:119]
  ds_read_b64_tr_b16 v[72:73], v8 offset:20480
  s_waitcnt lgkmcnt(12)
  v_mfma_f32_16x16x32_bf16 v[120:123], v[16:19], v[36:39], v[120:123]
  ds_read_b64_tr_b16 v[74:75], v8 offset:20992
  v_add_u32 v8, s42, v8
  v_mfma_f32_16x16x32_bf16 v[156:159], v[20:23], v[36:39], v[156:159]
  ds_read_b128 v[80:83], v10 offset:2048
  v_mfma_f32_16x16x32_bf16 v[192:195], v[24:27], v[36:39], v[192:195]
  ds_read_b128 v[84:87], v10 offset:4096
  s_waitcnt lgkmcnt(14)
  v_mfma_f32_16x16x32_bf16 v[196:199], v[24:27], v[40:43], v[196:199]
  ds_read_b128 v[88:91], v10 offset:6144
  v_mfma_f32_16x16x32_bf16 v[160:163], v[20:23], v[40:43], v[160:163]
  ds_read_b128 v[92:95], v10 offset:8192
  v_mfma_f32_16x16x32_bf16 v[124:127], v[16:19], v[40:43], v[124:127]
  ds_read_b128 v[96:99], v10 offset:10240
  s_waitcnt lgkmcnt(15)
  v_mfma_f32_16x16x32_bf16 v[128:131], v[16:19], v[44:47], v[128:131]
  ds_read_b128 v[100:103], v10 offset:12288
  v_mfma_f32_16x16x32_bf16 v[164:167], v[20:23], v[44:47], v[164:167]
  ds_read_b128 v[104:107], v10 offset:14336
  v_mfma_f32_16x16x32_bf16 v[200:203], v[24:27], v[44:47], v[200:203]
  ds_read_b128 v[108:111], v10 offset:16384
  v_add_u32 v9, s42, v9
  v_add_u32 v10, s42, v10
  s_waitcnt lgkmcnt(15)
  v_mfma_f32_16x16x32_bf16 v[204:207], v[24:27], v[48:51], v[204:207]
  v_mfma_f32_16x16x32_bf16 v[168:171], v[20:23], v[48:51], v[168:171]
  v_mfma_f32_16x16x32_bf16 v[132:135], v[16:19], v[48:51], v[132:135]
  s_waitcnt lgkmcnt(15)
  v_mfma_f32_16x16x32_bf16 v[136:139], v[16:19], v[52:55], v[136:139]
  v_mfma_f32_16x16x32_bf16 v[172:175], v[20:23], v[52:55], v[172:175]
  v_mfma_f32_16x16x32_bf16 v[208:211], v[24:27], v[52:55], v[208:211]
  s_waitcnt lgkmcnt(15)
  v_mfma_f32_16x16x32_bf16 v[212:215], v[24:27], v[56:59], v[212:215]
  v_mfma_f32_16x16x32_bf16 v[176:179], v[20:23], v[56:59], v[176:179]
  v_mfma_f32_16x16x32_bf16 v[140:143], v[16:19], v[56:59], v[140:143]
  s_waitcnt lgkmcnt(15)
  v_mfma_f32_16x16x32_bf16 v[144:147], v[16:19], v[60:63], v[144:147]
  v_mfma_f32_16x16x32_bf16 v[180:183], v[20:23], v[60:63], v[180:183]
  v_mfma_f32_16x16x32_bf16 v[216:219], v[24:27], v[60:63], v[216:219]
  s_waitcnt lgkmcnt(0)
  s_barrier
  v_mfma_f32_16x16x32_bf16 v[112:115], v[64:67], v[76:79], v[112:115]
  ds_read_b64_tr_b16 v[16:17], v8 offset:0
  s_add_u32 s40, s43, 43008
  v_mfma_f32_16x16x32_bf16 v[148:151], v[68:71], v[76:79], v[148:151]
  ds_read_b64_tr_b16 v[18:19], v8 offset:512
  s_cmp_eq_u32 s40, 129024
  v_mfma_f32_16x16x32_bf16 v[184:187], v[72:75], v[76:79], v[184:187]
  ds_read_b128 v[28:31], v9 offset:0
  s_cselect_b32 s40, 0, s40
  v_mfma_f32_16x16x32_bf16 v[188:191], v[72:75], v[80:83], v[188:191]
  ds_read_b64_tr_b16 v[20:21], v8 offset:8192
  s_sub_u32 s42, s40, s43
  v_mfma_f32_16x16x32_bf16 v[152:155], v[68:71], v[80:83], v[152:155]
  ds_read_b64_tr_b16 v[22:23], v8 offset:8704
  s_mov_b32 s43, s40
  v_mfma_f32_16x16x32_bf16 v[116:119], v[64:67], v[80:83], v[116:119]
  ds_read_b64_tr_b16 v[24:25], v8 offset:16384
  v_mfma_f32_16x16x32_bf16 v[120:123], v[64:67], v[84:87], v[120:123]
  ds_read_b64_tr_b16 v[26:27], v8 offset:16896
  v_mfma_f32_16x16x32_bf16 v[156:159], v[68:71], v[84:87], v[156:159]
  ds_read_b128 v[32:35], v9 offset:2048
  v_mfma_f32_16x16x32_bf16 v[192:195], v[72:75], v[84:87], v[192:195]
  ds_read_b128 v[36:39], v9 offset:4096
  v_mfma_f32_16x16x32_bf16 v[196:199], v[72:75], v[88:91], v[196:199]
  ds_read_b128 v[40:43], v9 offset:6144
  v_mfma_f32_16x16x32_bf16 v[160:163], v[68:71], v[88:91], v[160:163]
  ds_read_b128 v[44:47], v9 offset:8192
  v_mfma_f32_16x16x32_bf16 v[124:127], v[64:67], v[88:91], v[124:127]
  ds_read_b128 v[48:51], v9 offset:10240
  v_mfma_f32_16x16x32_bf16 v[128:131], v[64:67], v[92:95], v[128:131]
  ds_read_b128 v[52:55], v9 offset:12288
  v_mfma_f32_16x16x32_bf16 v[164:167], v[68:71], v[92:95], v[164:167]
  ds_read_b128 v[56:59], v9 offset:14336
  v_mfma_f32_16x16x32_bf16 v[200:203], v[72:75], v[92:95], v[200:203]
  ds_read_b128 v[60:63], v9 offset:16384
  v_mfma_f32_16x16x32_bf16 v[204:207], v[72:75], v[96:99], v[204:207]
  v_mfma_f32_16x16x32_bf16 v[168:171], v[68:71], v[96:99], v[168:171]
  v_mfma_f32_16x16x32_bf16 v[132:135], v[64:67], v[96:99], v[132:135]
  v_mfma_f32_16x16x32_bf16 v[136:139], v[64:67], v[100:103], v[136:139]
  v_mfma_f32_16x16x32_bf16 v[172:175], v[68:71], v[100:103], v[172:175]
  v_mfma_f32_16x16x32_bf16 v[208:211], v[72:75], v[100:103], v[208:211]
  v_mfma_f32_16x16x32_bf16 v[212:215], v[72:75], v[104:107], v[212:215]
  v_mfma_f32_16x16x32_bf16 v[176:179], v[68:71], v[104:107], v[176:179]
  v_mfma_f32_16x16x32_bf16 v[140:143], v[64:67], v[104:107], v[140:143]
  v_mfma_f32_16x16x32_bf16 v[144:147], v[64:67], v[108:111], v[144:147]
  v_mfma_f32_16x16x32_bf16 v[180:183], v[68:71], v[108:111], v[180:183]
  v_mfma_f32_16x16x32_bf16 v[216:219], v[72:75], v[108:111], v[216:219]
  s_sub_u32 s39, s39, 1
  s_cmp_lg_u32 s39, 0
  s_cbranch_scc1 cl1
  s_waitcnt lgkmcnt(12)
  v_mfma_f32_16x16x32_bf16 v[112:115], v[16:19], v[28:31], v[112:115]
  ds_read_b64_tr_b16 v[64:65], v8 offset:4096
  s_waitcnt lgkmcnt(11)
  v_mfma_f32_16x16x32_bf16 v[148:151], v[20:23], v[28:31], v[148:151]
  ds_read_b64_tr_b16 v[66:67], v8 offset:4608
  s_waitcnt lgkmcnt(10)
  v_mfma_f32_16x16x32_bf16 v[184:187], v[24:27], v[28:31], v[184:187]
  ds_read_b128 v[76:79], v10 offset:0
  s_waitcnt lgkmcnt(10)
  v_mfma_f32_16x16x32_bf16 v[188:191], v[24:27], v[32:35], v[188:191]
  ds_read_b64_tr_b16 v[68:69], v8 offset:12288
  v_mfma_f32_16x16x32_bf16 v[152:155], v[20:23], v[32:35], v[152:155]
  ds_read_b64_tr_b16 v[70:71], v8 offset:12800
  v_mfma_f32_16x16x32_bf16 v[116:119], v[16:19], v[32:35], v[116:119]
  ds_read_b64_tr_b16 v[72:73], v8 offset:20480
  s_waitcnt lgkmcnt(12)
  v_mfma_f32_16x16x32_bf16 v[120:123], v[16:19], v[36:39], v[120:123]
  ds_read_b64_tr_b16 v[74:75], v8 offset:20992
  v_mfma_f32_16x16x32_bf16 v[156:159], v[20:23], v[36:39], v[156:159]
  ds_read_b128 v[80:83], v10 offset:2048
  v_mfma_f32_16x16x32_bf16 v[192:195], v[24:27], v[36:39], v[192:195]
  ds_read_b128 v[84:87], v10 offset:4096
  s_waitcnt lgkmcnt(14)
  v_mfma_f32_16x16x32_bf16 v[196:199], v[24:27], v[40:43], v[196:199]
  ds_read_b128 v[88:91], v10 offset:6144
  v_mfma_f32_16x16x32_bf16 v[160:163], v[20:23], v[40:43], v[160:163]
  ds_read_b128 v[92:95], v10 offset:8192
  v_mfma_f32_16x16x32_bf16 v[124:127], v[16:19], v[40:43], v[124:127]
  ds_read_b128 v[96:99], v10 offset:10240
  s_waitcnt lgkmcnt(15)
  v_mfma_f32_16x16x32_bf16 v[128:131], v[16:19], v[44:47], v[128:131]
  ds_read_b128 v[100:103], v10 offset:12288
  v_mfma_f32_16x16x32_bf16 v[164:167], v[20:23], v[44:47], v[164:167]
  ds_read_b128 v[104:107], v10 offset:14336
  v_mfma_f32_16x16x32_bf16 v[200:203], v[24:27], v[44:47], v[200:203]
  ds_read_b128 v[108:111], v10 offset:16384
  s_waitcnt lgkmcnt(15)
  v_mfma_f32_16x16x32_bf16 v[204:207], v[24:27], v[48:51], v[204:207]
  ds_read_b64 v[224:225], v12 offset:0
  v_mfma_f32_16x16x32_bf16 v[168:171], v[20:23], v[48:51], v[168:171]
  ds_read_b64 v[226:227], v12 offset:128
  v_mfma_f32_16x16x32_bf16 v[132:135], v[16:19], v[48:51], v[132:135]
  ds_read_b64 v[228:229], v12 offset:256
  s_waitcnt lgkmcnt(15)
  v_mfma_f32_16x16x32_bf16 v[136:139], v[16:19], v[52:55], v[136:139]
  ds_read_b64 v[230:231], v12 offset:384
  v_mfma_f32_16x16x32_bf16 v[172:175], v[20:23], v[52:55], v[172:175]
  ds_read_b64 v[232:233], v12 offset:512
  v_mfma_f32_16x16x32_bf16 v[208:211], v[24:27], v[52:55], v[208:211]
  ds_read_b64 v[234:235], v12 offset:640
  s_waitcnt lgkmcnt(15)
  v_mfma_f32_16x16x32_bf16 v[212:215], v[24:27], v[56:59], v[212:215]
  ds_read_b64 v[236:237], v12 offset:768
  v_mfma_f32_16x16x32_bf16 v[176:179], v[20:23], v[56:59], v[176:179]
  ds_read_b64 v[238:239], v12 offset:896
  v_mfma_f32_16x16x32_bf16 v[140:143], v[16:19], v[56:59], v[140:143]
  ds_read_b64 v[240:241], v12 offset:1024
  s_waitcnt lgkmcnt(15)
  v_mfma_f32_16x16x32_bf16 v[144:147], v[16:19], v[60:63], v[144:147]
  v_mfma_f32_16x16x32_bf16 v[180:183], v[20:23], v[60:63], v[180:183]
  v_mfma_f32_16x16x32_bf16 v[216:219], v[24:27], v[60:63], v[216:219]
  s_waitcnt lgkmcnt(0)
  v_mfma_f32_16x16x32_bf16 v[112:115], v[64:67], v[76:79], v[112:115]
  v_mfma_f32_16x16x32_bf16 v[148:151], v[68:71], v[76:79], v[148:151]
  v_mfma_f32_16x16x32_bf16 v[184:187], v[72:75], v[76:79], v[184:187]
  v_mfma_f32_16x16x32_bf16 v[188:191], v[72:75], v[80:83], v[188:191]
  s_nop 4
  v_mov_b32_dpp v242, v112 row_newbcast:0 row_mask:0xf bank_mask:0xf
  v_mov_b32_dpp v243, v113 row_newbcast:0 row_mask:0xf bank_mask:0xf
  v_mov_b32_dpp v244, v114 row_newbcast:0 row_mask:0xf bank_mask:0xf
  v_mov_b32_dpp v245, v115 row_newbcast:0 row_mask:0xf bank_mask:0xf
  v_mov_b32_dpp v246, v148 row_newbcast:0 row_mask:0xf bank_mask:0xf
  v_mov_b32_dpp v247, v149 row_newbcast:0 row_mask:0xf bank_mask:0xf
  v_mov_b32_dpp v248, v150 row_newbcast:0 row_mask:0xf bank_mask:0xf
  v_mfma_f32_16x16x32_bf16 v[152:155], v[68:71], v[80:83], v[152:155]
  v_mov_b32_dpp v249, v151 row_newbcast:0 row_mask:0xf bank_mask:0xf
  v_mov_b32_dpp v250, v184 row_newbcast:0 row_mask:0xf bank_mask:0xf
  v_mov_b32_dpp v251, v185 row_newbcast:0 row_mask:0xf bank_mask:0xf
  v_mov_b32_dpp v252, v186 row_newbcast:0 row_mask:0xf bank_mask:0xf
  v_mov_b32_dpp v253, v187 row_newbcast:0 row_mask:0xf bank_mask:0xf
  v_pk_fma_f32 v[148:149], v[246:247], v[224:225], v[148:149] op_sel_hi:[1,0,1] neg_lo:[0,1,0] neg_hi:[0,1,0]
  v_pk_fma_f32 v[150:151], v[248:249], v[224:225], v[150:151] op_sel_hi:[1,0,1] neg_lo:[0,1,0] neg_hi:[0,1,0]
  v_mfma_f32_16x16x32_bf16 v[116:119], v[64:67], v[80:83], v[116:119]
  v_pk_fma_f32 v[184:185], v[250:251], v[224:225], v[184:185] op_sel_hi:[1,0,1] neg_lo:[0,1,0] neg_hi:[0,1,0]
  v_pk_fma_f32 v[186:187], v[252:253], v[224:225], v[186:187] op_sel_hi:[1,0,1] neg_lo:[0,1,0] neg_hi:[0,1,0]
  v_pk_mul_f32 v[148:149], v[148:149], v[224:225] op_sel:[0,1] op_sel_hi:[1,1]
  v_pk_mul_f32 v[150:151], v[150:151], v[224:225] op_sel:[0,1] op_sel_hi:[1,1]
  v_pk_mul_f32 v[184:185], v[184:185], v[224:225] op_sel:[0,1] op_sel_hi:[1,1]
  v_pk_mul_f32 v[186:187], v[186:187], v[224:225] op_sel:[0,1] op_sel_hi:[1,1]
  v_cvt_pk_bf16_f32 v16, v148, v149
  v_mfma_f32_16x16x32_bf16 v[120:123], v[64:67], v[84:87], v[120:123]
  v_cvt_pk_bf16_f32 v17, v150, v151
  ds_write_b64 v11, v[16:17] offset:128
  v_cvt_pk_bf16_f32 v18, v184, v185
  v_cvt_pk_bf16_f32 v19, v186, v187
  ds_write_b64 v11, v[18:19] offset:256
  v_pk_fma_f32 v[116:117], v[242:243], v[226:227], v[116:117] op_sel_hi:[1,0,1] neg_lo:[0,1,0] neg_hi:[0,1,0]
  v_pk_fma_f32 v[118:119], v[244:245], v[226:227], v[118:119] op_sel_hi:[1,0,1] neg_lo:[0,1,0] neg_hi:[0,1,0]
  v_mfma_f32_16x16x32_bf16 v[156:159], v[68:71], v[84:87], v[156:159]
  v_pk_fma_f32 v[152:153], v[246:247], v[226:227], v[152:153] op_sel_hi:[1,0,1] neg_lo:[0,1,0] neg_hi:[0,1,0]
  v_pk_fma_f32 v[154:155], v[248:249], v[226:227], v[154:155] op_sel_hi:[1,0,1] neg_lo:[0,1,0] neg_hi:[0,1,0]
  v_pk_fma_f32 v[188:189], v[250:251], v[226:227], v[188:189] op_sel_hi:[1,0,1] neg_lo:[0,1,0] neg_hi:[0,1,0]
  v_pk_fma_f32 v[190:191], v[252:253], v[226:227], v[190:191] op_sel_hi:[1,0,1] neg_lo:[0,1,0] neg_hi:[0,1,0]
  v_pk_mul_f32 v[116:117], v[116:117], v[226:227] op_sel:[0,1] op_sel_hi:[1,1]
  v_pk_mul_f32 v[118:119], v[118:119], v[226:227] op_sel:[0,1] op_sel_hi:[1,1]
  v_pk_mul_f32 v[152:153], v[152:153], v[226:227] op_sel:[0,1] op_sel_hi:[1,1]
  v_mfma_f32_16x16x32_bf16 v[192:195], v[72:75], v[84:87], v[192:195]
  v_pk_mul_f32 v[154:155], v[154:155], v[226:227] op_sel:[0,1] op_sel_hi:[1,1]
  v_pk_mul_f32 v[188:189], v[188:189], v[226:227] op_sel:[0,1] op_sel_hi:[1,1]
  v_pk_mul_f32 v[190:191], v[190:191], v[226:227] op_sel:[0,1] op_sel_hi:[1,1]
  v_cvt_pk_bf16_f32 v22, v116, v117
  v_cvt_pk_bf16_f32 v23, v118, v119
  ds_write_b64 v11, v[22:23] offset:3200
  v_cvt_pk_bf16_f32 v24, v152, v153
  v_mfma_f32_16x16x32_bf16 v[196:199], v[72:75], v[88:91], v[196:199]
  v_cvt_pk_bf16_f32 v25, v154, v155
  ds_write_b64 v11, v[24:25] offset:3328
  v_cvt_pk_bf16_f32 v26, v188, v189
  v_cvt_pk_bf16_f32 v27, v190, v191
  ds_write_b64 v11, v[26:27] offset:3456
  v_pk_fma_f32 v[120:121], v[242:243], v[228:229], v[120:121] op_sel_hi:[1,0,1] neg_lo:[0,1,0] neg_hi:[0,1,0]
  v_pk_fma_f32 v[122:123], v[244:245], v[228:229], v[122:123] op_sel_hi:[1,0,1] neg_lo:[0,1,0] neg_hi:[0,1,0]
  v_mfma_f32_16x16x32_bf16 v[160:163], v[68:71], v[88:91], v[160:163]
  v_pk_fma_f32 v[156:157], v[246:247], v[228:229], v[156:157] op_sel_hi:[1,0,1] neg_lo:[0,1,0] neg_hi:[0,1,0]
  v_pk_fma_f32 v[158:159], v[248:249], v[228:229], v[158:159] op_sel_hi:[1,0,1] neg_lo:[0,1,0] neg_hi:[0,1,0]
  v_pk_fma_f32 v[192:193], v[250:251], v[228:229], v[192:193] op_sel_hi:[1,0,1] neg_lo:[0,1,0] neg_hi:[0,1,0]
  v_pk_fma_f32 v[194:195], v[252:253], v[228:229], v[194:195] op_sel_hi:[1,0,1] neg_lo:[0,1,0] neg_hi:[0,1,0]
  v_pk_mul_f32 v[120:121], v[120:121], v[228:229] op_sel:[0,1] op_sel_hi:[1,1]
  v_pk_mul_f32 v[122:123], v[122:123], v[228:229] op_sel:[0,1] op_sel_hi:[1,1]
  v_pk_mul_f32 v[156:157], v[156:157], v[228:229] op_sel:[0,1] op_sel_hi:[1,1]
  v_mfma_f32_16x16x32_bf16 v[124:127], v[64:67], v[88:91], v[124:127]
  v_pk_mul_f32 v[158:159], v[158:159], v[228:229] op_sel:[0,1] op_sel_hi:[1,1]
  v_pk_mul_f32 v[192:193], v[192:193], v[228:229] op_sel:[0,1] op_sel_hi:[1,1]
  v_pk_mul_f32 v[194:195], v[194:195], v[228:229] op_sel:[0,1] op_sel_hi:[1,1]
  v_cvt_pk_bf16_f32 v28, v120, v121
  v_cvt_pk_bf16_f32 v29, v122, v123
  ds_write_b64 v11, v[28:29] offset:6400
  v_cvt_pk_bf16_f32 v30, v156, v157
  v_mfma_f32_16x16x32_bf16 v[128:131], v[64:67], v[92:95], v[128:131]
  v_cvt_pk_bf16_f32 v31, v158, v159
  ds_write_b64 v11, v[30:31] offset:6528
  v_cvt_pk_bf16_f32 v32, v192, v193
  v_cvt_pk_bf16_f32 v33, v194, v195
  ds_write_b64 v11, v[32:33] offset:6656
  v_pk_fma_f32 v[124:125], v[242:243], v[230:231], v[124:125] op_sel_hi:[1,0,1] neg_lo:[0,1,0] neg_hi:[0,1,0]
  v_pk_fma_f32 v[126:127], v[244:245], v[230:231], v[126:127] op_sel_hi:[1,0,1] neg_lo:[0,1,0] neg_hi:[0,1,0]
  v_mfma_f32_16x16x32_bf16 v[164:167], v[68:71], v[92:95], v[164:167]
  v_pk_fma_f32 v[160:161], v[246:247], v[230:231], v[160:161] op_sel_hi:[1,0,1] neg_lo:[0,1,0] neg_hi:[0,1,0]
  v_pk_fma_f32 v[162:163], v[248:249], v[230:231], v[162:163] op_sel_hi:[1,0,1] neg_lo:[0,1,0] neg_hi:[0,1,0]
  v_pk_fma_f32 v[196:197], v[250:251], v[230:231], v[196:197] op_sel_hi:[1,0,1] neg_lo:[0,1,0] neg_hi:[0,1,0]
  v_pk_fma_f32 v[198:199], v[252:253], v[230:231], v[198:199] op_sel_hi:[1,0,1] neg_lo:[0,1,0] neg_hi:[0,1,0]
  v_pk_mul_f32 v[124:125], v[124:125], v[230:231] op_sel:[0,1] op_sel_hi:[1,1]
  v_pk_mul_f32 v[126:127], v[126:127], v[230:231] op_sel:[0,1] op_sel_hi:[1,1]
  v_pk_mul_f32 v[160:161], v[160:161], v[230:231] op_sel:[0,1] op_sel_hi:[1,1]
  v_mfma_f32_16x16x32_bf16 v[200:203], v[72:75], v[92:95], v[200:203]
  v_pk_mul_f32 v[162:163], v[162:163], v[230:231] op_sel:[0,1] op_sel_hi:[1,1]
  v_pk_mul_f32 v[196:197], v[196:197], v[230:231] op_sel:[0,1] op_sel_hi:[1,1]
  v_pk_mul_f32 v[198:199], v[198:199], v[230:231] op_sel:[0,1] op_sel_hi:[1,1]
  v_cvt_pk_bf16_f32 v34, v124, v125
  v_cvt_pk_bf16_f32 v35, v126, v127
  ds_write_b64 v11, v[34:35] offset:9600
  v_cvt_pk_bf16_f32 v36, v160, v161
  v_mfma_f32_16x16x32_bf16 v[204:207], v[72:75], v[96:99], v[204:207]
  v_cvt_pk_bf16_f32 v37, v162, v163
  ds_write_b64 v11, v[36:37] offset:9728
  v_cvt_pk_bf16_f32 v38, v196, v197
  v_cvt_pk_bf16_f32 v39, v198, v199
  ds_write_b64 v11, v[38:39] offset:9856
  v_pk_fma_f32 v[128:129], v[242:243], v[232:233], v[128:129] op_sel_hi:[1,0,1] neg_lo:[0,1,0] neg_hi:[0,1,0]
  v_pk_fma_f32 v[130:131], v[244:245], v[232:233], v[130:131] op_sel_hi:[1,0,1] neg_lo:[0,1,0] neg_hi:[0,1,0]
  v_mfma_f32_16x16x32_bf16 v[168:171], v[68:71], v[96:99], v[168:171]
  v_pk_fma_f32 v[164:165], v[246:247], v[232:233], v[164:165] op_sel_hi:[1,0,1] neg_lo:[0,1,0] neg_hi:[0,1,0]
  v_pk_fma_f32 v[166:167], v[248:249], v[232:233], v[166:167] op_sel_hi:[1,0,1] neg_lo:[0,1,0] neg_hi:[0,1,0]
  v_pk_fma_f32 v[200:201], v[250:251], v[232:233], v[200:201] op_sel_hi:[1,0,1] neg_lo:[0,1,0] neg_hi:[0,1,0]
  v_pk_fma_f32 v[202:203], v[252:253], v[232:233], v[202:203] op_sel_hi:[1,0,1] neg_lo:[0,1,0] neg_hi:[0,1,0]
  v_pk_mul_f32 v[128:129], v[128:129], v[232:233] op_sel:[0,1] op_sel_hi:[1,1]
  v_pk_mul_f32 v[130:131], v[130:131], v[232:233] op_sel:[0,1] op_sel_hi:[1,1]
  v_pk_mul_f32 v[164:165], v[164:165], v[232:233] op_sel:[0,1] op_sel_hi:[1,1]
  v_mfma_f32_16x16x32_bf16 v[132:135], v[64:67], v[96:99], v[132:135]
  v_pk_mul_f32 v[166:167], v[166:167], v[232:233] op_sel:[0,1] op_sel_hi:[1,1]
  v_pk_mul_f32 v[200:201], v[200:201], v[232:233] op_sel:[0,1] op_sel_hi:[1,1]
  v_pk_mul_f32 v[202:203], v[202:203], v[232:233] op_sel:[0,1] op_sel_hi:[1,1]
  v_cvt_pk_bf16_f32 v40, v128, v129
  v_cvt_pk_bf16_f32 v41, v130, v131
  ds_write_b64 v11, v[40:41] offset:12800
  v_cvt_pk_bf16_f32 v42, v164, v165
  v_mfma_f32_16x16x32_bf16 v[136:139], v[64:67], v[100:103], v[136:139]
  v_cvt_pk_bf16_f32 v43, v166, v167
  ds_write_b64 v11, v[42:43] offset:12928
  v_cvt_pk_bf16_f32 v44, v200, v201
  v_cvt_pk_bf16_f32 v45, v202, v203
  ds_write_b64 v11, v[44:45] offset:13056
  v_pk_fma_f32 v[132:133], v[242:243], v[234:235], v[132:133] op_sel_hi:[1,0,1] neg_lo:[0,1,0] neg_hi:[0,1,0]
  v_pk_fma_f32 v[134:135], v[244:245], v[234:235], v[134:135] op_sel_hi:[1,0,1] neg_lo:[0,1,0] neg_hi:[0,1,0]
  v_mfma_f32_16x16x32_bf16 v[172:175], v[68:71], v[100:103], v[172:175]
  v_pk_fma_f32 v[168:169], v[246:247], v[234:235], v[168:169] op_sel_hi:[1,0,1] neg_lo:[0,1,0] neg_hi:[0,1,0]
  v_pk_fma_f32 v[170:171], v[248:249], v[234:235], v[170:171] op_sel_hi:[1,0,1] neg_lo:[0,1,0] neg_hi:[0,1,0]
  v_pk_fma_f32 v[204:205], v[250:251], v[234:235], v[204:205] op_sel_hi:[1,0,1] neg_lo:[0,1,0] neg_hi:[0,1,0]
  v_pk_fma_f32 v[206:207], v[252:253], v[234:235], v[206:207] op_sel_hi:[1,0,1] neg_lo:[0,1,0] neg_hi:[0,1,0]
  v_pk_mul_f32 v[132:133], v[132:133], v[234:235] op_sel:[0,1] op_sel_hi:[1,1]
  v_pk_mul_f32 v[134:135], v[134:135], v[234:235] op_sel:[0,1] op_sel_hi:[1,1]
  v_pk_mul_f32 v[168:169], v[168:169], v[234:235] op_sel:[0,1] op_sel_hi:[1,1]
  v_mfma_f32_16x16x32_bf16 v[208:211], v[72:75], v[100:103], v[208:211]
  v_pk_mul_f32 v[170:171], v[170:171], v[234:235] op_sel:[0,1] op_sel_hi:[1,1]
  v_pk_mul_f32 v[204:205], v[204:205], v[234:235] op_sel:[0,1] op_sel_hi:[1,1]
  v_pk_mul_f32 v[206:207], v[206:207], v[234:235] op_sel:[0,1] op_sel_hi:[1,1]
  v_cvt_pk_bf16_f32 v46, v132, v133
  v_cvt_pk_bf16_f32 v47, v134, v135
  ds_write_b64 v11, v[46:47] offset:16000
  v_cvt_pk_bf16_f32 v48, v168, v169
  v_mfma_f32_16x16x32_bf16 v[212:215], v[72:75], v[104:107], v[212:215]
  v_cvt_pk_bf16_f32 v49, v170, v171
  ds_write_b64 v11, v[48:49] offset:16128
  v_cvt_pk_bf16_f32 v50, v204, v205
  v_cvt_pk_bf16_f32 v51, v206, v207
  ds_write_b64 v11, v[50:51] offset:16256
  v_pk_fma_f32 v[136:137], v[242:243], v[236:237], v[136:137] op_sel_hi:[1,0,1] neg_lo:[0,1,0] neg_hi:[0,1,0]
  v_pk_fma_f32 v[138:139], v[244:245], v[236:237], v[138:139] op_sel_hi:[1,0,1] neg_lo:[0,1,0] neg_hi:[0,1,0]
  v_mfma_f32_16x16x32_bf16 v[176:179], v[68:71], v[104:107], v[176:179]
  v_pk_fma_f32 v[172:173], v[246:247], v[236:237], v[172:173] op_sel_hi:[1,0,1] neg_lo:[0,1,0] neg_hi:[0,1,0]
  v_pk_fma_f32 v[174:175], v[248:249], v[236:237], v[174:175] op_sel_hi:[1,0,1] neg_lo:[0,1,0] neg_hi:[0,1,0]
  v_pk_fma_f32 v[208:209], v[250:251], v[236:237], v[208:209] op_sel_hi:[1,0,1] neg_lo:[0,1,0] neg_hi:[0,1,0]
  v_pk_fma_f32 v[210:211], v[252:253], v[236:237], v[210:211] op_sel_hi:[1,0,1] neg_lo:[0,1,0] neg_hi:[0,1,0]
  v_pk_mul_f32 v[136:137], v[136:137], v[236:237] op_sel:[0,1] op_sel_hi:[1,1]
  v_pk_mul_f32 v[138:139], v[138:139], v[236:237] op_sel:[0,1] op_sel_hi:[1,1]
  v_pk_mul_f32 v[172:173], v[172:173], v[236:237] op_sel:[0,1] op_sel_hi:[1,1]
  v_mfma_f32_16x16x32_bf16 v[140:143], v[64:67], v[104:107], v[140:143]
  v_pk_mul_f32 v[174:175], v[174:175], v[236:237] op_sel:[0,1] op_sel_hi:[1,1]
  v_pk_mul_f32 v[208:209], v[208:209], v[236:237] op_sel:[0,1] op_sel_hi:[1,1]
  v_pk_mul_f32 v[210:211], v[210:211], v[236:237] op_sel:[0,1] op_sel_hi:[1,1]
  v_cvt_pk_bf16_f32 v52, v136, v137
  v_cvt_pk_bf16_f32 v53, v138, v139
  ds_write_b64 v11, v[52:53] offset:19200
  v_cvt_pk_bf16_f32 v54, v172, v173
  v_mfma_f32_16x16x32_bf16 v[144:147], v[64:67], v[108:111], v[144:147]
  v_cvt_pk_bf16_f32 v55, v174, v175
  ds_write_b64 v11, v[54:55] offset:19328
  v_cvt_pk_bf16_f32 v56, v208, v209
  v_cvt_pk_bf16_f32 v57, v210, v211
  ds_write_b64 v11, v[56:57] offset:19456
  v_pk_fma_f32 v[140:141], v[242:243], v[238:239], v[140:141] op_sel_hi:[1,0,1] neg_lo:[0,1,0] neg_hi:[0,1,0]
  v_pk_fma_f32 v[142:143], v[244:245], v[238:239], v[142:143] op_sel_hi:[1,0,1] neg_lo:[0,1,0] neg_hi:[0,1,0]
  v_mfma_f32_16x16x32_bf16 v[180:183], v[68:71], v[108:111], v[180:183]
  v_pk_fma_f32 v[176:177], v[246:247], v[238:239], v[176:177] op_sel_hi:[1,0,1] neg_lo:[0,1,0] neg_hi:[0,1,0]
  v_pk_fma_f32 v[178:179], v[248:249], v[238:239], v[178:179] op_sel_hi:[1,0,1] neg_lo:[0,1,0] neg_hi:[0,1,0]
  v_pk_fma_f32 v[212:213], v[250:251], v[238:239], v[212:213] op_sel_hi:[1,0,1] neg_lo:[0,1,0] neg_hi:[0,1,0]
  v_pk_fma_f32 v[214:215], v[252:253], v[238:239], v[214:215] op_sel_hi:[1,0,1] neg_lo:[0,1,0] neg_hi:[0,1,0]
  v_pk_mul_f32 v[140:141], v[140:141], v[238:239] op_sel:[0,1] op_sel_hi:[1,1]
  v_pk_mul_f32 v[142:143], v[142:143], v[238:239] op_sel:[0,1] op_sel_hi:[1,1]
  v_pk_mul_f32 v[176:177], v[176:177], v[238:239] op_sel:[0,1] op_sel_hi:[1,1]
  v_mfma_f32_16x16x32_bf16 v[216:219], v[72:75], v[108:111], v[216:219]
  v_pk_mul_f32 v[178:179], v[178:179], v[238:239] op_sel:[0,1] op_sel_hi:[1,1]
  v_pk_mul_f32 v[212:213], v[212:213], v[238:239] op_sel:[0,1] op_sel_hi:[1,1]
  v_pk_mul_f32 v[214:215], v[214:215], v[238:239] op_sel:[0,1] op_sel_hi:[1,1]
  v_cvt_pk_bf16_f32 v58, v140, v141
  v_cvt_pk_bf16_f32 v59, v142, v143
  ds_write_b64 v11, v[58:59] offset:22400
  v_cvt_pk_bf16_f32 v60, v176, v177
  s_barrier
  v_cvt_pk_bf16_f32 v61, v178, v179
  ds_write_b64 v11, v[60:61] offset:22528
  v_cvt_pk_bf16_f32 v62, v212, v213
  v_cvt_pk_bf16_f32 v63, v214, v215
  ds_write_b64 v11, v[62:63] offset:22656
  v_pk_fma_f32 v[144:145], v[242:243], v[240:241], v[144:145] op_sel_hi:[1,0,1] neg_lo:[0,1,0] neg_hi:[0,1,0]
  v_pk_fma_f32 v[146:147], v[244:245], v[240:241], v[146:147] op_sel_hi:[1,0,1] neg_lo:[0,1,0] neg_hi:[0,1,0]
  v_pk_fma_f32 v[180:181], v[246:247], v[240:241], v[180:181] op_sel_hi:[1,0,1] neg_lo:[0,1,0] neg_hi:[0,1,0]
  v_pk_fma_f32 v[182:183], v[248:249], v[240:241], v[182:183] op_sel_hi:[1,0,1] neg_lo:[0,1,0] neg_hi:[0,1,0]
  v_pk_fma_f32 v[216:217], v[250:251], v[240:241], v[216:217] op_sel_hi:[1,0,1] neg_lo:[0,1,0] neg_hi:[0,1,0]
  v_pk_fma_f32 v[218:219], v[252:253], v[240:241], v[218:219] op_sel_hi:[1,0,1] neg_lo:[0,1,0] neg_hi:[0,1,0]
  v_pk_mul_f32 v[144:145], v[144:145], v[240:241] op_sel:[0,1] op_sel_hi:[1,1]
  v_pk_mul_f32 v[146:147], v[146:147], v[240:241] op_sel:[0,1] op_sel_hi:[1,1]
  v_pk_mul_f32 v[180:181], v[180:181], v[240:241] op_sel:[0,1] op_sel_hi:[1,1]
  v_pk_mul_f32 v[182:183], v[182:183], v[240:241] op_sel:[0,1] op_sel_hi:[1,1]
  v_pk_mul_f32 v[216:217], v[216:217], v[240:241] op_sel:[0,1] op_sel_hi:[1,1]
  v_pk_mul_f32 v[218:219], v[218:219], v[240:241] op_sel:[0,1] op_sel_hi:[1,1]
  v_cvt_pk_bf16_f32 v16, v144, v145
  v_cvt_pk_bf16_f32 v17, v146, v147
  ds_write_b64 v11, v[16:17] offset:25600
  v_cvt_pk_bf16_f32 v18, v180, v181
  v_cvt_pk_bf16_f32 v19, v182, v183
  ds_write_b64 v11, v[18:19] offset:25728
  v_cvt_pk_bf16_f32 v20, v216, v217
  v_cvt_pk_bf16_f32 v21, v218, v219
  ds_write_b64 v11, v[20:21] offset:25856
attn:
  s_nop 7
  s_nop 7
  v_mov_b32 v18, 0x3e8293ee
  v_mov_b32 v19, 0xff800000
  s_mov_b32 s20, s82
  s_mov_b32 s21, s83
  s_mov_b32 s22, 4194304
  s_mov_b32 s23, 0x20000
  s_waitcnt lgkmcnt(0)
  s_barrier
  ds_read_b128 v[32:35], v223 offset:0
  ds_read_b128 v[36:39], v220 offset:0
  ds_read_b128 v[40:43], v221 offset:0
  ds_read_b128 v[80:83], v223 offset:64
  ds_read_b128 v[84:87], v220 offset:64
  ds_read_b128 v[88:91], v221 offset:64
  ds_read_b64_tr_b16 v[44:45], v222 offset:0
  ds_read_b64_tr_b16 v[46:47], v254 offset:0
  ds_read_b64_tr_b16 v[48:49], v222 offset:8
  ds_read_b64_tr_b16 v[50:51], v254 offset:8
  ds_read_b64_tr_b16 v[92:93], v222 offset:64
  ds_read_b64_tr_b16 v[94:95], v254 offset:64
  ds_read_b64_tr_b16 v[96:97], v222 offset:72
  ds_read_b64_tr_b16 v[98:99], v254 offset:72
  s_waitcnt lgkmcnt(11)
  v_mfma_f32_16x16x32_bf16 v[52:55], v[36:39], v[32:35], 0
  v_mfma_f32_16x16x32_bf16 v[56:59], v[40:43], v[32:35], 0
  s_waitcnt lgkmcnt(8)
  v_mfma_f32_16x16x32_bf16 v[100:103], v[84:87], v[80:83], 0
  v_mfma_f32_16x16x32_bf16 v[104:107], v[88:91], v[80:83], 0
  s_nop 3
  v_cndmask_b32 v52, v19, v52, s[86:87]
  s_nop 1
  v_cndmask_b32 v100, v19, v100, s[86:87]
  v_cndmask_b32 v53, v19, v53, s[88:89]
  v_cndmask_b32 v101, v19, v101, s[88:89]
  v_cndmask_b32 v54, v19, v54, s[90:91]
  v_cndmask_b32 v102, v19, v102, s[90:91]
  v_cndmask_b32 v55, v19, v55, s[92:93]
  v_cndmask_b32 v103, v19, v103, s[92:93]
  v_cndmask_b32 v56, v19, v56, s[94:95]
  v_cndmask_b32 v104, v19, v104, s[94:95]
  v_cndmask_b32 v57, v19, v57, s[96:97]
  v_cndmask_b32 v105, v19, v105, s[96:97]
  v_cndmask_b32 v58, v19, v58, s[98:99]
  v_cndmask_b32 v106, v19, v106, s[98:99]
  v_cndmask_b32 v59, v19, v59, s[100:101]
  v_cndmask_b32 v107, v19, v107, s[100:101]
  v_max3_f32 v60, v52, v53, v54
  v_max3_f32 v108, v100, v101, v102
  v_max3_f32 v61, v55, v56, v57
  v_max3_f32 v109, v103, v104, v105
  v_max3_f32 v60, v60, v58, v59
  v_max3_f32 v108, v108, v106, v107
  v_max_f32 v60, v60, v61
  v_max_f32 v108, v108, v109
  v_mov_b32 v61, v60
  v_mov_b32 v109, v108
  s_nop 0
  v_permlane16_swap_b32 v60, v61
  v_permlane16_swap_b32 v108, v109
  v_max_f32 v60, v60, v61
  v_max_f32 v108, v108, v109
  v_mov_b32 v61, v60
  v_mov_b32 v109, v108
  s_nop 0
  v_permlane32_swap_b32 v60, v61
  v_permlane32_swap_b32 v108, v109
  v_max_f32 v60, v60, v61
  v_max_f32 v108, v108, v109
  v_mul_f32 v60, v18, v60
  v_mul_f32 v108, v18, v108
  v_fma_f32 v52, v52, v18, -v60
  v_fma_f32 v100, v100, v18, -v108
  v_fma_f32 v53, v53, v18, -v60
  v_fma_f32 v101, v101, v18, -v108
  v_fma_f32 v54, v54, v18, -v60
  v_fma_f32 v102, v102, v18, -v108
  v_fma_f32 v55, v55, v18, -v60
  v_fma_f32 v103, v103, v18, -v108
  v_fma_f32 v56, v56, v18, -v60
  v_fma_f32 v104, v104, v18, -v108
  v_fma_f32 v57, v57, v18, -v60
  v_fma_f32 v105, v105, v18, -v108
  v_fma_f32 v58, v58, v18, -v60
  v_fma_f32 v106, v106, v18, -v108
  v_fma_f32 v59, v59, v18, -v60
  v_fma_f32 v107, v107, v18, -v108
  v_exp_f32 v52, v52
  v_exp_f32 v100, v100
  v_exp_f32 v53, v53
  v_exp_f32 v101, v101
  v_exp_f32 v54, v54
  v_exp_f32 v102, v102
  v_exp_f32 v55, v55
  v_exp_f32 v103, v103
  v_exp_f32 v56, v56
  v_exp_f32 v104, v104
  v_exp_f32 v57, v57
  v_exp_f32 v105, v105
  v_exp_f32 v58, v58
  v_exp_f32 v106, v106
  v_exp_f32 v59, v59
  v_exp_f32 v107, v107
  v_pk_add_f32 v[60:61], v[52:53], v[54:55]
  v_pk_add_f32 v[108:109], v[100:101], v[102:103]
  v_pk_add_f32 v[62:63], v[56:57], v[58:59]
  v_pk_add_f32 v[110:111], v[104:105], v[106:107]
  v_pk_add_f32 v[60:61], v[60:61], v[62:63]
  v_pk_add_f32 v[108:109], v[108:109], v[110:111]
  v_add_f32 v60, v60, v61
  v_add_f32 v108, v108, v109
  v_mov_b32 v61, v60
  v_mov_b32 v109, v108
  s_nop 0
  v_permlane16_swap_b32 v60, v61
  v_permlane16_swap_b32 v108, v109
  v_add_f32 v60, v60, v61
  v_add_f32 v108, v108, v109
  v_mov_b32 v61, v60
  v_mov_b32 v109, v108
  s_nop 0
  v_permlane32_swap_b32 v60, v61
  v_permlane32_swap_b32 v108, v109
  v_add_f32 v60, v60, v61
  v_add_f32 v108, v108, v109
  v_rcp_f32 v60, v60
  v_rcp_f32 v108, v108
  v_pk_mul_f32 v[52:53], v[52:53], v[60:61] op_sel_hi:[1,0]
  v_pk_mul_f32 v[100:101], v[100:101], v[108:109] op_sel_hi:[1,0]
  v_pk_mul_f32 v[54:55], v[54:55], v[60:61] op_sel_hi:[1,0]
  v_pk_mul_f32 v[102:103], v[102:103], v[108:109] op_sel_hi:[1,0]
  v_pk_mul_f32 v[56:57], v[56:57], v[60:61] op_sel_hi:[1,0]
  v_pk_mul_f32 v[104:105], v[104:105], v[108:109] op_sel_hi:[1,0]
  v_pk_mul_f32 v[58:59], v[58:59], v[60:61] op_sel_hi:[1,0]
  v_pk_mul_f32 v[106:107], v[106:107], v[108:109] op_sel_hi:[1,0]
  v_cvt_pk_bf16_f32 v64, v52, v53
  v_cvt_pk_bf16_f32 v112, v100, v101
  v_cvt_pk_bf16_f32 v65, v54, v55
  v_cvt_pk_bf16_f32 v113, v102, v103
  v_cvt_pk_bf16_f32 v66, v56, v57
  v_cvt_pk_bf16_f32 v114, v104, v105
  v_cvt_pk_bf16_f32 v67, v58, v59
  v_cvt_pk_bf16_f32 v115, v106, v107
  s_waitcnt lgkmcnt(0)
  v_mfma_f32_16x16x32_bf16 v[68:71], v[44:47], v[64:67], 0
  v_mfma_f32_16x16x32_bf16 v[116:119], v[92:95], v[112:115], 0
  v_mfma_f32_16x16x32_bf16 v[72:75], v[48:51], v[64:67], 0
  v_mfma_f32_16x16x32_bf16 v[120:123], v[96:99], v[112:115], 0
  s_nop 4
  v_cvt_pk_bf16_f32 v32, v68, v69
  v_cvt_pk_bf16_f32 v80, v116, v117
  v_cvt_pk_bf16_f32 v33, v70, v71
  v_cvt_pk_bf16_f32 v81, v118, v119
  v_cvt_pk_bf16_f32 v34, v72, v73
  v_cvt_pk_bf16_f32 v82, v120, v121
  v_cvt_pk_bf16_f32 v35, v74, v75
  v_cvt_pk_bf16_f32 v83, v122, v123
  buffer_store_dwordx4 v[32:35], v1, s[20:23], 0 offen offset:0 sc0 sc1
  buffer_store_dwordx4 v[80:83], v1, s[20:23], 0 offen offset:2048 sc0 sc1
  s_cmp_ge_u32 s4, 4
  s_cbranch_scc1 L_k1done
  s_lshl_b32 s32, s28, 2
  s_add_u32 s32, s32, s4
  s_lshl_b32 s34, s32, 16
  s_lshl_b32 s40, s32, 5
  v_lshlrev_b32 v13, 1, v4
  v_add_u32 v13, s40, v13
  v_lshlrev_b32 v12, 11, v13
  v_lshl_add_u32 v12, v3, 4, v12
  s_lshl_b32 s32, s29, 7
  v_add_u32 v12, s32, v12
  v_lshlrev_b32 v14, 4, v0
  s_mov_b32 s8, s82
  s_mov_b32 s9, s83
  s_mov_b32 s10, 4194304
  s_mov_b32 s11, 0x20000
  s_cmp_eq_u32 s3, 0
  s_cselect_b32 s16, s64, s84
  s_cselect_b32 s17, s65, s85
  s_cselect_b32 s18, 0, 25165824
  s_add_u32 s16, s16, s18
  s_addc_u32 s17, s17, 0
  s_mov_b32 s18, 4194304
  s_mov_b32 s19, 0x20000
  s_cmp_eq_u32 s3, 0
  s_cselect_b32 s12, s84, s84
  s_cselect_b32 s13, s85, s85
  s_cselect_b32 s14, 0, 33554432
  s_add_u32 s12, s12, s14
  s_addc_u32 s13, s13, 0
  s_mov_b32 s14, 0
  s_mov_b32 s15, 0x20000
  s_add_u32 s12, s12, 20971520
  s_addc_u32 s13, s13, 0
  s_mov_b32 s14, 262144
  v_lshl_add_u32 v16, v5, 3, v6
  v_lshlrev_b32 v16, 7, v16
  v_lshl_add_u32 v16, v7, 3, v16
  v_lshrrev_b32 v17, 1, v6
  v_lshl_or_b32 v17, v2, 1, v17
  v_lshl_add_u32 v16, v17, 5, v16
  v_add_u32 v16, 131072, v16
  v_xor_b32 v8, 0, v16
  v_xor_b32 v9, 32, v16
  v_xor_b32 v10, 64, v16
  v_xor_b32 v11, 96, v16
  v_add_u32 v16, v13, v2
  v_lshlrev_b32 v16, 3, v16
  s_lshl_b32 s32, s29, 14
  v_add_u32 v112, s32, v16
  v_lshrrev_b32 v17, 5, v0
  v_lshlrev_b32 v17, 17, v17
  v_add_u32 v113, v16, v17
  s_lshl_b32 s32, s4, 12
  v_lshlrev_b32 v16, 8, v4
  v_lshl_add_u32 v16, v5, 3, v16
  v_add_u32 v16, s32, v16
  v_and_b32 v17, 1, v4
  v_bfe_u32 v18, v4, 2, 1
  v_lshl_or_b32 v17, v18, 1, v17
  v_lshl_add_u32 v114, v17, 5, v16
  s_lshl_b32 s44, s29, 8
  s_lshl_b32 s40, s28, 2
  s_add_u32 s44, s44, s40
  s_add_u32 s44, s44, s4
  s_lshl_b32 s44, s44, 10
  v_lshl_add_u32 v16, v5, 3, v6
  v_lshlrev_b32 v16, 7, v16
  v_lshl_add_u32 v16, v7, 3, v16
  v_lshrrev_b32 v17, 1, v6
  v_lshl_or_b32 v17, v2, 1, v17
  v_lshl_add_u32 v16, v17, 5, v16
  v_xor_b32 v115, 0, v16
  v_add_u32 v115, s32, v115
  s_add_u32 s45, s44, 65536
  s_add_u32 s46, s44, 131072
  s_add_u32 s47, s44, 196608
  v_add_u32 v184, 16384, v113
  v_add_u32 v185, 32768, v113
  v_add_u32 v186, 49152, v113
  v_add_u32 v187, 65536, v113
  v_add_u32 v188, 81920, v113
  v_add_u32 v189, 98304, v113
  v_add_u32 v190, 114688, v113
  s_lshl_b32 s48, 0x303, s7
  s_lshr_b32 s48, s48, 8
  s_mov_b32 s49, s34
  s_add_u32 s50, s34, 32768
  s_add_u32 s41, s34, 65536
  s_add_u32 s24, s84, 29360128
  s_addc_u32 s25, s85, 0
  s_mov_b32 s26, 262144
  s_mov_b32 s27, 0x20000
  s_lshl_b32 s32, s28, 4
  v_min_u32 v119, 15, v0
  v_add_u32 v119, s32, v119
  v_max_i32 v119, 0, v119
  v_lshlrev_b32 v119, 7, v119
  s_lshl_b32 s55, s3, 17
  s_add_u32 s55, s55, 0
  s_waitcnt vmcnt(0)
  s_barrier
  buffer_load_dwordx4 v[96:99], v12, s[16:19], 0 offen offset:0 sc1
  buffer_load_dwordx4 v[100:103], v12, s[16:19], 0 offen offset:64 sc1
  buffer_load_dwordx4 v[104:107], v12, s[16:19], 0 offen offset:2048 sc1
  buffer_load_dwordx4 v[108:111], v12, s[16:19], 0 offen offset:2112 sc1
  s_mov_b32 s39, 0
  s_and_b32 s32, s4, 3
  s_cmp_lg_u32 s32, 0
  s_cbranch_scc1 poll2d
  s_sleep 8
poll2:
  buffer_load_dword v16, v119, s[24:27], s55 offen sc0 sc1
  s_waitcnt vmcnt(0)
  v_cmp_eq_u32 vcc, 0, v16
  s_add_u32 s39, s39, 1
  s_cmp_gt_u32 s39, 1000000
  s_cbranch_scc1 poll2d
  s_cbranch_vccnz poll2
poll2d:
  s_barrier
  s_bitcmp1_b32 s48, 0
  s_cselect_b32 s36, s50, s49
  s_add_u32 s36, s36, 0
  buffer_load_dwordx4 v[120:123], v14, s[8:11], s36 offen offset:0 sc1
  buffer_load_dwordx4 v[124:127], v14, s[8:11], s36 offen offset:1024 sc1
  buffer_load_dwordx4 v[128:131], v14, s[8:11], s36 offen offset:2048 sc1
  buffer_load_dwordx4 v[132:135], v14, s[8:11], s36 offen offset:3072 sc1
  s_bitcmp1_b32 s48, 1
  s_cselect_b32 s36, s50, s49
  s_add_u32 s36, s36, 4096
  buffer_load_dwordx4 v[136:139], v14, s[8:11], s36 offen offset:0 sc1
  buffer_load_dwordx4 v[140:143], v14, s[8:11], s36 offen offset:1024 sc1
  buffer_load_dwordx4 v[144:147], v14, s[8:11], s36 offen offset:2048 sc1
  buffer_load_dwordx4 v[148:151], v14, s[8:11], s36 offen offset:3072 sc1
  s_bitcmp1_b32 s48, 2
  s_cselect_b32 s36, s50, s49
  s_add_u32 s36, s36, 8192
  buffer_load_dwordx4 v[152:155], v14, s[8:11], s36 offen offset:0 sc1
  buffer_load_dwordx4 v[156:159], v14, s[8:11], s36 offen offset:1024 sc1
  buffer_load_dwordx4 v[160:163], v14, s[8:11], s36 offen offset:2048 sc1
  buffer_load_dwordx4 v[164:167], v14, s[8:11], s36 offen offset:3072 sc1
  s_bitcmp1_b32 s48, 3
  s_cselect_b32 s36, s50, s49
  s_add_u32 s36, s36, 12288
  buffer_load_dwordx4 v[168:171], v14, s[8:11], s36 offen offset:0 sc1
  buffer_load_dwordx4 v[172:175], v14, s[8:11], s36 offen offset:1024 sc1
  s_waitcnt vmcnt(14)
  v_permlane16_swap_b32 v96, v98
  v_permlane16_swap_b32 v97, v99
  v_permlane16_swap_b32 v100, v102
  v_permlane16_swap_b32 v101, v103
  v_permlane16_swap_b32 v104, v106
  v_permlane16_swap_b32 v105, v107
  v_permlane16_swap_b32 v108, v110
  v_permlane16_swap_b32 v109, v111
  v_lshlrev_b32 v48, 16, v96
  v_and_b32 v49, 0xffff0000, v96
  v_lshlrev_b32 v50, 16, v97
  v_and_b32 v51, 0xffff0000, v97
  v_lshlrev_b32 v52, 16, v98
  v_and_b32 v53, 0xffff0000, v98
  v_lshlrev_b32 v54, 16, v99
  v_and_b32 v55, 0xffff0000, v99
  v_lshlrev_b32 v56, 16, v100
  v_and_b32 v57, 0xffff0000, v100
  v_lshlrev_b32 v58, 16, v101
  v_and_b32 v59, 0xffff0000, v101
  v_lshlrev_b32 v60, 16, v102
  v_and_b32 v61, 0xffff0000, v102
  v_lshlrev_b32 v62, 16, v103
  v_and_b32 v63, 0xffff0000, v103
  v_lshlrev_b32 v64, 16, v104
  v_and_b32 v65, 0xffff0000, v104
  v_lshlrev_b32 v66, 16, v105
  v_and_b32 v67, 0xffff0000, v105
  v_lshlrev_b32 v68, 16, v106
  v_and_b32 v69, 0xffff0000, v106
  v_lshlrev_b32 v70, 16, v107
  v_and_b32 v71, 0xffff0000, v107
  v_lshlrev_b32 v72, 16, v108
  v_and_b32 v73, 0xffff0000, v108
  v_lshlrev_b32 v74, 16, v109
  v_and_b32 v75, 0xffff0000, v109
  v_lshlrev_b32 v76, 16, v110
  v_and_b32 v77, 0xffff0000, v110
  v_lshlrev_b32 v78, 16, v111
  v_and_b32 v79, 0xffff0000, v111
  s_mov_b32 s43, 0
  s_mov_b32 s39, 1
  s_barrier
  ds_read_b64_tr_b16 v[16:17], v8 offset:0
  ds_read_b64_tr_b16 v[18:19], v8 offset:512
  ds_read_b64_tr_b16 v[20:21], v9 offset:0
  ds_read_b64_tr_b16 v[22:23], v9 offset:512
  ds_read_b64_tr_b16 v[24:25], v10 offset:0
  ds_read_b64_tr_b16 v[26:27], v10 offset:512
  ds_read_b64_tr_b16 v[28:29], v11 offset:0
  ds_read_b64_tr_b16 v[30:31], v11 offset:512
  s_waitcnt vmcnt(13) lgkmcnt(6)
  v_mfma_f32_16x16x32_bf16 v[48:51], v[16:19], v[120:123], v[48:51]
  ds_read_b64_tr_b16 v[32:33], v8 offset:4096
  s_waitcnt vmcnt(12)
  v_mfma_f32_16x16x32_bf16 v[64:67], v[16:19], v[124:127], v[64:67]
  ds_read_b64_tr_b16 v[34:35], v8 offset:4608
  v_add_u32 v8, 8192, v8
  s_waitcnt lgkmcnt(6)
  v_mfma_f32_16x16x32_bf16 v[68:71], v[20:23], v[124:127], v[68:71]
  ds_read_b64_tr_b16 v[36:37], v9 offset:4096
  buffer_load_dwordx4 v[176:179], v14, s[8:11], s36 offen offset:2048 sc1
  v_mfma_f32_16x16x32_bf16 v[52:55], v[20:23], v[120:123], v[52:55]
  ds_read_b64_tr_b16 v[38:39], v9 offset:4608
  v_add_u32 v9, 8192, v9
  s_waitcnt lgkmcnt(6)
  v_mfma_f32_16x16x32_bf16 v[56:59], v[24:27], v[120:123], v[56:59]
  ds_read_b64_tr_b16 v[40:41], v10 offset:4096
  v_mfma_f32_16x16x32_bf16 v[72:75], v[24:27], v[124:127], v[72:75]
  ds_read_b64_tr_b16 v[42:43], v10 offset:4608
  v_add_u32 v10, 8192, v10
  s_waitcnt lgkmcnt(6)
  v_mfma_f32_16x16x32_bf16 v[76:79], v[28:31], v[124:127], v[76:79]
  ds_read_b64_tr_b16 v[44:45], v11 offset:4096
  buffer_load_dwordx4 v[180:183], v14, s[8:11], s36 offen offset:3072 sc1
  v_mfma_f32_16x16x32_bf16 v[60:63], v[28:31], v[120:123], v[60:63]
  ds_read_b64_tr_b16 v[46:47], v11 offset:4608
  v_add_u32 v11, 8192, v11
  s_waitcnt vmcnt(13) lgkmcnt(6)
  v_mfma_f32_16x16x32_bf16 v[48:51], v[32:35], v[128:131], v[48:51]
  ds_read_b64_tr_b16 v[16:17], v8 offset:0
  s_bitcmp1_b32 s48, 4
  s_cselect_b32 s36, s50, s49
  s_waitcnt vmcnt(12)
  v_mfma_f32_16x16x32_bf16 v[64:67], v[32:35], v[132:135], v[64:67]
  ds_read_b64_tr_b16 v[18:19], v8 offset:512
  s_add_u32 s36, s36, 16384
  s_waitcnt lgkmcnt(6)
  v_mfma_f32_16x16x32_bf16 v[68:71], v[36:39], v[132:135], v[68:71]
  ds_read_b64_tr_b16 v[20:21], v9 offset:0
  v_mfma_f32_16x16x32_bf16 v[52:55], v[36:39], v[128:131], v[52:55]
  ds_read_b64_tr_b16 v[22:23], v9 offset:512
  s_waitcnt lgkmcnt(6)
  v_mfma_f32_16x16x32_bf16 v[56:59], v[40:43], v[128:131], v[56:59]
  ds_read_b64_tr_b16 v[24:25], v10 offset:0
  buffer_load_dwordx4 v[120:123], v14, s[8:11], s36 offen offset:0 sc1
  v_mfma_f32_16x16x32_bf16 v[72:75], v[40:43], v[132:135], v[72:75]
  ds_read_b64_tr_b16 v[26:27], v10 offset:512
  s_waitcnt lgkmcnt(6)
  v_mfma_f32_16x16x32_bf16 v[76:79], v[44:47], v[132:135], v[76:79]
  ds_read_b64_tr_b16 v[28:29], v11 offset:0
  v_mfma_f32_16x16x32_bf16 v[60:63], v[44:47], v[128:131], v[60:63]
  ds_read_b64_tr_b16 v[30:31], v11 offset:512
  buffer_load_dwordx4 v[124:127], v14, s[8:11], s36 offen offset:1024 sc1
  s_waitcnt vmcnt(13) lgkmcnt(6)
  v_mfma_f32_16x16x32_bf16 v[48:51], v[16:19], v[136:139], v[48:51]
  ds_read_b64_tr_b16 v[32:33], v8 offset:4096
  s_waitcnt vmcnt(12)
  v_mfma_f32_16x16x32_bf16 v[64:67], v[16:19], v[140:143], v[64:67]
  ds_read_b64_tr_b16 v[34:35], v8 offset:4608
  v_add_u32 v8, 8192, v8
  s_waitcnt lgkmcnt(6)
  v_mfma_f32_16x16x32_bf16 v[68:71], v[20:23], v[140:143], v[68:71]
  ds_read_b64_tr_b16 v[36:37], v9 offset:4096
  buffer_load_dwordx4 v[128:131], v14, s[8:11], s36 offen offset:2048 sc1
  v_mfma_f32_16x16x32_bf16 v[52:55], v[20:23], v[136:139], v[52:55]
  ds_read_b64_tr_b16 v[38:39], v9 offset:4608
  v_add_u32 v9, 8192, v9
  s_waitcnt lgkmcnt(6)
  v_mfma_f32_16x16x32_bf16 v[56:59], v[24:27], v[136:139], v[56:59]
  ds_read_b64_tr_b16 v[40:41], v10 offset:4096
  v_mfma_f32_16x16x32_bf16 v[72:75], v[24:27], v[140:143], v[72:75]
  ds_read_b64_tr_b16 v[42:43], v10 offset:4608
  v_add_u32 v10, 8192, v10
  s_waitcnt lgkmcnt(6)
  v_mfma_f32_16x16x32_bf16 v[76:79], v[28:31], v[140:143], v[76:79]
  ds_read_b64_tr_b16 v[44:45], v11 offset:4096
  buffer_load_dwordx4 v[132:135], v14, s[8:11], s36 offen offset:3072 sc1
  v_mfma_f32_16x16x32_bf16 v[60:63], v[28:31], v[136:139], v[60:63]
  ds_read_b64_tr_b16 v[46:47], v11 offset:4608
  v_add_u32 v11, 8192, v11
  s_waitcnt vmcnt(13) lgkmcnt(6)
  v_mfma_f32_16x16x32_bf16 v[48:51], v[32:35], v[144:147], v[48:51]
  ds_read_b64_tr_b16 v[16:17], v8 offset:0
  s_bitcmp1_b32 s48, 5
  s_cselect_b32 s36, s50, s49
  s_waitcnt vmcnt(12)
  v_mfma_f32_16x16x32_bf16 v[64:67], v[32:35], v[148:151], v[64:67]
  ds_read_b64_tr_b16 v[18:19], v8 offset:512
  s_add_u32 s36, s36, 20480
  s_waitcnt lgkmcnt(6)
  v_mfma_f32_16x16x32_bf16 v[68:71], v[36:39], v[148:151], v[68:71]
  ds_read_b64_tr_b16 v[20:21], v9 offset:0
  v_mfma_f32_16x16x32_bf16 v[52:55], v[36:39], v[144:147], v[52:55]
  ds_read_b64_tr_b16 v[22:23], v9 offset:512
  s_waitcnt lgkmcnt(6)
  v_mfma_f32_16x16x32_bf16 v[56:59], v[40:43], v[144:147], v[56:59]
  ds_read_b64_tr_b16 v[24:25], v10 offset:0
  buffer_load_dwordx4 v[136:139], v14, s[8:11], s36 offen offset:0 sc1
  v_mfma_f32_16x16x32_bf16 v[72:75], v[40:43], v[148:151], v[72:75]
  ds_read_b64_tr_b16 v[26:27], v10 offset:512
  s_waitcnt lgkmcnt(6)
  v_mfma_f32_16x16x32_bf16 v[76:79], v[44:47], v[148:151], v[76:79]
  ds_read_b64_tr_b16 v[28:29], v11 offset:0
  v_mfma_f32_16x16x32_bf16 v[60:63], v[44:47], v[144:147], v[60:63]
  ds_read_b64_tr_b16 v[30:31], v11 offset:512
  buffer_load_dwordx4 v[140:143], v14, s[8:11], s36 offen offset:1024 sc1
  s_waitcnt vmcnt(13) lgkmcnt(6)
  v_mfma_f32_16x16x32_bf16 v[48:51], v[16:19], v[152:155], v[48:51]
  ds_read_b64_tr_b16 v[32:33], v8 offset:4096
  s_waitcnt vmcnt(12)
  v_mfma_f32_16x16x32_bf16 v[64:67], v[16:19], v[156:159], v[64:67]
  ds_read_b64_tr_b16 v[34:35], v8 offset:4608
  v_add_u32 v8, 8192, v8
  s_waitcnt lgkmcnt(6)
  v_mfma_f32_16x16x32_bf16 v[68:71], v[20:23], v[156:159], v[68:71]
  ds_read_b64_tr_b16 v[36:37], v9 offset:4096
  buffer_load_dwordx4 v[144:147], v14, s[8:11], s36 offen offset:2048 sc1
  v_mfma_f32_16x16x32_bf16 v[52:55], v[20:23], v[152:155], v[52:55]
  ds_read_b64_tr_b16 v[38:39], v9 offset:4608
  v_add_u32 v9, 8192, v9
  s_waitcnt lgkmcnt(6)
  v_mfma_f32_16x16x32_bf16 v[56:59], v[24:27], v[152:155], v[56:59]
  ds_read_b64_tr_b16 v[40:41], v10 offset:4096
  v_mfma_f32_16x16x32_bf16 v[72:75], v[24:27], v[156:159], v[72:75]
  ds_read_b64_tr_b16 v[42:43], v10 offset:4608
  v_add_u32 v10, 8192, v10
  s_waitcnt lgkmcnt(6)
  v_mfma_f32_16x16x32_bf16 v[76:79], v[28:31], v[156:159], v[76:79]
  ds_read_b64_tr_b16 v[44:45], v11 offset:4096
  buffer_load_dwordx4 v[148:151], v14, s[8:11], s36 offen offset:3072 sc1
  v_mfma_f32_16x16x32_bf16 v[60:63], v[28:31], v[152:155], v[60:63]
  ds_read_b64_tr_b16 v[46:47], v11 offset:4608
  v_add_u32 v11, 8192, v11
  s_waitcnt vmcnt(13) lgkmcnt(6)
  v_mfma_f32_16x16x32_bf16 v[48:51], v[32:35], v[160:163], v[48:51]
  ds_read_b64_tr_b16 v[16:17], v8 offset:0
  s_bitcmp1_b32 s48, 6
  s_cselect_b32 s36, s50, s49
  s_waitcnt vmcnt(12)
  v_mfma_f32_16x16x32_bf16 v[64:67], v[32:35], v[164:167], v[64:67]
  ds_read_b64_tr_b16 v[18:19], v8 offset:512
  s_add_u32 s36, s36, 24576
  s_waitcnt lgkmcnt(6)
  v_mfma_f32_16x16x32_bf16 v[68:71], v[36:39], v[164:167], v[68:71]
  ds_read_b64_tr_b16 v[20:21], v9 offset:0
  v_mfma_f32_16x16x32_bf16 v[52:55], v[36:39], v[160:163], v[52:55]
  ds_read_b64_tr_b16 v[22:23], v9 offset:512
  s_waitcnt lgkmcnt(6)
  v_mfma_f32_16x16x32_bf16 v[56:59], v[40:43], v[160:163], v[56:59]
  ds_read_b64_tr_b16 v[24:25], v10 offset:0
  buffer_load_dwordx4 v[152:155], v14, s[8:11], s36 offen offset:0 sc1
  v_mfma_f32_16x16x32_bf16 v[72:75], v[40:43], v[164:167], v[72:75]
  ds_read_b64_tr_b16 v[26:27], v10 offset:512
  s_waitcnt lgkmcnt(6)
  v_mfma_f32_16x16x32_bf16 v[76:79], v[44:47], v[164:167], v[76:79]
  ds_read_b64_tr_b16 v[28:29], v11 offset:0
  v_mfma_f32_16x16x32_bf16 v[60:63], v[44:47], v[160:163], v[60:63]
  ds_read_b64_tr_b16 v[30:31], v11 offset:512
  buffer_load_dwordx4 v[156:159], v14, s[8:11], s36 offen offset:1024 sc1
  s_waitcnt vmcnt(13) lgkmcnt(6)
  v_mfma_f32_16x16x32_bf16 v[48:51], v[16:19], v[168:171], v[48:51]
  ds_read_b64_tr_b16 v[32:33], v8 offset:4096
  s_waitcnt vmcnt(12)
  v_mfma_f32_16x16x32_bf16 v[64:67], v[16:19], v[172:175], v[64:67]
  ds_read_b64_tr_b16 v[34:35], v8 offset:4608
  v_add_u32 v8, 4294912256, v8
  s_waitcnt lgkmcnt(6)
  v_mfma_f32_16x16x32_bf16 v[68:71], v[20:23], v[172:175], v[68:71]
  ds_read_b64_tr_b16 v[36:37], v9 offset:4096
  buffer_load_dwordx4 v[160:163], v14, s[8:11], s36 offen offset:2048 sc1
  v_mfma_f32_16x16x32_bf16 v[52:55], v[20:23], v[168:171], v[52:55]
  ds_read_b64_tr_b16 v[38:39], v9 offset:4608
  v_add_u32 v9, 4294912256, v9
  s_waitcnt lgkmcnt(6)
  v_mfma_f32_16x16x32_bf16 v[56:59], v[24:27], v[168:171], v[56:59]
  ds_read_b64_tr_b16 v[40:41], v10 offset:4096
  v_mfma_f32_16x16x32_bf16 v[72:75], v[24:27], v[172:175], v[72:75]
  ds_read_b64_tr_b16 v[42:43], v10 offset:4608
  v_add_u32 v10, 4294912256, v10
  s_waitcnt lgkmcnt(6)
  v_mfma_f32_16x16x32_bf16 v[76:79], v[28:31], v[172:175], v[76:79]
  ds_read_b64_tr_b16 v[44:45], v11 offset:4096
  buffer_load_dwordx4 v[164:167], v14, s[8:11], s36 offen offset:3072 sc1
  v_mfma_f32_16x16x32_bf16 v[60:63], v[28:31], v[168:171], v[60:63]
  ds_read_b64_tr_b16 v[46:47], v11 offset:4608
  v_add_u32 v11, 4294912256, v11
  s_waitcnt vmcnt(13) lgkmcnt(6)
  v_mfma_f32_16x16x32_bf16 v[48:51], v[32:35], v[176:179], v[48:51]
  ds_read_b64_tr_b16 v[16:17], v8 offset:0
  s_bitcmp1_b32 s48, 7
  s_cselect_b32 s36, s50, s49
  s_waitcnt vmcnt(12)
  v_mfma_f32_16x16x32_bf16 v[64:67], v[32:35], v[180:183], v[64:67]
  ds_read_b64_tr_b16 v[18:19], v8 offset:512
  s_add_u32 s36, s36, 28672
  s_waitcnt lgkmcnt(6)
  v_mfma_f32_16x16x32_bf16 v[68:71], v[36:39], v[180:183], v[68:71]
  ds_read_b64_tr_b16 v[20:21], v9 offset:0
  v_mfma_f32_16x16x32_bf16 v[52:55], v[36:39], v[176:179], v[52:55]
  ds_read_b64_tr_b16 v[22:23], v9 offset:512
  s_waitcnt lgkmcnt(6)
  v_mfma_f32_16x16x32_bf16 v[56:59], v[40:43], v[176:179], v[56:59]
  ds_read_b64_tr_b16 v[24:25], v10 offset:0
  buffer_load_dwordx4 v[168:171], v14, s[8:11], s36 offen offset:0 sc1
  v_mfma_f32_16x16x32_bf16 v[72:75], v[40:43], v[180:183], v[72:75]
  ds_read_b64_tr_b16 v[26:27], v10 offset:512
  s_waitcnt lgkmcnt(6)
  v_mfma_f32_16x16x32_bf16 v[76:79], v[44:47], v[180:183], v[76:79]
  ds_read_b64_tr_b16 v[28:29], v11 offset:0
  v_mfma_f32_16x16x32_bf16 v[60:63], v[44:47], v[176:179], v[60:63]
  ds_read_b64_tr_b16 v[30:31], v11 offset:512
  buffer_load_dwordx4 v[172:175], v14, s[8:11], s36 offen offset:1024 sc1
  s_waitcnt vmcnt(13) lgkmcnt(6)
  v_mfma_f32_16x16x32_bf16 v[48:51], v[16:19], v[120:123], v[48:51]
  ds_read_b64_tr_b16 v[32:33], v8 offset:4096
  s_waitcnt vmcnt(12)
  v_mfma_f32_16x16x32_bf16 v[64:67], v[16:19], v[124:127], v[64:67]
  ds_read_b64_tr_b16 v[34:35], v8 offset:4608
  v_add_u32 v8, 8192, v8
  s_waitcnt lgkmcnt(6)
  v_mfma_f32_16x16x32_bf16 v[68:71], v[20:23], v[124:127], v[68:71]
  ds_read_b64_tr_b16 v[36:37], v9 offset:4096
  buffer_load_dwordx4 v[176:179], v14, s[8:11], s36 offen offset:2048 sc1
  v_mfma_f32_16x16x32_bf16 v[52:55], v[20:23], v[120:123], v[52:55]
  ds_read_b64_tr_b16 v[38:39], v9 offset:4608
  v_add_u32 v9, 8192, v9
  s_waitcnt lgkmcnt(6)
  v_mfma_f32_16x16x32_bf16 v[56:59], v[24:27], v[120:123], v[56:59]
  ds_read_b64_tr_b16 v[40:41], v10 offset:4096
  v_mfma_f32_16x16x32_bf16 v[72:75], v[24:27], v[124:127], v[72:75]
  ds_read_b64_tr_b16 v[42:43], v10 offset:4608
  v_add_u32 v10, 8192, v10
  s_waitcnt lgkmcnt(6)
  v_mfma_f32_16x16x32_bf16 v[76:79], v[28:31], v[124:127], v[76:79]
  ds_read_b64_tr_b16 v[44:45], v11 offset:4096
  buffer_load_dwordx4 v[180:183], v14, s[8:11], s36 offen offset:3072 sc1
  v_mfma_f32_16x16x32_bf16 v[60:63], v[28:31], v[120:123], v[60:63]
  ds_read_b64_tr_b16 v[46:47], v11 offset:4608
  v_add_u32 v11, 8192, v11
  s_waitcnt vmcnt(13) lgkmcnt(6)
  v_mfma_f32_16x16x32_bf16 v[48:51], v[32:35], v[128:131], v[48:51]
  ds_read_b64_tr_b16 v[16:17], v8 offset:0
  s_mov_b32 s49, s50
  s_add_u32 s50, s50, 32768
  s_waitcnt vmcnt(12)
  v_mfma_f32_16x16x32_bf16 v[64:67], v[32:35], v[132:135], v[64:67]
  ds_read_b64_tr_b16 v[18:19], v8 offset:512
  s_cmp_eq_u32 s50, s41
  s_cselect_b32 s50, s34, s50
  s_waitcnt lgkmcnt(6)
  v_mfma_f32_16x16x32_bf16 v[68:71], v[36:39], v[132:135], v[68:71]
  ds_read_b64_tr_b16 v[20:21], v9 offset:0
  s_bitcmp1_b32 s48, 0
  s_cselect_b32 s36, s50, s49
  v_mfma_f32_16x16x32_bf16 v[52:55], v[36:39], v[128:131], v[52:55]
  ds_read_b64_tr_b16 v[22:23], v9 offset:512
  s_add_u32 s36, s36, 0
  s_waitcnt lgkmcnt(6)
  v_mfma_f32_16x16x32_bf16 v[56:59], v[40:43], v[128:131], v[56:59]
  ds_read_b64_tr_b16 v[24:25], v10 offset:0
  buffer_load_dwordx4 v[120:123], v14, s[8:11], s36 offen offset:0 sc1
  v_mfma_f32_16x16x32_bf16 v[72:75], v[40:43], v[132:135], v[72:75]
  ds_read_b64_tr_b16 v[26:27], v10 offset:512
  s_waitcnt lgkmcnt(6)
  v_mfma_f32_16x16x32_bf16 v[76:79], v[44:47], v[132:135], v[76:79]
  ds_read_b64_tr_b16 v[28:29], v11 offset:0
  v_mfma_f32_16x16x32_bf16 v[60:63], v[44:47], v[128:131], v[60:63]
  ds_read_b64_tr_b16 v[30:31], v11 offset:512
  buffer_load_dwordx4 v[124:127], v14, s[8:11], s36 offen offset:1024 sc1
  s_waitcnt vmcnt(13) lgkmcnt(6)
  v_mfma_f32_16x16x32_bf16 v[48:51], v[16:19], v[136:139], v[48:51]
  ds_read_b64_tr_b16 v[32:33], v8 offset:4096
  s_waitcnt vmcnt(12)
  v_mfma_f32_16x16x32_bf16 v[64:67], v[16:19], v[140:143], v[64:67]
  ds_read_b64_tr_b16 v[34:35], v8 offset:4608
  v_add_u32 v8, 8192, v8
  s_waitcnt lgkmcnt(6)
  v_mfma_f32_16x16x32_bf16 v[68:71], v[20:23], v[140:143], v[68:71]
  ds_read_b64_tr_b16 v[36:37], v9 offset:4096
  buffer_load_dwordx4 v[128:131], v14, s[8:11], s36 offen offset:2048 sc1
  v_mfma_f32_16x16x32_bf16 v[52:55], v[20:23], v[136:139], v[52:55]
  ds_read_b64_tr_b16 v[38:39], v9 offset:4608
  v_add_u32 v9, 8192, v9
  s_waitcnt lgkmcnt(6)
  v_mfma_f32_16x16x32_bf16 v[56:59], v[24:27], v[136:139], v[56:59]
  ds_read_b64_tr_b16 v[40:41], v10 offset:4096
  v_mfma_f32_16x16x32_bf16 v[72:75], v[24:27], v[140:143], v[72:75]
  ds_read_b64_tr_b16 v[42:43], v10 offset:4608
  v_add_u32 v10, 8192, v10
  s_waitcnt lgkmcnt(6)
  v_mfma_f32_16x16x32_bf16 v[76:79], v[28:31], v[140:143], v[76:79]
  ds_read_b64_tr_b16 v[44:45], v11 offset:4096
  buffer_load_dwordx4 v[132:135], v14, s[8:11], s36 offen offset:3072 sc1
  v_mfma_f32_16x16x32_bf16 v[60:63], v[28:31], v[136:139], v[60:63]
  ds_read_b64_tr_b16 v[46:47], v11 offset:4608
  v_add_u32 v11, 8192, v11
  s_waitcnt vmcnt(13) lgkmcnt(6)
  v_mfma_f32_16x16x32_bf16 v[48:51], v[32:35], v[144:147], v[48:51]
  ds_read_b64_tr_b16 v[16:17], v8 offset:0
  s_bitcmp1_b32 s48, 1
  s_cselect_b32 s36, s50, s49
  s_waitcnt vmcnt(12)
  v_mfma_f32_16x16x32_bf16 v[64:67], v[32:35], v[148:151], v[64:67]
  ds_read_b64_tr_b16 v[18:19], v8 offset:512
  s_add_u32 s36, s36, 4096
  s_waitcnt lgkmcnt(6)
  v_mfma_f32_16x16x32_bf16 v[68:71], v[36:39], v[148:151], v[68:71]
  ds_read_b64_tr_b16 v[20:21], v9 offset:0
  v_mfma_f32_16x16x32_bf16 v[52:55], v[36:39], v[144:147], v[52:55]
  ds_read_b64_tr_b16 v[22:23], v9 offset:512
  s_waitcnt lgkmcnt(6)
  v_mfma_f32_16x16x32_bf16 v[56:59], v[40:43], v[144:147], v[56:59]
  ds_read_b64_tr_b16 v[24:25], v10 offset:0
  buffer_load_dwordx4 v[136:139], v14, s[8:11], s36 offen offset:0 sc1
  v_mfma_f32_16x16x32_bf16 v[72:75], v[40:43], v[148:151], v[72:75]
  ds_read_b64_tr_b16 v[26:27], v10 offset:512
  s_waitcnt lgkmcnt(6)
  v_mfma_f32_16x16x32_bf16 v[76:79], v[44:47], v[148:151], v[76:79]
  ds_read_b64_tr_b16 v[28:29], v11 offset:0
  v_mfma_f32_16x16x32_bf16 v[60:63], v[44:47], v[144:147], v[60:63]
  ds_read_b64_tr_b16 v[30:31], v11 offset:512
  buffer_load_dwordx4 v[140:143], v14, s[8:11], s36 offen offset:1024 sc1
  s_waitcnt vmcnt(13) lgkmcnt(6)
  v_mfma_f32_16x16x32_bf16 v[48:51], v[16:19], v[152:155], v[48:51]
  ds_read_b64_tr_b16 v[32:33], v8 offset:4096
  s_waitcnt vmcnt(12)
  v_mfma_f32_16x16x32_bf16 v[64:67], v[16:19], v[156:159], v[64:67]
  ds_read_b64_tr_b16 v[34:35], v8 offset:4608
  v_add_u32 v8, 4294850304, v8
  s_waitcnt lgkmcnt(6)
  v_mfma_f32_16x16x32_bf16 v[68:71], v[20:23], v[156:159], v[68:71]
  ds_read_b64_tr_b16 v[36:37], v9 offset:4096
  buffer_load_dwordx4 v[144:147], v14, s[8:11], s36 offen offset:2048 sc1
  v_mfma_f32_16x16x32_bf16 v[52:55], v[20:23], v[152:155], v[52:55]
  ds_read_b64_tr_b16 v[38:39], v9 offset:4608
  v_add_u32 v9, 4294850304, v9
  s_waitcnt lgkmcnt(6)
  v_mfma_f32_16x16x32_bf16 v[56:59], v[24:27], v[152:155], v[56:59]
  ds_read_b64_tr_b16 v[40:41], v10 offset:4096
  v_mfma_f32_16x16x32_bf16 v[72:75], v[24:27], v[156:159], v[72:75]
  ds_read_b64_tr_b16 v[42:43], v10 offset:4608
  v_add_u32 v10, 4294850304, v10
  s_waitcnt lgkmcnt(6)
  v_mfma_f32_16x16x32_bf16 v[76:79], v[28:31], v[156:159], v[76:79]
  ds_read_b64_tr_b16 v[44:45], v11 offset:4096
  buffer_load_dwordx4 v[148:151], v14, s[8:11], s36 offen offset:3072 sc1
  v_mfma_f32_16x16x32_bf16 v[60:63], v[28:31], v[152:155], v[60:63]
  ds_read_b64_tr_b16 v[46:47], v11 offset:4608
  v_add_u32 v11, 4294850304, v11
  s_waitcnt vmcnt(13) lgkmcnt(6)
  v_mfma_f32_16x16x32_bf16 v[48:51], v[32:35], v[160:163], v[48:51]
  ds_read_b64_tr_b16 v[16:17], v8 offset:0
  s_bitcmp1_b32 s48, 2
  s_cselect_b32 s36, s50, s49
  s_waitcnt vmcnt(12)
  v_mfma_f32_16x16x32_bf16 v[64:67], v[32:35], v[164:167], v[64:67]
  ds_read_b64_tr_b16 v[18:19], v8 offset:512
  s_add_u32 s36, s36, 8192
  s_waitcnt lgkmcnt(6)
  v_mfma_f32_16x16x32_bf16 v[68:71], v[36:39], v[164:167], v[68:71]
  ds_read_b64_tr_b16 v[20:21], v9 offset:0
  v_mfma_f32_16x16x32_bf16 v[52:55], v[36:39], v[160:163], v[52:55]
  ds_read_b64_tr_b16 v[22:23], v9 offset:512
  s_waitcnt lgkmcnt(6)
  v_mfma_f32_16x16x32_bf16 v[56:59], v[40:43], v[160:163], v[56:59]
  ds_read_b64_tr_b16 v[24:25], v10 offset:0
  buffer_load_dwordx4 v[152:155], v14, s[8:11], s36 offen offset:0 sc1
  v_mfma_f32_16x16x32_bf16 v[72:75], v[40:43], v[164:167], v[72:75]
  ds_read_b64_tr_b16 v[26:27], v10 offset:512
  s_waitcnt lgkmcnt(6)
  v_mfma_f32_16x16x32_bf16 v[76:79], v[44:47], v[164:167], v[76:79]
  ds_read_b64_tr_b16 v[28:29], v11 offset:0
  v_mfma_f32_16x16x32_bf16 v[60:63], v[44:47], v[160:163], v[60:63]
  ds_read_b64_tr_b16 v[30:31], v11 offset:512
  buffer_load_dwordx4 v[156:159], v14, s[8:11], s36 offen offset:1024 sc1
  s_waitcnt vmcnt(13) lgkmcnt(6)
  v_mfma_f32_16x16x32_bf16 v[48:51], v[16:19], v[168:171], v[48:51]
  ds_read_b64_tr_b16 v[32:33], v8 offset:4096
  s_waitcnt vmcnt(12)
  v_mfma_f32_16x16x32_bf16 v[64:67], v[16:19], v[172:175], v[64:67]
  ds_read_b64_tr_b16 v[34:35], v8 offset:4608
  v_add_u32 v8, 8192, v8
  s_waitcnt lgkmcnt(6)
  v_mfma_f32_16x16x32_bf16 v[68:71], v[20:23], v[172:175], v[68:71]
  ds_read_b64_tr_b16 v[36:37], v9 offset:4096
  buffer_load_dwordx4 v[160:163], v14, s[8:11], s36 offen offset:2048 sc1
  v_mfma_f32_16x16x32_bf16 v[52:55], v[20:23], v[168:171], v[52:55]
  ds_read_b64_tr_b16 v[38:39], v9 offset:4608
  v_add_u32 v9, 8192, v9
  s_waitcnt lgkmcnt(6)
  v_mfma_f32_16x16x32_bf16 v[56:59], v[24:27], v[168:171], v[56:59]
  ds_read_b64_tr_b16 v[40:41], v10 offset:4096
  v_mfma_f32_16x16x32_bf16 v[72:75], v[24:27], v[172:175], v[72:75]
  ds_read_b64_tr_b16 v[42:43], v10 offset:4608
  v_add_u32 v10, 8192, v10
  s_waitcnt lgkmcnt(6)
  v_mfma_f32_16x16x32_bf16 v[76:79], v[28:31], v[172:175], v[76:79]
  ds_read_b64_tr_b16 v[44:45], v11 offset:4096
  buffer_load_dwordx4 v[164:167], v14, s[8:11], s36 offen offset:3072 sc1
  v_mfma_f32_16x16x32_bf16 v[60:63], v[28:31], v[168:171], v[60:63]
  ds_read_b64_tr_b16 v[46:47], v11 offset:4608
  v_add_u32 v11, 8192, v11
  s_waitcnt vmcnt(13) lgkmcnt(6)
  v_mfma_f32_16x16x32_bf16 v[48:51], v[32:35], v[176:179], v[48:51]
  ds_read_b64_tr_b16 v[16:17], v8 offset:0
  s_bitcmp1_b32 s48, 3
  s_cselect_b32 s36, s50, s49
  s_waitcnt vmcnt(12)
  v_mfma_f32_16x16x32_bf16 v[64:67], v[32:35], v[180:183], v[64:67]
  ds_read_b64_tr_b16 v[18:19], v8 offset:512
  s_add_u32 s36, s36, 12288
  s_waitcnt lgkmcnt(6)
  v_mfma_f32_16x16x32_bf16 v[68:71], v[36:39], v[180:183], v[68:71]
  ds_read_b64_tr_b16 v[20:21], v9 offset:0
  v_mfma_f32_16x16x32_bf16 v[52:55], v[36:39], v[176:179], v[52:55]
  ds_read_b64_tr_b16 v[22:23], v9 offset:512
  s_waitcnt lgkmcnt(6)
  v_mfma_f32_16x16x32_bf16 v[56:59], v[40:43], v[176:179], v[56:59]
  ds_read_b64_tr_b16 v[24:25], v10 offset:0
  buffer_load_dwordx4 v[168:171], v14, s[8:11], s36 offen offset:0 sc1
  v_mfma_f32_16x16x32_bf16 v[72:75], v[40:43], v[180:183], v[72:75]
  ds_read_b64_tr_b16 v[26:27], v10 offset:512
  s_waitcnt lgkmcnt(6)
  v_mfma_f32_16x16x32_bf16 v[76:79], v[44:47], v[180:183], v[76:79]
  ds_read_b64_tr_b16 v[28:29], v11 offset:0
  v_mfma_f32_16x16x32_bf16 v[60:63], v[44:47], v[176:179], v[60:63]
  ds_read_b64_tr_b16 v[30:31], v11 offset:512
  buffer_load_dwordx4 v[172:175], v14, s[8:11], s36 offen offset:1024 sc1
  s_waitcnt vmcnt(13) lgkmcnt(6)
  v_mfma_f32_16x16x32_bf16 v[48:51], v[16:19], v[120:123], v[48:51]
  ds_read_b64_tr_b16 v[32:33], v8 offset:4096
  s_waitcnt vmcnt(12)
  v_mfma_f32_16x16x32_bf16 v[64:67], v[16:19], v[124:127], v[64:67]
  ds_read_b64_tr_b16 v[34:35], v8 offset:4608
  v_add_u32 v8, 8192, v8
  s_waitcnt lgkmcnt(6)
  v_mfma_f32_16x16x32_bf16 v[68:71], v[20:23], v[124:127], v[68:71]
  ds_read_b64_tr_b16 v[36:37], v9 offset:4096
  buffer_load_dwordx4 v[176:179], v14, s[8:11], s36 offen offset:2048 sc1
  v_mfma_f32_16x16x32_bf16 v[52:55], v[20:23], v[120:123], v[52:55]
  ds_read_b64_tr_b16 v[38:39], v9 offset:4608
  v_add_u32 v9, 8192, v9
  s_waitcnt lgkmcnt(6)
  v_mfma_f32_16x16x32_bf16 v[56:59], v[24:27], v[120:123], v[56:59]
  ds_read_b64_tr_b16 v[40:41], v10 offset:4096
  v_mfma_f32_16x16x32_bf16 v[72:75], v[24:27], v[124:127], v[72:75]
  ds_read_b64_tr_b16 v[42:43], v10 offset:4608
  v_add_u32 v10, 8192, v10
  s_waitcnt lgkmcnt(6)
  v_mfma_f32_16x16x32_bf16 v[76:79], v[28:31], v[124:127], v[76:79]
  ds_read_b64_tr_b16 v[44:45], v11 offset:4096
  buffer_load_dwordx4 v[180:183], v14, s[8:11], s36 offen offset:3072 sc1
  v_mfma_f32_16x16x32_bf16 v[60:63], v[28:31], v[120:123], v[60:63]
  ds_read_b64_tr_b16 v[46:47], v11 offset:4608
  v_add_u32 v11, 8192, v11
  s_waitcnt vmcnt(13) lgkmcnt(6)
  v_mfma_f32_16x16x32_bf16 v[48:51], v[32:35], v[128:131], v[48:51]
  ds_read_b64_tr_b16 v[16:17], v8 offset:0
  s_bitcmp1_b32 s48, 4
  s_cselect_b32 s36, s50, s49
  s_waitcnt vmcnt(12)
  v_mfma_f32_16x16x32_bf16 v[64:67], v[32:35], v[132:135], v[64:67]
  ds_read_b64_tr_b16 v[18:19], v8 offset:512
  s_add_u32 s36, s36, 16384
  s_waitcnt lgkmcnt(6)
  v_mfma_f32_16x16x32_bf16 v[68:71], v[36:39], v[132:135], v[68:71]
  ds_read_b64_tr_b16 v[20:21], v9 offset:0
  v_mfma_f32_16x16x32_bf16 v[52:55], v[36:39], v[128:131], v[52:55]
  ds_read_b64_tr_b16 v[22:23], v9 offset:512
  s_waitcnt lgkmcnt(6)
  v_mfma_f32_16x16x32_bf16 v[56:59], v[40:43], v[128:131], v[56:59]
  ds_read_b64_tr_b16 v[24:25], v10 offset:0
  buffer_load_dwordx4 v[120:123], v14, s[8:11], s36 offen offset:0 sc1
  v_mfma_f32_16x16x32_bf16 v[72:75], v[40:43], v[132:135], v[72:75]
  ds_read_b64_tr_b16 v[26:27], v10 offset:512
  s_waitcnt lgkmcnt(6)
  v_mfma_f32_16x16x32_bf16 v[76:79], v[44:47], v[132:135], v[76:79]
  ds_read_b64_tr_b16 v[28:29], v11 offset:0
  v_mfma_f32_16x16x32_bf16 v[60:63], v[44:47], v[128:131], v[60:63]
  ds_read_b64_tr_b16 v[30:31], v11 offset:512
  buffer_load_dwordx4 v[124:127], v14, s[8:11], s36 offen offset:1024 sc1
  s_waitcnt vmcnt(13) lgkmcnt(6)
  v_mfma_f32_16x16x32_bf16 v[48:51], v[16:19], v[136:139], v[48:51]
  ds_read_b64_tr_b16 v[32:33], v8 offset:4096
  s_waitcnt vmcnt(12)
  v_mfma_f32_16x16x32_bf16 v[64:67], v[16:19], v[140:143], v[64:67]
  ds_read_b64_tr_b16 v[34:35], v8 offset:4608
  v_add_u32 v8, 8192, v8
  s_waitcnt lgkmcnt(6)
  v_mfma_f32_16x16x32_bf16 v[68:71], v[20:23], v[140:143], v[68:71]
  ds_read_b64_tr_b16 v[36:37], v9 offset:4096
  buffer_load_dwordx4 v[128:131], v14, s[8:11], s36 offen offset:2048 sc1
  v_mfma_f32_16x16x32_bf16 v[52:55], v[20:23], v[136:139], v[52:55]
  ds_read_b64_tr_b16 v[38:39], v9 offset:4608
  v_add_u32 v9, 8192, v9
  s_waitcnt lgkmcnt(6)
  v_mfma_f32_16x16x32_bf16 v[56:59], v[24:27], v[136:139], v[56:59]
  ds_read_b64_tr_b16 v[40:41], v10 offset:4096
  v_mfma_f32_16x16x32_bf16 v[72:75], v[24:27], v[140:143], v[72:75]
  ds_read_b64_tr_b16 v[42:43], v10 offset:4608
  v_add_u32 v10, 8192, v10
  s_waitcnt lgkmcnt(6)
  v_mfma_f32_16x16x32_bf16 v[76:79], v[28:31], v[140:143], v[76:79]
  ds_read_b64_tr_b16 v[44:45], v11 offset:4096
  buffer_load_dwordx4 v[132:135], v14, s[8:11], s36 offen offset:3072 sc1
  v_mfma_f32_16x16x32_bf16 v[60:63], v[28:31], v[136:139], v[60:63]
  ds_read_b64_tr_b16 v[46:47], v11 offset:4608
  v_add_u32 v11, 8192, v11
  s_waitcnt vmcnt(13) lgkmcnt(6)
  v_mfma_f32_16x16x32_bf16 v[48:51], v[32:35], v[144:147], v[48:51]
  ds_read_b64_tr_b16 v[16:17], v8 offset:0
  s_bitcmp1_b32 s48, 5
  s_cselect_b32 s36, s50, s49
  s_waitcnt vmcnt(12)
  v_mfma_f32_16x16x32_bf16 v[64:67], v[32:35], v[148:151], v[64:67]
  ds_read_b64_tr_b16 v[18:19], v8 offset:512
  s_add_u32 s36, s36, 20480
  s_waitcnt lgkmcnt(6)
  v_mfma_f32_16x16x32_bf16 v[68:71], v[36:39], v[148:151], v[68:71]
  ds_read_b64_tr_b16 v[20:21], v9 offset:0
  v_mfma_f32_16x16x32_bf16 v[52:55], v[36:39], v[144:147], v[52:55]
  ds_read_b64_tr_b16 v[22:23], v9 offset:512
  s_waitcnt lgkmcnt(6)
  v_mfma_f32_16x16x32_bf16 v[56:59], v[40:43], v[144:147], v[56:59]
  ds_read_b64_tr_b16 v[24:25], v10 offset:0
  buffer_load_dwordx4 v[136:139], v14, s[8:11], s36 offen offset:0 sc1
  v_mfma_f32_16x16x32_bf16 v[72:75], v[40:43], v[148:151], v[72:75]
  ds_read_b64_tr_b16 v[26:27], v10 offset:512
  s_waitcnt lgkmcnt(6)
  v_mfma_f32_16x16x32_bf16 v[76:79], v[44:47], v[148:151], v[76:79]
  ds_read_b64_tr_b16 v[28:29], v11 offset:0
  v_mfma_f32_16x16x32_bf16 v[60:63], v[44:47], v[144:147], v[60:63]
  ds_read_b64_tr_b16 v[30:31], v11 offset:512
  buffer_load_dwordx4 v[140:143], v14, s[8:11], s36 offen offset:1024 sc1
  s_waitcnt vmcnt(13) lgkmcnt(6)
  v_mfma_f32_16x16x32_bf16 v[48:51], v[16:19], v[152:155], v[48:51]
  ds_read_b64_tr_b16 v[32:33], v8 offset:4096
  s_waitcnt vmcnt(12)
  v_mfma_f32_16x16x32_bf16 v[64:67], v[16:19], v[156:159], v[64:67]
  ds_read_b64_tr_b16 v[34:35], v8 offset:4608
  v_add_u32 v8, 8192, v8
  s_waitcnt lgkmcnt(6)
  v_mfma_f32_16x16x32_bf16 v[68:71], v[20:23], v[156:159], v[68:71]
  ds_read_b64_tr_b16 v[36:37], v9 offset:4096
  buffer_load_dwordx4 v[144:147], v14, s[8:11], s36 offen offset:2048 sc1
  v_mfma_f32_16x16x32_bf16 v[52:55], v[20:23], v[152:155], v[52:55]
  ds_read_b64_tr_b16 v[38:39], v9 offset:4608
  v_add_u32 v9, 8192, v9
  s_waitcnt lgkmcnt(6)
  v_mfma_f32_16x16x32_bf16 v[56:59], v[24:27], v[152:155], v[56:59]
  ds_read_b64_tr_b16 v[40:41], v10 offset:4096
  v_mfma_f32_16x16x32_bf16 v[72:75], v[24:27], v[156:159], v[72:75]
  ds_read_b64_tr_b16 v[42:43], v10 offset:4608
  v_add_u32 v10, 8192, v10
  s_waitcnt lgkmcnt(6)
  v_mfma_f32_16x16x32_bf16 v[76:79], v[28:31], v[156:159], v[76:79]
  ds_read_b64_tr_b16 v[44:45], v11 offset:4096
  buffer_load_dwordx4 v[148:151], v14, s[8:11], s36 offen offset:3072 sc1
  v_mfma_f32_16x16x32_bf16 v[60:63], v[28:31], v[152:155], v[60:63]
  ds_read_b64_tr_b16 v[46:47], v11 offset:4608
  v_add_u32 v11, 8192, v11
  s_waitcnt vmcnt(13) lgkmcnt(6)
  v_mfma_f32_16x16x32_bf16 v[48:51], v[32:35], v[160:163], v[48:51]
  ds_read_b64_tr_b16 v[16:17], v8 offset:0
  s_bitcmp1_b32 s48, 6
  s_cselect_b32 s36, s50, s49
  s_waitcnt vmcnt(12)
  v_mfma_f32_16x16x32_bf16 v[64:67], v[32:35], v[164:167], v[64:67]
  ds_read_b64_tr_b16 v[18:19], v8 offset:512
  s_add_u32 s36, s36, 24576
  s_waitcnt lgkmcnt(6)
  v_mfma_f32_16x16x32_bf16 v[68:71], v[36:39], v[164:167], v[68:71]
  ds_read_b64_tr_b16 v[20:21], v9 offset:0
  v_mfma_f32_16x16x32_bf16 v[52:55], v[36:39], v[160:163], v[52:55]
  ds_read_b64_tr_b16 v[22:23], v9 offset:512
  s_waitcnt lgkmcnt(6)
  v_mfma_f32_16x16x32_bf16 v[56:59], v[40:43], v[160:163], v[56:59]
  ds_read_b64_tr_b16 v[24:25], v10 offset:0
  buffer_load_dwordx4 v[152:155], v14, s[8:11], s36 offen offset:0 sc1
  v_mfma_f32_16x16x32_bf16 v[72:75], v[40:43], v[164:167], v[72:75]
  ds_read_b64_tr_b16 v[26:27], v10 offset:512
  s_waitcnt lgkmcnt(6)
  v_mfma_f32_16x16x32_bf16 v[76:79], v[44:47], v[164:167], v[76:79]
  ds_read_b64_tr_b16 v[28:29], v11 offset:0
  v_mfma_f32_16x16x32_bf16 v[60:63], v[44:47], v[160:163], v[60:63]
  ds_read_b64_tr_b16 v[30:31], v11 offset:512
  buffer_load_dwordx4 v[156:159], v14, s[8:11], s36 offen offset:1024 sc1
  s_waitcnt vmcnt(13) lgkmcnt(6)
  v_mfma_f32_16x16x32_bf16 v[48:51], v[16:19], v[168:171], v[48:51]
  ds_read_b64_tr_b16 v[32:33], v8 offset:4096
  s_waitcnt vmcnt(12)
  v_mfma_f32_16x16x32_bf16 v[64:67], v[16:19], v[172:175], v[64:67]
  ds_read_b64_tr_b16 v[34:35], v8 offset:4608
  v_add_u32 v8, 10240, v8
  s_waitcnt lgkmcnt(6)
  v_mfma_f32_16x16x32_bf16 v[68:71], v[20:23], v[172:175], v[68:71]
  ds_read_b64_tr_b16 v[36:37], v9 offset:4096
  buffer_load_dwordx4 v[160:163], v14, s[8:11], s36 offen offset:2048 sc1
  v_mfma_f32_16x16x32_bf16 v[52:55], v[20:23], v[168:171], v[52:55]
  ds_read_b64_tr_b16 v[38:39], v9 offset:4608
  v_add_u32 v9, 10240, v9
  s_waitcnt lgkmcnt(6)
  v_mfma_f32_16x16x32_bf16 v[56:59], v[24:27], v[168:171], v[56:59]
  ds_read_b64_tr_b16 v[40:41], v10 offset:4096
  v_mfma_f32_16x16x32_bf16 v[72:75], v[24:27], v[172:175], v[72:75]
  ds_read_b64_tr_b16 v[42:43], v10 offset:4608
  v_add_u32 v10, 10240, v10
  s_waitcnt lgkmcnt(6)
  v_mfma_f32_16x16x32_bf16 v[76:79], v[28:31], v[172:175], v[76:79]
  ds_read_b64_tr_b16 v[44:45], v11 offset:4096
  buffer_load_dwordx4 v[164:167], v14, s[8:11], s36 offen offset:3072 sc1
  v_mfma_f32_16x16x32_bf16 v[60:63], v[28:31], v[168:171], v[60:63]
  ds_read_b64_tr_b16 v[46:47], v11 offset:4608
  v_add_u32 v11, 10240, v11
  s_waitcnt vmcnt(13) lgkmcnt(6)
  v_mfma_f32_16x16x32_bf16 v[48:51], v[32:35], v[176:179], v[48:51]
  ds_read_b64_tr_b16 v[16:17], v8 offset:0
  s_bitcmp1_b32 s48, 7
  s_cselect_b32 s36, s50, s49
  s_waitcnt vmcnt(12)
  v_mfma_f32_16x16x32_bf16 v[64:67], v[32:35], v[180:183], v[64:67]
  ds_read_b64_tr_b16 v[18:19], v8 offset:512
  s_add_u32 s36, s36, 28672
  s_waitcnt lgkmcnt(6)
  v_mfma_f32_16x16x32_bf16 v[68:71], v[36:39], v[180:183], v[68:71]
  ds_read_b64_tr_b16 v[20:21], v9 offset:0
  v_mfma_f32_16x16x32_bf16 v[52:55], v[36:39], v[176:179], v[52:55]
  ds_read_b64_tr_b16 v[22:23], v9 offset:512
  s_waitcnt lgkmcnt(6)
  v_mfma_f32_16x16x32_bf16 v[56:59], v[40:43], v[176:179], v[56:59]
  ds_read_b64_tr_b16 v[24:25], v10 offset:0
  buffer_load_dwordx4 v[168:171], v14, s[8:11], s36 offen offset:0 sc1
  v_mfma_f32_16x16x32_bf16 v[72:75], v[40:43], v[180:183], v[72:75]
  ds_read_b64_tr_b16 v[26:27], v10 offset:512
  s_waitcnt lgkmcnt(6)
  v_mfma_f32_16x16x32_bf16 v[76:79], v[44:47], v[180:183], v[76:79]
  ds_read_b64_tr_b16 v[28:29], v11 offset:0
  v_mfma_f32_16x16x32_bf16 v[60:63], v[44:47], v[176:179], v[60:63]
  ds_read_b64_tr_b16 v[30:31], v11 offset:512
  buffer_load_dwordx4 v[172:175], v14, s[8:11], s36 offen offset:1024 sc1
  s_waitcnt vmcnt(13) lgkmcnt(6)
  v_mfma_f32_16x16x32_bf16 v[48:51], v[16:19], v[120:123], v[48:51]
  ds_read_b64_tr_b16 v[32:33], v8 offset:4096
  s_waitcnt vmcnt(12)
  v_mfma_f32_16x16x32_bf16 v[64:67], v[16:19], v[124:127], v[64:67]
  ds_read_b64_tr_b16 v[34:35], v8 offset:4608
  v_add_u32 v8, 8192, v8
  s_waitcnt lgkmcnt(6)
  v_mfma_f32_16x16x32_bf16 v[68:71], v[20:23], v[124:127], v[68:71]
  ds_read_b64_tr_b16 v[36:37], v9 offset:4096
  buffer_load_dwordx4 v[176:179], v14, s[8:11], s36 offen offset:2048 sc1
  v_mfma_f32_16x16x32_bf16 v[52:55], v[20:23], v[120:123], v[52:55]
  ds_read_b64_tr_b16 v[38:39], v9 offset:4608
  v_add_u32 v9, 8192, v9
  s_waitcnt lgkmcnt(6)
  v_mfma_f32_16x16x32_bf16 v[56:59], v[24:27], v[120:123], v[56:59]
  ds_read_b64_tr_b16 v[40:41], v10 offset:4096
  v_mfma_f32_16x16x32_bf16 v[72:75], v[24:27], v[124:127], v[72:75]
  ds_read_b64_tr_b16 v[42:43], v10 offset:4608
  v_add_u32 v10, 8192, v10
  s_waitcnt lgkmcnt(6)
  v_mfma_f32_16x16x32_bf16 v[76:79], v[28:31], v[124:127], v[76:79]
  ds_read_b64_tr_b16 v[44:45], v11 offset:4096
  buffer_load_dwordx4 v[180:183], v14, s[8:11], s36 offen offset:3072 sc1
  v_mfma_f32_16x16x32_bf16 v[60:63], v[28:31], v[120:123], v[60:63]
  ds_read_b64_tr_b16 v[46:47], v11 offset:4608
  v_add_u32 v11, 8192, v11
  s_waitcnt vmcnt(13) lgkmcnt(6)
  v_mfma_f32_16x16x32_bf16 v[48:51], v[32:35], v[128:131], v[48:51]
  ds_read_b64_tr_b16 v[16:17], v8 offset:0
  s_waitcnt vmcnt(12)
  v_mfma_f32_16x16x32_bf16 v[64:67], v[32:35], v[132:135], v[64:67]
  ds_read_b64_tr_b16 v[18:19], v8 offset:512
  s_waitcnt lgkmcnt(6)
  v_mfma_f32_16x16x32_bf16 v[68:71], v[36:39], v[132:135], v[68:71]
  ds_read_b64_tr_b16 v[20:21], v9 offset:0
  v_mfma_f32_16x16x32_bf16 v[52:55], v[36:39], v[128:131], v[52:55]
  ds_read_b64_tr_b16 v[22:23], v9 offset:512
  s_waitcnt lgkmcnt(6)
  v_mfma_f32_16x16x32_bf16 v[56:59], v[40:43], v[128:131], v[56:59]
  ds_read_b64_tr_b16 v[24:25], v10 offset:0
  v_mfma_f32_16x16x32_bf16 v[72:75], v[40:43], v[132:135], v[72:75]
  ds_read_b64_tr_b16 v[26:27], v10 offset:512
  s_waitcnt lgkmcnt(6)
  v_mfma_f32_16x16x32_bf16 v[76:79], v[44:47], v[132:135], v[76:79]
  ds_read_b64_tr_b16 v[28:29], v11 offset:0
  v_mfma_f32_16x16x32_bf16 v[60:63], v[44:47], v[128:131], v[60:63]
  ds_read_b64_tr_b16 v[30:31], v11 offset:512
  s_waitcnt vmcnt(11) lgkmcnt(6)
  v_mfma_f32_16x16x32_bf16 v[48:51], v[16:19], v[136:139], v[48:51]
  ds_read_b64_tr_b16 v[32:33], v8 offset:4096
  s_waitcnt vmcnt(10)
  v_mfma_f32_16x16x32_bf16 v[64:67], v[16:19], v[140:143], v[64:67]
  ds_read_b64_tr_b16 v[34:35], v8 offset:4608
  v_add_u32 v8, 8192, v8
  s_waitcnt lgkmcnt(6)
  v_mfma_f32_16x16x32_bf16 v[68:71], v[20:23], v[140:143], v[68:71]
  ds_read_b64_tr_b16 v[36:37], v9 offset:4096
  v_mfma_f32_16x16x32_bf16 v[52:55], v[20:23], v[136:139], v[52:55]
  ds_read_b64_tr_b16 v[38:39], v9 offset:4608
  v_add_u32 v9, 8192, v9
  s_waitcnt lgkmcnt(6)
  v_mfma_f32_16x16x32_bf16 v[56:59], v[24:27], v[136:139], v[56:59]
  ds_read_b64_tr_b16 v[40:41], v10 offset:4096
  v_mfma_f32_16x16x32_bf16 v[72:75], v[24:27], v[140:143], v[72:75]
  ds_read_b64_tr_b16 v[42:43], v10 offset:4608
  v_add_u32 v10, 8192, v10
  s_waitcnt lgkmcnt(6)
  v_mfma_f32_16x16x32_bf16 v[76:79], v[28:31], v[140:143], v[76:79]
  ds_read_b64_tr_b16 v[44:45], v11 offset:4096
  v_mfma_f32_16x16x32_bf16 v[60:63], v[28:31], v[136:139], v[60:63]
  ds_read_b64_tr_b16 v[46:47], v11 offset:4608
  v_add_u32 v11, 8192, v11
  s_waitcnt vmcnt(9) lgkmcnt(6)
  v_mfma_f32_16x16x32_bf16 v[48:51], v[32:35], v[144:147], v[48:51]
  ds_read_b64_tr_b16 v[16:17], v8 offset:0
  s_waitcnt vmcnt(8)
  v_mfma_f32_16x16x32_bf16 v[64:67], v[32:35], v[148:151], v[64:67]
  ds_read_b64_tr_b16 v[18:19], v8 offset:512
  s_waitcnt lgkmcnt(6)
  v_mfma_f32_16x16x32_bf16 v[68:71], v[36:39], v[148:151], v[68:71]
  ds_read_b64_tr_b16 v[20:21], v9 offset:0
  v_mfma_f32_16x16x32_bf16 v[52:55], v[36:39], v[144:147], v[52:55]
  ds_read_b64_tr_b16 v[22:23], v9 offset:512
  s_waitcnt lgkmcnt(6)
  v_mfma_f32_16x16x32_bf16 v[56:59], v[40:43], v[144:147], v[56:59]
  ds_read_b64_tr_b16 v[24:25], v10 offset:0
  v_mfma_f32_16x16x32_bf16 v[72:75], v[40:43], v[148:151], v[72:75]
  ds_read_b64_tr_b16 v[26:27], v10 offset:512
  s_waitcnt lgkmcnt(6)
  v_mfma_f32_16x16x32_bf16 v[76:79], v[44:47], v[148:151], v[76:79]
  ds_read_b64_tr_b16 v[28:29], v11 offset:0
  v_mfma_f32_16x16x32_bf16 v[60:63], v[44:47], v[144:147], v[60:63]
  ds_read_b64_tr_b16 v[30:31], v11 offset:512
  s_waitcnt vmcnt(7) lgkmcnt(6)
  v_mfma_f32_16x16x32_bf16 v[48:51], v[16:19], v[152:155], v[48:51]
  ds_read_b64_tr_b16 v[32:33], v8 offset:4096
  s_waitcnt vmcnt(6)
  v_mfma_f32_16x16x32_bf16 v[64:67], v[16:19], v[156:159], v[64:67]
  ds_read_b64_tr_b16 v[34:35], v8 offset:4608
  v_add_u32 v8, 8192, v8
  s_waitcnt lgkmcnt(6)
  v_mfma_f32_16x16x32_bf16 v[68:71], v[20:23], v[156:159], v[68:71]
  ds_read_b64_tr_b16 v[36:37], v9 offset:4096
  v_mfma_f32_16x16x32_bf16 v[52:55], v[20:23], v[152:155], v[52:55]
  ds_read_b64_tr_b16 v[38:39], v9 offset:4608
  v_add_u32 v9, 8192, v9
  s_waitcnt lgkmcnt(6)
  v_mfma_f32_16x16x32_bf16 v[56:59], v[24:27], v[152:155], v[56:59]
  ds_read_b64_tr_b16 v[40:41], v10 offset:4096
  v_mfma_f32_16x16x32_bf16 v[72:75], v[24:27], v[156:159], v[72:75]
  ds_read_b64_tr_b16 v[42:43], v10 offset:4608
  v_add_u32 v10, 8192, v10
  s_waitcnt lgkmcnt(6)
  v_mfma_f32_16x16x32_bf16 v[76:79], v[28:31], v[156:159], v[76:79]
  ds_read_b64_tr_b16 v[44:45], v11 offset:4096
  v_mfma_f32_16x16x32_bf16 v[60:63], v[28:31], v[152:155], v[60:63]
  ds_read_b64_tr_b16 v[46:47], v11 offset:4608
  v_add_u32 v11, 8192, v11
  s_waitcnt vmcnt(5) lgkmcnt(6)
  v_mfma_f32_16x16x32_bf16 v[48:51], v[32:35], v[160:163], v[48:51]
  ds_read_b64_tr_b16 v[16:17], v8 offset:0
  s_waitcnt vmcnt(4)
  v_mfma_f32_16x16x32_bf16 v[64:67], v[32:35], v[164:167], v[64:67]
  ds_read_b64_tr_b16 v[18:19], v8 offset:512
  s_waitcnt lgkmcnt(6)
  v_mfma_f32_16x16x32_bf16 v[68:71], v[36:39], v[164:167], v[68:71]
  ds_read_b64_tr_b16 v[20:21], v9 offset:0
  v_mfma_f32_16x16x32_bf16 v[52:55], v[36:39], v[160:163], v[52:55]
  ds_read_b64_tr_b16 v[22:23], v9 offset:512
  s_waitcnt lgkmcnt(6)
  v_mfma_f32_16x16x32_bf16 v[56:59], v[40:43], v[160:163], v[56:59]
  ds_read_b64_tr_b16 v[24:25], v10 offset:0
  v_mfma_f32_16x16x32_bf16 v[72:75], v[40:43], v[164:167], v[72:75]
  ds_read_b64_tr_b16 v[26:27], v10 offset:512
  s_waitcnt lgkmcnt(6)
  v_mfma_f32_16x16x32_bf16 v[76:79], v[44:47], v[164:167], v[76:79]
  ds_read_b64_tr_b16 v[28:29], v11 offset:0
  v_mfma_f32_16x16x32_bf16 v[60:63], v[44:47], v[160:163], v[60:63]
  ds_read_b64_tr_b16 v[30:31], v11 offset:512
  s_waitcnt vmcnt(3) lgkmcnt(6)
  v_mfma_f32_16x16x32_bf16 v[48:51], v[16:19], v[168:171], v[48:51]
  ds_read_b64_tr_b16 v[32:33], v8 offset:4096
  s_waitcnt vmcnt(2)
  v_mfma_f32_16x16x32_bf16 v[64:67], v[16:19], v[172:175], v[64:67]
  ds_read_b64_tr_b16 v[34:35], v8 offset:4608
  s_waitcnt lgkmcnt(6)
  v_mfma_f32_16x16x32_bf16 v[68:71], v[20:23], v[172:175], v[68:71]
  ds_read_b64_tr_b16 v[36:37], v9 offset:4096
  v_mfma_f32_16x16x32_bf16 v[52:55], v[20:23], v[168:171], v[52:55]
  ds_read_b64_tr_b16 v[38:39], v9 offset:4608
  s_waitcnt lgkmcnt(6)
  v_mfma_f32_16x16x32_bf16 v[56:59], v[24:27], v[168:171], v[56:59]
  ds_read_b64_tr_b16 v[40:41], v10 offset:4096
  v_mfma_f32_16x16x32_bf16 v[72:75], v[24:27], v[172:175], v[72:75]
  ds_read_b64_tr_b16 v[42:43], v10 offset:4608
  s_waitcnt lgkmcnt(6)
  v_mfma_f32_16x16x32_bf16 v[76:79], v[28:31], v[172:175], v[76:79]
  ds_read_b64_tr_b16 v[44:45], v11 offset:4096
  v_mfma_f32_16x16x32_bf16 v[60:63], v[28:31], v[168:171], v[60:63]
  ds_read_b64_tr_b16 v[46:47], v11 offset:4608
  s_waitcnt vmcnt(1) lgkmcnt(6)
  v_mfma_f32_16x16x32_bf16 v[48:51], v[32:35], v[176:179], v[48:51]
  s_waitcnt vmcnt(0)
  v_mfma_f32_16x16x32_bf16 v[64:67], v[32:35], v[180:183], v[64:67]
  s_waitcnt lgkmcnt(4)
  v_mfma_f32_16x16x32_bf16 v[68:71], v[36:39], v[180:183], v[68:71]
  v_mfma_f32_16x16x32_bf16 v[52:55], v[36:39], v[176:179], v[52:55]
  s_waitcnt lgkmcnt(2)
  v_mfma_f32_16x16x32_bf16 v[56:59], v[40:43], v[176:179], v[56:59]
  v_mfma_f32_16x16x32_bf16 v[72:75], v[40:43], v[180:183], v[72:75]
  s_waitcnt lgkmcnt(0)
  v_mfma_f32_16x16x32_bf16 v[76:79], v[44:47], v[180:183], v[76:79]
  v_mfma_f32_16x16x32_bf16 v[60:63], v[44:47], v[176:179], v[60:63]
  s_waitcnt lgkmcnt(0)
  s_barrier
  s_add_u32 s20, s82, 4194304
  s_addc_u32 s21, s83, 0
  s_mov_b32 s22, 4194304
  s_mov_b32 s23, 0x20000
  s_add_u32 s24, s82, 8388608
  s_addc_u32 s25, s83, 0
  s_mov_b32 s26, 4194304
  s_mov_b32 s27, 0x20000
  v_pk_add_f32 v[16:17], v[48:49], v[50:51]
  v_pk_mul_f32 v[18:19], v[48:49], v[48:49]
  v_pk_fma_f32 v[18:19], v[50:51], v[50:51], v[18:19]
  v_pk_add_f32 v[16:17], v[16:17], v[52:53]
  v_pk_fma_f32 v[18:19], v[52:53], v[52:53], v[18:19]
  v_pk_add_f32 v[16:17], v[16:17], v[54:55]
  v_pk_fma_f32 v[18:19], v[54:55], v[54:55], v[18:19]
  v_pk_add_f32 v[16:17], v[16:17], v[56:57]
  v_pk_fma_f32 v[18:19], v[56:57], v[56:57], v[18:19]
  v_pk_add_f32 v[16:17], v[16:17], v[58:59]
  v_pk_fma_f32 v[18:19], v[58:59], v[58:59], v[18:19]
  v_pk_add_f32 v[16:17], v[16:17], v[60:61]
  v_pk_fma_f32 v[18:19], v[60:61], v[60:61], v[18:19]
  v_pk_add_f32 v[16:17], v[16:17], v[62:63]
  v_pk_fma_f32 v[18:19], v[62:63], v[62:63], v[18:19]
  v_add_f32 v24, v16, v17
  v_add_f32 v26, v18, v19
  v_pk_add_f32 v[20:21], v[64:65], v[66:67]
  v_pk_mul_f32 v[22:23], v[64:65], v[64:65]
  v_pk_fma_f32 v[22:23], v[66:67], v[66:67], v[22:23]
  v_pk_add_f32 v[20:21], v[20:21], v[68:69]
  v_pk_fma_f32 v[22:23], v[68:69], v[68:69], v[22:23]
  v_pk_add_f32 v[20:21], v[20:21], v[70:71]
  v_pk_fma_f32 v[22:23], v[70:71], v[70:71], v[22:23]
  v_pk_add_f32 v[20:21], v[20:21], v[72:73]
  v_pk_fma_f32 v[22:23], v[72:73], v[72:73], v[22:23]
  v_pk_add_f32 v[20:21], v[20:21], v[74:75]
  v_pk_fma_f32 v[22:23], v[74:75], v[74:75], v[22:23]
  v_pk_add_f32 v[20:21], v[20:21], v[76:77]
  v_pk_fma_f32 v[22:23], v[76:77], v[76:77], v[22:23]
  v_pk_add_f32 v[20:21], v[20:21], v[78:79]
  v_pk_fma_f32 v[22:23], v[78:79], v[78:79], v[22:23]
  v_add_f32 v25, v20, v21
  v_add_f32 v27, v22, v23
  s_nop 0
  v_permlane16_swap_b32 v24, v25
  v_permlane16_swap_b32 v26, v27
  v_add_f32 v28, v24, v25
  v_add_f32 v29, v26, v27
  v_mov_b32 v30, v28
  v_mov_b32 v31, v29
  s_nop 0
  v_permlane32_swap_b32 v28, v30
  v_permlane32_swap_b32 v29, v31
  v_add_f32 v28, v28, v30
  v_add_f32 v29, v29, v31
  v_and_b32 v29, 0x7fffffff, v29
  s_mov_b32 exec_hi, 0
  buffer_store_dwordx2 v[28:29], v112, s[12:15], 0 offen sc0 sc1
  s_mov_b64 exec, -1
  v_cvt_pk_bf16_f32 v96, v48, v49
  v_cvt_pk_bf16_f32 v97, v50, v51
  v_cvt_pk_bf16_f32 v98, v52, v53
  v_cvt_pk_bf16_f32 v99, v54, v55
  v_cvt_pk_bf16_f32 v100, v56, v57
  v_cvt_pk_bf16_f32 v101, v58, v59
  v_cvt_pk_bf16_f32 v102, v60, v61
  v_cvt_pk_bf16_f32 v103, v62, v63
  v_cvt_pk_bf16_f32 v104, v64, v65
  v_cvt_pk_bf16_f32 v105, v66, v67
  v_cvt_pk_bf16_f32 v106, v68, v69
  v_cvt_pk_bf16_f32 v107, v70, v71
  v_cvt_pk_bf16_f32 v108, v72, v73
  v_cvt_pk_bf16_f32 v109, v74, v75
  v_cvt_pk_bf16_f32 v110, v76, v77
  v_cvt_pk_bf16_f32 v111, v78, v79
  v_permlane16_swap_b32 v96, v98
  v_permlane16_swap_b32 v97, v99
  v_permlane16_swap_b32 v100, v102
  v_permlane16_swap_b32 v101, v103
  v_permlane16_swap_b32 v104, v106
  v_permlane16_swap_b32 v105, v107
  v_permlane16_swap_b32 v108, v110
  v_permlane16_swap_b32 v109, v111
  v_xor_b32 v116, 32, v115
  v_xor_b32 v121, 32, v114
  v_xor_b32 v117, 64, v115
  v_xor_b32 v122, 64, v114
  v_xor_b32 v118, 96, v115
  v_xor_b32 v123, 96, v114
  v_mov_b32 v120, v114
  s_mov_b32 s39, 0
k2_poll:
  buffer_load_dwordx2 v[32:33], v113, s[12:15], 0 offen sc0 sc1
  buffer_load_dwordx2 v[34:35], v184, s[12:15], 0 offen sc0 sc1
  buffer_load_dwordx2 v[36:37], v185, s[12:15], 0 offen sc0 sc1
  buffer_load_dwordx2 v[38:39], v186, s[12:15], 0 offen sc0 sc1
  buffer_load_dwordx2 v[40:41], v187, s[12:15], 0 offen sc0 sc1
  buffer_load_dwordx2 v[42:43], v188, s[12:15], 0 offen sc0 sc1
  buffer_load_dwordx2 v[44:45], v189, s[12:15], 0 offen sc0 sc1
  buffer_load_dwordx2 v[46:47], v190, s[12:15], 0 offen sc0 sc1
  s_waitcnt vmcnt(0)
  v_min3_i32 v16, v33, v35, v37
  v_min3_i32 v17, v39, v41, v43
  v_min3_i32 v16, v16, v45, v47
  v_min_i32 v16, v16, v17
  v_cmp_gt_i32 vcc, 0, v16
  s_add_u32 s39, s39, 1
  s_cmp_gt_u32 s39, 1000000
  s_cbranch_scc1 k2_pdone
  s_cbranch_vccnz k2_poll
k2_pdone:
  buffer_store_dwordx4 v[96:99], v12, s[20:23], 0 offen offset:0 sc0 sc1
  buffer_store_dwordx4 v[100:103], v12, s[20:23], 0 offen offset:64 sc0 sc1
  buffer_store_dwordx4 v[104:107], v12, s[20:23], 0 offen offset:2048 sc0 sc1
  buffer_store_dwordx4 v[108:111], v12, s[20:23], 0 offen offset:2112 sc0 sc1
  v_pk_add_f32 v[32:33], v[32:33], v[34:35]
  v_pk_add_f32 v[36:37], v[36:37], v[38:39]
  v_pk_add_f32 v[40:41], v[40:41], v[42:43]
  v_pk_add_f32 v[44:45], v[44:45], v[46:47]
  v_pk_add_f32 v[32:33], v[32:33], v[36:37]
  v_pk_add_f32 v[40:41], v[40:41], v[44:45]
  v_pk_add_f32 v[32:33], v[32:33], v[40:41]
  v_mov_b32 v34, v32
  v_mov_b32 v35, v33
  s_nop 0
  v_permlane32_swap_b32 v32, v34
  v_permlane32_swap_b32 v33, v35
  v_add_f32 v32, v32, v34
  v_add_f32 v33, v33, v35
  v_mul_f32 v32, 0x3a800000, v32
  v_mul_f32 v33, 0x3a800000, v33
  v_fma_f32 v33, -v32, v32, v33
  v_max_f32 v33, 0, v33
  v_mov_b32 v36, v33
  v_cvt_pk_bf16_f32 v36, v36, v36
  v_lshlrev_b32 v36, 16, v36
  v_add_f32 v36, 0x3727c5ac, v36
  v_cvt_pk_bf16_f32 v36, v36, v36
  v_lshlrev_b32 v36, 16, v36
  v_sqrt_f32 v36, v36
  s_nop 0
  v_cvt_pk_bf16_f32 v36, v36, v36
  v_lshlrev_b32 v36, 16, v36
  v_rcp_f32 v36, v36
  s_nop 0
  v_mul_f32 v33, v33, v36
  v_mul_f32 v33, v33, v36
  v_cvt_pk_bf16_f32 v33, v33, v33
  v_lshlrev_b32 v33, 16, v33
  v_add_f32 v33, 0x3727c5ac, v33
  v_cvt_pk_bf16_f32 v33, v33, v33
  v_lshlrev_b32 v33, 16, v33
  v_sqrt_f32 v33, v33
  s_nop 0
  v_cvt_pk_bf16_f32 v33, v33, v33
  v_lshlrev_b32 v33, 16, v33
  v_rcp_f32 v33, v33
  s_nop 0
  v_mul_f32 v33, v33, v36
  v_mov_b32 v34, v32
  v_mov_b32 v35, v33
  s_nop 0
  v_permlane16_swap_b32 v32, v34
  v_permlane16_swap_b32 v33, v35
  v_pk_add_f32 v[48:49], v[48:49], v[32:33] op_sel_hi:[1,0] neg_lo:[0,1] neg_hi:[0,1]
  v_pk_add_f32 v[50:51], v[50:51], v[32:33] op_sel_hi:[1,0] neg_lo:[0,1] neg_hi:[0,1]
  v_pk_add_f32 v[52:53], v[52:53], v[32:33] op_sel_hi:[1,0] neg_lo:[0,1] neg_hi:[0,1]
  v_pk_add_f32 v[54:55], v[54:55], v[32:33] op_sel_hi:[1,0] neg_lo:[0,1] neg_hi:[0,1]
  v_pk_add_f32 v[56:57], v[56:57], v[32:33] op_sel_hi:[1,0] neg_lo:[0,1] neg_hi:[0,1]
  v_pk_add_f32 v[58:59], v[58:59], v[32:33] op_sel_hi:[1,0] neg_lo:[0,1] neg_hi:[0,1]
  v_pk_add_f32 v[60:61], v[60:61], v[32:33] op_sel_hi:[1,0] neg_lo:[0,1] neg_hi:[0,1]
  v_pk_add_f32 v[62:63], v[62:63], v[32:33] op_sel_hi:[1,0] neg_lo:[0,1] neg_hi:[0,1]
  v_pk_mul_f32 v[48:49], v[48:49], v[32:33] op_sel:[0,1] op_sel_hi:[1,1]
  v_pk_mul_f32 v[50:51], v[50:51], v[32:33] op_sel:[0,1] op_sel_hi:[1,1]
  v_pk_mul_f32 v[52:53], v[52:53], v[32:33] op_sel:[0,1] op_sel_hi:[1,1]
  v_pk_mul_f32 v[54:55], v[54:55], v[32:33] op_sel:[0,1] op_sel_hi:[1,1]
  v_pk_mul_f32 v[56:57], v[56:57], v[32:33] op_sel:[0,1] op_sel_hi:[1,1]
  v_pk_mul_f32 v[58:59], v[58:59], v[32:33] op_sel:[0,1] op_sel_hi:[1,1]
  v_pk_mul_f32 v[60:61], v[60:61], v[32:33] op_sel:[0,1] op_sel_hi:[1,1]
  v_pk_mul_f32 v[62:63], v[62:63], v[32:33] op_sel:[0,1] op_sel_hi:[1,1]
  v_cvt_pk_bf16_f32 v160, v48, v49
  v_cvt_pk_bf16_f32 v161, v50, v51
  ds_write_b64 v120, v[160:161] offset:0
  v_cvt_pk_bf16_f32 v162, v52, v53
  v_cvt_pk_bf16_f32 v163, v54, v55
  ds_write_b64 v121, v[162:163] offset:0
  v_cvt_pk_bf16_f32 v164, v56, v57
  v_cvt_pk_bf16_f32 v165, v58, v59
  ds_write_b64 v122, v[164:165] offset:0
  v_cvt_pk_bf16_f32 v166, v60, v61
  v_cvt_pk_bf16_f32 v167, v62, v63
  ds_write_b64 v123, v[166:167] offset:0
  v_pk_add_f32 v[64:65], v[64:65], v[34:35] op_sel_hi:[1,0] neg_lo:[0,1] neg_hi:[0,1]
  v_pk_add_f32 v[66:67], v[66:67], v[34:35] op_sel_hi:[1,0] neg_lo:[0,1] neg_hi:[0,1]
  v_pk_add_f32 v[68:69], v[68:69], v[34:35] op_sel_hi:[1,0] neg_lo:[0,1] neg_hi:[0,1]
  v_pk_add_f32 v[70:71], v[70:71], v[34:35] op_sel_hi:[1,0] neg_lo:[0,1] neg_hi:[0,1]
  v_pk_add_f32 v[72:73], v[72:73], v[34:35] op_sel_hi:[1,0] neg_lo:[0,1] neg_hi:[0,1]
  v_pk_add_f32 v[74:75], v[74:75], v[34:35] op_sel_hi:[1,0] neg_lo:[0,1] neg_hi:[0,1]
  v_pk_add_f32 v[76:77], v[76:77], v[34:35] op_sel_hi:[1,0] neg_lo:[0,1] neg_hi:[0,1]
  v_pk_add_f32 v[78:79], v[78:79], v[34:35] op_sel_hi:[1,0] neg_lo:[0,1] neg_hi:[0,1]
  v_pk_mul_f32 v[64:65], v[64:65], v[34:35] op_sel:[0,1] op_sel_hi:[1,1]
  v_pk_mul_f32 v[66:67], v[66:67], v[34:35] op_sel:[0,1] op_sel_hi:[1,1]
  v_pk_mul_f32 v[68:69], v[68:69], v[34:35] op_sel:[0,1] op_sel_hi:[1,1]
  v_pk_mul_f32 v[70:71], v[70:71], v[34:35] op_sel:[0,1] op_sel_hi:[1,1]
  v_pk_mul_f32 v[72:73], v[72:73], v[34:35] op_sel:[0,1] op_sel_hi:[1,1]
  v_pk_mul_f32 v[74:75], v[74:75], v[34:35] op_sel:[0,1] op_sel_hi:[1,1]
  v_pk_mul_f32 v[76:77], v[76:77], v[34:35] op_sel:[0,1] op_sel_hi:[1,1]
  v_pk_mul_f32 v[78:79], v[78:79], v[34:35] op_sel:[0,1] op_sel_hi:[1,1]
  v_cvt_pk_bf16_f32 v168, v64, v65
  v_cvt_pk_bf16_f32 v169, v66, v67
  ds_write_b64 v120, v[168:169] offset:128
  v_cvt_pk_bf16_f32 v170, v68, v69
  v_cvt_pk_bf16_f32 v171, v70, v71
  ds_write_b64 v121, v[170:171] offset:128
  v_cvt_pk_bf16_f32 v172, v72, v73
  v_cvt_pk_bf16_f32 v173, v74, v75
  ds_write_b64 v122, v[172:173] offset:128
  v_cvt_pk_bf16_f32 v174, v76, v77
  v_cvt_pk_bf16_f32 v175, v78, v79
  ds_write_b64 v123, v[174:175] offset:128
  s_waitcnt lgkmcnt(0)
  ds_read_b64_tr_b16 v[176:177], v115
  ds_read_b64_tr_b16 v[178:179], v115 offset:512
  ds_read_b64_tr_b16 v[180:181], v116
  ds_read_b64_tr_b16 v[182:183], v116 offset:512
  ds_read_b64_tr_b16 v[184:185], v117
  ds_read_b64_tr_b16 v[186:187], v117 offset:512
  ds_read_b64_tr_b16 v[188:189], v118
  ds_read_b64_tr_b16 v[190:191], v118 offset:512
  s_waitcnt lgkmcnt(6)
  buffer_store_dwordx4 v[176:179], v14, s[24:27], s44 offen sc0 sc1
  s_waitcnt lgkmcnt(4)
  buffer_store_dwordx4 v[180:183], v14, s[24:27], s45 offen sc0 sc1
  s_waitcnt lgkmcnt(2)
  buffer_store_dwordx4 v[184:187], v14, s[24:27], s46 offen sc0 sc1
  s_waitcnt lgkmcnt(0)
  buffer_store_dwordx4 v[188:191], v14, s[24:27], s47 offen sc0 sc1
  s_cmp_ge_u32 s2, 224
  s_cbranch_scc1 C_k3skip
  s_lshr_b32 s32, s2, 3
  s_mul_i32 s5, s32, 9363
  s_lshr_b32 s5, s5, 16
  s_mul_i32 s6, s5, 7
  s_sub_u32 s6, s32, s6
  s_lshl_b32 s7, s5, 1
  s_add_u32 s7, s7, s6
  s_and_b32 s7, s7, 7
  s_and_b32 s32, s2, 7
  s_lshr_b32 s28, s32, 2
  s_lshl_b32 s28, s28, 2
  s_add_u32 s28, s28, s5
  s_and_b32 s29, s32, 3
  s_mul_i32 s29, s29, 7
  s_add_u32 s29, s29, s6
  s_mov_b32 s30, 7
  s_mov_b32 s31, -1
  s_and_b32 s46, s4, 1
  s_lshr_b32 s41, s4, 1
  s_lshl_b32 s32, s29, 8
  s_lshl_b32 s44, s46, 7
  s_add_u32 s32, s32, s44
  v_lshlrev_b32 v16, 3, v5
  v_add_u32 v16, s32, v16
  s_mov_b32 s16, s74
  s_mov_b32 s17, s75
  s_mov_b32 s18, 7168
  s_mov_b32 s19, 0x20000
  buffer_load_dwordx2 v[144:145], v16, s[16:19], 0 offen offset:0
  buffer_load_dwordx2 v[146:147], v16, s[16:19], 0 offen offset:32
  buffer_load_dwordx2 v[148:149], v16, s[16:19], 0 offen offset:64
  buffer_load_dwordx2 v[150:151], v16, s[16:19], 0 offen offset:96
  s_add_u32 s20, s82, 12582912
  s_addc_u32 s21, s83, 0
  s_mov_b32 s22, 7340032
  s_mov_b32 s23, 0x20000
  v_lshl_add_u32 v17, v5, 3, v6
  v_lshlrev_b32 v17, 8, v17
  v_lshl_add_u32 v17, v7, 3, v17
  v_lshl_or_b32 v18, v2, 2, v6
  v_lshl_add_u32 v17, v18, 5, v17
  s_lshl_b32 s32, s46, 7
  s_add_u32 s32, s32, 16384
  v_xor_b32 v18, s32, v17
  s_lshl_b32 s32, s41, 13
  v_add_u32 v12, s32, v14
  v_xor_b32 v8, 0, v18
  v_xor_b32 v9, 32, v18
  v_xor_b32 v10, 64, v18
  v_xor_b32 v11, 96, v18
  v_bfe_u32 v17, v4, 2, 1
  v_lshlrev_b32 v17, 10, v17
  v_lshl_add_u32 v17, v3, 8, v17
  v_lshrrev_b32 v18, 3, v4
  v_lshl_add_u32 v17, v18, 6, v17
  v_lshl_add_u32 v152, v7, 4, v17
  v_add_u32 v153, 128, v152
  s_lshl_b32 s32, s28, 1
  s_add_u32 s32, s32, s41
  s_mul_i32 s32, s32, 224
  s_lshl_b32 s44, s29, 2
  s_add_u32 s32, s32, s44
  s_lshl_b32 s44, s46, 1
  s_add_u32 s32, s32, s44
  s_lshl_b32 s44, s32, 11
  s_add_u32 s45, s44, 229376
  s_waitcnt vmcnt(0)
  s_barrier
  v_lshlrev_b32 v80, 16, v144
  v_and_b32 v81, 0xffff0000, v144
  v_lshlrev_b32 v82, 16, v145
  v_and_b32 v83, 0xffff0000, v145
  v_mov_b64 v[96:97], v[80:81]
  v_mov_b64 v[98:99], v[82:83]
  v_mov_b64 v[112:113], v[80:81]
  v_mov_b64 v[114:115], v[82:83]
  v_mov_b64 v[128:129], v[80:81]
  v_mov_b64 v[130:131], v[82:83]
  v_lshlrev_b32 v84, 16, v146
  v_and_b32 v85, 0xffff0000, v146
  v_lshlrev_b32 v86, 16, v147
  v_and_b32 v87, 0xffff0000, v147
  v_mov_b64 v[100:101], v[84:85]
  v_mov_b64 v[102:103], v[86:87]
  v_mov_b64 v[116:117], v[84:85]
  v_mov_b64 v[118:119], v[86:87]
  v_mov_b64 v[132:133], v[84:85]
  v_mov_b64 v[134:135], v[86:87]
  v_lshlrev_b32 v88, 16, v148
  v_and_b32 v89, 0xffff0000, v148
  v_lshlrev_b32 v90, 16, v149
  v_and_b32 v91, 0xffff0000, v149
  v_mov_b64 v[104:105], v[88:89]
  v_mov_b64 v[106:107], v[90:91]
  v_mov_b64 v[120:121], v[88:89]
  v_mov_b64 v[122:123], v[90:91]
  v_mov_b64 v[136:137], v[88:89]
  v_mov_b64 v[138:139], v[90:91]
  v_lshlrev_b32 v92, 16, v150
  v_and_b32 v93, 0xffff0000, v150
  v_lshlrev_b32 v94, 16, v151
  v_and_b32 v95, 0xffff0000, v151
  v_mov_b64 v[108:109], v[92:93]
  v_mov_b64 v[110:111], v[94:95]
  v_mov_b64 v[124:125], v[92:93]
  v_mov_b64 v[126:127], v[94:95]
  v_mov_b64 v[140:141], v[92:93]
  v_mov_b64 v[142:143], v[94:95]
  s_barrier
  s_mov_b32 s43, 0
  s_mov_b32 s39, 31
  s_barrier
  ds_read_b64_tr_b16 v[16:17], v8 offset:0
  ds_read_b64_tr_b16 v[18:19], v8 offset:1024
  ds_read_b128 v[32:35], v12 offset:0
  ds_read_b128 v[36:39], v12 offset:2048
  ds_read_b64_tr_b16 v[20:21], v9 offset:0
  ds_read_b64_tr_b16 v[22:23], v9 offset:1024
  ds_read_b64_tr_b16 v[24:25], v10 offset:0
  ds_read_b64_tr_b16 v[26:27], v10 offset:1024
  ds_read_b128 v[40:43], v12 offset:4096
  ds_read_b128 v[44:47], v12 offset:6144
  ds_read_b64_tr_b16 v[28:29], v11 offset:0
  ds_read_b64_tr_b16 v[30:31], v11 offset:1024
  s_add_u32 s40, s43, 32768
  s_cmp_eq_u32 s40, 163840
  s_cselect_b32 s40, 0, s40
  s_sub_u32 s42, s40, s43
  s_mov_b32 s43, s40
cl3:
  s_waitcnt lgkmcnt(9)
  v_mfma_f32_16x16x32_bf16 v[80:83], v[16:19], v[32:35], v[80:83]
  ds_read_b64_tr_b16 v[48:49], v8 offset:8192
  s_waitcnt lgkmcnt(9)
  v_mfma_f32_16x16x32_bf16 v[96:99], v[16:19], v[36:39], v[96:99]
  ds_read_b64_tr_b16 v[50:51], v8 offset:9216
  v_add_u32 v8, s42, v8
  s_waitcnt lgkmcnt(8)
  v_mfma_f32_16x16x32_bf16 v[100:103], v[20:23], v[36:39], v[100:103]
  ds_read_b128 v[64:67], v12 offset:1024
  v_mfma_f32_16x16x32_bf16 v[84:87], v[20:23], v[32:35], v[84:87]
  ds_read_b128 v[68:71], v12 offset:3072
  s_waitcnt lgkmcnt(8)
  v_mfma_f32_16x16x32_bf16 v[88:91], v[24:27], v[32:35], v[88:91]
  ds_read_b64_tr_b16 v[52:53], v9 offset:8192
  v_mfma_f32_16x16x32_bf16 v[104:107], v[24:27], v[36:39], v[104:107]
  ds_read_b64_tr_b16 v[54:55], v9 offset:9216
  v_add_u32 v9, s42, v9
  s_waitcnt lgkmcnt(9)
  v_mfma_f32_16x16x32_bf16 v[120:123], v[24:27], v[40:43], v[120:123]
  ds_read_b64_tr_b16 v[56:57], v10 offset:8192
  v_mfma_f32_16x16x32_bf16 v[116:119], v[20:23], v[40:43], v[116:119]
  ds_read_b64_tr_b16 v[58:59], v10 offset:9216
  v_add_u32 v10, s42, v10
  v_mfma_f32_16x16x32_bf16 v[112:115], v[16:19], v[40:43], v[112:115]
  ds_read_b128 v[72:75], v12 offset:5120
  s_waitcnt lgkmcnt(11)
  v_mfma_f32_16x16x32_bf16 v[128:131], v[16:19], v[44:47], v[128:131]
  ds_read_b128 v[76:79], v12 offset:7168
  v_add_u32 v12, s42, v12
  v_mfma_f32_16x16x32_bf16 v[132:135], v[20:23], v[44:47], v[132:135]
  ds_read_b64_tr_b16 v[60:61], v11 offset:8192
  v_mfma_f32_16x16x32_bf16 v[136:139], v[24:27], v[44:47], v[136:139]
  ds_read_b64_tr_b16 v[62:63], v11 offset:9216
  v_add_u32 v11, s42, v11
  s_waitcnt lgkmcnt(12)
  v_mfma_f32_16x16x32_bf16 v[140:143], v[28:31], v[44:47], v[140:143]
  v_mfma_f32_16x16x32_bf16 v[124:127], v[28:31], v[40:43], v[124:127]
  v_mfma_f32_16x16x32_bf16 v[108:111], v[28:31], v[36:39], v[108:111]
  v_mfma_f32_16x16x32_bf16 v[92:95], v[28:31], v[32:35], v[92:95]
  s_barrier
  s_waitcnt lgkmcnt(9)
  v_mfma_f32_16x16x32_bf16 v[80:83], v[48:51], v[64:67], v[80:83]
  ds_read_b64_tr_b16 v[16:17], v8 offset:0
  s_add_u32 s40, s43, 32768
  s_waitcnt lgkmcnt(9)
  v_mfma_f32_16x16x32_bf16 v[96:99], v[48:51], v[68:71], v[96:99]
  ds_read_b64_tr_b16 v[18:19], v8 offset:1024
  s_cmp_eq_u32 s40, 163840
  s_waitcnt lgkmcnt(8)
  v_mfma_f32_16x16x32_bf16 v[100:103], v[52:55], v[68:71], v[100:103]
  ds_read_b128 v[32:35], v12 offset:0
  s_cselect_b32 s40, 0, s40
  v_mfma_f32_16x16x32_bf16 v[84:87], v[52:55], v[64:67], v[84:87]
  ds_read_b128 v[36:39], v12 offset:2048
  s_sub_u32 s42, s40, s43
  s_waitcnt lgkmcnt(8)
  v_mfma_f32_16x16x32_bf16 v[88:91], v[56:59], v[64:67], v[88:91]
  ds_read_b64_tr_b16 v[20:21], v9 offset:0
  s_mov_b32 s43, s40
  v_mfma_f32_16x16x32_bf16 v[104:107], v[56:59], v[68:71], v[104:107]
  ds_read_b64_tr_b16 v[22:23], v9 offset:1024
  s_waitcnt lgkmcnt(9)
  v_mfma_f32_16x16x32_bf16 v[120:123], v[56:59], v[72:75], v[120:123]
  ds_read_b64_tr_b16 v[24:25], v10 offset:0
  v_mfma_f32_16x16x32_bf16 v[116:119], v[52:55], v[72:75], v[116:119]
  ds_read_b64_tr_b16 v[26:27], v10 offset:1024
  v_mfma_f32_16x16x32_bf16 v[112:115], v[48:51], v[72:75], v[112:115]
  ds_read_b128 v[40:43], v12 offset:4096
  s_waitcnt lgkmcnt(11)
  v_mfma_f32_16x16x32_bf16 v[128:131], v[48:51], v[76:79], v[128:131]
  ds_read_b128 v[44:47], v12 offset:6144
  v_mfma_f32_16x16x32_bf16 v[132:135], v[52:55], v[76:79], v[132:135]
  ds_read_b64_tr_b16 v[28:29], v11 offset:0
  v_mfma_f32_16x16x32_bf16 v[136:139], v[56:59], v[76:79], v[136:139]
  ds_read_b64_tr_b16 v[30:31], v11 offset:1024
  s_waitcnt lgkmcnt(12)
  v_mfma_f32_16x16x32_bf16 v[140:143], v[60:63], v[76:79], v[140:143]
  v_mfma_f32_16x16x32_bf16 v[124:127], v[60:63], v[72:75], v[124:127]
  v_mfma_f32_16x16x32_bf16 v[108:111], v[60:63], v[68:71], v[108:111]
  v_mfma_f32_16x16x32_bf16 v[92:95], v[60:63], v[64:67], v[92:95]
  s_sub_u32 s39, s39, 1
  s_cmp_lg_u32 s39, 0
  s_cbranch_scc1 cl3
  s_waitcnt lgkmcnt(9)
  v_mfma_f32_16x16x32_bf16 v[80:83], v[16:19], v[32:35], v[80:83]
  ds_read_b64_tr_b16 v[48:49], v8 offset:8192
  s_waitcnt lgkmcnt(9)
  v_mfma_f32_16x16x32_bf16 v[96:99], v[16:19], v[36:39], v[96:99]
  ds_read_b64_tr_b16 v[50:51], v8 offset:9216
  s_waitcnt lgkmcnt(8)
  v_mfma_f32_16x16x32_bf16 v[100:103], v[20:23], v[36:39], v[100:103]
  ds_read_b128 v[64:67], v12 offset:1024
  v_mfma_f32_16x16x32_bf16 v[84:87], v[20:23], v[32:35], v[84:87]
  ds_read_b128 v[68:71], v12 offset:3072
  s_waitcnt lgkmcnt(8)
  v_mfma_f32_16x16x32_bf16 v[88:91], v[24:27], v[32:35], v[88:91]
  ds_read_b64_tr_b16 v[52:53], v9 offset:8192
  v_mfma_f32_16x16x32_bf16 v[104:107], v[24:27], v[36:39], v[104:107]
  ds_read_b64_tr_b16 v[54:55], v9 offset:9216
  s_waitcnt lgkmcnt(9)
  v_mfma_f32_16x16x32_bf16 v[120:123], v[24:27], v[40:43], v[120:123]
  ds_read_b64_tr_b16 v[56:57], v10 offset:8192
  v_mfma_f32_16x16x32_bf16 v[116:119], v[20:23], v[40:43], v[116:119]
  ds_read_b64_tr_b16 v[58:59], v10 offset:9216
  v_mfma_f32_16x16x32_bf16 v[112:115], v[16:19], v[40:43], v[112:115]
  ds_read_b128 v[72:75], v12 offset:5120
  s_waitcnt lgkmcnt(11)
  v_mfma_f32_16x16x32_bf16 v[128:131], v[16:19], v[44:47], v[128:131]
  ds_read_b128 v[76:79], v12 offset:7168
  v_mfma_f32_16x16x32_bf16 v[132:135], v[20:23], v[44:47], v[132:135]
  ds_read_b64_tr_b16 v[60:61], v11 offset:8192
  v_mfma_f32_16x16x32_bf16 v[136:139], v[24:27], v[44:47], v[136:139]
  ds_read_b64_tr_b16 v[62:63], v11 offset:9216
  s_waitcnt lgkmcnt(12)
  v_mfma_f32_16x16x32_bf16 v[140:143], v[28:31], v[44:47], v[140:143]
  v_mfma_f32_16x16x32_bf16 v[124:127], v[28:31], v[40:43], v[124:127]
  v_mfma_f32_16x16x32_bf16 v[108:111], v[28:31], v[36:39], v[108:111]
  v_mfma_f32_16x16x32_bf16 v[92:95], v[28:31], v[32:35], v[92:95]
  s_waitcnt lgkmcnt(9)
  v_mfma_f32_16x16x32_bf16 v[80:83], v[48:51], v[64:67], v[80:83]
  s_waitcnt lgkmcnt(8)
  v_mfma_f32_16x16x32_bf16 v[96:99], v[48:51], v[68:71], v[96:99]
  s_waitcnt lgkmcnt(6)
  v_mfma_f32_16x16x32_bf16 v[100:103], v[52:55], v[68:71], v[100:103]
  v_mfma_f32_16x16x32_bf16 v[84:87], v[52:55], v[64:67], v[84:87]
  s_waitcnt lgkmcnt(4)
  v_mfma_f32_16x16x32_bf16 v[88:91], v[56:59], v[64:67], v[88:91]
  v_mfma_f32_16x16x32_bf16 v[104:107], v[56:59], v[68:71], v[104:107]
  s_waitcnt lgkmcnt(3)
  v_mfma_f32_16x16x32_bf16 v[120:123], v[56:59], v[72:75], v[120:123]
  v_mfma_f32_16x16x32_bf16 v[116:119], v[52:55], v[72:75], v[116:119]
  v_mfma_f32_16x16x32_bf16 v[112:115], v[48:51], v[72:75], v[112:115]
  s_waitcnt lgkmcnt(2)
  v_mfma_f32_16x16x32_bf16 v[128:131], v[48:51], v[76:79], v[128:131]
  v_mfma_f32_16x16x32_bf16 v[132:135], v[52:55], v[76:79], v[132:135]
  v_mfma_f32_16x16x32_bf16 v[136:139], v[56:59], v[76:79], v[136:139]
  s_waitcnt lgkmcnt(0)
  v_mfma_f32_16x16x32_bf16 v[140:143], v[60:63], v[76:79], v[140:143]
  v_mfma_f32_16x16x32_bf16 v[124:127], v[60:63], v[72:75], v[124:127]
  v_mfma_f32_16x16x32_bf16 v[108:111], v[60:63], v[68:71], v[108:111]
  v_mfma_f32_16x16x32_bf16 v[92:95], v[60:63], v[64:67], v[92:95]
  s_waitcnt lgkmcnt(0)
  v_mov_b32 v16, 0xc0135761
  v_mov_b32 v17, 0xbdd2d3e8
  v_pk_mul_f32 v[24:25], v[80:81], v[80:81]
  v_pk_mul_f32 v[26:27], v[82:83], v[82:83]
  v_pk_mul_f32 v[28:29], v[84:85], v[84:85]
  v_pk_mul_f32 v[30:31], v[86:87], v[86:87]
  v_pk_fma_f32 v[24:25], v[24:25], v[16:17], v[16:17] op_sel:[0,1,0] op_sel_hi:[1,1,0]
  v_pk_fma_f32 v[26:27], v[26:27], v[16:17], v[16:17] op_sel:[0,1,0] op_sel_hi:[1,1,0]
  v_pk_fma_f32 v[28:29], v[28:29], v[16:17], v[16:17] op_sel:[0,1,0] op_sel_hi:[1,1,0]
  v_pk_fma_f32 v[30:31], v[30:31], v[16:17], v[16:17] op_sel:[0,1,0] op_sel_hi:[1,1,0]
  v_pk_mul_f32 v[24:25], v[24:25], v[80:81]
  v_pk_mul_f32 v[26:27], v[26:27], v[82:83]
  v_pk_mul_f32 v[28:29], v[28:29], v[84:85]
  v_pk_mul_f32 v[30:31], v[30:31], v[86:87]
  v_exp_f32 v24, v24
  v_exp_f32 v25, v25
  v_exp_f32 v26, v26
  v_exp_f32 v27, v27
  v_exp_f32 v28, v28
  v_exp_f32 v29, v29
  v_exp_f32 v30, v30
  v_exp_f32 v31, v31
  v_pk_add_f32 v[24:25], v[24:25], 1.0 op_sel_hi:[1,0]
  v_pk_add_f32 v[26:27], v[26:27], 1.0 op_sel_hi:[1,0]
  v_pk_add_f32 v[28:29], v[28:29], 1.0 op_sel_hi:[1,0]
  v_pk_add_f32 v[30:31], v[30:31], 1.0 op_sel_hi:[1,0]
  v_rcp_f32 v24, v24
  v_rcp_f32 v25, v25
  v_rcp_f32 v26, v26
  v_rcp_f32 v27, v27
  v_rcp_f32 v28, v28
  v_rcp_f32 v29, v29
  v_rcp_f32 v30, v30
  v_rcp_f32 v31, v31
  v_pk_mul_f32 v[24:25], v[24:25], v[80:81]
  v_pk_mul_f32 v[26:27], v[26:27], v[82:83]
  v_pk_mul_f32 v[28:29], v[28:29], v[84:85]
  v_pk_mul_f32 v[30:31], v[30:31], v[86:87]
  v_cvt_pk_bf16_f32 v164, v24, v25
  v_cvt_pk_bf16_f32 v165, v26, v27
  v_cvt_pk_bf16_f32 v166, v28, v29
  v_cvt_pk_bf16_f32 v167, v30, v31
  s_nop 0
  v_permlane16_swap_b32 v164, v166
  v_permlane16_swap_b32 v165, v167
  buffer_store_dwordx4 v[164:167], v152, s[20:23], s44 offen offset:0 sc0 sc1
  v_pk_mul_f32 v[40:41], v[88:89], v[88:89]
  v_pk_mul_f32 v[42:43], v[90:91], v[90:91]
  v_pk_mul_f32 v[44:45], v[92:93], v[92:93]
  v_pk_mul_f32 v[46:47], v[94:95], v[94:95]
  v_pk_fma_f32 v[40:41], v[40:41], v[16:17], v[16:17] op_sel:[0,1,0] op_sel_hi:[1,1,0]
  v_pk_fma_f32 v[42:43], v[42:43], v[16:17], v[16:17] op_sel:[0,1,0] op_sel_hi:[1,1,0]
  v_pk_fma_f32 v[44:45], v[44:45], v[16:17], v[16:17] op_sel:[0,1,0] op_sel_hi:[1,1,0]
  v_pk_fma_f32 v[46:47], v[46:47], v[16:17], v[16:17] op_sel:[0,1,0] op_sel_hi:[1,1,0]
  v_pk_mul_f32 v[40:41], v[40:41], v[88:89]
  v_pk_mul_f32 v[42:43], v[42:43], v[90:91]
  v_pk_mul_f32 v[44:45], v[44:45], v[92:93]
  v_pk_mul_f32 v[46:47], v[46:47], v[94:95]
  v_exp_f32 v40, v40
  v_exp_f32 v41, v41
  v_exp_f32 v42, v42
  v_exp_f32 v43, v43
  v_exp_f32 v44, v44
  v_exp_f32 v45, v45
  v_exp_f32 v46, v46
  v_exp_f32 v47, v47
  v_pk_add_f32 v[40:41], v[40:41], 1.0 op_sel_hi:[1,0]
  v_pk_add_f32 v[42:43], v[42:43], 1.0 op_sel_hi:[1,0]
  v_pk_add_f32 v[44:45], v[44:45], 1.0 op_sel_hi:[1,0]
  v_pk_add_f32 v[46:47], v[46:47], 1.0 op_sel_hi:[1,0]
  v_rcp_f32 v40, v40
  v_rcp_f32 v41, v41
  v_rcp_f32 v42, v42
  v_rcp_f32 v43, v43
  v_rcp_f32 v44, v44
  v_rcp_f32 v45, v45
  v_rcp_f32 v46, v46
  v_rcp_f32 v47, v47
  v_pk_mul_f32 v[40:41], v[40:41], v[88:89]
  v_pk_mul_f32 v[42:43], v[42:43], v[90:91]
  v_pk_mul_f32 v[44:45], v[44:45], v[92:93]
  v_pk_mul_f32 v[46:47], v[46:47], v[94:95]
  v_cvt_pk_bf16_f32 v168, v40, v41
  v_cvt_pk_bf16_f32 v169, v42, v43
  v_cvt_pk_bf16_f32 v170, v44, v45
  v_cvt_pk_bf16_f32 v171, v46, v47
  s_nop 0
  v_permlane16_swap_b32 v168, v170
  v_permlane16_swap_b32 v169, v171
  buffer_store_dwordx4 v[168:171], v152, s[20:23], s44 offen offset:2048 sc0 sc1
  v_pk_mul_f32 v[24:25], v[96:97], v[96:97]
  v_pk_mul_f32 v[26:27], v[98:99], v[98:99]
  v_pk_mul_f32 v[28:29], v[100:101], v[100:101]
  v_pk_mul_f32 v[30:31], v[102:103], v[102:103]
  v_pk_fma_f32 v[24:25], v[24:25], v[16:17], v[16:17] op_sel:[0,1,0] op_sel_hi:[1,1,0]
  v_pk_fma_f32 v[26:27], v[26:27], v[16:17], v[16:17] op_sel:[0,1,0] op_sel_hi:[1,1,0]
  v_pk_fma_f32 v[28:29], v[28:29], v[16:17], v[16:17] op_sel:[0,1,0] op_sel_hi:[1,1,0]
  v_pk_fma_f32 v[30:31], v[30:31], v[16:17], v[16:17] op_sel:[0,1,0] op_sel_hi:[1,1,0]
  v_pk_mul_f32 v[24:25], v[24:25], v[96:97]
  v_pk_mul_f32 v[26:27], v[26:27], v[98:99]
  v_pk_mul_f32 v[28:29], v[28:29], v[100:101]
  v_pk_mul_f32 v[30:31], v[30:31], v[102:103]
  v_exp_f32 v24, v24
  v_exp_f32 v25, v25
  v_exp_f32 v26, v26
  v_exp_f32 v27, v27
  v_exp_f32 v28, v28
  v_exp_f32 v29, v29
  v_exp_f32 v30, v30
  v_exp_f32 v31, v31
  v_pk_add_f32 v[24:25], v[24:25], 1.0 op_sel_hi:[1,0]
  v_pk_add_f32 v[26:27], v[26:27], 1.0 op_sel_hi:[1,0]
  v_pk_add_f32 v[28:29], v[28:29], 1.0 op_sel_hi:[1,0]
  v_pk_add_f32 v[30:31], v[30:31], 1.0 op_sel_hi:[1,0]
  v_rcp_f32 v24, v24
  v_rcp_f32 v25, v25
  v_rcp_f32 v26, v26
  v_rcp_f32 v27, v27
  v_rcp_f32 v28, v28
  v_rcp_f32 v29, v29
  v_rcp_f32 v30, v30
  v_rcp_f32 v31, v31
  v_pk_mul_f32 v[24:25], v[24:25], v[96:97]
  v_pk_mul_f32 v[26:27], v[26:27], v[98:99]
  v_pk_mul_f32 v[28:29], v[28:29], v[100:101]
  v_pk_mul_f32 v[30:31], v[30:31], v[102:103]
  v_cvt_pk_bf16_f32 v172, v24, v25
  v_cvt_pk_bf16_f32 v173, v26, v27
  v_cvt_pk_bf16_f32 v174, v28, v29
  v_cvt_pk_bf16_f32 v175, v30, v31
  s_nop 0
  v_permlane16_swap_b32 v172, v174
  v_permlane16_swap_b32 v173, v175
  buffer_store_dwordx4 v[172:175], v153, s[20:23], s44 offen offset:0 sc0 sc1
  v_pk_mul_f32 v[40:41], v[104:105], v[104:105]
  v_pk_mul_f32 v[42:43], v[106:107], v[106:107]
  v_pk_mul_f32 v[44:45], v[108:109], v[108:109]
  v_pk_mul_f32 v[46:47], v[110:111], v[110:111]
  v_pk_fma_f32 v[40:41], v[40:41], v[16:17], v[16:17] op_sel:[0,1,0] op_sel_hi:[1,1,0]
  v_pk_fma_f32 v[42:43], v[42:43], v[16:17], v[16:17] op_sel:[0,1,0] op_sel_hi:[1,1,0]
  v_pk_fma_f32 v[44:45], v[44:45], v[16:17], v[16:17] op_sel:[0,1,0] op_sel_hi:[1,1,0]
  v_pk_fma_f32 v[46:47], v[46:47], v[16:17], v[16:17] op_sel:[0,1,0] op_sel_hi:[1,1,0]
  v_pk_mul_f32 v[40:41], v[40:41], v[104:105]
  v_pk_mul_f32 v[42:43], v[42:43], v[106:107]
  v_pk_mul_f32 v[44:45], v[44:45], v[108:109]
  v_pk_mul_f32 v[46:47], v[46:47], v[110:111]
  v_exp_f32 v40, v40
  v_exp_f32 v41, v41
  v_exp_f32 v42, v42
  v_exp_f32 v43, v43
  v_exp_f32 v44, v44
  v_exp_f32 v45, v45
  v_exp_f32 v46, v46
  v_exp_f32 v47, v47
  v_pk_add_f32 v[40:41], v[40:41], 1.0 op_sel_hi:[1,0]
  v_pk_add_f32 v[42:43], v[42:43], 1.0 op_sel_hi:[1,0]
  v_pk_add_f32 v[44:45], v[44:45], 1.0 op_sel_hi:[1,0]
  v_pk_add_f32 v[46:47], v[46:47], 1.0 op_sel_hi:[1,0]
  v_rcp_f32 v40, v40
  v_rcp_f32 v41, v41
  v_rcp_f32 v42, v42
  v_rcp_f32 v43, v43
  v_rcp_f32 v44, v44
  v_rcp_f32 v45, v45
  v_rcp_f32 v46, v46
  v_rcp_f32 v47, v47
  v_pk_mul_f32 v[40:41], v[40:41], v[104:105]
  v_pk_mul_f32 v[42:43], v[42:43], v[106:107]
  v_pk_mul_f32 v[44:45], v[44:45], v[108:109]
  v_pk_mul_f32 v[46:47], v[46:47], v[110:111]
  v_cvt_pk_bf16_f32 v176, v40, v41
  v_cvt_pk_bf16_f32 v177, v42, v43
  v_cvt_pk_bf16_f32 v178, v44, v45
  v_cvt_pk_bf16_f32 v179, v46, v47
  s_nop 0
  v_permlane16_swap_b32 v176, v178
  v_permlane16_swap_b32 v177, v179
  buffer_store_dwordx4 v[176:179], v153, s[20:23], s44 offen offset:2048 sc0 sc1
  v_pk_mul_f32 v[24:25], v[112:113], v[112:113]
  v_pk_mul_f32 v[26:27], v[114:115], v[114:115]
  v_pk_mul_f32 v[28:29], v[116:117], v[116:117]
  v_pk_mul_f32 v[30:31], v[118:119], v[118:119]
  v_pk_fma_f32 v[24:25], v[24:25], v[16:17], v[16:17] op_sel:[0,1,0] op_sel_hi:[1,1,0]
  v_pk_fma_f32 v[26:27], v[26:27], v[16:17], v[16:17] op_sel:[0,1,0] op_sel_hi:[1,1,0]
  v_pk_fma_f32 v[28:29], v[28:29], v[16:17], v[16:17] op_sel:[0,1,0] op_sel_hi:[1,1,0]
  v_pk_fma_f32 v[30:31], v[30:31], v[16:17], v[16:17] op_sel:[0,1,0] op_sel_hi:[1,1,0]
  v_pk_mul_f32 v[24:25], v[24:25], v[112:113]
  v_pk_mul_f32 v[26:27], v[26:27], v[114:115]
  v_pk_mul_f32 v[28:29], v[28:29], v[116:117]
  v_pk_mul_f32 v[30:31], v[30:31], v[118:119]
  v_exp_f32 v24, v24
  v_exp_f32 v25, v25
  v_exp_f32 v26, v26
  v_exp_f32 v27, v27
  v_exp_f32 v28, v28
  v_exp_f32 v29, v29
  v_exp_f32 v30, v30
  v_exp_f32 v31, v31
  v_pk_add_f32 v[24:25], v[24:25], 1.0 op_sel_hi:[1,0]
  v_pk_add_f32 v[26:27], v[26:27], 1.0 op_sel_hi:[1,0]
  v_pk_add_f32 v[28:29], v[28:29], 1.0 op_sel_hi:[1,0]
  v_pk_add_f32 v[30:31], v[30:31], 1.0 op_sel_hi:[1,0]
  v_rcp_f32 v24, v24
  v_rcp_f32 v25, v25
  v_rcp_f32 v26, v26
  v_rcp_f32 v27, v27
  v_rcp_f32 v28, v28
  v_rcp_f32 v29, v29
  v_rcp_f32 v30, v30
  v_rcp_f32 v31, v31
  v_pk_mul_f32 v[24:25], v[24:25], v[112:113]
  v_pk_mul_f32 v[26:27], v[26:27], v[114:115]
  v_pk_mul_f32 v[28:29], v[28:29], v[116:117]
  v_pk_mul_f32 v[30:31], v[30:31], v[118:119]
  v_cvt_pk_bf16_f32 v180, v24, v25
  v_cvt_pk_bf16_f32 v181, v26, v27
  v_cvt_pk_bf16_f32 v182, v28, v29
  v_cvt_pk_bf16_f32 v183, v30, v31
  s_nop 0
  v_permlane16_swap_b32 v180, v182
  v_permlane16_swap_b32 v181, v183
  buffer_store_dwordx4 v[180:183], v152, s[20:23], s45 offen offset:0 sc0 sc1
  v_pk_mul_f32 v[40:41], v[120:121], v[120:121]
  v_pk_mul_f32 v[42:43], v[122:123], v[122:123]
  v_pk_mul_f32 v[44:45], v[124:125], v[124:125]
  v_pk_mul_f32 v[46:47], v[126:127], v[126:127]
  v_pk_fma_f32 v[40:41], v[40:41], v[16:17], v[16:17] op_sel:[0,1,0] op_sel_hi:[1,1,0]
  v_pk_fma_f32 v[42:43], v[42:43], v[16:17], v[16:17] op_sel:[0,1,0] op_sel_hi:[1,1,0]
  v_pk_fma_f32 v[44:45], v[44:45], v[16:17], v[16:17] op_sel:[0,1,0] op_sel_hi:[1,1,0]
  v_pk_fma_f32 v[46:47], v[46:47], v[16:17], v[16:17] op_sel:[0,1,0] op_sel_hi:[1,1,0]
  v_pk_mul_f32 v[40:41], v[40:41], v[120:121]
  v_pk_mul_f32 v[42:43], v[42:43], v[122:123]
  v_pk_mul_f32 v[44:45], v[44:45], v[124:125]
  v_pk_mul_f32 v[46:47], v[46:47], v[126:127]
  v_exp_f32 v40, v40
  v_exp_f32 v41, v41
  v_exp_f32 v42, v42
  v_exp_f32 v43, v43
  v_exp_f32 v44, v44
  v_exp_f32 v45, v45
  v_exp_f32 v46, v46
  v_exp_f32 v47, v47
  v_pk_add_f32 v[40:41], v[40:41], 1.0 op_sel_hi:[1,0]
  v_pk_add_f32 v[42:43], v[42:43], 1.0 op_sel_hi:[1,0]
  v_pk_add_f32 v[44:45], v[44:45], 1.0 op_sel_hi:[1,0]
  v_pk_add_f32 v[46:47], v[46:47], 1.0 op_sel_hi:[1,0]
  v_rcp_f32 v40, v40
  v_rcp_f32 v41, v41
  v_rcp_f32 v42, v42
  v_rcp_f32 v43, v43
  v_rcp_f32 v44, v44
  v_rcp_f32 v45, v45
  v_rcp_f32 v46, v46
  v_rcp_f32 v47, v47
  v_pk_mul_f32 v[40:41], v[40:41], v[120:121]
  v_pk_mul_f32 v[42:43], v[42:43], v[122:123]
  v_pk_mul_f32 v[44:45], v[44:45], v[124:125]
  v_pk_mul_f32 v[46:47], v[46:47], v[126:127]
  v_cvt_pk_bf16_f32 v184, v40, v41
  v_cvt_pk_bf16_f32 v185, v42, v43
  v_cvt_pk_bf16_f32 v186, v44, v45
  v_cvt_pk_bf16_f32 v187, v46, v47
  s_nop 0
  v_permlane16_swap_b32 v184, v186
  v_permlane16_swap_b32 v185, v187
  buffer_store_dwordx4 v[184:187], v152, s[20:23], s45 offen offset:2048 sc0 sc1
  v_pk_mul_f32 v[24:25], v[128:129], v[128:129]
  v_pk_mul_f32 v[26:27], v[130:131], v[130:131]
  v_pk_mul_f32 v[28:29], v[132:133], v[132:133]
  v_pk_mul_f32 v[30:31], v[134:135], v[134:135]
  v_pk_fma_f32 v[24:25], v[24:25], v[16:17], v[16:17] op_sel:[0,1,0] op_sel_hi:[1,1,0]
  v_pk_fma_f32 v[26:27], v[26:27], v[16:17], v[16:17] op_sel:[0,1,0] op_sel_hi:[1,1,0]
  v_pk_fma_f32 v[28:29], v[28:29], v[16:17], v[16:17] op_sel:[0,1,0] op_sel_hi:[1,1,0]
  v_pk_fma_f32 v[30:31], v[30:31], v[16:17], v[16:17] op_sel:[0,1,0] op_sel_hi:[1,1,0]
  v_pk_mul_f32 v[24:25], v[24:25], v[128:129]
  v_pk_mul_f32 v[26:27], v[26:27], v[130:131]
  v_pk_mul_f32 v[28:29], v[28:29], v[132:133]
  v_pk_mul_f32 v[30:31], v[30:31], v[134:135]
  v_exp_f32 v24, v24
  v_exp_f32 v25, v25
  v_exp_f32 v26, v26
  v_exp_f32 v27, v27
  v_exp_f32 v28, v28
  v_exp_f32 v29, v29
  v_exp_f32 v30, v30
  v_exp_f32 v31, v31
  v_pk_add_f32 v[24:25], v[24:25], 1.0 op_sel_hi:[1,0]
  v_pk_add_f32 v[26:27], v[26:27], 1.0 op_sel_hi:[1,0]
  v_pk_add_f32 v[28:29], v[28:29], 1.0 op_sel_hi:[1,0]
  v_pk_add_f32 v[30:31], v[30:31], 1.0 op_sel_hi:[1,0]
  v_rcp_f32 v24, v24
  v_rcp_f32 v25, v25
  v_rcp_f32 v26, v26
  v_rcp_f32 v27, v27
  v_rcp_f32 v28, v28
  v_rcp_f32 v29, v29
  v_rcp_f32 v30, v30
  v_rcp_f32 v31, v31
  v_pk_mul_f32 v[24:25], v[24:25], v[128:129]
  v_pk_mul_f32 v[26:27], v[26:27], v[130:131]
  v_pk_mul_f32 v[28:29], v[28:29], v[132:133]
  v_pk_mul_f32 v[30:31], v[30:31], v[134:135]
  v_cvt_pk_bf16_f32 v188, v24, v25
  v_cvt_pk_bf16_f32 v189, v26, v27
  v_cvt_pk_bf16_f32 v190, v28, v29
  v_cvt_pk_bf16_f32 v191, v30, v31
  s_nop 0
  v_permlane16_swap_b32 v188, v190
  v_permlane16_swap_b32 v189, v191
  buffer_store_dwordx4 v[188:191], v153, s[20:23], s45 offen offset:0 sc0 sc1
  v_pk_mul_f32 v[40:41], v[136:137], v[136:137]
  v_pk_mul_f32 v[42:43], v[138:139], v[138:139]
  v_pk_mul_f32 v[44:45], v[140:141], v[140:141]
  v_pk_mul_f32 v[46:47], v[142:143], v[142:143]
  v_pk_fma_f32 v[40:41], v[40:41], v[16:17], v[16:17] op_sel:[0,1,0] op_sel_hi:[1,1,0]
  v_pk_fma_f32 v[42:43], v[42:43], v[16:17], v[16:17] op_sel:[0,1,0] op_sel_hi:[1,1,0]
  v_pk_fma_f32 v[44:45], v[44:45], v[16:17], v[16:17] op_sel:[0,1,0] op_sel_hi:[1,1,0]
  v_pk_fma_f32 v[46:47], v[46:47], v[16:17], v[16:17] op_sel:[0,1,0] op_sel_hi:[1,1,0]
  v_pk_mul_f32 v[40:41], v[40:41], v[136:137]
  v_pk_mul_f32 v[42:43], v[42:43], v[138:139]
  v_pk_mul_f32 v[44:45], v[44:45], v[140:141]
  v_pk_mul_f32 v[46:47], v[46:47], v[142:143]
  v_exp_f32 v40, v40
  v_exp_f32 v41, v41
  v_exp_f32 v42, v42
  v_exp_f32 v43, v43
  v_exp_f32 v44, v44
  v_exp_f32 v45, v45
  v_exp_f32 v46, v46
  v_exp_f32 v47, v47
  v_pk_add_f32 v[40:41], v[40:41], 1.0 op_sel_hi:[1,0]
  v_pk_add_f32 v[42:43], v[42:43], 1.0 op_sel_hi:[1,0]
  v_pk_add_f32 v[44:45], v[44:45], 1.0 op_sel_hi:[1,0]
  v_pk_add_f32 v[46:47], v[46:47], 1.0 op_sel_hi:[1,0]
  v_rcp_f32 v40, v40
  v_rcp_f32 v41, v41
  v_rcp_f32 v42, v42
  v_rcp_f32 v43, v43
  v_rcp_f32 v44, v44
  v_rcp_f32 v45, v45
  v_rcp_f32 v46, v46
  v_rcp_f32 v47, v47
  v_pk_mul_f32 v[40:41], v[40:41], v[136:137]
  v_pk_mul_f32 v[42:43], v[42:43], v[138:139]
  v_pk_mul_f32 v[44:45], v[44:45], v[140:141]
  v_pk_mul_f32 v[46:47], v[46:47], v[142:143]
  v_cvt_pk_bf16_f32 v192, v40, v41
  v_cvt_pk_bf16_f32 v193, v42, v43
  v_cvt_pk_bf16_f32 v194, v44, v45
  v_cvt_pk_bf16_f32 v195, v46, v47
  s_nop 0
  v_permlane16_swap_b32 v192, v194
  v_permlane16_swap_b32 v193, v195
  buffer_store_dwordx4 v[192:195], v153, s[20:23], s45 offen offset:2048 sc0 sc1
C_k3skip:
  s_nop 7
  s_nop 7
  s_lshr_b32 s32, s2, 3
  s_lshr_b32 s5, s32, 3
  s_and_b32 s6, s32, 7
  s_lshl_b32 s7, s5, 1
  s_add_u32 s7, s7, s6
  s_and_b32 s7, s7, 7
  s_and_b32 s32, s2, 7
  s_lshr_b32 s28, s32, 2
  s_lshl_b32 s28, s28, 2
  s_add_u32 s28, s28, s5
  s_and_b32 s29, s32, 3
  s_mul_i32 s29, s29, 8
  s_add_u32 s29, s29, s6
  s_mov_b32 s30, 7
  s_mov_b32 s31, -1
  s_lshl_b32 s32, s29, 6
  v_add_u32 v13, s32, v4
  v_lshlrev_b32 v12, 11, v13
  v_lshl_add_u32 v12, v5, 4, v12
  s_lshl_b32 s32, s28, 8
  s_lshl_b32 s40, s4, 6
  s_add_u32 s32, s32, s40
  v_add_u32 v12, s32, v12
  v_lshlrev_b32 v13, 1, v13
  v_lshlrev_b32 v14, 4, v0
  s_lshl_b32 s34, s28, 2
  s_add_u32 s34, s34, s4
  s_mul_i32 s34, s34, 229376
  s_mov_b32 s45, 32768
  s_mov_b32 s46, 65536
  s_mov_b32 s47, 98304
  s_add_u32 s8, s82, 12582912
  s_addc_u32 s9, s83, 0
  s_mov_b32 s10, 7340032
  s_mov_b32 s11, 0x20000
  s_add_u32 s16, s82, 4194304
  s_addc_u32 s17, s83, 0
  s_mov_b32 s18, 4194304
  s_mov_b32 s19, 0x20000
  s_mov_b32 s12, s78
  s_mov_b32 s13, s79
  s_mov_b32 s14, 4096
  s_mov_b32 s15, 0x20000
  buffer_load_ushort v112, v13, s[12:15], 0 offen offset:0
  buffer_load_ushort v114, v13, s[12:15], 0 offen offset:32
  buffer_load_ushort v116, v13, s[12:15], 0 offen offset:64
  buffer_load_ushort v118, v13, s[12:15], 0 offen offset:96
  v_lshl_add_u32 v16, v5, 3, v6
  v_lshlrev_b32 v16, 7, v16
  v_lshl_add_u32 v16, v7, 3, v16
  v_lshrrev_b32 v17, 1, v6
  v_lshl_or_b32 v17, v2, 1, v17
  v_lshl_add_u32 v16, v17, 5, v16
  v_add_u32 v16, 98304, v16
  v_xor_b32 v8, 0, v16
  v_xor_b32 v9, 32, v16
  v_xor_b32 v10, 64, v16
  v_xor_b32 v11, 96, v16
  s_lshl_b32 s48, 0x303, s7
  s_lshr_b32 s48, s48, 8
  s_mov_b32 s49, s34
  s_add_u32 s50, s34, 32768
  s_add_u32 s41, s34, 229376
  v_lshlrev_b32 v184, 3, v0
  s_lshl_b32 s32, s4, 9
  s_add_u32 s32, s32, 90112
  v_add_u32 v185, s32, v184
  s_add_u32 s24, s84, 29360128
  s_addc_u32 s25, s85, 0
  s_mov_b32 s26, 262144
  s_mov_b32 s27, 0x20000
  s_lshl_b32 s32, s28, 5
  v_min_u32 v15, 27, v0
  v_add_u32 v15, s32, v15
  v_max_i32 v15, 0, v15
  v_lshlrev_b32 v15, 7, v15
  s_lshl_b32 s55, s3, 17
  s_add_u32 s55, s55, 65536
  s_waitcnt vmcnt(0)
  s_barrier
  s_cmp_lt_u32 s2, 224
  s_cbranch_scc1 C_nopf
  s_cmp_lg_u32 s3, 0
  s_cbranch_scc1 C_nopf
  s_mov_b32 s20, s76
  s_mov_b32 s21, s77
  s_mov_b32 s22, 14680064
  s_mov_b32 s23, 0x20000
  s_sub_u32 s32, s2, 224
  s_lshl_b32 s32, s32, 2
  s_add_u32 s32, s32, s4
  s_lshl_b32 s32, s32, 13
  v_lshlrev_b32 v17, 7, v0
  s_sleep 127
  buffer_load_dword v18, v17, s[20:23], s32 offen
  s_add_u32 s32, s32, 1048576
  buffer_load_dword v18, v17, s[20:23], s32 offen
  s_add_u32 s32, s32, 1048576
  s_waitcnt vmcnt(1)
  buffer_load_dword v18, v17, s[20:23], s32 offen
  s_add_u32 s32, s32, 1048576
  s_waitcnt vmcnt(1)
  buffer_load_dword v18, v17, s[20:23], s32 offen
  s_add_u32 s32, s32, 1048576
  s_waitcnt vmcnt(1)
  buffer_load_dword v18, v17, s[20:23], s32 offen
  s_add_u32 s32, s32, 1048576
  s_waitcnt vmcnt(1)
  buffer_load_dword v18, v17, s[20:23], s32 offen
  s_add_u32 s32, s32, 1048576
  s_waitcnt vmcnt(1)
  buffer_load_dword v18, v17, s[20:23], s32 offen
  s_add_u32 s32, s32, 1048576
  s_waitcnt vmcnt(1)
  buffer_load_dword v18, v17, s[20:23], s32 offen
  s_add_u32 s32, s32, 1048576
  s_waitcnt vmcnt(1)
  buffer_load_dword v18, v17, s[20:23], s32 offen
  s_add_u32 s32, s32, 1048576
  s_waitcnt vmcnt(1)
  buffer_load_dword v18, v17, s[20:23], s32 offen
  s_add_u32 s32, s32, 1048576
  s_waitcnt vmcnt(1)
  buffer_load_dword v18, v17, s[20:23], s32 offen
  s_add_u32 s32, s32, 1048576
  s_waitcnt vmcnt(1)
  buffer_load_dword v18, v17, s[20:23], s32 offen
  s_add_u32 s32, s32, 1048576
  s_waitcnt vmcnt(1)
  buffer_load_dword v18, v17, s[20:23], s32 offen
  s_add_u32 s32, s32, 1048576
  s_waitcnt vmcnt(1)
  buffer_load_dword v18, v17, s[20:23], s32 offen
  s_add_u32 s32, s32, 1048576
  s_waitcnt vmcnt(1)
C_nopf:
  s_mov_b32 s39, 0
  s_and_b32 s32, s4, 3
  s_cmp_lg_u32 s32, 0
  s_cbranch_scc1 poll4d
  s_sleep 8
poll4:
  buffer_load_dword v16, v15, s[24:27], s55 offen sc0 sc1
  s_waitcnt vmcnt(0)
  v_cmp_eq_u32 vcc, 0, v16
  s_add_u32 s39, s39, 1
  s_cmp_gt_u32 s39, 1000000
  s_cbranch_scc1 poll4d
  s_cbranch_vccnz poll4
poll4d:
  s_barrier
  buffer_load_dwordx4 v[96:99], v12, s[16:19], 0 offen sc1
  buffer_load_dwordx4 v[100:103], v12, s[16:19], s45 offen sc1
  buffer_load_dwordx4 v[104:107], v12, s[16:19], s46 offen sc1
  buffer_load_dwordx4 v[108:111], v12, s[16:19], s47 offen sc1
  s_cmp_eq_u32 s3, 0
  s_cselect_b32 s24, s84, s80
  s_cselect_b32 s25, s85, s81
  s_cselect_b32 s26, 25165824, 0
  s_add_u32 s24, s24, s26
  s_addc_u32 s25, s25, 0
  s_mov_b32 s26, 4194304
  s_mov_b32 s27, 0x20000
  s_add_u32 s12, s84, 55574528
  s_addc_u32 s13, s85, 0
  s_mov_b32 s14, 131072
  s_mov_b32 s15, 0x20000
  s_bitcmp1_b32 s48, 0
  s_cselect_b32 s36, s50, s49
  s_add_u32 s36, s36, 0
  buffer_load_dwordx4 v[120:123], v14, s[8:11], s36 offen offset:0 sc1
  buffer_load_dwordx4 v[124:127], v14, s[8:11], s36 offen offset:1024 sc1
  buffer_load_dwordx4 v[128:131], v14, s[8:11], s36 offen offset:2048 sc1
  buffer_load_dwordx4 v[132:135], v14, s[8:11], s36 offen offset:3072 sc1
  s_bitcmp1_b32 s48, 1
  s_cselect_b32 s36, s50, s49
  s_add_u32 s36, s36, 4096
  buffer_load_dwordx4 v[136:139], v14, s[8:11], s36 offen offset:0 sc1
  buffer_load_dwordx4 v[140:143], v14, s[8:11], s36 offen offset:1024 sc1
  buffer_load_dwordx4 v[144:147], v14, s[8:11], s36 offen offset:2048 sc1
  buffer_load_dwordx4 v[148:151], v14, s[8:11], s36 offen offset:3072 sc1
  s_bitcmp1_b32 s48, 2
  s_cselect_b32 s36, s50, s49
  s_add_u32 s36, s36, 8192
  buffer_load_dwordx4 v[152:155], v14, s[8:11], s36 offen offset:0 sc1
  buffer_load_dwordx4 v[156:159], v14, s[8:11], s36 offen offset:1024 sc1
  buffer_load_dwordx4 v[160:163], v14, s[8:11], s36 offen offset:2048 sc1
  buffer_load_dwordx4 v[164:167], v14, s[8:11], s36 offen offset:3072 sc1
  s_bitcmp1_b32 s48, 3
  s_cselect_b32 s36, s50, s49
  s_add_u32 s36, s36, 12288
  buffer_load_dwordx4 v[168:171], v14, s[8:11], s36 offen offset:0 sc1
  buffer_load_dwordx4 v[172:175], v14, s[8:11], s36 offen offset:1024 sc1
  s_waitcnt vmcnt(14)
  v_lshlrev_b32 v112, 16, v112
  v_lshlrev_b32 v48, 16, v96
  v_and_b32 v49, 0xffff0000, v96
  v_lshlrev_b32 v50, 16, v97
  v_and_b32 v51, 0xffff0000, v97
  v_lshlrev_b32 v52, 16, v98
  v_and_b32 v53, 0xffff0000, v98
  v_lshlrev_b32 v54, 16, v99
  v_and_b32 v55, 0xffff0000, v99
  v_pk_add_f32 v[48:49], v[48:49], v[112:113] op_sel_hi:[1,0]
  v_pk_add_f32 v[50:51], v[50:51], v[112:113] op_sel_hi:[1,0]
  v_pk_add_f32 v[52:53], v[52:53], v[112:113] op_sel_hi:[1,0]
  v_pk_add_f32 v[54:55], v[54:55], v[112:113] op_sel_hi:[1,0]
  v_lshlrev_b32 v114, 16, v114
  v_lshlrev_b32 v56, 16, v100
  v_and_b32 v57, 0xffff0000, v100
  v_lshlrev_b32 v58, 16, v101
  v_and_b32 v59, 0xffff0000, v101
  v_lshlrev_b32 v60, 16, v102
  v_and_b32 v61, 0xffff0000, v102
  v_lshlrev_b32 v62, 16, v103
  v_and_b32 v63, 0xffff0000, v103
  v_pk_add_f32 v[56:57], v[56:57], v[114:115] op_sel_hi:[1,0]
  v_pk_add_f32 v[58:59], v[58:59], v[114:115] op_sel_hi:[1,0]
  v_pk_add_f32 v[60:61], v[60:61], v[114:115] op_sel_hi:[1,0]
  v_pk_add_f32 v[62:63], v[62:63], v[114:115] op_sel_hi:[1,0]
  v_lshlrev_b32 v116, 16, v116
  v_lshlrev_b32 v64, 16, v104
  v_and_b32 v65, 0xffff0000, v104
  v_lshlrev_b32 v66, 16, v105
  v_and_b32 v67, 0xffff0000, v105
  v_lshlrev_b32 v68, 16, v106
  v_and_b32 v69, 0xffff0000, v106
  v_lshlrev_b32 v70, 16, v107
  v_and_b32 v71, 0xffff0000, v107
  v_pk_add_f32 v[64:65], v[64:65], v[116:117] op_sel_hi:[1,0]
  v_pk_add_f32 v[66:67], v[66:67], v[116:117] op_sel_hi:[1,0]
  v_pk_add_f32 v[68:69], v[68:69], v[116:117] op_sel_hi:[1,0]
  v_pk_add_f32 v[70:71], v[70:71], v[116:117] op_sel_hi:[1,0]
  v_lshlrev_b32 v118, 16, v118
  v_lshlrev_b32 v72, 16, v108
  v_and_b32 v73, 0xffff0000, v108
  v_lshlrev_b32 v74, 16, v109
  v_and_b32 v75, 0xffff0000, v109
  v_lshlrev_b32 v76, 16, v110
  v_and_b32 v77, 0xffff0000, v110
  v_lshlrev_b32 v78, 16, v111
  v_and_b32 v79, 0xffff0000, v111
  v_pk_add_f32 v[72:73], v[72:73], v[118:119] op_sel_hi:[1,0]
  v_pk_add_f32 v[74:75], v[74:75], v[118:119] op_sel_hi:[1,0]
  v_pk_add_f32 v[76:77], v[76:77], v[118:119] op_sel_hi:[1,0]
  v_pk_add_f32 v[78:79], v[78:79], v[118:119] op_sel_hi:[1,0]
  s_mov_b32 s43, 0
  s_mov_b32 s39, 6
  s_barrier
  ds_read_b64_tr_b16 v[16:17], v8 offset:0
  ds_read_b64_tr_b16 v[18:19], v8 offset:512
  ds_read_b64_tr_b16 v[20:21], v9 offset:0
  ds_read_b64_tr_b16 v[22:23], v9 offset:512
  ds_read_b64_tr_b16 v[24:25], v10 offset:0
  ds_read_b64_tr_b16 v[26:27], v10 offset:512
  ds_read_b64_tr_b16 v[28:29], v11 offset:0
  ds_read_b64_tr_b16 v[30:31], v11 offset:512
  s_add_u32 s40, s43, 8192
  s_cmp_eq_u32 s40, 65536
  s_cselect_b32 s40, 0, s40
  s_sub_u32 s42, s40, s43
  s_mov_b32 s43, s40
cd5:
  s_waitcnt vmcnt(13) lgkmcnt(6)
  v_mfma_f32_16x16x32_bf16 v[48:51], v[120:123], v[16:19], v[48:51]
  ds_read_b64_tr_b16 v[32:33], v8 offset:4096
  s_waitcnt vmcnt(12)
  v_mfma_f32_16x16x32_bf16 v[52:55], v[124:127], v[16:19], v[52:55]
  ds_read_b64_tr_b16 v[34:35], v8 offset:4608
  v_add_u32 v8, s42, v8
  s_waitcnt lgkmcnt(6)
  v_mfma_f32_16x16x32_bf16 v[60:63], v[124:127], v[20:23], v[60:63]
  ds_read_b64_tr_b16 v[36:37], v9 offset:4096
  buffer_load_dwordx4 v[176:179], v14, s[8:11], s36 offen offset:2048 sc1
  v_mfma_f32_16x16x32_bf16 v[56:59], v[120:123], v[20:23], v[56:59]
  ds_read_b64_tr_b16 v[38:39], v9 offset:4608
  v_add_u32 v9, s42, v9
  s_waitcnt lgkmcnt(6)
  v_mfma_f32_16x16x32_bf16 v[64:67], v[120:123], v[24:27], v[64:67]
  ds_read_b64_tr_b16 v[40:41], v10 offset:4096
  v_mfma_f32_16x16x32_bf16 v[68:71], v[124:127], v[24:27], v[68:71]
  ds_read_b64_tr_b16 v[42:43], v10 offset:4608
  v_add_u32 v10, s42, v10
  s_waitcnt lgkmcnt(6)
  v_mfma_f32_16x16x32_bf16 v[76:79], v[124:127], v[28:31], v[76:79]
  ds_read_b64_tr_b16 v[44:45], v11 offset:4096
  buffer_load_dwordx4 v[180:183], v14, s[8:11], s36 offen offset:3072 sc1
  v_mfma_f32_16x16x32_bf16 v[72:75], v[120:123], v[28:31], v[72:75]
  ds_read_b64_tr_b16 v[46:47], v11 offset:4608
  v_add_u32 v11, s42, v11
  s_barrier
  s_waitcnt vmcnt(13) lgkmcnt(6)
  v_mfma_f32_16x16x32_bf16 v[48:51], v[128:131], v[32:35], v[48:51]
  ds_read_b64_tr_b16 v[16:17], v8 offset:0
  s_bitcmp1_b32 s48, 4
  s_cselect_b32 s36, s50, s49
  s_waitcnt vmcnt(12)
  v_mfma_f32_16x16x32_bf16 v[52:55], v[132:135], v[32:35], v[52:55]
  ds_read_b64_tr_b16 v[18:19], v8 offset:512
  s_add_u32 s36, s36, 16384
  s_add_u32 s40, s43, 8192
  s_waitcnt lgkmcnt(6)
  v_mfma_f32_16x16x32_bf16 v[60:63], v[132:135], v[36:39], v[60:63]
  ds_read_b64_tr_b16 v[20:21], v9 offset:0
  s_cmp_eq_u32 s40, 65536
  s_cselect_b32 s40, 0, s40
  v_mfma_f32_16x16x32_bf16 v[56:59], v[128:131], v[36:39], v[56:59]
  ds_read_b64_tr_b16 v[22:23], v9 offset:512
  s_sub_u32 s42, s40, s43
  s_mov_b32 s43, s40
  s_waitcnt lgkmcnt(6)
  v_mfma_f32_16x16x32_bf16 v[64:67], v[128:131], v[40:43], v[64:67]
  ds_read_b64_tr_b16 v[24:25], v10 offset:0
  buffer_load_dwordx4 v[120:123], v14, s[8:11], s36 offen offset:0 sc1
  v_mfma_f32_16x16x32_bf16 v[68:71], v[132:135], v[40:43], v[68:71]
  ds_read_b64_tr_b16 v[26:27], v10 offset:512
  s_waitcnt lgkmcnt(6)
  v_mfma_f32_16x16x32_bf16 v[76:79], v[132:135], v[44:47], v[76:79]
  ds_read_b64_tr_b16 v[28:29], v11 offset:0
  v_mfma_f32_16x16x32_bf16 v[72:75], v[128:131], v[44:47], v[72:75]
  ds_read_b64_tr_b16 v[30:31], v11 offset:512
  buffer_load_dwordx4 v[124:127], v14, s[8:11], s36 offen offset:1024 sc1
  s_waitcnt vmcnt(13) lgkmcnt(6)
  v_mfma_f32_16x16x32_bf16 v[48:51], v[136:139], v[16:19], v[48:51]
  ds_read_b64_tr_b16 v[32:33], v8 offset:4096
  s_waitcnt vmcnt(12)
  v_mfma_f32_16x16x32_bf16 v[52:55], v[140:143], v[16:19], v[52:55]
  ds_read_b64_tr_b16 v[34:35], v8 offset:4608
  v_add_u32 v8, s42, v8
  s_waitcnt lgkmcnt(6)
  v_mfma_f32_16x16x32_bf16 v[60:63], v[140:143], v[20:23], v[60:63]
  ds_read_b64_tr_b16 v[36:37], v9 offset:4096
  buffer_load_dwordx4 v[128:131], v14, s[8:11], s36 offen offset:2048 sc1
  v_mfma_f32_16x16x32_bf16 v[56:59], v[136:139], v[20:23], v[56:59]
  ds_read_b64_tr_b16 v[38:39], v9 offset:4608
  v_add_u32 v9, s42, v9
  s_waitcnt lgkmcnt(6)
  v_mfma_f32_16x16x32_bf16 v[64:67], v[136:139], v[24:27], v[64:67]
  ds_read_b64_tr_b16 v[40:41], v10 offset:4096
  v_mfma_f32_16x16x32_bf16 v[68:71], v[140:143], v[24:27], v[68:71]
  ds_read_b64_tr_b16 v[42:43], v10 offset:4608
  v_add_u32 v10, s42, v10
  s_waitcnt lgkmcnt(6)
  v_mfma_f32_16x16x32_bf16 v[76:79], v[140:143], v[28:31], v[76:79]
  ds_read_b64_tr_b16 v[44:45], v11 offset:4096
  buffer_load_dwordx4 v[132:135], v14, s[8:11], s36 offen offset:3072 sc1
  v_mfma_f32_16x16x32_bf16 v[72:75], v[136:139], v[28:31], v[72:75]
  ds_read_b64_tr_b16 v[46:47], v11 offset:4608
  v_add_u32 v11, s42, v11
  s_barrier
  s_waitcnt vmcnt(13) lgkmcnt(6)
  v_mfma_f32_16x16x32_bf16 v[48:51], v[144:147], v[32:35], v[48:51]
  ds_read_b64_tr_b16 v[16:17], v8 offset:0
  s_bitcmp1_b32 s48, 5
  s_cselect_b32 s36, s50, s49
  s_waitcnt vmcnt(12)
  v_mfma_f32_16x16x32_bf16 v[52:55], v[148:151], v[32:35], v[52:55]
  ds_read_b64_tr_b16 v[18:19], v8 offset:512
  s_add_u32 s36, s36, 20480
  s_add_u32 s40, s43, 8192
  s_waitcnt lgkmcnt(6)
  v_mfma_f32_16x16x32_bf16 v[60:63], v[148:151], v[36:39], v[60:63]
  ds_read_b64_tr_b16 v[20:21], v9 offset:0
  s_cmp_eq_u32 s40, 65536
  s_cselect_b32 s40, 0, s40
  v_mfma_f32_16x16x32_bf16 v[56:59], v[144:147], v[36:39], v[56:59]
  ds_read_b64_tr_b16 v[22:23], v9 offset:512
  s_sub_u32 s42, s40, s43
  s_mov_b32 s43, s40
  s_waitcnt lgkmcnt(6)
  v_mfma_f32_16x16x32_bf16 v[64:67], v[144:147], v[40:43], v[64:67]
  ds_read_b64_tr_b16 v[24:25], v10 offset:0
  buffer_load_dwordx4 v[136:139], v14, s[8:11], s36 offen offset:0 sc1
  v_mfma_f32_16x16x32_bf16 v[68:71], v[148:151], v[40:43], v[68:71]
  ds_read_b64_tr_b16 v[26:27], v10 offset:512
  s_waitcnt lgkmcnt(6)
  v_mfma_f32_16x16x32_bf16 v[76:79], v[148:151], v[44:47], v[76:79]
  ds_read_b64_tr_b16 v[28:29], v11 offset:0
  v_mfma_f32_16x16x32_bf16 v[72:75], v[144:147], v[44:47], v[72:75]
  ds_read_b64_tr_b16 v[30:31], v11 offset:512
  buffer_load_dwordx4 v[140:143], v14, s[8:11], s36 offen offset:1024 sc1
  s_waitcnt vmcnt(13) lgkmcnt(6)
  v_mfma_f32_16x16x32_bf16 v[48:51], v[152:155], v[16:19], v[48:51]
  ds_read_b64_tr_b16 v[32:33], v8 offset:4096
  s_waitcnt vmcnt(12)
  v_mfma_f32_16x16x32_bf16 v[52:55], v[156:159], v[16:19], v[52:55]
  ds_read_b64_tr_b16 v[34:35], v8 offset:4608
  v_add_u32 v8, s42, v8
  s_waitcnt lgkmcnt(6)
  v_mfma_f32_16x16x32_bf16 v[60:63], v[156:159], v[20:23], v[60:63]
  ds_read_b64_tr_b16 v[36:37], v9 offset:4096
  buffer_load_dwordx4 v[144:147], v14, s[8:11], s36 offen offset:2048 sc1
  v_mfma_f32_16x16x32_bf16 v[56:59], v[152:155], v[20:23], v[56:59]
  ds_read_b64_tr_b16 v[38:39], v9 offset:4608
  v_add_u32 v9, s42, v9
  s_waitcnt lgkmcnt(6)
  v_mfma_f32_16x16x32_bf16 v[64:67], v[152:155], v[24:27], v[64:67]
  ds_read_b64_tr_b16 v[40:41], v10 offset:4096
  v_mfma_f32_16x16x32_bf16 v[68:71], v[156:159], v[24:27], v[68:71]
  ds_read_b64_tr_b16 v[42:43], v10 offset:4608
  v_add_u32 v10, s42, v10
  s_waitcnt lgkmcnt(6)
  v_mfma_f32_16x16x32_bf16 v[76:79], v[156:159], v[28:31], v[76:79]
  ds_read_b64_tr_b16 v[44:45], v11 offset:4096
  buffer_load_dwordx4 v[148:151], v14, s[8:11], s36 offen offset:3072 sc1
  v_mfma_f32_16x16x32_bf16 v[72:75], v[152:155], v[28:31], v[72:75]
  ds_read_b64_tr_b16 v[46:47], v11 offset:4608
  v_add_u32 v11, s42, v11
  s_barrier
  s_waitcnt vmcnt(13) lgkmcnt(6)
  v_mfma_f32_16x16x32_bf16 v[48:51], v[160:163], v[32:35], v[48:51]
  ds_read_b64_tr_b16 v[16:17], v8 offset:0
  s_bitcmp1_b32 s48, 6
  s_cselect_b32 s36, s50, s49
  s_waitcnt vmcnt(12)
  v_mfma_f32_16x16x32_bf16 v[52:55], v[164:167], v[32:35], v[52:55]
  ds_read_b64_tr_b16 v[18:19], v8 offset:512
  s_add_u32 s36, s36, 24576
  s_add_u32 s40, s43, 8192
  s_waitcnt lgkmcnt(6)
  v_mfma_f32_16x16x32_bf16 v[60:63], v[164:167], v[36:39], v[60:63]
  ds_read_b64_tr_b16 v[20:21], v9 offset:0
  s_cmp_eq_u32 s40, 65536
  s_cselect_b32 s40, 0, s40
  v_mfma_f32_16x16x32_bf16 v[56:59], v[160:163], v[36:39], v[56:59]
  ds_read_b64_tr_b16 v[22:23], v9 offset:512
  s_sub_u32 s42, s40, s43
  s_mov_b32 s43, s40
  s_waitcnt lgkmcnt(6)
  v_mfma_f32_16x16x32_bf16 v[64:67], v[160:163], v[40:43], v[64:67]
  ds_read_b64_tr_b16 v[24:25], v10 offset:0
  buffer_load_dwordx4 v[152:155], v14, s[8:11], s36 offen offset:0 sc1
  v_mfma_f32_16x16x32_bf16 v[68:71], v[164:167], v[40:43], v[68:71]
  ds_read_b64_tr_b16 v[26:27], v10 offset:512
  s_waitcnt lgkmcnt(6)
  v_mfma_f32_16x16x32_bf16 v[76:79], v[164:167], v[44:47], v[76:79]
  ds_read_b64_tr_b16 v[28:29], v11 offset:0
  v_mfma_f32_16x16x32_bf16 v[72:75], v[160:163], v[44:47], v[72:75]
  ds_read_b64_tr_b16 v[30:31], v11 offset:512
  buffer_load_dwordx4 v[156:159], v14, s[8:11], s36 offen offset:1024 sc1
  s_waitcnt vmcnt(13) lgkmcnt(6)
  v_mfma_f32_16x16x32_bf16 v[48:51], v[168:171], v[16:19], v[48:51]
  ds_read_b64_tr_b16 v[32:33], v8 offset:4096
  s_waitcnt vmcnt(12)
  v_mfma_f32_16x16x32_bf16 v[52:55], v[172:175], v[16:19], v[52:55]
  ds_read_b64_tr_b16 v[34:35], v8 offset:4608
  v_add_u32 v8, s42, v8
  s_waitcnt lgkmcnt(6)
  v_mfma_f32_16x16x32_bf16 v[60:63], v[172:175], v[20:23], v[60:63]
  ds_read_b64_tr_b16 v[36:37], v9 offset:4096
  buffer_load_dwordx4 v[160:163], v14, s[8:11], s36 offen offset:2048 sc1
  v_mfma_f32_16x16x32_bf16 v[56:59], v[168:171], v[20:23], v[56:59]
  ds_read_b64_tr_b16 v[38:39], v9 offset:4608
  v_add_u32 v9, s42, v9
  s_waitcnt lgkmcnt(6)
  v_mfma_f32_16x16x32_bf16 v[64:67], v[168:171], v[24:27], v[64:67]
  ds_read_b64_tr_b16 v[40:41], v10 offset:4096
  v_mfma_f32_16x16x32_bf16 v[68:71], v[172:175], v[24:27], v[68:71]
  ds_read_b64_tr_b16 v[42:43], v10 offset:4608
  v_add_u32 v10, s42, v10
  s_waitcnt lgkmcnt(6)
  v_mfma_f32_16x16x32_bf16 v[76:79], v[172:175], v[28:31], v[76:79]
  ds_read_b64_tr_b16 v[44:45], v11 offset:4096
  buffer_load_dwordx4 v[164:167], v14, s[8:11], s36 offen offset:3072 sc1
  v_mfma_f32_16x16x32_bf16 v[72:75], v[168:171], v[28:31], v[72:75]
  ds_read_b64_tr_b16 v[46:47], v11 offset:4608
  v_add_u32 v11, s42, v11
  s_barrier
  s_waitcnt vmcnt(13) lgkmcnt(6)
  v_mfma_f32_16x16x32_bf16 v[48:51], v[176:179], v[32:35], v[48:51]
  ds_read_b64_tr_b16 v[16:17], v8 offset:0
  s_bitcmp1_b32 s48, 7
  s_cselect_b32 s36, s50, s49
  s_waitcnt vmcnt(12)
  v_mfma_f32_16x16x32_bf16 v[52:55], v[180:183], v[32:35], v[52:55]
  ds_read_b64_tr_b16 v[18:19], v8 offset:512
  s_add_u32 s36, s36, 28672
  s_add_u32 s40, s43, 8192
  s_waitcnt lgkmcnt(6)
  v_mfma_f32_16x16x32_bf16 v[60:63], v[180:183], v[36:39], v[60:63]
  ds_read_b64_tr_b16 v[20:21], v9 offset:0
  s_cmp_eq_u32 s40, 65536
  s_cselect_b32 s40, 0, s40
  v_mfma_f32_16x16x32_bf16 v[56:59], v[176:179], v[36:39], v[56:59]
  ds_read_b64_tr_b16 v[22:23], v9 offset:512
  s_sub_u32 s42, s40, s43
  s_mov_b32 s43, s40
  s_waitcnt lgkmcnt(6)
  v_mfma_f32_16x16x32_bf16 v[64:67], v[176:179], v[40:43], v[64:67]
  ds_read_b64_tr_b16 v[24:25], v10 offset:0
  buffer_load_dwordx4 v[168:171], v14, s[8:11], s36 offen offset:0 sc1
  v_mfma_f32_16x16x32_bf16 v[68:71], v[180:183], v[40:43], v[68:71]
  ds_read_b64_tr_b16 v[26:27], v10 offset:512
  s_waitcnt lgkmcnt(6)
  v_mfma_f32_16x16x32_bf16 v[76:79], v[180:183], v[44:47], v[76:79]
  ds_read_b64_tr_b16 v[28:29], v11 offset:0
  v_mfma_f32_16x16x32_bf16 v[72:75], v[176:179], v[44:47], v[72:75]
  ds_read_b64_tr_b16 v[30:31], v11 offset:512
  buffer_load_dwordx4 v[172:175], v14, s[8:11], s36 offen offset:1024 sc1
  s_waitcnt vmcnt(13) lgkmcnt(6)
  v_mfma_f32_16x16x32_bf16 v[48:51], v[120:123], v[16:19], v[48:51]
  ds_read_b64_tr_b16 v[32:33], v8 offset:4096
  s_waitcnt vmcnt(12)
  v_mfma_f32_16x16x32_bf16 v[52:55], v[124:127], v[16:19], v[52:55]
  ds_read_b64_tr_b16 v[34:35], v8 offset:4608
  v_add_u32 v8, s42, v8
  s_waitcnt lgkmcnt(6)
  v_mfma_f32_16x16x32_bf16 v[60:63], v[124:127], v[20:23], v[60:63]
  ds_read_b64_tr_b16 v[36:37], v9 offset:4096
  buffer_load_dwordx4 v[176:179], v14, s[8:11], s36 offen offset:2048 sc1
  v_mfma_f32_16x16x32_bf16 v[56:59], v[120:123], v[20:23], v[56:59]
  ds_read_b64_tr_b16 v[38:39], v9 offset:4608
  v_add_u32 v9, s42, v9
  s_waitcnt lgkmcnt(6)
  v_mfma_f32_16x16x32_bf16 v[64:67], v[120:123], v[24:27], v[64:67]
  ds_read_b64_tr_b16 v[40:41], v10 offset:4096
  v_mfma_f32_16x16x32_bf16 v[68:71], v[124:127], v[24:27], v[68:71]
  ds_read_b64_tr_b16 v[42:43], v10 offset:4608
  v_add_u32 v10, s42, v10
  s_waitcnt lgkmcnt(6)
  v_mfma_f32_16x16x32_bf16 v[76:79], v[124:127], v[28:31], v[76:79]
  ds_read_b64_tr_b16 v[44:45], v11 offset:4096
  buffer_load_dwordx4 v[180:183], v14, s[8:11], s36 offen offset:3072 sc1
  v_mfma_f32_16x16x32_bf16 v[72:75], v[120:123], v[28:31], v[72:75]
  ds_read_b64_tr_b16 v[46:47], v11 offset:4608
  v_add_u32 v11, s42, v11
  s_barrier
  s_waitcnt vmcnt(13) lgkmcnt(6)
  v_mfma_f32_16x16x32_bf16 v[48:51], v[128:131], v[32:35], v[48:51]
  ds_read_b64_tr_b16 v[16:17], v8 offset:0
  s_mov_b32 s49, s50
  s_add_u32 s50, s50, 32768
  s_waitcnt vmcnt(12)
  v_mfma_f32_16x16x32_bf16 v[52:55], v[132:135], v[32:35], v[52:55]
  ds_read_b64_tr_b16 v[18:19], v8 offset:512
  s_cmp_eq_u32 s50, s41
  s_cselect_b32 s50, s34, s50
  s_waitcnt lgkmcnt(6)
  v_mfma_f32_16x16x32_bf16 v[60:63], v[132:135], v[36:39], v[60:63]
  ds_read_b64_tr_b16 v[20:21], v9 offset:0
  s_bitcmp1_b32 s48, 0
  s_cselect_b32 s36, s50, s49
  v_mfma_f32_16x16x32_bf16 v[56:59], v[128:131], v[36:39], v[56:59]
  ds_read_b64_tr_b16 v[22:23], v9 offset:512
  s_add_u32 s36, s36, 0
  s_add_u32 s40, s43, 8192
  s_waitcnt lgkmcnt(6)
  v_mfma_f32_16x16x32_bf16 v[64:67], v[128:131], v[40:43], v[64:67]
  ds_read_b64_tr_b16 v[24:25], v10 offset:0
  s_cmp_eq_u32 s40, 65536
  s_cselect_b32 s40, 0, s40
  buffer_load_dwordx4 v[120:123], v14, s[8:11], s36 offen offset:0 sc1
  v_mfma_f32_16x16x32_bf16 v[68:71], v[132:135], v[40:43], v[68:71]
  ds_read_b64_tr_b16 v[26:27], v10 offset:512
  s_sub_u32 s42, s40, s43
  s_mov_b32 s43, s40
  s_waitcnt lgkmcnt(6)
  v_mfma_f32_16x16x32_bf16 v[76:79], v[132:135], v[44:47], v[76:79]
  ds_read_b64_tr_b16 v[28:29], v11 offset:0
  v_mfma_f32_16x16x32_bf16 v[72:75], v[128:131], v[44:47], v[72:75]
  ds_read_b64_tr_b16 v[30:31], v11 offset:512
  buffer_load_dwordx4 v[124:127], v14, s[8:11], s36 offen offset:1024 sc1
  s_waitcnt vmcnt(13) lgkmcnt(6)
  v_mfma_f32_16x16x32_bf16 v[48:51], v[136:139], v[16:19], v[48:51]
  ds_read_b64_tr_b16 v[32:33], v8 offset:4096
  s_waitcnt vmcnt(12)
  v_mfma_f32_16x16x32_bf16 v[52:55], v[140:143], v[16:19], v[52:55]
  ds_read_b64_tr_b16 v[34:35], v8 offset:4608
  v_add_u32 v8, s42, v8
  s_waitcnt lgkmcnt(6)
  v_mfma_f32_16x16x32_bf16 v[60:63], v[140:143], v[20:23], v[60:63]
  ds_read_b64_tr_b16 v[36:37], v9 offset:4096
  buffer_load_dwordx4 v[128:131], v14, s[8:11], s36 offen offset:2048 sc1
  v_mfma_f32_16x16x32_bf16 v[56:59], v[136:139], v[20:23], v[56:59]
  ds_read_b64_tr_b16 v[38:39], v9 offset:4608
  v_add_u32 v9, s42, v9
  s_waitcnt lgkmcnt(6)
  v_mfma_f32_16x16x32_bf16 v[64:67], v[136:139], v[24:27], v[64:67]
  ds_read_b64_tr_b16 v[40:41], v10 offset:4096
  v_mfma_f32_16x16x32_bf16 v[68:71], v[140:143], v[24:27], v[68:71]
  ds_read_b64_tr_b16 v[42:43], v10 offset:4608
  v_add_u32 v10, s42, v10
  s_waitcnt lgkmcnt(6)
  v_mfma_f32_16x16x32_bf16 v[76:79], v[140:143], v[28:31], v[76:79]
  ds_read_b64_tr_b16 v[44:45], v11 offset:4096
  buffer_load_dwordx4 v[132:135], v14, s[8:11], s36 offen offset:3072 sc1
  v_mfma_f32_16x16x32_bf16 v[72:75], v[136:139], v[28:31], v[72:75]
  ds_read_b64_tr_b16 v[46:47], v11 offset:4608
  v_add_u32 v11, s42, v11
  s_barrier
  s_waitcnt vmcnt(13) lgkmcnt(6)
  v_mfma_f32_16x16x32_bf16 v[48:51], v[144:147], v[32:35], v[48:51]
  ds_read_b64_tr_b16 v[16:17], v8 offset:0
  s_bitcmp1_b32 s48, 1
  s_cselect_b32 s36, s50, s49
  s_waitcnt vmcnt(12)
  v_mfma_f32_16x16x32_bf16 v[52:55], v[148:151], v[32:35], v[52:55]
  ds_read_b64_tr_b16 v[18:19], v8 offset:512
  s_add_u32 s36, s36, 4096
  s_add_u32 s40, s43, 8192
  s_waitcnt lgkmcnt(6)
  v_mfma_f32_16x16x32_bf16 v[60:63], v[148:151], v[36:39], v[60:63]
  ds_read_b64_tr_b16 v[20:21], v9 offset:0
  s_cmp_eq_u32 s40, 65536
  s_cselect_b32 s40, 0, s40
  v_mfma_f32_16x16x32_bf16 v[56:59], v[144:147], v[36:39], v[56:59]
  ds_read_b64_tr_b16 v[22:23], v9 offset:512
  s_sub_u32 s42, s40, s43
  s_mov_b32 s43, s40
  s_waitcnt lgkmcnt(6)
  v_mfma_f32_16x16x32_bf16 v[64:67], v[144:147], v[40:43], v[64:67]
  ds_read_b64_tr_b16 v[24:25], v10 offset:0
  buffer_load_dwordx4 v[136:139], v14, s[8:11], s36 offen offset:0 sc1
  v_mfma_f32_16x16x32_bf16 v[68:71], v[148:151], v[40:43], v[68:71]
  ds_read_b64_tr_b16 v[26:27], v10 offset:512
  s_waitcnt lgkmcnt(6)
  v_mfma_f32_16x16x32_bf16 v[76:79], v[148:151], v[44:47], v[76:79]
  ds_read_b64_tr_b16 v[28:29], v11 offset:0
  v_mfma_f32_16x16x32_bf16 v[72:75], v[144:147], v[44:47], v[72:75]
  ds_read_b64_tr_b16 v[30:31], v11 offset:512
  buffer_load_dwordx4 v[140:143], v14, s[8:11], s36 offen offset:1024 sc1
  s_waitcnt vmcnt(13) lgkmcnt(6)
  v_mfma_f32_16x16x32_bf16 v[48:51], v[152:155], v[16:19], v[48:51]
  ds_read_b64_tr_b16 v[32:33], v8 offset:4096
  s_waitcnt vmcnt(12)
  v_mfma_f32_16x16x32_bf16 v[52:55], v[156:159], v[16:19], v[52:55]
  ds_read_b64_tr_b16 v[34:35], v8 offset:4608
  v_add_u32 v8, s42, v8
  s_waitcnt lgkmcnt(6)
  v_mfma_f32_16x16x32_bf16 v[60:63], v[156:159], v[20:23], v[60:63]
  ds_read_b64_tr_b16 v[36:37], v9 offset:4096
  buffer_load_dwordx4 v[144:147], v14, s[8:11], s36 offen offset:2048 sc1
  v_mfma_f32_16x16x32_bf16 v[56:59], v[152:155], v[20:23], v[56:59]
  ds_read_b64_tr_b16 v[38:39], v9 offset:4608
  v_add_u32 v9, s42, v9
  s_waitcnt lgkmcnt(6)
  v_mfma_f32_16x16x32_bf16 v[64:67], v[152:155], v[24:27], v[64:67]
  ds_read_b64_tr_b16 v[40:41], v10 offset:4096
  v_mfma_f32_16x16x32_bf16 v[68:71], v[156:159], v[24:27], v[68:71]
  ds_read_b64_tr_b16 v[42:43], v10 offset:4608
  v_add_u32 v10, s42, v10
  s_waitcnt lgkmcnt(6)
  v_mfma_f32_16x16x32_bf16 v[76:79], v[156:159], v[28:31], v[76:79]
  ds_read_b64_tr_b16 v[44:45], v11 offset:4096
  buffer_load_dwordx4 v[148:151], v14, s[8:11], s36 offen offset:3072 sc1
  v_mfma_f32_16x16x32_bf16 v[72:75], v[152:155], v[28:31], v[72:75]
  ds_read_b64_tr_b16 v[46:47], v11 offset:4608
  v_add_u32 v11, s42, v11
  s_barrier
  s_waitcnt vmcnt(13) lgkmcnt(6)
  v_mfma_f32_16x16x32_bf16 v[48:51], v[160:163], v[32:35], v[48:51]
  ds_read_b64_tr_b16 v[16:17], v8 offset:0
  s_bitcmp1_b32 s48, 2
  s_cselect_b32 s36, s50, s49
  s_waitcnt vmcnt(12)
  v_mfma_f32_16x16x32_bf16 v[52:55], v[164:167], v[32:35], v[52:55]
  ds_read_b64_tr_b16 v[18:19], v8 offset:512
  s_add_u32 s36, s36, 8192
  s_add_u32 s40, s43, 8192
  s_waitcnt lgkmcnt(6)
  v_mfma_f32_16x16x32_bf16 v[60:63], v[164:167], v[36:39], v[60:63]
  ds_read_b64_tr_b16 v[20:21], v9 offset:0
  s_cmp_eq_u32 s40, 65536
  s_cselect_b32 s40, 0, s40
  v_mfma_f32_16x16x32_bf16 v[56:59], v[160:163], v[36:39], v[56:59]
  ds_read_b64_tr_b16 v[22:23], v9 offset:512
  s_sub_u32 s42, s40, s43
  s_mov_b32 s43, s40
  s_waitcnt lgkmcnt(6)
  v_mfma_f32_16x16x32_bf16 v[64:67], v[160:163], v[40:43], v[64:67]
  ds_read_b64_tr_b16 v[24:25], v10 offset:0
  buffer_load_dwordx4 v[152:155], v14, s[8:11], s36 offen offset:0 sc1
  v_mfma_f32_16x16x32_bf16 v[68:71], v[164:167], v[40:43], v[68:71]
  ds_read_b64_tr_b16 v[26:27], v10 offset:512
  s_waitcnt lgkmcnt(6)
  v_mfma_f32_16x16x32_bf16 v[76:79], v[164:167], v[44:47], v[76:79]
  ds_read_b64_tr_b16 v[28:29], v11 offset:0
  v_mfma_f32_16x16x32_bf16 v[72:75], v[160:163], v[44:47], v[72:75]
  ds_read_b64_tr_b16 v[30:31], v11 offset:512
  buffer_load_dwordx4 v[156:159], v14, s[8:11], s36 offen offset:1024 sc1
  s_waitcnt vmcnt(13) lgkmcnt(6)
  v_mfma_f32_16x16x32_bf16 v[48:51], v[168:171], v[16:19], v[48:51]
  ds_read_b64_tr_b16 v[32:33], v8 offset:4096
  s_waitcnt vmcnt(12)
  v_mfma_f32_16x16x32_bf16 v[52:55], v[172:175], v[16:19], v[52:55]
  ds_read_b64_tr_b16 v[34:35], v8 offset:4608
  v_add_u32 v8, s42, v8
  s_waitcnt lgkmcnt(6)
  v_mfma_f32_16x16x32_bf16 v[60:63], v[172:175], v[20:23], v[60:63]
  ds_read_b64_tr_b16 v[36:37], v9 offset:4096
  buffer_load_dwordx4 v[160:163], v14, s[8:11], s36 offen offset:2048 sc1
  v_mfma_f32_16x16x32_bf16 v[56:59], v[168:171], v[20:23], v[56:59]
  ds_read_b64_tr_b16 v[38:39], v9 offset:4608
  v_add_u32 v9, s42, v9
  s_waitcnt lgkmcnt(6)
  v_mfma_f32_16x16x32_bf16 v[64:67], v[168:171], v[24:27], v[64:67]
  ds_read_b64_tr_b16 v[40:41], v10 offset:4096
  v_mfma_f32_16x16x32_bf16 v[68:71], v[172:175], v[24:27], v[68:71]
  ds_read_b64_tr_b16 v[42:43], v10 offset:4608
  v_add_u32 v10, s42, v10
  s_waitcnt lgkmcnt(6)
  v_mfma_f32_16x16x32_bf16 v[76:79], v[172:175], v[28:31], v[76:79]
  ds_read_b64_tr_b16 v[44:45], v11 offset:4096
  buffer_load_dwordx4 v[164:167], v14, s[8:11], s36 offen offset:3072 sc1
  v_mfma_f32_16x16x32_bf16 v[72:75], v[168:171], v[28:31], v[72:75]
  ds_read_b64_tr_b16 v[46:47], v11 offset:4608
  v_add_u32 v11, s42, v11
  s_barrier
  s_waitcnt vmcnt(13) lgkmcnt(6)
  v_mfma_f32_16x16x32_bf16 v[48:51], v[176:179], v[32:35], v[48:51]
  ds_read_b64_tr_b16 v[16:17], v8 offset:0
  s_bitcmp1_b32 s48, 3
  s_cselect_b32 s36, s50, s49
  s_waitcnt vmcnt(12)
  v_mfma_f32_16x16x32_bf16 v[52:55], v[180:183], v[32:35], v[52:55]
  ds_read_b64_tr_b16 v[18:19], v8 offset:512
  s_add_u32 s36, s36, 12288
  s_add_u32 s40, s43, 8192
  s_waitcnt lgkmcnt(6)
  v_mfma_f32_16x16x32_bf16 v[60:63], v[180:183], v[36:39], v[60:63]
  ds_read_b64_tr_b16 v[20:21], v9 offset:0
  s_cmp_eq_u32 s40, 65536
  s_cselect_b32 s40, 0, s40
  v_mfma_f32_16x16x32_bf16 v[56:59], v[176:179], v[36:39], v[56:59]
  ds_read_b64_tr_b16 v[22:23], v9 offset:512
  s_sub_u32 s42, s40, s43
  s_mov_b32 s43, s40
  s_waitcnt lgkmcnt(6)
  v_mfma_f32_16x16x32_bf16 v[64:67], v[176:179], v[40:43], v[64:67]
  ds_read_b64_tr_b16 v[24:25], v10 offset:0
  buffer_load_dwordx4 v[168:171], v14, s[8:11], s36 offen offset:0 sc1
  v_mfma_f32_16x16x32_bf16 v[68:71], v[180:183], v[40:43], v[68:71]
  ds_read_b64_tr_b16 v[26:27], v10 offset:512
  s_waitcnt lgkmcnt(6)
  v_mfma_f32_16x16x32_bf16 v[76:79], v[180:183], v[44:47], v[76:79]
  ds_read_b64_tr_b16 v[28:29], v11 offset:0
  v_mfma_f32_16x16x32_bf16 v[72:75], v[176:179], v[44:47], v[72:75]
  ds_read_b64_tr_b16 v[30:31], v11 offset:512
  buffer_load_dwordx4 v[172:175], v14, s[8:11], s36 offen offset:1024 sc1
  s_sub_u32 s39, s39, 1
  s_cmp_lg_u32 s39, 0
  s_cbranch_scc1 cd5
  s_waitcnt vmcnt(13) lgkmcnt(6)
  v_mfma_f32_16x16x32_bf16 v[48:51], v[120:123], v[16:19], v[48:51]
  ds_read_b64_tr_b16 v[32:33], v8 offset:4096
  s_waitcnt vmcnt(12)
  v_mfma_f32_16x16x32_bf16 v[52:55], v[124:127], v[16:19], v[52:55]
  ds_read_b64_tr_b16 v[34:35], v8 offset:4608
  v_add_u32 v8, s42, v8
  s_waitcnt lgkmcnt(6)
  v_mfma_f32_16x16x32_bf16 v[60:63], v[124:127], v[20:23], v[60:63]
  ds_read_b64_tr_b16 v[36:37], v9 offset:4096
  buffer_load_dwordx4 v[176:179], v14, s[8:11], s36 offen offset:2048 sc1
  v_mfma_f32_16x16x32_bf16 v[56:59], v[120:123], v[20:23], v[56:59]
  ds_read_b64_tr_b16 v[38:39], v9 offset:4608
  v_add_u32 v9, s42, v9
  s_waitcnt lgkmcnt(6)
  v_mfma_f32_16x16x32_bf16 v[64:67], v[120:123], v[24:27], v[64:67]
  ds_read_b64_tr_b16 v[40:41], v10 offset:4096
  v_mfma_f32_16x16x32_bf16 v[68:71], v[124:127], v[24:27], v[68:71]
  ds_read_b64_tr_b16 v[42:43], v10 offset:4608
  v_add_u32 v10, s42, v10
  s_waitcnt lgkmcnt(6)
  v_mfma_f32_16x16x32_bf16 v[76:79], v[124:127], v[28:31], v[76:79]
  ds_read_b64_tr_b16 v[44:45], v11 offset:4096
  buffer_load_dwordx4 v[180:183], v14, s[8:11], s36 offen offset:3072 sc1
  v_mfma_f32_16x16x32_bf16 v[72:75], v[120:123], v[28:31], v[72:75]
  ds_read_b64_tr_b16 v[46:47], v11 offset:4608
  v_add_u32 v11, s42, v11
  s_barrier
  s_waitcnt vmcnt(13) lgkmcnt(6)
  v_mfma_f32_16x16x32_bf16 v[48:51], v[128:131], v[32:35], v[48:51]
  ds_read_b64_tr_b16 v[16:17], v8 offset:0
  s_bitcmp1_b32 s48, 4
  s_cselect_b32 s36, s50, s49
  s_waitcnt vmcnt(12)
  v_mfma_f32_16x16x32_bf16 v[52:55], v[132:135], v[32:35], v[52:55]
  ds_read_b64_tr_b16 v[18:19], v8 offset:512
  s_add_u32 s36, s36, 16384
  s_add_u32 s40, s43, 8192
  s_waitcnt lgkmcnt(6)
  v_mfma_f32_16x16x32_bf16 v[60:63], v[132:135], v[36:39], v[60:63]
  ds_read_b64_tr_b16 v[20:21], v9 offset:0
  s_cmp_eq_u32 s40, 65536
  s_cselect_b32 s40, 0, s40
  v_mfma_f32_16x16x32_bf16 v[56:59], v[128:131], v[36:39], v[56:59]
  ds_read_b64_tr_b16 v[22:23], v9 offset:512
  s_sub_u32 s42, s40, s43
  s_mov_b32 s43, s40
  s_waitcnt lgkmcnt(6)
  v_mfma_f32_16x16x32_bf16 v[64:67], v[128:131], v[40:43], v[64:67]
  ds_read_b64_tr_b16 v[24:25], v10 offset:0
  buffer_load_dwordx4 v[120:123], v14, s[8:11], s36 offen offset:0 sc1
  v_mfma_f32_16x16x32_bf16 v[68:71], v[132:135], v[40:43], v[68:71]
  ds_read_b64_tr_b16 v[26:27], v10 offset:512
  s_waitcnt lgkmcnt(6)
  v_mfma_f32_16x16x32_bf16 v[76:79], v[132:135], v[44:47], v[76:79]
  ds_read_b64_tr_b16 v[28:29], v11 offset:0
  v_mfma_f32_16x16x32_bf16 v[72:75], v[128:131], v[44:47], v[72:75]
  ds_read_b64_tr_b16 v[30:31], v11 offset:512
  buffer_load_dwordx4 v[124:127], v14, s[8:11], s36 offen offset:1024 sc1
  s_waitcnt vmcnt(13) lgkmcnt(6)
  v_mfma_f32_16x16x32_bf16 v[48:51], v[136:139], v[16:19], v[48:51]
  ds_read_b64_tr_b16 v[32:33], v8 offset:4096
  s_waitcnt vmcnt(12)
  v_mfma_f32_16x16x32_bf16 v[52:55], v[140:143], v[16:19], v[52:55]
  ds_read_b64_tr_b16 v[34:35], v8 offset:4608
  v_add_u32 v8, s42, v8
  s_waitcnt lgkmcnt(6)
  v_mfma_f32_16x16x32_bf16 v[60:63], v[140:143], v[20:23], v[60:63]
  ds_read_b64_tr_b16 v[36:37], v9 offset:4096
  buffer_load_dwordx4 v[128:131], v14, s[8:11], s36 offen offset:2048 sc1
  v_mfma_f32_16x16x32_bf16 v[56:59], v[136:139], v[20:23], v[56:59]
  ds_read_b64_tr_b16 v[38:39], v9 offset:4608
  v_add_u32 v9, s42, v9
  s_waitcnt lgkmcnt(6)
  v_mfma_f32_16x16x32_bf16 v[64:67], v[136:139], v[24:27], v[64:67]
  ds_read_b64_tr_b16 v[40:41], v10 offset:4096
  v_mfma_f32_16x16x32_bf16 v[68:71], v[140:143], v[24:27], v[68:71]
  ds_read_b64_tr_b16 v[42:43], v10 offset:4608
  v_add_u32 v10, s42, v10
  s_waitcnt lgkmcnt(6)
  v_mfma_f32_16x16x32_bf16 v[76:79], v[140:143], v[28:31], v[76:79]
  ds_read_b64_tr_b16 v[44:45], v11 offset:4096
  buffer_load_dwordx4 v[132:135], v14, s[8:11], s36 offen offset:3072 sc1
  v_mfma_f32_16x16x32_bf16 v[72:75], v[136:139], v[28:31], v[72:75]
  ds_read_b64_tr_b16 v[46:47], v11 offset:4608
  v_add_u32 v11, s42, v11
  s_barrier
  s_waitcnt vmcnt(13) lgkmcnt(6)
  v_mfma_f32_16x16x32_bf16 v[48:51], v[144:147], v[32:35], v[48:51]
  ds_read_b64_tr_b16 v[16:17], v8 offset:0
  s_bitcmp1_b32 s48, 5
  s_cselect_b32 s36, s50, s49
  s_waitcnt vmcnt(12)
  v_mfma_f32_16x16x32_bf16 v[52:55], v[148:151], v[32:35], v[52:55]
  ds_read_b64_tr_b16 v[18:19], v8 offset:512
  s_add_u32 s36, s36, 20480
  s_add_u32 s40, s43, 8192
  s_waitcnt lgkmcnt(6)
  v_mfma_f32_16x16x32_bf16 v[60:63], v[148:151], v[36:39], v[60:63]
  ds_read_b64_tr_b16 v[20:21], v9 offset:0
  s_cmp_eq_u32 s40, 65536
  s_cselect_b32 s40, 0, s40
  v_mfma_f32_16x16x32_bf16 v[56:59], v[144:147], v[36:39], v[56:59]
  ds_read_b64_tr_b16 v[22:23], v9 offset:512
  s_sub_u32 s42, s40, s43
  s_mov_b32 s43, s40
  s_waitcnt lgkmcnt(6)
  v_mfma_f32_16x16x32_bf16 v[64:67], v[144:147], v[40:43], v[64:67]
  ds_read_b64_tr_b16 v[24:25], v10 offset:0
  buffer_load_dwordx4 v[136:139], v14, s[8:11], s36 offen offset:0 sc1
  v_mfma_f32_16x16x32_bf16 v[68:71], v[148:151], v[40:43], v[68:71]
  ds_read_b64_tr_b16 v[26:27], v10 offset:512
  s_waitcnt lgkmcnt(6)
  v_mfma_f32_16x16x32_bf16 v[76:79], v[148:151], v[44:47], v[76:79]
  ds_read_b64_tr_b16 v[28:29], v11 offset:0
  v_mfma_f32_16x16x32_bf16 v[72:75], v[144:147], v[44:47], v[72:75]
  ds_read_b64_tr_b16 v[30:31], v11 offset:512
  buffer_load_dwordx4 v[140:143], v14, s[8:11], s36 offen offset:1024 sc1
  s_waitcnt vmcnt(13) lgkmcnt(6)
  v_mfma_f32_16x16x32_bf16 v[48:51], v[152:155], v[16:19], v[48:51]
  ds_read_b64_tr_b16 v[32:33], v8 offset:4096
  s_waitcnt vmcnt(12)
  v_mfma_f32_16x16x32_bf16 v[52:55], v[156:159], v[16:19], v[52:55]
  ds_read_b64_tr_b16 v[34:35], v8 offset:4608
  v_add_u32 v8, s42, v8
  s_waitcnt lgkmcnt(6)
  v_mfma_f32_16x16x32_bf16 v[60:63], v[156:159], v[20:23], v[60:63]
  ds_read_b64_tr_b16 v[36:37], v9 offset:4096
  buffer_load_dwordx4 v[144:147], v14, s[8:11], s36 offen offset:2048 sc1
  v_mfma_f32_16x16x32_bf16 v[56:59], v[152:155], v[20:23], v[56:59]
  ds_read_b64_tr_b16 v[38:39], v9 offset:4608
  v_add_u32 v9, s42, v9
  s_waitcnt lgkmcnt(6)
  v_mfma_f32_16x16x32_bf16 v[64:67], v[152:155], v[24:27], v[64:67]
  ds_read_b64_tr_b16 v[40:41], v10 offset:4096
  v_mfma_f32_16x16x32_bf16 v[68:71], v[156:159], v[24:27], v[68:71]
  ds_read_b64_tr_b16 v[42:43], v10 offset:4608
  v_add_u32 v10, s42, v10
  s_waitcnt lgkmcnt(6)
  v_mfma_f32_16x16x32_bf16 v[76:79], v[156:159], v[28:31], v[76:79]
  ds_read_b64_tr_b16 v[44:45], v11 offset:4096
  buffer_load_dwordx4 v[148:151], v14, s[8:11], s36 offen offset:3072 sc1
  v_mfma_f32_16x16x32_bf16 v[72:75], v[152:155], v[28:31], v[72:75]
  ds_read_b64_tr_b16 v[46:47], v11 offset:4608
  v_add_u32 v11, s42, v11
  s_barrier
  s_waitcnt vmcnt(13) lgkmcnt(6)
  v_mfma_f32_16x16x32_bf16 v[48:51], v[160:163], v[32:35], v[48:51]
  ds_read_b64_tr_b16 v[16:17], v8 offset:0
  s_bitcmp1_b32 s48, 6
  s_cselect_b32 s36, s50, s49
  s_waitcnt vmcnt(12)
  v_mfma_f32_16x16x32_bf16 v[52:55], v[164:167], v[32:35], v[52:55]
  ds_read_b64_tr_b16 v[18:19], v8 offset:512
  s_add_u32 s36, s36, 24576
  s_add_u32 s40, s43, 8192
  s_waitcnt lgkmcnt(6)
  v_mfma_f32_16x16x32_bf16 v[60:63], v[164:167], v[36:39], v[60:63]
  ds_read_b64_tr_b16 v[20:21], v9 offset:0
  s_cmp_eq_u32 s40, 65536
  s_cselect_b32 s40, 0, s40
  v_mfma_f32_16x16x32_bf16 v[56:59], v[160:163], v[36:39], v[56:59]
  ds_read_b64_tr_b16 v[22:23], v9 offset:512
  s_sub_u32 s42, s40, s43
  s_mov_b32 s43, s40
  s_waitcnt lgkmcnt(6)
  v_mfma_f32_16x16x32_bf16 v[64:67], v[160:163], v[40:43], v[64:67]
  ds_read_b64_tr_b16 v[24:25], v10 offset:0
  buffer_load_dwordx4 v[152:155], v14, s[8:11], s36 offen offset:0 sc1
  v_mfma_f32_16x16x32_bf16 v[68:71], v[164:167], v[40:43], v[68:71]
  ds_read_b64_tr_b16 v[26:27], v10 offset:512
  s_waitcnt lgkmcnt(6)
  v_mfma_f32_16x16x32_bf16 v[76:79], v[164:167], v[44:47], v[76:79]
  ds_read_b64_tr_b16 v[28:29], v11 offset:0
  v_mfma_f32_16x16x32_bf16 v[72:75], v[160:163], v[44:47], v[72:75]
  ds_read_b64_tr_b16 v[30:31], v11 offset:512
  buffer_load_dwordx4 v[156:159], v14, s[8:11], s36 offen offset:1024 sc1
  s_waitcnt vmcnt(13) lgkmcnt(6)
  v_mfma_f32_16x16x32_bf16 v[48:51], v[168:171], v[16:19], v[48:51]
  ds_read_b64_tr_b16 v[32:33], v8 offset:4096
  s_waitcnt vmcnt(12)
  v_mfma_f32_16x16x32_bf16 v[52:55], v[172:175], v[16:19], v[52:55]
  ds_read_b64_tr_b16 v[34:35], v8 offset:4608
  v_add_u32 v8, s42, v8
  s_waitcnt lgkmcnt(6)
  v_mfma_f32_16x16x32_bf16 v[60:63], v[172:175], v[20:23], v[60:63]
  ds_read_b64_tr_b16 v[36:37], v9 offset:4096
  buffer_load_dwordx4 v[160:163], v14, s[8:11], s36 offen offset:2048 sc1
  v_mfma_f32_16x16x32_bf16 v[56:59], v[168:171], v[20:23], v[56:59]
  ds_read_b64_tr_b16 v[38:39], v9 offset:4608
  v_add_u32 v9, s42, v9
  s_waitcnt lgkmcnt(6)
  v_mfma_f32_16x16x32_bf16 v[64:67], v[168:171], v[24:27], v[64:67]
  ds_read_b64_tr_b16 v[40:41], v10 offset:4096
  v_mfma_f32_16x16x32_bf16 v[68:71], v[172:175], v[24:27], v[68:71]
  ds_read_b64_tr_b16 v[42:43], v10 offset:4608
  v_add_u32 v10, s42, v10
  s_waitcnt lgkmcnt(6)
  v_mfma_f32_16x16x32_bf16 v[76:79], v[172:175], v[28:31], v[76:79]
  ds_read_b64_tr_b16 v[44:45], v11 offset:4096
  buffer_load_dwordx4 v[164:167], v14, s[8:11], s36 offen offset:3072 sc1
  v_mfma_f32_16x16x32_bf16 v[72:75], v[168:171], v[28:31], v[72:75]
  ds_read_b64_tr_b16 v[46:47], v11 offset:4608
  v_add_u32 v11, s42, v11
  s_barrier
  s_waitcnt vmcnt(13) lgkmcnt(6)
  v_mfma_f32_16x16x32_bf16 v[48:51], v[176:179], v[32:35], v[48:51]
  ds_read_b64_tr_b16 v[16:17], v8 offset:0
  s_bitcmp1_b32 s48, 7
  s_cselect_b32 s36, s50, s49
  s_waitcnt vmcnt(12)
  v_mfma_f32_16x16x32_bf16 v[52:55], v[180:183], v[32:35], v[52:55]
  ds_read_b64_tr_b16 v[18:19], v8 offset:512
  s_add_u32 s36, s36, 28672
  s_add_u32 s40, s43, 8192
  s_waitcnt lgkmcnt(6)
  v_mfma_f32_16x16x32_bf16 v[60:63], v[180:183], v[36:39], v[60:63]
  ds_read_b64_tr_b16 v[20:21], v9 offset:0
  s_cmp_eq_u32 s40, 65536
  s_cselect_b32 s40, 0, s40
  v_mfma_f32_16x16x32_bf16 v[56:59], v[176:179], v[36:39], v[56:59]
  ds_read_b64_tr_b16 v[22:23], v9 offset:512
  s_sub_u32 s42, s40, s43
  s_mov_b32 s43, s40
  s_waitcnt lgkmcnt(6)
  v_mfma_f32_16x16x32_bf16 v[64:67], v[176:179], v[40:43], v[64:67]
  ds_read_b64_tr_b16 v[24:25], v10 offset:0
  buffer_load_dwordx4 v[168:171], v14, s[8:11], s36 offen offset:0 sc1
  v_mfma_f32_16x16x32_bf16 v[68:71], v[180:183], v[40:43], v[68:71]
  ds_read_b64_tr_b16 v[26:27], v10 offset:512
  s_waitcnt lgkmcnt(6)
  v_mfma_f32_16x16x32_bf16 v[76:79], v[180:183], v[44:47], v[76:79]
  ds_read_b64_tr_b16 v[28:29], v11 offset:0
  v_mfma_f32_16x16x32_bf16 v[72:75], v[176:179], v[44:47], v[72:75]
  ds_read_b64_tr_b16 v[30:31], v11 offset:512
  buffer_load_dwordx4 v[172:175], v14, s[8:11], s36 offen offset:1024 sc1
  s_waitcnt vmcnt(13) lgkmcnt(6)
  v_mfma_f32_16x16x32_bf16 v[48:51], v[120:123], v[16:19], v[48:51]
  ds_read_b64_tr_b16 v[32:33], v8 offset:4096
  s_waitcnt vmcnt(12)
  v_mfma_f32_16x16x32_bf16 v[52:55], v[124:127], v[16:19], v[52:55]
  ds_read_b64_tr_b16 v[34:35], v8 offset:4608
  v_add_u32 v8, s42, v8
  s_waitcnt lgkmcnt(6)
  v_mfma_f32_16x16x32_bf16 v[60:63], v[124:127], v[20:23], v[60:63]
  ds_read_b64_tr_b16 v[36:37], v9 offset:4096
  buffer_load_dwordx4 v[176:179], v14, s[8:11], s36 offen offset:2048 sc1
  v_mfma_f32_16x16x32_bf16 v[56:59], v[120:123], v[20:23], v[56:59]
  ds_read_b64_tr_b16 v[38:39], v9 offset:4608
  v_add_u32 v9, s42, v9
  s_waitcnt lgkmcnt(6)
  v_mfma_f32_16x16x32_bf16 v[64:67], v[120:123], v[24:27], v[64:67]
  ds_read_b64_tr_b16 v[40:41], v10 offset:4096
  v_mfma_f32_16x16x32_bf16 v[68:71], v[124:127], v[24:27], v[68:71]
  ds_read_b64_tr_b16 v[42:43], v10 offset:4608
  v_add_u32 v10, s42, v10
  s_waitcnt lgkmcnt(6)
  v_mfma_f32_16x16x32_bf16 v[76:79], v[124:127], v[28:31], v[76:79]
  ds_read_b64_tr_b16 v[44:45], v11 offset:4096
  buffer_load_dwordx4 v[180:183], v14, s[8:11], s36 offen offset:3072 sc1
  v_mfma_f32_16x16x32_bf16 v[72:75], v[120:123], v[28:31], v[72:75]
  ds_read_b64_tr_b16 v[46:47], v11 offset:4608
  v_add_u32 v11, s42, v11
  s_barrier
  s_waitcnt vmcnt(13) lgkmcnt(6)
  v_mfma_f32_16x16x32_bf16 v[48:51], v[128:131], v[32:35], v[48:51]
  ds_read_b64_tr_b16 v[16:17], v8 offset:0
  s_add_u32 s40, s43, 8192
  s_cmp_eq_u32 s40, 65536
  s_waitcnt vmcnt(12)
  v_mfma_f32_16x16x32_bf16 v[52:55], v[132:135], v[32:35], v[52:55]
  ds_read_b64_tr_b16 v[18:19], v8 offset:512
  s_cselect_b32 s40, 0, s40
  s_sub_u32 s42, s40, s43
  s_waitcnt lgkmcnt(6)
  v_mfma_f32_16x16x32_bf16 v[60:63], v[132:135], v[36:39], v[60:63]
  ds_read_b64_tr_b16 v[20:21], v9 offset:0
  s_mov_b32 s43, s40
  v_mfma_f32_16x16x32_bf16 v[56:59], v[128:131], v[36:39], v[56:59]
  ds_read_b64_tr_b16 v[22:23], v9 offset:512
  s_waitcnt lgkmcnt(6)
  v_mfma_f32_16x16x32_bf16 v[64:67], v[128:131], v[40:43], v[64:67]
  ds_read_b64_tr_b16 v[24:25], v10 offset:0
  v_mfma_f32_16x16x32_bf16 v[68:71], v[132:135], v[40:43], v[68:71]
  ds_read_b64_tr_b16 v[26:27], v10 offset:512
  s_waitcnt lgkmcnt(6)
  v_mfma_f32_16x16x32_bf16 v[76:79], v[132:135], v[44:47], v[76:79]
  ds_read_b64_tr_b16 v[28:29], v11 offset:0
  v_mfma_f32_16x16x32_bf16 v[72:75], v[128:131], v[44:47], v[72:75]
  ds_read_b64_tr_b16 v[30:31], v11 offset:512
  s_waitcnt vmcnt(11) lgkmcnt(6)
  v_mfma_f32_16x16x32_bf16 v[48:51], v[136:139], v[16:19], v[48:51]
  ds_read_b64_tr_b16 v[32:33], v8 offset:4096
  s_waitcnt vmcnt(10)
  v_mfma_f32_16x16x32_bf16 v[52:55], v[140:143], v[16:19], v[52:55]
  ds_read_b64_tr_b16 v[34:35], v8 offset:4608
  v_add_u32 v8, s42, v8
  s_waitcnt lgkmcnt(6)
  v_mfma_f32_16x16x32_bf16 v[60:63], v[140:143], v[20:23], v[60:63]
  ds_read_b64_tr_b16 v[36:37], v9 offset:4096
  v_mfma_f32_16x16x32_bf16 v[56:59], v[136:139], v[20:23], v[56:59]
  ds_read_b64_tr_b16 v[38:39], v9 offset:4608
  v_add_u32 v9, s42, v9
  s_waitcnt lgkmcnt(6)
  v_mfma_f32_16x16x32_bf16 v[64:67], v[136:139], v[24:27], v[64:67]
  ds_read_b64_tr_b16 v[40:41], v10 offset:4096
  v_mfma_f32_16x16x32_bf16 v[68:71], v[140:143], v[24:27], v[68:71]
  ds_read_b64_tr_b16 v[42:43], v10 offset:4608
  v_add_u32 v10, s42, v10
  s_waitcnt lgkmcnt(6)
  v_mfma_f32_16x16x32_bf16 v[76:79], v[140:143], v[28:31], v[76:79]
  ds_read_b64_tr_b16 v[44:45], v11 offset:4096
  v_mfma_f32_16x16x32_bf16 v[72:75], v[136:139], v[28:31], v[72:75]
  ds_read_b64_tr_b16 v[46:47], v11 offset:4608
  v_add_u32 v11, s42, v11
  s_barrier
  s_waitcnt vmcnt(9) lgkmcnt(6)
  v_mfma_f32_16x16x32_bf16 v[48:51], v[144:147], v[32:35], v[48:51]
  ds_read_b64_tr_b16 v[16:17], v8 offset:0
  s_add_u32 s40, s43, 8192
  s_cmp_eq_u32 s40, 65536
  s_waitcnt vmcnt(8)
  v_mfma_f32_16x16x32_bf16 v[52:55], v[148:151], v[32:35], v[52:55]
  ds_read_b64_tr_b16 v[18:19], v8 offset:512
  s_cselect_b32 s40, 0, s40
  s_sub_u32 s42, s40, s43
  s_waitcnt lgkmcnt(6)
  v_mfma_f32_16x16x32_bf16 v[60:63], v[148:151], v[36:39], v[60:63]
  ds_read_b64_tr_b16 v[20:21], v9 offset:0
  s_mov_b32 s43, s40
  v_mfma_f32_16x16x32_bf16 v[56:59], v[144:147], v[36:39], v[56:59]
  ds_read_b64_tr_b16 v[22:23], v9 offset:512
  s_waitcnt lgkmcnt(6)
  v_mfma_f32_16x16x32_bf16 v[64:67], v[144:147], v[40:43], v[64:67]
  ds_read_b64_tr_b16 v[24:25], v10 offset:0
  v_mfma_f32_16x16x32_bf16 v[68:71], v[148:151], v[40:43], v[68:71]
  ds_read_b64_tr_b16 v[26:27], v10 offset:512
  s_waitcnt lgkmcnt(6)
  v_mfma_f32_16x16x32_bf16 v[76:79], v[148:151], v[44:47], v[76:79]
  ds_read_b64_tr_b16 v[28:29], v11 offset:0
  v_mfma_f32_16x16x32_bf16 v[72:75], v[144:147], v[44:47], v[72:75]
  ds_read_b64_tr_b16 v[30:31], v11 offset:512
  s_waitcnt vmcnt(7) lgkmcnt(6)
  v_mfma_f32_16x16x32_bf16 v[48:51], v[152:155], v[16:19], v[48:51]
  ds_read_b64_tr_b16 v[32:33], v8 offset:4096
  s_waitcnt vmcnt(6)
  v_mfma_f32_16x16x32_bf16 v[52:55], v[156:159], v[16:19], v[52:55]
  ds_read_b64_tr_b16 v[34:35], v8 offset:4608
  v_add_u32 v8, s42, v8
  s_waitcnt lgkmcnt(6)
  v_mfma_f32_16x16x32_bf16 v[60:63], v[156:159], v[20:23], v[60:63]
  ds_read_b64_tr_b16 v[36:37], v9 offset:4096
  v_mfma_f32_16x16x32_bf16 v[56:59], v[152:155], v[20:23], v[56:59]
  ds_read_b64_tr_b16 v[38:39], v9 offset:4608
  v_add_u32 v9, s42, v9
  s_waitcnt lgkmcnt(6)
  v_mfma_f32_16x16x32_bf16 v[64:67], v[152:155], v[24:27], v[64:67]
  ds_read_b64_tr_b16 v[40:41], v10 offset:4096
  v_mfma_f32_16x16x32_bf16 v[68:71], v[156:159], v[24:27], v[68:71]
  ds_read_b64_tr_b16 v[42:43], v10 offset:4608
  v_add_u32 v10, s42, v10
  s_waitcnt lgkmcnt(6)
  v_mfma_f32_16x16x32_bf16 v[76:79], v[156:159], v[28:31], v[76:79]
  ds_read_b64_tr_b16 v[44:45], v11 offset:4096
  v_mfma_f32_16x16x32_bf16 v[72:75], v[152:155], v[28:31], v[72:75]
  ds_read_b64_tr_b16 v[46:47], v11 offset:4608
  v_add_u32 v11, s42, v11
  s_barrier
  s_waitcnt vmcnt(5) lgkmcnt(6)
  v_mfma_f32_16x16x32_bf16 v[48:51], v[160:163], v[32:35], v[48:51]
  ds_read_b64_tr_b16 v[16:17], v8 offset:0
  s_add_u32 s40, s43, 8192
  s_cmp_eq_u32 s40, 65536
  s_waitcnt vmcnt(4)
  v_mfma_f32_16x16x32_bf16 v[52:55], v[164:167], v[32:35], v[52:55]
  ds_read_b64_tr_b16 v[18:19], v8 offset:512
  s_cselect_b32 s40, 0, s40
  s_sub_u32 s42, s40, s43
  s_waitcnt lgkmcnt(6)
  v_mfma_f32_16x16x32_bf16 v[60:63], v[164:167], v[36:39], v[60:63]
  ds_read_b64_tr_b16 v[20:21], v9 offset:0
  s_mov_b32 s43, s40
  v_mfma_f32_16x16x32_bf16 v[56:59], v[160:163], v[36:39], v[56:59]
  ds_read_b64_tr_b16 v[22:23], v9 offset:512
  s_waitcnt lgkmcnt(6)
  v_mfma_f32_16x16x32_bf16 v[64:67], v[160:163], v[40:43], v[64:67]
  ds_read_b64_tr_b16 v[24:25], v10 offset:0
  v_mfma_f32_16x16x32_bf16 v[68:71], v[164:167], v[40:43], v[68:71]
  ds_read_b64_tr_b16 v[26:27], v10 offset:512
  s_waitcnt lgkmcnt(6)
  v_mfma_f32_16x16x32_bf16 v[76:79], v[164:167], v[44:47], v[76:79]
  ds_read_b64_tr_b16 v[28:29], v11 offset:0
  v_mfma_f32_16x16x32_bf16 v[72:75], v[160:163], v[44:47], v[72:75]
  ds_read_b64_tr_b16 v[30:31], v11 offset:512
  s_waitcnt vmcnt(3) lgkmcnt(6)
  v_mfma_f32_16x16x32_bf16 v[48:51], v[168:171], v[16:19], v[48:51]
  ds_read_b64_tr_b16 v[32:33], v8 offset:4096
  s_waitcnt vmcnt(2)
  v_mfma_f32_16x16x32_bf16 v[52:55], v[172:175], v[16:19], v[52:55]
  ds_read_b64_tr_b16 v[34:35], v8 offset:4608
  s_waitcnt lgkmcnt(6)
  v_mfma_f32_16x16x32_bf16 v[60:63], v[172:175], v[20:23], v[60:63]
  ds_read_b64_tr_b16 v[36:37], v9 offset:4096
  v_mfma_f32_16x16x32_bf16 v[56:59], v[168:171], v[20:23], v[56:59]
  ds_read_b64_tr_b16 v[38:39], v9 offset:4608
  s_waitcnt lgkmcnt(6)
  v_mfma_f32_16x16x32_bf16 v[64:67], v[168:171], v[24:27], v[64:67]
  ds_read_b64_tr_b16 v[40:41], v10 offset:4096
  v_mfma_f32_16x16x32_bf16 v[68:71], v[172:175], v[24:27], v[68:71]
  ds_read_b64_tr_b16 v[42:43], v10 offset:4608
  s_waitcnt lgkmcnt(6)
  v_mfma_f32_16x16x32_bf16 v[76:79], v[172:175], v[28:31], v[76:79]
  ds_read_b64_tr_b16 v[44:45], v11 offset:4096
  v_mfma_f32_16x16x32_bf16 v[72:75], v[168:171], v[28:31], v[72:75]
  ds_read_b64_tr_b16 v[46:47], v11 offset:4608
  s_waitcnt vmcnt(1) lgkmcnt(6)
  v_mfma_f32_16x16x32_bf16 v[48:51], v[176:179], v[32:35], v[48:51]
  s_waitcnt vmcnt(0)
  v_mfma_f32_16x16x32_bf16 v[52:55], v[180:183], v[32:35], v[52:55]
  s_waitcnt lgkmcnt(4)
  v_mfma_f32_16x16x32_bf16 v[60:63], v[180:183], v[36:39], v[60:63]
  v_mfma_f32_16x16x32_bf16 v[56:59], v[176:179], v[36:39], v[56:59]
  s_waitcnt lgkmcnt(2)
  v_mfma_f32_16x16x32_bf16 v[64:67], v[176:179], v[40:43], v[64:67]
  v_mfma_f32_16x16x32_bf16 v[68:71], v[180:183], v[40:43], v[68:71]
  s_waitcnt lgkmcnt(0)
  v_mfma_f32_16x16x32_bf16 v[76:79], v[180:183], v[44:47], v[76:79]
  v_mfma_f32_16x16x32_bf16 v[72:75], v[176:179], v[44:47], v[72:75]
  s_waitcnt lgkmcnt(0)
  s_cmp_eq_u32 s3, 0
  s_cbranch_scc1 C_st
  v_cvt_pk_bf16_f32 v96, v48, v49
  v_cvt_pk_bf16_f32 v97, v50, v51
  v_cvt_pk_bf16_f32 v98, v52, v53
  v_cvt_pk_bf16_f32 v99, v54, v55
  buffer_store_dwordx4 v[96:99], v12, s[24:27], 0 offen sc0 sc1
  v_cvt_pk_bf16_f32 v100, v56, v57
  v_cvt_pk_bf16_f32 v101, v58, v59
  v_cvt_pk_bf16_f32 v102, v60, v61
  v_cvt_pk_bf16_f32 v103, v62, v63
  buffer_store_dwordx4 v[100:103], v12, s[24:27], s45 offen sc0 sc1
  v_cvt_pk_bf16_f32 v104, v64, v65
  v_cvt_pk_bf16_f32 v105, v66, v67
  v_cvt_pk_bf16_f32 v106, v68, v69
  v_cvt_pk_bf16_f32 v107, v70, v71
  buffer_store_dwordx4 v[104:107], v12, s[24:27], s46 offen sc0 sc1
  v_cvt_pk_bf16_f32 v108, v72, v73
  v_cvt_pk_bf16_f32 v109, v74, v75
  v_cvt_pk_bf16_f32 v110, v76, v77
  v_cvt_pk_bf16_f32 v111, v78, v79
  buffer_store_dwordx4 v[108:111], v12, s[24:27], s47 offen sc0 sc1
  s_branch C_end
C_st:
  s_nop 7
  v_pk_add_f32 v[16:17], v[48:49], v[50:51]
  v_pk_mul_f32 v[18:19], v[48:49], v[48:49]
  v_pk_fma_f32 v[18:19], v[50:51], v[50:51], v[18:19]
  v_pk_add_f32 v[16:17], v[16:17], v[52:53]
  v_pk_fma_f32 v[18:19], v[52:53], v[52:53], v[18:19]
  v_pk_add_f32 v[16:17], v[16:17], v[54:55]
  v_pk_fma_f32 v[18:19], v[54:55], v[54:55], v[18:19]
  v_add_f32 v32, v16, v17
  v_add_f32 v36, v18, v19
  v_pk_add_f32 v[20:21], v[56:57], v[58:59]
  v_pk_mul_f32 v[22:23], v[56:57], v[56:57]
  v_pk_fma_f32 v[22:23], v[58:59], v[58:59], v[22:23]
  v_pk_add_f32 v[20:21], v[20:21], v[60:61]
  v_pk_fma_f32 v[22:23], v[60:61], v[60:61], v[22:23]
  v_pk_add_f32 v[20:21], v[20:21], v[62:63]
  v_pk_fma_f32 v[22:23], v[62:63], v[62:63], v[22:23]
  v_add_f32 v33, v20, v21
  v_add_f32 v37, v22, v23
  v_pk_add_f32 v[24:25], v[64:65], v[66:67]
  v_pk_mul_f32 v[26:27], v[64:65], v[64:65]
  v_pk_fma_f32 v[26:27], v[66:67], v[66:67], v[26:27]
  v_pk_add_f32 v[24:25], v[24:25], v[68:69]
  v_pk_fma_f32 v[26:27], v[68:69], v[68:69], v[26:27]
  v_pk_add_f32 v[24:25], v[24:25], v[70:71]
  v_pk_fma_f32 v[26:27], v[70:71], v[70:71], v[26:27]
  v_add_f32 v34, v24, v25
  v_add_f32 v38, v26, v27
  v_pk_add_f32 v[28:29], v[72:73], v[74:75]
  v_pk_mul_f32 v[30:31], v[72:73], v[72:73]
  v_pk_fma_f32 v[30:31], v[74:75], v[74:75], v[30:31]
  v_pk_add_f32 v[28:29], v[28:29], v[76:77]
  v_pk_fma_f32 v[30:31], v[76:77], v[76:77], v[30:31]
  v_pk_add_f32 v[28:29], v[28:29], v[78:79]
  v_pk_fma_f32 v[30:31], v[78:79], v[78:79], v[30:31]
  v_add_f32 v35, v28, v29
  v_add_f32 v39, v30, v31
  v_permlane16_swap_b32 v32, v33
  v_permlane16_swap_b32 v34, v35
  v_permlane16_swap_b32 v36, v37
  v_permlane16_swap_b32 v38, v39
  v_add_f32 v32, v32, v33
  v_add_f32 v34, v34, v35
  v_add_f32 v36, v36, v37
  v_add_f32 v38, v38, v39
  v_permlane32_swap_b32 v32, v34
  s_nop 0
  v_permlane32_swap_b32 v36, v38
  v_add_f32 v40, v32, v34
  v_add_f32 v41, v36, v38
  ds_write_b64 v185, v[40:41]
  s_lshl_b32 s32, s28, 14
  s_lshl_b32 s40, s29, 9
  s_add_u32 s32, s32, s40
  s_waitcnt lgkmcnt(0)
  s_barrier
  s_cmp_lg_u32 s4, 0
  s_cbranch_scc1 C_nost
  ds_read_b64 v[44:45], v185 offset:512
  ds_read_b64 v[46:47], v185 offset:1024
  ds_read_b64 v[18:19], v185 offset:1536
  s_waitcnt lgkmcnt(0)
  v_pk_add_f32 v[40:41], v[40:41], v[44:45]
  v_pk_add_f32 v[46:47], v[46:47], v[18:19]
  v_pk_add_f32 v[40:41], v[40:41], v[46:47]
  buffer_store_dwordx2 v[40:41], v184, s[12:15], s32 offen sc0 sc1
C_nost:
  s_nop 1
  v_cvt_pk_bf16_f32 v96, v48, v49
  v_cvt_pk_bf16_f32 v97, v50, v51
  v_cvt_pk_bf16_f32 v98, v52, v53
  v_cvt_pk_bf16_f32 v99, v54, v55
  buffer_store_dwordx4 v[96:99], v12, s[24:27], 0 offen sc0 sc1
  v_cvt_pk_bf16_f32 v100, v56, v57
  v_cvt_pk_bf16_f32 v101, v58, v59
  v_cvt_pk_bf16_f32 v102, v60, v61
  v_cvt_pk_bf16_f32 v103, v62, v63
  buffer_store_dwordx4 v[100:103], v12, s[24:27], s45 offen sc0 sc1
  v_cvt_pk_bf16_f32 v104, v64, v65
  v_cvt_pk_bf16_f32 v105, v66, v67
  v_cvt_pk_bf16_f32 v106, v68, v69
  v_cvt_pk_bf16_f32 v107, v70, v71
  buffer_store_dwordx4 v[104:107], v12, s[24:27], s46 offen sc0 sc1
  v_cvt_pk_bf16_f32 v108, v72, v73
  v_cvt_pk_bf16_f32 v109, v74, v75
  v_cvt_pk_bf16_f32 v110, v76, v77
  v_cvt_pk_bf16_f32 v111, v78, v79
  buffer_store_dwordx4 v[108:111], v12, s[24:27], s47 offen sc0 sc1
  s_lshr_b32 s32, s2, 3
  s_lshr_b32 s5, s32, 3
  s_and_b32 s6, s32, 7
  s_lshl_b32 s7, s5, 1
  s_add_u32 s7, s7, s6
  s_and_b32 s7, s7, 7
  s_and_b32 s32, s2, 7
  s_lshr_b32 s28, s32, 1
  s_lshl_b32 s28, s28, 2
  s_add_u32 s28, s28, s5
  s_and_b32 s29, s32, 1
  s_mul_i32 s29, s29, 8
  s_add_u32 s29, s29, s6
  s_mov_b32 s30, 7
  s_mov_b32 s31, -1
  v_and_b32 v4, 15, v0
  v_lshrrev_b32 v5, 4, v0
  v_lshrrev_b32 v6, 2, v4
  v_and_b32 v7, 3, v0
  v_lshrrev_b32 v3, 5, v0
  v_and_b32 v2, 1, v5
  v_lshl_or_b32 v3, v2, 1, v3
  v_lshl_add_u32 v21, v5, 3, v6
  v_lshlrev_b32 v21, 7, v21
  v_lshl_add_u32 v21, v7, 3, v21
  v_lshrrev_b32 v22, 1, v6
  v_lshl_or_b32 v22, v2, 1, v22
  v_lshl_add_u32 v21, v22, 5, v21
  v_add_u32 v21, 18432, v21
  v_xor_b32 v8, 0, v21
  s_lshl_b32 s32, s4, 5
  v_xor_b32 v8, s32, v8
  v_lshrrev_b32 v21, 1, v4
  v_xor_b32 v21, v21, v5
  v_lshlrev_b32 v21, 4, v21
  v_lshlrev_b32 v22, 7, v4
  v_add_u32 v9, v21, v22
  v_xor_b32 v10, 64, v9
  v_and_b32 v21, 1, v4
  v_mul_u32_u24 v21, 28800, v21
  v_lshrrev_b32 v22, 1, v4
  v_mul_u32_u24 v22, 400, v22
  v_lshlrev_b32 v23, 3, v5
  v_add3_u32 v11, v21, v22, v23
  s_add_u32 s32, s32, 43008
  v_add_u32 v11, s32, v11
  v_lshlrev_b32 v12, 3, v4
  v_add_u32 v12, 129024, v12
  v_mov_b64 v[112:113], 0
  v_mov_b64 v[114:115], 0
  v_mov_b64 v[116:117], 0
  v_mov_b64 v[118:119], 0
  v_mov_b64 v[120:121], 0
  v_mov_b64 v[122:123], 0
  v_mov_b64 v[124:125], 0
  v_mov_b64 v[126:127], 0
  v_mov_b64 v[128:129], 0
  v_mov_b64 v[130:131], 0
  v_mov_b64 v[132:133], 0
  v_mov_b64 v[134:135], 0
  v_mov_b64 v[136:137], 0
  v_mov_b64 v[138:139], 0
  v_mov_b64 v[140:141], 0
  v_mov_b64 v[142:143], 0
  v_mov_b64 v[144:145], 0
  v_mov_b64 v[146:147], 0
  v_mov_b64 v[148:149], 0
  v_mov_b64 v[150:151], 0
  v_mov_b64 v[152:153], 0
  v_mov_b64 v[154:155], 0
  v_mov_b64 v[156:157], 0
  v_mov_b64 v[158:159], 0
  v_mov_b64 v[160:161], 0
  v_mov_b64 v[162:163], 0
  v_mov_b64 v[164:165], 0
  v_mov_b64 v[166:167], 0
  v_mov_b64 v[168:169], 0
  v_mov_b64 v[170:171], 0
  v_mov_b64 v[172:173], 0
  v_mov_b64 v[174:175], 0
  v_mov_b64 v[176:177], 0
  v_mov_b64 v[178:179], 0
  v_mov_b64 v[180:181], 0
  v_mov_b64 v[182:183], 0
  v_mov_b64 v[184:185], 0
  v_mov_b64 v[186:187], 0
  v_mov_b64 v[188:189], 0
  v_mov_b64 v[190:191], 0
  v_mov_b64 v[192:193], 0
  v_mov_b64 v[194:195], 0
  v_mov_b64 v[196:197], 0
  v_mov_b64 v[198:199], 0
  v_mov_b64 v[200:201], 0
  v_mov_b64 v[202:203], 0
  v_mov_b64 v[204:205], 0
  v_mov_b64 v[206:207], 0
  v_mov_b64 v[208:209], 0
  v_mov_b64 v[210:211], 0
  v_mov_b64 v[212:213], 0
  v_mov_b64 v[214:215], 0
  v_mov_b64 v[216:217], 0
  v_mov_b64 v[218:219], 0
  s_waitcnt vmcnt(0)
  s_barrier
  s_barrier
  s_mov_b32 s3, 1
  s_mov_b32 s51, 9
  s_add_u32 s82, s84, 33554432
  s_addc_u32 s83, s85, 0
  s_branch C_top
C_end:
  s_endpgm
L_start:
  s_nop 7
  s_nop 7
  s_sub_u32 s57, s4, 4
  v_and_b32 v134, 3, v0
  v_lshlrev_b32 v134, 6, v134
  s_lshr_b32 s32, s2, 3
  s_lshr_b32 s5, s32, 3
  s_and_b32 s6, s32, 7
  s_lshl_b32 s7, s5, 1
  s_add_u32 s7, s7, s6
  s_and_b32 s7, s7, 7
  s_and_b32 s32, s2, 7
  s_lshr_b32 s28, s32, 1
  s_lshl_b32 s28, s28, 2
  s_add_u32 s28, s28, s5
  s_and_b32 s29, s32, 1
  s_mul_i32 s29, s29, 8
  s_add_u32 s29, s29, s6
  s_mov_b32 s30, 7
  s_mov_b32 s31, -1
  s_mov_b32 s41, s57
  s_mul_i32 s32, s41, 16
  s_add_u32 s32, s32, 0
  v_lshrrev_b32 v2, 3, v0
  v_add_u32 v2, s32, v2
  v_bfe_u32 v3, v2, 1, 1
  v_bfe_u32 v4, v2, 3, 1
  v_lshl_or_b32 v3, v4, 1, v3
  v_lshlrev_b32 v3, 1, v3
  v_and_b32 v4, 7, v0
  v_xor_b32 v3, v3, v4
  v_lshlrev_b32 v3, 4, v3
  s_mov_b32 s32, 6144
  v_mul_lo_u32 v2, v2, s32
  v_add_u32 v13, v2, v3
  s_mul_i32 s32, s41, 16
  s_add_u32 s32, s32, 8
  v_lshrrev_b32 v2, 3, v0
  v_add_u32 v2, s32, v2
  v_bfe_u32 v3, v2, 1, 1
  v_bfe_u32 v4, v2, 3, 1
  v_lshl_or_b32 v3, v4, 1, v3
  v_lshlrev_b32 v3, 1, v3
  v_and_b32 v4, 7, v0
  v_xor_b32 v3, v3, v4
  v_lshlrev_b32 v3, 4, v3
  s_mov_b32 s32, 6144
  v_mul_lo_u32 v2, v2, s32
  v_add_u32 v14, v2, v3
  v_subrev_u32 v14, 1024, v14
  v_add_u32 v15, 2048, v13
  v_add_u32 v16, 2048, v14
  v_add_u32 v17, 4096, v13
  v_add_u32 v18, 4096, v14
  s_lshl_b32 s46, s41, 11
  s_add_u32 s46, s46, 18432
  s_add_u32 s47, s46, 8192
  s_add_u32 s48, s46, 16384
  s_lshl_b32 s35, s29, 7
  s_lshl_b32 s40, s28, 7
  s_sub_u32 s40, s40, 16
  s_lshl_b32 s32, s41, 5
  s_add_u32 s32, s32, 16
  v_lshrrev_b32 v2, 3, v0
  v_add_u32 v2, s32, v2
  v_bfe_u32 v3, v2, 1, 3
  v_and_b32 v4, 7, v0
  v_xor_b32 v3, v3, v4
  v_lshlrev_b32 v3, 4, v3
  v_add_u32 v2, s40, v2
  v_max_i32 v2, 0, v2
  v_lshlrev_b32 v2, 11, v2
  v_add_u32 v8, v2, v3
  v_add_u32 v10, 30720, v8
  s_lshl_b32 s32, s41, 5
  s_add_u32 s32, s32, 24
  v_lshrrev_b32 v2, 3, v0
  v_add_u32 v2, s32, v2
  v_bfe_u32 v3, v2, 1, 3
  v_and_b32 v4, 7, v0
  v_xor_b32 v3, v3, v4
  v_lshlrev_b32 v3, 4, v3
  v_add_u32 v2, s40, v2
  v_max_i32 v2, 0, v2
  v_lshlrev_b32 v2, 11, v2
  v_add_u32 v9, v2, v3
  v_subrev_u32 v9, 1024, v9
  v_add_u32 v11, 30720, v9
  s_lshl_b32 s32, s41, 3
  v_lshrrev_b32 v2, 3, v0
  v_add_u32 v2, s32, v2
  v_bfe_u32 v3, v2, 1, 3
  v_and_b32 v4, 7, v0
  v_xor_b32 v3, v3, v4
  v_lshlrev_b32 v3, 4, v3
  v_add_u32 v2, s40, v2
  v_max_i32 v2, 0, v2
  v_lshlrev_b32 v2, 11, v2
  v_add_u32 v12, v2, v3
  s_lshl_b32 s44, s41, 12
  s_add_u32 s44, s44, 2048
  s_lshl_b32 s45, s41, 10
  s_mov_b32 s34, 0
  s_cmp_eq_u32 s41, 0
  s_cselect_b32 s52, 0xffffff00, -1
  s_mov_b32 s53, -1
  v_mov_b32 v20, 0x3f803f80
  v_mov_b32 v21, v20
  v_mov_b32 v22, v20
  v_mov_b32 v23, v20
  v_lshlrev_b32 v24, 4, v0
  v_add_u32 v25, 86016, v24
  s_mov_b64 exec, 0xff
  ds_write_b128 v24, v[20:23]
  ds_write_b128 v24, v[20:23] offset:43008
  ds_write_b128 v25, v[20:23]
  s_mov_b64 exec, -1
  s_lshl_b32 s32, s41, 6
  v_add_u32 v26, s32, v0
  v_min_u32 v26, 143, v26
  v_add_u32 v27, s40, v26
  v_max_i32 v27, 0, v27
  v_lshlrev_b32 v27, 3, v27
  v_lshlrev_b32 v26, 3, v26
  v_add_u32 v26, 129024, v26
  s_lshl_b32 s32, s2, 3
  s_lshl_b32 s40, s57, 1
  s_add_u32 s32, s32, s40
  v_lshrrev_b32 v72, 5, v0
  v_add_u32 v72, s32, v72
  v_lshlrev_b32 v46, 11, v72
  v_and_b32 v2, 31, v0
  v_lshl_add_u32 v46, v2, 4, v46
  v_lshlrev_b32 v72, 3, v72
  v_add_u32 v72, 22020096, v72
  s_cmp_eq_u32 s57, 0
  s_cselect_b32 s58, 0, -1
  v_mov_b32 v64, s58
  v_mov_b32 v65, s58
  v_mov_b32 v66, s58
  v_mov_b32 v67, s58
  v_lshrrev_b32 v2, 3, v0
  v_lshlrev_b32 v2, 15, v2
  v_and_b32 v3, 7, v0
  v_lshl_add_u32 v2, v3, 4, v2
  v_lshlrev_b32 v3, 4, v0
  s_cselect_b64 vcc, -1, 0
  s_lshl_b32 s58, s2, 7
  s_add_u32 s58, s58, 29360128
  s_lshl_b32 s59, s2, 10
  s_add_u32 s59, s59, 20971520
  s_cmp_eq_u32 s57, 0
  s_cselect_b32 s58, s58, s59
  s_add_u32 s59, s59, 33554432
  s_cmp_eq_u32 s57, 2
  s_cselect_b32 s58, s59, s58
  s_cmp_eq_u32 s57, 3
  s_cselect_b32 s58, 134217728, s58
  v_cndmask_b32 v47, v3, v2, vcc
  s_and_b32 s59, s2, 3
  s_lshl_b32 s59, s59, 6
  v_mov_b32 v73, s59
  v_mov_b32 v74, 1
  s_lshl_b32 s56, s3, 10
  s_mul_i32 s32, s28, 16
  s_add_u32 s56, s56, s32
  s_add_u32 s56, s56, s29
  s_add_u32 s56, s56, 0
  s_lshl_b32 s56, s56, 7
  s_mov_b32 s38, 0
  s_waitcnt lgkmcnt(0)
  s_mov_b32 s8, s64
  s_mov_b32 s9, s65
  s_mov_b32 s10, 4194304
  s_mov_b32 s11, 0x20000
  s_mov_b32 s12, s66
  s_mov_b32 s13, s67
  s_mov_b32 s14, 6291456
  s_mov_b32 s15, 0x20000
  s_branch L_first
L_top:
  s_nop 7
  s_nop 7
  s_lshl_b32 s56, s3, 10
  s_mul_i32 s32, s28, 16
  s_add_u32 s56, s56, s32
  s_add_u32 s56, s56, s29
  s_add_u32 s56, s56, 0
  s_lshl_b32 s56, s56, 7
  s_mov_b32 s24, s72
  s_mov_b32 s25, s73
  s_mov_b32 s26, 14680064
  s_mov_b32 s27, 0x20000
  s_lshl_b32 s54, s2, 2
  s_add_u32 s54, s54, s57
  s_mul_i32 s54, s54, 0
  s_add_u32 s54, s54, 0
  s_cmp_ge_u32 s57, 2
  s_cbranch_scc1 L_k1B
  s_mov_b32 s30, 7
  s_mov_b32 s31, -1
  s_mov_b32 s38, 0
  s_add_u32 s30, s30, 1
  s_and_b32 s30, s30, 7
  s_cselect_b32 s32, 0, 1
  s_add_u32 s31, s31, s32
  s_sub_u32 s32, s30, s7
  s_and_b32 s32, s32, 7
  s_cmp_lt_u32 s32, 2
  s_cselect_b32 s32, 1, 0
  s_add_u32 s32, s32, s31
  s_cmp_ge_u32 s32, 2
  s_cselect_b32 s32, 0, s32
  s_lshl_b32 s33, s32, 3
  s_add_u32 s33, s33, s30
  s_mul_i32 s36, s33, 128
  s_add_u32 s36, s36, s34
  s_add_u32 m0, s38, s45
  s_mov_b64 exec, s[52:53]
  buffer_load_dwordx4 v12, s[8:11], s36 offen offset:0 sc1 lds
  s_mov_b64 exec, -1
  s_add_u32 m0, s38, s44
  s_nop 0
  buffer_load_dwordx4 v8, s[8:11], s36 offen offset:0 sc1 lds
  buffer_load_dwordx4 v9, s[8:11], s36 offen offset:1024 sc1 lds
  buffer_load_dwordx4 v10, s[8:11], s36 offen offset:2048 sc1 lds
  buffer_load_dwordx4 v11, s[8:11], s36 offen offset:3072 sc1 lds
  s_add_u32 s38, s38, 43008
  s_cmp_eq_u32 s38, 129024
  s_cselect_b32 s38, 0, s38
  s_add_u32 s30, s30, 1
  s_and_b32 s30, s30, 7
  s_cselect_b32 s32, 0, 1
  s_add_u32 s31, s31, s32
  s_sub_u32 s32, s30, s7
  s_and_b32 s32, s32, 7
  s_cmp_lt_u32 s32, 2
  s_cselect_b32 s32, 1, 0
  s_add_u32 s32, s32, s31
  s_cmp_ge_u32 s32, 2
  s_cselect_b32 s32, 0, s32
  s_lshl_b32 s33, s32, 3
  s_add_u32 s33, s33, s30
  s_mul_i32 s36, s33, 128
  s_add_u32 s36, s36, s34
  s_add_u32 m0, s38, s45
  s_mov_b64 exec, s[52:53]
  buffer_load_dwordx4 v12, s[8:11], s36 offen offset:0 sc1 lds
  s_mov_b64 exec, -1
  s_add_u32 m0, s38, s44
  s_nop 0
  buffer_load_dwordx4 v8, s[8:11], s36 offen offset:0 sc1 lds
  buffer_load_dwordx4 v9, s[8:11], s36 offen offset:1024 sc1 lds
  buffer_load_dwordx4 v10, s[8:11], s36 offen offset:2048 sc1 lds
  buffer_load_dwordx4 v11, s[8:11], s36 offen offset:3072 sc1 lds
  s_add_u32 s38, s38, 43008
  s_cmp_eq_u32 s38, 129024
  s_cselect_b32 s38, 0, s38
  s_waitcnt vmcnt(5)
  s_barrier
  s_add_u32 s30, s30, 1
  s_and_b32 s30, s30, 7
  s_cselect_b32 s32, 0, 1
  s_add_u32 s31, s31, s32
  s_sub_u32 s32, s30, s7
  s_and_b32 s32, s32, 7
  s_cmp_lt_u32 s32, 2
  s_cselect_b32 s32, 1, 0
  s_add_u32 s32, s32, s31
  s_cmp_ge_u32 s32, 2
  s_cselect_b32 s32, 0, s32
  s_lshl_b32 s33, s32, 3
  s_add_u32 s33, s33, s30
  s_mul_i32 s36, s33, 128
  s_add_u32 s36, s36, s34
  s_mul_i32 s37, s33, 393216
  s_add_u32 s37, s37, s35
  s_add_u32 m0, s38, s45
  s_mov_b64 exec, s[52:53]
  buffer_load_dwordx4 v12, s[8:11], s36 offen offset:0 sc1 lds
  s_mov_b64 exec, -1
  s_add_u32 m0, s38, s44
  s_nop 0
  buffer_load_dwordx4 v8, s[8:11], s36 offen offset:0 sc1 lds
  buffer_load_dwordx4 v9, s[8:11], s36 offen offset:1024 sc1 lds
  buffer_load_dwordx4 v10, s[8:11], s36 offen offset:2048 sc1 lds
  buffer_load_dwordx4 v11, s[8:11], s36 offen offset:3072 sc1 lds
  s_add_u32 m0, s38, s46
  s_nop 0
  buffer_load_dwordx4 v13, s[12:15], s37 offen offset:0  lds
  buffer_load_dwordx4 v14, s[12:15], s37 offen offset:1024  lds
  s_add_u32 m0, s38, s47
  s_nop 0
  buffer_load_dwordx4 v15, s[12:15], s37 offen offset:0  lds
  buffer_load_dwordx4 v16, s[12:15], s37 offen offset:1024  lds
  s_add_u32 m0, s38, s48
  s_nop 0
  buffer_load_dwordx4 v17, s[12:15], s37 offen offset:0  lds
  buffer_load_dwordx4 v18, s[12:15], s37 offen offset:1024  lds
  s_add_u32 s38, s38, 43008
  s_cmp_eq_u32 s38, 129024
  s_cselect_b32 s38, 0, s38
L_jA:
  s_nop 1
  s_waitcnt vmcnt(11)
  s_barrier
  s_add_u32 s30, s30, 1
  s_and_b32 s30, s30, 7
  s_cselect_b32 s32, 0, 1
  s_add_u32 s31, s31, s32
  s_sub_u32 s32, s30, s7
  s_and_b32 s32, s32, 7
  s_cmp_lt_u32 s32, 2
  s_cselect_b32 s32, 1, 0
  s_add_u32 s32, s32, s31
  s_cmp_ge_u32 s32, 2
  s_cselect_b32 s32, 0, s32
  s_lshl_b32 s33, s32, 3
  s_add_u32 s33, s33, s30
  s_mul_i32 s36, s33, 128
  s_add_u32 s36, s36, s34
  s_mul_i32 s37, s33, 393216
  s_add_u32 s37, s37, s35
  s_add_u32 m0, s38, s45
  s_mov_b64 exec, s[52:53]
  buffer_load_dwordx4 v12, s[8:11], s36 offen offset:0 sc1 lds
  s_mov_b64 exec, -1
  s_add_u32 m0, s38, s44
  s_nop 0
  buffer_load_dwordx4 v8, s[8:11], s36 offen offset:0 sc1 lds
  buffer_load_dwordx4 v9, s[8:11], s36 offen offset:1024 sc1 lds
  buffer_load_dwordx4 v10, s[8:11], s36 offen offset:2048 sc1 lds
  buffer_load_dwordx4 v11, s[8:11], s36 offen offset:3072 sc1 lds
  s_add_u32 m0, s38, s46
  s_nop 0
  buffer_load_dwordx4 v13, s[12:15], s37 offen offset:0  lds
  buffer_load_dwordx4 v14, s[12:15], s37 offen offset:1024  lds
  s_add_u32 m0, s38, s47
  s_nop 0
  buffer_load_dwordx4 v15, s[12:15], s37 offen offset:0  lds
  buffer_load_dwordx4 v16, s[12:15], s37 offen offset:1024  lds
  s_add_u32 m0, s38, s48
  s_nop 0
  buffer_load_dwordx4 v17, s[12:15], s37 offen offset:0  lds
  buffer_load_dwordx4 v18, s[12:15], s37 offen offset:1024  lds
  s_add_u32 s38, s38, 43008
  s_cmp_eq_u32 s38, 129024
  s_cselect_b32 s38, 0, s38
  s_waitcnt vmcnt(11)
  s_barrier
  s_add_u32 s30, s30, 1
  s_and_b32 s30, s30, 7
  s_cselect_b32 s32, 0, 1
  s_add_u32 s31, s31, s32
  s_sub_u32 s32, s30, s7
  s_and_b32 s32, s32, 7
  s_cmp_lt_u32 s32, 2
  s_cselect_b32 s32, 1, 0
  s_add_u32 s32, s32, s31
  s_cmp_ge_u32 s32, 2
  s_cselect_b32 s32, 0, s32
  s_lshl_b32 s33, s32, 3
  s_add_u32 s33, s33, s30
  s_mul_i32 s36, s33, 128
  s_add_u32 s36, s36, s34
  s_mul_i32 s37, s33, 393216
  s_add_u32 s37, s37, s35
  s_add_u32 m0, s38, s45
  s_mov_b64 exec, s[52:53]
  buffer_load_dwordx4 v12, s[8:11], s36 offen offset:0 sc1 lds
  s_mov_b64 exec, -1
  s_add_u32 m0, s38, s44
  s_nop 0
  buffer_load_dwordx4 v8, s[8:11], s36 offen offset:0 sc1 lds
  buffer_load_dwordx4 v9, s[8:11], s36 offen offset:1024 sc1 lds
  buffer_load_dwordx4 v10, s[8:11], s36 offen offset:2048 sc1 lds
  buffer_load_dwordx4 v11, s[8:11], s36 offen offset:3072 sc1 lds
  s_add_u32 m0, s38, s46
  s_nop 0
  buffer_load_dwordx4 v13, s[12:15], s37 offen offset:0  lds
  buffer_load_dwordx4 v14, s[12:15], s37 offen offset:1024  lds
  s_add_u32 m0, s38, s47
  s_nop 0
  buffer_load_dwordx4 v15, s[12:15], s37 offen offset:0  lds
  buffer_load_dwordx4 v16, s[12:15], s37 offen offset:1024  lds
  s_add_u32 m0, s38, s48
  s_nop 0
  buffer_load_dwordx4 v17, s[12:15], s37 offen offset:0  lds
  buffer_load_dwordx4 v18, s[12:15], s37 offen offset:1024  lds
  s_add_u32 s38, s38, 43008
  s_cmp_eq_u32 s38, 129024
  s_cselect_b32 s38, 0, s38
  s_cmp_lg_u32 s3, 0
  s_cbranch_scc1 e6
  s_cmp_lg_u32 s57, 0
  s_cbranch_scc1 g7
  s_mov_b64 exec, 1
  global_atomic_add v73, v74, s[62:63] sc1
  s_mov_b64 exec, -1
g7:
e6:
  s_nop 1
  s_mov_b32 s39, 9
ll8:
  s_waitcnt vmcnt(11)
  s_barrier
  s_add_u32 s30, s30, 1
  s_and_b32 s30, s30, 7
  s_cselect_b32 s32, 0, 1
  s_add_u32 s31, s31, s32
  s_sub_u32 s32, s30, s7
  s_and_b32 s32, s32, 7
  s_cmp_lt_u32 s32, 2
  s_cselect_b32 s32, 1, 0
  s_add_u32 s32, s32, s31
  s_cmp_ge_u32 s32, 2
  s_cselect_b32 s32, 0, s32
  s_lshl_b32 s33, s32, 3
  s_add_u32 s33, s33, s30
  s_mul_i32 s36, s33, 128
  s_add_u32 s36, s36, s34
  s_mul_i32 s37, s33, 393216
  s_add_u32 s37, s37, s35
  s_add_u32 m0, s38, s45
  s_mov_b64 exec, s[52:53]
  buffer_load_dwordx4 v12, s[8:11], s36 offen offset:0 sc1 lds
  s_mov_b64 exec, -1
  s_add_u32 m0, s38, s44
  s_nop 0
  buffer_load_dwordx4 v8, s[8:11], s36 offen offset:0 sc1 lds
  buffer_load_dwordx4 v9, s[8:11], s36 offen offset:1024 sc1 lds
  buffer_load_dwordx4 v10, s[8:11], s36 offen offset:2048 sc1 lds
  buffer_load_dwordx4 v11, s[8:11], s36 offen offset:3072 sc1 lds
  s_add_u32 m0, s38, s46
  s_nop 0
  buffer_load_dwordx4 v13, s[12:15], s37 offen offset:0  lds
  buffer_load_dwordx4 v14, s[12:15], s37 offen offset:1024  lds
  s_add_u32 m0, s38, s47
  s_nop 0
  buffer_load_dwordx4 v15, s[12:15], s37 offen offset:0  lds
  buffer_load_dwordx4 v16, s[12:15], s37 offen offset:1024  lds
  s_add_u32 m0, s38, s48
  s_nop 0
  buffer_load_dwordx4 v17, s[12:15], s37 offen offset:0  lds
  buffer_load_dwordx4 v18, s[12:15], s37 offen offset:1024  lds
  s_add_u32 s38, s38, 43008
  s_cmp_eq_u32 s38, 129024
  s_cselect_b32 s38, 0, s38
  s_sub_u32 s39, s39, 1
  s_cmp_lg_u32 s39, 0
  s_cbranch_scc1 ll8
  s_waitcnt vmcnt(11)
  s_barrier
  s_add_u32 s30, s30, 1
  s_and_b32 s30, s30, 7
  s_cselect_b32 s32, 0, 1
  s_add_u32 s31, s31, s32
  s_sub_u32 s32, s30, s7
  s_and_b32 s32, s32, 7
  s_cmp_lt_u32 s32, 2
  s_cselect_b32 s32, 1, 0
  s_add_u32 s32, s32, s31
  s_cmp_ge_u32 s32, 2
  s_cselect_b32 s32, 0, s32
  s_lshl_b32 s33, s32, 3
  s_add_u32 s33, s33, s30
  s_mul_i32 s36, s33, 128
  s_add_u32 s36, s36, s34
  s_mul_i32 s37, s33, 393216
  s_add_u32 s37, s37, s35
  s_add_u32 m0, s38, s45
  s_mov_b64 exec, s[52:53]
  buffer_load_dwordx4 v12, s[8:11], s36 offen offset:0 sc1 lds
  s_mov_b64 exec, -1
  s_add_u32 m0, s38, s44
  s_nop 0
  buffer_load_dwordx4 v8, s[8:11], s36 offen offset:0 sc1 lds
  buffer_load_dwordx4 v9, s[8:11], s36 offen offset:1024 sc1 lds
  buffer_load_dwordx4 v10, s[8:11], s36 offen offset:2048 sc1 lds
  buffer_load_dwordx4 v11, s[8:11], s36 offen offset:3072 sc1 lds
  s_add_u32 m0, s38, s46
  s_nop 0
  buffer_load_dwordx4 v13, s[12:15], s37 offen offset:0  lds
  buffer_load_dwordx4 v14, s[12:15], s37 offen offset:1024  lds
  s_add_u32 m0, s38, s47
  s_nop 0
  buffer_load_dwordx4 v15, s[12:15], s37 offen offset:0  lds
  buffer_load_dwordx4 v16, s[12:15], s37 offen offset:1024  lds
  s_add_u32 m0, s38, s48
  s_nop 0
  buffer_load_dwordx4 v17, s[12:15], s37 offen offset:0  lds
  buffer_load_dwordx4 v18, s[12:15], s37 offen offset:1024  lds
  s_add_u32 s38, s38, 43008
  s_cmp_eq_u32 s38, 129024
  s_cselect_b32 s38, 0, s38
  global_load_dword v29, v134, s[62:63] sc0 sc1
  s_waitcnt vmcnt(11)
  s_barrier
  s_add_u32 s30, s30, 1
  s_and_b32 s30, s30, 7
  s_cselect_b32 s32, 0, 1
  s_add_u32 s31, s31, s32
  s_sub_u32 s32, s30, s7
  s_and_b32 s32, s32, 7
  s_cmp_lt_u32 s32, 2
  s_cselect_b32 s32, 1, 0
  s_add_u32 s32, s32, s31
  s_cmp_ge_u32 s32, 2
  s_cselect_b32 s32, 0, s32
  s_lshl_b32 s33, s32, 3
  s_add_u32 s33, s33, s30
  s_mul_i32 s36, s33, 128
  s_add_u32 s36, s36, s34
  s_mul_i32 s37, s33, 393216
  s_add_u32 s37, s37, s35
  s_add_u32 m0, s38, s45
  s_mov_b64 exec, s[52:53]
  buffer_load_dwordx4 v12, s[8:11], s36 offen offset:0 sc1 lds
  s_mov_b64 exec, -1
  s_add_u32 m0, s38, s44
  s_nop 0
  buffer_load_dwordx4 v8, s[8:11], s36 offen offset:0 sc1 lds
  buffer_load_dwordx4 v9, s[8:11], s36 offen offset:1024 sc1 lds
  buffer_load_dwordx4 v10, s[8:11], s36 offen offset:2048 sc1 lds
  buffer_load_dwordx4 v11, s[8:11], s36 offen offset:3072 sc1 lds
  s_add_u32 m0, s38, s46
  s_nop 0
  buffer_load_dwordx4 v13, s[12:15], s37 offen offset:0  lds
  buffer_load_dwordx4 v14, s[12:15], s37 offen offset:1024  lds
  s_add_u32 m0, s38, s47
  s_nop 0
  buffer_load_dwordx4 v15, s[12:15], s37 offen offset:0  lds
  buffer_load_dwordx4 v16, s[12:15], s37 offen offset:1024  lds
  s_add_u32 m0, s38, s48
  s_nop 0
  buffer_load_dwordx4 v17, s[12:15], s37 offen offset:0  lds
  buffer_load_dwordx4 v18, s[12:15], s37 offen offset:1024  lds
  s_add_u32 s38, s38, 43008
  s_cmp_eq_u32 s38, 129024
  s_cselect_b32 s38, 0, s38
  s_cmp_lg_u32 s3, 0
  s_cbranch_scc1 st9g
  s_waitcnt vmcnt(11)
  s_mov_b32 s61, 0
st9p:
  v_cmp_gt_u32 vcc, 64, v29
  s_add_u32 s61, s61, 1
  s_cmp_gt_u32 s61, 1000000
  s_cbranch_scc1 st9g
  s_cbranch_vccz st9g
  global_load_dword v29, v134, s[62:63] sc0 sc1
  s_waitcnt vmcnt(0)
  s_branch st9p
st9g:
  buffer_load_dwordx2 v[30:31], v27, s[20:23], 0 offen sc1
  s_mov_b32 s32, 16384
  buffer_load_dwordx2 v[32:33], v27, s[20:23], s32 offen sc1
  s_mov_b32 s32, 32768
  buffer_load_dwordx2 v[34:35], v27, s[20:23], s32 offen sc1
  s_mov_b32 s32, 49152
  buffer_load_dwordx2 v[36:37], v27, s[20:23], s32 offen sc1
  s_mov_b32 s32, 65536
  buffer_load_dwordx2 v[38:39], v27, s[20:23], s32 offen sc1
  s_mov_b32 s32, 81920
  buffer_load_dwordx2 v[40:41], v27, s[20:23], s32 offen sc1
  s_mov_b32 s32, 98304
  buffer_load_dwordx2 v[42:43], v27, s[20:23], s32 offen sc1
  s_mov_b32 s32, 114688
  buffer_load_dwordx2 v[44:45], v27, s[20:23], s32 offen sc1
  s_waitcnt vmcnt(19)
  s_barrier
  s_branch L_k1t
L_k1B:
  s_nop 7
  s_nop 7
  s_mov_b32 s30, 7
  s_mov_b32 s31, -1
  s_mov_b32 s38, 0
  s_add_u32 s30, s30, 1
  s_and_b32 s30, s30, 7
  s_cselect_b32 s32, 0, 1
  s_add_u32 s31, s31, s32
  s_sub_u32 s32, s30, s7
  s_and_b32 s32, s32, 7
  s_cmp_lt_u32 s32, 2
  s_cselect_b32 s32, 1, 0
  s_add_u32 s32, s32, s31
  s_cmp_ge_u32 s32, 2
  s_cselect_b32 s32, 0, s32
  s_lshl_b32 s33, s32, 3
  s_add_u32 s33, s33, s30
  s_mul_i32 s36, s33, 128
  s_add_u32 s36, s36, s34
  s_add_u32 m0, s38, s44
  s_nop 0
  buffer_load_dwordx4 v8, s[8:11], s36 offen offset:0 sc1 lds
  buffer_load_dwordx4 v9, s[8:11], s36 offen offset:1024 sc1 lds
  buffer_load_dwordx4 v10, s[8:11], s36 offen offset:2048 sc1 lds
  buffer_load_dwordx4 v11, s[8:11], s36 offen offset:3072 sc1 lds
  s_add_u32 s38, s38, 43008
  s_cmp_eq_u32 s38, 129024
  s_cselect_b32 s38, 0, s38
  s_add_u32 s30, s30, 1
  s_and_b32 s30, s30, 7
  s_cselect_b32 s32, 0, 1
  s_add_u32 s31, s31, s32
  s_sub_u32 s32, s30, s7
  s_and_b32 s32, s32, 7
  s_cmp_lt_u32 s32, 2
  s_cselect_b32 s32, 1, 0
  s_add_u32 s32, s32, s31
  s_cmp_ge_u32 s32, 2
  s_cselect_b32 s32, 0, s32
  s_lshl_b32 s33, s32, 3
  s_add_u32 s33, s33, s30
  s_mul_i32 s36, s33, 128
  s_add_u32 s36, s36, s34
  s_add_u32 m0, s38, s44
  s_nop 0
  buffer_load_dwordx4 v8, s[8:11], s36 offen offset:0 sc1 lds
  buffer_load_dwordx4 v9, s[8:11], s36 offen offset:1024 sc1 lds
  buffer_load_dwordx4 v10, s[8:11], s36 offen offset:2048 sc1 lds
  buffer_load_dwordx4 v11, s[8:11], s36 offen offset:3072 sc1 lds
  s_add_u32 s38, s38, 43008
  s_cmp_eq_u32 s38, 129024
  s_cselect_b32 s38, 0, s38
  s_waitcnt vmcnt(4)
  s_barrier
  s_add_u32 s30, s30, 1
  s_and_b32 s30, s30, 7
  s_cselect_b32 s32, 0, 1
  s_add_u32 s31, s31, s32
  s_sub_u32 s32, s30, s7
  s_and_b32 s32, s32, 7
  s_cmp_lt_u32 s32, 2
  s_cselect_b32 s32, 1, 0
  s_add_u32 s32, s32, s31
  s_cmp_ge_u32 s32, 2
  s_cselect_b32 s32, 0, s32
  s_lshl_b32 s33, s32, 3
  s_add_u32 s33, s33, s30
  s_mul_i32 s36, s33, 128
  s_add_u32 s36, s36, s34
  s_mul_i32 s37, s33, 393216
  s_add_u32 s37, s37, s35
  s_add_u32 m0, s38, s44
  s_nop 0
  buffer_load_dwordx4 v8, s[8:11], s36 offen offset:0 sc1 lds
  buffer_load_dwordx4 v9, s[8:11], s36 offen offset:1024 sc1 lds
  buffer_load_dwordx4 v10, s[8:11], s36 offen offset:2048 sc1 lds
  buffer_load_dwordx4 v11, s[8:11], s36 offen offset:3072 sc1 lds
  s_add_u32 m0, s38, s46
  s_nop 0
  buffer_load_dwordx4 v13, s[12:15], s37 offen offset:0  lds
  buffer_load_dwordx4 v14, s[12:15], s37 offen offset:1024  lds
  s_add_u32 m0, s38, s47
  s_nop 0
  buffer_load_dwordx4 v15, s[12:15], s37 offen offset:0  lds
  buffer_load_dwordx4 v16, s[12:15], s37 offen offset:1024  lds
  s_add_u32 m0, s38, s48
  s_nop 0
  buffer_load_dwordx4 v17, s[12:15], s37 offen offset:0  lds
  buffer_load_dwordx4 v18, s[12:15], s37 offen offset:1024  lds
  s_add_u32 s38, s38, 43008
  s_cmp_eq_u32 s38, 129024
  s_cselect_b32 s38, 0, s38
L_jB:
  s_nop 1
  s_waitcnt vmcnt(10)
  s_barrier
  s_add_u32 s30, s30, 1
  s_and_b32 s30, s30, 7
  s_cselect_b32 s32, 0, 1
  s_add_u32 s31, s31, s32
  s_sub_u32 s32, s30, s7
  s_and_b32 s32, s32, 7
  s_cmp_lt_u32 s32, 2
  s_cselect_b32 s32, 1, 0
  s_add_u32 s32, s32, s31
  s_cmp_ge_u32 s32, 2
  s_cselect_b32 s32, 0, s32
  s_lshl_b32 s33, s32, 3
  s_add_u32 s33, s33, s30
  s_mul_i32 s36, s33, 128
  s_add_u32 s36, s36, s34
  s_mul_i32 s37, s33, 393216
  s_add_u32 s37, s37, s35
  s_add_u32 m0, s38, s44
  s_nop 0
  buffer_load_dwordx4 v8, s[8:11], s36 offen offset:0 sc1 lds
  buffer_load_dwordx4 v9, s[8:11], s36 offen offset:1024 sc1 lds
  buffer_load_dwordx4 v10, s[8:11], s36 offen offset:2048 sc1 lds
  buffer_load_dwordx4 v11, s[8:11], s36 offen offset:3072 sc1 lds
  s_add_u32 m0, s38, s46
  s_nop 0
  buffer_load_dwordx4 v13, s[12:15], s37 offen offset:0  lds
  buffer_load_dwordx4 v14, s[12:15], s37 offen offset:1024  lds
  s_add_u32 m0, s38, s47
  s_nop 0
  buffer_load_dwordx4 v15, s[12:15], s37 offen offset:0  lds
  buffer_load_dwordx4 v16, s[12:15], s37 offen offset:1024  lds
  s_add_u32 m0, s38, s48
  s_nop 0
  buffer_load_dwordx4 v17, s[12:15], s37 offen offset:0  lds
  buffer_load_dwordx4 v18, s[12:15], s37 offen offset:1024  lds
  s_add_u32 s38, s38, 43008
  s_cmp_eq_u32 s38, 129024
  s_cselect_b32 s38, 0, s38
  s_waitcnt vmcnt(10)
  s_barrier
  s_add_u32 s30, s30, 1
  s_and_b32 s30, s30, 7
  s_cselect_b32 s32, 0, 1
  s_add_u32 s31, s31, s32
  s_sub_u32 s32, s30, s7
  s_and_b32 s32, s32, 7
  s_cmp_lt_u32 s32, 2
  s_cselect_b32 s32, 1, 0
  s_add_u32 s32, s32, s31
  s_cmp_ge_u32 s32, 2
  s_cselect_b32 s32, 0, s32
  s_lshl_b32 s33, s32, 3
  s_add_u32 s33, s33, s30
  s_mul_i32 s36, s33, 128
  s_add_u32 s36, s36, s34
  s_mul_i32 s37, s33, 393216
  s_add_u32 s37, s37, s35
  s_add_u32 m0, s38, s44
  s_nop 0
  buffer_load_dwordx4 v8, s[8:11], s36 offen offset:0 sc1 lds
  buffer_load_dwordx4 v9, s[8:11], s36 offen offset:1024 sc1 lds
  buffer_load_dwordx4 v10, s[8:11], s36 offen offset:2048 sc1 lds
  buffer_load_dwordx4 v11, s[8:11], s36 offen offset:3072 sc1 lds
  s_add_u32 m0, s38, s46
  s_nop 0
  buffer_load_dwordx4 v13, s[12:15], s37 offen offset:0  lds
  buffer_load_dwordx4 v14, s[12:15], s37 offen offset:1024  lds
  s_add_u32 m0, s38, s47
  s_nop 0
  buffer_load_dwordx4 v15, s[12:15], s37 offen offset:0  lds
  buffer_load_dwordx4 v16, s[12:15], s37 offen offset:1024  lds
  s_add_u32 m0, s38, s48
  s_nop 0
  buffer_load_dwordx4 v17, s[12:15], s37 offen offset:0  lds
  buffer_load_dwordx4 v18, s[12:15], s37 offen offset:1024  lds
  s_add_u32 s38, s38, 43008
  s_cmp_eq_u32 s38, 129024
  s_cselect_b32 s38, 0, s38
  s_cmp_lg_u32 s3, 0
  s_cbranch_scc1 e10
  s_cmp_lg_u32 s57, 0
  s_cbranch_scc1 g11
  s_mov_b64 exec, 1
  global_atomic_add v73, v74, s[62:63] sc1
  s_mov_b64 exec, -1
g11:
e10:
  s_nop 1
  s_mov_b32 s39, 9
ll12:
  s_waitcnt vmcnt(10)
  s_barrier
  s_add_u32 s30, s30, 1
  s_and_b32 s30, s30, 7
  s_cselect_b32 s32, 0, 1
  s_add_u32 s31, s31, s32
  s_sub_u32 s32, s30, s7
  s_and_b32 s32, s32, 7
  s_cmp_lt_u32 s32, 2
  s_cselect_b32 s32, 1, 0
  s_add_u32 s32, s32, s31
  s_cmp_ge_u32 s32, 2
  s_cselect_b32 s32, 0, s32
  s_lshl_b32 s33, s32, 3
  s_add_u32 s33, s33, s30
  s_mul_i32 s36, s33, 128
  s_add_u32 s36, s36, s34
  s_mul_i32 s37, s33, 393216
  s_add_u32 s37, s37, s35
  s_add_u32 m0, s38, s44
  s_nop 0
  buffer_load_dwordx4 v8, s[8:11], s36 offen offset:0 sc1 lds
  buffer_load_dwordx4 v9, s[8:11], s36 offen offset:1024 sc1 lds
  buffer_load_dwordx4 v10, s[8:11], s36 offen offset:2048 sc1 lds
  buffer_load_dwordx4 v11, s[8:11], s36 offen offset:3072 sc1 lds
  s_add_u32 m0, s38, s46
  s_nop 0
  buffer_load_dwordx4 v13, s[12:15], s37 offen offset:0  lds
  buffer_load_dwordx4 v14, s[12:15], s37 offen offset:1024  lds
  s_add_u32 m0, s38, s47
  s_nop 0
  buffer_load_dwordx4 v15, s[12:15], s37 offen offset:0  lds
  buffer_load_dwordx4 v16, s[12:15], s37 offen offset:1024  lds
  s_add_u32 m0, s38, s48
  s_nop 0
  buffer_load_dwordx4 v17, s[12:15], s37 offen offset:0  lds
  buffer_load_dwordx4 v18, s[12:15], s37 offen offset:1024  lds
  s_add_u32 s38, s38, 43008
  s_cmp_eq_u32 s38, 129024
  s_cselect_b32 s38, 0, s38
  s_sub_u32 s39, s39, 1
  s_cmp_lg_u32 s39, 0
  s_cbranch_scc1 ll12
  s_waitcnt vmcnt(10)
  s_barrier
  s_add_u32 s30, s30, 1
  s_and_b32 s30, s30, 7
  s_cselect_b32 s32, 0, 1
  s_add_u32 s31, s31, s32
  s_sub_u32 s32, s30, s7
  s_and_b32 s32, s32, 7
  s_cmp_lt_u32 s32, 2
  s_cselect_b32 s32, 1, 0
  s_add_u32 s32, s32, s31
  s_cmp_ge_u32 s32, 2
  s_cselect_b32 s32, 0, s32
  s_lshl_b32 s33, s32, 3
  s_add_u32 s33, s33, s30
  s_mul_i32 s36, s33, 128
  s_add_u32 s36, s36, s34
  s_mul_i32 s37, s33, 393216
  s_add_u32 s37, s37, s35
  s_add_u32 m0, s38, s44
  s_nop 0
  buffer_load_dwordx4 v8, s[8:11], s36 offen offset:0 sc1 lds
  buffer_load_dwordx4 v9, s[8:11], s36 offen offset:1024 sc1 lds
  buffer_load_dwordx4 v10, s[8:11], s36 offen offset:2048 sc1 lds
  buffer_load_dwordx4 v11, s[8:11], s36 offen offset:3072 sc1 lds
  s_add_u32 m0, s38, s46
  s_nop 0
  buffer_load_dwordx4 v13, s[12:15], s37 offen offset:0  lds
  buffer_load_dwordx4 v14, s[12:15], s37 offen offset:1024  lds
  s_add_u32 m0, s38, s47
  s_nop 0
  buffer_load_dwordx4 v15, s[12:15], s37 offen offset:0  lds
  buffer_load_dwordx4 v16, s[12:15], s37 offen offset:1024  lds
  s_add_u32 m0, s38, s48
  s_nop 0
  buffer_load_dwordx4 v17, s[12:15], s37 offen offset:0  lds
  buffer_load_dwordx4 v18, s[12:15], s37 offen offset:1024  lds
  s_add_u32 s38, s38, 43008
  s_cmp_eq_u32 s38, 129024
  s_cselect_b32 s38, 0, s38
  global_load_dword v29, v134, s[62:63] sc0 sc1
  s_waitcnt vmcnt(10)
  s_barrier
  s_add_u32 s30, s30, 1
  s_and_b32 s30, s30, 7
  s_cselect_b32 s32, 0, 1
  s_add_u32 s31, s31, s32
  s_sub_u32 s32, s30, s7
  s_and_b32 s32, s32, 7
  s_cmp_lt_u32 s32, 2
  s_cselect_b32 s32, 1, 0
  s_add_u32 s32, s32, s31
  s_cmp_ge_u32 s32, 2
  s_cselect_b32 s32, 0, s32
  s_lshl_b32 s33, s32, 3
  s_add_u32 s33, s33, s30
  s_mul_i32 s36, s33, 128
  s_add_u32 s36, s36, s34
  s_mul_i32 s37, s33, 393216
  s_add_u32 s37, s37, s35
  s_add_u32 m0, s38, s44
  s_nop 0
  buffer_load_dwordx4 v8, s[8:11], s36 offen offset:0 sc1 lds
  buffer_load_dwordx4 v9, s[8:11], s36 offen offset:1024 sc1 lds
  buffer_load_dwordx4 v10, s[8:11], s36 offen offset:2048 sc1 lds
  buffer_load_dwordx4 v11, s[8:11], s36 offen offset:3072 sc1 lds
  s_add_u32 m0, s38, s46
  s_nop 0
  buffer_load_dwordx4 v13, s[12:15], s37 offen offset:0  lds
  buffer_load_dwordx4 v14, s[12:15], s37 offen offset:1024  lds
  s_add_u32 m0, s38, s47
  s_nop 0
  buffer_load_dwordx4 v15, s[12:15], s37 offen offset:0  lds
  buffer_load_dwordx4 v16, s[12:15], s37 offen offset:1024  lds
  s_add_u32 m0, s38, s48
  s_nop 0
  buffer_load_dwordx4 v17, s[12:15], s37 offen offset:0  lds
  buffer_load_dwordx4 v18, s[12:15], s37 offen offset:1024  lds
  s_add_u32 s38, s38, 43008
  s_cmp_eq_u32 s38, 129024
  s_cselect_b32 s38, 0, s38
  s_cmp_lg_u32 s3, 0
  s_cbranch_scc1 st13g
  s_waitcnt vmcnt(10)
  s_mov_b32 s61, 0
st13p:
  v_cmp_gt_u32 vcc, 64, v29
  s_add_u32 s61, s61, 1
  s_cmp_gt_u32 s61, 1000000
  s_cbranch_scc1 st13g
  s_cbranch_vccz st13g
  global_load_dword v29, v134, s[62:63] sc0 sc1
  s_waitcnt vmcnt(0)
  s_branch st13p
st13g:
  buffer_load_dwordx2 v[30:31], v27, s[20:23], 0 offen sc1
  s_mov_b32 s32, 16384
  buffer_load_dwordx2 v[32:33], v27, s[20:23], s32 offen sc1
  s_mov_b32 s32, 32768
  buffer_load_dwordx2 v[34:35], v27, s[20:23], s32 offen sc1
  s_mov_b32 s32, 49152
  buffer_load_dwordx2 v[36:37], v27, s[20:23], s32 offen sc1
  s_mov_b32 s32, 65536
  buffer_load_dwordx2 v[38:39], v27, s[20:23], s32 offen sc1
  s_mov_b32 s32, 81920
  buffer_load_dwordx2 v[40:41], v27, s[20:23], s32 offen sc1
  s_mov_b32 s32, 98304
  buffer_load_dwordx2 v[42:43], v27, s[20:23], s32 offen sc1
  s_mov_b32 s32, 114688
  buffer_load_dwordx2 v[44:45], v27, s[20:23], s32 offen sc1
  s_waitcnt vmcnt(18)
  s_barrier
  s_branch L_k1t
L_first:
  s_nop 7
  s_nop 7
  s_cmp_ge_u32 s57, 2
  s_cbranch_scc1 L_firstB
  s_add_u32 s30, s30, 1
  s_and_b32 s30, s30, 7
  s_cselect_b32 s32, 0, 1
  s_add_u32 s31, s31, s32
  s_sub_u32 s32, s30, s7
  s_and_b32 s32, s32, 7
  s_cmp_lt_u32 s32, 2
  s_cselect_b32 s32, 1, 0
  s_add_u32 s32, s32, s31
  s_cmp_ge_u32 s32, 2
  s_cselect_b32 s32, 0, s32
  s_lshl_b32 s33, s32, 3
  s_add_u32 s33, s33, s30
  s_mul_i32 s36, s33, 128
  s_add_u32 s36, s36, s34
  s_mul_i32 s37, s33, 393216
  s_add_u32 s37, s37, s35
  s_add_u32 m0, s38, s45
  s_mov_b64 exec, s[52:53]
  buffer_load_dwordx4 v12, s[8:11], s36 offen offset:0 sc1 lds
  s_mov_b64 exec, -1
  s_add_u32 m0, s38, s44
  s_nop 0
  buffer_load_dwordx4 v8, s[8:11], s36 offen offset:0 sc1 lds
  buffer_load_dwordx4 v9, s[8:11], s36 offen offset:1024 sc1 lds
  buffer_load_dwordx4 v10, s[8:11], s36 offen offset:2048 sc1 lds
  buffer_load_dwordx4 v11, s[8:11], s36 offen offset:3072 sc1 lds
  s_add_u32 m0, s38, s46
  s_nop 0
  buffer_load_dwordx4 v13, s[12:15], s37 offen offset:0  lds
  buffer_load_dwordx4 v14, s[12:15], s37 offen offset:1024  lds
  s_add_u32 m0, s38, s47
  s_nop 0
  buffer_load_dwordx4 v15, s[12:15], s37 offen offset:0  lds
  buffer_load_dwordx4 v16, s[12:15], s37 offen offset:1024  lds
  s_add_u32 m0, s38, s48
  s_nop 0
  buffer_load_dwordx4 v17, s[12:15], s37 offen offset:0  lds
  buffer_load_dwordx4 v18, s[12:15], s37 offen offset:1024  lds
  s_add_u32 s38, s38, 43008
  s_cmp_eq_u32 s38, 129024
  s_cselect_b32 s38, 0, s38
  s_mov_b32 s16, s84
  s_mov_b32 s17, s85
  s_mov_b32 s18, 67108864
  s_mov_b32 s19, 0x20000
  s_add_u32 s20, s84, 22020096
  s_addc_u32 s21, s85, 0
  s_mov_b32 s22, 16384
  s_mov_b32 s23, 0x20000
  s_mov_b32 s82, s84
  s_mov_b32 s83, s85
  s_add_u32 s30, s30, 1
  s_and_b32 s30, s30, 7
  s_cselect_b32 s32, 0, 1
  s_add_u32 s31, s31, s32
  s_sub_u32 s32, s30, s7
  s_and_b32 s32, s32, 7
  s_cmp_lt_u32 s32, 2
  s_cselect_b32 s32, 1, 0
  s_add_u32 s32, s32, s31
  s_cmp_ge_u32 s32, 2
  s_cselect_b32 s32, 0, s32
  s_lshl_b32 s33, s32, 3
  s_add_u32 s33, s33, s30
  s_mul_i32 s36, s33, 128
  s_add_u32 s36, s36, s34
  s_mul_i32 s37, s33, 393216
  s_add_u32 s37, s37, s35
  s_add_u32 m0, s38, s45
  s_mov_b64 exec, s[52:53]
  buffer_load_dwordx4 v12, s[8:11], s36 offen offset:0 sc1 lds
  s_mov_b64 exec, -1
  s_add_u32 m0, s38, s44
  s_nop 0
  buffer_load_dwordx4 v8, s[8:11], s36 offen offset:0 sc1 lds
  buffer_load_dwordx4 v9, s[8:11], s36 offen offset:1024 sc1 lds
  buffer_load_dwordx4 v10, s[8:11], s36 offen offset:2048 sc1 lds
  buffer_load_dwordx4 v11, s[8:11], s36 offen offset:3072 sc1 lds
  s_add_u32 m0, s38, s46
  s_nop 0
  buffer_load_dwordx4 v13, s[12:15], s37 offen offset:0  lds
  buffer_load_dwordx4 v14, s[12:15], s37 offen offset:1024  lds
  s_add_u32 m0, s38, s47
  s_nop 0
  buffer_load_dwordx4 v15, s[12:15], s37 offen offset:0  lds
  buffer_load_dwordx4 v16, s[12:15], s37 offen offset:1024  lds
  s_add_u32 m0, s38, s48
  s_nop 0
  buffer_load_dwordx4 v17, s[12:15], s37 offen offset:0  lds
  buffer_load_dwordx4 v18, s[12:15], s37 offen offset:1024  lds
  s_add_u32 s38, s38, 43008
  s_cmp_eq_u32 s38, 129024
  s_cselect_b32 s38, 0, s38
  buffer_load_dwordx4 v[48:51], v46, s[8:11], 0 offen offset:0
  buffer_load_dwordx4 v[52:55], v46, s[8:11], 0 offen offset:512
  buffer_load_dwordx4 v[56:59], v46, s[8:11], 0 offen offset:1024
  buffer_load_dwordx4 v[60:63], v46, s[8:11], 0 offen offset:1536
  buffer_store_dwordx4 v[64:67], v47, s[16:19], s58 offen sc0 sc1
  s_barrier
  s_waitcnt vmcnt(16)
  s_barrier
  s_add_u32 s30, s30, 1
  s_and_b32 s30, s30, 7
  s_cselect_b32 s32, 0, 1
  s_add_u32 s31, s31, s32
  s_sub_u32 s32, s30, s7
  s_and_b32 s32, s32, 7
  s_cmp_lt_u32 s32, 2
  s_cselect_b32 s32, 1, 0
  s_add_u32 s32, s32, s31
  s_cmp_ge_u32 s32, 2
  s_cselect_b32 s32, 0, s32
  s_lshl_b32 s33, s32, 3
  s_add_u32 s33, s33, s30
  s_mul_i32 s36, s33, 128
  s_add_u32 s36, s36, s34
  s_mul_i32 s37, s33, 393216
  s_add_u32 s37, s37, s35
  s_add_u32 m0, s38, s45
  s_mov_b64 exec, s[52:53]
  buffer_load_dwordx4 v12, s[8:11], s36 offen offset:0 sc1 lds
  s_mov_b64 exec, -1
  s_add_u32 m0, s38, s44
  s_nop 0
  buffer_load_dwordx4 v8, s[8:11], s36 offen offset:0 sc1 lds
  buffer_load_dwordx4 v9, s[8:11], s36 offen offset:1024 sc1 lds
  buffer_load_dwordx4 v10, s[8:11], s36 offen offset:2048 sc1 lds
  buffer_load_dwordx4 v11, s[8:11], s36 offen offset:3072 sc1 lds
  s_add_u32 m0, s38, s46
  s_nop 0
  buffer_load_dwordx4 v13, s[12:15], s37 offen offset:0  lds
  buffer_load_dwordx4 v14, s[12:15], s37 offen offset:1024  lds
  s_add_u32 m0, s38, s47
  s_nop 0
  buffer_load_dwordx4 v15, s[12:15], s37 offen offset:0  lds
  buffer_load_dwordx4 v16, s[12:15], s37 offen offset:1024  lds
  s_add_u32 m0, s38, s48
  s_nop 0
  buffer_load_dwordx4 v17, s[12:15], s37 offen offset:0  lds
  buffer_load_dwordx4 v18, s[12:15], s37 offen offset:1024  lds
  s_add_u32 s38, s38, 43008
  s_cmp_eq_u32 s38, 129024
  s_cselect_b32 s38, 0, s38
  v_mov_b32 v68, 0
  v_mov_b32 v69, 0
  v_mov_b32 v70, 0x3f803f80
  s_waitcnt vmcnt(12)
  v_dot2c_f32_bf16 v68, v70, v48
  v_dot2c_f32_bf16 v69, v48, v48
  v_dot2c_f32_bf16 v68, v70, v49
  v_dot2c_f32_bf16 v69, v49, v49
  v_dot2c_f32_bf16 v68, v70, v50
  v_dot2c_f32_bf16 v69, v50, v50
  v_dot2c_f32_bf16 v68, v70, v51
  v_dot2c_f32_bf16 v69, v51, v51
  v_dot2c_f32_bf16 v68, v70, v52
  v_dot2c_f32_bf16 v69, v52, v52
  v_dot2c_f32_bf16 v68, v70, v53
  v_dot2c_f32_bf16 v69, v53, v53
  v_dot2c_f32_bf16 v68, v70, v54
  v_dot2c_f32_bf16 v69, v54, v54
  v_dot2c_f32_bf16 v68, v70, v55
  v_dot2c_f32_bf16 v69, v55, v55
  v_dot2c_f32_bf16 v68, v70, v56
  v_dot2c_f32_bf16 v69, v56, v56
  v_dot2c_f32_bf16 v68, v70, v57
  v_dot2c_f32_bf16 v69, v57, v57
  v_dot2c_f32_bf16 v68, v70, v58
  v_dot2c_f32_bf16 v69, v58, v58
  v_dot2c_f32_bf16 v68, v70, v59
  v_dot2c_f32_bf16 v69, v59, v59
  v_dot2c_f32_bf16 v68, v70, v60
  v_dot2c_f32_bf16 v69, v60, v60
  v_dot2c_f32_bf16 v68, v70, v61
  v_dot2c_f32_bf16 v69, v61, v61
  v_dot2c_f32_bf16 v68, v70, v62
  v_dot2c_f32_bf16 v69, v62, v62
  v_dot2c_f32_bf16 v68, v70, v63
  v_dot2c_f32_bf16 v69, v63, v63
  s_nop 1
  v_add_f32_dpp v68, v68, v68 quad_perm:[1,0,3,2] row_mask:0xf bank_mask:0xf
  v_add_f32_dpp v69, v69, v69 quad_perm:[1,0,3,2] row_mask:0xf bank_mask:0xf
  s_nop 0
  v_add_f32_dpp v68, v68, v68 quad_perm:[2,3,0,1] row_mask:0xf bank_mask:0xf
  v_add_f32_dpp v69, v69, v69 quad_perm:[2,3,0,1] row_mask:0xf bank_mask:0xf
  s_nop 0
  v_add_f32_dpp v68, v68, v68 row_half_mirror row_mask:0xf bank_mask:0xf
  v_add_f32_dpp v69, v69, v69 row_half_mirror row_mask:0xf bank_mask:0xf
  s_nop 0
  v_add_f32_dpp v68, v68, v68 row_mirror row_mask:0xf bank_mask:0xf
  v_add_f32_dpp v69, v69, v69 row_mirror row_mask:0xf bank_mask:0xf
  v_mov_b32 v70, v68
  v_mov_b32 v71, v69
  s_nop 0
  v_permlane16_swap_b32 v68, v70
  v_permlane16_swap_b32 v69, v71
  v_add_f32 v68, v68, v70
  v_add_f32 v69, v69, v71
  s_mov_b32 exec_lo, 1
  s_mov_b32 exec_hi, 1
  buffer_store_dwordx2 v[68:69], v72, s[16:19], 0 offen sc0 sc1
  s_mov_b64 exec, -1
  s_branch L_jA
L_firstB:
  s_nop 7
  s_nop 7
  s_add_u32 s30, s30, 1
  s_and_b32 s30, s30, 7
  s_cselect_b32 s32, 0, 1
  s_add_u32 s31, s31, s32
  s_sub_u32 s32, s30, s7
  s_and_b32 s32, s32, 7
  s_cmp_lt_u32 s32, 2
  s_cselect_b32 s32, 1, 0
  s_add_u32 s32, s32, s31
  s_cmp_ge_u32 s32, 2
  s_cselect_b32 s32, 0, s32
  s_lshl_b32 s33, s32, 3
  s_add_u32 s33, s33, s30
  s_mul_i32 s36, s33, 128
  s_add_u32 s36, s36, s34
  s_mul_i32 s37, s33, 393216
  s_add_u32 s37, s37, s35
  s_add_u32 m0, s38, s44
  s_nop 0
  buffer_load_dwordx4 v8, s[8:11], s36 offen offset:0 sc1 lds
  buffer_load_dwordx4 v9, s[8:11], s36 offen offset:1024 sc1 lds
  buffer_load_dwordx4 v10, s[8:11], s36 offen offset:2048 sc1 lds
  buffer_load_dwordx4 v11, s[8:11], s36 offen offset:3072 sc1 lds
  s_add_u32 m0, s38, s46
  s_nop 0
  buffer_load_dwordx4 v13, s[12:15], s37 offen offset:0  lds
  buffer_load_dwordx4 v14, s[12:15], s37 offen offset:1024  lds
  s_add_u32 m0, s38, s47
  s_nop 0
  buffer_load_dwordx4 v15, s[12:15], s37 offen offset:0  lds
  buffer_load_dwordx4 v16, s[12:15], s37 offen offset:1024  lds
  s_add_u32 m0, s38, s48
  s_nop 0
  buffer_load_dwordx4 v17, s[12:15], s37 offen offset:0  lds
  buffer_load_dwordx4 v18, s[12:15], s37 offen offset:1024  lds
  s_add_u32 s38, s38, 43008
  s_cmp_eq_u32 s38, 129024
  s_cselect_b32 s38, 0, s38
  s_mov_b32 s16, s84
  s_mov_b32 s17, s85
  s_mov_b32 s18, 67108864
  s_mov_b32 s19, 0x20000
  s_add_u32 s20, s84, 22020096
  s_addc_u32 s21, s85, 0
  s_mov_b32 s22, 16384
  s_mov_b32 s23, 0x20000
  s_mov_b32 s82, s84
  s_mov_b32 s83, s85
  s_add_u32 s30, s30, 1
  s_and_b32 s30, s30, 7
  s_cselect_b32 s32, 0, 1
  s_add_u32 s31, s31, s32
  s_sub_u32 s32, s30, s7
  s_and_b32 s32, s32, 7
  s_cmp_lt_u32 s32, 2
  s_cselect_b32 s32, 1, 0
  s_add_u32 s32, s32, s31
  s_cmp_ge_u32 s32, 2
  s_cselect_b32 s32, 0, s32
  s_lshl_b32 s33, s32, 3
  s_add_u32 s33, s33, s30
  s_mul_i32 s36, s33, 128
  s_add_u32 s36, s36, s34
  s_mul_i32 s37, s33, 393216
  s_add_u32 s37, s37, s35
  s_add_u32 m0, s38, s44
  s_nop 0
  buffer_load_dwordx4 v8, s[8:11], s36 offen offset:0 sc1 lds
  buffer_load_dwordx4 v9, s[8:11], s36 offen offset:1024 sc1 lds
  buffer_load_dwordx4 v10, s[8:11], s36 offen offset:2048 sc1 lds
  buffer_load_dwordx4 v11, s[8:11], s36 offen offset:3072 sc1 lds
  s_add_u32 m0, s38, s46
  s_nop 0
  buffer_load_dwordx4 v13, s[12:15], s37 offen offset:0  lds
  buffer_load_dwordx4 v14, s[12:15], s37 offen offset:1024  lds
  s_add_u32 m0, s38, s47
  s_nop 0
  buffer_load_dwordx4 v15, s[12:15], s37 offen offset:0  lds
  buffer_load_dwordx4 v16, s[12:15], s37 offen offset:1024  lds
  s_add_u32 m0, s38, s48
  s_nop 0
  buffer_load_dwordx4 v17, s[12:15], s37 offen offset:0  lds
  buffer_load_dwordx4 v18, s[12:15], s37 offen offset:1024  lds
  s_add_u32 s38, s38, 43008
  s_cmp_eq_u32 s38, 129024
  s_cselect_b32 s38, 0, s38
  buffer_load_dwordx4 v[48:51], v46, s[8:11], 0 offen offset:0
  buffer_load_dwordx4 v[52:55], v46, s[8:11], 0 offen offset:512
  buffer_load_dwordx4 v[56:59], v46, s[8:11], 0 offen offset:1024
  buffer_load_dwordx4 v[60:63], v46, s[8:11], 0 offen offset:1536
  buffer_store_dwordx4 v[64:67], v47, s[16:19], s58 offen sc0 sc1
  s_barrier
  s_waitcnt vmcnt(15)
  s_barrier
  s_add_u32 s30, s30, 1
  s_and_b32 s30, s30, 7
  s_cselect_b32 s32, 0, 1
  s_add_u32 s31, s31, s32
  s_sub_u32 s32, s30, s7
  s_and_b32 s32, s32, 7
  s_cmp_lt_u32 s32, 2
  s_cselect_b32 s32, 1, 0
  s_add_u32 s32, s32, s31
  s_cmp_ge_u32 s32, 2
  s_cselect_b32 s32, 0, s32
  s_lshl_b32 s33, s32, 3
  s_add_u32 s33, s33, s30
  s_mul_i32 s36, s33, 128
  s_add_u32 s36, s36, s34
  s_mul_i32 s37, s33, 393216
  s_add_u32 s37, s37, s35
  s_add_u32 m0, s38, s44
  s_nop 0
  buffer_load_dwordx4 v8, s[8:11], s36 offen offset:0 sc1 lds
  buffer_load_dwordx4 v9, s[8:11], s36 offen offset:1024 sc1 lds
  buffer_load_dwordx4 v10, s[8:11], s36 offen offset:2048 sc1 lds
  buffer_load_dwordx4 v11, s[8:11], s36 offen offset:3072 sc1 lds
  s_add_u32 m0, s38, s46
  s_nop 0
  buffer_load_dwordx4 v13, s[12:15], s37 offen offset:0  lds
  buffer_load_dwordx4 v14, s[12:15], s37 offen offset:1024  lds
  s_add_u32 m0, s38, s47
  s_nop 0
  buffer_load_dwordx4 v15, s[12:15], s37 offen offset:0  lds
  buffer_load_dwordx4 v16, s[12:15], s37 offen offset:1024  lds
  s_add_u32 m0, s38, s48
  s_nop 0
  buffer_load_dwordx4 v17, s[12:15], s37 offen offset:0  lds
  buffer_load_dwordx4 v18, s[12:15], s37 offen offset:1024  lds
  s_add_u32 s38, s38, 43008
  s_cmp_eq_u32 s38, 129024
  s_cselect_b32 s38, 0, s38
  v_mov_b32 v68, 0
  v_mov_b32 v69, 0
  v_mov_b32 v70, 0x3f803f80
  s_waitcnt vmcnt(11)
  v_dot2c_f32_bf16 v68, v70, v48
  v_dot2c_f32_bf16 v69, v48, v48
  v_dot2c_f32_bf16 v68, v70, v49
  v_dot2c_f32_bf16 v69, v49, v49
  v_dot2c_f32_bf16 v68, v70, v50
  v_dot2c_f32_bf16 v69, v50, v50
  v_dot2c_f32_bf16 v68, v70, v51
  v_dot2c_f32_bf16 v69, v51, v51
  v_dot2c_f32_bf16 v68, v70, v52
  v_dot2c_f32_bf16 v69, v52, v52
  v_dot2c_f32_bf16 v68, v70, v53
  v_dot2c_f32_bf16 v69, v53, v53
  v_dot2c_f32_bf16 v68, v70, v54
  v_dot2c_f32_bf16 v69, v54, v54
  v_dot2c_f32_bf16 v68, v70, v55
  v_dot2c_f32_bf16 v69, v55, v55
  v_dot2c_f32_bf16 v68, v70, v56
  v_dot2c_f32_bf16 v69, v56, v56
  v_dot2c_f32_bf16 v68, v70, v57
  v_dot2c_f32_bf16 v69, v57, v57
  v_dot2c_f32_bf16 v68, v70, v58
  v_dot2c_f32_bf16 v69, v58, v58
  v_dot2c_f32_bf16 v68, v70, v59
  v_dot2c_f32_bf16 v69, v59, v59
  v_dot2c_f32_bf16 v68, v70, v60
  v_dot2c_f32_bf16 v69, v60, v60
  v_dot2c_f32_bf16 v68, v70, v61
  v_dot2c_f32_bf16 v69, v61, v61
  v_dot2c_f32_bf16 v68, v70, v62
  v_dot2c_f32_bf16 v69, v62, v62
  v_dot2c_f32_bf16 v68, v70, v63
  v_dot2c_f32_bf16 v69, v63, v63
  s_nop 1
  v_add_f32_dpp v68, v68, v68 quad_perm:[1,0,3,2] row_mask:0xf bank_mask:0xf
  v_add_f32_dpp v69, v69, v69 quad_perm:[1,0,3,2] row_mask:0xf bank_mask:0xf
  s_nop 0
  v_add_f32_dpp v68, v68, v68 quad_perm:[2,3,0,1] row_mask:0xf bank_mask:0xf
  v_add_f32_dpp v69, v69, v69 quad_perm:[2,3,0,1] row_mask:0xf bank_mask:0xf
  s_nop 0
  v_add_f32_dpp v68, v68, v68 row_half_mirror row_mask:0xf bank_mask:0xf
  v_add_f32_dpp v69, v69, v69 row_half_mirror row_mask:0xf bank_mask:0xf
  s_nop 0
  v_add_f32_dpp v68, v68, v68 row_mirror row_mask:0xf bank_mask:0xf
  v_add_f32_dpp v69, v69, v69 row_mirror row_mask:0xf bank_mask:0xf
  v_mov_b32 v70, v68
  v_mov_b32 v71, v69
  s_nop 0
  v_permlane16_swap_b32 v68, v70
  v_permlane16_swap_b32 v69, v71
  v_add_f32 v68, v68, v70
  v_add_f32 v69, v69, v71
  s_mov_b32 exec_lo, 1
  s_mov_b32 exec_hi, 1
  buffer_store_dwordx2 v[68:69], v72, s[16:19], 0 offen sc0 sc1
  s_mov_b64 exec, -1
  s_branch L_jB
L_k1t:
  s_nop 7
  s_nop 7
  s_waitcnt vmcnt(0)
  v_pk_add_f32 v[30:31], v[30:31], v[32:33]
  v_pk_add_f32 v[34:35], v[34:35], v[36:37]
  v_pk_add_f32 v[38:39], v[38:39], v[40:41]
  v_pk_add_f32 v[42:43], v[42:43], v[44:45]
  v_pk_add_f32 v[30:31], v[30:31], v[34:35]
  v_pk_add_f32 v[38:39], v[38:39], v[42:43]
  v_pk_add_f32 v[30:31], v[30:31], v[38:39]
  v_mul_f32 v30, 0x3a800000, v30
  v_mul_f32 v31, 0x3a800000, v31
  v_fma_f32 v31, -v30, v30, v31
  v_max_f32 v31, 0, v31
  v_mov_b32 v32, v31
  v_cvt_pk_bf16_f32 v32, v32, v32
  v_lshlrev_b32 v32, 16, v32
  v_add_f32 v32, 0x3727c5ac, v32
  v_cvt_pk_bf16_f32 v32, v32, v32
  v_lshlrev_b32 v32, 16, v32
  v_sqrt_f32 v32, v32
  s_nop 0
  v_cvt_pk_bf16_f32 v32, v32, v32
  v_lshlrev_b32 v32, 16, v32
  v_rcp_f32 v32, v32
  v_cvt_pk_bf16_f32 v30, v30, v30
  v_lshlrev_b32 v30, 16, v30
  v_mov_b32 v31, v32
  ds_write_b64 v26, v[30:31]
  s_waitcnt lgkmcnt(0)
  s_mov_b32 s41, s57
  s_mul_i32 s32, s41, 16
  s_add_u32 s32, s32, 0
  v_lshrrev_b32 v2, 3, v0
  v_add_u32 v2, s32, v2
  v_bfe_u32 v3, v2, 1, 1
  v_bfe_u32 v4, v2, 3, 1
  v_lshl_or_b32 v3, v4, 1, v3
  v_lshlrev_b32 v3, 1, v3
  v_and_b32 v4, 7, v0
  v_xor_b32 v3, v3, v4
  v_lshlrev_b32 v3, 4, v3
  s_mov_b32 s32, 2048
  v_mul_lo_u32 v2, v2, s32
  v_add_u32 v130, v2, v3
  s_mul_i32 s32, s41, 16
  s_add_u32 s32, s32, 8
  v_lshrrev_b32 v2, 3, v0
  v_add_u32 v2, s32, v2
  v_bfe_u32 v3, v2, 1, 1
  v_bfe_u32 v4, v2, 3, 1
  v_lshl_or_b32 v3, v4, 1, v3
  v_lshlrev_b32 v3, 1, v3
  v_and_b32 v4, 7, v0
  v_xor_b32 v3, v3, v4
  v_lshlrev_b32 v3, 4, v3
  s_mov_b32 s32, 2048
  v_mul_lo_u32 v2, v2, s32
  v_add_u32 v131, v2, v3
  v_subrev_u32 v131, 1024, v131
  s_mov_b32 s12, s68
  s_mov_b32 s13, s69
  s_mov_b32 s14, 2097152
  s_mov_b32 s15, 0x20000
  s_mov_b32 s30, 7
  s_mov_b32 s31, -1
  s_lshl_b32 s52, s57, 11
  s_add_u32 s30, s30, 1
  s_and_b32 s30, s30, 7
  s_cselect_b32 s32, 0, 1
  s_add_u32 s31, s31, s32
  s_sub_u32 s32, s30, s7
  s_and_b32 s32, s32, 7
  s_cmp_lt_u32 s32, 2
  s_cselect_b32 s32, 1, 0
  s_add_u32 s32, s32, s31
  s_cmp_ge_u32 s32, 2
  s_cselect_b32 s32, 0, s32
  s_lshl_b32 s33, s32, 3
  s_add_u32 s33, s33, s30
  s_lshl_b32 s37, s33, 17
  s_add_u32 s37, s37, s35
  s_add_u32 m0, s52, 131072
  s_nop 0
  buffer_load_dwordx4 v130, s[12:15], s37 offen lds
  buffer_load_dwordx4 v131, s[12:15], s37 offen offset:1024 lds
  s_add_u32 s30, s30, 1
  s_and_b32 s30, s30, 7
  s_cselect_b32 s32, 0, 1
  s_add_u32 s31, s31, s32
  s_sub_u32 s32, s30, s7
  s_and_b32 s32, s32, 7
  s_cmp_lt_u32 s32, 2
  s_cselect_b32 s32, 1, 0
  s_add_u32 s32, s32, s31
  s_cmp_ge_u32 s32, 2
  s_cselect_b32 s32, 0, s32
  s_lshl_b32 s33, s32, 3
  s_add_u32 s33, s33, s30
  s_lshl_b32 s37, s33, 17
  s_add_u32 s37, s37, s35
  s_add_u32 m0, s52, 139264
  s_nop 0
  buffer_load_dwordx4 v130, s[12:15], s37 offen lds
  buffer_load_dwordx4 v131, s[12:15], s37 offen offset:1024 lds
  s_add_u32 s30, s30, 1
  s_and_b32 s30, s30, 7
  s_cselect_b32 s32, 0, 1
  s_add_u32 s31, s31, s32
  s_sub_u32 s32, s30, s7
  s_and_b32 s32, s32, 7
  s_cmp_lt_u32 s32, 2
  s_cselect_b32 s32, 1, 0
  s_add_u32 s32, s32, s31
  s_cmp_ge_u32 s32, 2
  s_cselect_b32 s32, 0, s32
  s_lshl_b32 s33, s32, 3
  s_add_u32 s33, s33, s30
  s_lshl_b32 s37, s33, 17
  s_add_u32 s37, s37, s35
  s_add_u32 m0, s52, 147456
  s_nop 0
  buffer_load_dwordx4 v130, s[12:15], s37 offen lds
  buffer_load_dwordx4 v131, s[12:15], s37 offen offset:1024 lds
  s_add_u32 s30, s30, 1
  s_and_b32 s30, s30, 7
  s_cselect_b32 s32, 0, 1
  s_add_u32 s31, s31, s32
  s_sub_u32 s32, s30, s7
  s_and_b32 s32, s32, 7
  s_cmp_lt_u32 s32, 2
  s_cselect_b32 s32, 1, 0
  s_add_u32 s32, s32, s31
  s_cmp_ge_u32 s32, 2
  s_cselect_b32 s32, 0, s32
  s_lshl_b32 s33, s32, 3
  s_add_u32 s33, s33, s30
  s_lshl_b32 s37, s33, 17
  s_add_u32 s37, s37, s35
  s_add_u32 m0, s52, 155648
  s_nop 0
  buffer_load_dwordx4 v130, s[12:15], s37 offen lds
  buffer_load_dwordx4 v131, s[12:15], s37 offen offset:1024 lds
  s_waitcnt vmcnt(8)
  s_barrier
  s_add_u32 s30, s30, 1
  s_and_b32 s30, s30, 7
  s_cselect_b32 s32, 0, 1
  s_add_u32 s31, s31, s32
  s_sub_u32 s32, s30, s7
  s_and_b32 s32, s32, 7
  s_cmp_lt_u32 s32, 2
  s_cselect_b32 s32, 1, 0
  s_add_u32 s32, s32, s31
  s_cmp_ge_u32 s32, 2
  s_cselect_b32 s32, 0, s32
  s_lshl_b32 s33, s32, 3
  s_add_u32 s33, s33, s30
  s_lshl_b32 s37, s33, 17
  s_add_u32 s37, s37, s35
  s_add_u32 m0, s52, 100608
  s_nop 0
  buffer_load_dwordx4 v130, s[12:15], s37 offen lds
  buffer_load_dwordx4 v131, s[12:15], s37 offen offset:1024 lds
  s_add_u32 s30, s30, 1
  s_and_b32 s30, s30, 7
  s_cselect_b32 s32, 0, 1
  s_add_u32 s31, s31, s32
  s_sub_u32 s32, s30, s7
  s_and_b32 s32, s32, 7
  s_cmp_lt_u32 s32, 2
  s_cselect_b32 s32, 1, 0
  s_add_u32 s32, s32, s31
  s_cmp_ge_u32 s32, 2
  s_cselect_b32 s32, 0, s32
  s_lshl_b32 s33, s32, 3
  s_add_u32 s33, s33, s30
  s_lshl_b32 s37, s33, 17
  s_add_u32 s37, s37, s35
  s_add_u32 m0, s52, 108800
  s_nop 0
  buffer_load_dwordx4 v130, s[12:15], s37 offen lds
  buffer_load_dwordx4 v131, s[12:15], s37 offen offset:1024 lds
  s_add_u32 s30, s30, 1
  s_and_b32 s30, s30, 7
  s_cselect_b32 s32, 0, 1
  s_add_u32 s31, s31, s32
  s_sub_u32 s32, s30, s7
  s_and_b32 s32, s32, 7
  s_cmp_lt_u32 s32, 2
  s_cselect_b32 s32, 1, 0
  s_add_u32 s32, s32, s31
  s_cmp_ge_u32 s32, 2
  s_cselect_b32 s32, 0, s32
  s_lshl_b32 s33, s32, 3
  s_add_u32 s33, s33, s30
  s_lshl_b32 s37, s33, 17
  s_add_u32 s37, s37, s35
  s_add_u32 m0, s52, 116992
  s_nop 0
  buffer_load_dwordx4 v130, s[12:15], s37 offen lds
  buffer_load_dwordx4 v131, s[12:15], s37 offen offset:1024 lds
  s_cmp_lg_u32 s3, 0
  s_cbranch_scc1 e14
  v_and_b32 v4, 15, v0
  v_lshrrev_b32 v5, 4, v0
  v_lshrrev_b32 v6, 2, v4
  v_and_b32 v7, 3, v0
  v_lshrrev_b32 v3, 5, v0
  v_and_b32 v2, 1, v5
  v_lshl_or_b32 v3, v2, 1, v3
  s_lshr_b32 s40, s4, 1
  s_and_b32 s41, s4, 1
  s_mul_i32 s32, s41, 28800
  s_add_u32 s32, s32, 43008
  s_lshl_b32 s49, s40, 4
  v_add_u32 v76, s49, v4
  v_lshlrev_b32 v77, 4, v5
  v_add_u32 v77, s32, v77
  v_mul_u32_u24 v78, 400, v76
  v_add_u32 v220, v78, v77
  v_add_u32 v223, 3200, v220
  v_add_u32 v220, 128, v220
  v_add_u32 v76, 16, v76
  v_min_u32 v76, 71, v76
  v_mul_u32_u24 v78, 400, v76
  v_add3_u32 v221, v78, v77, 64
  v_add_u32 v221, 64, v221
  v_lshl_add_u32 v76, v5, 2, v6
  v_add_u32 v76, s49, v76
  v_lshlrev_b32 v77, 4, v7
  v_add_u32 v77, s32, v77
  v_add_u32 v77, 256, v77
  v_mul_u32_u24 v78, 400, v76
  v_add_u32 v222, v78, v77
  v_add_u32 v76, 16, v76
  v_min_u32 v76, 71, v76
  v_mul_u32_u24 v78, 400, v76
  v_add_u32 v254, v78, v77
  s_lshl_b32 s50, s28, 2
  s_add_u32 s50, s50, s40
  s_lshl_b32 s50, s50, 16
  s_lshl_b32 s51, s29, 12
  s_add_u32 s50, s50, s51
  s_lshl_b32 s51, s41, 10
  s_add_u32 s50, s50, s51
  v_lshlrev_b32 v1, 4, v0
  v_add_u32 v1, s50, v1
  v_lshlrev_b32 v76, 2, v5
  v_sub_u32 v76, v76, v4
  s_or_b32 s51, s28, s40
  s_cmp_eq_u32 s51, 0
  s_cselect_b32 s51, 0, -1
  v_add_u32 v77, -1, v76
  v_cmp_gt_u32 s[86:87], 8, v77
  v_add_u32 v77, 0, v76
  v_cmp_gt_u32 s[88:89], 8, v77
  v_add_u32 v77, 1, v76
  v_cmp_gt_u32 s[90:91], 8, v77
  v_add_u32 v77, 2, v76
  v_cmp_gt_u32 s[92:93], 8, v77
  v_add_u32 v77, 15, v76
  v_cmp_gt_u32 s[94:95], 8, v77
  v_add_u32 v77, 16, v76
  v_cmp_gt_u32 s[96:97], 8, v77
  v_add_u32 v77, 17, v76
  v_cmp_gt_u32 s[98:99], 8, v77
  v_add_u32 v77, 18, v76
  v_cmp_gt_u32 s[100:101], 8, v77
  s_and_b32 s86, s86, s51
  s_and_b32 s88, s88, s51
  s_and_b32 s90, s90, s51
  s_and_b32 s92, s92, s51
e14:
  s_nop 1
  s_waitcnt lgkmcnt(0)
  s_barrier
  s_add_u32 s30, s30, 1
  s_and_b32 s30, s30, 7
  s_cselect_b32 s32, 0, 1
  s_add_u32 s31, s31, s32
  s_sub_u32 s32, s30, s7
  s_and_b32 s32, s32, 7
  s_cmp_lt_u32 s32, 2
  s_cselect_b32 s32, 1, 0
  s_add_u32 s32, s32, s31
  s_cmp_ge_u32 s32, 2
  s_cselect_b32 s32, 0, s32
  s_lshl_b32 s33, s32, 3
  s_add_u32 s33, s33, s30
  s_lshl_b32 s37, s33, 17
  s_add_u32 s37, s37, s35
  s_add_u32 m0, s52, 0
  s_nop 0
  buffer_load_dwordx4 v130, s[12:15], s37 offen lds
  buffer_load_dwordx4 v131, s[12:15], s37 offen offset:1024 lds
  s_add_u32 s30, s30, 1
  s_and_b32 s30, s30, 7
  s_cselect_b32 s32, 0, 1
  s_add_u32 s31, s31, s32
  s_sub_u32 s32, s30, s7
  s_and_b32 s32, s32, 7
  s_cmp_lt_u32 s32, 2
  s_cselect_b32 s32, 1, 0
  s_add_u32 s32, s32, s31
  s_cmp_ge_u32 s32, 2
  s_cselect_b32 s32, 0, s32
  s_lshl_b32 s33, s32, 3
  s_add_u32 s33, s33, s30
  s_lshl_b32 s37, s33, 17
  s_add_u32 s37, s37, s35
  s_add_u32 m0, s52, 8192
  s_nop 0
  buffer_load_dwordx4 v130, s[12:15], s37 offen lds
  buffer_load_dwordx4 v131, s[12:15], s37 offen offset:1024 lds
  s_add_u32 s30, s30, 1
  s_and_b32 s30, s30, 7
  s_cselect_b32 s32, 0, 1
  s_add_u32 s31, s31, s32
  s_sub_u32 s32, s30, s7
  s_and_b32 s32, s32, 7
  s_cmp_lt_u32 s32, 2
  s_cselect_b32 s32, 1, 0
  s_add_u32 s32, s32, s31
  s_cmp_ge_u32 s32, 2
  s_cselect_b32 s32, 0, s32
  s_lshl_b32 s33, s32, 3
  s_add_u32 s33, s33, s30
  s_lshl_b32 s37, s33, 17
  s_add_u32 s37, s37, s35
  s_add_u32 m0, s52, 16384
  s_nop 0
  buffer_load_dwordx4 v130, s[12:15], s37 offen lds
  buffer_load_dwordx4 v131, s[12:15], s37 offen offset:1024 lds
  s_add_u32 s30, s30, 1
  s_and_b32 s30, s30, 7
  s_cselect_b32 s32, 0, 1
  s_add_u32 s31, s31, s32
  s_sub_u32 s32, s30, s7
  s_and_b32 s32, s32, 7
  s_cmp_lt_u32 s32, 2
  s_cselect_b32 s32, 1, 0
  s_add_u32 s32, s32, s31
  s_cmp_ge_u32 s32, 2
  s_cselect_b32 s32, 0, s32
  s_lshl_b32 s33, s32, 3
  s_add_u32 s33, s33, s30
  s_lshl_b32 s37, s33, 17
  s_add_u32 s37, s37, s35
  s_add_u32 m0, s52, 24576
  s_nop 0
  buffer_load_dwordx4 v130, s[12:15], s37 offen lds
  buffer_load_dwordx4 v131, s[12:15], s37 offen offset:1024 lds
  s_add_u32 s30, s30, 1
  s_and_b32 s30, s30, 7
  s_cselect_b32 s32, 0, 1
  s_add_u32 s31, s31, s32
  s_sub_u32 s32, s30, s7
  s_and_b32 s32, s32, 7
  s_cmp_lt_u32 s32, 2
  s_cselect_b32 s32, 1, 0
  s_add_u32 s32, s32, s31
  s_cmp_ge_u32 s32, 2
  s_cselect_b32 s32, 0, s32
  s_lshl_b32 s33, s32, 3
  s_add_u32 s33, s33, s30
  s_lshl_b32 s37, s33, 17
  s_add_u32 s37, s37, s35
  s_add_u32 m0, s52, 32768
  s_nop 0
  buffer_load_dwordx4 v130, s[12:15], s37 offen lds
  buffer_load_dwordx4 v131, s[12:15], s37 offen offset:1024 lds
  s_branch attn
L_k1done:
  s_nop 7
  s_nop 7
  s_add_u32 s24, s84, 29360128
  s_addc_u32 s25, s85, 0
  s_mov_b32 s26, 262144
  s_mov_b32 s27, 0x20000
  v_mov_b32 v136, 0
  v_mov_b32 v137, 1
  s_cmp_eq_u32 s57, 0
  s_cselect_b32 s26, s26, 0
  s_waitcnt vmcnt(0)
  s_barrier
  s_mov_b64 exec, 1
  buffer_store_dword v137, v136, s[24:27], s56 offen sc0 sc1
  s_mov_b64 exec, -1
  s_add_u32 s30, s30, 1
  s_and_b32 s30, s30, 7
  s_cselect_b32 s32, 0, 1
  s_add_u32 s31, s31, s32
  s_sub_u32 s32, s30, s7
  s_and_b32 s32, s32, 7
  s_cmp_lt_u32 s32, 2
  s_cselect_b32 s32, 1, 0
  s_add_u32 s32, s32, s31
  s_cmp_ge_u32 s32, 2
  s_cselect_b32 s32, 0, s32
  s_lshl_b32 s33, s32, 3
  s_add_u32 s33, s33, s30
  s_lshl_b32 s37, s33, 17
  s_add_u32 s37, s37, s35
  s_add_u32 m0, s52, 43008
  s_nop 0
  buffer_load_dwordx4 v130, s[12:15], s37 offen lds
  buffer_load_dwordx4 v131, s[12:15], s37 offen offset:1024 lds
  s_add_u32 s30, s30, 1
  s_and_b32 s30, s30, 7
  s_cselect_b32 s32, 0, 1
  s_add_u32 s31, s31, s32
  s_sub_u32 s32, s30, s7
  s_and_b32 s32, s32, 7
  s_cmp_lt_u32 s32, 2
  s_cselect_b32 s32, 1, 0
  s_add_u32 s32, s32, s31
  s_cmp_ge_u32 s32, 2
  s_cselect_b32 s32, 0, s32
  s_lshl_b32 s33, s32, 3
  s_add_u32 s33, s33, s30
  s_lshl_b32 s37, s33, 17
  s_add_u32 s37, s37, s35
  s_add_u32 m0, s52, 51200
  s_nop 0
  buffer_load_dwordx4 v130, s[12:15], s37 offen lds
  buffer_load_dwordx4 v131, s[12:15], s37 offen offset:1024 lds
  s_add_u32 s30, s30, 1
  s_and_b32 s30, s30, 7
  s_cselect_b32 s32, 0, 1
  s_add_u32 s31, s31, s32
  s_sub_u32 s32, s30, s7
  s_and_b32 s32, s32, 7
  s_cmp_lt_u32 s32, 2
  s_cselect_b32 s32, 1, 0
  s_add_u32 s32, s32, s31
  s_cmp_ge_u32 s32, 2
  s_cselect_b32 s32, 0, s32
  s_lshl_b32 s33, s32, 3
  s_add_u32 s33, s33, s30
  s_lshl_b32 s37, s33, 17
  s_add_u32 s37, s37, s35
  s_add_u32 m0, s52, 59392
  s_nop 0
  buffer_load_dwordx4 v130, s[12:15], s37 offen lds
  buffer_load_dwordx4 v131, s[12:15], s37 offen offset:1024 lds
  s_add_u32 s30, s30, 1
  s_and_b32 s30, s30, 7
  s_cselect_b32 s32, 0, 1
  s_add_u32 s31, s31, s32
  s_sub_u32 s32, s30, s7
  s_and_b32 s32, s32, 7
  s_cmp_lt_u32 s32, 2
  s_cselect_b32 s32, 1, 0
  s_add_u32 s32, s32, s31
  s_cmp_ge_u32 s32, 2
  s_cselect_b32 s32, 0, s32
  s_lshl_b32 s33, s32, 3
  s_add_u32 s33, s33, s30
  s_lshl_b32 s37, s33, 17
  s_add_u32 s37, s37, s35
  s_add_u32 m0, s52, 67584
  s_nop 0
  buffer_load_dwordx4 v130, s[12:15], s37 offen lds
  buffer_load_dwordx4 v131, s[12:15], s37 offen offset:1024 lds
  s_lshl_b32 s56, s3, 10
  s_mul_i32 s32, s29, 16
  s_add_u32 s56, s56, s32
  s_add_u32 s56, s56, s28
  s_add_u32 s56, s56, 256
  s_lshl_b32 s56, s56, 7
  s_barrier
  s_waitcnt vmcnt(0)
  s_barrier
  s_cmp_ge_u32 s2, 224
  s_cbranch_scc1 L_k3skip
  s_lshr_b32 s32, s2, 3
  s_mul_i32 s5, s32, 9363
  s_lshr_b32 s5, s5, 16
  s_mul_i32 s6, s5, 7
  s_sub_u32 s6, s32, s6
  s_lshl_b32 s7, s5, 1
  s_add_u32 s7, s7, s6
  s_and_b32 s7, s7, 7
  s_and_b32 s32, s2, 7
  s_lshr_b32 s28, s32, 2
  s_lshl_b32 s28, s28, 2
  s_add_u32 s28, s28, s5
  s_and_b32 s29, s32, 3
  s_mul_i32 s29, s29, 7
  s_add_u32 s29, s29, s6
  s_mov_b32 s30, 7
  s_mov_b32 s31, -1
  s_lshl_b32 s44, s57, 12
  s_add_u32 s45, s44, 16384
  v_lshlrev_b32 v8, 4, v0
  v_add_u32 v13, 63488, v8
  v_lshrrev_b32 v2, 4, v0
  v_lshlrev_b32 v3, 1, v2
  v_and_b32 v4, 15, v0
  v_xor_b32 v3, v3, v4
  v_lshlrev_b32 v3, 4, v3
  s_lshl_b32 s32, s57, 4
  v_add_u32 v2, s32, v2
  s_mov_b32 s32, 7168
  v_mul_lo_u32 v2, v2, s32
  v_add_u32 v9, v2, v3
  v_xor_b32 v3, 128, v3
  v_add_u32 v11, v2, v3
  v_add_u32 v10, 27648, v9
  v_add_u32 v12, 82944, v11
  v_add_u32 v11, 55296, v11
  s_lshl_b32 s34, s28, 2
  s_add_u32 s34, s34, s57
  s_lshl_b32 s34, s34, 17
  s_lshl_b32 s35, s29, 8
  s_add_u32 s8, s82, 8388608
  s_addc_u32 s9, s83, 0
  s_mov_b32 s10, 4194304
  s_mov_b32 s11, 0x20000
  s_mov_b32 s12, s72
  s_mov_b32 s13, s73
  s_mov_b32 s14, 14680064
  s_mov_b32 s15, 0x20000
  s_add_u32 s16, s84, 29360128
  s_addc_u32 s17, s85, 0
  s_mov_b32 s18, 262144
  s_mov_b32 s19, 0x20000
  s_lshl_b32 s32, s28, 5
  v_min_u32 v14, 31, v0
  v_add_u32 v14, s32, v14
  v_max_i32 v14, 0, v14
  v_lshlrev_b32 v14, 7, v14
  s_lshl_b32 s55, s3, 17
  s_add_u32 s55, s55, 32768
  s_lshr_b32 s32, s2, 3
  s_add_u32 s32, s32, 0
  s_lshl_b32 s32, s32, 2
  s_add_u32 s32, s32, s57
  s_lshl_b32 s32, s32, 6
  v_add_u32 v2, s32, v0
  v_mul_u32_u24 v3, 74899, v2
  v_lshrrev_b32 v3, 20, v3
  v_mul_u32_u24 v4, 14, v3
  v_sub_u32 v4, v2, v4
  v_add_u32 v3, 192, v3
  v_mul_u32_u24 v3, 7168, v3
  v_lshl_add_u32 v3, v4, 7, v3
  s_and_b32 s32, s2, 3
  s_mul_i32 s32, s32, 1792
  s_lshl_b32 s40, s3, 30
  s_add_u32 s32, s32, s40
  v_add_u32 v16, s32, v3
  s_barrier
  s_barrier
  s_mov_b64 exec, 1
  buffer_store_dword v137, v136, s[24:27], s56 offen sc0 sc1
  s_mov_b64 exec, -1
  s_mov_b32 s30, 7
  s_mov_b32 s31, -1
  s_mov_b32 s38, 0
  s_add_u32 s30, s30, 1
  s_and_b32 s30, s30, 7
  s_cselect_b32 s32, 0, 1
  s_add_u32 s31, s31, s32
  s_sub_u32 s32, s30, s7
  s_and_b32 s32, s32, 7
  s_cmp_lt_u32 s32, 2
  s_cselect_b32 s32, 1, 0
  s_add_u32 s32, s32, s31
  s_cmp_ge_u32 s32, 4
  s_cselect_b32 s32, 0, s32
  s_lshl_b32 s33, s32, 3
  s_add_u32 s33, s33, s30
  s_mul_i32 s37, s33, 458752
  s_add_u32 s37, s37, s35
  s_add_u32 m0, s38, s45
  s_nop 0
  buffer_load_dwordx4 v9, s[12:15], s37 offen offset:0  lds
  buffer_load_dwordx4 v10, s[12:15], s37 offen offset:1024  lds
  buffer_load_dwordx4 v11, s[12:15], s37 offen offset:2048  lds
  buffer_load_dwordx4 v12, s[12:15], s37 offen offset:3072  lds
  s_add_u32 s38, s38, 32768
  s_cmp_eq_u32 s38, 163840
  s_cselect_b32 s38, 0, s38
  s_add_u32 s30, s30, 1
  s_and_b32 s30, s30, 7
  s_cselect_b32 s32, 0, 1
  s_add_u32 s31, s31, s32
  s_sub_u32 s32, s30, s7
  s_and_b32 s32, s32, 7
  s_cmp_lt_u32 s32, 2
  s_cselect_b32 s32, 1, 0
  s_add_u32 s32, s32, s31
  s_cmp_ge_u32 s32, 4
  s_cselect_b32 s32, 0, s32
  s_lshl_b32 s33, s32, 3
  s_add_u32 s33, s33, s30
  s_mul_i32 s37, s33, 458752
  s_add_u32 s37, s37, s35
  s_add_u32 m0, s38, s45
  s_nop 0
  buffer_load_dwordx4 v9, s[12:15], s37 offen offset:0  lds
  buffer_load_dwordx4 v10, s[12:15], s37 offen offset:1024  lds
  buffer_load_dwordx4 v11, s[12:15], s37 offen offset:2048  lds
  buffer_load_dwordx4 v12, s[12:15], s37 offen offset:3072  lds
  s_add_u32 s38, s38, 32768
  s_cmp_eq_u32 s38, 163840
  s_cselect_b32 s38, 0, s38
  s_add_u32 s30, s30, 1
  s_and_b32 s30, s30, 7
  s_cselect_b32 s32, 0, 1
  s_add_u32 s31, s31, s32
  s_sub_u32 s32, s30, s7
  s_and_b32 s32, s32, 7
  s_cmp_lt_u32 s32, 2
  s_cselect_b32 s32, 1, 0
  s_add_u32 s32, s32, s31
  s_cmp_ge_u32 s32, 4
  s_cselect_b32 s32, 0, s32
  s_lshl_b32 s33, s32, 3
  s_add_u32 s33, s33, s30
  s_mul_i32 s37, s33, 458752
  s_add_u32 s37, s37, s35
  s_add_u32 m0, s38, s45
  s_nop 0
  buffer_load_dwordx4 v9, s[12:15], s37 offen offset:0  lds
  buffer_load_dwordx4 v10, s[12:15], s37 offen offset:1024  lds
  buffer_load_dwordx4 v11, s[12:15], s37 offen offset:2048  lds
  buffer_load_dwordx4 v12, s[12:15], s37 offen offset:3072  lds
  s_add_u32 s38, s38, 32768
  s_cmp_eq_u32 s38, 163840
  s_cselect_b32 s38, 0, s38
  buffer_load_dword v135, v16, s[12:15], 0 offen
  s_lshl_b32 s56, s3, 10
  s_mul_i32 s32, s28, 32
  s_add_u32 s56, s56, s32
  s_add_u32 s56, s56, s29
  s_add_u32 s56, s56, 512
  s_lshl_b32 s56, s56, 7
  s_mov_b32 s39, 0
  s_and_b32 s32, s4, 3
  s_cmp_lg_u32 s32, 0
  s_cbranch_scc1 poll15d
  s_sleep 8
poll15:
  buffer_load_dword v15, v14, s[16:19], s55 offen sc0 sc1
  s_waitcnt vmcnt(0)
  v_cmp_eq_u32 vcc, 0, v15
  s_add_u32 s39, s39, 1
  s_cmp_gt_u32 s39, 1000000
  s_cbranch_scc1 poll15d
  s_cbranch_vccnz poll15
poll15d:
  s_barrier
  s_mov_b32 s30, 7
  s_mov_b32 s31, -1
  s_mov_b32 s38, 0
  s_add_u32 s30, s30, 1
  s_and_b32 s30, s30, 7
  s_cselect_b32 s32, 0, 1
  s_add_u32 s31, s31, s32
  s_sub_u32 s32, s30, s7
  s_and_b32 s32, s32, 7
  s_cmp_lt_u32 s32, 2
  s_cselect_b32 s32, 1, 0
  s_add_u32 s32, s32, s31
  s_cmp_ge_u32 s32, 4
  s_cselect_b32 s32, 0, s32
  s_lshl_b32 s33, s32, 3
  s_add_u32 s33, s33, s30
  s_mul_i32 s36, s33, 2048
  s_add_u32 s36, s36, s34
  s_add_u32 m0, s38, s44
  s_nop 0
  buffer_load_dwordx4 v8, s[8:11], s36 offen offset:0 sc1 lds
  buffer_load_dwordx4 v8, s[8:11], s36 offen offset:1024 sc1 lds
  buffer_load_dwordx4 v13, s[8:11], s36 offen offset:2048 sc1 lds
  buffer_load_dwordx4 v13, s[8:11], s36 offen offset:3072 sc1 lds
  s_add_u32 s38, s38, 32768
  s_cmp_eq_u32 s38, 163840
  s_cselect_b32 s38, 0, s38
  s_add_u32 s30, s30, 1
  s_and_b32 s30, s30, 7
  s_cselect_b32 s32, 0, 1
  s_add_u32 s31, s31, s32
  s_sub_u32 s32, s30, s7
  s_and_b32 s32, s32, 7
  s_cmp_lt_u32 s32, 2
  s_cselect_b32 s32, 1, 0
  s_add_u32 s32, s32, s31
  s_cmp_ge_u32 s32, 4
  s_cselect_b32 s32, 0, s32
  s_lshl_b32 s33, s32, 3
  s_add_u32 s33, s33, s30
  s_mul_i32 s36, s33, 2048
  s_add_u32 s36, s36, s34
  s_add_u32 m0, s38, s44
  s_nop 0
  buffer_load_dwordx4 v8, s[8:11], s36 offen offset:0 sc1 lds
  buffer_load_dwordx4 v8, s[8:11], s36 offen offset:1024 sc1 lds
  buffer_load_dwordx4 v13, s[8:11], s36 offen offset:2048 sc1 lds
  buffer_load_dwordx4 v13, s[8:11], s36 offen offset:3072 sc1 lds
  s_add_u32 s38, s38, 32768
  s_cmp_eq_u32 s38, 163840
  s_cselect_b32 s38, 0, s38
  s_add_u32 s30, s30, 1
  s_and_b32 s30, s30, 7
  s_cselect_b32 s32, 0, 1
  s_add_u32 s31, s31, s32
  s_sub_u32 s32, s30, s7
  s_and_b32 s32, s32, 7
  s_cmp_lt_u32 s32, 2
  s_cselect_b32 s32, 1, 0
  s_add_u32 s32, s32, s31
  s_cmp_ge_u32 s32, 4
  s_cselect_b32 s32, 0, s32
  s_lshl_b32 s33, s32, 3
  s_add_u32 s33, s33, s30
  s_mul_i32 s36, s33, 2048
  s_add_u32 s36, s36, s34
  s_add_u32 m0, s38, s44
  s_nop 0
  buffer_load_dwordx4 v8, s[8:11], s36 offen offset:0 sc1 lds
  buffer_load_dwordx4 v8, s[8:11], s36 offen offset:1024 sc1 lds
  buffer_load_dwordx4 v13, s[8:11], s36 offen offset:2048 sc1 lds
  buffer_load_dwordx4 v13, s[8:11], s36 offen offset:3072 sc1 lds
  s_add_u32 s38, s38, 32768
  s_cmp_eq_u32 s38, 163840
  s_cselect_b32 s38, 0, s38
  s_waitcnt vmcnt(8)
  s_barrier
  s_add_u32 s30, s30, 1
  s_and_b32 s30, s30, 7
  s_cselect_b32 s32, 0, 1
  s_add_u32 s31, s31, s32
  s_sub_u32 s32, s30, s7
  s_and_b32 s32, s32, 7
  s_cmp_lt_u32 s32, 2
  s_cselect_b32 s32, 1, 0
  s_add_u32 s32, s32, s31
  s_cmp_ge_u32 s32, 4
  s_cselect_b32 s32, 0, s32
  s_lshl_b32 s33, s32, 3
  s_add_u32 s33, s33, s30
  s_mul_i32 s36, s33, 2048
  s_add_u32 s36, s36, s34
  s_mul_i32 s37, s33, 458752
  s_add_u32 s37, s37, s35
  s_add_u32 m0, s38, s44
  s_nop 0
  buffer_load_dwordx4 v8, s[8:11], s36 offen offset:0 sc1 lds
  buffer_load_dwordx4 v8, s[8:11], s36 offen offset:1024 sc1 lds
  buffer_load_dwordx4 v13, s[8:11], s36 offen offset:2048 sc1 lds
  buffer_load_dwordx4 v13, s[8:11], s36 offen offset:3072 sc1 lds
  s_add_u32 m0, s38, s45
  s_nop 0
  buffer_load_dwordx4 v9, s[12:15], s37 offen offset:0  lds
  buffer_load_dwordx4 v10, s[12:15], s37 offen offset:1024  lds
  buffer_load_dwordx4 v11, s[12:15], s37 offen offset:2048  lds
  buffer_load_dwordx4 v12, s[12:15], s37 offen offset:3072  lds
  s_add_u32 s38, s38, 32768
  s_cmp_eq_u32 s38, 163840
  s_cselect_b32 s38, 0, s38
  s_waitcnt vmcnt(12)
  s_barrier
  s_add_u32 s30, s30, 1
  s_and_b32 s30, s30, 7
  s_cselect_b32 s32, 0, 1
  s_add_u32 s31, s31, s32
  s_sub_u32 s32, s30, s7
  s_and_b32 s32, s32, 7
  s_cmp_lt_u32 s32, 2
  s_cselect_b32 s32, 1, 0
  s_add_u32 s32, s32, s31
  s_cmp_ge_u32 s32, 4
  s_cselect_b32 s32, 0, s32
  s_lshl_b32 s33, s32, 3
  s_add_u32 s33, s33, s30
  s_mul_i32 s36, s33, 2048
  s_add_u32 s36, s36, s34
  s_mul_i32 s37, s33, 458752
  s_add_u32 s37, s37, s35
  s_add_u32 m0, s38, s44
  s_nop 0
  buffer_load_dwordx4 v8, s[8:11], s36 offen offset:0 sc1 lds
  buffer_load_dwordx4 v8, s[8:11], s36 offen offset:1024 sc1 lds
  buffer_load_dwordx4 v13, s[8:11], s36 offen offset:2048 sc1 lds
  buffer_load_dwordx4 v13, s[8:11], s36 offen offset:3072 sc1 lds
  s_add_u32 m0, s38, s45
  s_nop 0
  buffer_load_dwordx4 v9, s[12:15], s37 offen offset:0  lds
  buffer_load_dwordx4 v10, s[12:15], s37 offen offset:1024  lds
  buffer_load_dwordx4 v11, s[12:15], s37 offen offset:2048  lds
  buffer_load_dwordx4 v12, s[12:15], s37 offen offset:3072  lds
  s_add_u32 s38, s38, 32768
  s_cmp_eq_u32 s38, 163840
  s_cselect_b32 s38, 0, s38
  s_mov_b32 s39, 27
ll16:
  s_waitcnt vmcnt(16)
  s_barrier
  s_add_u32 s30, s30, 1
  s_and_b32 s30, s30, 7
  s_cselect_b32 s32, 0, 1
  s_add_u32 s31, s31, s32
  s_sub_u32 s32, s30, s7
  s_and_b32 s32, s32, 7
  s_cmp_lt_u32 s32, 2
  s_cselect_b32 s32, 1, 0
  s_add_u32 s32, s32, s31
  s_cmp_ge_u32 s32, 4
  s_cselect_b32 s32, 0, s32
  s_lshl_b32 s33, s32, 3
  s_add_u32 s33, s33, s30
  s_mul_i32 s36, s33, 2048
  s_add_u32 s36, s36, s34
  s_mul_i32 s37, s33, 458752
  s_add_u32 s37, s37, s35
  s_add_u32 m0, s38, s44
  s_nop 0
  buffer_load_dwordx4 v8, s[8:11], s36 offen offset:0 sc1 lds
  buffer_load_dwordx4 v8, s[8:11], s36 offen offset:1024 sc1 lds
  buffer_load_dwordx4 v13, s[8:11], s36 offen offset:2048 sc1 lds
  buffer_load_dwordx4 v13, s[8:11], s36 offen offset:3072 sc1 lds
  s_add_u32 m0, s38, s45
  s_nop 0
  buffer_load_dwordx4 v9, s[12:15], s37 offen offset:0  lds
  buffer_load_dwordx4 v10, s[12:15], s37 offen offset:1024  lds
  buffer_load_dwordx4 v11, s[12:15], s37 offen offset:2048  lds
  buffer_load_dwordx4 v12, s[12:15], s37 offen offset:3072  lds
  s_add_u32 s38, s38, 32768
  s_cmp_eq_u32 s38, 163840
  s_cselect_b32 s38, 0, s38
  s_sub_u32 s39, s39, 1
  s_cmp_lg_u32 s39, 0
  s_cbranch_scc1 ll16
  s_waitcnt vmcnt(16)
  s_barrier
  s_waitcnt vmcnt(8)
  s_barrier
  s_waitcnt vmcnt(0)
  s_barrier
  s_lshr_b32 s32, s2, 3
  s_lshr_b32 s5, s32, 3
  s_and_b32 s6, s32, 7
  s_lshl_b32 s7, s5, 1
  s_add_u32 s7, s7, s6
  s_and_b32 s7, s7, 7
  s_and_b32 s32, s2, 7
  s_lshr_b32 s28, s32, 2
  s_lshl_b32 s28, s28, 2
  s_add_u32 s28, s28, s5
  s_and_b32 s29, s32, 3
  s_mul_i32 s29, s29, 8
  s_add_u32 s29, s29, s6
  s_mov_b32 s30, 7
  s_mov_b32 s31, -1
  s_mov_b32 s41, s57
  s_lshl_b32 s45, s41, 11
  s_mul_i32 s32, s41, 16
  s_add_u32 s32, s32, 0
  v_lshrrev_b32 v2, 3, v0
  v_add_u32 v2, s32, v2
  v_bfe_u32 v3, v2, 1, 1
  v_bfe_u32 v4, v2, 3, 1
  v_lshl_or_b32 v3, v4, 1, v3
  v_lshlrev_b32 v3, 1, v3
  v_and_b32 v4, 7, v0
  v_xor_b32 v3, v3, v4
  v_lshlrev_b32 v3, 4, v3
  s_mov_b32 s32, 4096
  v_mul_lo_u32 v2, v2, s32
  v_add_u32 v9, v2, v3
  s_mul_i32 s32, s41, 16
  s_add_u32 s32, s32, 8
  v_lshrrev_b32 v2, 3, v0
  v_add_u32 v2, s32, v2
  v_bfe_u32 v3, v2, 1, 1
  v_bfe_u32 v4, v2, 3, 1
  v_lshl_or_b32 v3, v4, 1, v3
  v_lshlrev_b32 v3, 1, v3
  v_and_b32 v4, 7, v0
  v_xor_b32 v3, v3, v4
  v_lshlrev_b32 v3, 4, v3
  s_mov_b32 s32, 4096
  v_mul_lo_u32 v2, v2, s32
  v_add_u32 v10, v2, v3
  v_subrev_u32 v10, 1024, v10
  s_lshl_b32 s35, s29, 7
  s_mov_b32 s12, s76
  s_mov_b32 s13, s77
  s_mov_b32 s14, 14680064
  s_mov_b32 s15, 0x20000
  s_branch L_k4
L_k3skip:
  s_nop 7
  s_nop 7
  s_lshr_b32 s32, s2, 3
  s_lshr_b32 s5, s32, 3
  s_and_b32 s6, s32, 7
  s_lshl_b32 s7, s5, 1
  s_add_u32 s7, s7, s6
  s_and_b32 s7, s7, 7
  s_and_b32 s32, s2, 7
  s_lshr_b32 s28, s32, 2
  s_lshl_b32 s28, s28, 2
  s_add_u32 s28, s28, s5
  s_and_b32 s29, s32, 3
  s_mul_i32 s29, s29, 8
  s_add_u32 s29, s29, s6
  s_mov_b32 s30, 7
  s_mov_b32 s31, -1
  s_mov_b32 s41, s57
  s_lshl_b32 s45, s41, 11
  s_mul_i32 s32, s41, 16
  s_add_u32 s32, s32, 0
  v_lshrrev_b32 v2, 3, v0
  v_add_u32 v2, s32, v2
  v_bfe_u32 v3, v2, 1, 1
  v_bfe_u32 v4, v2, 3, 1
  v_lshl_or_b32 v3, v4, 1, v3
  v_lshlrev_b32 v3, 1, v3
  v_and_b32 v4, 7, v0
  v_xor_b32 v3, v3, v4
  v_lshlrev_b32 v3, 4, v3
  s_mov_b32 s32, 4096
  v_mul_lo_u32 v2, v2, s32
  v_add_u32 v9, v2, v3
  s_mul_i32 s32, s41, 16
  s_add_u32 s32, s32, 8
  v_lshrrev_b32 v2, 3, v0
  v_add_u32 v2, s32, v2
  v_bfe_u32 v3, v2, 1, 1
  v_bfe_u32 v4, v2, 3, 1
  v_lshl_or_b32 v3, v4, 1, v3
  v_lshlrev_b32 v3, 1, v3
  v_and_b32 v4, 7, v0
  v_xor_b32 v3, v3, v4
  v_lshlrev_b32 v3, 4, v3
  s_mov_b32 s32, 4096
  v_mul_lo_u32 v2, v2, s32
  v_add_u32 v10, v2, v3
  v_subrev_u32 v10, 1024, v10
  s_lshl_b32 s35, s29, 7
  s_mov_b32 s12, s76
  s_mov_b32 s13, s77
  s_mov_b32 s14, 14680064
  s_mov_b32 s15, 0x20000
  s_barrier
L_k4:
  s_nop 7
  s_nop 7
  s_mov_b32 s30, 7
  s_mov_b32 s31, -1
  s_mov_b32 s38, 98304
  s_add_u32 s30, s30, 1
  s_and_b32 s30, s30, 7
  s_cselect_b32 s32, 0, 1
  s_add_u32 s31, s31, s32
  s_sub_u32 s32, s30, s7
  s_and_b32 s32, s32, 7
  s_cmp_lt_u32 s32, 2
  s_cselect_b32 s32, 1, 0
  s_add_u32 s32, s32, s31
  s_cmp_ge_u32 s32, 7
  s_cselect_b32 s32, 0, s32
  s_lshl_b32 s33, s32, 3
  s_add_u32 s33, s33, s30
  s_mul_i32 s37, s33, 262144
  s_add_u32 s37, s37, s35
  s_add_u32 m0, s38, s45
  s_nop 0
  buffer_load_dwordx4 v9, s[12:15], s37 offen offset:0  lds
  buffer_load_dwordx4 v10, s[12:15], s37 offen offset:1024  lds
  s_add_u32 s38, s38, 8192
  s_cmp_eq_u32 s38, 163840
  s_cselect_b32 s38, 98304, s38
  s_add_u32 s30, s30, 1
  s_and_b32 s30, s30, 7
  s_cselect_b32 s32, 0, 1
  s_add_u32 s31, s31, s32
  s_sub_u32 s32, s30, s7
  s_and_b32 s32, s32, 7
  s_cmp_lt_u32 s32, 2
  s_cselect_b32 s32, 1, 0
  s_add_u32 s32, s32, s31
  s_cmp_ge_u32 s32, 7
  s_cselect_b32 s32, 0, s32
  s_lshl_b32 s33, s32, 3
  s_add_u32 s33, s33, s30
  s_mul_i32 s37, s33, 262144
  s_add_u32 s37, s37, s35
  s_add_u32 m0, s38, s45
  s_nop 0
  buffer_load_dwordx4 v9, s[12:15], s37 offen offset:0  lds
  buffer_load_dwordx4 v10, s[12:15], s37 offen offset:1024  lds
  s_add_u32 s38, s38, 8192
  s_cmp_eq_u32 s38, 163840
  s_cselect_b32 s38, 98304, s38
  s_add_u32 s30, s30, 1
  s_and_b32 s30, s30, 7
  s_cselect_b32 s32, 0, 1
  s_add_u32 s31, s31, s32
  s_sub_u32 s32, s30, s7
  s_and_b32 s32, s32, 7
  s_cmp_lt_u32 s32, 2
  s_cselect_b32 s32, 1, 0
  s_add_u32 s32, s32, s31
  s_cmp_ge_u32 s32, 7
  s_cselect_b32 s32, 0, s32
  s_lshl_b32 s33, s32, 3
  s_add_u32 s33, s33, s30
  s_mul_i32 s37, s33, 262144
  s_add_u32 s37, s37, s35
  s_add_u32 m0, s38, s45
  s_nop 0
  buffer_load_dwordx4 v9, s[12:15], s37 offen offset:0  lds
  buffer_load_dwordx4 v10, s[12:15], s37 offen offset:1024  lds
  s_add_u32 s38, s38, 8192
  s_cmp_eq_u32 s38, 163840
  s_cselect_b32 s38, 98304, s38
  s_add_u32 s30, s30, 1
  s_and_b32 s30, s30, 7
  s_cselect_b32 s32, 0, 1
  s_add_u32 s31, s31, s32
  s_sub_u32 s32, s30, s7
  s_and_b32 s32, s32, 7
  s_cmp_lt_u32 s32, 2
  s_cselect_b32 s32, 1, 0
  s_add_u32 s32, s32, s31
  s_cmp_ge_u32 s32, 7
  s_cselect_b32 s32, 0, s32
  s_lshl_b32 s33, s32, 3
  s_add_u32 s33, s33, s30
  s_mul_i32 s37, s33, 262144
  s_add_u32 s37, s37, s35
  s_add_u32 m0, s38, s45
  s_nop 0
  buffer_load_dwordx4 v9, s[12:15], s37 offen offset:0  lds
  buffer_load_dwordx4 v10, s[12:15], s37 offen offset:1024  lds
  s_add_u32 s38, s38, 8192
  s_cmp_eq_u32 s38, 163840
  s_cselect_b32 s38, 98304, s38
  s_add_u32 s30, s30, 1
  s_and_b32 s30, s30, 7
  s_cselect_b32 s32, 0, 1
  s_add_u32 s31, s31, s32
  s_sub_u32 s32, s30, s7
  s_and_b32 s32, s32, 7
  s_cmp_lt_u32 s32, 2
  s_cselect_b32 s32, 1, 0
  s_add_u32 s32, s32, s31
  s_cmp_ge_u32 s32, 7
  s_cselect_b32 s32, 0, s32
  s_lshl_b32 s33, s32, 3
  s_add_u32 s33, s33, s30
  s_mul_i32 s37, s33, 262144
  s_add_u32 s37, s37, s35
  s_add_u32 m0, s38, s45
  s_nop 0
  buffer_load_dwordx4 v9, s[12:15], s37 offen offset:0  lds
  buffer_load_dwordx4 v10, s[12:15], s37 offen offset:1024  lds
  s_add_u32 s38, s38, 8192
  s_cmp_eq_u32 s38, 163840
  s_cselect_b32 s38, 98304, s38
  s_add_u32 s30, s30, 1
  s_and_b32 s30, s30, 7
  s_cselect_b32 s32, 0, 1
  s_add_u32 s31, s31, s32
  s_sub_u32 s32, s30, s7
  s_and_b32 s32, s32, 7
  s_cmp_lt_u32 s32, 2
  s_cselect_b32 s32, 1, 0
  s_add_u32 s32, s32, s31
  s_cmp_ge_u32 s32, 7
  s_cselect_b32 s32, 0, s32
  s_lshl_b32 s33, s32, 3
  s_add_u32 s33, s33, s30
  s_mul_i32 s37, s33, 262144
  s_add_u32 s37, s37, s35
  s_add_u32 m0, s38, s45
  s_nop 0
  buffer_load_dwordx4 v9, s[12:15], s37 offen offset:0  lds
  buffer_load_dwordx4 v10, s[12:15], s37 offen offset:1024  lds
  s_add_u32 s38, s38, 8192
  s_cmp_eq_u32 s38, 163840
  s_cselect_b32 s38, 98304, s38
  s_barrier
  s_mov_b64 exec, 1
  buffer_store_dword v137, v136, s[24:27], s56 offen sc0 sc1
  s_mov_b64 exec, -1
  s_lshl_b32 s56, s3, 10
  s_mul_i32 s32, s29, 8
  s_add_u32 s56, s56, s32
  s_add_u32 s56, s56, s28
  s_add_u32 s56, s56, 768
  s_lshl_b32 s56, s56, 7
  s_barrier
  s_mov_b32 s39, 50
ll17:
  s_waitcnt vmcnt(10)
  s_barrier
  s_add_u32 s30, s30, 1
  s_and_b32 s30, s30, 7
  s_cselect_b32 s32, 0, 1
  s_add_u32 s31, s31, s32
  s_sub_u32 s32, s30, s7
  s_and_b32 s32, s32, 7
  s_cmp_lt_u32 s32, 2
  s_cselect_b32 s32, 1, 0
  s_add_u32 s32, s32, s31
  s_cmp_ge_u32 s32, 7
  s_cselect_b32 s32, 0, s32
  s_lshl_b32 s33, s32, 3
  s_add_u32 s33, s33, s30
  s_mul_i32 s37, s33, 262144
  s_add_u32 s37, s37, s35
  s_add_u32 m0, s38, s45
  s_nop 0
  buffer_load_dwordx4 v9, s[12:15], s37 offen offset:0  lds
  buffer_load_dwordx4 v10, s[12:15], s37 offen offset:1024  lds
  s_add_u32 s38, s38, 8192
  s_cmp_eq_u32 s38, 163840
  s_cselect_b32 s38, 98304, s38
  s_sub_u32 s39, s39, 1
  s_cmp_lg_u32 s39, 0
  s_cbranch_scc1 ll17
  s_waitcnt vmcnt(10)
  s_barrier
  s_waitcnt vmcnt(8)
  s_barrier
  s_waitcnt vmcnt(6)
  s_barrier
  s_waitcnt vmcnt(4)
  s_barrier
  s_waitcnt vmcnt(2)
  s_barrier
  s_waitcnt vmcnt(0)
  s_barrier
  s_cmp_lg_u32 s3, 0
  s_cbranch_scc1 L_end
  s_lshr_b32 s32, s2, 3
  s_lshr_b32 s5, s32, 3
  s_and_b32 s6, s32, 7
  s_lshl_b32 s7, s5, 1
  s_add_u32 s7, s7, s6
  s_and_b32 s7, s7, 7
  s_and_b32 s32, s2, 7
  s_lshr_b32 s28, s32, 1
  s_lshl_b32 s28, s28, 2
  s_add_u32 s28, s28, s5
  s_and_b32 s29, s32, 1
  s_mul_i32 s29, s29, 8
  s_add_u32 s29, s29, s6
  s_mov_b32 s30, 7
  s_mov_b32 s31, -1
  s_mov_b32 s41, s57
  s_mul_i32 s32, s41, 16
  s_add_u32 s32, s32, 0
  v_lshrrev_b32 v2, 3, v0
  v_add_u32 v2, s32, v2
  v_bfe_u32 v3, v2, 1, 1
  v_bfe_u32 v4, v2, 3, 1
  v_lshl_or_b32 v3, v4, 1, v3
  v_lshlrev_b32 v3, 1, v3
  v_and_b32 v4, 7, v0
  v_xor_b32 v3, v3, v4
  v_lshlrev_b32 v3, 4, v3
  s_mov_b32 s32, 6144
  v_mul_lo_u32 v2, v2, s32
  v_add_u32 v13, v2, v3
  s_mul_i32 s32, s41, 16
  s_add_u32 s32, s32, 8
  v_lshrrev_b32 v2, 3, v0
  v_add_u32 v2, s32, v2
  v_bfe_u32 v3, v2, 1, 1
  v_bfe_u32 v4, v2, 3, 1
  v_lshl_or_b32 v3, v4, 1, v3
  v_lshlrev_b32 v3, 1, v3
  v_and_b32 v4, 7, v0
  v_xor_b32 v3, v3, v4
  v_lshlrev_b32 v3, 4, v3
  s_mov_b32 s32, 6144
  v_mul_lo_u32 v2, v2, s32
  v_add_u32 v14, v2, v3
  v_subrev_u32 v14, 1024, v14
  v_add_u32 v15, 2048, v13
  v_add_u32 v16, 2048, v14
  v_add_u32 v17, 4096, v13
  v_add_u32 v18, 4096, v14
  s_lshl_b32 s46, s41, 11
  s_add_u32 s46, s46, 18432
  s_add_u32 s47, s46, 8192
  s_add_u32 s48, s46, 16384
  s_lshl_b32 s35, s29, 7
  s_mov_b32 s12, s66
  s_mov_b32 s13, s67
  s_mov_b32 s14, 6291456
  s_mov_b32 s15, 0x20000
  s_mov_b32 s30, 7
  s_mov_b32 s31, -1
  s_mov_b32 s38, 0
  s_add_u32 s30, s30, 1
  s_and_b32 s30, s30, 7
  s_cselect_b32 s32, 0, 1
  s_add_u32 s31, s31, s32
  s_sub_u32 s32, s30, s7
  s_and_b32 s32, s32, 7
  s_cmp_lt_u32 s32, 2
  s_cselect_b32 s32, 1, 0
  s_add_u32 s32, s32, s31
  s_cmp_ge_u32 s32, 2
  s_cselect_b32 s32, 0, s32
  s_lshl_b32 s33, s32, 3
  s_add_u32 s33, s33, s30
  s_mul_i32 s37, s33, 393216
  s_add_u32 s37, s37, s35
  s_add_u32 m0, s38, s46
  s_nop 0
  buffer_load_dwordx4 v13, s[12:15], s37 offen offset:0  lds
  buffer_load_dwordx4 v14, s[12:15], s37 offen offset:1024  lds
  s_add_u32 m0, s38, s47
  s_nop 0
  buffer_load_dwordx4 v15, s[12:15], s37 offen offset:0  lds
  buffer_load_dwordx4 v16, s[12:15], s37 offen offset:1024  lds
  s_add_u32 m0, s38, s48
  s_nop 0
  buffer_load_dwordx4 v17, s[12:15], s37 offen offset:0  lds
  buffer_load_dwordx4 v18, s[12:15], s37 offen offset:1024  lds
  s_add_u32 s38, s38, 43008
  s_cmp_eq_u32 s38, 129024
  s_cselect_b32 s38, 0, s38
  s_add_u32 s30, s30, 1
  s_and_b32 s30, s30, 7
  s_cselect_b32 s32, 0, 1
  s_add_u32 s31, s31, s32
  s_sub_u32 s32, s30, s7
  s_and_b32 s32, s32, 7
  s_cmp_lt_u32 s32, 2
  s_cselect_b32 s32, 1, 0
  s_add_u32 s32, s32, s31
  s_cmp_ge_u32 s32, 2
  s_cselect_b32 s32, 0, s32
  s_lshl_b32 s33, s32, 3
  s_add_u32 s33, s33, s30
  s_mul_i32 s37, s33, 393216
  s_add_u32 s37, s37, s35
  s_add_u32 m0, s38, s46
  s_nop 0
  buffer_load_dwordx4 v13, s[12:15], s37 offen offset:0  lds
  buffer_load_dwordx4 v14, s[12:15], s37 offen offset:1024  lds
  s_add_u32 m0, s38, s47
  s_nop 0
  buffer_load_dwordx4 v15, s[12:15], s37 offen offset:0  lds
  buffer_load_dwordx4 v16, s[12:15], s37 offen offset:1024  lds
  s_add_u32 m0, s38, s48
  s_nop 0
  buffer_load_dwordx4 v17, s[12:15], s37 offen offset:0  lds
  buffer_load_dwordx4 v18, s[12:15], s37 offen offset:1024  lds
  s_add_u32 s38, s38, 43008
  s_cmp_eq_u32 s38, 129024
  s_cselect_b32 s38, 0, s38
  s_lshl_b32 s40, s28, 7
  s_sub_u32 s40, s40, 16
  s_lshl_b32 s32, s41, 5
  s_add_u32 s32, s32, 16
  v_lshrrev_b32 v2, 3, v0
  v_add_u32 v2, s32, v2
  v_bfe_u32 v3, v2, 1, 3
  v_and_b32 v4, 7, v0
  v_xor_b32 v3, v3, v4
  v_lshlrev_b32 v3, 4, v3
  v_add_u32 v2, s40, v2
  v_max_i32 v2, 0, v2
  v_lshlrev_b32 v2, 11, v2
  v_add_u32 v8, v2, v3
  v_add_u32 v10, 30720, v8
  s_lshl_b32 s32, s41, 5
  s_add_u32 s32, s32, 24
  v_lshrrev_b32 v2, 3, v0
  v_add_u32 v2, s32, v2
  v_bfe_u32 v3, v2, 1, 3
  v_and_b32 v4, 7, v0
  v_xor_b32 v3, v3, v4
  v_lshlrev_b32 v3, 4, v3
  v_add_u32 v2, s40, v2
  v_max_i32 v2, 0, v2
  v_lshlrev_b32 v2, 11, v2
  v_add_u32 v9, v2, v3
  v_subrev_u32 v9, 1024, v9
  v_add_u32 v11, 30720, v9
  s_lshl_b32 s32, s41, 3
  v_lshrrev_b32 v2, 3, v0
  v_add_u32 v2, s32, v2
  v_bfe_u32 v3, v2, 1, 3
  v_and_b32 v4, 7, v0
  v_xor_b32 v3, v3, v4
  v_lshlrev_b32 v3, 4, v3
  v_add_u32 v2, s40, v2
  v_max_i32 v2, 0, v2
  v_lshlrev_b32 v2, 11, v2
  v_add_u32 v12, v2, v3
  s_lshl_b32 s44, s41, 12
  s_add_u32 s44, s44, 2048
  s_lshl_b32 s45, s41, 10
  s_mov_b32 s34, 0
  s_cmp_eq_u32 s41, 0
  s_cselect_b32 s52, 0xffffff00, -1
  s_mov_b32 s53, -1
  v_mov_b32 v20, 0x3f803f80
  v_mov_b32 v21, v20
  v_mov_b32 v22, v20
  v_mov_b32 v23, v20
  v_lshlrev_b32 v24, 4, v0
  v_add_u32 v25, 86016, v24
  s_mov_b64 exec, 0xff
  ds_write_b128 v24, v[20:23]
  ds_write_b128 v24, v[20:23] offset:43008
  ds_write_b128 v25, v[20:23]
  s_mov_b64 exec, -1
  s_lshl_b32 s32, s41, 6
  v_add_u32 v26, s32, v0
  v_min_u32 v26, 143, v26
  v_add_u32 v27, s40, v26
  v_max_i32 v27, 0, v27
  v_lshlrev_b32 v27, 3, v27
  v_lshlrev_b32 v26, 3, v26
  v_add_u32 v26, 129024, v26
  s_add_u32 s8, s84, 25165824
  s_addc_u32 s9, s85, 0
  s_mov_b32 s10, 4194304
  s_mov_b32 s11, 0x20000
  s_add_u32 s20, s84, 55574528
  s_addc_u32 s21, s85, 0
  s_mov_b32 s22, 131072
  s_mov_b32 s23, 0x20000
  s_waitcnt lgkmcnt(0)
  s_add_u32 s16, s84, 29360128
  s_addc_u32 s17, s85, 0
  s_mov_b32 s18, 262144
  s_mov_b32 s19, 0x20000
  s_lshl_b32 s32, s28, 4
  s_sub_u32 s32, s32, 8
  v_min_u32 v28, 23, v0
  v_add_u32 v28, s32, v28
  v_max_i32 v28, 0, v28
  v_lshlrev_b32 v28, 7, v28
  s_lshl_b32 s55, s3, 17
  s_add_u32 s55, s55, 98304
  s_barrier
  s_barrier
  s_mov_b64 exec, 1
  buffer_store_dword v137, v136, s[24:27], s56 offen sc0 sc1
  s_mov_b64 exec, -1
  s_mov_b32 s39, 0
  s_and_b32 s32, s4, 3
  s_cmp_lg_u32 s32, 0
  s_cbranch_scc1 poll18d
  s_sleep 8
poll18:
  buffer_load_dword v29, v28, s[16:19], s55 offen sc0 sc1
  s_waitcnt vmcnt(0)
  v_cmp_eq_u32 vcc, 0, v29
  s_add_u32 s39, s39, 1
  s_cmp_gt_u32 s39, 1000000
  s_cbranch_scc1 poll18d
  s_cbranch_vccnz poll18
poll18d:
  s_barrier
  s_mov_b32 s3, 1
  s_add_u32 s82, s84, 33554432
  s_addc_u32 s83, s85, 0
  s_branch L_top
L_end:
mega_end:
  s_endpgm
.section .rodata,"a"
.p2align 6
.amdhsa_kernel interleave_layers__sliding_local_dilated__mixer_token_mlp__prompt_kernel
  .amdhsa_next_free_vgpr 256
  .amdhsa_next_free_sgpr 102
  .amdhsa_accum_offset 256
  .amdhsa_group_segment_fixed_size 0
  .amdhsa_kernarg_size 88
  .amdhsa_user_sgpr_count 2
  .amdhsa_user_sgpr_kernarg_segment_ptr 1
  .amdhsa_system_sgpr_workgroup_id_x 1
.end_amdhsa_kernel
```

```asm
; @launch grid=(256,1,1) block=(512,1,1) lds=163840
.amdgcn_target "amdgcn-amd-amdhsa--gfx950"
.text
.globl interleave_layers__sliding_local_dilated__mixer_token_mlp__prompt_kernel
.type interleave_layers__sliding_local_dilated__mixer_token_mlp__prompt_kernel,@function
.p2align 8
interleave_layers__sliding_local_dilated__mixer_token_mlp__prompt_kernel:
  s_cmp_ge_u32 s2, 256
  s_cbranch_scc1 mega_end
  s_load_dwordx16 s[64:79], s[0:1], 0
  s_load_dwordx2 s[80:81], s[0:1], 64
  s_load_dwordx2 s[84:85], s[0:1], 80
  s_load_dwordx2 s[62:63], s[0:1], 72
  v_lshrrev_b32 v1, 6, v0
  v_and_b32 v0, 63, v0
  v_readfirstlane_b32 s4, v1
  s_mov_b32 s3, 0
  v_mov_b32 v130, 0
  v_mov_b32 v131, 0
  v_mov_b32 v134, 0
  s_cmp_ge_u32 s4, 4
  s_cbranch_scc1 L_start
  s_lshr_b32 s32, s2, 3
  s_lshr_b32 s5, s32, 3
  s_and_b32 s6, s32, 7
  s_lshl_b32 s7, s5, 1
  s_add_u32 s7, s7, s6
  s_and_b32 s7, s7, 7
  s_and_b32 s32, s2, 7
  s_lshr_b32 s28, s32, 1
  s_lshl_b32 s28, s28, 2
  s_add_u32 s28, s28, s5
  s_and_b32 s29, s32, 1
  s_mul_i32 s29, s29, 8
  s_add_u32 s29, s29, s6
  s_mov_b32 s30, 7
  s_mov_b32 s31, -1
  v_and_b32 v4, 15, v0
  v_lshrrev_b32 v5, 4, v0
  v_lshrrev_b32 v6, 2, v4
  v_and_b32 v7, 3, v0
  v_lshrrev_b32 v3, 5, v0
  v_and_b32 v2, 1, v5
  v_lshl_or_b32 v3, v2, 1, v3
  v_lshl_add_u32 v21, v5, 3, v6
  v_lshlrev_b32 v21, 7, v21
  v_lshl_add_u32 v21, v7, 3, v21
  v_lshrrev_b32 v22, 1, v6
  v_lshl_or_b32 v22, v2, 1, v22
  v_lshl_add_u32 v21, v22, 5, v21
  v_add_u32 v21, 18432, v21
  v_xor_b32 v8, 0, v21
  s_lshl_b32 s32, s4, 5
  v_xor_b32 v8, s32, v8
  v_lshrrev_b32 v21, 1, v4
  v_xor_b32 v21, v21, v5
  v_lshlrev_b32 v21, 4, v21
  v_lshlrev_b32 v22, 7, v4
  v_add_u32 v9, v21, v22
  v_xor_b32 v10, 64, v9
  v_and_b32 v21, 1, v4
  v_mul_u32_u24 v21, 28800, v21
  v_lshrrev_b32 v22, 1, v4
  v_mul_u32_u24 v22, 400, v22
  v_lshlrev_b32 v23, 3, v5
  v_add3_u32 v11, v21, v22, v23
  s_add_u32 s32, s32, 43008
  v_add_u32 v11, s32, v11
  v_lshlrev_b32 v12, 3, v4
  v_add_u32 v12, 129024, v12
  v_mov_b64 v[112:113], 0
  v_mov_b64 v[114:115], 0
  v_mov_b64 v[116:117], 0
  v_mov_b64 v[118:119], 0
  v_mov_b64 v[120:121], 0
  v_mov_b64 v[122:123], 0
  v_mov_b64 v[124:125], 0
  v_mov_b64 v[126:127], 0
  v_mov_b64 v[128:129], 0
  v_mov_b64 v[130:131], 0
  v_mov_b64 v[132:133], 0
  v_mov_b64 v[134:135], 0
  v_mov_b64 v[136:137], 0
  v_mov_b64 v[138:139], 0
  v_mov_b64 v[140:141], 0
  v_mov_b64 v[142:143], 0
  v_mov_b64 v[144:145], 0
  v_mov_b64 v[146:147], 0
  v_mov_b64 v[148:149], 0
  v_mov_b64 v[150:151], 0
  v_mov_b64 v[152:153], 0
  v_mov_b64 v[154:155], 0
  v_mov_b64 v[156:157], 0
  v_mov_b64 v[158:159], 0
  v_mov_b64 v[160:161], 0
  v_mov_b64 v[162:163], 0
  v_mov_b64 v[164:165], 0
  v_mov_b64 v[166:167], 0
  v_mov_b64 v[168:169], 0
  v_mov_b64 v[170:171], 0
  v_mov_b64 v[172:173], 0
  v_mov_b64 v[174:175], 0
  v_mov_b64 v[176:177], 0
  v_mov_b64 v[178:179], 0
  v_mov_b64 v[180:181], 0
  v_mov_b64 v[182:183], 0
  v_mov_b64 v[184:185], 0
  v_mov_b64 v[186:187], 0
  v_mov_b64 v[188:189], 0
  v_mov_b64 v[190:191], 0
  v_mov_b64 v[192:193], 0
  v_mov_b64 v[194:195], 0
  v_mov_b64 v[196:197], 0
  v_mov_b64 v[198:199], 0
  v_mov_b64 v[200:201], 0
  v_mov_b64 v[202:203], 0
  v_mov_b64 v[204:205], 0
  v_mov_b64 v[206:207], 0
  v_mov_b64 v[208:209], 0
  v_mov_b64 v[210:211], 0
  v_mov_b64 v[212:213], 0
  v_mov_b64 v[214:215], 0
  v_mov_b64 v[216:217], 0
  v_mov_b64 v[218:219], 0
  s_lshr_b32 s40, s4, 1
  s_and_b32 s41, s4, 1
  s_mul_i32 s32, s41, 28800
  s_add_u32 s32, s32, 43008
  s_lshl_b32 s49, s40, 4
  v_add_u32 v76, s49, v4
  v_lshlrev_b32 v77, 4, v5
  v_add_u32 v77, s32, v77
  v_mul_u32_u24 v78, 400, v76
  v_add_u32 v220, v78, v77
  v_add_u32 v223, 3200, v220
  v_add_u32 v220, 128, v220
  v_add_u32 v76, 16, v76
  v_min_u32 v76, 71, v76
  v_mul_u32_u24 v78, 400, v76
  v_add3_u32 v221, v78, v77, 64
  v_add_u32 v221, 64, v221
  v_lshl_add_u32 v76, v5, 2, v6
  v_add_u32 v76, s49, v76
  v_lshlrev_b32 v77, 4, v7
  v_add_u32 v77, s32, v77
  v_add_u32 v77, 256, v77
  v_mul_u32_u24 v78, 400, v76
  v_add_u32 v222, v78, v77
  v_add_u32 v76, 16, v76
  v_min_u32 v76, 71, v76
  v_mul_u32_u24 v78, 400, v76
  v_add_u32 v254, v78, v77
  s_lshl_b32 s50, s28, 2
  s_add_u32 s50, s50, s40
  s_lshl_b32 s50, s50, 16
  s_lshl_b32 s51, s29, 12
  s_add_u32 s50, s50, s51
  s_lshl_b32 s51, s41, 10
  s_add_u32 s50, s50, s51
  v_lshlrev_b32 v1, 4, v0
  v_add_u32 v1, s50, v1
  v_lshlrev_b32 v76, 2, v5
  v_sub_u32 v76, v76, v4
  s_or_b32 s51, s28, s40
  s_cmp_eq_u32 s51, 0
  s_cselect_b32 s51, 0, -1
  v_add_u32 v77, -1, v76
  v_cmp_gt_u32 s[86:87], 8, v77
  v_add_u32 v77, 0, v76
  v_cmp_gt_u32 s[88:89], 8, v77
  v_add_u32 v77, 1, v76
  v_cmp_gt_u32 s[90:91], 8, v77
  v_add_u32 v77, 2, v76
  v_cmp_gt_u32 s[92:93], 8, v77
  v_add_u32 v77, 15, v76
  v_cmp_gt_u32 s[94:95], 8, v77
  v_add_u32 v77, 16, v76
  v_cmp_gt_u32 s[96:97], 8, v77
  v_add_u32 v77, 17, v76
  v_cmp_gt_u32 s[98:99], 8, v77
  v_add_u32 v77, 18, v76
  v_cmp_gt_u32 s[100:101], 8, v77
  s_and_b32 s86, s86, s51
  s_and_b32 s88, s88, s51
  s_and_b32 s90, s90, s51
  s_and_b32 s92, s92, s51
  s_waitcnt lgkmcnt(0)
  s_mov_b32 s82, s84
  s_mov_b32 s83, s85
  s_mov_b32 s12, s84
  s_mov_b32 s13, s85
  s_mov_b32 s14, 0
  s_mov_b32 s15, 0x20000
  s_mov_b32 s20, s66
  s_mov_b32 s21, s67
  s_mov_b32 s22, 6291456
  s_mov_b32 s23, 0x20000
  s_cmp_eq_u32 s4, 3
  s_cselect_b32 s20, s68, s20
  s_cselect_b32 s21, s69, s21
  s_cselect_b32 s22, 2097152, s22
  s_cselect_b32 s47, 0, s4
  s_lshl_b32 s47, s47, 8
  s_add_u32 s47, s47, s2
  s_lshl_b32 s47, s47, 13
  v_lshlrev_b32 v13, 7, v0
  s_barrier
  s_mov_b32 s51, s4
  s_cmp_lg_u32 s51, 0
  s_cbranch_scc1 C_wm0
  buffer_load_dword v15, v13, s[20:23], s47 offen
C_wm0:
C_top:
  s_nop 7
  s_nop 7
  s_mov_b32 s43, 0
  s_mov_b32 s39, 12
  s_barrier
  ds_read_b64_tr_b16 v[16:17], v8 offset:0
  ds_read_b64_tr_b16 v[18:19], v8 offset:512
  ds_read_b128 v[28:31], v9 offset:0
  ds_read_b64_tr_b16 v[20:21], v8 offset:8192
  ds_read_b64_tr_b16 v[22:23], v8 offset:8704
  ds_read_b64_tr_b16 v[24:25], v8 offset:16384
  ds_read_b64_tr_b16 v[26:27], v8 offset:16896
  ds_read_b128 v[32:35], v9 offset:2048
  ds_read_b128 v[36:39], v9 offset:4096
  ds_read_b128 v[40:43], v9 offset:6144
  ds_read_b128 v[44:47], v9 offset:8192
  ds_read_b128 v[48:51], v9 offset:10240
  ds_read_b128 v[52:55], v9 offset:12288
  ds_read_b128 v[56:59], v9 offset:14336
  ds_read_b128 v[60:63], v9 offset:16384
  s_add_u32 s40, s43, 43008
  s_cmp_eq_u32 s40, 129024
  s_cselect_b32 s40, 0, s40
  s_sub_u32 s42, s40, s43
  s_mov_b32 s43, s40
  s_waitcnt lgkmcnt(12)
  v_mfma_f32_16x16x32_bf16 v[112:115], v[16:19], v[28:31], v[112:115]
  ds_read_b64_tr_b16 v[64:65], v8 offset:4096
  s_waitcnt lgkmcnt(11)
  v_mfma_f32_16x16x32_bf16 v[148:151], v[20:23], v[28:31], v[148:151]
  ds_read_b64_tr_b16 v[66:67], v8 offset:4608
  s_waitcnt lgkmcnt(10)
  v_mfma_f32_16x16x32_bf16 v[184:187], v[24:27], v[28:31], v[184:187]
  ds_read_b128 v[76:79], v10 offset:0
  s_waitcnt lgkmcnt(10)
  v_mfma_f32_16x16x32_bf16 v[188:191], v[24:27], v[32:35], v[188:191]
  ds_read_b64_tr_b16 v[68:69], v8 offset:12288
  v_mfma_f32_16x16x32_bf16 v[152:155], v[20:23], v[32:35], v[152:155]
  ds_read_b64_tr_b16 v[70:71], v8 offset:12800
  v_mfma_f32_16x16x32_bf16 v[116:119], v[16:19], v[32:35], v[116:119]
  ds_read_b64_tr_b16 v[72:73], v8 offset:20480
  s_waitcnt lgkmcnt(12)
  v_mfma_f32_16x16x32_bf16 v[120:123], v[16:19], v[36:39], v[120:123]
  ds_read_b64_tr_b16 v[74:75], v8 offset:20992
  v_add_u32 v8, s42, v8
  v_mfma_f32_16x16x32_bf16 v[156:159], v[20:23], v[36:39], v[156:159]
  ds_read_b128 v[80:83], v10 offset:2048
  v_mfma_f32_16x16x32_bf16 v[192:195], v[24:27], v[36:39], v[192:195]
  ds_read_b128 v[84:87], v10 offset:4096
  s_waitcnt lgkmcnt(14)
  v_mfma_f32_16x16x32_bf16 v[196:199], v[24:27], v[40:43], v[196:199]
  ds_read_b128 v[88:91], v10 offset:6144
  v_mfma_f32_16x16x32_bf16 v[160:163], v[20:23], v[40:43], v[160:163]
  ds_read_b128 v[92:95], v10 offset:8192
  v_mfma_f32_16x16x32_bf16 v[124:127], v[16:19], v[40:43], v[124:127]
  ds_read_b128 v[96:99], v10 offset:10240
  s_waitcnt lgkmcnt(14)
  v_mfma_f32_16x16x32_bf16 v[128:131], v[16:19], v[44:47], v[128:131]
  ds_read_b128 v[100:103], v10 offset:12288
  v_mfma_f32_16x16x32_bf16 v[164:167], v[20:23], v[44:47], v[164:167]
  ds_read_b128 v[104:107], v10 offset:14336
  v_mfma_f32_16x16x32_bf16 v[200:203], v[24:27], v[44:47], v[200:203]
  ds_read_b128 v[108:111], v10 offset:16384
  v_add_u32 v9, s42, v9
  v_add_u32 v10, s42, v10
  v_mfma_f32_16x16x32_bf16 v[204:207], v[24:27], v[48:51], v[204:207]
  v_mfma_f32_16x16x32_bf16 v[168:171], v[20:23], v[48:51], v[168:171]
  v_mfma_f32_16x16x32_bf16 v[132:135], v[16:19], v[48:51], v[132:135]
  v_mfma_f32_16x16x32_bf16 v[136:139], v[16:19], v[52:55], v[136:139]
  v_mfma_f32_16x16x32_bf16 v[172:175], v[20:23], v[52:55], v[172:175]
  v_mfma_f32_16x16x32_bf16 v[208:211], v[24:27], v[52:55], v[208:211]
  s_waitcnt lgkmcnt(14)
  v_mfma_f32_16x16x32_bf16 v[212:215], v[24:27], v[56:59], v[212:215]
  v_mfma_f32_16x16x32_bf16 v[176:179], v[20:23], v[56:59], v[176:179]
  v_mfma_f32_16x16x32_bf16 v[140:143], v[16:19], v[56:59], v[140:143]
  v_mfma_f32_16x16x32_bf16 v[144:147], v[16:19], v[60:63], v[144:147]
  v_mfma_f32_16x16x32_bf16 v[180:183], v[20:23], v[60:63], v[180:183]
  v_mfma_f32_16x16x32_bf16 v[216:219], v[24:27], v[60:63], v[216:219]
  s_waitcnt lgkmcnt(0)
  s_barrier
  s_cmp_lg_u32 s51, 1
  s_cbranch_scc1 C_wm1
  buffer_load_dword v15, v13, s[20:23], s47 offen
C_wm1:
  v_mfma_f32_16x16x32_bf16 v[112:115], v[64:67], v[76:79], v[112:115]
  ds_read_b64_tr_b16 v[16:17], v8 offset:0
  s_add_u32 s40, s43, 43008
  v_mfma_f32_16x16x32_bf16 v[148:151], v[68:71], v[76:79], v[148:151]
  ds_read_b64_tr_b16 v[18:19], v8 offset:512
  s_cmp_eq_u32 s40, 129024
  v_mfma_f32_16x16x32_bf16 v[184:187], v[72:75], v[76:79], v[184:187]
  ds_read_b128 v[28:31], v9 offset:0
  s_cselect_b32 s40, 0, s40
  v_mfma_f32_16x16x32_bf16 v[188:191], v[72:75], v[80:83], v[188:191]
  ds_read_b64_tr_b16 v[20:21], v8 offset:8192
  s_sub_u32 s42, s40, s43
  v_mfma_f32_16x16x32_bf16 v[152:155], v[68:71], v[80:83], v[152:155]
  ds_read_b64_tr_b16 v[22:23], v8 offset:8704
  s_mov_b32 s43, s40
  v_mfma_f32_16x16x32_bf16 v[116:119], v[64:67], v[80:83], v[116:119]
  ds_read_b64_tr_b16 v[24:25], v8 offset:16384
  v_mfma_f32_16x16x32_bf16 v[120:123], v[64:67], v[84:87], v[120:123]
  ds_read_b64_tr_b16 v[26:27], v8 offset:16896
  v_mfma_f32_16x16x32_bf16 v[156:159], v[68:71], v[84:87], v[156:159]
  ds_read_b128 v[32:35], v9 offset:2048
  v_mfma_f32_16x16x32_bf16 v[192:195], v[72:75], v[84:87], v[192:195]
  ds_read_b128 v[36:39], v9 offset:4096
  v_mfma_f32_16x16x32_bf16 v[196:199], v[72:75], v[88:91], v[196:199]
  ds_read_b128 v[40:43], v9 offset:6144
  v_mfma_f32_16x16x32_bf16 v[160:163], v[68:71], v[88:91], v[160:163]
  ds_read_b128 v[44:47], v9 offset:8192
  v_mfma_f32_16x16x32_bf16 v[124:127], v[64:67], v[88:91], v[124:127]
  ds_read_b128 v[48:51], v9 offset:10240
  v_mfma_f32_16x16x32_bf16 v[128:131], v[64:67], v[92:95], v[128:131]
  ds_read_b128 v[52:55], v9 offset:12288
  v_mfma_f32_16x16x32_bf16 v[164:167], v[68:71], v[92:95], v[164:167]
  ds_read_b128 v[56:59], v9 offset:14336
  v_mfma_f32_16x16x32_bf16 v[200:203], v[72:75], v[92:95], v[200:203]
  ds_read_b128 v[60:63], v9 offset:16384
  v_mfma_f32_16x16x32_bf16 v[204:207], v[72:75], v[96:99], v[204:207]
  v_mfma_f32_16x16x32_bf16 v[168:171], v[68:71], v[96:99], v[168:171]
  v_mfma_f32_16x16x32_bf16 v[132:135], v[64:67], v[96:99], v[132:135]
  v_mfma_f32_16x16x32_bf16 v[136:139], v[64:67], v[100:103], v[136:139]
  v_mfma_f32_16x16x32_bf16 v[172:175], v[68:71], v[100:103], v[172:175]
  v_mfma_f32_16x16x32_bf16 v[208:211], v[72:75], v[100:103], v[208:211]
  v_mfma_f32_16x16x32_bf16 v[212:215], v[72:75], v[104:107], v[212:215]
  v_mfma_f32_16x16x32_bf16 v[176:179], v[68:71], v[104:107], v[176:179]
  v_mfma_f32_16x16x32_bf16 v[140:143], v[64:67], v[104:107], v[140:143]
  v_mfma_f32_16x16x32_bf16 v[144:147], v[64:67], v[108:111], v[144:147]
  v_mfma_f32_16x16x32_bf16 v[180:183], v[68:71], v[108:111], v[180:183]
  v_mfma_f32_16x16x32_bf16 v[216:219], v[72:75], v[108:111], v[216:219]
  s_waitcnt lgkmcnt(12)
  v_mfma_f32_16x16x32_bf16 v[112:115], v[16:19], v[28:31], v[112:115]
  ds_read_b64_tr_b16 v[64:65], v8 offset:4096
  s_waitcnt lgkmcnt(11)
  v_mfma_f32_16x16x32_bf16 v[148:151], v[20:23], v[28:31], v[148:151]
  ds_read_b64_tr_b16 v[66:67], v8 offset:4608
  s_waitcnt lgkmcnt(10)
  v_mfma_f32_16x16x32_bf16 v[184:187], v[24:27], v[28:31], v[184:187]
  ds_read_b128 v[76:79], v10 offset:0
  s_waitcnt lgkmcnt(10)
  v_mfma_f32_16x16x32_bf16 v[188:191], v[24:27], v[32:35], v[188:191]
  ds_read_b64_tr_b16 v[68:69], v8 offset:12288
  v_mfma_f32_16x16x32_bf16 v[152:155], v[20:23], v[32:35], v[152:155]
  ds_read_b64_tr_b16 v[70:71], v8 offset:12800
  v_mfma_f32_16x16x32_bf16 v[116:119], v[16:19], v[32:35], v[116:119]
  ds_read_b64_tr_b16 v[72:73], v8 offset:20480
  s_waitcnt lgkmcnt(12)
  v_mfma_f32_16x16x32_bf16 v[120:123], v[16:19], v[36:39], v[120:123]
  ds_read_b64_tr_b16 v[74:75], v8 offset:20992
  v_add_u32 v8, s42, v8
  v_mfma_f32_16x16x32_bf16 v[156:159], v[20:23], v[36:39], v[156:159]
  ds_read_b128 v[80:83], v10 offset:2048
  v_mfma_f32_16x16x32_bf16 v[192:195], v[24:27], v[36:39], v[192:195]
  ds_read_b128 v[84:87], v10 offset:4096
  s_waitcnt lgkmcnt(14)
  v_mfma_f32_16x16x32_bf16 v[196:199], v[24:27], v[40:43], v[196:199]
  ds_read_b128 v[88:91], v10 offset:6144
  v_mfma_f32_16x16x32_bf16 v[160:163], v[20:23], v[40:43], v[160:163]
  ds_read_b128 v[92:95], v10 offset:8192
  v_mfma_f32_16x16x32_bf16 v[124:127], v[16:19], v[40:43], v[124:127]
  ds_read_b128 v[96:99], v10 offset:10240
  s_waitcnt lgkmcnt(14)
  v_mfma_f32_16x16x32_bf16 v[128:131], v[16:19], v[44:47], v[128:131]
  ds_read_b128 v[100:103], v10 offset:12288
  v_mfma_f32_16x16x32_bf16 v[164:167], v[20:23], v[44:47], v[164:167]
  ds_read_b128 v[104:107], v10 offset:14336
  v_mfma_f32_16x16x32_bf16 v[200:203], v[24:27], v[44:47], v[200:203]
  ds_read_b128 v[108:111], v10 offset:16384
  v_add_u32 v9, s42, v9
  v_add_u32 v10, s42, v10
  v_mfma_f32_16x16x32_bf16 v[204:207], v[24:27], v[48:51], v[204:207]
  v_mfma_f32_16x16x32_bf16 v[168:171], v[20:23], v[48:51], v[168:171]
  v_mfma_f32_16x16x32_bf16 v[132:135], v[16:19], v[48:51], v[132:135]
  v_mfma_f32_16x16x32_bf16 v[136:139], v[16:19], v[52:55], v[136:139]
  v_mfma_f32_16x16x32_bf16 v[172:175], v[20:23], v[52:55], v[172:175]
  v_mfma_f32_16x16x32_bf16 v[208:211], v[24:27], v[52:55], v[208:211]
  s_waitcnt lgkmcnt(14)
  v_mfma_f32_16x16x32_bf16 v[212:215], v[24:27], v[56:59], v[212:215]
  v_mfma_f32_16x16x32_bf16 v[176:179], v[20:23], v[56:59], v[176:179]
  v_mfma_f32_16x16x32_bf16 v[140:143], v[16:19], v[56:59], v[140:143]
  v_mfma_f32_16x16x32_bf16 v[144:147], v[16:19], v[60:63], v[144:147]
  v_mfma_f32_16x16x32_bf16 v[180:183], v[20:23], v[60:63], v[180:183]
  v_mfma_f32_16x16x32_bf16 v[216:219], v[24:27], v[60:63], v[216:219]
  s_waitcnt lgkmcnt(0)
  s_barrier
  s_cmp_lg_u32 s51, 2
  s_cbranch_scc1 C_wm2
  buffer_load_dword v15, v13, s[20:23], s47 offen
C_wm2:
  v_mfma_f32_16x16x32_bf16 v[112:115], v[64:67], v[76:79], v[112:115]
  ds_read_b64_tr_b16 v[16:17], v8 offset:0
  s_add_u32 s40, s43, 43008
  v_mfma_f32_16x16x32_bf16 v[148:151], v[68:71], v[76:79], v[148:151]
  ds_read_b64_tr_b16 v[18:19], v8 offset:512
  s_cmp_eq_u32 s40, 129024
  v_mfma_f32_16x16x32_bf16 v[184:187], v[72:75], v[76:79], v[184:187]
  ds_read_b128 v[28:31], v9 offset:0
  s_cselect_b32 s40, 0, s40
  v_mfma_f32_16x16x32_bf16 v[188:191], v[72:75], v[80:83], v[188:191]
  ds_read_b64_tr_b16 v[20:21], v8 offset:8192
  s_sub_u32 s42, s40, s43
  v_mfma_f32_16x16x32_bf16 v[152:155], v[68:71], v[80:83], v[152:155]
  ds_read_b64_tr_b16 v[22:23], v8 offset:8704
  s_mov_b32 s43, s40
  v_mfma_f32_16x16x32_bf16 v[116:119], v[64:67], v[80:83], v[116:119]
  ds_read_b64_tr_b16 v[24:25], v8 offset:16384
  v_mfma_f32_16x16x32_bf16 v[120:123], v[64:67], v[84:87], v[120:123]
  ds_read_b64_tr_b16 v[26:27], v8 offset:16896
  v_mfma_f32_16x16x32_bf16 v[156:159], v[68:71], v[84:87], v[156:159]
  ds_read_b128 v[32:35], v9 offset:2048
  v_mfma_f32_16x16x32_bf16 v[192:195], v[72:75], v[84:87], v[192:195]
  ds_read_b128 v[36:39], v9 offset:4096
  v_mfma_f32_16x16x32_bf16 v[196:199], v[72:75], v[88:91], v[196:199]
  ds_read_b128 v[40:43], v9 offset:6144
  v_mfma_f32_16x16x32_bf16 v[160:163], v[68:71], v[88:91], v[160:163]
  ds_read_b128 v[44:47], v9 offset:8192
  v_mfma_f32_16x16x32_bf16 v[124:127], v[64:67], v[88:91], v[124:127]
  ds_read_b128 v[48:51], v9 offset:10240
  v_mfma_f32_16x16x32_bf16 v[128:131], v[64:67], v[92:95], v[128:131]
  ds_read_b128 v[52:55], v9 offset:12288
  v_mfma_f32_16x16x32_bf16 v[164:167], v[68:71], v[92:95], v[164:167]
  ds_read_b128 v[56:59], v9 offset:14336
  v_mfma_f32_16x16x32_bf16 v[200:203], v[72:75], v[92:95], v[200:203]
  ds_read_b128 v[60:63], v9 offset:16384
  v_mfma_f32_16x16x32_bf16 v[204:207], v[72:75], v[96:99], v[204:207]
  v_mfma_f32_16x16x32_bf16 v[168:171], v[68:71], v[96:99], v[168:171]
  v_mfma_f32_16x16x32_bf16 v[132:135], v[64:67], v[96:99], v[132:135]
  v_mfma_f32_16x16x32_bf16 v[136:139], v[64:67], v[100:103], v[136:139]
  v_mfma_f32_16x16x32_bf16 v[172:175], v[68:71], v[100:103], v[172:175]
  v_mfma_f32_16x16x32_bf16 v[208:211], v[72:75], v[100:103], v[208:211]
  v_mfma_f32_16x16x32_bf16 v[212:215], v[72:75], v[104:107], v[212:215]
  v_mfma_f32_16x16x32_bf16 v[176:179], v[68:71], v[104:107], v[176:179]
  v_mfma_f32_16x16x32_bf16 v[140:143], v[64:67], v[104:107], v[140:143]
  v_mfma_f32_16x16x32_bf16 v[144:147], v[64:67], v[108:111], v[144:147]
  v_mfma_f32_16x16x32_bf16 v[180:183], v[68:71], v[108:111], v[180:183]
  v_mfma_f32_16x16x32_bf16 v[216:219], v[72:75], v[108:111], v[216:219]
  s_waitcnt lgkmcnt(12)
  v_mfma_f32_16x16x32_bf16 v[112:115], v[16:19], v[28:31], v[112:115]
  ds_read_b64_tr_b16 v[64:65], v8 offset:4096
  s_waitcnt lgkmcnt(11)
  v_mfma_f32_16x16x32_bf16 v[148:151], v[20:23], v[28:31], v[148:151]
  ds_read_b64_tr_b16 v[66:67], v8 offset:4608
  s_waitcnt lgkmcnt(10)
  v_mfma_f32_16x16x32_bf16 v[184:187], v[24:27], v[28:31], v[184:187]
  ds_read_b128 v[76:79], v10 offset:0
  s_waitcnt lgkmcnt(10)
  v_mfma_f32_16x16x32_bf16 v[188:191], v[24:27], v[32:35], v[188:191]
  ds_read_b64_tr_b16 v[68:69], v8 offset:12288
  v_mfma_f32_16x16x32_bf16 v[152:155], v[20:23], v[32:35], v[152:155]
  ds_read_b64_tr_b16 v[70:71], v8 offset:12800
  v_mfma_f32_16x16x32_bf16 v[116:119], v[16:19], v[32:35], v[116:119]
  ds_read_b64_tr_b16 v[72:73], v8 offset:20480
  s_waitcnt lgkmcnt(12)
  v_mfma_f32_16x16x32_bf16 v[120:123], v[16:19], v[36:39], v[120:123]
  ds_read_b64_tr_b16 v[74:75], v8 offset:20992
  v_add_u32 v8, s42, v8
  v_mfma_f32_16x16x32_bf16 v[156:159], v[20:23], v[36:39], v[156:159]
  ds_read_b128 v[80:83], v10 offset:2048
  v_mfma_f32_16x16x32_bf16 v[192:195], v[24:27], v[36:39], v[192:195]
  ds_read_b128 v[84:87], v10 offset:4096
  s_waitcnt lgkmcnt(14)
  v_mfma_f32_16x16x32_bf16 v[196:199], v[24:27], v[40:43], v[196:199]
  ds_read_b128 v[88:91], v10 offset:6144
  v_mfma_f32_16x16x32_bf16 v[160:163], v[20:23], v[40:43], v[160:163]
  ds_read_b128 v[92:95], v10 offset:8192
  v_mfma_f32_16x16x32_bf16 v[124:127], v[16:19], v[40:43], v[124:127]
  ds_read_b128 v[96:99], v10 offset:10240
  s_waitcnt lgkmcnt(14)
  v_mfma_f32_16x16x32_bf16 v[128:131], v[16:19], v[44:47], v[128:131]
  ds_read_b128 v[100:103], v10 offset:12288
  v_mfma_f32_16x16x32_bf16 v[164:167], v[20:23], v[44:47], v[164:167]
  ds_read_b128 v[104:107], v10 offset:14336
  v_mfma_f32_16x16x32_bf16 v[200:203], v[24:27], v[44:47], v[200:203]
  ds_read_b128 v[108:111], v10 offset:16384
  v_add_u32 v9, s42, v9
  v_add_u32 v10, s42, v10
  v_mfma_f32_16x16x32_bf16 v[204:207], v[24:27], v[48:51], v[204:207]
  v_mfma_f32_16x16x32_bf16 v[168:171], v[20:23], v[48:51], v[168:171]
  v_mfma_f32_16x16x32_bf16 v[132:135], v[16:19], v[48:51], v[132:135]
  v_mfma_f32_16x16x32_bf16 v[136:139], v[16:19], v[52:55], v[136:139]
  v_mfma_f32_16x16x32_bf16 v[172:175], v[20:23], v[52:55], v[172:175]
  v_mfma_f32_16x16x32_bf16 v[208:211], v[24:27], v[52:55], v[208:211]
  s_waitcnt lgkmcnt(14)
  v_mfma_f32_16x16x32_bf16 v[212:215], v[24:27], v[56:59], v[212:215]
  v_mfma_f32_16x16x32_bf16 v[176:179], v[20:23], v[56:59], v[176:179]
  v_mfma_f32_16x16x32_bf16 v[140:143], v[16:19], v[56:59], v[140:143]
  v_mfma_f32_16x16x32_bf16 v[144:147], v[16:19], v[60:63], v[144:147]
  v_mfma_f32_16x16x32_bf16 v[180:183], v[20:23], v[60:63], v[180:183]
  v_mfma_f32_16x16x32_bf16 v[216:219], v[24:27], v[60:63], v[216:219]
  s_waitcnt lgkmcnt(0)
  s_barrier
  s_cmp_lg_u32 s51, 3
  s_cbranch_scc1 C_wm3
  buffer_load_dword v15, v13, s[20:23], s47 offen
C_wm3:
  v_mfma_f32_16x16x32_bf16 v[112:115], v[64:67], v[76:79], v[112:115]
  ds_read_b64_tr_b16 v[16:17], v8 offset:0
  s_add_u32 s40, s43, 43008
  v_mfma_f32_16x16x32_bf16 v[148:151], v[68:71], v[76:79], v[148:151]
  ds_read_b64_tr_b16 v[18:19], v8 offset:512
  s_cmp_eq_u32 s40, 129024
  v_mfma_f32_16x16x32_bf16 v[184:187], v[72:75], v[76:79], v[184:187]
  ds_read_b128 v[28:31], v9 offset:0
  s_cselect_b32 s40, 0, s40
  v_mfma_f32_16x16x32_bf16 v[188:191], v[72:75], v[80:83], v[188:191]
  ds_read_b64_tr_b16 v[20:21], v8 offset:8192
  s_sub_u32 s42, s40, s43
  v_mfma_f32_16x16x32_bf16 v[152:155], v[68:71], v[80:83], v[152:155]
  ds_read_b64_tr_b16 v[22:23], v8 offset:8704
  s_mov_b32 s43, s40
  v_mfma_f32_16x16x32_bf16 v[116:119], v[64:67], v[80:83], v[116:119]
  ds_read_b64_tr_b16 v[24:25], v8 offset:16384
  v_mfma_f32_16x16x32_bf16 v[120:123], v[64:67], v[84:87], v[120:123]
  ds_read_b64_tr_b16 v[26:27], v8 offset:16896
  v_mfma_f32_16x16x32_bf16 v[156:159], v[68:71], v[84:87], v[156:159]
  ds_read_b128 v[32:35], v9 offset:2048
  v_mfma_f32_16x16x32_bf16 v[192:195], v[72:75], v[84:87], v[192:195]
  ds_read_b128 v[36:39], v9 offset:4096
  v_mfma_f32_16x16x32_bf16 v[196:199], v[72:75], v[88:91], v[196:199]
  ds_read_b128 v[40:43], v9 offset:6144
  v_mfma_f32_16x16x32_bf16 v[160:163], v[68:71], v[88:91], v[160:163]
  ds_read_b128 v[44:47], v9 offset:8192
  v_mfma_f32_16x16x32_bf16 v[124:127], v[64:67], v[88:91], v[124:127]
  ds_read_b128 v[48:51], v9 offset:10240
  v_mfma_f32_16x16x32_bf16 v[128:131], v[64:67], v[92:95], v[128:131]
  ds_read_b128 v[52:55], v9 offset:12288
  v_mfma_f32_16x16x32_bf16 v[164:167], v[68:71], v[92:95], v[164:167]
  ds_read_b128 v[56:59], v9 offset:14336
  v_mfma_f32_16x16x32_bf16 v[200:203], v[72:75], v[92:95], v[200:203]
  ds_read_b128 v[60:63], v9 offset:16384
  v_mfma_f32_16x16x32_bf16 v[204:207], v[72:75], v[96:99], v[204:207]
  v_mfma_f32_16x16x32_bf16 v[168:171], v[68:71], v[96:99], v[168:171]
  v_mfma_f32_16x16x32_bf16 v[132:135], v[64:67], v[96:99], v[132:135]
  v_mfma_f32_16x16x32_bf16 v[136:139], v[64:67], v[100:103], v[136:139]
  v_mfma_f32_16x16x32_bf16 v[172:175], v[68:71], v[100:103], v[172:175]
  v_mfma_f32_16x16x32_bf16 v[208:211], v[72:75], v[100:103], v[208:211]
  v_mfma_f32_16x16x32_bf16 v[212:215], v[72:75], v[104:107], v[212:215]
  v_mfma_f32_16x16x32_bf16 v[176:179], v[68:71], v[104:107], v[176:179]
  v_mfma_f32_16x16x32_bf16 v[140:143], v[64:67], v[104:107], v[140:143]
  v_mfma_f32_16x16x32_bf16 v[144:147], v[64:67], v[108:111], v[144:147]
  v_mfma_f32_16x16x32_bf16 v[180:183], v[68:71], v[108:111], v[180:183]
  v_mfma_f32_16x16x32_bf16 v[216:219], v[72:75], v[108:111], v[216:219]
cl1:
  s_waitcnt lgkmcnt(12)
  v_mfma_f32_16x16x32_bf16 v[112:115], v[16:19], v[28:31], v[112:115]
  ds_read_b64_tr_b16 v[64:65], v8 offset:4096
  s_waitcnt lgkmcnt(11)
  v_mfma_f32_16x16x32_bf16 v[148:151], v[20:23], v[28:31], v[148:151]
  ds_read_b64_tr_b16 v[66:67], v8 offset:4608
  s_waitcnt lgkmcnt(10)
  v_mfma_f32_16x16x32_bf16 v[184:187], v[24:27], v[28:31], v[184:187]
  ds_read_b128 v[76:79], v10 offset:0
  s_waitcnt lgkmcnt(10)
  v_mfma_f32_16x16x32_bf16 v[188:191], v[24:27], v[32:35], v[188:191]
  ds_read_b64_tr_b16 v[68:69], v8 offset:12288
  v_mfma_f32_16x16x32_bf16 v[152:155], v[20:23], v[32:35], v[152:155]
  ds_read_b64_tr_b16 v[70:71], v8 offset:12800
  v_mfma_f32_16x16x32_bf16 v[116:119], v[16:19], v[32:35], v[116:119]
  ds_read_b64_tr_b16 v[72:73], v8 offset:20480
  s_waitcnt lgkmcnt(12)
  v_mfma_f32_16x16x32_bf16 v[120:123], v[16:19], v[36:39], v[120:123]
  ds_read_b64_tr_b16 v[74:75], v8 offset:20992
  v_add_u32 v8, s42, v8
  v_mfma_f32_16x16x32_bf16 v[156:159], v[20:23], v[36:39], v[156:159]
  ds_read_b128 v[80:83], v10 offset:2048
  v_mfma_f32_16x16x32_bf16 v[192:195], v[24:27], v[36:39], v[192:195]
  ds_read_b128 v[84:87], v10 offset:4096
  s_waitcnt lgkmcnt(14)
  v_mfma_f32_16x16x32_bf16 v[196:199], v[24:27], v[40:43], v[196:199]
  ds_read_b128 v[88:91], v10 offset:6144
  v_mfma_f32_16x16x32_bf16 v[160:163], v[20:23], v[40:43], v[160:163]
  ds_read_b128 v[92:95], v10 offset:8192
  v_mfma_f32_16x16x32_bf16 v[124:127], v[16:19], v[40:43], v[124:127]
  ds_read_b128 v[96:99], v10 offset:10240
  s_waitcnt lgkmcnt(14)
  v_mfma_f32_16x16x32_bf16 v[128:131], v[16:19], v[44:47], v[128:131]
  ds_read_b128 v[100:103], v10 offset:12288
  v_mfma_f32_16x16x32_bf16 v[164:167], v[20:23], v[44:47], v[164:167]
  ds_read_b128 v[104:107], v10 offset:14336
  v_mfma_f32_16x16x32_bf16 v[200:203], v[24:27], v[44:47], v[200:203]
  ds_read_b128 v[108:111], v10 offset:16384
  v_add_u32 v9, s42, v9
  v_add_u32 v10, s42, v10
  v_mfma_f32_16x16x32_bf16 v[204:207], v[24:27], v[48:51], v[204:207]
  v_mfma_f32_16x16x32_bf16 v[168:171], v[20:23], v[48:51], v[168:171]
  v_mfma_f32_16x16x32_bf16 v[132:135], v[16:19], v[48:51], v[132:135]
  v_mfma_f32_16x16x32_bf16 v[136:139], v[16:19], v[52:55], v[136:139]
  v_mfma_f32_16x16x32_bf16 v[172:175], v[20:23], v[52:55], v[172:175]
  v_mfma_f32_16x16x32_bf16 v[208:211], v[24:27], v[52:55], v[208:211]
  s_waitcnt lgkmcnt(14)
  v_mfma_f32_16x16x32_bf16 v[212:215], v[24:27], v[56:59], v[212:215]
  v_mfma_f32_16x16x32_bf16 v[176:179], v[20:23], v[56:59], v[176:179]
  v_mfma_f32_16x16x32_bf16 v[140:143], v[16:19], v[56:59], v[140:143]
  v_mfma_f32_16x16x32_bf16 v[144:147], v[16:19], v[60:63], v[144:147]
  v_mfma_f32_16x16x32_bf16 v[180:183], v[20:23], v[60:63], v[180:183]
  v_mfma_f32_16x16x32_bf16 v[216:219], v[24:27], v[60:63], v[216:219]
  s_waitcnt lgkmcnt(0)
  s_barrier
  v_mfma_f32_16x16x32_bf16 v[112:115], v[64:67], v[76:79], v[112:115]
  ds_read_b64_tr_b16 v[16:17], v8 offset:0
  s_add_u32 s40, s43, 43008
  v_mfma_f32_16x16x32_bf16 v[148:151], v[68:71], v[76:79], v[148:151]
  ds_read_b64_tr_b16 v[18:19], v8 offset:512
  s_cmp_eq_u32 s40, 129024
  v_mfma_f32_16x16x32_bf16 v[184:187], v[72:75], v[76:79], v[184:187]
  ds_read_b128 v[28:31], v9 offset:0
  s_cselect_b32 s40, 0, s40
  v_mfma_f32_16x16x32_bf16 v[188:191], v[72:75], v[80:83], v[188:191]
  ds_read_b64_tr_b16 v[20:21], v8 offset:8192
  s_sub_u32 s42, s40, s43
  v_mfma_f32_16x16x32_bf16 v[152:155], v[68:71], v[80:83], v[152:155]
  ds_read_b64_tr_b16 v[22:23], v8 offset:8704
  s_mov_b32 s43, s40
  v_mfma_f32_16x16x32_bf16 v[116:119], v[64:67], v[80:83], v[116:119]
  ds_read_b64_tr_b16 v[24:25], v8 offset:16384
  v_mfma_f32_16x16x32_bf16 v[120:123], v[64:67], v[84:87], v[120:123]
  ds_read_b64_tr_b16 v[26:27], v8 offset:16896
  v_mfma_f32_16x16x32_bf16 v[156:159], v[68:71], v[84:87], v[156:159]
  ds_read_b128 v[32:35], v9 offset:2048
  v_mfma_f32_16x16x32_bf16 v[192:195], v[72:75], v[84:87], v[192:195]
  ds_read_b128 v[36:39], v9 offset:4096
  v_mfma_f32_16x16x32_bf16 v[196:199], v[72:75], v[88:91], v[196:199]
  ds_read_b128 v[40:43], v9 offset:6144
  v_mfma_f32_16x16x32_bf16 v[160:163], v[68:71], v[88:91], v[160:163]
  ds_read_b128 v[44:47], v9 offset:8192
  v_mfma_f32_16x16x32_bf16 v[124:127], v[64:67], v[88:91], v[124:127]
  ds_read_b128 v[48:51], v9 offset:10240
  v_mfma_f32_16x16x32_bf16 v[128:131], v[64:67], v[92:95], v[128:131]
  ds_read_b128 v[52:55], v9 offset:12288
  v_mfma_f32_16x16x32_bf16 v[164:167], v[68:71], v[92:95], v[164:167]
  ds_read_b128 v[56:59], v9 offset:14336
  v_mfma_f32_16x16x32_bf16 v[200:203], v[72:75], v[92:95], v[200:203]
  ds_read_b128 v[60:63], v9 offset:16384
  v_mfma_f32_16x16x32_bf16 v[204:207], v[72:75], v[96:99], v[204:207]
  v_mfma_f32_16x16x32_bf16 v[168:171], v[68:71], v[96:99], v[168:171]
  v_mfma_f32_16x16x32_bf16 v[132:135], v[64:67], v[96:99], v[132:135]
  v_mfma_f32_16x16x32_bf16 v[136:139], v[64:67], v[100:103], v[136:139]
  v_mfma_f32_16x16x32_bf16 v[172:175], v[68:71], v[100:103], v[172:175]
  v_mfma_f32_16x16x32_bf16 v[208:211], v[72:75], v[100:103], v[208:211]
  v_mfma_f32_16x16x32_bf16 v[212:215], v[72:75], v[104:107], v[212:215]
  v_mfma_f32_16x16x32_bf16 v[176:179], v[68:71], v[104:107], v[176:179]
  v_mfma_f32_16x16x32_bf16 v[140:143], v[64:67], v[104:107], v[140:143]
  v_mfma_f32_16x16x32_bf16 v[144:147], v[64:67], v[108:111], v[144:147]
  v_mfma_f32_16x16x32_bf16 v[180:183], v[68:71], v[108:111], v[180:183]
  v_mfma_f32_16x16x32_bf16 v[216:219], v[72:75], v[108:111], v[216:219]
  s_sub_u32 s39, s39, 1
  s_cmp_lg_u32 s39, 0
  s_cbranch_scc1 cl1
  s_waitcnt lgkmcnt(12)
  v_mfma_f32_16x16x32_bf16 v[112:115], v[16:19], v[28:31], v[112:115]
  ds_read_b64_tr_b16 v[64:65], v8 offset:4096
  s_waitcnt lgkmcnt(11)
  v_mfma_f32_16x16x32_bf16 v[148:151], v[20:23], v[28:31], v[148:151]
  ds_read_b64_tr_b16 v[66:67], v8 offset:4608
  s_waitcnt lgkmcnt(10)
  v_mfma_f32_16x16x32_bf16 v[184:187], v[24:27], v[28:31], v[184:187]
  ds_read_b128 v[76:79], v10 offset:0
  s_waitcnt lgkmcnt(10)
  v_mfma_f32_16x16x32_bf16 v[188:191], v[24:27], v[32:35], v[188:191]
  ds_read_b64_tr_b16 v[68:69], v8 offset:12288
  v_mfma_f32_16x16x32_bf16 v[152:155], v[20:23], v[32:35], v[152:155]
  ds_read_b64_tr_b16 v[70:71], v8 offset:12800
  v_mfma_f32_16x16x32_bf16 v[116:119], v[16:19], v[32:35], v[116:119]
  ds_read_b64_tr_b16 v[72:73], v8 offset:20480
  s_waitcnt lgkmcnt(12)
  v_mfma_f32_16x16x32_bf16 v[120:123], v[16:19], v[36:39], v[120:123]
  ds_read_b64_tr_b16 v[74:75], v8 offset:20992
  v_mfma_f32_16x16x32_bf16 v[156:159], v[20:23], v[36:39], v[156:159]
  ds_read_b128 v[80:83], v10 offset:2048
  v_mfma_f32_16x16x32_bf16 v[192:195], v[24:27], v[36:39], v[192:195]
  ds_read_b128 v[84:87], v10 offset:4096
  s_waitcnt lgkmcnt(14)
  v_mfma_f32_16x16x32_bf16 v[196:199], v[24:27], v[40:43], v[196:199]
  ds_read_b128 v[88:91], v10 offset:6144
  v_mfma_f32_16x16x32_bf16 v[160:163], v[20:23], v[40:43], v[160:163]
  ds_read_b128 v[92:95], v10 offset:8192
  v_mfma_f32_16x16x32_bf16 v[124:127], v[16:19], v[40:43], v[124:127]
  ds_read_b128 v[96:99], v10 offset:10240
  s_waitcnt lgkmcnt(14)
  v_mfma_f32_16x16x32_bf16 v[128:131], v[16:19], v[44:47], v[128:131]
  ds_read_b128 v[100:103], v10 offset:12288
  v_mfma_f32_16x16x32_bf16 v[164:167], v[20:23], v[44:47], v[164:167]
  ds_read_b128 v[104:107], v10 offset:14336
  v_mfma_f32_16x16x32_bf16 v[200:203], v[24:27], v[44:47], v[200:203]
  ds_read_b128 v[108:111], v10 offset:16384
  v_mfma_f32_16x16x32_bf16 v[204:207], v[24:27], v[48:51], v[204:207]
  ds_read_b64 v[224:225], v12 offset:0
  v_mfma_f32_16x16x32_bf16 v[168:171], v[20:23], v[48:51], v[168:171]
  ds_read_b64 v[226:227], v12 offset:128
  v_mfma_f32_16x16x32_bf16 v[132:135], v[16:19], v[48:51], v[132:135]
  ds_read_b64 v[228:229], v12 offset:256
  v_mfma_f32_16x16x32_bf16 v[136:139], v[16:19], v[52:55], v[136:139]
  ds_read_b64 v[230:231], v12 offset:384
  v_mfma_f32_16x16x32_bf16 v[172:175], v[20:23], v[52:55], v[172:175]
  ds_read_b64 v[232:233], v12 offset:512
  v_mfma_f32_16x16x32_bf16 v[208:211], v[24:27], v[52:55], v[208:211]
  ds_read_b64 v[234:235], v12 offset:640
  s_waitcnt lgkmcnt(14)
  v_mfma_f32_16x16x32_bf16 v[212:215], v[24:27], v[56:59], v[212:215]
  ds_read_b64 v[236:237], v12 offset:768
  v_mfma_f32_16x16x32_bf16 v[176:179], v[20:23], v[56:59], v[176:179]
  ds_read_b64 v[238:239], v12 offset:896
  v_mfma_f32_16x16x32_bf16 v[140:143], v[16:19], v[56:59], v[140:143]
  ds_read_b64 v[240:241], v12 offset:1024
  v_mfma_f32_16x16x32_bf16 v[144:147], v[16:19], v[60:63], v[144:147]
  v_mfma_f32_16x16x32_bf16 v[180:183], v[20:23], v[60:63], v[180:183]
  v_mfma_f32_16x16x32_bf16 v[216:219], v[24:27], v[60:63], v[216:219]
  s_waitcnt lgkmcnt(0)
  v_mfma_f32_16x16x32_bf16 v[112:115], v[64:67], v[76:79], v[112:115]
  v_mfma_f32_16x16x32_bf16 v[148:151], v[68:71], v[76:79], v[148:151]
  v_mfma_f32_16x16x32_bf16 v[184:187], v[72:75], v[76:79], v[184:187]
  v_mfma_f32_16x16x32_bf16 v[188:191], v[72:75], v[80:83], v[188:191]
  s_nop 4
  v_mov_b32_dpp v242, v112 row_newbcast:0 row_mask:0xf bank_mask:0xf
  v_mov_b32_dpp v243, v113 row_newbcast:0 row_mask:0xf bank_mask:0xf
  v_mov_b32_dpp v244, v114 row_newbcast:0 row_mask:0xf bank_mask:0xf
  v_mov_b32_dpp v245, v115 row_newbcast:0 row_mask:0xf bank_mask:0xf
  v_mov_b32_dpp v246, v148 row_newbcast:0 row_mask:0xf bank_mask:0xf
  v_mov_b32_dpp v247, v149 row_newbcast:0 row_mask:0xf bank_mask:0xf
  v_mov_b32_dpp v248, v150 row_newbcast:0 row_mask:0xf bank_mask:0xf
  v_mfma_f32_16x16x32_bf16 v[152:155], v[68:71], v[80:83], v[152:155]
  v_mov_b32_dpp v249, v151 row_newbcast:0 row_mask:0xf bank_mask:0xf
  v_mov_b32_dpp v250, v184 row_newbcast:0 row_mask:0xf bank_mask:0xf
  v_mov_b32_dpp v251, v185 row_newbcast:0 row_mask:0xf bank_mask:0xf
  v_mov_b32_dpp v252, v186 row_newbcast:0 row_mask:0xf bank_mask:0xf
  v_mov_b32_dpp v253, v187 row_newbcast:0 row_mask:0xf bank_mask:0xf
  v_pk_fma_f32 v[148:149], v[246:247], v[224:225], v[148:149] op_sel_hi:[1,0,1] neg_lo:[0,1,0] neg_hi:[0,1,0]
  v_pk_fma_f32 v[150:151], v[248:249], v[224:225], v[150:151] op_sel_hi:[1,0,1] neg_lo:[0,1,0] neg_hi:[0,1,0]
  v_mfma_f32_16x16x32_bf16 v[116:119], v[64:67], v[80:83], v[116:119]
  v_pk_fma_f32 v[184:185], v[250:251], v[224:225], v[184:185] op_sel_hi:[1,0,1] neg_lo:[0,1,0] neg_hi:[0,1,0]
  v_pk_fma_f32 v[186:187], v[252:253], v[224:225], v[186:187] op_sel_hi:[1,0,1] neg_lo:[0,1,0] neg_hi:[0,1,0]
  v_pk_mul_f32 v[148:149], v[148:149], v[224:225] op_sel:[0,1] op_sel_hi:[1,1]
  v_pk_mul_f32 v[150:151], v[150:151], v[224:225] op_sel:[0,1] op_sel_hi:[1,1]
  v_pk_mul_f32 v[184:185], v[184:185], v[224:225] op_sel:[0,1] op_sel_hi:[1,1]
  v_pk_mul_f32 v[186:187], v[186:187], v[224:225] op_sel:[0,1] op_sel_hi:[1,1]
  v_cvt_pk_bf16_f32 v16, v148, v149
  v_mfma_f32_16x16x32_bf16 v[120:123], v[64:67], v[84:87], v[120:123]
  v_cvt_pk_bf16_f32 v17, v150, v151
  ds_write_b64 v11, v[16:17] offset:128
  v_cvt_pk_bf16_f32 v18, v184, v185
  v_cvt_pk_bf16_f32 v19, v186, v187
  ds_write_b64 v11, v[18:19] offset:256
  v_pk_fma_f32 v[116:117], v[242:243], v[226:227], v[116:117] op_sel_hi:[1,0,1] neg_lo:[0,1,0] neg_hi:[0,1,0]
  v_pk_fma_f32 v[118:119], v[244:245], v[226:227], v[118:119] op_sel_hi:[1,0,1] neg_lo:[0,1,0] neg_hi:[0,1,0]
  v_mfma_f32_16x16x32_bf16 v[156:159], v[68:71], v[84:87], v[156:159]
  v_pk_fma_f32 v[152:153], v[246:247], v[226:227], v[152:153] op_sel_hi:[1,0,1] neg_lo:[0,1,0] neg_hi:[0,1,0]
  v_pk_fma_f32 v[154:155], v[248:249], v[226:227], v[154:155] op_sel_hi:[1,0,1] neg_lo:[0,1,0] neg_hi:[0,1,0]
  v_pk_fma_f32 v[188:189], v[250:251], v[226:227], v[188:189] op_sel_hi:[1,0,1] neg_lo:[0,1,0] neg_hi:[0,1,0]
  v_pk_fma_f32 v[190:191], v[252:253], v[226:227], v[190:191] op_sel_hi:[1,0,1] neg_lo:[0,1,0] neg_hi:[0,1,0]
  v_pk_mul_f32 v[116:117], v[116:117], v[226:227] op_sel:[0,1] op_sel_hi:[1,1]
  v_pk_mul_f32 v[118:119], v[118:119], v[226:227] op_sel:[0,1] op_sel_hi:[1,1]
  v_pk_mul_f32 v[152:153], v[152:153], v[226:227] op_sel:[0,1] op_sel_hi:[1,1]
  v_mfma_f32_16x16x32_bf16 v[192:195], v[72:75], v[84:87], v[192:195]
  v_pk_mul_f32 v[154:155], v[154:155], v[226:227] op_sel:[0,1] op_sel_hi:[1,1]
  v_pk_mul_f32 v[188:189], v[188:189], v[226:227] op_sel:[0,1] op_sel_hi:[1,1]
  v_pk_mul_f32 v[190:191], v[190:191], v[226:227] op_sel:[0,1] op_sel_hi:[1,1]
  v_cvt_pk_bf16_f32 v22, v116, v117
  v_cvt_pk_bf16_f32 v23, v118, v119
  ds_write_b64 v11, v[22:23] offset:3200
  v_cvt_pk_bf16_f32 v24, v152, v153
  v_mfma_f32_16x16x32_bf16 v[196:199], v[72:75], v[88:91], v[196:199]
  v_cvt_pk_bf16_f32 v25, v154, v155
  ds_write_b64 v11, v[24:25] offset:3328
  v_cvt_pk_bf16_f32 v26, v188, v189
  v_cvt_pk_bf16_f32 v27, v190, v191
  ds_write_b64 v11, v[26:27] offset:3456
  v_pk_fma_f32 v[120:121], v[242:243], v[228:229], v[120:121] op_sel_hi:[1,0,1] neg_lo:[0,1,0] neg_hi:[0,1,0]
  v_pk_fma_f32 v[122:123], v[244:245], v[228:229], v[122:123] op_sel_hi:[1,0,1] neg_lo:[0,1,0] neg_hi:[0,1,0]
  v_mfma_f32_16x16x32_bf16 v[160:163], v[68:71], v[88:91], v[160:163]
  v_pk_fma_f32 v[156:157], v[246:247], v[228:229], v[156:157] op_sel_hi:[1,0,1] neg_lo:[0,1,0] neg_hi:[0,1,0]
  v_pk_fma_f32 v[158:159], v[248:249], v[228:229], v[158:159] op_sel_hi:[1,0,1] neg_lo:[0,1,0] neg_hi:[0,1,0]
  v_pk_fma_f32 v[192:193], v[250:251], v[228:229], v[192:193] op_sel_hi:[1,0,1] neg_lo:[0,1,0] neg_hi:[0,1,0]
  v_pk_fma_f32 v[194:195], v[252:253], v[228:229], v[194:195] op_sel_hi:[1,0,1] neg_lo:[0,1,0] neg_hi:[0,1,0]
  v_pk_mul_f32 v[120:121], v[120:121], v[228:229] op_sel:[0,1] op_sel_hi:[1,1]
  v_pk_mul_f32 v[122:123], v[122:123], v[228:229] op_sel:[0,1] op_sel_hi:[1,1]
  v_pk_mul_f32 v[156:157], v[156:157], v[228:229] op_sel:[0,1] op_sel_hi:[1,1]
  v_mfma_f32_16x16x32_bf16 v[124:127], v[64:67], v[88:91], v[124:127]
  v_pk_mul_f32 v[158:159], v[158:159], v[228:229] op_sel:[0,1] op_sel_hi:[1,1]
  v_pk_mul_f32 v[192:193], v[192:193], v[228:229] op_sel:[0,1] op_sel_hi:[1,1]
  v_pk_mul_f32 v[194:195], v[194:195], v[228:229] op_sel:[0,1] op_sel_hi:[1,1]
  v_cvt_pk_bf16_f32 v28, v120, v121
  v_cvt_pk_bf16_f32 v29, v122, v123
  ds_write_b64 v11, v[28:29] offset:6400
  v_cvt_pk_bf16_f32 v30, v156, v157
  v_mfma_f32_16x16x32_bf16 v[128:131], v[64:67], v[92:95], v[128:131]
  v_cvt_pk_bf16_f32 v31, v158, v159
  ds_write_b64 v11, v[30:31] offset:6528
  v_cvt_pk_bf16_f32 v32, v192, v193
  v_cvt_pk_bf16_f32 v33, v194, v195
  ds_write_b64 v11, v[32:33] offset:6656
  v_pk_fma_f32 v[124:125], v[242:243], v[230:231], v[124:125] op_sel_hi:[1,0,1] neg_lo:[0,1,0] neg_hi:[0,1,0]
  v_pk_fma_f32 v[126:127], v[244:245], v[230:231], v[126:127] op_sel_hi:[1,0,1] neg_lo:[0,1,0] neg_hi:[0,1,0]
  v_mfma_f32_16x16x32_bf16 v[164:167], v[68:71], v[92:95], v[164:167]
  v_pk_fma_f32 v[160:161], v[246:247], v[230:231], v[160:161] op_sel_hi:[1,0,1] neg_lo:[0,1,0] neg_hi:[0,1,0]
  v_pk_fma_f32 v[162:163], v[248:249], v[230:231], v[162:163] op_sel_hi:[1,0,1] neg_lo:[0,1,0] neg_hi:[0,1,0]
  v_pk_fma_f32 v[196:197], v[250:251], v[230:231], v[196:197] op_sel_hi:[1,0,1] neg_lo:[0,1,0] neg_hi:[0,1,0]
  v_pk_fma_f32 v[198:199], v[252:253], v[230:231], v[198:199] op_sel_hi:[1,0,1] neg_lo:[0,1,0] neg_hi:[0,1,0]
  v_pk_mul_f32 v[124:125], v[124:125], v[230:231] op_sel:[0,1] op_sel_hi:[1,1]
  v_pk_mul_f32 v[126:127], v[126:127], v[230:231] op_sel:[0,1] op_sel_hi:[1,1]
  v_pk_mul_f32 v[160:161], v[160:161], v[230:231] op_sel:[0,1] op_sel_hi:[1,1]
  v_mfma_f32_16x16x32_bf16 v[200:203], v[72:75], v[92:95], v[200:203]
  v_pk_mul_f32 v[162:163], v[162:163], v[230:231] op_sel:[0,1] op_sel_hi:[1,1]
  v_pk_mul_f32 v[196:197], v[196:197], v[230:231] op_sel:[0,1] op_sel_hi:[1,1]
  v_pk_mul_f32 v[198:199], v[198:199], v[230:231] op_sel:[0,1] op_sel_hi:[1,1]
  v_cvt_pk_bf16_f32 v34, v124, v125
  v_cvt_pk_bf16_f32 v35, v126, v127
  ds_write_b64 v11, v[34:35] offset:9600
  v_cvt_pk_bf16_f32 v36, v160, v161
  v_mfma_f32_16x16x32_bf16 v[204:207], v[72:75], v[96:99], v[204:207]
  v_cvt_pk_bf16_f32 v37, v162, v163
  ds_write_b64 v11, v[36:37] offset:9728
  v_cvt_pk_bf16_f32 v38, v196, v197
  v_cvt_pk_bf16_f32 v39, v198, v199
  ds_write_b64 v11, v[38:39] offset:9856
  v_pk_fma_f32 v[128:129], v[242:243], v[232:233], v[128:129] op_sel_hi:[1,0,1] neg_lo:[0,1,0] neg_hi:[0,1,0]
  v_pk_fma_f32 v[130:131], v[244:245], v[232:233], v[130:131] op_sel_hi:[1,0,1] neg_lo:[0,1,0] neg_hi:[0,1,0]
  v_mfma_f32_16x16x32_bf16 v[168:171], v[68:71], v[96:99], v[168:171]
  v_pk_fma_f32 v[164:165], v[246:247], v[232:233], v[164:165] op_sel_hi:[1,0,1] neg_lo:[0,1,0] neg_hi:[0,1,0]
  v_pk_fma_f32 v[166:167], v[248:249], v[232:233], v[166:167] op_sel_hi:[1,0,1] neg_lo:[0,1,0] neg_hi:[0,1,0]
  v_pk_fma_f32 v[200:201], v[250:251], v[232:233], v[200:201] op_sel_hi:[1,0,1] neg_lo:[0,1,0] neg_hi:[0,1,0]
  v_pk_fma_f32 v[202:203], v[252:253], v[232:233], v[202:203] op_sel_hi:[1,0,1] neg_lo:[0,1,0] neg_hi:[0,1,0]
  v_pk_mul_f32 v[128:129], v[128:129], v[232:233] op_sel:[0,1] op_sel_hi:[1,1]
  v_pk_mul_f32 v[130:131], v[130:131], v[232:233] op_sel:[0,1] op_sel_hi:[1,1]
  v_pk_mul_f32 v[164:165], v[164:165], v[232:233] op_sel:[0,1] op_sel_hi:[1,1]
  v_mfma_f32_16x16x32_bf16 v[132:135], v[64:67], v[96:99], v[132:135]
  v_pk_mul_f32 v[166:167], v[166:167], v[232:233] op_sel:[0,1] op_sel_hi:[1,1]
  v_pk_mul_f32 v[200:201], v[200:201], v[232:233] op_sel:[0,1] op_sel_hi:[1,1]
  v_pk_mul_f32 v[202:203], v[202:203], v[232:233] op_sel:[0,1] op_sel_hi:[1,1]
  v_cvt_pk_bf16_f32 v40, v128, v129
  v_cvt_pk_bf16_f32 v41, v130, v131
  ds_write_b64 v11, v[40:41] offset:12800
  v_cvt_pk_bf16_f32 v42, v164, v165
  v_mfma_f32_16x16x32_bf16 v[136:139], v[64:67], v[100:103], v[136:139]
  v_cvt_pk_bf16_f32 v43, v166, v167
  ds_write_b64 v11, v[42:43] offset:12928
  v_cvt_pk_bf16_f32 v44, v200, v201
  v_cvt_pk_bf16_f32 v45, v202, v203
  ds_write_b64 v11, v[44:45] offset:13056
  v_pk_fma_f32 v[132:133], v[242:243], v[234:235], v[132:133] op_sel_hi:[1,0,1] neg_lo:[0,1,0] neg_hi:[0,1,0]
  v_pk_fma_f32 v[134:135], v[244:245], v[234:235], v[134:135] op_sel_hi:[1,0,1] neg_lo:[0,1,0] neg_hi:[0,1,0]
  v_mfma_f32_16x16x32_bf16 v[172:175], v[68:71], v[100:103], v[172:175]
  v_pk_fma_f32 v[168:169], v[246:247], v[234:235], v[168:169] op_sel_hi:[1,0,1] neg_lo:[0,1,0] neg_hi:[0,1,0]
  v_pk_fma_f32 v[170:171], v[248:249], v[234:235], v[170:171] op_sel_hi:[1,0,1] neg_lo:[0,1,0] neg_hi:[0,1,0]
  v_pk_fma_f32 v[204:205], v[250:251], v[234:235], v[204:205] op_sel_hi:[1,0,1] neg_lo:[0,1,0] neg_hi:[0,1,0]
  v_pk_fma_f32 v[206:207], v[252:253], v[234:235], v[206:207] op_sel_hi:[1,0,1] neg_lo:[0,1,0] neg_hi:[0,1,0]
  v_pk_mul_f32 v[132:133], v[132:133], v[234:235] op_sel:[0,1] op_sel_hi:[1,1]
  v_pk_mul_f32 v[134:135], v[134:135], v[234:235] op_sel:[0,1] op_sel_hi:[1,1]
  v_pk_mul_f32 v[168:169], v[168:169], v[234:235] op_sel:[0,1] op_sel_hi:[1,1]
  v_mfma_f32_16x16x32_bf16 v[208:211], v[72:75], v[100:103], v[208:211]
  v_pk_mul_f32 v[170:171], v[170:171], v[234:235] op_sel:[0,1] op_sel_hi:[1,1]
  v_pk_mul_f32 v[204:205], v[204:205], v[234:235] op_sel:[0,1] op_sel_hi:[1,1]
  v_pk_mul_f32 v[206:207], v[206:207], v[234:235] op_sel:[0,1] op_sel_hi:[1,1]
  v_cvt_pk_bf16_f32 v46, v132, v133
  v_cvt_pk_bf16_f32 v47, v134, v135
  ds_write_b64 v11, v[46:47] offset:16000
  v_cvt_pk_bf16_f32 v48, v168, v169
  v_mfma_f32_16x16x32_bf16 v[212:215], v[72:75], v[104:107], v[212:215]
  v_cvt_pk_bf16_f32 v49, v170, v171
  ds_write_b64 v11, v[48:49] offset:16128
  v_cvt_pk_bf16_f32 v50, v204, v205
  v_cvt_pk_bf16_f32 v51, v206, v207
  ds_write_b64 v11, v[50:51] offset:16256
  v_pk_fma_f32 v[136:137], v[242:243], v[236:237], v[136:137] op_sel_hi:[1,0,1] neg_lo:[0,1,0] neg_hi:[0,1,0]
  v_pk_fma_f32 v[138:139], v[244:245], v[236:237], v[138:139] op_sel_hi:[1,0,1] neg_lo:[0,1,0] neg_hi:[0,1,0]
  v_mfma_f32_16x16x32_bf16 v[176:179], v[68:71], v[104:107], v[176:179]
  v_pk_fma_f32 v[172:173], v[246:247], v[236:237], v[172:173] op_sel_hi:[1,0,1] neg_lo:[0,1,0] neg_hi:[0,1,0]
  v_pk_fma_f32 v[174:175], v[248:249], v[236:237], v[174:175] op_sel_hi:[1,0,1] neg_lo:[0,1,0] neg_hi:[0,1,0]
  v_pk_fma_f32 v[208:209], v[250:251], v[236:237], v[208:209] op_sel_hi:[1,0,1] neg_lo:[0,1,0] neg_hi:[0,1,0]
  v_pk_fma_f32 v[210:211], v[252:253], v[236:237], v[210:211] op_sel_hi:[1,0,1] neg_lo:[0,1,0] neg_hi:[0,1,0]
  v_pk_mul_f32 v[136:137], v[136:137], v[236:237] op_sel:[0,1] op_sel_hi:[1,1]
  v_pk_mul_f32 v[138:139], v[138:139], v[236:237] op_sel:[0,1] op_sel_hi:[1,1]
  v_pk_mul_f32 v[172:173], v[172:173], v[236:237] op_sel:[0,1] op_sel_hi:[1,1]
  v_mfma_f32_16x16x32_bf16 v[140:143], v[64:67], v[104:107], v[140:143]
  v_pk_mul_f32 v[174:175], v[174:175], v[236:237] op_sel:[0,1] op_sel_hi:[1,1]
  v_pk_mul_f32 v[208:209], v[208:209], v[236:237] op_sel:[0,1] op_sel_hi:[1,1]
  v_pk_mul_f32 v[210:211], v[210:211], v[236:237] op_sel:[0,1] op_sel_hi:[1,1]
  v_cvt_pk_bf16_f32 v52, v136, v137
  v_cvt_pk_bf16_f32 v53, v138, v139
  ds_write_b64 v11, v[52:53] offset:19200
  v_cvt_pk_bf16_f32 v54, v172, v173
  v_mfma_f32_16x16x32_bf16 v[144:147], v[64:67], v[108:111], v[144:147]
  v_cvt_pk_bf16_f32 v55, v174, v175
  ds_write_b64 v11, v[54:55] offset:19328
  v_cvt_pk_bf16_f32 v56, v208, v209
  v_cvt_pk_bf16_f32 v57, v210, v211
  ds_write_b64 v11, v[56:57] offset:19456
  v_pk_fma_f32 v[140:141], v[242:243], v[238:239], v[140:141] op_sel_hi:[1,0,1] neg_lo:[0,1,0] neg_hi:[0,1,0]
  v_pk_fma_f32 v[142:143], v[244:245], v[238:239], v[142:143] op_sel_hi:[1,0,1] neg_lo:[0,1,0] neg_hi:[0,1,0]
  v_mfma_f32_16x16x32_bf16 v[180:183], v[68:71], v[108:111], v[180:183]
  v_pk_fma_f32 v[176:177], v[246:247], v[238:239], v[176:177] op_sel_hi:[1,0,1] neg_lo:[0,1,0] neg_hi:[0,1,0]
  v_pk_fma_f32 v[178:179], v[248:249], v[238:239], v[178:179] op_sel_hi:[1,0,1] neg_lo:[0,1,0] neg_hi:[0,1,0]
  v_pk_fma_f32 v[212:213], v[250:251], v[238:239], v[212:213] op_sel_hi:[1,0,1] neg_lo:[0,1,0] neg_hi:[0,1,0]
  v_pk_fma_f32 v[214:215], v[252:253], v[238:239], v[214:215] op_sel_hi:[1,0,1] neg_lo:[0,1,0] neg_hi:[0,1,0]
  v_pk_mul_f32 v[140:141], v[140:141], v[238:239] op_sel:[0,1] op_sel_hi:[1,1]
  v_pk_mul_f32 v[142:143], v[142:143], v[238:239] op_sel:[0,1] op_sel_hi:[1,1]
  v_pk_mul_f32 v[176:177], v[176:177], v[238:239] op_sel:[0,1] op_sel_hi:[1,1]
  v_mfma_f32_16x16x32_bf16 v[216:219], v[72:75], v[108:111], v[216:219]
  v_pk_mul_f32 v[178:179], v[178:179], v[238:239] op_sel:[0,1] op_sel_hi:[1,1]
  v_pk_mul_f32 v[212:213], v[212:213], v[238:239] op_sel:[0,1] op_sel_hi:[1,1]
  v_pk_mul_f32 v[214:215], v[214:215], v[238:239] op_sel:[0,1] op_sel_hi:[1,1]
  v_cvt_pk_bf16_f32 v58, v140, v141
  v_cvt_pk_bf16_f32 v59, v142, v143
  ds_write_b64 v11, v[58:59] offset:22400
  v_cvt_pk_bf16_f32 v60, v176, v177
  s_barrier
  v_cvt_pk_bf16_f32 v61, v178, v179
  ds_write_b64 v11, v[60:61] offset:22528
  v_cvt_pk_bf16_f32 v62, v212, v213
  v_cvt_pk_bf16_f32 v63, v214, v215
  ds_write_b64 v11, v[62:63] offset:22656
  v_pk_fma_f32 v[144:145], v[242:243], v[240:241], v[144:145] op_sel_hi:[1,0,1] neg_lo:[0,1,0] neg_hi:[0,1,0]
  v_pk_fma_f32 v[146:147], v[244:245], v[240:241], v[146:147] op_sel_hi:[1,0,1] neg_lo:[0,1,0] neg_hi:[0,1,0]
  v_pk_fma_f32 v[180:181], v[246:247], v[240:241], v[180:181] op_sel_hi:[1,0,1] neg_lo:[0,1,0] neg_hi:[0,1,0]
  v_pk_fma_f32 v[182:183], v[248:249], v[240:241], v[182:183] op_sel_hi:[1,0,1] neg_lo:[0,1,0] neg_hi:[0,1,0]
  v_pk_fma_f32 v[216:217], v[250:251], v[240:241], v[216:217] op_sel_hi:[1,0,1] neg_lo:[0,1,0] neg_hi:[0,1,0]
  v_pk_fma_f32 v[218:219], v[252:253], v[240:241], v[218:219] op_sel_hi:[1,0,1] neg_lo:[0,1,0] neg_hi:[0,1,0]
  v_pk_mul_f32 v[144:145], v[144:145], v[240:241] op_sel:[0,1] op_sel_hi:[1,1]
  v_pk_mul_f32 v[146:147], v[146:147], v[240:241] op_sel:[0,1] op_sel_hi:[1,1]
  v_pk_mul_f32 v[180:181], v[180:181], v[240:241] op_sel:[0,1] op_sel_hi:[1,1]
  v_pk_mul_f32 v[182:183], v[182:183], v[240:241] op_sel:[0,1] op_sel_hi:[1,1]
  v_pk_mul_f32 v[216:217], v[216:217], v[240:241] op_sel:[0,1] op_sel_hi:[1,1]
  v_pk_mul_f32 v[218:219], v[218:219], v[240:241] op_sel:[0,1] op_sel_hi:[1,1]
  v_cvt_pk_bf16_f32 v16, v144, v145
  v_cvt_pk_bf16_f32 v17, v146, v147
  ds_write_b64 v11, v[16:17] offset:25600
  v_cvt_pk_bf16_f32 v18, v180, v181
  v_cvt_pk_bf16_f32 v19, v182, v183
  ds_write_b64 v11, v[18:19] offset:25728
  v_cvt_pk_bf16_f32 v20, v216, v217
  v_cvt_pk_bf16_f32 v21, v218, v219
  ds_write_b64 v11, v[20:21] offset:25856
  s_branch attn
C_top1:
  s_nop 7
  s_nop 7
  s_mov_b32 s43, 0
  s_mov_b32 s39, 15
  s_barrier
  ds_read_b64_tr_b16 v[16:17], v8 offset:0
  ds_read_b64_tr_b16 v[18:19], v8 offset:512
  ds_read_b128 v[28:31], v9 offset:0
  ds_read_b64_tr_b16 v[20:21], v8 offset:8192
  ds_read_b64_tr_b16 v[22:23], v8 offset:8704
  ds_read_b64_tr_b16 v[24:25], v8 offset:16384
  ds_read_b64_tr_b16 v[26:27], v8 offset:16896
  ds_read_b128 v[32:35], v9 offset:2048
  ds_read_b128 v[36:39], v9 offset:4096
  ds_read_b128 v[40:43], v9 offset:6144
  ds_read_b128 v[44:47], v9 offset:8192
  ds_read_b128 v[48:51], v9 offset:10240
  ds_read_b128 v[52:55], v9 offset:12288
  ds_read_b128 v[56:59], v9 offset:14336
  ds_read_b128 v[60:63], v9 offset:16384
  s_add_u32 s40, s43, 43008
  s_cmp_eq_u32 s40, 129024
  s_cselect_b32 s40, 0, s40
  s_sub_u32 s42, s40, s43
  s_mov_b32 s43, s40
cl2:
  s_waitcnt lgkmcnt(10)
  v_mfma_f32_16x16x32_bf16 v[148:151], v[20:23], v[28:31], v[148:151]
  ds_read_b64_tr_b16 v[64:65], v8 offset:4096
  s_waitcnt lgkmcnt(9)
  v_mfma_f32_16x16x32_bf16 v[184:187], v[24:27], v[28:31], v[184:187]
  ds_read_b64_tr_b16 v[66:67], v8 offset:4608
  s_waitcnt lgkmcnt(9)
  v_mfma_f32_16x16x32_bf16 v[188:191], v[24:27], v[32:35], v[188:191]
  ds_read_b128 v[76:79], v10 offset:0
  v_mfma_f32_16x16x32_bf16 v[152:155], v[20:23], v[32:35], v[152:155]
  ds_read_b64_tr_b16 v[68:69], v8 offset:12288
  v_mfma_f32_16x16x32_bf16 v[116:119], v[16:19], v[32:35], v[116:119]
  ds_read_b64_tr_b16 v[70:71], v8 offset:12800
  s_waitcnt lgkmcnt(11)
  v_mfma_f32_16x16x32_bf16 v[120:123], v[16:19], v[36:39], v[120:123]
  ds_read_b64_tr_b16 v[72:73], v8 offset:20480
  v_mfma_f32_16x16x32_bf16 v[156:159], v[20:23], v[36:39], v[156:159]
  ds_read_b64_tr_b16 v[74:75], v8 offset:20992
  v_add_u32 v8, s42, v8
  v_mfma_f32_16x16x32_bf16 v[192:195], v[24:27], v[36:39], v[192:195]
  ds_read_b128 v[80:83], v10 offset:2048
  s_waitcnt lgkmcnt(13)
  v_mfma_f32_16x16x32_bf16 v[196:199], v[24:27], v[40:43], v[196:199]
  ds_read_b128 v[84:87], v10 offset:4096
  v_mfma_f32_16x16x32_bf16 v[160:163], v[20:23], v[40:43], v[160:163]
  ds_read_b128 v[88:91], v10 offset:6144
  v_mfma_f32_16x16x32_bf16 v[124:127], v[16:19], v[40:43], v[124:127]
  ds_read_b128 v[92:95], v10 offset:8192
  s_waitcnt lgkmcnt(14)
  v_mfma_f32_16x16x32_bf16 v[128:131], v[16:19], v[44:47], v[128:131]
  ds_read_b128 v[96:99], v10 offset:10240
  v_mfma_f32_16x16x32_bf16 v[164:167], v[20:23], v[44:47], v[164:167]
  ds_read_b128 v[100:103], v10 offset:12288
  v_mfma_f32_16x16x32_bf16 v[200:203], v[24:27], v[44:47], v[200:203]
  ds_read_b128 v[104:107], v10 offset:14336
  v_mfma_f32_16x16x32_bf16 v[204:207], v[24:27], v[48:51], v[204:207]
  ds_read_b128 v[108:111], v10 offset:16384
  v_add_u32 v9, s42, v9
  v_add_u32 v10, s42, v10
  v_mfma_f32_16x16x32_bf16 v[168:171], v[20:23], v[48:51], v[168:171]
  v_mfma_f32_16x16x32_bf16 v[132:135], v[16:19], v[48:51], v[132:135]
  s_waitcnt lgkmcnt(14)
  v_mfma_f32_16x16x32_bf16 v[136:139], v[16:19], v[52:55], v[136:139]
  v_mfma_f32_16x16x32_bf16 v[172:175], v[20:23], v[52:55], v[172:175]
  v_mfma_f32_16x16x32_bf16 v[208:211], v[24:27], v[52:55], v[208:211]
  v_mfma_f32_16x16x32_bf16 v[212:215], v[24:27], v[56:59], v[212:215]
  v_mfma_f32_16x16x32_bf16 v[176:179], v[20:23], v[56:59], v[176:179]
  v_mfma_f32_16x16x32_bf16 v[140:143], v[16:19], v[56:59], v[140:143]
  v_mfma_f32_16x16x32_bf16 v[144:147], v[16:19], v[60:63], v[144:147]
  v_mfma_f32_16x16x32_bf16 v[180:183], v[20:23], v[60:63], v[180:183]
  v_mfma_f32_16x16x32_bf16 v[216:219], v[24:27], v[60:63], v[216:219]
  s_waitcnt lgkmcnt(0)
  s_barrier
  v_mfma_f32_16x16x32_bf16 v[148:151], v[68:71], v[76:79], v[148:151]
  ds_read_b64_tr_b16 v[16:17], v8 offset:0
  s_add_u32 s40, s43, 43008
  v_mfma_f32_16x16x32_bf16 v[184:187], v[72:75], v[76:79], v[184:187]
  ds_read_b64_tr_b16 v[18:19], v8 offset:512
  s_cmp_eq_u32 s40, 129024
  v_mfma_f32_16x16x32_bf16 v[188:191], v[72:75], v[80:83], v[188:191]
  ds_read_b128 v[28:31], v9 offset:0
  s_cselect_b32 s40, 0, s40
  v_mfma_f32_16x16x32_bf16 v[152:155], v[68:71], v[80:83], v[152:155]
  ds_read_b64_tr_b16 v[20:21], v8 offset:8192
  s_sub_u32 s42, s40, s43
  v_mfma_f32_16x16x32_bf16 v[116:119], v[64:67], v[80:83], v[116:119]
  ds_read_b64_tr_b16 v[22:23], v8 offset:8704
  s_mov_b32 s43, s40
  v_mfma_f32_16x16x32_bf16 v[120:123], v[64:67], v[84:87], v[120:123]
  ds_read_b64_tr_b16 v[24:25], v8 offset:16384
  v_mfma_f32_16x16x32_bf16 v[156:159], v[68:71], v[84:87], v[156:159]
  ds_read_b64_tr_b16 v[26:27], v8 offset:16896
  v_mfma_f32_16x16x32_bf16 v[192:195], v[72:75], v[84:87], v[192:195]
  ds_read_b128 v[32:35], v9 offset:2048
  v_mfma_f32_16x16x32_bf16 v[196:199], v[72:75], v[88:91], v[196:199]
  ds_read_b128 v[36:39], v9 offset:4096
  v_mfma_f32_16x16x32_bf16 v[160:163], v[68:71], v[88:91], v[160:163]
  ds_read_b128 v[40:43], v9 offset:6144
  v_mfma_f32_16x16x32_bf16 v[124:127], v[64:67], v[88:91], v[124:127]
  ds_read_b128 v[44:47], v9 offset:8192
  v_mfma_f32_16x16x32_bf16 v[128:131], v[64:67], v[92:95], v[128:131]
  ds_read_b128 v[48:51], v9 offset:10240
  v_mfma_f32_16x16x32_bf16 v[164:167], v[68:71], v[92:95], v[164:167]
  ds_read_b128 v[52:55], v9 offset:12288
  v_mfma_f32_16x16x32_bf16 v[200:203], v[72:75], v[92:95], v[200:203]
  ds_read_b128 v[56:59], v9 offset:14336
  v_mfma_f32_16x16x32_bf16 v[204:207], v[72:75], v[96:99], v[204:207]
  ds_read_b128 v[60:63], v9 offset:16384
  v_mfma_f32_16x16x32_bf16 v[168:171], v[68:71], v[96:99], v[168:171]
  v_mfma_f32_16x16x32_bf16 v[132:135], v[64:67], v[96:99], v[132:135]
  v_mfma_f32_16x16x32_bf16 v[136:139], v[64:67], v[100:103], v[136:139]
  v_mfma_f32_16x16x32_bf16 v[172:175], v[68:71], v[100:103], v[172:175]
  v_mfma_f32_16x16x32_bf16 v[208:211], v[72:75], v[100:103], v[208:211]
  v_mfma_f32_16x16x32_bf16 v[212:215], v[72:75], v[104:107], v[212:215]
  v_mfma_f32_16x16x32_bf16 v[176:179], v[68:71], v[104:107], v[176:179]
  v_mfma_f32_16x16x32_bf16 v[140:143], v[64:67], v[104:107], v[140:143]
  v_mfma_f32_16x16x32_bf16 v[144:147], v[64:67], v[108:111], v[144:147]
  v_mfma_f32_16x16x32_bf16 v[180:183], v[68:71], v[108:111], v[180:183]
  v_mfma_f32_16x16x32_bf16 v[216:219], v[72:75], v[108:111], v[216:219]
  s_sub_u32 s39, s39, 1
  s_cmp_lg_u32 s39, 0
  s_cbranch_scc1 cl2
  s_waitcnt lgkmcnt(10)
  v_mfma_f32_16x16x32_bf16 v[148:151], v[20:23], v[28:31], v[148:151]
  ds_read_b64_tr_b16 v[64:65], v8 offset:4096
  s_waitcnt lgkmcnt(9)
  v_mfma_f32_16x16x32_bf16 v[184:187], v[24:27], v[28:31], v[184:187]
  ds_read_b64_tr_b16 v[66:67], v8 offset:4608
  s_waitcnt lgkmcnt(9)
  v_mfma_f32_16x16x32_bf16 v[188:191], v[24:27], v[32:35], v[188:191]
  ds_read_b128 v[76:79], v10 offset:0
  v_mfma_f32_16x16x32_bf16 v[152:155], v[20:23], v[32:35], v[152:155]
  ds_read_b64_tr_b16 v[68:69], v8 offset:12288
  v_mfma_f32_16x16x32_bf16 v[116:119], v[16:19], v[32:35], v[116:119]
  ds_read_b64_tr_b16 v[70:71], v8 offset:12800
  s_waitcnt lgkmcnt(11)
  v_mfma_f32_16x16x32_bf16 v[120:123], v[16:19], v[36:39], v[120:123]
  ds_read_b64_tr_b16 v[72:73], v8 offset:20480
  v_mfma_f32_16x16x32_bf16 v[156:159], v[20:23], v[36:39], v[156:159]
  ds_read_b64_tr_b16 v[74:75], v8 offset:20992
  v_mfma_f32_16x16x32_bf16 v[192:195], v[24:27], v[36:39], v[192:195]
  ds_read_b128 v[80:83], v10 offset:2048
  s_waitcnt lgkmcnt(13)
  v_mfma_f32_16x16x32_bf16 v[196:199], v[24:27], v[40:43], v[196:199]
  ds_read_b128 v[84:87], v10 offset:4096
  v_mfma_f32_16x16x32_bf16 v[160:163], v[20:23], v[40:43], v[160:163]
  ds_read_b128 v[88:91], v10 offset:6144
  v_mfma_f32_16x16x32_bf16 v[124:127], v[16:19], v[40:43], v[124:127]
  ds_read_b128 v[92:95], v10 offset:8192
  s_waitcnt lgkmcnt(14)
  v_mfma_f32_16x16x32_bf16 v[128:131], v[16:19], v[44:47], v[128:131]
  ds_read_b128 v[96:99], v10 offset:10240
  v_mfma_f32_16x16x32_bf16 v[164:167], v[20:23], v[44:47], v[164:167]
  ds_read_b128 v[100:103], v10 offset:12288
  v_mfma_f32_16x16x32_bf16 v[200:203], v[24:27], v[44:47], v[200:203]
  ds_read_b128 v[104:107], v10 offset:14336
  v_mfma_f32_16x16x32_bf16 v[204:207], v[24:27], v[48:51], v[204:207]
  ds_read_b128 v[108:111], v10 offset:16384
  v_mfma_f32_16x16x32_bf16 v[168:171], v[20:23], v[48:51], v[168:171]
  ds_read_b64 v[224:225], v12 offset:0
  v_mfma_f32_16x16x32_bf16 v[132:135], v[16:19], v[48:51], v[132:135]
  ds_read_b64 v[226:227], v12 offset:128
  s_waitcnt lgkmcnt(14)
  v_mfma_f32_16x16x32_bf16 v[136:139], v[16:19], v[52:55], v[136:139]
  ds_read_b64 v[228:229], v12 offset:256
  v_mfma_f32_16x16x32_bf16 v[172:175], v[20:23], v[52:55], v[172:175]
  ds_read_b64 v[230:231], v12 offset:384
  v_mfma_f32_16x16x32_bf16 v[208:211], v[24:27], v[52:55], v[208:211]
  ds_read_b64 v[232:233], v12 offset:512
  v_mfma_f32_16x16x32_bf16 v[212:215], v[24:27], v[56:59], v[212:215]
  ds_read_b64 v[234:235], v12 offset:640
  v_mfma_f32_16x16x32_bf16 v[176:179], v[20:23], v[56:59], v[176:179]
  ds_read_b64 v[236:237], v12 offset:768
  v_mfma_f32_16x16x32_bf16 v[140:143], v[16:19], v[56:59], v[140:143]
  ds_read_b64 v[238:239], v12 offset:896
  v_mfma_f32_16x16x32_bf16 v[144:147], v[16:19], v[60:63], v[144:147]
  ds_read_b64 v[240:241], v12 offset:1024
  v_mfma_f32_16x16x32_bf16 v[180:183], v[20:23], v[60:63], v[180:183]
  v_mfma_f32_16x16x32_bf16 v[216:219], v[24:27], v[60:63], v[216:219]
  s_waitcnt lgkmcnt(0)
  v_mfma_f32_16x16x32_bf16 v[148:151], v[68:71], v[76:79], v[148:151]
  v_mfma_f32_16x16x32_bf16 v[184:187], v[72:75], v[76:79], v[184:187]
  v_mfma_f32_16x16x32_bf16 v[188:191], v[72:75], v[80:83], v[188:191]
  s_nop 5
  v_mov_b32_dpp v246, v148 row_newbcast:0 row_mask:0xf bank_mask:0xf
  v_mov_b32_dpp v247, v149 row_newbcast:0 row_mask:0xf bank_mask:0xf
  v_mov_b32_dpp v248, v150 row_newbcast:0 row_mask:0xf bank_mask:0xf
  v_mov_b32_dpp v249, v151 row_newbcast:0 row_mask:0xf bank_mask:0xf
  v_mov_b32_dpp v250, v184 row_newbcast:0 row_mask:0xf bank_mask:0xf
  v_mov_b32_dpp v251, v185 row_newbcast:0 row_mask:0xf bank_mask:0xf
  v_mov_b32_dpp v252, v186 row_newbcast:0 row_mask:0xf bank_mask:0xf
  v_mfma_f32_16x16x32_bf16 v[152:155], v[68:71], v[80:83], v[152:155]
  v_mov_b32_dpp v253, v187 row_newbcast:0 row_mask:0xf bank_mask:0xf
  v_pk_fma_f32 v[148:149], v[246:247], v[224:225], v[148:149] op_sel_hi:[1,0,1] neg_lo:[0,1,0] neg_hi:[0,1,0]
  v_pk_fma_f32 v[150:151], v[248:249], v[224:225], v[150:151] op_sel_hi:[1,0,1] neg_lo:[0,1,0] neg_hi:[0,1,0]
  v_pk_fma_f32 v[184:185], v[250:251], v[224:225], v[184:185] op_sel_hi:[1,0,1] neg_lo:[0,1,0] neg_hi:[0,1,0]
  v_pk_fma_f32 v[186:187], v[252:253], v[224:225], v[186:187] op_sel_hi:[1,0,1] neg_lo:[0,1,0] neg_hi:[0,1,0]
  v_pk_mul_f32 v[148:149], v[148:149], v[224:225] op_sel:[0,1] op_sel_hi:[1,1]
  v_pk_mul_f32 v[150:151], v[150:151], v[224:225] op_sel:[0,1] op_sel_hi:[1,1]
  v_mfma_f32_16x16x32_bf16 v[116:119], v[64:67], v[80:83], v[116:119]
  v_pk_mul_f32 v[184:185], v[184:185], v[224:225] op_sel:[0,1] op_sel_hi:[1,1]
  v_pk_mul_f32 v[186:187], v[186:187], v[224:225] op_sel:[0,1] op_sel_hi:[1,1]
  v_cvt_pk_bf16_f32 v16, v148, v149
  v_cvt_pk_bf16_f32 v17, v150, v151
  ds_write_b64 v11, v[16:17] offset:128
  v_cvt_pk_bf16_f32 v18, v184, v185
  v_cvt_pk_bf16_f32 v19, v186, v187
  v_mfma_f32_16x16x32_bf16 v[120:123], v[64:67], v[84:87], v[120:123]
  ds_write_b64 v11, v[18:19] offset:256
  v_pk_fma_f32 v[116:117], v[242:243], v[226:227], v[116:117] op_sel_hi:[1,0,1] neg_lo:[0,1,0] neg_hi:[0,1,0]
  v_pk_fma_f32 v[118:119], v[244:245], v[226:227], v[118:119] op_sel_hi:[1,0,1] neg_lo:[0,1,0] neg_hi:[0,1,0]
  v_pk_fma_f32 v[152:153], v[246:247], v[226:227], v[152:153] op_sel_hi:[1,0,1] neg_lo:[0,1,0] neg_hi:[0,1,0]
  v_pk_fma_f32 v[154:155], v[248:249], v[226:227], v[154:155] op_sel_hi:[1,0,1] neg_lo:[0,1,0] neg_hi:[0,1,0]
  v_pk_fma_f32 v[188:189], v[250:251], v[226:227], v[188:189] op_sel_hi:[1,0,1] neg_lo:[0,1,0] neg_hi:[0,1,0]
  v_pk_fma_f32 v[190:191], v[252:253], v[226:227], v[190:191] op_sel_hi:[1,0,1] neg_lo:[0,1,0] neg_hi:[0,1,0]
  v_mfma_f32_16x16x32_bf16 v[156:159], v[68:71], v[84:87], v[156:159]
  v_pk_mul_f32 v[116:117], v[116:117], v[226:227] op_sel:[0,1] op_sel_hi:[1,1]
  v_pk_mul_f32 v[118:119], v[118:119], v[226:227] op_sel:[0,1] op_sel_hi:[1,1]
  v_pk_mul_f32 v[152:153], v[152:153], v[226:227] op_sel:[0,1] op_sel_hi:[1,1]
  v_pk_mul_f32 v[154:155], v[154:155], v[226:227] op_sel:[0,1] op_sel_hi:[1,1]
  v_pk_mul_f32 v[188:189], v[188:189], v[226:227] op_sel:[0,1] op_sel_hi:[1,1]
  v_pk_mul_f32 v[190:191], v[190:191], v[226:227] op_sel:[0,1] op_sel_hi:[1,1]
  v_cvt_pk_bf16_f32 v22, v116, v117
  v_mfma_f32_16x16x32_bf16 v[192:195], v[72:75], v[84:87], v[192:195]
  v_cvt_pk_bf16_f32 v23, v118, v119
  ds_write_b64 v11, v[22:23] offset:3200
  v_cvt_pk_bf16_f32 v24, v152, v153
  v_cvt_pk_bf16_f32 v25, v154, v155
  ds_write_b64 v11, v[24:25] offset:3328
  v_cvt_pk_bf16_f32 v26, v188, v189
  v_cvt_pk_bf16_f32 v27, v190, v191
  v_mfma_f32_16x16x32_bf16 v[196:199], v[72:75], v[88:91], v[196:199]
  ds_write_b64 v11, v[26:27] offset:3456
  v_pk_fma_f32 v[120:121], v[242:243], v[228:229], v[120:121] op_sel_hi:[1,0,1] neg_lo:[0,1,0] neg_hi:[0,1,0]
  v_pk_fma_f32 v[122:123], v[244:245], v[228:229], v[122:123] op_sel_hi:[1,0,1] neg_lo:[0,1,0] neg_hi:[0,1,0]
  v_pk_fma_f32 v[156:157], v[246:247], v[228:229], v[156:157] op_sel_hi:[1,0,1] neg_lo:[0,1,0] neg_hi:[0,1,0]
  v_pk_fma_f32 v[158:159], v[248:249], v[228:229], v[158:159] op_sel_hi:[1,0,1] neg_lo:[0,1,0] neg_hi:[0,1,0]
  v_pk_fma_f32 v[192:193], v[250:251], v[228:229], v[192:193] op_sel_hi:[1,0,1] neg_lo:[0,1,0] neg_hi:[0,1,0]
  v_pk_fma_f32 v[194:195], v[252:253], v[228:229], v[194:195] op_sel_hi:[1,0,1] neg_lo:[0,1,0] neg_hi:[0,1,0]
  v_mfma_f32_16x16x32_bf16 v[160:163], v[68:71], v[88:91], v[160:163]
  v_pk_mul_f32 v[120:121], v[120:121], v[228:229] op_sel:[0,1] op_sel_hi:[1,1]
  v_pk_mul_f32 v[122:123], v[122:123], v[228:229] op_sel:[0,1] op_sel_hi:[1,1]
  v_pk_mul_f32 v[156:157], v[156:157], v[228:229] op_sel:[0,1] op_sel_hi:[1,1]
  v_pk_mul_f32 v[158:159], v[158:159], v[228:229] op_sel:[0,1] op_sel_hi:[1,1]
  v_pk_mul_f32 v[192:193], v[192:193], v[228:229] op_sel:[0,1] op_sel_hi:[1,1]
  v_pk_mul_f32 v[194:195], v[194:195], v[228:229] op_sel:[0,1] op_sel_hi:[1,1]
  v_cvt_pk_bf16_f32 v28, v120, v121
  v_mfma_f32_16x16x32_bf16 v[124:127], v[64:67], v[88:91], v[124:127]
  v_cvt_pk_bf16_f32 v29, v122, v123
  ds_write_b64 v11, v[28:29] offset:6400
  v_cvt_pk_bf16_f32 v30, v156, v157
  v_cvt_pk_bf16_f32 v31, v158, v159
  ds_write_b64 v11, v[30:31] offset:6528
  v_cvt_pk_bf16_f32 v32, v192, v193
  v_cvt_pk_bf16_f32 v33, v194, v195
  v_mfma_f32_16x16x32_bf16 v[128:131], v[64:67], v[92:95], v[128:131]
  ds_write_b64 v11, v[32:33] offset:6656
  v_pk_fma_f32 v[124:125], v[242:243], v[230:231], v[124:125] op_sel_hi:[1,0,1] neg_lo:[0,1,0] neg_hi:[0,1,0]
  v_pk_fma_f32 v[126:127], v[244:245], v[230:231], v[126:127] op_sel_hi:[1,0,1] neg_lo:[0,1,0] neg_hi:[0,1,0]
  v_pk_fma_f32 v[160:161], v[246:247], v[230:231], v[160:161] op_sel_hi:[1,0,1] neg_lo:[0,1,0] neg_hi:[0,1,0]
  v_pk_fma_f32 v[162:163], v[248:249], v[230:231], v[162:163] op_sel_hi:[1,0,1] neg_lo:[0,1,0] neg_hi:[0,1,0]
  v_pk_fma_f32 v[196:197], v[250:251], v[230:231], v[196:197] op_sel_hi:[1,0,1] neg_lo:[0,1,0] neg_hi:[0,1,0]
  v_pk_fma_f32 v[198:199], v[252:253], v[230:231], v[198:199] op_sel_hi:[1,0,1] neg_lo:[0,1,0] neg_hi:[0,1,0]
  v_mfma_f32_16x16x32_bf16 v[164:167], v[68:71], v[92:95], v[164:167]
  v_pk_mul_f32 v[124:125], v[124:125], v[230:231] op_sel:[0,1] op_sel_hi:[1,1]
  v_pk_mul_f32 v[126:127], v[126:127], v[230:231] op_sel:[0,1] op_sel_hi:[1,1]
  v_pk_mul_f32 v[160:161], v[160:161], v[230:231] op_sel:[0,1] op_sel_hi:[1,1]
  v_pk_mul_f32 v[162:163], v[162:163], v[230:231] op_sel:[0,1] op_sel_hi:[1,1]
  v_pk_mul_f32 v[196:197], v[196:197], v[230:231] op_sel:[0,1] op_sel_hi:[1,1]
  v_pk_mul_f32 v[198:199], v[198:199], v[230:231] op_sel:[0,1] op_sel_hi:[1,1]
  v_cvt_pk_bf16_f32 v34, v124, v125
  v_mfma_f32_16x16x32_bf16 v[200:203], v[72:75], v[92:95], v[200:203]
  v_cvt_pk_bf16_f32 v35, v126, v127
  ds_write_b64 v11, v[34:35] offset:9600
  v_cvt_pk_bf16_f32 v36, v160, v161
  v_cvt_pk_bf16_f32 v37, v162, v163
  ds_write_b64 v11, v[36:37] offset:9728
  v_cvt_pk_bf16_f32 v38, v196, v197
  v_cvt_pk_bf16_f32 v39, v198, v199
  v_mfma_f32_16x16x32_bf16 v[204:207], v[72:75], v[96:99], v[204:207]
  ds_write_b64 v11, v[38:39] offset:9856
  v_pk_fma_f32 v[128:129], v[242:243], v[232:233], v[128:129] op_sel_hi:[1,0,1] neg_lo:[0,1,0] neg_hi:[0,1,0]
  v_pk_fma_f32 v[130:131], v[244:245], v[232:233], v[130:131] op_sel_hi:[1,0,1] neg_lo:[0,1,0] neg_hi:[0,1,0]
  v_pk_fma_f32 v[164:165], v[246:247], v[232:233], v[164:165] op_sel_hi:[1,0,1] neg_lo:[0,1,0] neg_hi:[0,1,0]
  v_pk_fma_f32 v[166:167], v[248:249], v[232:233], v[166:167] op_sel_hi:[1,0,1] neg_lo:[0,1,0] neg_hi:[0,1,0]
  v_pk_fma_f32 v[200:201], v[250:251], v[232:233], v[200:201] op_sel_hi:[1,0,1] neg_lo:[0,1,0] neg_hi:[0,1,0]
  v_pk_fma_f32 v[202:203], v[252:253], v[232:233], v[202:203] op_sel_hi:[1,0,1] neg_lo:[0,1,0] neg_hi:[0,1,0]
  v_mfma_f32_16x16x32_bf16 v[168:171], v[68:71], v[96:99], v[168:171]
  v_pk_mul_f32 v[128:129], v[128:129], v[232:233] op_sel:[0,1] op_sel_hi:[1,1]
  v_pk_mul_f32 v[130:131], v[130:131], v[232:233] op_sel:[0,1] op_sel_hi:[1,1]
  v_pk_mul_f32 v[164:165], v[164:165], v[232:233] op_sel:[0,1] op_sel_hi:[1,1]
  v_pk_mul_f32 v[166:167], v[166:167], v[232:233] op_sel:[0,1] op_sel_hi:[1,1]
  v_pk_mul_f32 v[200:201], v[200:201], v[232:233] op_sel:[0,1] op_sel_hi:[1,1]
  v_pk_mul_f32 v[202:203], v[202:203], v[232:233] op_sel:[0,1] op_sel_hi:[1,1]
  v_cvt_pk_bf16_f32 v40, v128, v129
  v_mfma_f32_16x16x32_bf16 v[132:135], v[64:67], v[96:99], v[132:135]
  v_cvt_pk_bf16_f32 v41, v130, v131
  ds_write_b64 v11, v[40:41] offset:12800
  v_cvt_pk_bf16_f32 v42, v164, v165
  v_cvt_pk_bf16_f32 v43, v166, v167
  ds_write_b64 v11, v[42:43] offset:12928
  v_cvt_pk_bf16_f32 v44, v200, v201
  v_cvt_pk_bf16_f32 v45, v202, v203
  v_mfma_f32_16x16x32_bf16 v[136:139], v[64:67], v[100:103], v[136:139]
  ds_write_b64 v11, v[44:45] offset:13056
  v_pk_fma_f32 v[132:133], v[242:243], v[234:235], v[132:133] op_sel_hi:[1,0,1] neg_lo:[0,1,0] neg_hi:[0,1,0]
  v_pk_fma_f32 v[134:135], v[244:245], v[234:235], v[134:135] op_sel_hi:[1,0,1] neg_lo:[0,1,0] neg_hi:[0,1,0]
  v_pk_fma_f32 v[168:169], v[246:247], v[234:235], v[168:169] op_sel_hi:[1,0,1] neg_lo:[0,1,0] neg_hi:[0,1,0]
  v_pk_fma_f32 v[170:171], v[248:249], v[234:235], v[170:171] op_sel_hi:[1,0,1] neg_lo:[0,1,0] neg_hi:[0,1,0]
  v_pk_fma_f32 v[204:205], v[250:251], v[234:235], v[204:205] op_sel_hi:[1,0,1] neg_lo:[0,1,0] neg_hi:[0,1,0]
  v_pk_fma_f32 v[206:207], v[252:253], v[234:235], v[206:207] op_sel_hi:[1,0,1] neg_lo:[0,1,0] neg_hi:[0,1,0]
  v_mfma_f32_16x16x32_bf16 v[172:175], v[68:71], v[100:103], v[172:175]
  v_pk_mul_f32 v[132:133], v[132:133], v[234:235] op_sel:[0,1] op_sel_hi:[1,1]
  v_pk_mul_f32 v[134:135], v[134:135], v[234:235] op_sel:[0,1] op_sel_hi:[1,1]
  v_pk_mul_f32 v[168:169], v[168:169], v[234:235] op_sel:[0,1] op_sel_hi:[1,1]
  v_pk_mul_f32 v[170:171], v[170:171], v[234:235] op_sel:[0,1] op_sel_hi:[1,1]
  v_pk_mul_f32 v[204:205], v[204:205], v[234:235] op_sel:[0,1] op_sel_hi:[1,1]
  v_pk_mul_f32 v[206:207], v[206:207], v[234:235] op_sel:[0,1] op_sel_hi:[1,1]
  v_cvt_pk_bf16_f32 v46, v132, v133
  v_mfma_f32_16x16x32_bf16 v[208:211], v[72:75], v[100:103], v[208:211]
  v_cvt_pk_bf16_f32 v47, v134, v135
  ds_write_b64 v11, v[46:47] offset:16000
  v_cvt_pk_bf16_f32 v48, v168, v169
  v_cvt_pk_bf16_f32 v49, v170, v171
  ds_write_b64 v11, v[48:49] offset:16128
  v_cvt_pk_bf16_f32 v50, v204, v205
  v_cvt_pk_bf16_f32 v51, v206, v207
  v_mfma_f32_16x16x32_bf16 v[212:215], v[72:75], v[104:107], v[212:215]
  ds_write_b64 v11, v[50:51] offset:16256
  v_pk_fma_f32 v[136:137], v[242:243], v[236:237], v[136:137] op_sel_hi:[1,0,1] neg_lo:[0,1,0] neg_hi:[0,1,0]
  v_pk_fma_f32 v[138:139], v[244:245], v[236:237], v[138:139] op_sel_hi:[1,0,1] neg_lo:[0,1,0] neg_hi:[0,1,0]
  v_pk_fma_f32 v[172:173], v[246:247], v[236:237], v[172:173] op_sel_hi:[1,0,1] neg_lo:[0,1,0] neg_hi:[0,1,0]
  v_pk_fma_f32 v[174:175], v[248:249], v[236:237], v[174:175] op_sel_hi:[1,0,1] neg_lo:[0,1,0] neg_hi:[0,1,0]
  v_pk_fma_f32 v[208:209], v[250:251], v[236:237], v[208:209] op_sel_hi:[1,0,1] neg_lo:[0,1,0] neg_hi:[0,1,0]
  v_pk_fma_f32 v[210:211], v[252:253], v[236:237], v[210:211] op_sel_hi:[1,0,1] neg_lo:[0,1,0] neg_hi:[0,1,0]
  v_mfma_f32_16x16x32_bf16 v[176:179], v[68:71], v[104:107], v[176:179]
  v_pk_mul_f32 v[136:137], v[136:137], v[236:237] op_sel:[0,1] op_sel_hi:[1,1]
  v_pk_mul_f32 v[138:139], v[138:139], v[236:237] op_sel:[0,1] op_sel_hi:[1,1]
  v_pk_mul_f32 v[172:173], v[172:173], v[236:237] op_sel:[0,1] op_sel_hi:[1,1]
  v_pk_mul_f32 v[174:175], v[174:175], v[236:237] op_sel:[0,1] op_sel_hi:[1,1]
  v_pk_mul_f32 v[208:209], v[208:209], v[236:237] op_sel:[0,1] op_sel_hi:[1,1]
  v_pk_mul_f32 v[210:211], v[210:211], v[236:237] op_sel:[0,1] op_sel_hi:[1,1]
  v_cvt_pk_bf16_f32 v52, v136, v137
  v_mfma_f32_16x16x32_bf16 v[140:143], v[64:67], v[104:107], v[140:143]
  v_cvt_pk_bf16_f32 v53, v138, v139
  ds_write_b64 v11, v[52:53] offset:19200
  v_cvt_pk_bf16_f32 v54, v172, v173
  v_cvt_pk_bf16_f32 v55, v174, v175
  ds_write_b64 v11, v[54:55] offset:19328
  v_cvt_pk_bf16_f32 v56, v208, v209
  v_cvt_pk_bf16_f32 v57, v210, v211
  v_mfma_f32_16x16x32_bf16 v[144:147], v[64:67], v[108:111], v[144:147]
  ds_write_b64 v11, v[56:57] offset:19456
  v_pk_fma_f32 v[140:141], v[242:243], v[238:239], v[140:141] op_sel_hi:[1,0,1] neg_lo:[0,1,0] neg_hi:[0,1,0]
  v_pk_fma_f32 v[142:143], v[244:245], v[238:239], v[142:143] op_sel_hi:[1,0,1] neg_lo:[0,1,0] neg_hi:[0,1,0]
  v_pk_fma_f32 v[176:177], v[246:247], v[238:239], v[176:177] op_sel_hi:[1,0,1] neg_lo:[0,1,0] neg_hi:[0,1,0]
  v_pk_fma_f32 v[178:179], v[248:249], v[238:239], v[178:179] op_sel_hi:[1,0,1] neg_lo:[0,1,0] neg_hi:[0,1,0]
  v_pk_fma_f32 v[212:213], v[250:251], v[238:239], v[212:213] op_sel_hi:[1,0,1] neg_lo:[0,1,0] neg_hi:[0,1,0]
  v_pk_fma_f32 v[214:215], v[252:253], v[238:239], v[214:215] op_sel_hi:[1,0,1] neg_lo:[0,1,0] neg_hi:[0,1,0]
  v_mfma_f32_16x16x32_bf16 v[180:183], v[68:71], v[108:111], v[180:183]
  v_pk_mul_f32 v[140:141], v[140:141], v[238:239] op_sel:[0,1] op_sel_hi:[1,1]
  v_pk_mul_f32 v[142:143], v[142:143], v[238:239] op_sel:[0,1] op_sel_hi:[1,1]
  v_pk_mul_f32 v[176:177], v[176:177], v[238:239] op_sel:[0,1] op_sel_hi:[1,1]
  v_pk_mul_f32 v[178:179], v[178:179], v[238:239] op_sel:[0,1] op_sel_hi:[1,1]
  v_pk_mul_f32 v[212:213], v[212:213], v[238:239] op_sel:[0,1] op_sel_hi:[1,1]
  v_pk_mul_f32 v[214:215], v[214:215], v[238:239] op_sel:[0,1] op_sel_hi:[1,1]
  v_cvt_pk_bf16_f32 v58, v140, v141
  v_mfma_f32_16x16x32_bf16 v[216:219], v[72:75], v[108:111], v[216:219]
  v_cvt_pk_bf16_f32 v59, v142, v143
  ds_write_b64 v11, v[58:59] offset:22400
  v_cvt_pk_bf16_f32 v60, v176, v177
  v_cvt_pk_bf16_f32 v61, v178, v179
  ds_write_b64 v11, v[60:61] offset:22528
  v_cvt_pk_bf16_f32 v62, v212, v213
  v_cvt_pk_bf16_f32 v63, v214, v215
  s_barrier
  ds_write_b64 v11, v[62:63] offset:22656
  v_pk_fma_f32 v[144:145], v[242:243], v[240:241], v[144:145] op_sel_hi:[1,0,1] neg_lo:[0,1,0] neg_hi:[0,1,0]
  v_pk_fma_f32 v[146:147], v[244:245], v[240:241], v[146:147] op_sel_hi:[1,0,1] neg_lo:[0,1,0] neg_hi:[0,1,0]
  v_pk_fma_f32 v[180:181], v[246:247], v[240:241], v[180:181] op_sel_hi:[1,0,1] neg_lo:[0,1,0] neg_hi:[0,1,0]
  v_pk_fma_f32 v[182:183], v[248:249], v[240:241], v[182:183] op_sel_hi:[1,0,1] neg_lo:[0,1,0] neg_hi:[0,1,0]
  v_pk_fma_f32 v[216:217], v[250:251], v[240:241], v[216:217] op_sel_hi:[1,0,1] neg_lo:[0,1,0] neg_hi:[0,1,0]
  v_pk_fma_f32 v[218:219], v[252:253], v[240:241], v[218:219] op_sel_hi:[1,0,1] neg_lo:[0,1,0] neg_hi:[0,1,0]
  v_pk_mul_f32 v[144:145], v[144:145], v[240:241] op_sel:[0,1] op_sel_hi:[1,1]
  v_pk_mul_f32 v[146:147], v[146:147], v[240:241] op_sel:[0,1] op_sel_hi:[1,1]
  v_pk_mul_f32 v[180:181], v[180:181], v[240:241] op_sel:[0,1] op_sel_hi:[1,1]
  v_pk_mul_f32 v[182:183], v[182:183], v[240:241] op_sel:[0,1] op_sel_hi:[1,1]
  v_pk_mul_f32 v[216:217], v[216:217], v[240:241] op_sel:[0,1] op_sel_hi:[1,1]
  v_pk_mul_f32 v[218:219], v[218:219], v[240:241] op_sel:[0,1] op_sel_hi:[1,1]
  v_cvt_pk_bf16_f32 v16, v144, v145
  v_cvt_pk_bf16_f32 v17, v146, v147
  ds_write_b64 v11, v[16:17] offset:25600
  v_cvt_pk_bf16_f32 v18, v180, v181
  v_cvt_pk_bf16_f32 v19, v182, v183
  ds_write_b64 v11, v[18:19] offset:25728
  v_cvt_pk_bf16_f32 v20, v216, v217
  v_cvt_pk_bf16_f32 v21, v218, v219
  ds_write_b64 v11, v[20:21] offset:25856
attn:
  s_nop 7
  s_nop 7
  v_mov_b32 v18, 0x3e8293ee
  v_mov_b32 v19, 0xff800000
  s_mov_b32 s20, s82
  s_mov_b32 s21, s83
  s_mov_b32 s22, 4194304
  s_mov_b32 s23, 0x20000
  s_waitcnt lgkmcnt(0)
  s_barrier
  ds_read_b128 v[32:35], v223 offset:0
  ds_read_b128 v[36:39], v220 offset:0
  ds_read_b128 v[40:43], v221 offset:0
  ds_read_b128 v[80:83], v223 offset:64
  ds_read_b128 v[84:87], v220 offset:64
  ds_read_b128 v[88:91], v221 offset:64
  ds_read_b64_tr_b16 v[44:45], v222 offset:0
  ds_read_b64_tr_b16 v[46:47], v254 offset:0
  ds_read_b64_tr_b16 v[48:49], v222 offset:8
  ds_read_b64_tr_b16 v[50:51], v254 offset:8
  ds_read_b64_tr_b16 v[92:93], v222 offset:64
  ds_read_b64_tr_b16 v[94:95], v254 offset:64
  ds_read_b64_tr_b16 v[96:97], v222 offset:72
  ds_read_b64_tr_b16 v[98:99], v254 offset:72
  s_waitcnt lgkmcnt(11)
  v_mfma_f32_16x16x32_bf16 v[52:55], v[36:39], v[32:35], 0
  v_mfma_f32_16x16x32_bf16 v[56:59], v[40:43], v[32:35], 0
  s_waitcnt lgkmcnt(8)
  v_mfma_f32_16x16x32_bf16 v[100:103], v[84:87], v[80:83], 0
  v_mfma_f32_16x16x32_bf16 v[104:107], v[88:91], v[80:83], 0
  s_nop 3
  v_cndmask_b32 v52, v19, v52, s[86:87]
  s_nop 1
  v_cndmask_b32 v100, v19, v100, s[86:87]
  v_cndmask_b32 v53, v19, v53, s[88:89]
  v_cndmask_b32 v101, v19, v101, s[88:89]
  v_cndmask_b32 v54, v19, v54, s[90:91]
  v_cndmask_b32 v102, v19, v102, s[90:91]
  v_cndmask_b32 v55, v19, v55, s[92:93]
  v_cndmask_b32 v103, v19, v103, s[92:93]
  v_cndmask_b32 v56, v19, v56, s[94:95]
  v_cndmask_b32 v104, v19, v104, s[94:95]
  v_cndmask_b32 v57, v19, v57, s[96:97]
  v_cndmask_b32 v105, v19, v105, s[96:97]
  v_cndmask_b32 v58, v19, v58, s[98:99]
  v_cndmask_b32 v106, v19, v106, s[98:99]
  v_cndmask_b32 v59, v19, v59, s[100:101]
  v_cndmask_b32 v107, v19, v107, s[100:101]
  v_max3_f32 v60, v52, v53, v54
  v_max3_f32 v108, v100, v101, v102
  v_max3_f32 v61, v55, v56, v57
  v_max3_f32 v109, v103, v104, v105
  v_max3_f32 v60, v60, v58, v59
  v_max3_f32 v108, v108, v106, v107
  v_max_f32 v60, v60, v61
  v_max_f32 v108, v108, v109
  v_mov_b32 v61, v60
  v_mov_b32 v109, v108
  s_nop 0
  v_permlane16_swap_b32 v60, v61
  v_permlane16_swap_b32 v108, v109
  v_max_f32 v60, v60, v61
  v_max_f32 v108, v108, v109
  v_mov_b32 v61, v60
  v_mov_b32 v109, v108
  s_nop 0
  v_permlane32_swap_b32 v60, v61
  v_permlane32_swap_b32 v108, v109
  v_max_f32 v60, v60, v61
  v_max_f32 v108, v108, v109
  v_mul_f32 v60, v18, v60
  v_mul_f32 v108, v18, v108
  v_fma_f32 v52, v52, v18, -v60
  v_fma_f32 v100, v100, v18, -v108
  v_fma_f32 v53, v53, v18, -v60
  v_fma_f32 v101, v101, v18, -v108
  v_fma_f32 v54, v54, v18, -v60
  v_fma_f32 v102, v102, v18, -v108
  v_fma_f32 v55, v55, v18, -v60
  v_fma_f32 v103, v103, v18, -v108
  v_fma_f32 v56, v56, v18, -v60
  v_fma_f32 v104, v104, v18, -v108
  v_fma_f32 v57, v57, v18, -v60
  v_fma_f32 v105, v105, v18, -v108
  v_fma_f32 v58, v58, v18, -v60
  v_fma_f32 v106, v106, v18, -v108
  v_fma_f32 v59, v59, v18, -v60
  v_fma_f32 v107, v107, v18, -v108
  v_exp_f32 v52, v52
  v_exp_f32 v100, v100
  v_exp_f32 v53, v53
  v_exp_f32 v101, v101
  v_exp_f32 v54, v54
  v_exp_f32 v102, v102
  v_exp_f32 v55, v55
  v_exp_f32 v103, v103
  v_exp_f32 v56, v56
  v_exp_f32 v104, v104
  v_exp_f32 v57, v57
  v_exp_f32 v105, v105
  v_exp_f32 v58, v58
  v_exp_f32 v106, v106
  v_exp_f32 v59, v59
  v_exp_f32 v107, v107
  v_pk_add_f32 v[60:61], v[52:53], v[54:55]
  v_pk_add_f32 v[108:109], v[100:101], v[102:103]
  v_pk_add_f32 v[62:63], v[56:57], v[58:59]
  v_pk_add_f32 v[110:111], v[104:105], v[106:107]
  v_pk_add_f32 v[60:61], v[60:61], v[62:63]
  v_pk_add_f32 v[108:109], v[108:109], v[110:111]
  v_add_f32 v60, v60, v61
  v_add_f32 v108, v108, v109
  v_mov_b32 v61, v60
  v_mov_b32 v109, v108
  s_nop 0
  v_permlane16_swap_b32 v60, v61
  v_permlane16_swap_b32 v108, v109
  v_add_f32 v60, v60, v61
  v_add_f32 v108, v108, v109
  v_mov_b32 v61, v60
  v_mov_b32 v109, v108
  s_nop 0
  v_permlane32_swap_b32 v60, v61
  v_permlane32_swap_b32 v108, v109
  v_add_f32 v60, v60, v61
  v_add_f32 v108, v108, v109
  v_rcp_f32 v60, v60
  v_rcp_f32 v108, v108
  v_pk_mul_f32 v[52:53], v[52:53], v[60:61] op_sel_hi:[1,0]
  v_pk_mul_f32 v[100:101], v[100:101], v[108:109] op_sel_hi:[1,0]
  v_pk_mul_f32 v[54:55], v[54:55], v[60:61] op_sel_hi:[1,0]
  v_pk_mul_f32 v[102:103], v[102:103], v[108:109] op_sel_hi:[1,0]
  v_pk_mul_f32 v[56:57], v[56:57], v[60:61] op_sel_hi:[1,0]
  v_pk_mul_f32 v[104:105], v[104:105], v[108:109] op_sel_hi:[1,0]
  v_pk_mul_f32 v[58:59], v[58:59], v[60:61] op_sel_hi:[1,0]
  v_pk_mul_f32 v[106:107], v[106:107], v[108:109] op_sel_hi:[1,0]
  v_cvt_pk_bf16_f32 v64, v52, v53
  v_cvt_pk_bf16_f32 v112, v100, v101
  v_cvt_pk_bf16_f32 v65, v54, v55
  v_cvt_pk_bf16_f32 v113, v102, v103
  v_cvt_pk_bf16_f32 v66, v56, v57
  v_cvt_pk_bf16_f32 v114, v104, v105
  v_cvt_pk_bf16_f32 v67, v58, v59
  v_cvt_pk_bf16_f32 v115, v106, v107
  s_waitcnt lgkmcnt(0)
  v_mfma_f32_16x16x32_bf16 v[68:71], v[44:47], v[64:67], 0
  v_mfma_f32_16x16x32_bf16 v[116:119], v[92:95], v[112:115], 0
  v_mfma_f32_16x16x32_bf16 v[72:75], v[48:51], v[64:67], 0
  v_mfma_f32_16x16x32_bf16 v[120:123], v[96:99], v[112:115], 0
  s_nop 4
  v_cvt_pk_bf16_f32 v32, v68, v69
  v_cvt_pk_bf16_f32 v80, v116, v117
  v_cvt_pk_bf16_f32 v33, v70, v71
  v_cvt_pk_bf16_f32 v81, v118, v119
  v_cvt_pk_bf16_f32 v34, v72, v73
  v_cvt_pk_bf16_f32 v82, v120, v121
  v_cvt_pk_bf16_f32 v35, v74, v75
  v_cvt_pk_bf16_f32 v83, v122, v123
  buffer_store_dwordx4 v[32:35], v1, s[20:23], 0 offen offset:0 sc0 sc1
  buffer_store_dwordx4 v[80:83], v1, s[20:23], 0 offen offset:2048 sc0 sc1
  s_cmp_ge_u32 s4, 4
  s_cbranch_scc1 L_k1done
  s_lshl_b32 s32, s28, 2
  s_add_u32 s32, s32, s4
  s_lshl_b32 s34, s32, 16
  s_lshl_b32 s40, s32, 5
  v_lshlrev_b32 v13, 1, v4
  v_add_u32 v13, s40, v13
  v_lshlrev_b32 v12, 11, v13
  v_lshl_add_u32 v12, v3, 4, v12
  s_lshl_b32 s32, s29, 7
  v_add_u32 v12, s32, v12
  v_lshlrev_b32 v14, 4, v0
  s_mov_b32 s8, s82
  s_mov_b32 s9, s83
  s_mov_b32 s10, 4194304
  s_mov_b32 s11, 0x20000
  s_cmp_eq_u32 s3, 0
  s_cselect_b32 s16, s64, s84
  s_cselect_b32 s17, s65, s85
  s_cselect_b32 s18, 0, 25165824
  s_add_u32 s16, s16, s18
  s_addc_u32 s17, s17, 0
  s_mov_b32 s18, 4194304
  s_mov_b32 s19, 0x20000
  s_cmp_eq_u32 s3, 0
  s_cselect_b32 s12, s84, s84
  s_cselect_b32 s13, s85, s85
  s_cselect_b32 s14, 0, 33554432
  s_add_u32 s12, s12, s14
  s_addc_u32 s13, s13, 0
  s_mov_b32 s14, 0
  s_mov_b32 s15, 0x20000
  s_add_u32 s12, s12, 20971520
  s_addc_u32 s13, s13, 0
  s_mov_b32 s14, 262144
  v_lshl_add_u32 v16, v5, 3, v6
  v_lshlrev_b32 v16, 7, v16
  v_lshl_add_u32 v16, v7, 3, v16
  v_lshrrev_b32 v17, 1, v6
  v_lshl_or_b32 v17, v2, 1, v17
  v_lshl_add_u32 v16, v17, 5, v16
  v_add_u32 v16, 131072, v16
  v_xor_b32 v8, 0, v16
  v_xor_b32 v9, 32, v16
  v_xor_b32 v10, 64, v16
  v_xor_b32 v11, 96, v16
  v_add_u32 v16, v13, v2
  v_lshlrev_b32 v16, 3, v16
  s_lshl_b32 s32, s29, 14
  v_add_u32 v112, s32, v16
  v_lshrrev_b32 v17, 5, v0
  v_lshlrev_b32 v17, 17, v17
  v_add_u32 v113, v16, v17
  s_lshl_b32 s32, s4, 12
  v_lshlrev_b32 v16, 8, v4
  v_lshl_add_u32 v16, v5, 3, v16
  v_add_u32 v16, s32, v16
  v_and_b32 v17, 1, v4
  v_bfe_u32 v18, v4, 2, 1
  v_lshl_or_b32 v17, v18, 1, v17
  v_lshl_add_u32 v114, v17, 5, v16
  s_lshl_b32 s44, s29, 8
  s_lshl_b32 s40, s28, 2
  s_add_u32 s44, s44, s40
  s_add_u32 s44, s44, s4
  s_lshl_b32 s44, s44, 10
  v_lshl_add_u32 v16, v5, 3, v6
  v_lshlrev_b32 v16, 7, v16
  v_lshl_add_u32 v16, v7, 3, v16
  v_lshrrev_b32 v17, 1, v6
  v_lshl_or_b32 v17, v2, 1, v17
  v_lshl_add_u32 v16, v17, 5, v16
  v_xor_b32 v115, 0, v16
  v_add_u32 v115, s32, v115
  s_add_u32 s45, s44, 65536
  s_add_u32 s46, s44, 131072
  s_add_u32 s47, s44, 196608
  v_add_u32 v80, 16384, v113
  v_add_u32 v81, 32768, v113
  v_add_u32 v82, 49152, v113
  v_add_u32 v83, 65536, v113
  v_add_u32 v84, 81920, v113
  v_add_u32 v85, 98304, v113
  v_add_u32 v86, 114688, v113
  s_lshl_b32 s48, 0x303, s7
  s_lshr_b32 s48, s48, 8
  s_mov_b32 s49, s34
  s_add_u32 s50, s34, 32768
  s_add_u32 s41, s34, 65536
  s_add_u32 s24, s84, 29360128
  s_addc_u32 s25, s85, 0
  s_mov_b32 s26, 262144
  s_mov_b32 s27, 0x20000
  s_lshl_b32 s32, s28, 4
  v_min_u32 v119, 15, v0
  v_add_u32 v119, s32, v119
  v_max_i32 v119, 0, v119
  v_lshlrev_b32 v119, 7, v119
  s_lshl_b32 s55, s3, 17
  s_add_u32 s55, s55, 0
  s_waitcnt vmcnt(0)
  s_barrier
  buffer_load_dwordx4 v[96:99], v12, s[16:19], 0 offen offset:0 sc1
  buffer_load_dwordx4 v[100:103], v12, s[16:19], 0 offen offset:64 sc1
  buffer_load_dwordx4 v[104:107], v12, s[16:19], 0 offen offset:2048 sc1
  buffer_load_dwordx4 v[108:111], v12, s[16:19], 0 offen offset:2112 sc1
  s_mov_b32 s39, 0
  s_and_b32 s32, s4, 3
  s_cmp_lg_u32 s32, 0
  s_cbranch_scc1 poll3d
  s_sleep 8
poll3:
  buffer_load_dword v16, v119, s[24:27], s55 offen sc0 sc1
  s_waitcnt vmcnt(0)
  v_cmp_eq_u32 vcc, 0, v16
  s_add_u32 s39, s39, 1
  s_cmp_gt_u32 s39, 1000000
  s_cbranch_scc1 poll3d
  s_cbranch_vccnz poll3
poll3d:
  s_barrier
  s_bitcmp1_b32 s48, 0
  s_cselect_b32 s36, s50, s49
  s_add_u32 s36, s36, 0
  buffer_load_dwordx4 v[120:123], v14, s[8:11], s36 offen offset:0 sc1
  buffer_load_dwordx4 v[124:127], v14, s[8:11], s36 offen offset:1024 sc1
  buffer_load_dwordx4 v[128:131], v14, s[8:11], s36 offen offset:2048 sc1
  buffer_load_dwordx4 v[132:135], v14, s[8:11], s36 offen offset:3072 sc1
  s_bitcmp1_b32 s48, 1
  s_cselect_b32 s36, s50, s49
  s_add_u32 s36, s36, 4096
  buffer_load_dwordx4 v[136:139], v14, s[8:11], s36 offen offset:0 sc1
  buffer_load_dwordx4 v[140:143], v14, s[8:11], s36 offen offset:1024 sc1
  buffer_load_dwordx4 v[144:147], v14, s[8:11], s36 offen offset:2048 sc1
  buffer_load_dwordx4 v[148:151], v14, s[8:11], s36 offen offset:3072 sc1
  s_bitcmp1_b32 s48, 2
  s_cselect_b32 s36, s50, s49
  s_add_u32 s36, s36, 8192
  buffer_load_dwordx4 v[152:155], v14, s[8:11], s36 offen offset:0 sc1
  buffer_load_dwordx4 v[156:159], v14, s[8:11], s36 offen offset:1024 sc1
  buffer_load_dwordx4 v[160:163], v14, s[8:11], s36 offen offset:2048 sc1
  buffer_load_dwordx4 v[164:167], v14, s[8:11], s36 offen offset:3072 sc1
  s_bitcmp1_b32 s48, 3
  s_cselect_b32 s36, s50, s49
  s_add_u32 s36, s36, 12288
  buffer_load_dwordx4 v[168:171], v14, s[8:11], s36 offen offset:0 sc1
  buffer_load_dwordx4 v[172:175], v14, s[8:11], s36 offen offset:1024 sc1
  s_waitcnt vmcnt(14)
  v_permlane16_swap_b32 v96, v98
  v_permlane16_swap_b32 v97, v99
  v_permlane16_swap_b32 v100, v102
  v_permlane16_swap_b32 v101, v103
  v_permlane16_swap_b32 v104, v106
  v_permlane16_swap_b32 v105, v107
  v_permlane16_swap_b32 v108, v110
  v_permlane16_swap_b32 v109, v111
  v_lshlrev_b32 v48, 16, v96
  v_and_b32 v49, 0xffff0000, v96
  v_lshlrev_b32 v50, 16, v97
  v_and_b32 v51, 0xffff0000, v97
  v_lshlrev_b32 v52, 16, v98
  v_and_b32 v53, 0xffff0000, v98
  v_lshlrev_b32 v54, 16, v99
  v_and_b32 v55, 0xffff0000, v99
  v_lshlrev_b32 v56, 16, v100
  v_and_b32 v57, 0xffff0000, v100
  v_lshlrev_b32 v58, 16, v101
  v_and_b32 v59, 0xffff0000, v101
  v_lshlrev_b32 v60, 16, v102
  v_and_b32 v61, 0xffff0000, v102
  v_lshlrev_b32 v62, 16, v103
  v_and_b32 v63, 0xffff0000, v103
  v_lshlrev_b32 v64, 16, v104
  v_and_b32 v65, 0xffff0000, v104
  v_lshlrev_b32 v66, 16, v105
  v_and_b32 v67, 0xffff0000, v105
  v_lshlrev_b32 v68, 16, v106
  v_and_b32 v69, 0xffff0000, v106
  v_lshlrev_b32 v70, 16, v107
  v_and_b32 v71, 0xffff0000, v107
  v_lshlrev_b32 v72, 16, v108
  v_and_b32 v73, 0xffff0000, v108
  v_lshlrev_b32 v74, 16, v109
  v_and_b32 v75, 0xffff0000, v109
  v_lshlrev_b32 v76, 16, v110
  v_and_b32 v77, 0xffff0000, v110
  v_lshlrev_b32 v78, 16, v111
  v_and_b32 v79, 0xffff0000, v111
  s_mov_b32 s43, 0
  s_mov_b32 s39, 1
  s_barrier
  ds_read_b64_tr_b16 v[16:17], v8 offset:0
  ds_read_b64_tr_b16 v[18:19], v8 offset:512
  ds_read_b64_tr_b16 v[20:21], v9 offset:0
  ds_read_b64_tr_b16 v[22:23], v9 offset:512
  ds_read_b64_tr_b16 v[24:25], v10 offset:0
  ds_read_b64_tr_b16 v[26:27], v10 offset:512
  ds_read_b64_tr_b16 v[28:29], v11 offset:0
  ds_read_b64_tr_b16 v[30:31], v11 offset:512
  s_waitcnt vmcnt(13) lgkmcnt(6)
  v_mfma_f32_16x16x32_bf16 v[48:51], v[16:19], v[120:123], v[48:51]
  ds_read_b64_tr_b16 v[32:33], v8 offset:4096
  s_waitcnt vmcnt(12)
  v_mfma_f32_16x16x32_bf16 v[64:67], v[16:19], v[124:127], v[64:67]
  ds_read_b64_tr_b16 v[34:35], v8 offset:4608
  v_add_u32 v8, 8192, v8
  s_waitcnt lgkmcnt(6)
  v_mfma_f32_16x16x32_bf16 v[68:71], v[20:23], v[124:127], v[68:71]
  ds_read_b64_tr_b16 v[36:37], v9 offset:4096
  buffer_load_dwordx4 v[176:179], v14, s[8:11], s36 offen offset:2048 sc1
  v_mfma_f32_16x16x32_bf16 v[52:55], v[20:23], v[120:123], v[52:55]
  ds_read_b64_tr_b16 v[38:39], v9 offset:4608
  v_add_u32 v9, 8192, v9
  s_waitcnt lgkmcnt(6)
  v_mfma_f32_16x16x32_bf16 v[56:59], v[24:27], v[120:123], v[56:59]
  ds_read_b64_tr_b16 v[40:41], v10 offset:4096
  v_mfma_f32_16x16x32_bf16 v[72:75], v[24:27], v[124:127], v[72:75]
  ds_read_b64_tr_b16 v[42:43], v10 offset:4608
  v_add_u32 v10, 8192, v10
  s_waitcnt lgkmcnt(6)
  v_mfma_f32_16x16x32_bf16 v[76:79], v[28:31], v[124:127], v[76:79]
  ds_read_b64_tr_b16 v[44:45], v11 offset:4096
  buffer_load_dwordx4 v[180:183], v14, s[8:11], s36 offen offset:3072 sc1
  v_mfma_f32_16x16x32_bf16 v[60:63], v[28:31], v[120:123], v[60:63]
  ds_read_b64_tr_b16 v[46:47], v11 offset:4608
  v_add_u32 v11, 8192, v11
  s_waitcnt vmcnt(13) lgkmcnt(6)
  v_mfma_f32_16x16x32_bf16 v[48:51], v[32:35], v[128:131], v[48:51]
  ds_read_b64_tr_b16 v[16:17], v8 offset:0
  s_bitcmp1_b32 s48, 4
  s_cselect_b32 s36, s50, s49
  s_waitcnt vmcnt(12)
  v_mfma_f32_16x16x32_bf16 v[64:67], v[32:35], v[132:135], v[64:67]
  ds_read_b64_tr_b16 v[18:19], v8 offset:512
  s_add_u32 s36, s36, 16384
  s_waitcnt lgkmcnt(6)
  v_mfma_f32_16x16x32_bf16 v[68:71], v[36:39], v[132:135], v[68:71]
  ds_read_b64_tr_b16 v[20:21], v9 offset:0
  v_mfma_f32_16x16x32_bf16 v[52:55], v[36:39], v[128:131], v[52:55]
  ds_read_b64_tr_b16 v[22:23], v9 offset:512
  s_waitcnt lgkmcnt(6)
  v_mfma_f32_16x16x32_bf16 v[56:59], v[40:43], v[128:131], v[56:59]
  ds_read_b64_tr_b16 v[24:25], v10 offset:0
  buffer_load_dwordx4 v[120:123], v14, s[8:11], s36 offen offset:0 sc1
  v_mfma_f32_16x16x32_bf16 v[72:75], v[40:43], v[132:135], v[72:75]
  ds_read_b64_tr_b16 v[26:27], v10 offset:512
  s_waitcnt lgkmcnt(6)
  v_mfma_f32_16x16x32_bf16 v[76:79], v[44:47], v[132:135], v[76:79]
  ds_read_b64_tr_b16 v[28:29], v11 offset:0
  v_mfma_f32_16x16x32_bf16 v[60:63], v[44:47], v[128:131], v[60:63]
  ds_read_b64_tr_b16 v[30:31], v11 offset:512
  buffer_load_dwordx4 v[124:127], v14, s[8:11], s36 offen offset:1024 sc1
  s_waitcnt vmcnt(13) lgkmcnt(6)
  v_mfma_f32_16x16x32_bf16 v[48:51], v[16:19], v[136:139], v[48:51]
  ds_read_b64_tr_b16 v[32:33], v8 offset:4096
  s_waitcnt vmcnt(12)
  v_mfma_f32_16x16x32_bf16 v[64:67], v[16:19], v[140:143], v[64:67]
  ds_read_b64_tr_b16 v[34:35], v8 offset:4608
  v_add_u32 v8, 8192, v8
  s_waitcnt lgkmcnt(6)
  v_mfma_f32_16x16x32_bf16 v[68:71], v[20:23], v[140:143], v[68:71]
  ds_read_b64_tr_b16 v[36:37], v9 offset:4096
  buffer_load_dwordx4 v[128:131], v14, s[8:11], s36 offen offset:2048 sc1
  v_mfma_f32_16x16x32_bf16 v[52:55], v[20:23], v[136:139], v[52:55]
  ds_read_b64_tr_b16 v[38:39], v9 offset:4608
  v_add_u32 v9, 8192, v9
  s_waitcnt lgkmcnt(6)
  v_mfma_f32_16x16x32_bf16 v[56:59], v[24:27], v[136:139], v[56:59]
  ds_read_b64_tr_b16 v[40:41], v10 offset:4096
  v_mfma_f32_16x16x32_bf16 v[72:75], v[24:27], v[140:143], v[72:75]
  ds_read_b64_tr_b16 v[42:43], v10 offset:4608
  v_add_u32 v10, 8192, v10
  s_waitcnt lgkmcnt(6)
  v_mfma_f32_16x16x32_bf16 v[76:79], v[28:31], v[140:143], v[76:79]
  ds_read_b64_tr_b16 v[44:45], v11 offset:4096
  buffer_load_dwordx4 v[132:135], v14, s[8:11], s36 offen offset:3072 sc1
  v_mfma_f32_16x16x32_bf16 v[60:63], v[28:31], v[136:139], v[60:63]
  ds_read_b64_tr_b16 v[46:47], v11 offset:4608
  v_add_u32 v11, 8192, v11
  s_waitcnt vmcnt(13) lgkmcnt(6)
  v_mfma_f32_16x16x32_bf16 v[48:51], v[32:35], v[144:147], v[48:51]
  ds_read_b64_tr_b16 v[16:17], v8 offset:0
  s_bitcmp1_b32 s48, 5
  s_cselect_b32 s36, s50, s49
  s_waitcnt vmcnt(12)
  v_mfma_f32_16x16x32_bf16 v[64:67], v[32:35], v[148:151], v[64:67]
  ds_read_b64_tr_b16 v[18:19], v8 offset:512
  s_add_u32 s36, s36, 20480
  s_waitcnt lgkmcnt(6)
  v_mfma_f32_16x16x32_bf16 v[68:71], v[36:39], v[148:151], v[68:71]
  ds_read_b64_tr_b16 v[20:21], v9 offset:0
  v_mfma_f32_16x16x32_bf16 v[52:55], v[36:39], v[144:147], v[52:55]
  ds_read_b64_tr_b16 v[22:23], v9 offset:512
  s_waitcnt lgkmcnt(6)
  v_mfma_f32_16x16x32_bf16 v[56:59], v[40:43], v[144:147], v[56:59]
  ds_read_b64_tr_b16 v[24:25], v10 offset:0
  buffer_load_dwordx4 v[136:139], v14, s[8:11], s36 offen offset:0 sc1
  v_mfma_f32_16x16x32_bf16 v[72:75], v[40:43], v[148:151], v[72:75]
  ds_read_b64_tr_b16 v[26:27], v10 offset:512
  s_waitcnt lgkmcnt(6)
  v_mfma_f32_16x16x32_bf16 v[76:79], v[44:47], v[148:151], v[76:79]
  ds_read_b64_tr_b16 v[28:29], v11 offset:0
  v_mfma_f32_16x16x32_bf16 v[60:63], v[44:47], v[144:147], v[60:63]
  ds_read_b64_tr_b16 v[30:31], v11 offset:512
  buffer_load_dwordx4 v[140:143], v14, s[8:11], s36 offen offset:1024 sc1
  s_waitcnt vmcnt(13) lgkmcnt(6)
  v_mfma_f32_16x16x32_bf16 v[48:51], v[16:19], v[152:155], v[48:51]
  ds_read_b64_tr_b16 v[32:33], v8 offset:4096
  s_waitcnt vmcnt(12)
  v_mfma_f32_16x16x32_bf16 v[64:67], v[16:19], v[156:159], v[64:67]
  ds_read_b64_tr_b16 v[34:35], v8 offset:4608
  v_add_u32 v8, 8192, v8
  s_waitcnt lgkmcnt(6)
  v_mfma_f32_16x16x32_bf16 v[68:71], v[20:23], v[156:159], v[68:71]
  ds_read_b64_tr_b16 v[36:37], v9 offset:4096
  buffer_load_dwordx4 v[144:147], v14, s[8:11], s36 offen offset:2048 sc1
  v_mfma_f32_16x16x32_bf16 v[52:55], v[20:23], v[152:155], v[52:55]
  ds_read_b64_tr_b16 v[38:39], v9 offset:4608
  v_add_u32 v9, 8192, v9
  s_waitcnt lgkmcnt(6)
  v_mfma_f32_16x16x32_bf16 v[56:59], v[24:27], v[152:155], v[56:59]
  ds_read_b64_tr_b16 v[40:41], v10 offset:4096
  v_mfma_f32_16x16x32_bf16 v[72:75], v[24:27], v[156:159], v[72:75]
  ds_read_b64_tr_b16 v[42:43], v10 offset:4608
  v_add_u32 v10, 8192, v10
  s_waitcnt lgkmcnt(6)
  v_mfma_f32_16x16x32_bf16 v[76:79], v[28:31], v[156:159], v[76:79]
  ds_read_b64_tr_b16 v[44:45], v11 offset:4096
  buffer_load_dwordx4 v[148:151], v14, s[8:11], s36 offen offset:3072 sc1
  v_mfma_f32_16x16x32_bf16 v[60:63], v[28:31], v[152:155], v[60:63]
  ds_read_b64_tr_b16 v[46:47], v11 offset:4608
  v_add_u32 v11, 8192, v11
  s_waitcnt vmcnt(13) lgkmcnt(6)
  v_mfma_f32_16x16x32_bf16 v[48:51], v[32:35], v[160:163], v[48:51]
  ds_read_b64_tr_b16 v[16:17], v8 offset:0
  s_bitcmp1_b32 s48, 6
  s_cselect_b32 s36, s50, s49
  s_waitcnt vmcnt(12)
  v_mfma_f32_16x16x32_bf16 v[64:67], v[32:35], v[164:167], v[64:67]
  ds_read_b64_tr_b16 v[18:19], v8 offset:512
  s_add_u32 s36, s36, 24576
  s_waitcnt lgkmcnt(6)
  v_mfma_f32_16x16x32_bf16 v[68:71], v[36:39], v[164:167], v[68:71]
  ds_read_b64_tr_b16 v[20:21], v9 offset:0
  v_mfma_f32_16x16x32_bf16 v[52:55], v[36:39], v[160:163], v[52:55]
  ds_read_b64_tr_b16 v[22:23], v9 offset:512
  s_waitcnt lgkmcnt(6)
  v_mfma_f32_16x16x32_bf16 v[56:59], v[40:43], v[160:163], v[56:59]
  ds_read_b64_tr_b16 v[24:25], v10 offset:0
  buffer_load_dwordx4 v[152:155], v14, s[8:11], s36 offen offset:0 sc1
  v_mfma_f32_16x16x32_bf16 v[72:75], v[40:43], v[164:167], v[72:75]
  ds_read_b64_tr_b16 v[26:27], v10 offset:512
  s_waitcnt lgkmcnt(6)
  v_mfma_f32_16x16x32_bf16 v[76:79], v[44:47], v[164:167], v[76:79]
  ds_read_b64_tr_b16 v[28:29], v11 offset:0
  v_mfma_f32_16x16x32_bf16 v[60:63], v[44:47], v[160:163], v[60:63]
  ds_read_b64_tr_b16 v[30:31], v11 offset:512
  buffer_load_dwordx4 v[156:159], v14, s[8:11], s36 offen offset:1024 sc1
  s_waitcnt vmcnt(13) lgkmcnt(6)
  v_mfma_f32_16x16x32_bf16 v[48:51], v[16:19], v[168:171], v[48:51]
  ds_read_b64_tr_b16 v[32:33], v8 offset:4096
  s_waitcnt vmcnt(12)
  v_mfma_f32_16x16x32_bf16 v[64:67], v[16:19], v[172:175], v[64:67]
  ds_read_b64_tr_b16 v[34:35], v8 offset:4608
  v_add_u32 v8, 4294912256, v8
  s_waitcnt lgkmcnt(6)
  v_mfma_f32_16x16x32_bf16 v[68:71], v[20:23], v[172:175], v[68:71]
  ds_read_b64_tr_b16 v[36:37], v9 offset:4096
  buffer_load_dwordx4 v[160:163], v14, s[8:11], s36 offen offset:2048 sc1
  v_mfma_f32_16x16x32_bf16 v[52:55], v[20:23], v[168:171], v[52:55]
  ds_read_b64_tr_b16 v[38:39], v9 offset:4608
  v_add_u32 v9, 4294912256, v9
  s_waitcnt lgkmcnt(6)
  v_mfma_f32_16x16x32_bf16 v[56:59], v[24:27], v[168:171], v[56:59]
  ds_read_b64_tr_b16 v[40:41], v10 offset:4096
  v_mfma_f32_16x16x32_bf16 v[72:75], v[24:27], v[172:175], v[72:75]
  ds_read_b64_tr_b16 v[42:43], v10 offset:4608
  v_add_u32 v10, 4294912256, v10
  s_waitcnt lgkmcnt(6)
  v_mfma_f32_16x16x32_bf16 v[76:79], v[28:31], v[172:175], v[76:79]
  ds_read_b64_tr_b16 v[44:45], v11 offset:4096
  buffer_load_dwordx4 v[164:167], v14, s[8:11], s36 offen offset:3072 sc1
  v_mfma_f32_16x16x32_bf16 v[60:63], v[28:31], v[168:171], v[60:63]
  ds_read_b64_tr_b16 v[46:47], v11 offset:4608
  v_add_u32 v11, 4294912256, v11
  s_waitcnt vmcnt(13) lgkmcnt(6)
  v_mfma_f32_16x16x32_bf16 v[48:51], v[32:35], v[176:179], v[48:51]
  ds_read_b64_tr_b16 v[16:17], v8 offset:0
  s_bitcmp1_b32 s48, 7
  s_cselect_b32 s36, s50, s49
  s_waitcnt vmcnt(12)
  v_mfma_f32_16x16x32_bf16 v[64:67], v[32:35], v[180:183], v[64:67]
  ds_read_b64_tr_b16 v[18:19], v8 offset:512
  s_add_u32 s36, s36, 28672
  s_waitcnt lgkmcnt(6)
  v_mfma_f32_16x16x32_bf16 v[68:71], v[36:39], v[180:183], v[68:71]
  ds_read_b64_tr_b16 v[20:21], v9 offset:0
  v_mfma_f32_16x16x32_bf16 v[52:55], v[36:39], v[176:179], v[52:55]
  ds_read_b64_tr_b16 v[22:23], v9 offset:512
  s_waitcnt lgkmcnt(6)
  v_mfma_f32_16x16x32_bf16 v[56:59], v[40:43], v[176:179], v[56:59]
  ds_read_b64_tr_b16 v[24:25], v10 offset:0
  buffer_load_dwordx4 v[168:171], v14, s[8:11], s36 offen offset:0 sc1
  v_mfma_f32_16x16x32_bf16 v[72:75], v[40:43], v[180:183], v[72:75]
  ds_read_b64_tr_b16 v[26:27], v10 offset:512
  s_waitcnt lgkmcnt(6)
  v_mfma_f32_16x16x32_bf16 v[76:79], v[44:47], v[180:183], v[76:79]
  ds_read_b64_tr_b16 v[28:29], v11 offset:0
  v_mfma_f32_16x16x32_bf16 v[60:63], v[44:47], v[176:179], v[60:63]
  ds_read_b64_tr_b16 v[30:31], v11 offset:512
  buffer_load_dwordx4 v[172:175], v14, s[8:11], s36 offen offset:1024 sc1
  s_waitcnt vmcnt(13) lgkmcnt(6)
  v_mfma_f32_16x16x32_bf16 v[48:51], v[16:19], v[120:123], v[48:51]
  ds_read_b64_tr_b16 v[32:33], v8 offset:4096
  s_waitcnt vmcnt(12)
  v_mfma_f32_16x16x32_bf16 v[64:67], v[16:19], v[124:127], v[64:67]
  ds_read_b64_tr_b16 v[34:35], v8 offset:4608
  v_add_u32 v8, 8192, v8
  s_waitcnt lgkmcnt(6)
  v_mfma_f32_16x16x32_bf16 v[68:71], v[20:23], v[124:127], v[68:71]
  ds_read_b64_tr_b16 v[36:37], v9 offset:4096
  buffer_load_dwordx4 v[176:179], v14, s[8:11], s36 offen offset:2048 sc1
  v_mfma_f32_16x16x32_bf16 v[52:55], v[20:23], v[120:123], v[52:55]
  ds_read_b64_tr_b16 v[38:39], v9 offset:4608
  v_add_u32 v9, 8192, v9
  s_waitcnt lgkmcnt(6)
  v_mfma_f32_16x16x32_bf16 v[56:59], v[24:27], v[120:123], v[56:59]
  ds_read_b64_tr_b16 v[40:41], v10 offset:4096
  v_mfma_f32_16x16x32_bf16 v[72:75], v[24:27], v[124:127], v[72:75]
  ds_read_b64_tr_b16 v[42:43], v10 offset:4608
  v_add_u32 v10, 8192, v10
  s_waitcnt lgkmcnt(6)
  v_mfma_f32_16x16x32_bf16 v[76:79], v[28:31], v[124:127], v[76:79]
  ds_read_b64_tr_b16 v[44:45], v11 offset:4096
  buffer_load_dwordx4 v[180:183], v14, s[8:11], s36 offen offset:3072 sc1
  v_mfma_f32_16x16x32_bf16 v[60:63], v[28:31], v[120:123], v[60:63]
  ds_read_b64_tr_b16 v[46:47], v11 offset:4608
  v_add_u32 v11, 8192, v11
  s_waitcnt vmcnt(13) lgkmcnt(6)
  v_mfma_f32_16x16x32_bf16 v[48:51], v[32:35], v[128:131], v[48:51]
  ds_read_b64_tr_b16 v[16:17], v8 offset:0
  s_mov_b32 s49, s50
  s_add_u32 s50, s50, 32768
  s_waitcnt vmcnt(12)
  v_mfma_f32_16x16x32_bf16 v[64:67], v[32:35], v[132:135], v[64:67]
  ds_read_b64_tr_b16 v[18:19], v8 offset:512
  s_cmp_eq_u32 s50, s41
  s_cselect_b32 s50, s34, s50
  s_waitcnt lgkmcnt(6)
  v_mfma_f32_16x16x32_bf16 v[68:71], v[36:39], v[132:135], v[68:71]
  ds_read_b64_tr_b16 v[20:21], v9 offset:0
  s_bitcmp1_b32 s48, 0
  s_cselect_b32 s36, s50, s49
  v_mfma_f32_16x16x32_bf16 v[52:55], v[36:39], v[128:131], v[52:55]
  ds_read_b64_tr_b16 v[22:23], v9 offset:512
  s_add_u32 s36, s36, 0
  s_waitcnt lgkmcnt(6)
  v_mfma_f32_16x16x32_bf16 v[56:59], v[40:43], v[128:131], v[56:59]
  ds_read_b64_tr_b16 v[24:25], v10 offset:0
  buffer_load_dwordx4 v[120:123], v14, s[8:11], s36 offen offset:0 sc1
  v_mfma_f32_16x16x32_bf16 v[72:75], v[40:43], v[132:135], v[72:75]
  ds_read_b64_tr_b16 v[26:27], v10 offset:512
  s_waitcnt lgkmcnt(6)
  v_mfma_f32_16x16x32_bf16 v[76:79], v[44:47], v[132:135], v[76:79]
  ds_read_b64_tr_b16 v[28:29], v11 offset:0
  v_mfma_f32_16x16x32_bf16 v[60:63], v[44:47], v[128:131], v[60:63]
  ds_read_b64_tr_b16 v[30:31], v11 offset:512
  buffer_load_dwordx4 v[124:127], v14, s[8:11], s36 offen offset:1024 sc1
  s_waitcnt vmcnt(13) lgkmcnt(6)
  v_mfma_f32_16x16x32_bf16 v[48:51], v[16:19], v[136:139], v[48:51]
  ds_read_b64_tr_b16 v[32:33], v8 offset:4096
  s_waitcnt vmcnt(12)
  v_mfma_f32_16x16x32_bf16 v[64:67], v[16:19], v[140:143], v[64:67]
  ds_read_b64_tr_b16 v[34:35], v8 offset:4608
  v_add_u32 v8, 8192, v8
  s_waitcnt lgkmcnt(6)
  v_mfma_f32_16x16x32_bf16 v[68:71], v[20:23], v[140:143], v[68:71]
  ds_read_b64_tr_b16 v[36:37], v9 offset:4096
  buffer_load_dwordx4 v[128:131], v14, s[8:11], s36 offen offset:2048 sc1
  v_mfma_f32_16x16x32_bf16 v[52:55], v[20:23], v[136:139], v[52:55]
  ds_read_b64_tr_b16 v[38:39], v9 offset:4608
  v_add_u32 v9, 8192, v9
  s_waitcnt lgkmcnt(6)
  v_mfma_f32_16x16x32_bf16 v[56:59], v[24:27], v[136:139], v[56:59]
  ds_read_b64_tr_b16 v[40:41], v10 offset:4096
  v_mfma_f32_16x16x32_bf16 v[72:75], v[24:27], v[140:143], v[72:75]
  ds_read_b64_tr_b16 v[42:43], v10 offset:4608
  v_add_u32 v10, 8192, v10
  s_waitcnt lgkmcnt(6)
  v_mfma_f32_16x16x32_bf16 v[76:79], v[28:31], v[140:143], v[76:79]
  ds_read_b64_tr_b16 v[44:45], v11 offset:4096
  buffer_load_dwordx4 v[132:135], v14, s[8:11], s36 offen offset:3072 sc1
  v_mfma_f32_16x16x32_bf16 v[60:63], v[28:31], v[136:139], v[60:63]
  ds_read_b64_tr_b16 v[46:47], v11 offset:4608
  v_add_u32 v11, 8192, v11
  s_waitcnt vmcnt(13) lgkmcnt(6)
  v_mfma_f32_16x16x32_bf16 v[48:51], v[32:35], v[144:147], v[48:51]
  ds_read_b64_tr_b16 v[16:17], v8 offset:0
  s_bitcmp1_b32 s48, 1
  s_cselect_b32 s36, s50, s49
  s_waitcnt vmcnt(12)
  v_mfma_f32_16x16x32_bf16 v[64:67], v[32:35], v[148:151], v[64:67]
  ds_read_b64_tr_b16 v[18:19], v8 offset:512
  s_add_u32 s36, s36, 4096
  s_waitcnt lgkmcnt(6)
  v_mfma_f32_16x16x32_bf16 v[68:71], v[36:39], v[148:151], v[68:71]
  ds_read_b64_tr_b16 v[20:21], v9 offset:0
  v_mfma_f32_16x16x32_bf16 v[52:55], v[36:39], v[144:147], v[52:55]
  ds_read_b64_tr_b16 v[22:23], v9 offset:512
  s_waitcnt lgkmcnt(6)
  v_mfma_f32_16x16x32_bf16 v[56:59], v[40:43], v[144:147], v[56:59]
  ds_read_b64_tr_b16 v[24:25], v10 offset:0
  buffer_load_dwordx4 v[136:139], v14, s[8:11], s36 offen offset:0 sc1
  v_mfma_f32_16x16x32_bf16 v[72:75], v[40:43], v[148:151], v[72:75]
  ds_read_b64_tr_b16 v[26:27], v10 offset:512
  s_waitcnt lgkmcnt(6)
  v_mfma_f32_16x16x32_bf16 v[76:79], v[44:47], v[148:151], v[76:79]
  ds_read_b64_tr_b16 v[28:29], v11 offset:0
  v_mfma_f32_16x16x32_bf16 v[60:63], v[44:47], v[144:147], v[60:63]
  ds_read_b64_tr_b16 v[30:31], v11 offset:512
  buffer_load_dwordx4 v[140:143], v14, s[8:11], s36 offen offset:1024 sc1
  s_waitcnt vmcnt(13) lgkmcnt(6)
  v_mfma_f32_16x16x32_bf16 v[48:51], v[16:19], v[152:155], v[48:51]
  ds_read_b64_tr_b16 v[32:33], v8 offset:4096
  s_waitcnt vmcnt(12)
  v_mfma_f32_16x16x32_bf16 v[64:67], v[16:19], v[156:159], v[64:67]
  ds_read_b64_tr_b16 v[34:35], v8 offset:4608
  v_add_u32 v8, 4294850304, v8
  s_waitcnt lgkmcnt(6)
  v_mfma_f32_16x16x32_bf16 v[68:71], v[20:23], v[156:159], v[68:71]
  ds_read_b64_tr_b16 v[36:37], v9 offset:4096
  buffer_load_dwordx4 v[144:147], v14, s[8:11], s36 offen offset:2048 sc1
  v_mfma_f32_16x16x32_bf16 v[52:55], v[20:23], v[152:155], v[52:55]
  ds_read_b64_tr_b16 v[38:39], v9 offset:4608
  v_add_u32 v9, 4294850304, v9
  s_waitcnt lgkmcnt(6)
  v_mfma_f32_16x16x32_bf16 v[56:59], v[24:27], v[152:155], v[56:59]
  ds_read_b64_tr_b16 v[40:41], v10 offset:4096
  v_mfma_f32_16x16x32_bf16 v[72:75], v[24:27], v[156:159], v[72:75]
  ds_read_b64_tr_b16 v[42:43], v10 offset:4608
  v_add_u32 v10, 4294850304, v10
  s_waitcnt lgkmcnt(6)
  v_mfma_f32_16x16x32_bf16 v[76:79], v[28:31], v[156:159], v[76:79]
  ds_read_b64_tr_b16 v[44:45], v11 offset:4096
  buffer_load_dwordx4 v[148:151], v14, s[8:11], s36 offen offset:3072 sc1
  v_mfma_f32_16x16x32_bf16 v[60:63], v[28:31], v[152:155], v[60:63]
  ds_read_b64_tr_b16 v[46:47], v11 offset:4608
  v_add_u32 v11, 4294850304, v11
  s_waitcnt vmcnt(13) lgkmcnt(6)
  v_mfma_f32_16x16x32_bf16 v[48:51], v[32:35], v[160:163], v[48:51]
  ds_read_b64_tr_b16 v[16:17], v8 offset:0
  s_bitcmp1_b32 s48, 2
  s_cselect_b32 s36, s50, s49
  s_waitcnt vmcnt(12)
  v_mfma_f32_16x16x32_bf16 v[64:67], v[32:35], v[164:167], v[64:67]
  ds_read_b64_tr_b16 v[18:19], v8 offset:512
  s_add_u32 s36, s36, 8192
  s_waitcnt lgkmcnt(6)
  v_mfma_f32_16x16x32_bf16 v[68:71], v[36:39], v[164:167], v[68:71]
  ds_read_b64_tr_b16 v[20:21], v9 offset:0
  v_mfma_f32_16x16x32_bf16 v[52:55], v[36:39], v[160:163], v[52:55]
  ds_read_b64_tr_b16 v[22:23], v9 offset:512
  s_waitcnt lgkmcnt(6)
  v_mfma_f32_16x16x32_bf16 v[56:59], v[40:43], v[160:163], v[56:59]
  ds_read_b64_tr_b16 v[24:25], v10 offset:0
  buffer_load_dwordx4 v[152:155], v14, s[8:11], s36 offen offset:0 sc1
  v_mfma_f32_16x16x32_bf16 v[72:75], v[40:43], v[164:167], v[72:75]
  ds_read_b64_tr_b16 v[26:27], v10 offset:512
  s_waitcnt lgkmcnt(6)
  v_mfma_f32_16x16x32_bf16 v[76:79], v[44:47], v[164:167], v[76:79]
  ds_read_b64_tr_b16 v[28:29], v11 offset:0
  v_mfma_f32_16x16x32_bf16 v[60:63], v[44:47], v[160:163], v[60:63]
  ds_read_b64_tr_b16 v[30:31], v11 offset:512
  buffer_load_dwordx4 v[156:159], v14, s[8:11], s36 offen offset:1024 sc1
  s_waitcnt vmcnt(13) lgkmcnt(6)
  v_mfma_f32_16x16x32_bf16 v[48:51], v[16:19], v[168:171], v[48:51]
  ds_read_b64_tr_b16 v[32:33], v8 offset:4096
  s_waitcnt vmcnt(12)
  v_mfma_f32_16x16x32_bf16 v[64:67], v[16:19], v[172:175], v[64:67]
  ds_read_b64_tr_b16 v[34:35], v8 offset:4608
  v_add_u32 v8, 8192, v8
  s_waitcnt lgkmcnt(6)
  v_mfma_f32_16x16x32_bf16 v[68:71], v[20:23], v[172:175], v[68:71]
  ds_read_b64_tr_b16 v[36:37], v9 offset:4096
  buffer_load_dwordx4 v[160:163], v14, s[8:11], s36 offen offset:2048 sc1
  v_mfma_f32_16x16x32_bf16 v[52:55], v[20:23], v[168:171], v[52:55]
  ds_read_b64_tr_b16 v[38:39], v9 offset:4608
  v_add_u32 v9, 8192, v9
  s_waitcnt lgkmcnt(6)
  v_mfma_f32_16x16x32_bf16 v[56:59], v[24:27], v[168:171], v[56:59]
  ds_read_b64_tr_b16 v[40:41], v10 offset:4096
  v_mfma_f32_16x16x32_bf16 v[72:75], v[24:27], v[172:175], v[72:75]
  ds_read_b64_tr_b16 v[42:43], v10 offset:4608
  v_add_u32 v10, 8192, v10
  s_waitcnt lgkmcnt(6)
  v_mfma_f32_16x16x32_bf16 v[76:79], v[28:31], v[172:175], v[76:79]
  ds_read_b64_tr_b16 v[44:45], v11 offset:4096
  buffer_load_dwordx4 v[164:167], v14, s[8:11], s36 offen offset:3072 sc1
  v_mfma_f32_16x16x32_bf16 v[60:63], v[28:31], v[168:171], v[60:63]
  ds_read_b64_tr_b16 v[46:47], v11 offset:4608
  v_add_u32 v11, 8192, v11
  s_waitcnt vmcnt(13) lgkmcnt(6)
  v_mfma_f32_16x16x32_bf16 v[48:51], v[32:35], v[176:179], v[48:51]
  ds_read_b64_tr_b16 v[16:17], v8 offset:0
  s_bitcmp1_b32 s48, 3
  s_cselect_b32 s36, s50, s49
  s_waitcnt vmcnt(12)
  v_mfma_f32_16x16x32_bf16 v[64:67], v[32:35], v[180:183], v[64:67]
  ds_read_b64_tr_b16 v[18:19], v8 offset:512
  s_add_u32 s36, s36, 12288
  s_waitcnt lgkmcnt(6)
  v_mfma_f32_16x16x32_bf16 v[68:71], v[36:39], v[180:183], v[68:71]
  ds_read_b64_tr_b16 v[20:21], v9 offset:0
  v_mfma_f32_16x16x32_bf16 v[52:55], v[36:39], v[176:179], v[52:55]
  ds_read_b64_tr_b16 v[22:23], v9 offset:512
  s_waitcnt lgkmcnt(6)
  v_mfma_f32_16x16x32_bf16 v[56:59], v[40:43], v[176:179], v[56:59]
  ds_read_b64_tr_b16 v[24:25], v10 offset:0
  buffer_load_dwordx4 v[168:171], v14, s[8:11], s36 offen offset:0 sc1
  v_mfma_f32_16x16x32_bf16 v[72:75], v[40:43], v[180:183], v[72:75]
  ds_read_b64_tr_b16 v[26:27], v10 offset:512
  s_waitcnt lgkmcnt(6)
  v_mfma_f32_16x16x32_bf16 v[76:79], v[44:47], v[180:183], v[76:79]
  ds_read_b64_tr_b16 v[28:29], v11 offset:0
  v_mfma_f32_16x16x32_bf16 v[60:63], v[44:47], v[176:179], v[60:63]
  ds_read_b64_tr_b16 v[30:31], v11 offset:512
  buffer_load_dwordx4 v[172:175], v14, s[8:11], s36 offen offset:1024 sc1
  s_waitcnt vmcnt(13) lgkmcnt(6)
  v_mfma_f32_16x16x32_bf16 v[48:51], v[16:19], v[120:123], v[48:51]
  ds_read_b64_tr_b16 v[32:33], v8 offset:4096
  s_waitcnt vmcnt(12)
  v_mfma_f32_16x16x32_bf16 v[64:67], v[16:19], v[124:127], v[64:67]
  ds_read_b64_tr_b16 v[34:35], v8 offset:4608
  v_add_u32 v8, 8192, v8
  s_waitcnt lgkmcnt(6)
  v_mfma_f32_16x16x32_bf16 v[68:71], v[20:23], v[124:127], v[68:71]
  ds_read_b64_tr_b16 v[36:37], v9 offset:4096
  buffer_load_dwordx4 v[176:179], v14, s[8:11], s36 offen offset:2048 sc1
  v_mfma_f32_16x16x32_bf16 v[52:55], v[20:23], v[120:123], v[52:55]
  ds_read_b64_tr_b16 v[38:39], v9 offset:4608
  v_add_u32 v9, 8192, v9
  s_waitcnt lgkmcnt(6)
  v_mfma_f32_16x16x32_bf16 v[56:59], v[24:27], v[120:123], v[56:59]
  ds_read_b64_tr_b16 v[40:41], v10 offset:4096
  v_mfma_f32_16x16x32_bf16 v[72:75], v[24:27], v[124:127], v[72:75]
  ds_read_b64_tr_b16 v[42:43], v10 offset:4608
  v_add_u32 v10, 8192, v10
  s_waitcnt lgkmcnt(6)
  v_mfma_f32_16x16x32_bf16 v[76:79], v[28:31], v[124:127], v[76:79]
  ds_read_b64_tr_b16 v[44:45], v11 offset:4096
  buffer_load_dwordx4 v[180:183], v14, s[8:11], s36 offen offset:3072 sc1
  v_mfma_f32_16x16x32_bf16 v[60:63], v[28:31], v[120:123], v[60:63]
  ds_read_b64_tr_b16 v[46:47], v11 offset:4608
  v_add_u32 v11, 8192, v11
  s_waitcnt vmcnt(13) lgkmcnt(6)
  v_mfma_f32_16x16x32_bf16 v[48:51], v[32:35], v[128:131], v[48:51]
  ds_read_b64_tr_b16 v[16:17], v8 offset:0
  s_bitcmp1_b32 s48, 4
  s_cselect_b32 s36, s50, s49
  s_waitcnt vmcnt(12)
  v_mfma_f32_16x16x32_bf16 v[64:67], v[32:35], v[132:135], v[64:67]
  ds_read_b64_tr_b16 v[18:19], v8 offset:512
  s_add_u32 s36, s36, 16384
  s_waitcnt lgkmcnt(6)
  v_mfma_f32_16x16x32_bf16 v[68:71], v[36:39], v[132:135], v[68:71]
  ds_read_b64_tr_b16 v[20:21], v9 offset:0
  v_mfma_f32_16x16x32_bf16 v[52:55], v[36:39], v[128:131], v[52:55]
  ds_read_b64_tr_b16 v[22:23], v9 offset:512
  s_waitcnt lgkmcnt(6)
  v_mfma_f32_16x16x32_bf16 v[56:59], v[40:43], v[128:131], v[56:59]
  ds_read_b64_tr_b16 v[24:25], v10 offset:0
  buffer_load_dwordx4 v[120:123], v14, s[8:11], s36 offen offset:0 sc1
  v_mfma_f32_16x16x32_bf16 v[72:75], v[40:43], v[132:135], v[72:75]
  ds_read_b64_tr_b16 v[26:27], v10 offset:512
  s_waitcnt lgkmcnt(6)
  v_mfma_f32_16x16x32_bf16 v[76:79], v[44:47], v[132:135], v[76:79]
  ds_read_b64_tr_b16 v[28:29], v11 offset:0
  v_mfma_f32_16x16x32_bf16 v[60:63], v[44:47], v[128:131], v[60:63]
  ds_read_b64_tr_b16 v[30:31], v11 offset:512
  buffer_load_dwordx4 v[124:127], v14, s[8:11], s36 offen offset:1024 sc1
  s_waitcnt vmcnt(13) lgkmcnt(6)
  v_mfma_f32_16x16x32_bf16 v[48:51], v[16:19], v[136:139], v[48:51]
  ds_read_b64_tr_b16 v[32:33], v8 offset:4096
  s_waitcnt vmcnt(12)
  v_mfma_f32_16x16x32_bf16 v[64:67], v[16:19], v[140:143], v[64:67]
  ds_read_b64_tr_b16 v[34:35], v8 offset:4608
  v_add_u32 v8, 8192, v8
  s_waitcnt lgkmcnt(6)
  v_mfma_f32_16x16x32_bf16 v[68:71], v[20:23], v[140:143], v[68:71]
  ds_read_b64_tr_b16 v[36:37], v9 offset:4096
  buffer_load_dwordx4 v[128:131], v14, s[8:11], s36 offen offset:2048 sc1
  v_mfma_f32_16x16x32_bf16 v[52:55], v[20:23], v[136:139], v[52:55]
  ds_read_b64_tr_b16 v[38:39], v9 offset:4608
  v_add_u32 v9, 8192, v9
  s_waitcnt lgkmcnt(6)
  v_mfma_f32_16x16x32_bf16 v[56:59], v[24:27], v[136:139], v[56:59]
  ds_read_b64_tr_b16 v[40:41], v10 offset:4096
  v_mfma_f32_16x16x32_bf16 v[72:75], v[24:27], v[140:143], v[72:75]
  ds_read_b64_tr_b16 v[42:43], v10 offset:4608
  v_add_u32 v10, 8192, v10
  s_waitcnt lgkmcnt(6)
  v_mfma_f32_16x16x32_bf16 v[76:79], v[28:31], v[140:143], v[76:79]
  ds_read_b64_tr_b16 v[44:45], v11 offset:4096
  buffer_load_dwordx4 v[132:135], v14, s[8:11], s36 offen offset:3072 sc1
  v_mfma_f32_16x16x32_bf16 v[60:63], v[28:31], v[136:139], v[60:63]
  ds_read_b64_tr_b16 v[46:47], v11 offset:4608
  v_add_u32 v11, 8192, v11
  s_waitcnt vmcnt(13) lgkmcnt(6)
  v_mfma_f32_16x16x32_bf16 v[48:51], v[32:35], v[144:147], v[48:51]
  ds_read_b64_tr_b16 v[16:17], v8 offset:0
  s_bitcmp1_b32 s48, 5
  s_cselect_b32 s36, s50, s49
  s_waitcnt vmcnt(12)
  v_mfma_f32_16x16x32_bf16 v[64:67], v[32:35], v[148:151], v[64:67]
  ds_read_b64_tr_b16 v[18:19], v8 offset:512
  s_add_u32 s36, s36, 20480
  s_waitcnt lgkmcnt(6)
  v_mfma_f32_16x16x32_bf16 v[68:71], v[36:39], v[148:151], v[68:71]
  ds_read_b64_tr_b16 v[20:21], v9 offset:0
  v_mfma_f32_16x16x32_bf16 v[52:55], v[36:39], v[144:147], v[52:55]
  ds_read_b64_tr_b16 v[22:23], v9 offset:512
  s_waitcnt lgkmcnt(6)
  v_mfma_f32_16x16x32_bf16 v[56:59], v[40:43], v[144:147], v[56:59]
  ds_read_b64_tr_b16 v[24:25], v10 offset:0
  buffer_load_dwordx4 v[136:139], v14, s[8:11], s36 offen offset:0 sc1
  v_mfma_f32_16x16x32_bf16 v[72:75], v[40:43], v[148:151], v[72:75]
  ds_read_b64_tr_b16 v[26:27], v10 offset:512
  s_waitcnt lgkmcnt(6)
  v_mfma_f32_16x16x32_bf16 v[76:79], v[44:47], v[148:151], v[76:79]
  ds_read_b64_tr_b16 v[28:29], v11 offset:0
  v_mfma_f32_16x16x32_bf16 v[60:63], v[44:47], v[144:147], v[60:63]
  ds_read_b64_tr_b16 v[30:31], v11 offset:512
  buffer_load_dwordx4 v[140:143], v14, s[8:11], s36 offen offset:1024 sc1
  s_waitcnt vmcnt(13) lgkmcnt(6)
  v_mfma_f32_16x16x32_bf16 v[48:51], v[16:19], v[152:155], v[48:51]
  ds_read_b64_tr_b16 v[32:33], v8 offset:4096
  s_waitcnt vmcnt(12)
  v_mfma_f32_16x16x32_bf16 v[64:67], v[16:19], v[156:159], v[64:67]
  ds_read_b64_tr_b16 v[34:35], v8 offset:4608
  v_add_u32 v8, 8192, v8
  s_waitcnt lgkmcnt(6)
  v_mfma_f32_16x16x32_bf16 v[68:71], v[20:23], v[156:159], v[68:71]
  ds_read_b64_tr_b16 v[36:37], v9 offset:4096
  buffer_load_dwordx4 v[144:147], v14, s[8:11], s36 offen offset:2048 sc1
  v_mfma_f32_16x16x32_bf16 v[52:55], v[20:23], v[152:155], v[52:55]
  ds_read_b64_tr_b16 v[38:39], v9 offset:4608
  v_add_u32 v9, 8192, v9
  s_waitcnt lgkmcnt(6)
  v_mfma_f32_16x16x32_bf16 v[56:59], v[24:27], v[152:155], v[56:59]
  ds_read_b64_tr_b16 v[40:41], v10 offset:4096
  v_mfma_f32_16x16x32_bf16 v[72:75], v[24:27], v[156:159], v[72:75]
  ds_read_b64_tr_b16 v[42:43], v10 offset:4608
  v_add_u32 v10, 8192, v10
  s_waitcnt lgkmcnt(6)
  v_mfma_f32_16x16x32_bf16 v[76:79], v[28:31], v[156:159], v[76:79]
  ds_read_b64_tr_b16 v[44:45], v11 offset:4096
  buffer_load_dwordx4 v[148:151], v14, s[8:11], s36 offen offset:3072 sc1
  v_mfma_f32_16x16x32_bf16 v[60:63], v[28:31], v[152:155], v[60:63]
  ds_read_b64_tr_b16 v[46:47], v11 offset:4608
  v_add_u32 v11, 8192, v11
  s_waitcnt vmcnt(13) lgkmcnt(6)
  v_mfma_f32_16x16x32_bf16 v[48:51], v[32:35], v[160:163], v[48:51]
  ds_read_b64_tr_b16 v[16:17], v8 offset:0
  s_bitcmp1_b32 s48, 6
  s_cselect_b32 s36, s50, s49
  s_waitcnt vmcnt(12)
  v_mfma_f32_16x16x32_bf16 v[64:67], v[32:35], v[164:167], v[64:67]
  ds_read_b64_tr_b16 v[18:19], v8 offset:512
  s_add_u32 s36, s36, 24576
  s_waitcnt lgkmcnt(6)
  v_mfma_f32_16x16x32_bf16 v[68:71], v[36:39], v[164:167], v[68:71]
  ds_read_b64_tr_b16 v[20:21], v9 offset:0
  v_mfma_f32_16x16x32_bf16 v[52:55], v[36:39], v[160:163], v[52:55]
  ds_read_b64_tr_b16 v[22:23], v9 offset:512
  s_waitcnt lgkmcnt(6)
  v_mfma_f32_16x16x32_bf16 v[56:59], v[40:43], v[160:163], v[56:59]
  ds_read_b64_tr_b16 v[24:25], v10 offset:0
  buffer_load_dwordx4 v[152:155], v14, s[8:11], s36 offen offset:0 sc1
  v_mfma_f32_16x16x32_bf16 v[72:75], v[40:43], v[164:167], v[72:75]
  ds_read_b64_tr_b16 v[26:27], v10 offset:512
  s_waitcnt lgkmcnt(6)
  v_mfma_f32_16x16x32_bf16 v[76:79], v[44:47], v[164:167], v[76:79]
  ds_read_b64_tr_b16 v[28:29], v11 offset:0
  v_mfma_f32_16x16x32_bf16 v[60:63], v[44:47], v[160:163], v[60:63]
  ds_read_b64_tr_b16 v[30:31], v11 offset:512
  buffer_load_dwordx4 v[156:159], v14, s[8:11], s36 offen offset:1024 sc1
  s_waitcnt vmcnt(13) lgkmcnt(6)
  v_mfma_f32_16x16x32_bf16 v[48:51], v[16:19], v[168:171], v[48:51]
  ds_read_b64_tr_b16 v[32:33], v8 offset:4096
  s_waitcnt vmcnt(12)
  v_mfma_f32_16x16x32_bf16 v[64:67], v[16:19], v[172:175], v[64:67]
  ds_read_b64_tr_b16 v[34:35], v8 offset:4608
  v_add_u32 v8, 10240, v8
  s_waitcnt lgkmcnt(6)
  v_mfma_f32_16x16x32_bf16 v[68:71], v[20:23], v[172:175], v[68:71]
  ds_read_b64_tr_b16 v[36:37], v9 offset:4096
  buffer_load_dwordx4 v[160:163], v14, s[8:11], s36 offen offset:2048 sc1
  v_mfma_f32_16x16x32_bf16 v[52:55], v[20:23], v[168:171], v[52:55]
  ds_read_b64_tr_b16 v[38:39], v9 offset:4608
  v_add_u32 v9, 10240, v9
  s_waitcnt lgkmcnt(6)
  v_mfma_f32_16x16x32_bf16 v[56:59], v[24:27], v[168:171], v[56:59]
  ds_read_b64_tr_b16 v[40:41], v10 offset:4096
  v_mfma_f32_16x16x32_bf16 v[72:75], v[24:27], v[172:175], v[72:75]
  ds_read_b64_tr_b16 v[42:43], v10 offset:4608
  v_add_u32 v10, 10240, v10
  s_waitcnt lgkmcnt(6)
  v_mfma_f32_16x16x32_bf16 v[76:79], v[28:31], v[172:175], v[76:79]
  ds_read_b64_tr_b16 v[44:45], v11 offset:4096
  buffer_load_dwordx4 v[164:167], v14, s[8:11], s36 offen offset:3072 sc1
  v_mfma_f32_16x16x32_bf16 v[60:63], v[28:31], v[168:171], v[60:63]
  ds_read_b64_tr_b16 v[46:47], v11 offset:4608
  v_add_u32 v11, 10240, v11
  s_waitcnt vmcnt(13) lgkmcnt(6)
  v_mfma_f32_16x16x32_bf16 v[48:51], v[32:35], v[176:179], v[48:51]
  ds_read_b64_tr_b16 v[16:17], v8 offset:0
  s_bitcmp1_b32 s48, 7
  s_cselect_b32 s36, s50, s49
  s_waitcnt vmcnt(12)
  v_mfma_f32_16x16x32_bf16 v[64:67], v[32:35], v[180:183], v[64:67]
  ds_read_b64_tr_b16 v[18:19], v8 offset:512
  s_add_u32 s36, s36, 28672
  s_waitcnt lgkmcnt(6)
  v_mfma_f32_16x16x32_bf16 v[68:71], v[36:39], v[180:183], v[68:71]
  ds_read_b64_tr_b16 v[20:21], v9 offset:0
  v_mfma_f32_16x16x32_bf16 v[52:55], v[36:39], v[176:179], v[52:55]
  ds_read_b64_tr_b16 v[22:23], v9 offset:512
  s_waitcnt lgkmcnt(6)
  v_mfma_f32_16x16x32_bf16 v[56:59], v[40:43], v[176:179], v[56:59]
  ds_read_b64_tr_b16 v[24:25], v10 offset:0
  buffer_load_dwordx4 v[168:171], v14, s[8:11], s36 offen offset:0 sc1
  v_mfma_f32_16x16x32_bf16 v[72:75], v[40:43], v[180:183], v[72:75]
  ds_read_b64_tr_b16 v[26:27], v10 offset:512
  s_waitcnt lgkmcnt(6)
  v_mfma_f32_16x16x32_bf16 v[76:79], v[44:47], v[180:183], v[76:79]
  ds_read_b64_tr_b16 v[28:29], v11 offset:0
  v_mfma_f32_16x16x32_bf16 v[60:63], v[44:47], v[176:179], v[60:63]
  ds_read_b64_tr_b16 v[30:31], v11 offset:512
  buffer_load_dwordx4 v[172:175], v14, s[8:11], s36 offen offset:1024 sc1
  s_waitcnt vmcnt(13) lgkmcnt(6)
  v_mfma_f32_16x16x32_bf16 v[48:51], v[16:19], v[120:123], v[48:51]
  ds_read_b64_tr_b16 v[32:33], v8 offset:4096
  s_waitcnt vmcnt(12)
  v_mfma_f32_16x16x32_bf16 v[64:67], v[16:19], v[124:127], v[64:67]
  ds_read_b64_tr_b16 v[34:35], v8 offset:4608
  v_add_u32 v8, 8192, v8
  s_waitcnt lgkmcnt(6)
  v_mfma_f32_16x16x32_bf16 v[68:71], v[20:23], v[124:127], v[68:71]
  ds_read_b64_tr_b16 v[36:37], v9 offset:4096
  buffer_load_dwordx4 v[176:179], v14, s[8:11], s36 offen offset:2048 sc1
  v_mfma_f32_16x16x32_bf16 v[52:55], v[20:23], v[120:123], v[52:55]
  ds_read_b64_tr_b16 v[38:39], v9 offset:4608
  v_add_u32 v9, 8192, v9
  s_waitcnt lgkmcnt(6)
  v_mfma_f32_16x16x32_bf16 v[56:59], v[24:27], v[120:123], v[56:59]
  ds_read_b64_tr_b16 v[40:41], v10 offset:4096
  v_mfma_f32_16x16x32_bf16 v[72:75], v[24:27], v[124:127], v[72:75]
  ds_read_b64_tr_b16 v[42:43], v10 offset:4608
  v_add_u32 v10, 8192, v10
  s_waitcnt lgkmcnt(6)
  v_mfma_f32_16x16x32_bf16 v[76:79], v[28:31], v[124:127], v[76:79]
  ds_read_b64_tr_b16 v[44:45], v11 offset:4096
  buffer_load_dwordx4 v[180:183], v14, s[8:11], s36 offen offset:3072 sc1
  v_mfma_f32_16x16x32_bf16 v[60:63], v[28:31], v[120:123], v[60:63]
  ds_read_b64_tr_b16 v[46:47], v11 offset:4608
  v_add_u32 v11, 8192, v11
  s_waitcnt vmcnt(13) lgkmcnt(6)
  v_mfma_f32_16x16x32_bf16 v[48:51], v[32:35], v[128:131], v[48:51]
  ds_read_b64_tr_b16 v[16:17], v8 offset:0
  s_waitcnt vmcnt(12)
  v_mfma_f32_16x16x32_bf16 v[64:67], v[32:35], v[132:135], v[64:67]
  ds_read_b64_tr_b16 v[18:19], v8 offset:512
  s_waitcnt lgkmcnt(6)
  v_mfma_f32_16x16x32_bf16 v[68:71], v[36:39], v[132:135], v[68:71]
  ds_read_b64_tr_b16 v[20:21], v9 offset:0
  v_mfma_f32_16x16x32_bf16 v[52:55], v[36:39], v[128:131], v[52:55]
  ds_read_b64_tr_b16 v[22:23], v9 offset:512
  s_waitcnt lgkmcnt(6)
  v_mfma_f32_16x16x32_bf16 v[56:59], v[40:43], v[128:131], v[56:59]
  ds_read_b64_tr_b16 v[24:25], v10 offset:0
  v_mfma_f32_16x16x32_bf16 v[72:75], v[40:43], v[132:135], v[72:75]
  ds_read_b64_tr_b16 v[26:27], v10 offset:512
  s_waitcnt lgkmcnt(6)
  v_mfma_f32_16x16x32_bf16 v[76:79], v[44:47], v[132:135], v[76:79]
  ds_read_b64_tr_b16 v[28:29], v11 offset:0
  v_mfma_f32_16x16x32_bf16 v[60:63], v[44:47], v[128:131], v[60:63]
  ds_read_b64_tr_b16 v[30:31], v11 offset:512
  s_waitcnt vmcnt(11) lgkmcnt(6)
  v_mfma_f32_16x16x32_bf16 v[48:51], v[16:19], v[136:139], v[48:51]
  ds_read_b64_tr_b16 v[32:33], v8 offset:4096
  s_waitcnt vmcnt(10)
  v_mfma_f32_16x16x32_bf16 v[64:67], v[16:19], v[140:143], v[64:67]
  ds_read_b64_tr_b16 v[34:35], v8 offset:4608
  v_add_u32 v8, 8192, v8
  s_waitcnt lgkmcnt(6)
  v_mfma_f32_16x16x32_bf16 v[68:71], v[20:23], v[140:143], v[68:71]
  ds_read_b64_tr_b16 v[36:37], v9 offset:4096
  v_mfma_f32_16x16x32_bf16 v[52:55], v[20:23], v[136:139], v[52:55]
  ds_read_b64_tr_b16 v[38:39], v9 offset:4608
  v_add_u32 v9, 8192, v9
  s_waitcnt lgkmcnt(6)
  v_mfma_f32_16x16x32_bf16 v[56:59], v[24:27], v[136:139], v[56:59]
  ds_read_b64_tr_b16 v[40:41], v10 offset:4096
  v_mfma_f32_16x16x32_bf16 v[72:75], v[24:27], v[140:143], v[72:75]
  ds_read_b64_tr_b16 v[42:43], v10 offset:4608
  v_add_u32 v10, 8192, v10
  s_waitcnt lgkmcnt(6)
  v_mfma_f32_16x16x32_bf16 v[76:79], v[28:31], v[140:143], v[76:79]
  ds_read_b64_tr_b16 v[44:45], v11 offset:4096
  v_mfma_f32_16x16x32_bf16 v[60:63], v[28:31], v[136:139], v[60:63]
  ds_read_b64_tr_b16 v[46:47], v11 offset:4608
  v_add_u32 v11, 8192, v11
  s_waitcnt vmcnt(9) lgkmcnt(6)
  v_mfma_f32_16x16x32_bf16 v[48:51], v[32:35], v[144:147], v[48:51]
  ds_read_b64_tr_b16 v[16:17], v8 offset:0
  s_waitcnt vmcnt(8)
  v_mfma_f32_16x16x32_bf16 v[64:67], v[32:35], v[148:151], v[64:67]
  ds_read_b64_tr_b16 v[18:19], v8 offset:512
  s_waitcnt lgkmcnt(6)
  v_mfma_f32_16x16x32_bf16 v[68:71], v[36:39], v[148:151], v[68:71]
  ds_read_b64_tr_b16 v[20:21], v9 offset:0
  v_mfma_f32_16x16x32_bf16 v[52:55], v[36:39], v[144:147], v[52:55]
  ds_read_b64_tr_b16 v[22:23], v9 offset:512
  s_waitcnt lgkmcnt(6)
  v_mfma_f32_16x16x32_bf16 v[56:59], v[40:43], v[144:147], v[56:59]
  ds_read_b64_tr_b16 v[24:25], v10 offset:0
  v_mfma_f32_16x16x32_bf16 v[72:75], v[40:43], v[148:151], v[72:75]
  ds_read_b64_tr_b16 v[26:27], v10 offset:512
  s_waitcnt lgkmcnt(6)
  v_mfma_f32_16x16x32_bf16 v[76:79], v[44:47], v[148:151], v[76:79]
  ds_read_b64_tr_b16 v[28:29], v11 offset:0
  v_mfma_f32_16x16x32_bf16 v[60:63], v[44:47], v[144:147], v[60:63]
  ds_read_b64_tr_b16 v[30:31], v11 offset:512
  s_waitcnt vmcnt(7) lgkmcnt(6)
  v_mfma_f32_16x16x32_bf16 v[48:51], v[16:19], v[152:155], v[48:51]
  ds_read_b64_tr_b16 v[32:33], v8 offset:4096
  s_waitcnt vmcnt(6)
  v_mfma_f32_16x16x32_bf16 v[64:67], v[16:19], v[156:159], v[64:67]
  ds_read_b64_tr_b16 v[34:35], v8 offset:4608
  v_add_u32 v8, 8192, v8
  s_waitcnt lgkmcnt(6)
  v_mfma_f32_16x16x32_bf16 v[68:71], v[20:23], v[156:159], v[68:71]
  ds_read_b64_tr_b16 v[36:37], v9 offset:4096
  v_mfma_f32_16x16x32_bf16 v[52:55], v[20:23], v[152:155], v[52:55]
  ds_read_b64_tr_b16 v[38:39], v9 offset:4608
  v_add_u32 v9, 8192, v9
  s_waitcnt lgkmcnt(6)
  v_mfma_f32_16x16x32_bf16 v[56:59], v[24:27], v[152:155], v[56:59]
  ds_read_b64_tr_b16 v[40:41], v10 offset:4096
  v_mfma_f32_16x16x32_bf16 v[72:75], v[24:27], v[156:159], v[72:75]
  ds_read_b64_tr_b16 v[42:43], v10 offset:4608
  v_add_u32 v10, 8192, v10
  s_waitcnt lgkmcnt(6)
  v_mfma_f32_16x16x32_bf16 v[76:79], v[28:31], v[156:159], v[76:79]
  ds_read_b64_tr_b16 v[44:45], v11 offset:4096
  v_mfma_f32_16x16x32_bf16 v[60:63], v[28:31], v[152:155], v[60:63]
  ds_read_b64_tr_b16 v[46:47], v11 offset:4608
  v_add_u32 v11, 8192, v11
  s_waitcnt vmcnt(5) lgkmcnt(6)
  v_mfma_f32_16x16x32_bf16 v[48:51], v[32:35], v[160:163], v[48:51]
  ds_read_b64_tr_b16 v[16:17], v8 offset:0
  s_waitcnt vmcnt(4)
  v_mfma_f32_16x16x32_bf16 v[64:67], v[32:35], v[164:167], v[64:67]
  ds_read_b64_tr_b16 v[18:19], v8 offset:512
  s_waitcnt lgkmcnt(6)
  v_mfma_f32_16x16x32_bf16 v[68:71], v[36:39], v[164:167], v[68:71]
  ds_read_b64_tr_b16 v[20:21], v9 offset:0
  v_mfma_f32_16x16x32_bf16 v[52:55], v[36:39], v[160:163], v[52:55]
  ds_read_b64_tr_b16 v[22:23], v9 offset:512
  s_waitcnt lgkmcnt(6)
  v_mfma_f32_16x16x32_bf16 v[56:59], v[40:43], v[160:163], v[56:59]
  ds_read_b64_tr_b16 v[24:25], v10 offset:0
  v_mfma_f32_16x16x32_bf16 v[72:75], v[40:43], v[164:167], v[72:75]
  ds_read_b64_tr_b16 v[26:27], v10 offset:512
  s_waitcnt lgkmcnt(6)
  v_mfma_f32_16x16x32_bf16 v[76:79], v[44:47], v[164:167], v[76:79]
  ds_read_b64_tr_b16 v[28:29], v11 offset:0
  v_mfma_f32_16x16x32_bf16 v[60:63], v[44:47], v[160:163], v[60:63]
  ds_read_b64_tr_b16 v[30:31], v11 offset:512
  s_waitcnt vmcnt(3) lgkmcnt(6)
  v_mfma_f32_16x16x32_bf16 v[48:51], v[16:19], v[168:171], v[48:51]
  ds_read_b64_tr_b16 v[32:33], v8 offset:4096
  s_waitcnt vmcnt(2)
  v_mfma_f32_16x16x32_bf16 v[64:67], v[16:19], v[172:175], v[64:67]
  ds_read_b64_tr_b16 v[34:35], v8 offset:4608
  s_waitcnt lgkmcnt(6)
  v_mfma_f32_16x16x32_bf16 v[68:71], v[20:23], v[172:175], v[68:71]
  ds_read_b64_tr_b16 v[36:37], v9 offset:4096
  v_mfma_f32_16x16x32_bf16 v[52:55], v[20:23], v[168:171], v[52:55]
  ds_read_b64_tr_b16 v[38:39], v9 offset:4608
  s_waitcnt lgkmcnt(6)
  v_mfma_f32_16x16x32_bf16 v[56:59], v[24:27], v[168:171], v[56:59]
  ds_read_b64_tr_b16 v[40:41], v10 offset:4096
  v_mfma_f32_16x16x32_bf16 v[72:75], v[24:27], v[172:175], v[72:75]
  ds_read_b64_tr_b16 v[42:43], v10 offset:4608
  s_waitcnt lgkmcnt(6)
  v_mfma_f32_16x16x32_bf16 v[76:79], v[28:31], v[172:175], v[76:79]
  ds_read_b64_tr_b16 v[44:45], v11 offset:4096
  v_mfma_f32_16x16x32_bf16 v[60:63], v[28:31], v[168:171], v[60:63]
  ds_read_b64_tr_b16 v[46:47], v11 offset:4608
  s_waitcnt vmcnt(1) lgkmcnt(6)
  v_mfma_f32_16x16x32_bf16 v[48:51], v[32:35], v[176:179], v[48:51]
  s_waitcnt vmcnt(0)
  v_mfma_f32_16x16x32_bf16 v[64:67], v[32:35], v[180:183], v[64:67]
  s_waitcnt lgkmcnt(4)
  v_mfma_f32_16x16x32_bf16 v[68:71], v[36:39], v[180:183], v[68:71]
  v_mfma_f32_16x16x32_bf16 v[52:55], v[36:39], v[176:179], v[52:55]
  s_waitcnt lgkmcnt(2)
  v_mfma_f32_16x16x32_bf16 v[56:59], v[40:43], v[176:179], v[56:59]
  v_mfma_f32_16x16x32_bf16 v[72:75], v[40:43], v[180:183], v[72:75]
  s_waitcnt lgkmcnt(0)
  v_mfma_f32_16x16x32_bf16 v[76:79], v[44:47], v[180:183], v[76:79]
  v_mfma_f32_16x16x32_bf16 v[60:63], v[44:47], v[176:179], v[60:63]
  s_waitcnt lgkmcnt(0)
  s_barrier
  s_add_u32 s20, s82, 4194304
  s_addc_u32 s21, s83, 0
  s_mov_b32 s22, 4194304
  s_mov_b32 s23, 0x20000
  s_add_u32 s24, s82, 8388608
  s_addc_u32 s25, s83, 0
  s_mov_b32 s26, 4194304
  s_mov_b32 s27, 0x20000
  v_pk_add_f32 v[16:17], v[48:49], v[50:51]
  v_pk_mul_f32 v[18:19], v[48:49], v[48:49]
  v_pk_fma_f32 v[18:19], v[50:51], v[50:51], v[18:19]
  v_pk_add_f32 v[16:17], v[16:17], v[52:53]
  v_pk_fma_f32 v[18:19], v[52:53], v[52:53], v[18:19]
  v_pk_add_f32 v[16:17], v[16:17], v[54:55]
  v_pk_fma_f32 v[18:19], v[54:55], v[54:55], v[18:19]
  v_pk_add_f32 v[16:17], v[16:17], v[56:57]
  v_pk_fma_f32 v[18:19], v[56:57], v[56:57], v[18:19]
  v_pk_add_f32 v[16:17], v[16:17], v[58:59]
  v_pk_fma_f32 v[18:19], v[58:59], v[58:59], v[18:19]
  v_pk_add_f32 v[16:17], v[16:17], v[60:61]
  v_pk_fma_f32 v[18:19], v[60:61], v[60:61], v[18:19]
  v_pk_add_f32 v[16:17], v[16:17], v[62:63]
  v_pk_fma_f32 v[18:19], v[62:63], v[62:63], v[18:19]
  v_add_f32 v24, v16, v17
  v_add_f32 v26, v18, v19
  v_pk_add_f32 v[20:21], v[64:65], v[66:67]
  v_pk_mul_f32 v[22:23], v[64:65], v[64:65]
  v_pk_fma_f32 v[22:23], v[66:67], v[66:67], v[22:23]
  v_pk_add_f32 v[20:21], v[20:21], v[68:69]
  v_pk_fma_f32 v[22:23], v[68:69], v[68:69], v[22:23]
  v_pk_add_f32 v[20:21], v[20:21], v[70:71]
  v_pk_fma_f32 v[22:23], v[70:71], v[70:71], v[22:23]
  v_pk_add_f32 v[20:21], v[20:21], v[72:73]
  v_pk_fma_f32 v[22:23], v[72:73], v[72:73], v[22:23]
  v_pk_add_f32 v[20:21], v[20:21], v[74:75]
  v_pk_fma_f32 v[22:23], v[74:75], v[74:75], v[22:23]
  v_pk_add_f32 v[20:21], v[20:21], v[76:77]
  v_pk_fma_f32 v[22:23], v[76:77], v[76:77], v[22:23]
  v_pk_add_f32 v[20:21], v[20:21], v[78:79]
  v_pk_fma_f32 v[22:23], v[78:79], v[78:79], v[22:23]
  v_add_f32 v25, v20, v21
  v_add_f32 v27, v22, v23
  s_nop 0
  v_permlane16_swap_b32 v24, v25
  v_permlane16_swap_b32 v26, v27
  v_add_f32 v28, v24, v25
  v_add_f32 v29, v26, v27
  v_mov_b32 v30, v28
  v_mov_b32 v31, v29
  s_nop 0
  v_permlane32_swap_b32 v28, v30
  v_permlane32_swap_b32 v29, v31
  v_add_f32 v28, v28, v30
  v_add_f32 v29, v29, v31
  v_and_b32 v29, 0x7fffffff, v29
  s_mov_b32 exec_hi, 0
  buffer_store_dwordx2 v[28:29], v112, s[12:15], 0 offen sc0 sc1
  s_mov_b64 exec, -1
  v_cvt_pk_bf16_f32 v96, v48, v49
  v_cvt_pk_bf16_f32 v97, v50, v51
  v_cvt_pk_bf16_f32 v98, v52, v53
  v_cvt_pk_bf16_f32 v99, v54, v55
  v_cvt_pk_bf16_f32 v100, v56, v57
  v_cvt_pk_bf16_f32 v101, v58, v59
  v_cvt_pk_bf16_f32 v102, v60, v61
  v_cvt_pk_bf16_f32 v103, v62, v63
  v_cvt_pk_bf16_f32 v104, v64, v65
  v_cvt_pk_bf16_f32 v105, v66, v67
  v_cvt_pk_bf16_f32 v106, v68, v69
  v_cvt_pk_bf16_f32 v107, v70, v71
  v_cvt_pk_bf16_f32 v108, v72, v73
  v_cvt_pk_bf16_f32 v109, v74, v75
  v_cvt_pk_bf16_f32 v110, v76, v77
  v_cvt_pk_bf16_f32 v111, v78, v79
  v_permlane16_swap_b32 v96, v98
  v_permlane16_swap_b32 v97, v99
  v_permlane16_swap_b32 v100, v102
  v_permlane16_swap_b32 v101, v103
  v_permlane16_swap_b32 v104, v106
  v_permlane16_swap_b32 v105, v107
  v_permlane16_swap_b32 v108, v110
  v_permlane16_swap_b32 v109, v111
  v_xor_b32 v116, 32, v115
  v_xor_b32 v121, 32, v114
  v_xor_b32 v117, 64, v115
  v_xor_b32 v122, 64, v114
  v_xor_b32 v118, 96, v115
  v_xor_b32 v123, 96, v114
  v_mov_b32 v120, v114
  s_mov_b32 s39, 0
k2_poll:
  buffer_load_dwordx2 v[32:33], v113, s[12:15], 0 offen sc0 sc1
  buffer_load_dwordx2 v[34:35], v80, s[12:15], 0 offen sc0 sc1
  buffer_load_dwordx2 v[36:37], v81, s[12:15], 0 offen sc0 sc1
  buffer_load_dwordx2 v[38:39], v82, s[12:15], 0 offen sc0 sc1
  buffer_load_dwordx2 v[40:41], v83, s[12:15], 0 offen sc0 sc1
  buffer_load_dwordx2 v[42:43], v84, s[12:15], 0 offen sc0 sc1
  buffer_load_dwordx2 v[44:45], v85, s[12:15], 0 offen sc0 sc1
  buffer_load_dwordx2 v[46:47], v86, s[12:15], 0 offen sc0 sc1
  s_waitcnt vmcnt(0)
  v_min3_i32 v16, v33, v35, v37
  v_min3_i32 v17, v39, v41, v43
  v_min3_i32 v16, v16, v45, v47
  v_min_i32 v16, v16, v17
  v_cmp_gt_i32 vcc, 0, v16
  s_add_u32 s39, s39, 1
  s_cmp_gt_u32 s39, 1000000
  s_cbranch_scc1 k2_pdone
  s_cbranch_vccnz k2_poll
k2_pdone:
  buffer_store_dwordx4 v[96:99], v12, s[20:23], 0 offen offset:0 sc0 sc1
  buffer_store_dwordx4 v[100:103], v12, s[20:23], 0 offen offset:64 sc0 sc1
  buffer_store_dwordx4 v[104:107], v12, s[20:23], 0 offen offset:2048 sc0 sc1
  buffer_store_dwordx4 v[108:111], v12, s[20:23], 0 offen offset:2112 sc0 sc1
  v_pk_add_f32 v[32:33], v[32:33], v[34:35]
  v_pk_add_f32 v[36:37], v[36:37], v[38:39]
  v_pk_add_f32 v[40:41], v[40:41], v[42:43]
  v_pk_add_f32 v[44:45], v[44:45], v[46:47]
  v_pk_add_f32 v[32:33], v[32:33], v[36:37]
  v_pk_add_f32 v[40:41], v[40:41], v[44:45]
  v_pk_add_f32 v[32:33], v[32:33], v[40:41]
  v_mov_b32 v34, v32
  v_mov_b32 v35, v33
  s_nop 0
  v_permlane32_swap_b32 v32, v34
  v_permlane32_swap_b32 v33, v35
  v_add_f32 v32, v32, v34
  v_add_f32 v33, v33, v35
  v_mul_f32 v32, 0x3a800000, v32
  v_mul_f32 v33, 0x3a800000, v33
  v_fma_f32 v33, -v32, v32, v33
  v_max_f32 v33, 0, v33
  v_mov_b32 v36, v33
  v_cvt_pk_bf16_f32 v36, v36, v36
  v_lshlrev_b32 v36, 16, v36
  v_add_f32 v36, 0x3727c5ac, v36
  v_cvt_pk_bf16_f32 v36, v36, v36
  v_lshlrev_b32 v36, 16, v36
  v_sqrt_f32 v36, v36
  s_nop 0
  v_cvt_pk_bf16_f32 v36, v36, v36
  v_lshlrev_b32 v36, 16, v36
  v_rcp_f32 v36, v36
  s_nop 0
  v_mul_f32 v33, v33, v36
  v_mul_f32 v33, v33, v36
  v_cvt_pk_bf16_f32 v33, v33, v33
  v_lshlrev_b32 v33, 16, v33
  v_add_f32 v33, 0x3727c5ac, v33
  v_cvt_pk_bf16_f32 v33, v33, v33
  v_lshlrev_b32 v33, 16, v33
  v_sqrt_f32 v33, v33
  s_nop 0
  v_cvt_pk_bf16_f32 v33, v33, v33
  v_lshlrev_b32 v33, 16, v33
  v_rcp_f32 v33, v33
  s_nop 0
  v_mul_f32 v33, v33, v36
  v_mov_b32 v34, v32
  v_mov_b32 v35, v33
  s_nop 0
  v_permlane16_swap_b32 v32, v34
  v_permlane16_swap_b32 v33, v35
  v_pk_add_f32 v[48:49], v[48:49], v[32:33] op_sel_hi:[1,0] neg_lo:[0,1] neg_hi:[0,1]
  v_pk_add_f32 v[50:51], v[50:51], v[32:33] op_sel_hi:[1,0] neg_lo:[0,1] neg_hi:[0,1]
  v_pk_add_f32 v[52:53], v[52:53], v[32:33] op_sel_hi:[1,0] neg_lo:[0,1] neg_hi:[0,1]
  v_pk_add_f32 v[54:55], v[54:55], v[32:33] op_sel_hi:[1,0] neg_lo:[0,1] neg_hi:[0,1]
  v_pk_add_f32 v[56:57], v[56:57], v[32:33] op_sel_hi:[1,0] neg_lo:[0,1] neg_hi:[0,1]
  v_pk_add_f32 v[58:59], v[58:59], v[32:33] op_sel_hi:[1,0] neg_lo:[0,1] neg_hi:[0,1]
  v_pk_add_f32 v[60:61], v[60:61], v[32:33] op_sel_hi:[1,0] neg_lo:[0,1] neg_hi:[0,1]
  v_pk_add_f32 v[62:63], v[62:63], v[32:33] op_sel_hi:[1,0] neg_lo:[0,1] neg_hi:[0,1]
  v_pk_mul_f32 v[48:49], v[48:49], v[32:33] op_sel:[0,1] op_sel_hi:[1,1]
  v_pk_mul_f32 v[50:51], v[50:51], v[32:33] op_sel:[0,1] op_sel_hi:[1,1]
  v_pk_mul_f32 v[52:53], v[52:53], v[32:33] op_sel:[0,1] op_sel_hi:[1,1]
  v_pk_mul_f32 v[54:55], v[54:55], v[32:33] op_sel:[0,1] op_sel_hi:[1,1]
  v_pk_mul_f32 v[56:57], v[56:57], v[32:33] op_sel:[0,1] op_sel_hi:[1,1]
  v_pk_mul_f32 v[58:59], v[58:59], v[32:33] op_sel:[0,1] op_sel_hi:[1,1]
  v_pk_mul_f32 v[60:61], v[60:61], v[32:33] op_sel:[0,1] op_sel_hi:[1,1]
  v_pk_mul_f32 v[62:63], v[62:63], v[32:33] op_sel:[0,1] op_sel_hi:[1,1]
  v_cvt_pk_bf16_f32 v160, v48, v49
  v_cvt_pk_bf16_f32 v161, v50, v51
  ds_write_b64 v120, v[160:161] offset:0
  v_cvt_pk_bf16_f32 v162, v52, v53
  v_cvt_pk_bf16_f32 v163, v54, v55
  ds_write_b64 v121, v[162:163] offset:0
  v_cvt_pk_bf16_f32 v164, v56, v57
  v_cvt_pk_bf16_f32 v165, v58, v59
  ds_write_b64 v122, v[164:165] offset:0
  v_cvt_pk_bf16_f32 v166, v60, v61
  v_cvt_pk_bf16_f32 v167, v62, v63
  ds_write_b64 v123, v[166:167] offset:0
  v_pk_add_f32 v[64:65], v[64:65], v[34:35] op_sel_hi:[1,0] neg_lo:[0,1] neg_hi:[0,1]
  v_pk_add_f32 v[66:67], v[66:67], v[34:35] op_sel_hi:[1,0] neg_lo:[0,1] neg_hi:[0,1]
  v_pk_add_f32 v[68:69], v[68:69], v[34:35] op_sel_hi:[1,0] neg_lo:[0,1] neg_hi:[0,1]
  v_pk_add_f32 v[70:71], v[70:71], v[34:35] op_sel_hi:[1,0] neg_lo:[0,1] neg_hi:[0,1]
  v_pk_add_f32 v[72:73], v[72:73], v[34:35] op_sel_hi:[1,0] neg_lo:[0,1] neg_hi:[0,1]
  v_pk_add_f32 v[74:75], v[74:75], v[34:35] op_sel_hi:[1,0] neg_lo:[0,1] neg_hi:[0,1]
  v_pk_add_f32 v[76:77], v[76:77], v[34:35] op_sel_hi:[1,0] neg_lo:[0,1] neg_hi:[0,1]
  v_pk_add_f32 v[78:79], v[78:79], v[34:35] op_sel_hi:[1,0] neg_lo:[0,1] neg_hi:[0,1]
  v_pk_mul_f32 v[64:65], v[64:65], v[34:35] op_sel:[0,1] op_sel_hi:[1,1]
  v_pk_mul_f32 v[66:67], v[66:67], v[34:35] op_sel:[0,1] op_sel_hi:[1,1]
  v_pk_mul_f32 v[68:69], v[68:69], v[34:35] op_sel:[0,1] op_sel_hi:[1,1]
  v_pk_mul_f32 v[70:71], v[70:71], v[34:35] op_sel:[0,1] op_sel_hi:[1,1]
  v_pk_mul_f32 v[72:73], v[72:73], v[34:35] op_sel:[0,1] op_sel_hi:[1,1]
  v_pk_mul_f32 v[74:75], v[74:75], v[34:35] op_sel:[0,1] op_sel_hi:[1,1]
  v_pk_mul_f32 v[76:77], v[76:77], v[34:35] op_sel:[0,1] op_sel_hi:[1,1]
  v_pk_mul_f32 v[78:79], v[78:79], v[34:35] op_sel:[0,1] op_sel_hi:[1,1]
  v_cvt_pk_bf16_f32 v168, v64, v65
  v_cvt_pk_bf16_f32 v169, v66, v67
  ds_write_b64 v120, v[168:169] offset:128
  v_cvt_pk_bf16_f32 v170, v68, v69
  v_cvt_pk_bf16_f32 v171, v70, v71
  ds_write_b64 v121, v[170:171] offset:128
  v_cvt_pk_bf16_f32 v172, v72, v73
  v_cvt_pk_bf16_f32 v173, v74, v75
  ds_write_b64 v122, v[172:173] offset:128
  v_cvt_pk_bf16_f32 v174, v76, v77
  v_cvt_pk_bf16_f32 v175, v78, v79
  ds_write_b64 v123, v[174:175] offset:128
  s_waitcnt lgkmcnt(0)
  ds_read_b64_tr_b16 v[176:177], v115
  ds_read_b64_tr_b16 v[178:179], v115 offset:512
  ds_read_b64_tr_b16 v[180:181], v116
  ds_read_b64_tr_b16 v[182:183], v116 offset:512
  ds_read_b64_tr_b16 v[184:185], v117
  ds_read_b64_tr_b16 v[186:187], v117 offset:512
  ds_read_b64_tr_b16 v[188:189], v118
  ds_read_b64_tr_b16 v[190:191], v118 offset:512
  s_waitcnt lgkmcnt(6)
  buffer_store_dwordx4 v[176:179], v14, s[24:27], s44 offen sc0 sc1
  s_waitcnt lgkmcnt(4)
  buffer_store_dwordx4 v[180:183], v14, s[24:27], s45 offen sc0 sc1
  s_waitcnt lgkmcnt(2)
  buffer_store_dwordx4 v[184:187], v14, s[24:27], s46 offen sc0 sc1
  s_waitcnt lgkmcnt(0)
  buffer_store_dwordx4 v[188:191], v14, s[24:27], s47 offen sc0 sc1
  s_cmp_ge_u32 s2, 224
  s_cbranch_scc1 C_k3skip
  s_lshr_b32 s32, s2, 3
  s_mul_i32 s5, s32, 9363
  s_lshr_b32 s5, s5, 16
  s_mul_i32 s6, s5, 7
  s_sub_u32 s6, s32, s6
  s_lshl_b32 s7, s5, 1
  s_add_u32 s7, s7, s6
  s_and_b32 s7, s7, 7
  s_and_b32 s32, s2, 7
  s_lshr_b32 s28, s32, 2
  s_lshl_b32 s28, s28, 2
  s_add_u32 s28, s28, s5
  s_and_b32 s29, s32, 3
  s_mul_i32 s29, s29, 7
  s_add_u32 s29, s29, s6
  s_mov_b32 s30, 7
  s_mov_b32 s31, -1
  s_and_b32 s46, s4, 1
  s_lshr_b32 s41, s4, 1
  s_lshl_b32 s32, s29, 8
  s_lshl_b32 s44, s46, 7
  s_add_u32 s32, s32, s44
  v_lshlrev_b32 v16, 3, v5
  v_add_u32 v16, s32, v16
  s_mov_b32 s16, s74
  s_mov_b32 s17, s75
  s_mov_b32 s18, 7168
  s_mov_b32 s19, 0x20000
  buffer_load_dwordx2 v[144:145], v16, s[16:19], 0 offen offset:0
  buffer_load_dwordx2 v[146:147], v16, s[16:19], 0 offen offset:32
  buffer_load_dwordx2 v[148:149], v16, s[16:19], 0 offen offset:64
  buffer_load_dwordx2 v[150:151], v16, s[16:19], 0 offen offset:96
  s_add_u32 s20, s82, 12582912
  s_addc_u32 s21, s83, 0
  s_mov_b32 s22, 7340032
  s_mov_b32 s23, 0x20000
  v_lshl_add_u32 v17, v5, 3, v6
  v_lshlrev_b32 v17, 8, v17
  v_lshl_add_u32 v17, v7, 3, v17
  v_lshl_or_b32 v18, v2, 2, v6
  v_lshl_add_u32 v17, v18, 5, v17
  s_lshl_b32 s32, s46, 7
  s_add_u32 s32, s32, 16384
  v_xor_b32 v18, s32, v17
  s_lshl_b32 s32, s41, 13
  v_add_u32 v12, s32, v14
  v_xor_b32 v8, 0, v18
  v_xor_b32 v9, 32, v18
  v_xor_b32 v10, 64, v18
  v_xor_b32 v11, 96, v18
  v_bfe_u32 v17, v4, 2, 1
  v_lshlrev_b32 v17, 10, v17
  v_lshl_add_u32 v17, v3, 8, v17
  v_lshrrev_b32 v18, 3, v4
  v_lshl_add_u32 v17, v18, 6, v17
  v_lshl_add_u32 v152, v7, 4, v17
  v_add_u32 v153, 128, v152
  s_lshl_b32 s32, s28, 1
  s_add_u32 s32, s32, s41
  s_mul_i32 s32, s32, 224
  s_lshl_b32 s44, s29, 2
  s_add_u32 s32, s32, s44
  s_lshl_b32 s44, s46, 1
  s_add_u32 s32, s32, s44
  s_lshl_b32 s44, s32, 11
  s_add_u32 s45, s44, 229376
  s_waitcnt vmcnt(0)
  s_barrier
  v_lshlrev_b32 v80, 16, v144
  v_and_b32 v81, 0xffff0000, v144
  v_lshlrev_b32 v82, 16, v145
  v_and_b32 v83, 0xffff0000, v145
  v_mov_b64 v[96:97], v[80:81]
  v_mov_b64 v[98:99], v[82:83]
  v_mov_b64 v[112:113], v[80:81]
  v_mov_b64 v[114:115], v[82:83]
  v_mov_b64 v[128:129], v[80:81]
  v_mov_b64 v[130:131], v[82:83]
  v_lshlrev_b32 v84, 16, v146
  v_and_b32 v85, 0xffff0000, v146
  v_lshlrev_b32 v86, 16, v147
  v_and_b32 v87, 0xffff0000, v147
  v_mov_b64 v[100:101], v[84:85]
  v_mov_b64 v[102:103], v[86:87]
  v_mov_b64 v[116:117], v[84:85]
  v_mov_b64 v[118:119], v[86:87]
  v_mov_b64 v[132:133], v[84:85]
  v_mov_b64 v[134:135], v[86:87]
  v_lshlrev_b32 v88, 16, v148
  v_and_b32 v89, 0xffff0000, v148
  v_lshlrev_b32 v90, 16, v149
  v_and_b32 v91, 0xffff0000, v149
  v_mov_b64 v[104:105], v[88:89]
  v_mov_b64 v[106:107], v[90:91]
  v_mov_b64 v[120:121], v[88:89]
  v_mov_b64 v[122:123], v[90:91]
  v_mov_b64 v[136:137], v[88:89]
  v_mov_b64 v[138:139], v[90:91]
  v_lshlrev_b32 v92, 16, v150
  v_and_b32 v93, 0xffff0000, v150
  v_lshlrev_b32 v94, 16, v151
  v_and_b32 v95, 0xffff0000, v151
  v_mov_b64 v[108:109], v[92:93]
  v_mov_b64 v[110:111], v[94:95]
  v_mov_b64 v[124:125], v[92:93]
  v_mov_b64 v[126:127], v[94:95]
  v_mov_b64 v[140:141], v[92:93]
  v_mov_b64 v[142:143], v[94:95]
  s_barrier
  s_mov_b32 s43, 0
  s_mov_b32 s39, 15
  s_add_u32 s40, s43, 32768
  s_cmp_eq_u32 s40, 163840
  s_cselect_b32 s40, 0, s40
  s_sub_u32 s42, s40, s43
  s_mov_b32 s43, s40
  s_barrier
  ds_read_b64_tr_b16 v[16:17], v8 offset:0
  ds_read_b64_tr_b16 v[18:19], v8 offset:1024
  ds_read_b128 v[32:35], v12 offset:0
  ds_read_b64_tr_b16 v[48:49], v8 offset:8192
  ds_read_b64_tr_b16 v[50:51], v8 offset:9216
  ds_read_b128 v[64:67], v12 offset:1024
  ds_read_b128 v[68:71], v12 offset:3072
  ds_read_b128 v[36:39], v12 offset:2048
  ds_read_b64_tr_b16 v[20:21], v9 offset:0
  ds_read_b64_tr_b16 v[22:23], v9 offset:1024
  ds_read_b64_tr_b16 v[52:53], v9 offset:8192
  ds_read_b64_tr_b16 v[54:55], v9 offset:9216
  ds_read_b64_tr_b16 v[24:25], v10 offset:0
  ds_read_b64_tr_b16 v[26:27], v10 offset:1024
  ds_read_b64_tr_b16 v[56:57], v10 offset:8192
  ds_read_b64_tr_b16 v[58:59], v10 offset:9216
  ds_read_b128 v[40:43], v12 offset:4096
  ds_read_b128 v[72:75], v12 offset:5120
  ds_read_b128 v[76:79], v12 offset:7168
  ds_read_b128 v[44:47], v12 offset:6144
  ds_read_b64_tr_b16 v[28:29], v11 offset:0
  ds_read_b64_tr_b16 v[30:31], v11 offset:1024
  ds_read_b64_tr_b16 v[60:61], v11 offset:8192
  ds_read_b64_tr_b16 v[62:63], v11 offset:9216
  v_add_u32 v8, s42, v8
  v_add_u32 v9, s42, v9
  v_add_u32 v10, s42, v10
  v_add_u32 v11, s42, v11
  v_add_u32 v12, s42, v12
cf4:
  s_barrier
  s_waitcnt lgkmcnt(14)
  v_mfma_f32_16x16x32_bf16 v[80:83], v[16:19], v[32:35], v[80:83]
  ds_read_b64_tr_b16 v[156:157], v8 offset:0
  s_add_u32 s40, s43, 32768
  s_cmp_eq_u32 s40, 163840
  v_mfma_f32_16x16x32_bf16 v[80:83], v[48:51], v[64:67], v[80:83]
  ds_read_b64_tr_b16 v[158:159], v8 offset:1024
  s_cselect_b32 s40, 0, s40
  s_sub_u32 s42, s40, s43
  v_mfma_f32_16x16x32_bf16 v[96:99], v[48:51], v[68:71], v[96:99]
  ds_read_b128 v[172:175], v12 offset:0
  s_mov_b32 s43, s40
  v_mfma_f32_16x16x32_bf16 v[96:99], v[16:19], v[36:39], v[96:99]
  ds_read_b64_tr_b16 v[188:189], v8 offset:8192
  v_mfma_f32_16x16x32_bf16 v[100:103], v[20:23], v[36:39], v[100:103]
  ds_read_b64_tr_b16 v[190:191], v8 offset:9216
  v_add_u32 v8, s42, v8
  s_waitcnt lgkmcnt(14)
  v_mfma_f32_16x16x32_bf16 v[100:103], v[52:55], v[68:71], v[100:103]
  ds_read_b128 v[204:207], v12 offset:1024
  v_mfma_f32_16x16x32_bf16 v[84:87], v[52:55], v[64:67], v[84:87]
  ds_read_b128 v[208:211], v12 offset:3072
  v_mfma_f32_16x16x32_bf16 v[84:87], v[20:23], v[32:35], v[84:87]
  ds_read_b128 v[176:179], v12 offset:2048
  v_mfma_f32_16x16x32_bf16 v[88:91], v[24:27], v[32:35], v[88:91]
  ds_read_b64_tr_b16 v[160:161], v9 offset:0
  s_waitcnt lgkmcnt(14)
  v_mfma_f32_16x16x32_bf16 v[88:91], v[56:59], v[64:67], v[88:91]
  ds_read_b64_tr_b16 v[162:163], v9 offset:1024
  v_mfma_f32_16x16x32_bf16 v[104:107], v[56:59], v[68:71], v[104:107]
  ds_read_b64_tr_b16 v[192:193], v9 offset:8192
  v_mfma_f32_16x16x32_bf16 v[104:107], v[24:27], v[36:39], v[104:107]
  ds_read_b64_tr_b16 v[194:195], v9 offset:9216
  v_add_u32 v9, s42, v9
  v_mfma_f32_16x16x32_bf16 v[120:123], v[24:27], v[40:43], v[120:123]
  ds_read_b64_tr_b16 v[164:165], v10 offset:0
  v_mfma_f32_16x16x32_bf16 v[120:123], v[56:59], v[72:75], v[120:123]
  ds_read_b64_tr_b16 v[166:167], v10 offset:1024
  v_mfma_f32_16x16x32_bf16 v[116:119], v[52:55], v[72:75], v[116:119]
  ds_read_b64_tr_b16 v[196:197], v10 offset:8192
  v_mfma_f32_16x16x32_bf16 v[116:119], v[20:23], v[40:43], v[116:119]
  ds_read_b64_tr_b16 v[198:199], v10 offset:9216
  v_add_u32 v10, s42, v10
  v_mfma_f32_16x16x32_bf16 v[112:115], v[16:19], v[40:43], v[112:115]
  ds_read_b128 v[180:183], v12 offset:4096
  v_mfma_f32_16x16x32_bf16 v[112:115], v[48:51], v[72:75], v[112:115]
  ds_read_b128 v[212:215], v12 offset:5120
  v_mfma_f32_16x16x32_bf16 v[128:131], v[48:51], v[76:79], v[128:131]
  ds_read_b128 v[216:219], v12 offset:7168
  s_waitcnt lgkmcnt(14)
  v_mfma_f32_16x16x32_bf16 v[128:131], v[16:19], v[44:47], v[128:131]
  ds_read_b128 v[184:187], v12 offset:6144
  v_add_u32 v12, s42, v12
  v_mfma_f32_16x16x32_bf16 v[132:135], v[20:23], v[44:47], v[132:135]
  ds_read_b64_tr_b16 v[168:169], v11 offset:0
  v_mfma_f32_16x16x32_bf16 v[132:135], v[52:55], v[76:79], v[132:135]
  ds_read_b64_tr_b16 v[170:171], v11 offset:1024
  v_mfma_f32_16x16x32_bf16 v[136:139], v[56:59], v[76:79], v[136:139]
  ds_read_b64_tr_b16 v[200:201], v11 offset:8192
  v_mfma_f32_16x16x32_bf16 v[136:139], v[24:27], v[44:47], v[136:139]
  ds_read_b64_tr_b16 v[202:203], v11 offset:9216
  v_add_u32 v11, s42, v11
  v_mfma_f32_16x16x32_bf16 v[140:143], v[28:31], v[44:47], v[140:143]
  v_mfma_f32_16x16x32_bf16 v[140:143], v[60:63], v[76:79], v[140:143]
  v_mfma_f32_16x16x32_bf16 v[124:127], v[60:63], v[72:75], v[124:127]
  v_mfma_f32_16x16x32_bf16 v[124:127], v[28:31], v[40:43], v[124:127]
  v_mfma_f32_16x16x32_bf16 v[108:111], v[28:31], v[36:39], v[108:111]
  v_mfma_f32_16x16x32_bf16 v[108:111], v[60:63], v[68:71], v[108:111]
  v_mfma_f32_16x16x32_bf16 v[92:95], v[60:63], v[64:67], v[92:95]
  v_mfma_f32_16x16x32_bf16 v[92:95], v[28:31], v[32:35], v[92:95]
  s_barrier
  s_waitcnt lgkmcnt(14)
  v_mfma_f32_16x16x32_bf16 v[80:83], v[156:159], v[172:175], v[80:83]
  ds_read_b64_tr_b16 v[16:17], v8 offset:0
  s_add_u32 s40, s43, 32768
  s_cmp_eq_u32 s40, 163840
  v_mfma_f32_16x16x32_bf16 v[80:83], v[188:191], v[204:207], v[80:83]
  ds_read_b64_tr_b16 v[18:19], v8 offset:1024
  s_cselect_b32 s40, 0, s40
  s_sub_u32 s42, s40, s43
  v_mfma_f32_16x16x32_bf16 v[96:99], v[188:191], v[208:211], v[96:99]
  ds_read_b128 v[32:35], v12 offset:0
  s_mov_b32 s43, s40
  v_mfma_f32_16x16x32_bf16 v[96:99], v[156:159], v[176:179], v[96:99]
  ds_read_b64_tr_b16 v[48:49], v8 offset:8192
  v_mfma_f32_16x16x32_bf16 v[100:103], v[160:163], v[176:179], v[100:103]
  ds_read_b64_tr_b16 v[50:51], v8 offset:9216
  v_add_u32 v8, s42, v8
  s_waitcnt lgkmcnt(14)
  v_mfma_f32_16x16x32_bf16 v[100:103], v[192:195], v[208:211], v[100:103]
  ds_read_b128 v[64:67], v12 offset:1024
  v_mfma_f32_16x16x32_bf16 v[84:87], v[192:195], v[204:207], v[84:87]
  ds_read_b128 v[68:71], v12 offset:3072
  v_mfma_f32_16x16x32_bf16 v[84:87], v[160:163], v[172:175], v[84:87]
  ds_read_b128 v[36:39], v12 offset:2048
  v_mfma_f32_16x16x32_bf16 v[88:91], v[164:167], v[172:175], v[88:91]
  ds_read_b64_tr_b16 v[20:21], v9 offset:0
  s_waitcnt lgkmcnt(14)
  v_mfma_f32_16x16x32_bf16 v[88:91], v[196:199], v[204:207], v[88:91]
  ds_read_b64_tr_b16 v[22:23], v9 offset:1024
  v_mfma_f32_16x16x32_bf16 v[104:107], v[196:199], v[208:211], v[104:107]
  ds_read_b64_tr_b16 v[52:53], v9 offset:8192
  v_mfma_f32_16x16x32_bf16 v[104:107], v[164:167], v[176:179], v[104:107]
  ds_read_b64_tr_b16 v[54:55], v9 offset:9216
  v_add_u32 v9, s42, v9
  v_mfma_f32_16x16x32_bf16 v[120:123], v[164:167], v[180:183], v[120:123]
  ds_read_b64_tr_b16 v[24:25], v10 offset:0
  v_mfma_f32_16x16x32_bf16 v[120:123], v[196:199], v[212:215], v[120:123]
  ds_read_b64_tr_b16 v[26:27], v10 offset:1024
  v_mfma_f32_16x16x32_bf16 v[116:119], v[192:195], v[212:215], v[116:119]
  ds_read_b64_tr_b16 v[56:57], v10 offset:8192
  v_mfma_f32_16x16x32_bf16 v[116:119], v[160:163], v[180:183], v[116:119]
  ds_read_b64_tr_b16 v[58:59], v10 offset:9216
  v_add_u32 v10, s42, v10
  v_mfma_f32_16x16x32_bf16 v[112:115], v[156:159], v[180:183], v[112:115]
  ds_read_b128 v[40:43], v12 offset:4096
  v_mfma_f32_16x16x32_bf16 v[112:115], v[188:191], v[212:215], v[112:115]
  ds_read_b128 v[72:75], v12 offset:5120
  v_mfma_f32_16x16x32_bf16 v[128:131], v[188:191], v[216:219], v[128:131]
  ds_read_b128 v[76:79], v12 offset:7168
  s_waitcnt lgkmcnt(14)
  v_mfma_f32_16x16x32_bf16 v[128:131], v[156:159], v[184:187], v[128:131]
  ds_read_b128 v[44:47], v12 offset:6144
  v_add_u32 v12, s42, v12
  v_mfma_f32_16x16x32_bf16 v[132:135], v[160:163], v[184:187], v[132:135]
  ds_read_b64_tr_b16 v[28:29], v11 offset:0
  v_mfma_f32_16x16x32_bf16 v[132:135], v[192:195], v[216:219], v[132:135]
  ds_read_b64_tr_b16 v[30:31], v11 offset:1024
  v_mfma_f32_16x16x32_bf16 v[136:139], v[196:199], v[216:219], v[136:139]
  ds_read_b64_tr_b16 v[60:61], v11 offset:8192
  v_mfma_f32_16x16x32_bf16 v[136:139], v[164:167], v[184:187], v[136:139]
  ds_read_b64_tr_b16 v[62:63], v11 offset:9216
  v_add_u32 v11, s42, v11
  v_mfma_f32_16x16x32_bf16 v[140:143], v[168:171], v[184:187], v[140:143]
  v_mfma_f32_16x16x32_bf16 v[140:143], v[200:203], v[216:219], v[140:143]
  v_mfma_f32_16x16x32_bf16 v[124:127], v[200:203], v[212:215], v[124:127]
  v_mfma_f32_16x16x32_bf16 v[124:127], v[168:171], v[180:183], v[124:127]
  v_mfma_f32_16x16x32_bf16 v[108:111], v[168:171], v[176:179], v[108:111]
  v_mfma_f32_16x16x32_bf16 v[108:111], v[200:203], v[208:211], v[108:111]
  v_mfma_f32_16x16x32_bf16 v[92:95], v[200:203], v[204:207], v[92:95]
  v_mfma_f32_16x16x32_bf16 v[92:95], v[168:171], v[172:175], v[92:95]
  s_sub_u32 s39, s39, 1
  s_cmp_lg_u32 s39, 0
  s_cbranch_scc1 cf4
  s_barrier
  s_waitcnt lgkmcnt(14)
  v_mfma_f32_16x16x32_bf16 v[80:83], v[16:19], v[32:35], v[80:83]
  ds_read_b64_tr_b16 v[156:157], v8 offset:0
  s_add_u32 s40, s43, 32768
  s_cmp_eq_u32 s40, 163840
  v_mfma_f32_16x16x32_bf16 v[80:83], v[48:51], v[64:67], v[80:83]
  ds_read_b64_tr_b16 v[158:159], v8 offset:1024
  s_cselect_b32 s40, 0, s40
  s_sub_u32 s42, s40, s43
  v_mfma_f32_16x16x32_bf16 v[96:99], v[48:51], v[68:71], v[96:99]
  ds_read_b128 v[172:175], v12 offset:0
  s_mov_b32 s43, s40
  v_mfma_f32_16x16x32_bf16 v[96:99], v[16:19], v[36:39], v[96:99]
  ds_read_b64_tr_b16 v[188:189], v8 offset:8192
  v_mfma_f32_16x16x32_bf16 v[100:103], v[20:23], v[36:39], v[100:103]
  ds_read_b64_tr_b16 v[190:191], v8 offset:9216
  v_add_u32 v8, s42, v8
  s_waitcnt lgkmcnt(14)
  v_mfma_f32_16x16x32_bf16 v[100:103], v[52:55], v[68:71], v[100:103]
  ds_read_b128 v[204:207], v12 offset:1024
  v_mfma_f32_16x16x32_bf16 v[84:87], v[52:55], v[64:67], v[84:87]
  ds_read_b128 v[208:211], v12 offset:3072
  v_mfma_f32_16x16x32_bf16 v[84:87], v[20:23], v[32:35], v[84:87]
  ds_read_b128 v[176:179], v12 offset:2048
  v_mfma_f32_16x16x32_bf16 v[88:91], v[24:27], v[32:35], v[88:91]
  ds_read_b64_tr_b16 v[160:161], v9 offset:0
  s_waitcnt lgkmcnt(14)
  v_mfma_f32_16x16x32_bf16 v[88:91], v[56:59], v[64:67], v[88:91]
  ds_read_b64_tr_b16 v[162:163], v9 offset:1024
  v_mfma_f32_16x16x32_bf16 v[104:107], v[56:59], v[68:71], v[104:107]
  ds_read_b64_tr_b16 v[192:193], v9 offset:8192
  v_mfma_f32_16x16x32_bf16 v[104:107], v[24:27], v[36:39], v[104:107]
  ds_read_b64_tr_b16 v[194:195], v9 offset:9216
  v_add_u32 v9, s42, v9
  v_mfma_f32_16x16x32_bf16 v[120:123], v[24:27], v[40:43], v[120:123]
  ds_read_b64_tr_b16 v[164:165], v10 offset:0
  v_mfma_f32_16x16x32_bf16 v[120:123], v[56:59], v[72:75], v[120:123]
  ds_read_b64_tr_b16 v[166:167], v10 offset:1024
  v_mfma_f32_16x16x32_bf16 v[116:119], v[52:55], v[72:75], v[116:119]
  ds_read_b64_tr_b16 v[196:197], v10 offset:8192
  v_mfma_f32_16x16x32_bf16 v[116:119], v[20:23], v[40:43], v[116:119]
  ds_read_b64_tr_b16 v[198:199], v10 offset:9216
  v_add_u32 v10, s42, v10
  v_mfma_f32_16x16x32_bf16 v[112:115], v[16:19], v[40:43], v[112:115]
  ds_read_b128 v[180:183], v12 offset:4096
  v_mfma_f32_16x16x32_bf16 v[112:115], v[48:51], v[72:75], v[112:115]
  ds_read_b128 v[212:215], v12 offset:5120
  v_mfma_f32_16x16x32_bf16 v[128:131], v[48:51], v[76:79], v[128:131]
  ds_read_b128 v[216:219], v12 offset:7168
  s_waitcnt lgkmcnt(14)
  v_mfma_f32_16x16x32_bf16 v[128:131], v[16:19], v[44:47], v[128:131]
  ds_read_b128 v[184:187], v12 offset:6144
  v_add_u32 v12, s42, v12
  v_mfma_f32_16x16x32_bf16 v[132:135], v[20:23], v[44:47], v[132:135]
  ds_read_b64_tr_b16 v[168:169], v11 offset:0
  v_mfma_f32_16x16x32_bf16 v[132:135], v[52:55], v[76:79], v[132:135]
  ds_read_b64_tr_b16 v[170:171], v11 offset:1024
  v_mfma_f32_16x16x32_bf16 v[136:139], v[56:59], v[76:79], v[136:139]
  ds_read_b64_tr_b16 v[200:201], v11 offset:8192
  v_mfma_f32_16x16x32_bf16 v[136:139], v[24:27], v[44:47], v[136:139]
  ds_read_b64_tr_b16 v[202:203], v11 offset:9216
  v_add_u32 v11, s42, v11
  v_mfma_f32_16x16x32_bf16 v[140:143], v[28:31], v[44:47], v[140:143]
  v_mfma_f32_16x16x32_bf16 v[140:143], v[60:63], v[76:79], v[140:143]
  v_mfma_f32_16x16x32_bf16 v[124:127], v[60:63], v[72:75], v[124:127]
  v_mfma_f32_16x16x32_bf16 v[124:127], v[28:31], v[40:43], v[124:127]
  v_mfma_f32_16x16x32_bf16 v[108:111], v[28:31], v[36:39], v[108:111]
  v_mfma_f32_16x16x32_bf16 v[108:111], v[60:63], v[68:71], v[108:111]
  v_mfma_f32_16x16x32_bf16 v[92:95], v[60:63], v[64:67], v[92:95]
  v_mfma_f32_16x16x32_bf16 v[92:95], v[28:31], v[32:35], v[92:95]
  s_waitcnt lgkmcnt(14)
  v_mfma_f32_16x16x32_bf16 v[80:83], v[156:159], v[172:175], v[80:83]
  v_mfma_f32_16x16x32_bf16 v[80:83], v[188:191], v[204:207], v[80:83]
  v_mfma_f32_16x16x32_bf16 v[96:99], v[188:191], v[208:211], v[96:99]
  v_mfma_f32_16x16x32_bf16 v[96:99], v[156:159], v[176:179], v[96:99]
  v_mfma_f32_16x16x32_bf16 v[100:103], v[160:163], v[176:179], v[100:103]
  s_waitcnt lgkmcnt(12)
  v_mfma_f32_16x16x32_bf16 v[100:103], v[192:195], v[208:211], v[100:103]
  v_mfma_f32_16x16x32_bf16 v[84:87], v[192:195], v[204:207], v[84:87]
  v_mfma_f32_16x16x32_bf16 v[84:87], v[160:163], v[172:175], v[84:87]
  s_waitcnt lgkmcnt(10)
  v_mfma_f32_16x16x32_bf16 v[88:91], v[164:167], v[172:175], v[88:91]
  s_waitcnt lgkmcnt(8)
  v_mfma_f32_16x16x32_bf16 v[88:91], v[196:199], v[204:207], v[88:91]
  v_mfma_f32_16x16x32_bf16 v[104:107], v[196:199], v[208:211], v[104:107]
  v_mfma_f32_16x16x32_bf16 v[104:107], v[164:167], v[176:179], v[104:107]
  s_waitcnt lgkmcnt(7)
  v_mfma_f32_16x16x32_bf16 v[120:123], v[164:167], v[180:183], v[120:123]
  s_waitcnt lgkmcnt(6)
  v_mfma_f32_16x16x32_bf16 v[120:123], v[196:199], v[212:215], v[120:123]
  v_mfma_f32_16x16x32_bf16 v[116:119], v[192:195], v[212:215], v[116:119]
  v_mfma_f32_16x16x32_bf16 v[116:119], v[160:163], v[180:183], v[116:119]
  v_mfma_f32_16x16x32_bf16 v[112:115], v[156:159], v[180:183], v[112:115]
  v_mfma_f32_16x16x32_bf16 v[112:115], v[188:191], v[212:215], v[112:115]
  s_waitcnt lgkmcnt(5)
  v_mfma_f32_16x16x32_bf16 v[128:131], v[188:191], v[216:219], v[128:131]
  s_waitcnt lgkmcnt(4)
  v_mfma_f32_16x16x32_bf16 v[128:131], v[156:159], v[184:187], v[128:131]
  v_mfma_f32_16x16x32_bf16 v[132:135], v[160:163], v[184:187], v[132:135]
  v_mfma_f32_16x16x32_bf16 v[132:135], v[192:195], v[216:219], v[132:135]
  v_mfma_f32_16x16x32_bf16 v[136:139], v[196:199], v[216:219], v[136:139]
  v_mfma_f32_16x16x32_bf16 v[136:139], v[164:167], v[184:187], v[136:139]
  s_waitcnt lgkmcnt(2)
  v_mfma_f32_16x16x32_bf16 v[140:143], v[168:171], v[184:187], v[140:143]
  s_waitcnt lgkmcnt(0)
  v_mfma_f32_16x16x32_bf16 v[140:143], v[200:203], v[216:219], v[140:143]
  v_mfma_f32_16x16x32_bf16 v[124:127], v[200:203], v[212:215], v[124:127]
  v_mfma_f32_16x16x32_bf16 v[124:127], v[168:171], v[180:183], v[124:127]
  v_mfma_f32_16x16x32_bf16 v[108:111], v[168:171], v[176:179], v[108:111]
  v_mfma_f32_16x16x32_bf16 v[108:111], v[200:203], v[208:211], v[108:111]
  v_mfma_f32_16x16x32_bf16 v[92:95], v[200:203], v[204:207], v[92:95]
  v_mfma_f32_16x16x32_bf16 v[92:95], v[168:171], v[172:175], v[92:95]
  s_waitcnt lgkmcnt(0)
  v_mov_b32 v16, 0xc0135761
  v_mov_b32 v17, 0xbdd2d3e8
  v_pk_mul_f32 v[24:25], v[80:81], v[80:81]
  v_pk_mul_f32 v[26:27], v[82:83], v[82:83]
  v_pk_mul_f32 v[28:29], v[84:85], v[84:85]
  v_pk_mul_f32 v[30:31], v[86:87], v[86:87]
  v_pk_fma_f32 v[24:25], v[24:25], v[16:17], v[16:17] op_sel:[0,1,0] op_sel_hi:[1,1,0]
  v_pk_fma_f32 v[26:27], v[26:27], v[16:17], v[16:17] op_sel:[0,1,0] op_sel_hi:[1,1,0]
  v_pk_fma_f32 v[28:29], v[28:29], v[16:17], v[16:17] op_sel:[0,1,0] op_sel_hi:[1,1,0]
  v_pk_fma_f32 v[30:31], v[30:31], v[16:17], v[16:17] op_sel:[0,1,0] op_sel_hi:[1,1,0]
  v_pk_mul_f32 v[24:25], v[24:25], v[80:81]
  v_pk_mul_f32 v[26:27], v[26:27], v[82:83]
  v_pk_mul_f32 v[28:29], v[28:29], v[84:85]
  v_pk_mul_f32 v[30:31], v[30:31], v[86:87]
  v_exp_f32 v24, v24
  v_exp_f32 v25, v25
  v_exp_f32 v26, v26
  v_exp_f32 v27, v27
  v_exp_f32 v28, v28
  v_exp_f32 v29, v29
  v_exp_f32 v30, v30
  v_exp_f32 v31, v31
  v_pk_add_f32 v[24:25], v[24:25], 1.0 op_sel_hi:[1,0]
  v_pk_add_f32 v[26:27], v[26:27], 1.0 op_sel_hi:[1,0]
  v_pk_add_f32 v[28:29], v[28:29], 1.0 op_sel_hi:[1,0]
  v_pk_add_f32 v[30:31], v[30:31], 1.0 op_sel_hi:[1,0]
  v_rcp_f32 v24, v24
  v_rcp_f32 v25, v25
  v_rcp_f32 v26, v26
  v_rcp_f32 v27, v27
  v_rcp_f32 v28, v28
  v_rcp_f32 v29, v29
  v_rcp_f32 v30, v30
  v_rcp_f32 v31, v31
  v_pk_mul_f32 v[24:25], v[24:25], v[80:81]
  v_pk_mul_f32 v[26:27], v[26:27], v[82:83]
  v_pk_mul_f32 v[28:29], v[28:29], v[84:85]
  v_pk_mul_f32 v[30:31], v[30:31], v[86:87]
  v_cvt_pk_bf16_f32 v164, v24, v25
  v_cvt_pk_bf16_f32 v165, v26, v27
  v_cvt_pk_bf16_f32 v166, v28, v29
  v_cvt_pk_bf16_f32 v167, v30, v31
  s_nop 0
  v_permlane16_swap_b32 v164, v166
  v_permlane16_swap_b32 v165, v167
  buffer_store_dwordx4 v[164:167], v152, s[20:23], s44 offen offset:0 sc0 sc1
  v_pk_mul_f32 v[40:41], v[88:89], v[88:89]
  v_pk_mul_f32 v[42:43], v[90:91], v[90:91]
  v_pk_mul_f32 v[44:45], v[92:93], v[92:93]
  v_pk_mul_f32 v[46:47], v[94:95], v[94:95]
  v_pk_fma_f32 v[40:41], v[40:41], v[16:17], v[16:17] op_sel:[0,1,0] op_sel_hi:[1,1,0]
  v_pk_fma_f32 v[42:43], v[42:43], v[16:17], v[16:17] op_sel:[0,1,0] op_sel_hi:[1,1,0]
  v_pk_fma_f32 v[44:45], v[44:45], v[16:17], v[16:17] op_sel:[0,1,0] op_sel_hi:[1,1,0]
  v_pk_fma_f32 v[46:47], v[46:47], v[16:17], v[16:17] op_sel:[0,1,0] op_sel_hi:[1,1,0]
  v_pk_mul_f32 v[40:41], v[40:41], v[88:89]
  v_pk_mul_f32 v[42:43], v[42:43], v[90:91]
  v_pk_mul_f32 v[44:45], v[44:45], v[92:93]
  v_pk_mul_f32 v[46:47], v[46:47], v[94:95]
  v_exp_f32 v40, v40
  v_exp_f32 v41, v41
  v_exp_f32 v42, v42
  v_exp_f32 v43, v43
  v_exp_f32 v44, v44
  v_exp_f32 v45, v45
  v_exp_f32 v46, v46
  v_exp_f32 v47, v47
  v_pk_add_f32 v[40:41], v[40:41], 1.0 op_sel_hi:[1,0]
  v_pk_add_f32 v[42:43], v[42:43], 1.0 op_sel_hi:[1,0]
  v_pk_add_f32 v[44:45], v[44:45], 1.0 op_sel_hi:[1,0]
  v_pk_add_f32 v[46:47], v[46:47], 1.0 op_sel_hi:[1,0]
  v_rcp_f32 v40, v40
  v_rcp_f32 v41, v41
  v_rcp_f32 v42, v42
  v_rcp_f32 v43, v43
  v_rcp_f32 v44, v44
  v_rcp_f32 v45, v45
  v_rcp_f32 v46, v46
  v_rcp_f32 v47, v47
  v_pk_mul_f32 v[40:41], v[40:41], v[88:89]
  v_pk_mul_f32 v[42:43], v[42:43], v[90:91]
  v_pk_mul_f32 v[44:45], v[44:45], v[92:93]
  v_pk_mul_f32 v[46:47], v[46:47], v[94:95]
  v_cvt_pk_bf16_f32 v168, v40, v41
  v_cvt_pk_bf16_f32 v169, v42, v43
  v_cvt_pk_bf16_f32 v170, v44, v45
  v_cvt_pk_bf16_f32 v171, v46, v47
  s_nop 0
  v_permlane16_swap_b32 v168, v170
  v_permlane16_swap_b32 v169, v171
  buffer_store_dwordx4 v[168:171], v152, s[20:23], s44 offen offset:2048 sc0 sc1
  v_pk_mul_f32 v[24:25], v[96:97], v[96:97]
  v_pk_mul_f32 v[26:27], v[98:99], v[98:99]
  v_pk_mul_f32 v[28:29], v[100:101], v[100:101]
  v_pk_mul_f32 v[30:31], v[102:103], v[102:103]
  v_pk_fma_f32 v[24:25], v[24:25], v[16:17], v[16:17] op_sel:[0,1,0] op_sel_hi:[1,1,0]
  v_pk_fma_f32 v[26:27], v[26:27], v[16:17], v[16:17] op_sel:[0,1,0] op_sel_hi:[1,1,0]
  v_pk_fma_f32 v[28:29], v[28:29], v[16:17], v[16:17] op_sel:[0,1,0] op_sel_hi:[1,1,0]
  v_pk_fma_f32 v[30:31], v[30:31], v[16:17], v[16:17] op_sel:[0,1,0] op_sel_hi:[1,1,0]
  v_pk_mul_f32 v[24:25], v[24:25], v[96:97]
  v_pk_mul_f32 v[26:27], v[26:27], v[98:99]
  v_pk_mul_f32 v[28:29], v[28:29], v[100:101]
  v_pk_mul_f32 v[30:31], v[30:31], v[102:103]
  v_exp_f32 v24, v24
  v_exp_f32 v25, v25
  v_exp_f32 v26, v26
  v_exp_f32 v27, v27
  v_exp_f32 v28, v28
  v_exp_f32 v29, v29
  v_exp_f32 v30, v30
  v_exp_f32 v31, v31
  v_pk_add_f32 v[24:25], v[24:25], 1.0 op_sel_hi:[1,0]
  v_pk_add_f32 v[26:27], v[26:27], 1.0 op_sel_hi:[1,0]
  v_pk_add_f32 v[28:29], v[28:29], 1.0 op_sel_hi:[1,0]
  v_pk_add_f32 v[30:31], v[30:31], 1.0 op_sel_hi:[1,0]
  v_rcp_f32 v24, v24
  v_rcp_f32 v25, v25
  v_rcp_f32 v26, v26
  v_rcp_f32 v27, v27
  v_rcp_f32 v28, v28
  v_rcp_f32 v29, v29
  v_rcp_f32 v30, v30
  v_rcp_f32 v31, v31
  v_pk_mul_f32 v[24:25], v[24:25], v[96:97]
  v_pk_mul_f32 v[26:27], v[26:27], v[98:99]
  v_pk_mul_f32 v[28:29], v[28:29], v[100:101]
  v_pk_mul_f32 v[30:31], v[30:31], v[102:103]
  v_cvt_pk_bf16_f32 v172, v24, v25
  v_cvt_pk_bf16_f32 v173, v26, v27
  v_cvt_pk_bf16_f32 v174, v28, v29
  v_cvt_pk_bf16_f32 v175, v30, v31
  s_nop 0
  v_permlane16_swap_b32 v172, v174
  v_permlane16_swap_b32 v173, v175
  buffer_store_dwordx4 v[172:175], v153, s[20:23], s44 offen offset:0 sc0 sc1
  v_pk_mul_f32 v[40:41], v[104:105], v[104:105]
  v_pk_mul_f32 v[42:43], v[106:107], v[106:107]
  v_pk_mul_f32 v[44:45], v[108:109], v[108:109]
  v_pk_mul_f32 v[46:47], v[110:111], v[110:111]
  v_pk_fma_f32 v[40:41], v[40:41], v[16:17], v[16:17] op_sel:[0,1,0] op_sel_hi:[1,1,0]
  v_pk_fma_f32 v[42:43], v[42:43], v[16:17], v[16:17] op_sel:[0,1,0] op_sel_hi:[1,1,0]
  v_pk_fma_f32 v[44:45], v[44:45], v[16:17], v[16:17] op_sel:[0,1,0] op_sel_hi:[1,1,0]
  v_pk_fma_f32 v[46:47], v[46:47], v[16:17], v[16:17] op_sel:[0,1,0] op_sel_hi:[1,1,0]
  v_pk_mul_f32 v[40:41], v[40:41], v[104:105]
  v_pk_mul_f32 v[42:43], v[42:43], v[106:107]
  v_pk_mul_f32 v[44:45], v[44:45], v[108:109]
  v_pk_mul_f32 v[46:47], v[46:47], v[110:111]
  v_exp_f32 v40, v40
  v_exp_f32 v41, v41
  v_exp_f32 v42, v42
  v_exp_f32 v43, v43
  v_exp_f32 v44, v44
  v_exp_f32 v45, v45
  v_exp_f32 v46, v46
  v_exp_f32 v47, v47
  v_pk_add_f32 v[40:41], v[40:41], 1.0 op_sel_hi:[1,0]
  v_pk_add_f32 v[42:43], v[42:43], 1.0 op_sel_hi:[1,0]
  v_pk_add_f32 v[44:45], v[44:45], 1.0 op_sel_hi:[1,0]
  v_pk_add_f32 v[46:47], v[46:47], 1.0 op_sel_hi:[1,0]
  v_rcp_f32 v40, v40
  v_rcp_f32 v41, v41
  v_rcp_f32 v42, v42
  v_rcp_f32 v43, v43
  v_rcp_f32 v44, v44
  v_rcp_f32 v45, v45
  v_rcp_f32 v46, v46
  v_rcp_f32 v47, v47
  v_pk_mul_f32 v[40:41], v[40:41], v[104:105]
  v_pk_mul_f32 v[42:43], v[42:43], v[106:107]
  v_pk_mul_f32 v[44:45], v[44:45], v[108:109]
  v_pk_mul_f32 v[46:47], v[46:47], v[110:111]
  v_cvt_pk_bf16_f32 v176, v40, v41
  v_cvt_pk_bf16_f32 v177, v42, v43
  v_cvt_pk_bf16_f32 v178, v44, v45
  v_cvt_pk_bf16_f32 v179, v46, v47
  s_nop 0
  v_permlane16_swap_b32 v176, v178
  v_permlane16_swap_b32 v177, v179
  buffer_store_dwordx4 v[176:179], v153, s[20:23], s44 offen offset:2048 sc0 sc1
  v_pk_mul_f32 v[24:25], v[112:113], v[112:113]
  v_pk_mul_f32 v[26:27], v[114:115], v[114:115]
  v_pk_mul_f32 v[28:29], v[116:117], v[116:117]
  v_pk_mul_f32 v[30:31], v[118:119], v[118:119]
  v_pk_fma_f32 v[24:25], v[24:25], v[16:17], v[16:17] op_sel:[0,1,0] op_sel_hi:[1,1,0]
  v_pk_fma_f32 v[26:27], v[26:27], v[16:17], v[16:17] op_sel:[0,1,0] op_sel_hi:[1,1,0]
  v_pk_fma_f32 v[28:29], v[28:29], v[16:17], v[16:17] op_sel:[0,1,0] op_sel_hi:[1,1,0]
  v_pk_fma_f32 v[30:31], v[30:31], v[16:17], v[16:17] op_sel:[0,1,0] op_sel_hi:[1,1,0]
  v_pk_mul_f32 v[24:25], v[24:25], v[112:113]
  v_pk_mul_f32 v[26:27], v[26:27], v[114:115]
  v_pk_mul_f32 v[28:29], v[28:29], v[116:117]
  v_pk_mul_f32 v[30:31], v[30:31], v[118:119]
  v_exp_f32 v24, v24
  v_exp_f32 v25, v25
  v_exp_f32 v26, v26
  v_exp_f32 v27, v27
  v_exp_f32 v28, v28
  v_exp_f32 v29, v29
  v_exp_f32 v30, v30
  v_exp_f32 v31, v31
  v_pk_add_f32 v[24:25], v[24:25], 1.0 op_sel_hi:[1,0]
  v_pk_add_f32 v[26:27], v[26:27], 1.0 op_sel_hi:[1,0]
  v_pk_add_f32 v[28:29], v[28:29], 1.0 op_sel_hi:[1,0]
  v_pk_add_f32 v[30:31], v[30:31], 1.0 op_sel_hi:[1,0]
  v_rcp_f32 v24, v24
  v_rcp_f32 v25, v25
  v_rcp_f32 v26, v26
  v_rcp_f32 v27, v27
  v_rcp_f32 v28, v28
  v_rcp_f32 v29, v29
  v_rcp_f32 v30, v30
  v_rcp_f32 v31, v31
  v_pk_mul_f32 v[24:25], v[24:25], v[112:113]
  v_pk_mul_f32 v[26:27], v[26:27], v[114:115]
  v_pk_mul_f32 v[28:29], v[28:29], v[116:117]
  v_pk_mul_f32 v[30:31], v[30:31], v[118:119]
  v_cvt_pk_bf16_f32 v180, v24, v25
  v_cvt_pk_bf16_f32 v181, v26, v27
  v_cvt_pk_bf16_f32 v182, v28, v29
  v_cvt_pk_bf16_f32 v183, v30, v31
  s_nop 0
  v_permlane16_swap_b32 v180, v182
  v_permlane16_swap_b32 v181, v183
  buffer_store_dwordx4 v[180:183], v152, s[20:23], s45 offen offset:0 sc0 sc1
  v_pk_mul_f32 v[40:41], v[120:121], v[120:121]
  v_pk_mul_f32 v[42:43], v[122:123], v[122:123]
  v_pk_mul_f32 v[44:45], v[124:125], v[124:125]
  v_pk_mul_f32 v[46:47], v[126:127], v[126:127]
  v_pk_fma_f32 v[40:41], v[40:41], v[16:17], v[16:17] op_sel:[0,1,0] op_sel_hi:[1,1,0]
  v_pk_fma_f32 v[42:43], v[42:43], v[16:17], v[16:17] op_sel:[0,1,0] op_sel_hi:[1,1,0]
  v_pk_fma_f32 v[44:45], v[44:45], v[16:17], v[16:17] op_sel:[0,1,0] op_sel_hi:[1,1,0]
  v_pk_fma_f32 v[46:47], v[46:47], v[16:17], v[16:17] op_sel:[0,1,0] op_sel_hi:[1,1,0]
  v_pk_mul_f32 v[40:41], v[40:41], v[120:121]
  v_pk_mul_f32 v[42:43], v[42:43], v[122:123]
  v_pk_mul_f32 v[44:45], v[44:45], v[124:125]
  v_pk_mul_f32 v[46:47], v[46:47], v[126:127]
  v_exp_f32 v40, v40
  v_exp_f32 v41, v41
  v_exp_f32 v42, v42
  v_exp_f32 v43, v43
  v_exp_f32 v44, v44
  v_exp_f32 v45, v45
  v_exp_f32 v46, v46
  v_exp_f32 v47, v47
  v_pk_add_f32 v[40:41], v[40:41], 1.0 op_sel_hi:[1,0]
  v_pk_add_f32 v[42:43], v[42:43], 1.0 op_sel_hi:[1,0]
  v_pk_add_f32 v[44:45], v[44:45], 1.0 op_sel_hi:[1,0]
  v_pk_add_f32 v[46:47], v[46:47], 1.0 op_sel_hi:[1,0]
  v_rcp_f32 v40, v40
  v_rcp_f32 v41, v41
  v_rcp_f32 v42, v42
  v_rcp_f32 v43, v43
  v_rcp_f32 v44, v44
  v_rcp_f32 v45, v45
  v_rcp_f32 v46, v46
  v_rcp_f32 v47, v47
  v_pk_mul_f32 v[40:41], v[40:41], v[120:121]
  v_pk_mul_f32 v[42:43], v[42:43], v[122:123]
  v_pk_mul_f32 v[44:45], v[44:45], v[124:125]
  v_pk_mul_f32 v[46:47], v[46:47], v[126:127]
  v_cvt_pk_bf16_f32 v184, v40, v41
  v_cvt_pk_bf16_f32 v185, v42, v43
  v_cvt_pk_bf16_f32 v186, v44, v45
  v_cvt_pk_bf16_f32 v187, v46, v47
  s_nop 0
  v_permlane16_swap_b32 v184, v186
  v_permlane16_swap_b32 v185, v187
  buffer_store_dwordx4 v[184:187], v152, s[20:23], s45 offen offset:2048 sc0 sc1
  v_pk_mul_f32 v[24:25], v[128:129], v[128:129]
  v_pk_mul_f32 v[26:27], v[130:131], v[130:131]
  v_pk_mul_f32 v[28:29], v[132:133], v[132:133]
  v_pk_mul_f32 v[30:31], v[134:135], v[134:135]
  v_pk_fma_f32 v[24:25], v[24:25], v[16:17], v[16:17] op_sel:[0,1,0] op_sel_hi:[1,1,0]
  v_pk_fma_f32 v[26:27], v[26:27], v[16:17], v[16:17] op_sel:[0,1,0] op_sel_hi:[1,1,0]
  v_pk_fma_f32 v[28:29], v[28:29], v[16:17], v[16:17] op_sel:[0,1,0] op_sel_hi:[1,1,0]
  v_pk_fma_f32 v[30:31], v[30:31], v[16:17], v[16:17] op_sel:[0,1,0] op_sel_hi:[1,1,0]
  v_pk_mul_f32 v[24:25], v[24:25], v[128:129]
  v_pk_mul_f32 v[26:27], v[26:27], v[130:131]
  v_pk_mul_f32 v[28:29], v[28:29], v[132:133]
  v_pk_mul_f32 v[30:31], v[30:31], v[134:135]
  v_exp_f32 v24, v24
  v_exp_f32 v25, v25
  v_exp_f32 v26, v26
  v_exp_f32 v27, v27
  v_exp_f32 v28, v28
  v_exp_f32 v29, v29
  v_exp_f32 v30, v30
  v_exp_f32 v31, v31
  v_pk_add_f32 v[24:25], v[24:25], 1.0 op_sel_hi:[1,0]
  v_pk_add_f32 v[26:27], v[26:27], 1.0 op_sel_hi:[1,0]
  v_pk_add_f32 v[28:29], v[28:29], 1.0 op_sel_hi:[1,0]
  v_pk_add_f32 v[30:31], v[30:31], 1.0 op_sel_hi:[1,0]
  v_rcp_f32 v24, v24
  v_rcp_f32 v25, v25
  v_rcp_f32 v26, v26
  v_rcp_f32 v27, v27
  v_rcp_f32 v28, v28
  v_rcp_f32 v29, v29
  v_rcp_f32 v30, v30
  v_rcp_f32 v31, v31
  v_pk_mul_f32 v[24:25], v[24:25], v[128:129]
  v_pk_mul_f32 v[26:27], v[26:27], v[130:131]
  v_pk_mul_f32 v[28:29], v[28:29], v[132:133]
  v_pk_mul_f32 v[30:31], v[30:31], v[134:135]
  v_cvt_pk_bf16_f32 v188, v24, v25
  v_cvt_pk_bf16_f32 v189, v26, v27
  v_cvt_pk_bf16_f32 v190, v28, v29
  v_cvt_pk_bf16_f32 v191, v30, v31
  s_nop 0
  v_permlane16_swap_b32 v188, v190
  v_permlane16_swap_b32 v189, v191
  buffer_store_dwordx4 v[188:191], v153, s[20:23], s45 offen offset:0 sc0 sc1
  v_pk_mul_f32 v[40:41], v[136:137], v[136:137]
  v_pk_mul_f32 v[42:43], v[138:139], v[138:139]
  v_pk_mul_f32 v[44:45], v[140:141], v[140:141]
  v_pk_mul_f32 v[46:47], v[142:143], v[142:143]
  v_pk_fma_f32 v[40:41], v[40:41], v[16:17], v[16:17] op_sel:[0,1,0] op_sel_hi:[1,1,0]
  v_pk_fma_f32 v[42:43], v[42:43], v[16:17], v[16:17] op_sel:[0,1,0] op_sel_hi:[1,1,0]
  v_pk_fma_f32 v[44:45], v[44:45], v[16:17], v[16:17] op_sel:[0,1,0] op_sel_hi:[1,1,0]
  v_pk_fma_f32 v[46:47], v[46:47], v[16:17], v[16:17] op_sel:[0,1,0] op_sel_hi:[1,1,0]
  v_pk_mul_f32 v[40:41], v[40:41], v[136:137]
  v_pk_mul_f32 v[42:43], v[42:43], v[138:139]
  v_pk_mul_f32 v[44:45], v[44:45], v[140:141]
  v_pk_mul_f32 v[46:47], v[46:47], v[142:143]
  v_exp_f32 v40, v40
  v_exp_f32 v41, v41
  v_exp_f32 v42, v42
  v_exp_f32 v43, v43
  v_exp_f32 v44, v44
  v_exp_f32 v45, v45
  v_exp_f32 v46, v46
  v_exp_f32 v47, v47
  v_pk_add_f32 v[40:41], v[40:41], 1.0 op_sel_hi:[1,0]
  v_pk_add_f32 v[42:43], v[42:43], 1.0 op_sel_hi:[1,0]
  v_pk_add_f32 v[44:45], v[44:45], 1.0 op_sel_hi:[1,0]
  v_pk_add_f32 v[46:47], v[46:47], 1.0 op_sel_hi:[1,0]
  v_rcp_f32 v40, v40
  v_rcp_f32 v41, v41
  v_rcp_f32 v42, v42
  v_rcp_f32 v43, v43
  v_rcp_f32 v44, v44
  v_rcp_f32 v45, v45
  v_rcp_f32 v46, v46
  v_rcp_f32 v47, v47
  v_pk_mul_f32 v[40:41], v[40:41], v[136:137]
  v_pk_mul_f32 v[42:43], v[42:43], v[138:139]
  v_pk_mul_f32 v[44:45], v[44:45], v[140:141]
  v_pk_mul_f32 v[46:47], v[46:47], v[142:143]
  v_cvt_pk_bf16_f32 v192, v40, v41
  v_cvt_pk_bf16_f32 v193, v42, v43
  v_cvt_pk_bf16_f32 v194, v44, v45
  v_cvt_pk_bf16_f32 v195, v46, v47
  s_nop 0
  v_permlane16_swap_b32 v192, v194
  v_permlane16_swap_b32 v193, v195
  buffer_store_dwordx4 v[192:195], v153, s[20:23], s45 offen offset:2048 sc0 sc1
C_k3skip:
  s_nop 7
  s_nop 7
  s_lshr_b32 s32, s2, 3
  s_lshr_b32 s5, s32, 3
  s_and_b32 s6, s32, 7
  s_lshl_b32 s7, s5, 1
  s_add_u32 s7, s7, s6
  s_and_b32 s7, s7, 7
  s_and_b32 s32, s2, 7
  s_lshr_b32 s28, s32, 2
  s_lshl_b32 s28, s28, 2
  s_add_u32 s28, s28, s5
  s_and_b32 s29, s32, 3
  s_mul_i32 s29, s29, 8
  s_add_u32 s29, s29, s6
  s_mov_b32 s30, 7
  s_mov_b32 s31, -1
  s_lshl_b32 s32, s29, 6
  v_add_u32 v13, s32, v4
  v_lshlrev_b32 v12, 11, v13
  v_lshl_add_u32 v12, v5, 4, v12
  s_lshl_b32 s32, s28, 8
  s_lshl_b32 s40, s4, 6
  s_add_u32 s32, s32, s40
  v_add_u32 v12, s32, v12
  v_lshlrev_b32 v13, 1, v13
  v_lshlrev_b32 v14, 4, v0
  s_lshl_b32 s34, s28, 2
  s_add_u32 s34, s34, s4
  s_mul_i32 s34, s34, 229376
  s_mov_b32 s45, 32768
  s_mov_b32 s46, 65536
  s_mov_b32 s47, 98304
  s_add_u32 s8, s82, 12582912
  s_addc_u32 s9, s83, 0
  s_mov_b32 s10, 7340032
  s_mov_b32 s11, 0x20000
  s_add_u32 s16, s82, 4194304
  s_addc_u32 s17, s83, 0
  s_mov_b32 s18, 4194304
  s_mov_b32 s19, 0x20000
  s_mov_b32 s12, s78
  s_mov_b32 s13, s79
  s_mov_b32 s14, 4096
  s_mov_b32 s15, 0x20000
  buffer_load_ushort v112, v13, s[12:15], 0 offen offset:0
  buffer_load_ushort v114, v13, s[12:15], 0 offen offset:32
  buffer_load_ushort v116, v13, s[12:15], 0 offen offset:64
  buffer_load_ushort v118, v13, s[12:15], 0 offen offset:96
  v_lshl_add_u32 v16, v5, 3, v6
  v_lshlrev_b32 v16, 7, v16
  v_lshl_add_u32 v16, v7, 3, v16
  v_lshrrev_b32 v17, 1, v6
  v_lshl_or_b32 v17, v2, 1, v17
  v_lshl_add_u32 v16, v17, 5, v16
  v_add_u32 v16, 98304, v16
  v_xor_b32 v8, 0, v16
  v_xor_b32 v9, 32, v16
  v_xor_b32 v10, 64, v16
  v_xor_b32 v11, 96, v16
  s_lshl_b32 s48, 0x303, s7
  s_lshr_b32 s48, s48, 8
  s_mov_b32 s49, s34
  s_add_u32 s50, s34, 32768
  s_add_u32 s41, s34, 229376
  v_lshlrev_b32 v184, 3, v0
  s_lshl_b32 s32, s4, 9
  s_add_u32 s32, s32, 90112
  v_add_u32 v185, s32, v184
  s_add_u32 s24, s84, 29360128
  s_addc_u32 s25, s85, 0
  s_mov_b32 s26, 262144
  s_mov_b32 s27, 0x20000
  s_lshl_b32 s32, s28, 5
  v_min_u32 v15, 27, v0
  v_add_u32 v15, s32, v15
  v_max_i32 v15, 0, v15
  v_lshlrev_b32 v15, 7, v15
  s_lshl_b32 s55, s3, 17
  s_add_u32 s55, s55, 65536
  s_waitcnt vmcnt(0)
  s_barrier
  s_cmp_lt_u32 s2, 224
  s_cbranch_scc1 C_nopf
  s_cmp_lg_u32 s3, 0
  s_cbranch_scc1 C_nopf
  s_mov_b32 s20, s76
  s_mov_b32 s21, s77
  s_mov_b32 s22, 14680064
  s_mov_b32 s23, 0x20000
  s_sub_u32 s32, s2, 224
  s_lshl_b32 s32, s32, 2
  s_add_u32 s32, s32, s4
  s_lshl_b32 s32, s32, 13
  v_lshlrev_b32 v17, 7, v0
  s_sleep 127
  buffer_load_dword v18, v17, s[20:23], s32 offen
  s_add_u32 s32, s32, 1048576
  buffer_load_dword v18, v17, s[20:23], s32 offen
  s_add_u32 s32, s32, 1048576
  s_waitcnt vmcnt(1)
  buffer_load_dword v18, v17, s[20:23], s32 offen
  s_add_u32 s32, s32, 1048576
  s_waitcnt vmcnt(1)
  buffer_load_dword v18, v17, s[20:23], s32 offen
  s_add_u32 s32, s32, 1048576
  s_waitcnt vmcnt(1)
  buffer_load_dword v18, v17, s[20:23], s32 offen
  s_add_u32 s32, s32, 1048576
  s_waitcnt vmcnt(1)
  buffer_load_dword v18, v17, s[20:23], s32 offen
  s_add_u32 s32, s32, 1048576
  s_waitcnt vmcnt(1)
  buffer_load_dword v18, v17, s[20:23], s32 offen
  s_add_u32 s32, s32, 1048576
  s_waitcnt vmcnt(1)
  buffer_load_dword v18, v17, s[20:23], s32 offen
  s_add_u32 s32, s32, 1048576
  s_waitcnt vmcnt(1)
  buffer_load_dword v18, v17, s[20:23], s32 offen
  s_add_u32 s32, s32, 1048576
  s_waitcnt vmcnt(1)
  buffer_load_dword v18, v17, s[20:23], s32 offen
  s_add_u32 s32, s32, 1048576
  s_waitcnt vmcnt(1)
  buffer_load_dword v18, v17, s[20:23], s32 offen
  s_add_u32 s32, s32, 1048576
  s_waitcnt vmcnt(1)
  buffer_load_dword v18, v17, s[20:23], s32 offen
  s_add_u32 s32, s32, 1048576
  s_waitcnt vmcnt(1)
  buffer_load_dword v18, v17, s[20:23], s32 offen
  s_add_u32 s32, s32, 1048576
  s_waitcnt vmcnt(1)
  buffer_load_dword v18, v17, s[20:23], s32 offen
  s_add_u32 s32, s32, 1048576
  s_waitcnt vmcnt(1)
C_nopf:
  s_mov_b32 s39, 0
  s_and_b32 s32, s4, 3
  s_cmp_lg_u32 s32, 0
  s_cbranch_scc1 poll5d
  s_sleep 8
poll5:
  buffer_load_dword v16, v15, s[24:27], s55 offen sc0 sc1
  s_waitcnt vmcnt(0)
  v_cmp_eq_u32 vcc, 0, v16
  s_add_u32 s39, s39, 1
  s_cmp_gt_u32 s39, 1000000
  s_cbranch_scc1 poll5d
  s_cbranch_vccnz poll5
poll5d:
  s_barrier
  buffer_load_dwordx4 v[96:99], v12, s[16:19], 0 offen sc1
  buffer_load_dwordx4 v[100:103], v12, s[16:19], s45 offen sc1
  buffer_load_dwordx4 v[104:107], v12, s[16:19], s46 offen sc1
  buffer_load_dwordx4 v[108:111], v12, s[16:19], s47 offen sc1
  s_cmp_eq_u32 s3, 0
  s_cselect_b32 s24, s84, s80
  s_cselect_b32 s25, s85, s81
  s_cselect_b32 s26, 25165824, 0
  s_add_u32 s24, s24, s26
  s_addc_u32 s25, s25, 0
  s_mov_b32 s26, 4194304
  s_mov_b32 s27, 0x20000
  s_add_u32 s12, s84, 55574528
  s_addc_u32 s13, s85, 0
  s_mov_b32 s14, 131072
  s_mov_b32 s15, 0x20000
  s_bitcmp1_b32 s48, 0
  s_cselect_b32 s36, s50, s49
  s_add_u32 s36, s36, 0
  buffer_load_dwordx4 v[120:123], v14, s[8:11], s36 offen offset:0 sc1
  buffer_load_dwordx4 v[124:127], v14, s[8:11], s36 offen offset:1024 sc1
  buffer_load_dwordx4 v[128:131], v14, s[8:11], s36 offen offset:2048 sc1
  buffer_load_dwordx4 v[132:135], v14, s[8:11], s36 offen offset:3072 sc1
  s_bitcmp1_b32 s48, 1
  s_cselect_b32 s36, s50, s49
  s_add_u32 s36, s36, 4096
  buffer_load_dwordx4 v[136:139], v14, s[8:11], s36 offen offset:0 sc1
  buffer_load_dwordx4 v[140:143], v14, s[8:11], s36 offen offset:1024 sc1
  buffer_load_dwordx4 v[144:147], v14, s[8:11], s36 offen offset:2048 sc1
  buffer_load_dwordx4 v[148:151], v14, s[8:11], s36 offen offset:3072 sc1
  s_bitcmp1_b32 s48, 2
  s_cselect_b32 s36, s50, s49
  s_add_u32 s36, s36, 8192
  buffer_load_dwordx4 v[152:155], v14, s[8:11], s36 offen offset:0 sc1
  buffer_load_dwordx4 v[156:159], v14, s[8:11], s36 offen offset:1024 sc1
  buffer_load_dwordx4 v[160:163], v14, s[8:11], s36 offen offset:2048 sc1
  buffer_load_dwordx4 v[164:167], v14, s[8:11], s36 offen offset:3072 sc1
  s_bitcmp1_b32 s48, 3
  s_cselect_b32 s36, s50, s49
  s_add_u32 s36, s36, 12288
  buffer_load_dwordx4 v[168:171], v14, s[8:11], s36 offen offset:0 sc1
  buffer_load_dwordx4 v[172:175], v14, s[8:11], s36 offen offset:1024 sc1
  s_waitcnt vmcnt(14)
  v_lshlrev_b32 v112, 16, v112
  v_lshlrev_b32 v48, 16, v96
  v_and_b32 v49, 0xffff0000, v96
  v_lshlrev_b32 v50, 16, v97
  v_and_b32 v51, 0xffff0000, v97
  v_lshlrev_b32 v52, 16, v98
  v_and_b32 v53, 0xffff0000, v98
  v_lshlrev_b32 v54, 16, v99
  v_and_b32 v55, 0xffff0000, v99
  v_pk_add_f32 v[48:49], v[48:49], v[112:113] op_sel_hi:[1,0]
  v_pk_add_f32 v[50:51], v[50:51], v[112:113] op_sel_hi:[1,0]
  v_pk_add_f32 v[52:53], v[52:53], v[112:113] op_sel_hi:[1,0]
  v_pk_add_f32 v[54:55], v[54:55], v[112:113] op_sel_hi:[1,0]
  v_lshlrev_b32 v114, 16, v114
  v_lshlrev_b32 v56, 16, v100
  v_and_b32 v57, 0xffff0000, v100
  v_lshlrev_b32 v58, 16, v101
  v_and_b32 v59, 0xffff0000, v101
  v_lshlrev_b32 v60, 16, v102
  v_and_b32 v61, 0xffff0000, v102
  v_lshlrev_b32 v62, 16, v103
  v_and_b32 v63, 0xffff0000, v103
  v_pk_add_f32 v[56:57], v[56:57], v[114:115] op_sel_hi:[1,0]
  v_pk_add_f32 v[58:59], v[58:59], v[114:115] op_sel_hi:[1,0]
  v_pk_add_f32 v[60:61], v[60:61], v[114:115] op_sel_hi:[1,0]
  v_pk_add_f32 v[62:63], v[62:63], v[114:115] op_sel_hi:[1,0]
  v_lshlrev_b32 v116, 16, v116
  v_lshlrev_b32 v64, 16, v104
  v_and_b32 v65, 0xffff0000, v104
  v_lshlrev_b32 v66, 16, v105
  v_and_b32 v67, 0xffff0000, v105
  v_lshlrev_b32 v68, 16, v106
  v_and_b32 v69, 0xffff0000, v106
  v_lshlrev_b32 v70, 16, v107
  v_and_b32 v71, 0xffff0000, v107
  v_pk_add_f32 v[64:65], v[64:65], v[116:117] op_sel_hi:[1,0]
  v_pk_add_f32 v[66:67], v[66:67], v[116:117] op_sel_hi:[1,0]
  v_pk_add_f32 v[68:69], v[68:69], v[116:117] op_sel_hi:[1,0]
  v_pk_add_f32 v[70:71], v[70:71], v[116:117] op_sel_hi:[1,0]
  v_lshlrev_b32 v118, 16, v118
  v_lshlrev_b32 v72, 16, v108
  v_and_b32 v73, 0xffff0000, v108
  v_lshlrev_b32 v74, 16, v109
  v_and_b32 v75, 0xffff0000, v109
  v_lshlrev_b32 v76, 16, v110
  v_and_b32 v77, 0xffff0000, v110
  v_lshlrev_b32 v78, 16, v111
  v_and_b32 v79, 0xffff0000, v111
  v_pk_add_f32 v[72:73], v[72:73], v[118:119] op_sel_hi:[1,0]
  v_pk_add_f32 v[74:75], v[74:75], v[118:119] op_sel_hi:[1,0]
  v_pk_add_f32 v[76:77], v[76:77], v[118:119] op_sel_hi:[1,0]
  v_pk_add_f32 v[78:79], v[78:79], v[118:119] op_sel_hi:[1,0]
  s_mov_b32 s43, 0
  s_mov_b32 s39, 6
  s_barrier
  ds_read_b64_tr_b16 v[16:17], v8 offset:0
  ds_read_b64_tr_b16 v[18:19], v8 offset:512
  ds_read_b64_tr_b16 v[20:21], v9 offset:0
  ds_read_b64_tr_b16 v[22:23], v9 offset:512
  ds_read_b64_tr_b16 v[24:25], v10 offset:0
  ds_read_b64_tr_b16 v[26:27], v10 offset:512
  ds_read_b64_tr_b16 v[28:29], v11 offset:0
  ds_read_b64_tr_b16 v[30:31], v11 offset:512
  s_add_u32 s40, s43, 8192
  s_cmp_eq_u32 s40, 65536
  s_cselect_b32 s40, 0, s40
  s_sub_u32 s42, s40, s43
  s_mov_b32 s43, s40
cd6:
  s_waitcnt vmcnt(13) lgkmcnt(6)
  v_mfma_f32_16x16x32_bf16 v[48:51], v[120:123], v[16:19], v[48:51]
  ds_read_b64_tr_b16 v[32:33], v8 offset:4096
  s_waitcnt vmcnt(12)
  v_mfma_f32_16x16x32_bf16 v[52:55], v[124:127], v[16:19], v[52:55]
  ds_read_b64_tr_b16 v[34:35], v8 offset:4608
  v_add_u32 v8, s42, v8
  s_waitcnt lgkmcnt(6)
  v_mfma_f32_16x16x32_bf16 v[60:63], v[124:127], v[20:23], v[60:63]
  ds_read_b64_tr_b16 v[36:37], v9 offset:4096
  buffer_load_dwordx4 v[176:179], v14, s[8:11], s36 offen offset:2048 sc1
  v_mfma_f32_16x16x32_bf16 v[56:59], v[120:123], v[20:23], v[56:59]
  ds_read_b64_tr_b16 v[38:39], v9 offset:4608
  v_add_u32 v9, s42, v9
  s_waitcnt lgkmcnt(6)
  v_mfma_f32_16x16x32_bf16 v[64:67], v[120:123], v[24:27], v[64:67]
  ds_read_b64_tr_b16 v[40:41], v10 offset:4096
  v_mfma_f32_16x16x32_bf16 v[68:71], v[124:127], v[24:27], v[68:71]
  ds_read_b64_tr_b16 v[42:43], v10 offset:4608
  v_add_u32 v10, s42, v10
  s_waitcnt lgkmcnt(6)
  v_mfma_f32_16x16x32_bf16 v[76:79], v[124:127], v[28:31], v[76:79]
  ds_read_b64_tr_b16 v[44:45], v11 offset:4096
  buffer_load_dwordx4 v[180:183], v14, s[8:11], s36 offen offset:3072 sc1
  v_mfma_f32_16x16x32_bf16 v[72:75], v[120:123], v[28:31], v[72:75]
  ds_read_b64_tr_b16 v[46:47], v11 offset:4608
  v_add_u32 v11, s42, v11
  s_barrier
  s_waitcnt vmcnt(13) lgkmcnt(6)
  v_mfma_f32_16x16x32_bf16 v[48:51], v[128:131], v[32:35], v[48:51]
  ds_read_b64_tr_b16 v[16:17], v8 offset:0
  s_bitcmp1_b32 s48, 4
  s_cselect_b32 s36, s50, s49
  s_waitcnt vmcnt(12)
  v_mfma_f32_16x16x32_bf16 v[52:55], v[132:135], v[32:35], v[52:55]
  ds_read_b64_tr_b16 v[18:19], v8 offset:512
  s_add_u32 s36, s36, 16384
  s_add_u32 s40, s43, 8192
  s_waitcnt lgkmcnt(6)
  v_mfma_f32_16x16x32_bf16 v[60:63], v[132:135], v[36:39], v[60:63]
  ds_read_b64_tr_b16 v[20:21], v9 offset:0
  s_cmp_eq_u32 s40, 65536
  s_cselect_b32 s40, 0, s40
  v_mfma_f32_16x16x32_bf16 v[56:59], v[128:131], v[36:39], v[56:59]
  ds_read_b64_tr_b16 v[22:23], v9 offset:512
  s_sub_u32 s42, s40, s43
  s_mov_b32 s43, s40
  s_waitcnt lgkmcnt(6)
  v_mfma_f32_16x16x32_bf16 v[64:67], v[128:131], v[40:43], v[64:67]
  ds_read_b64_tr_b16 v[24:25], v10 offset:0
  buffer_load_dwordx4 v[120:123], v14, s[8:11], s36 offen offset:0 sc1
  v_mfma_f32_16x16x32_bf16 v[68:71], v[132:135], v[40:43], v[68:71]
  ds_read_b64_tr_b16 v[26:27], v10 offset:512
  s_waitcnt lgkmcnt(6)
  v_mfma_f32_16x16x32_bf16 v[76:79], v[132:135], v[44:47], v[76:79]
  ds_read_b64_tr_b16 v[28:29], v11 offset:0
  v_mfma_f32_16x16x32_bf16 v[72:75], v[128:131], v[44:47], v[72:75]
  ds_read_b64_tr_b16 v[30:31], v11 offset:512
  buffer_load_dwordx4 v[124:127], v14, s[8:11], s36 offen offset:1024 sc1
  s_waitcnt vmcnt(13) lgkmcnt(6)
  v_mfma_f32_16x16x32_bf16 v[48:51], v[136:139], v[16:19], v[48:51]
  ds_read_b64_tr_b16 v[32:33], v8 offset:4096
  s_waitcnt vmcnt(12)
  v_mfma_f32_16x16x32_bf16 v[52:55], v[140:143], v[16:19], v[52:55]
  ds_read_b64_tr_b16 v[34:35], v8 offset:4608
  v_add_u32 v8, s42, v8
  s_waitcnt lgkmcnt(6)
  v_mfma_f32_16x16x32_bf16 v[60:63], v[140:143], v[20:23], v[60:63]
  ds_read_b64_tr_b16 v[36:37], v9 offset:4096
  buffer_load_dwordx4 v[128:131], v14, s[8:11], s36 offen offset:2048 sc1
  v_mfma_f32_16x16x32_bf16 v[56:59], v[136:139], v[20:23], v[56:59]
  ds_read_b64_tr_b16 v[38:39], v9 offset:4608
  v_add_u32 v9, s42, v9
  s_waitcnt lgkmcnt(6)
  v_mfma_f32_16x16x32_bf16 v[64:67], v[136:139], v[24:27], v[64:67]
  ds_read_b64_tr_b16 v[40:41], v10 offset:4096
  v_mfma_f32_16x16x32_bf16 v[68:71], v[140:143], v[24:27], v[68:71]
  ds_read_b64_tr_b16 v[42:43], v10 offset:4608
  v_add_u32 v10, s42, v10
  s_waitcnt lgkmcnt(6)
  v_mfma_f32_16x16x32_bf16 v[76:79], v[140:143], v[28:31], v[76:79]
  ds_read_b64_tr_b16 v[44:45], v11 offset:4096
  buffer_load_dwordx4 v[132:135], v14, s[8:11], s36 offen offset:3072 sc1
  v_mfma_f32_16x16x32_bf16 v[72:75], v[136:139], v[28:31], v[72:75]
  ds_read_b64_tr_b16 v[46:47], v11 offset:4608
  v_add_u32 v11, s42, v11
  s_barrier
  s_waitcnt vmcnt(13) lgkmcnt(6)
  v_mfma_f32_16x16x32_bf16 v[48:51], v[144:147], v[32:35], v[48:51]
  ds_read_b64_tr_b16 v[16:17], v8 offset:0
  s_bitcmp1_b32 s48, 5
  s_cselect_b32 s36, s50, s49
  s_waitcnt vmcnt(12)
  v_mfma_f32_16x16x32_bf16 v[52:55], v[148:151], v[32:35], v[52:55]
  ds_read_b64_tr_b16 v[18:19], v8 offset:512
  s_add_u32 s36, s36, 20480
  s_add_u32 s40, s43, 8192
  s_waitcnt lgkmcnt(6)
  v_mfma_f32_16x16x32_bf16 v[60:63], v[148:151], v[36:39], v[60:63]
  ds_read_b64_tr_b16 v[20:21], v9 offset:0
  s_cmp_eq_u32 s40, 65536
  s_cselect_b32 s40, 0, s40
  v_mfma_f32_16x16x32_bf16 v[56:59], v[144:147], v[36:39], v[56:59]
  ds_read_b64_tr_b16 v[22:23], v9 offset:512
  s_sub_u32 s42, s40, s43
  s_mov_b32 s43, s40
  s_waitcnt lgkmcnt(6)
  v_mfma_f32_16x16x32_bf16 v[64:67], v[144:147], v[40:43], v[64:67]
  ds_read_b64_tr_b16 v[24:25], v10 offset:0
  buffer_load_dwordx4 v[136:139], v14, s[8:11], s36 offen offset:0 sc1
  v_mfma_f32_16x16x32_bf16 v[68:71], v[148:151], v[40:43], v[68:71]
  ds_read_b64_tr_b16 v[26:27], v10 offset:512
  s_waitcnt lgkmcnt(6)
  v_mfma_f32_16x16x32_bf16 v[76:79], v[148:151], v[44:47], v[76:79]
  ds_read_b64_tr_b16 v[28:29], v11 offset:0
  v_mfma_f32_16x16x32_bf16 v[72:75], v[144:147], v[44:47], v[72:75]
  ds_read_b64_tr_b16 v[30:31], v11 offset:512
  buffer_load_dwordx4 v[140:143], v14, s[8:11], s36 offen offset:1024 sc1
  s_waitcnt vmcnt(13) lgkmcnt(6)
  v_mfma_f32_16x16x32_bf16 v[48:51], v[152:155], v[16:19], v[48:51]
  ds_read_b64_tr_b16 v[32:33], v8 offset:4096
  s_waitcnt vmcnt(12)
  v_mfma_f32_16x16x32_bf16 v[52:55], v[156:159], v[16:19], v[52:55]
  ds_read_b64_tr_b16 v[34:35], v8 offset:4608
  v_add_u32 v8, s42, v8
  s_waitcnt lgkmcnt(6)
  v_mfma_f32_16x16x32_bf16 v[60:63], v[156:159], v[20:23], v[60:63]
  ds_read_b64_tr_b16 v[36:37], v9 offset:4096
  buffer_load_dwordx4 v[144:147], v14, s[8:11], s36 offen offset:2048 sc1
  v_mfma_f32_16x16x32_bf16 v[56:59], v[152:155], v[20:23], v[56:59]
  ds_read_b64_tr_b16 v[38:39], v9 offset:4608
  v_add_u32 v9, s42, v9
  s_waitcnt lgkmcnt(6)
  v_mfma_f32_16x16x32_bf16 v[64:67], v[152:155], v[24:27], v[64:67]
  ds_read_b64_tr_b16 v[40:41], v10 offset:4096
  v_mfma_f32_16x16x32_bf16 v[68:71], v[156:159], v[24:27], v[68:71]
  ds_read_b64_tr_b16 v[42:43], v10 offset:4608
  v_add_u32 v10, s42, v10
  s_waitcnt lgkmcnt(6)
  v_mfma_f32_16x16x32_bf16 v[76:79], v[156:159], v[28:31], v[76:79]
  ds_read_b64_tr_b16 v[44:45], v11 offset:4096
  buffer_load_dwordx4 v[148:151], v14, s[8:11], s36 offen offset:3072 sc1
  v_mfma_f32_16x16x32_bf16 v[72:75], v[152:155], v[28:31], v[72:75]
  ds_read_b64_tr_b16 v[46:47], v11 offset:4608
  v_add_u32 v11, s42, v11
  s_barrier
  s_waitcnt vmcnt(13) lgkmcnt(6)
  v_mfma_f32_16x16x32_bf16 v[48:51], v[160:163], v[32:35], v[48:51]
  ds_read_b64_tr_b16 v[16:17], v8 offset:0
  s_bitcmp1_b32 s48, 6
  s_cselect_b32 s36, s50, s49
  s_waitcnt vmcnt(12)
  v_mfma_f32_16x16x32_bf16 v[52:55], v[164:167], v[32:35], v[52:55]
  ds_read_b64_tr_b16 v[18:19], v8 offset:512
  s_add_u32 s36, s36, 24576
  s_add_u32 s40, s43, 8192
  s_waitcnt lgkmcnt(6)
  v_mfma_f32_16x16x32_bf16 v[60:63], v[164:167], v[36:39], v[60:63]
  ds_read_b64_tr_b16 v[20:21], v9 offset:0
  s_cmp_eq_u32 s40, 65536
  s_cselect_b32 s40, 0, s40
  v_mfma_f32_16x16x32_bf16 v[56:59], v[160:163], v[36:39], v[56:59]
  ds_read_b64_tr_b16 v[22:23], v9 offset:512
  s_sub_u32 s42, s40, s43
  s_mov_b32 s43, s40
  s_waitcnt lgkmcnt(6)
  v_mfma_f32_16x16x32_bf16 v[64:67], v[160:163], v[40:43], v[64:67]
  ds_read_b64_tr_b16 v[24:25], v10 offset:0
  buffer_load_dwordx4 v[152:155], v14, s[8:11], s36 offen offset:0 sc1
  v_mfma_f32_16x16x32_bf16 v[68:71], v[164:167], v[40:43], v[68:71]
  ds_read_b64_tr_b16 v[26:27], v10 offset:512
  s_waitcnt lgkmcnt(6)
  v_mfma_f32_16x16x32_bf16 v[76:79], v[164:167], v[44:47], v[76:79]
  ds_read_b64_tr_b16 v[28:29], v11 offset:0
  v_mfma_f32_16x16x32_bf16 v[72:75], v[160:163], v[44:47], v[72:75]
  ds_read_b64_tr_b16 v[30:31], v11 offset:512
  buffer_load_dwordx4 v[156:159], v14, s[8:11], s36 offen offset:1024 sc1
  s_waitcnt vmcnt(13) lgkmcnt(6)
  v_mfma_f32_16x16x32_bf16 v[48:51], v[168:171], v[16:19], v[48:51]
  ds_read_b64_tr_b16 v[32:33], v8 offset:4096
  s_waitcnt vmcnt(12)
  v_mfma_f32_16x16x32_bf16 v[52:55], v[172:175], v[16:19], v[52:55]
  ds_read_b64_tr_b16 v[34:35], v8 offset:4608
  v_add_u32 v8, s42, v8
  s_waitcnt lgkmcnt(6)
  v_mfma_f32_16x16x32_bf16 v[60:63], v[172:175], v[20:23], v[60:63]
  ds_read_b64_tr_b16 v[36:37], v9 offset:4096
  buffer_load_dwordx4 v[160:163], v14, s[8:11], s36 offen offset:2048 sc1
  v_mfma_f32_16x16x32_bf16 v[56:59], v[168:171], v[20:23], v[56:59]
  ds_read_b64_tr_b16 v[38:39], v9 offset:4608
  v_add_u32 v9, s42, v9
  s_waitcnt lgkmcnt(6)
  v_mfma_f32_16x16x32_bf16 v[64:67], v[168:171], v[24:27], v[64:67]
  ds_read_b64_tr_b16 v[40:41], v10 offset:4096
  v_mfma_f32_16x16x32_bf16 v[68:71], v[172:175], v[24:27], v[68:71]
  ds_read_b64_tr_b16 v[42:43], v10 offset:4608
  v_add_u32 v10, s42, v10
  s_waitcnt lgkmcnt(6)
  v_mfma_f32_16x16x32_bf16 v[76:79], v[172:175], v[28:31], v[76:79]
  ds_read_b64_tr_b16 v[44:45], v11 offset:4096
  buffer_load_dwordx4 v[164:167], v14, s[8:11], s36 offen offset:3072 sc1
  v_mfma_f32_16x16x32_bf16 v[72:75], v[168:171], v[28:31], v[72:75]
  ds_read_b64_tr_b16 v[46:47], v11 offset:4608
  v_add_u32 v11, s42, v11
  s_barrier
  s_waitcnt vmcnt(13) lgkmcnt(6)
  v_mfma_f32_16x16x32_bf16 v[48:51], v[176:179], v[32:35], v[48:51]
  ds_read_b64_tr_b16 v[16:17], v8 offset:0
  s_bitcmp1_b32 s48, 7
  s_cselect_b32 s36, s50, s49
  s_waitcnt vmcnt(12)
  v_mfma_f32_16x16x32_bf16 v[52:55], v[180:183], v[32:35], v[52:55]
  ds_read_b64_tr_b16 v[18:19], v8 offset:512
  s_add_u32 s36, s36, 28672
  s_add_u32 s40, s43, 8192
  s_waitcnt lgkmcnt(6)
  v_mfma_f32_16x16x32_bf16 v[60:63], v[180:183], v[36:39], v[60:63]
  ds_read_b64_tr_b16 v[20:21], v9 offset:0
  s_cmp_eq_u32 s40, 65536
  s_cselect_b32 s40, 0, s40
  v_mfma_f32_16x16x32_bf16 v[56:59], v[176:179], v[36:39], v[56:59]
  ds_read_b64_tr_b16 v[22:23], v9 offset:512
  s_sub_u32 s42, s40, s43
  s_mov_b32 s43, s40
  s_waitcnt lgkmcnt(6)
  v_mfma_f32_16x16x32_bf16 v[64:67], v[176:179], v[40:43], v[64:67]
  ds_read_b64_tr_b16 v[24:25], v10 offset:0
  buffer_load_dwordx4 v[168:171], v14, s[8:11], s36 offen offset:0 sc1
  v_mfma_f32_16x16x32_bf16 v[68:71], v[180:183], v[40:43], v[68:71]
  ds_read_b64_tr_b16 v[26:27], v10 offset:512
  s_waitcnt lgkmcnt(6)
  v_mfma_f32_16x16x32_bf16 v[76:79], v[180:183], v[44:47], v[76:79]
  ds_read_b64_tr_b16 v[28:29], v11 offset:0
  v_mfma_f32_16x16x32_bf16 v[72:75], v[176:179], v[44:47], v[72:75]
  ds_read_b64_tr_b16 v[30:31], v11 offset:512
  buffer_load_dwordx4 v[172:175], v14, s[8:11], s36 offen offset:1024 sc1
  s_waitcnt vmcnt(13) lgkmcnt(6)
  v_mfma_f32_16x16x32_bf16 v[48:51], v[120:123], v[16:19], v[48:51]
  ds_read_b64_tr_b16 v[32:33], v8 offset:4096
  s_waitcnt vmcnt(12)
  v_mfma_f32_16x16x32_bf16 v[52:55], v[124:127], v[16:19], v[52:55]
  ds_read_b64_tr_b16 v[34:35], v8 offset:4608
  v_add_u32 v8, s42, v8
  s_waitcnt lgkmcnt(6)
  v_mfma_f32_16x16x32_bf16 v[60:63], v[124:127], v[20:23], v[60:63]
  ds_read_b64_tr_b16 v[36:37], v9 offset:4096
  buffer_load_dwordx4 v[176:179], v14, s[8:11], s36 offen offset:2048 sc1
  v_mfma_f32_16x16x32_bf16 v[56:59], v[120:123], v[20:23], v[56:59]
  ds_read_b64_tr_b16 v[38:39], v9 offset:4608
  v_add_u32 v9, s42, v9
  s_waitcnt lgkmcnt(6)
  v_mfma_f32_16x16x32_bf16 v[64:67], v[120:123], v[24:27], v[64:67]
  ds_read_b64_tr_b16 v[40:41], v10 offset:4096
  v_mfma_f32_16x16x32_bf16 v[68:71], v[124:127], v[24:27], v[68:71]
  ds_read_b64_tr_b16 v[42:43], v10 offset:4608
  v_add_u32 v10, s42, v10
  s_waitcnt lgkmcnt(6)
  v_mfma_f32_16x16x32_bf16 v[76:79], v[124:127], v[28:31], v[76:79]
  ds_read_b64_tr_b16 v[44:45], v11 offset:4096
  buffer_load_dwordx4 v[180:183], v14, s[8:11], s36 offen offset:3072 sc1
  v_mfma_f32_16x16x32_bf16 v[72:75], v[120:123], v[28:31], v[72:75]
  ds_read_b64_tr_b16 v[46:47], v11 offset:4608
  v_add_u32 v11, s42, v11
  s_barrier
  s_waitcnt vmcnt(13) lgkmcnt(6)
  v_mfma_f32_16x16x32_bf16 v[48:51], v[128:131], v[32:35], v[48:51]
  ds_read_b64_tr_b16 v[16:17], v8 offset:0
  s_mov_b32 s49, s50
  s_add_u32 s50, s50, 32768
  s_waitcnt vmcnt(12)
  v_mfma_f32_16x16x32_bf16 v[52:55], v[132:135], v[32:35], v[52:55]
  ds_read_b64_tr_b16 v[18:19], v8 offset:512
  s_cmp_eq_u32 s50, s41
  s_cselect_b32 s50, s34, s50
  s_waitcnt lgkmcnt(6)
  v_mfma_f32_16x16x32_bf16 v[60:63], v[132:135], v[36:39], v[60:63]
  ds_read_b64_tr_b16 v[20:21], v9 offset:0
  s_bitcmp1_b32 s48, 0
  s_cselect_b32 s36, s50, s49
  v_mfma_f32_16x16x32_bf16 v[56:59], v[128:131], v[36:39], v[56:59]
  ds_read_b64_tr_b16 v[22:23], v9 offset:512
  s_add_u32 s36, s36, 0
  s_add_u32 s40, s43, 8192
  s_waitcnt lgkmcnt(6)
  v_mfma_f32_16x16x32_bf16 v[64:67], v[128:131], v[40:43], v[64:67]
  ds_read_b64_tr_b16 v[24:25], v10 offset:0
  s_cmp_eq_u32 s40, 65536
  s_cselect_b32 s40, 0, s40
  buffer_load_dwordx4 v[120:123], v14, s[8:11], s36 offen offset:0 sc1
  v_mfma_f32_16x16x32_bf16 v[68:71], v[132:135], v[40:43], v[68:71]
  ds_read_b64_tr_b16 v[26:27], v10 offset:512
  s_sub_u32 s42, s40, s43
  s_mov_b32 s43, s40
  s_waitcnt lgkmcnt(6)
  v_mfma_f32_16x16x32_bf16 v[76:79], v[132:135], v[44:47], v[76:79]
  ds_read_b64_tr_b16 v[28:29], v11 offset:0
  v_mfma_f32_16x16x32_bf16 v[72:75], v[128:131], v[44:47], v[72:75]
  ds_read_b64_tr_b16 v[30:31], v11 offset:512
  buffer_load_dwordx4 v[124:127], v14, s[8:11], s36 offen offset:1024 sc1
  s_waitcnt vmcnt(13) lgkmcnt(6)
  v_mfma_f32_16x16x32_bf16 v[48:51], v[136:139], v[16:19], v[48:51]
  ds_read_b64_tr_b16 v[32:33], v8 offset:4096
  s_waitcnt vmcnt(12)
  v_mfma_f32_16x16x32_bf16 v[52:55], v[140:143], v[16:19], v[52:55]
  ds_read_b64_tr_b16 v[34:35], v8 offset:4608
  v_add_u32 v8, s42, v8
  s_waitcnt lgkmcnt(6)
  v_mfma_f32_16x16x32_bf16 v[60:63], v[140:143], v[20:23], v[60:63]
  ds_read_b64_tr_b16 v[36:37], v9 offset:4096
  buffer_load_dwordx4 v[128:131], v14, s[8:11], s36 offen offset:2048 sc1
  v_mfma_f32_16x16x32_bf16 v[56:59], v[136:139], v[20:23], v[56:59]
  ds_read_b64_tr_b16 v[38:39], v9 offset:4608
  v_add_u32 v9, s42, v9
  s_waitcnt lgkmcnt(6)
  v_mfma_f32_16x16x32_bf16 v[64:67], v[136:139], v[24:27], v[64:67]
  ds_read_b64_tr_b16 v[40:41], v10 offset:4096
  v_mfma_f32_16x16x32_bf16 v[68:71], v[140:143], v[24:27], v[68:71]
  ds_read_b64_tr_b16 v[42:43], v10 offset:4608
  v_add_u32 v10, s42, v10
  s_waitcnt lgkmcnt(6)
  v_mfma_f32_16x16x32_bf16 v[76:79], v[140:143], v[28:31], v[76:79]
  ds_read_b64_tr_b16 v[44:45], v11 offset:4096
  buffer_load_dwordx4 v[132:135], v14, s[8:11], s36 offen offset:3072 sc1
  v_mfma_f32_16x16x32_bf16 v[72:75], v[136:139], v[28:31], v[72:75]
  ds_read_b64_tr_b16 v[46:47], v11 offset:4608
  v_add_u32 v11, s42, v11
  s_barrier
  s_waitcnt vmcnt(13) lgkmcnt(6)
  v_mfma_f32_16x16x32_bf16 v[48:51], v[144:147], v[32:35], v[48:51]
  ds_read_b64_tr_b16 v[16:17], v8 offset:0
  s_bitcmp1_b32 s48, 1
  s_cselect_b32 s36, s50, s49
  s_waitcnt vmcnt(12)
  v_mfma_f32_16x16x32_bf16 v[52:55], v[148:151], v[32:35], v[52:55]
  ds_read_b64_tr_b16 v[18:19], v8 offset:512
  s_add_u32 s36, s36, 4096
  s_add_u32 s40, s43, 8192
  s_waitcnt lgkmcnt(6)
  v_mfma_f32_16x16x32_bf16 v[60:63], v[148:151], v[36:39], v[60:63]
  ds_read_b64_tr_b16 v[20:21], v9 offset:0
  s_cmp_eq_u32 s40, 65536
  s_cselect_b32 s40, 0, s40
  v_mfma_f32_16x16x32_bf16 v[56:59], v[144:147], v[36:39], v[56:59]
  ds_read_b64_tr_b16 v[22:23], v9 offset:512
  s_sub_u32 s42, s40, s43
  s_mov_b32 s43, s40
  s_waitcnt lgkmcnt(6)
  v_mfma_f32_16x16x32_bf16 v[64:67], v[144:147], v[40:43], v[64:67]
  ds_read_b64_tr_b16 v[24:25], v10 offset:0
  buffer_load_dwordx4 v[136:139], v14, s[8:11], s36 offen offset:0 sc1
  v_mfma_f32_16x16x32_bf16 v[68:71], v[148:151], v[40:43], v[68:71]
  ds_read_b64_tr_b16 v[26:27], v10 offset:512
  s_waitcnt lgkmcnt(6)
  v_mfma_f32_16x16x32_bf16 v[76:79], v[148:151], v[44:47], v[76:79]
  ds_read_b64_tr_b16 v[28:29], v11 offset:0
  v_mfma_f32_16x16x32_bf16 v[72:75], v[144:147], v[44:47], v[72:75]
  ds_read_b64_tr_b16 v[30:31], v11 offset:512
  buffer_load_dwordx4 v[140:143], v14, s[8:11], s36 offen offset:1024 sc1
  s_waitcnt vmcnt(13) lgkmcnt(6)
  v_mfma_f32_16x16x32_bf16 v[48:51], v[152:155], v[16:19], v[48:51]
  ds_read_b64_tr_b16 v[32:33], v8 offset:4096
  s_waitcnt vmcnt(12)
  v_mfma_f32_16x16x32_bf16 v[52:55], v[156:159], v[16:19], v[52:55]
  ds_read_b64_tr_b16 v[34:35], v8 offset:4608
  v_add_u32 v8, s42, v8
  s_waitcnt lgkmcnt(6)
  v_mfma_f32_16x16x32_bf16 v[60:63], v[156:159], v[20:23], v[60:63]
  ds_read_b64_tr_b16 v[36:37], v9 offset:4096
  buffer_load_dwordx4 v[144:147], v14, s[8:11], s36 offen offset:2048 sc1
  v_mfma_f32_16x16x32_bf16 v[56:59], v[152:155], v[20:23], v[56:59]
  ds_read_b64_tr_b16 v[38:39], v9 offset:4608
  v_add_u32 v9, s42, v9
  s_waitcnt lgkmcnt(6)
  v_mfma_f32_16x16x32_bf16 v[64:67], v[152:155], v[24:27], v[64:67]
  ds_read_b64_tr_b16 v[40:41], v10 offset:4096
  v_mfma_f32_16x16x32_bf16 v[68:71], v[156:159], v[24:27], v[68:71]
  ds_read_b64_tr_b16 v[42:43], v10 offset:4608
  v_add_u32 v10, s42, v10
  s_waitcnt lgkmcnt(6)
  v_mfma_f32_16x16x32_bf16 v[76:79], v[156:159], v[28:31], v[76:79]
  ds_read_b64_tr_b16 v[44:45], v11 offset:4096
  buffer_load_dwordx4 v[148:151], v14, s[8:11], s36 offen offset:3072 sc1
  v_mfma_f32_16x16x32_bf16 v[72:75], v[152:155], v[28:31], v[72:75]
  ds_read_b64_tr_b16 v[46:47], v11 offset:4608
  v_add_u32 v11, s42, v11
  s_barrier
  s_waitcnt vmcnt(13) lgkmcnt(6)
  v_mfma_f32_16x16x32_bf16 v[48:51], v[160:163], v[32:35], v[48:51]
  ds_read_b64_tr_b16 v[16:17], v8 offset:0
  s_bitcmp1_b32 s48, 2
  s_cselect_b32 s36, s50, s49
  s_waitcnt vmcnt(12)
  v_mfma_f32_16x16x32_bf16 v[52:55], v[164:167], v[32:35], v[52:55]
  ds_read_b64_tr_b16 v[18:19], v8 offset:512
  s_add_u32 s36, s36, 8192
  s_add_u32 s40, s43, 8192
  s_waitcnt lgkmcnt(6)
  v_mfma_f32_16x16x32_bf16 v[60:63], v[164:167], v[36:39], v[60:63]
  ds_read_b64_tr_b16 v[20:21], v9 offset:0
  s_cmp_eq_u32 s40, 65536
  s_cselect_b32 s40, 0, s40
  v_mfma_f32_16x16x32_bf16 v[56:59], v[160:163], v[36:39], v[56:59]
  ds_read_b64_tr_b16 v[22:23], v9 offset:512
  s_sub_u32 s42, s40, s43
  s_mov_b32 s43, s40
  s_waitcnt lgkmcnt(6)
  v_mfma_f32_16x16x32_bf16 v[64:67], v[160:163], v[40:43], v[64:67]
  ds_read_b64_tr_b16 v[24:25], v10 offset:0
  buffer_load_dwordx4 v[152:155], v14, s[8:11], s36 offen offset:0 sc1
  v_mfma_f32_16x16x32_bf16 v[68:71], v[164:167], v[40:43], v[68:71]
  ds_read_b64_tr_b16 v[26:27], v10 offset:512
  s_waitcnt lgkmcnt(6)
  v_mfma_f32_16x16x32_bf16 v[76:79], v[164:167], v[44:47], v[76:79]
  ds_read_b64_tr_b16 v[28:29], v11 offset:0
  v_mfma_f32_16x16x32_bf16 v[72:75], v[160:163], v[44:47], v[72:75]
  ds_read_b64_tr_b16 v[30:31], v11 offset:512
  buffer_load_dwordx4 v[156:159], v14, s[8:11], s36 offen offset:1024 sc1
  s_waitcnt vmcnt(13) lgkmcnt(6)
  v_mfma_f32_16x16x32_bf16 v[48:51], v[168:171], v[16:19], v[48:51]
  ds_read_b64_tr_b16 v[32:33], v8 offset:4096
  s_waitcnt vmcnt(12)
  v_mfma_f32_16x16x32_bf16 v[52:55], v[172:175], v[16:19], v[52:55]
  ds_read_b64_tr_b16 v[34:35], v8 offset:4608
  v_add_u32 v8, s42, v8
  s_waitcnt lgkmcnt(6)
  v_mfma_f32_16x16x32_bf16 v[60:63], v[172:175], v[20:23], v[60:63]
  ds_read_b64_tr_b16 v[36:37], v9 offset:4096
  buffer_load_dwordx4 v[160:163], v14, s[8:11], s36 offen offset:2048 sc1
  v_mfma_f32_16x16x32_bf16 v[56:59], v[168:171], v[20:23], v[56:59]
  ds_read_b64_tr_b16 v[38:39], v9 offset:4608
  v_add_u32 v9, s42, v9
  s_waitcnt lgkmcnt(6)
  v_mfma_f32_16x16x32_bf16 v[64:67], v[168:171], v[24:27], v[64:67]
  ds_read_b64_tr_b16 v[40:41], v10 offset:4096
  v_mfma_f32_16x16x32_bf16 v[68:71], v[172:175], v[24:27], v[68:71]
  ds_read_b64_tr_b16 v[42:43], v10 offset:4608
  v_add_u32 v10, s42, v10
  s_waitcnt lgkmcnt(6)
  v_mfma_f32_16x16x32_bf16 v[76:79], v[172:175], v[28:31], v[76:79]
  ds_read_b64_tr_b16 v[44:45], v11 offset:4096
  buffer_load_dwordx4 v[164:167], v14, s[8:11], s36 offen offset:3072 sc1
  v_mfma_f32_16x16x32_bf16 v[72:75], v[168:171], v[28:31], v[72:75]
  ds_read_b64_tr_b16 v[46:47], v11 offset:4608
  v_add_u32 v11, s42, v11
  s_barrier
  s_waitcnt vmcnt(13) lgkmcnt(6)
  v_mfma_f32_16x16x32_bf16 v[48:51], v[176:179], v[32:35], v[48:51]
  ds_read_b64_tr_b16 v[16:17], v8 offset:0
  s_bitcmp1_b32 s48, 3
  s_cselect_b32 s36, s50, s49
  s_waitcnt vmcnt(12)
  v_mfma_f32_16x16x32_bf16 v[52:55], v[180:183], v[32:35], v[52:55]
  ds_read_b64_tr_b16 v[18:19], v8 offset:512
  s_add_u32 s36, s36, 12288
  s_add_u32 s40, s43, 8192
  s_waitcnt lgkmcnt(6)
  v_mfma_f32_16x16x32_bf16 v[60:63], v[180:183], v[36:39], v[60:63]
  ds_read_b64_tr_b16 v[20:21], v9 offset:0
  s_cmp_eq_u32 s40, 65536
  s_cselect_b32 s40, 0, s40
  v_mfma_f32_16x16x32_bf16 v[56:59], v[176:179], v[36:39], v[56:59]
  ds_read_b64_tr_b16 v[22:23], v9 offset:512
  s_sub_u32 s42, s40, s43
  s_mov_b32 s43, s40
  s_waitcnt lgkmcnt(6)
  v_mfma_f32_16x16x32_bf16 v[64:67], v[176:179], v[40:43], v[64:67]
  ds_read_b64_tr_b16 v[24:25], v10 offset:0
  buffer_load_dwordx4 v[168:171], v14, s[8:11], s36 offen offset:0 sc1
  v_mfma_f32_16x16x32_bf16 v[68:71], v[180:183], v[40:43], v[68:71]
  ds_read_b64_tr_b16 v[26:27], v10 offset:512
  s_waitcnt lgkmcnt(6)
  v_mfma_f32_16x16x32_bf16 v[76:79], v[180:183], v[44:47], v[76:79]
  ds_read_b64_tr_b16 v[28:29], v11 offset:0
  v_mfma_f32_16x16x32_bf16 v[72:75], v[176:179], v[44:47], v[72:75]
  ds_read_b64_tr_b16 v[30:31], v11 offset:512
  buffer_load_dwordx4 v[172:175], v14, s[8:11], s36 offen offset:1024 sc1
  s_sub_u32 s39, s39, 1
  s_cmp_lg_u32 s39, 0
  s_cbranch_scc1 cd6
  s_waitcnt vmcnt(13) lgkmcnt(6)
  v_mfma_f32_16x16x32_bf16 v[48:51], v[120:123], v[16:19], v[48:51]
  ds_read_b64_tr_b16 v[32:33], v8 offset:4096
  s_waitcnt vmcnt(12)
  v_mfma_f32_16x16x32_bf16 v[52:55], v[124:127], v[16:19], v[52:55]
  ds_read_b64_tr_b16 v[34:35], v8 offset:4608
  v_add_u32 v8, s42, v8
  s_waitcnt lgkmcnt(6)
  v_mfma_f32_16x16x32_bf16 v[60:63], v[124:127], v[20:23], v[60:63]
  ds_read_b64_tr_b16 v[36:37], v9 offset:4096
  buffer_load_dwordx4 v[176:179], v14, s[8:11], s36 offen offset:2048 sc1
  v_mfma_f32_16x16x32_bf16 v[56:59], v[120:123], v[20:23], v[56:59]
  ds_read_b64_tr_b16 v[38:39], v9 offset:4608
  v_add_u32 v9, s42, v9
  s_waitcnt lgkmcnt(6)
  v_mfma_f32_16x16x32_bf16 v[64:67], v[120:123], v[24:27], v[64:67]
  ds_read_b64_tr_b16 v[40:41], v10 offset:4096
  v_mfma_f32_16x16x32_bf16 v[68:71], v[124:127], v[24:27], v[68:71]
  ds_read_b64_tr_b16 v[42:43], v10 offset:4608
  v_add_u32 v10, s42, v10
  s_waitcnt lgkmcnt(6)
  v_mfma_f32_16x16x32_bf16 v[76:79], v[124:127], v[28:31], v[76:79]
  ds_read_b64_tr_b16 v[44:45], v11 offset:4096
  buffer_load_dwordx4 v[180:183], v14, s[8:11], s36 offen offset:3072 sc1
  v_mfma_f32_16x16x32_bf16 v[72:75], v[120:123], v[28:31], v[72:75]
  ds_read_b64_tr_b16 v[46:47], v11 offset:4608
  v_add_u32 v11, s42, v11
  s_barrier
  s_waitcnt vmcnt(13) lgkmcnt(6)
  v_mfma_f32_16x16x32_bf16 v[48:51], v[128:131], v[32:35], v[48:51]
  ds_read_b64_tr_b16 v[16:17], v8 offset:0
  s_bitcmp1_b32 s48, 4
  s_cselect_b32 s36, s50, s49
  s_waitcnt vmcnt(12)
  v_mfma_f32_16x16x32_bf16 v[52:55], v[132:135], v[32:35], v[52:55]
  ds_read_b64_tr_b16 v[18:19], v8 offset:512
  s_add_u32 s36, s36, 16384
  s_add_u32 s40, s43, 8192
  s_waitcnt lgkmcnt(6)
  v_mfma_f32_16x16x32_bf16 v[60:63], v[132:135], v[36:39], v[60:63]
  ds_read_b64_tr_b16 v[20:21], v9 offset:0
  s_cmp_eq_u32 s40, 65536
  s_cselect_b32 s40, 0, s40
  v_mfma_f32_16x16x32_bf16 v[56:59], v[128:131], v[36:39], v[56:59]
  ds_read_b64_tr_b16 v[22:23], v9 offset:512
  s_sub_u32 s42, s40, s43
  s_mov_b32 s43, s40
  s_waitcnt lgkmcnt(6)
  v_mfma_f32_16x16x32_bf16 v[64:67], v[128:131], v[40:43], v[64:67]
  ds_read_b64_tr_b16 v[24:25], v10 offset:0
  buffer_load_dwordx4 v[120:123], v14, s[8:11], s36 offen offset:0 sc1
  v_mfma_f32_16x16x32_bf16 v[68:71], v[132:135], v[40:43], v[68:71]
  ds_read_b64_tr_b16 v[26:27], v10 offset:512
  s_waitcnt lgkmcnt(6)
  v_mfma_f32_16x16x32_bf16 v[76:79], v[132:135], v[44:47], v[76:79]
  ds_read_b64_tr_b16 v[28:29], v11 offset:0
  v_mfma_f32_16x16x32_bf16 v[72:75], v[128:131], v[44:47], v[72:75]
  ds_read_b64_tr_b16 v[30:31], v11 offset:512
  buffer_load_dwordx4 v[124:127], v14, s[8:11], s36 offen offset:1024 sc1
  s_waitcnt vmcnt(13) lgkmcnt(6)
  v_mfma_f32_16x16x32_bf16 v[48:51], v[136:139], v[16:19], v[48:51]
  ds_read_b64_tr_b16 v[32:33], v8 offset:4096
  s_waitcnt vmcnt(12)
  v_mfma_f32_16x16x32_bf16 v[52:55], v[140:143], v[16:19], v[52:55]
  ds_read_b64_tr_b16 v[34:35], v8 offset:4608
  v_add_u32 v8, s42, v8
  s_waitcnt lgkmcnt(6)
  v_mfma_f32_16x16x32_bf16 v[60:63], v[140:143], v[20:23], v[60:63]
  ds_read_b64_tr_b16 v[36:37], v9 offset:4096
  buffer_load_dwordx4 v[128:131], v14, s[8:11], s36 offen offset:2048 sc1
  v_mfma_f32_16x16x32_bf16 v[56:59], v[136:139], v[20:23], v[56:59]
  ds_read_b64_tr_b16 v[38:39], v9 offset:4608
  v_add_u32 v9, s42, v9
  s_waitcnt lgkmcnt(6)
  v_mfma_f32_16x16x32_bf16 v[64:67], v[136:139], v[24:27], v[64:67]
  ds_read_b64_tr_b16 v[40:41], v10 offset:4096
  v_mfma_f32_16x16x32_bf16 v[68:71], v[140:143], v[24:27], v[68:71]
  ds_read_b64_tr_b16 v[42:43], v10 offset:4608
  v_add_u32 v10, s42, v10
  s_waitcnt lgkmcnt(6)
  v_mfma_f32_16x16x32_bf16 v[76:79], v[140:143], v[28:31], v[76:79]
  ds_read_b64_tr_b16 v[44:45], v11 offset:4096
  buffer_load_dwordx4 v[132:135], v14, s[8:11], s36 offen offset:3072 sc1
  v_mfma_f32_16x16x32_bf16 v[72:75], v[136:139], v[28:31], v[72:75]
  ds_read_b64_tr_b16 v[46:47], v11 offset:4608
  v_add_u32 v11, s42, v11
  s_barrier
  s_waitcnt vmcnt(13) lgkmcnt(6)
  v_mfma_f32_16x16x32_bf16 v[48:51], v[144:147], v[32:35], v[48:51]
  ds_read_b64_tr_b16 v[16:17], v8 offset:0
  s_bitcmp1_b32 s48, 5
  s_cselect_b32 s36, s50, s49
  s_waitcnt vmcnt(12)
  v_mfma_f32_16x16x32_bf16 v[52:55], v[148:151], v[32:35], v[52:55]
  ds_read_b64_tr_b16 v[18:19], v8 offset:512
  s_add_u32 s36, s36, 20480
  s_add_u32 s40, s43, 8192
  s_waitcnt lgkmcnt(6)
  v_mfma_f32_16x16x32_bf16 v[60:63], v[148:151], v[36:39], v[60:63]
  ds_read_b64_tr_b16 v[20:21], v9 offset:0
  s_cmp_eq_u32 s40, 65536
  s_cselect_b32 s40, 0, s40
  v_mfma_f32_16x16x32_bf16 v[56:59], v[144:147], v[36:39], v[56:59]
  ds_read_b64_tr_b16 v[22:23], v9 offset:512
  s_sub_u32 s42, s40, s43
  s_mov_b32 s43, s40
  s_waitcnt lgkmcnt(6)
  v_mfma_f32_16x16x32_bf16 v[64:67], v[144:147], v[40:43], v[64:67]
  ds_read_b64_tr_b16 v[24:25], v10 offset:0
  buffer_load_dwordx4 v[136:139], v14, s[8:11], s36 offen offset:0 sc1
  v_mfma_f32_16x16x32_bf16 v[68:71], v[148:151], v[40:43], v[68:71]
  ds_read_b64_tr_b16 v[26:27], v10 offset:512
  s_waitcnt lgkmcnt(6)
  v_mfma_f32_16x16x32_bf16 v[76:79], v[148:151], v[44:47], v[76:79]
  ds_read_b64_tr_b16 v[28:29], v11 offset:0
  v_mfma_f32_16x16x32_bf16 v[72:75], v[144:147], v[44:47], v[72:75]
  ds_read_b64_tr_b16 v[30:31], v11 offset:512
  buffer_load_dwordx4 v[140:143], v14, s[8:11], s36 offen offset:1024 sc1
  s_waitcnt vmcnt(13) lgkmcnt(6)
  v_mfma_f32_16x16x32_bf16 v[48:51], v[152:155], v[16:19], v[48:51]
  ds_read_b64_tr_b16 v[32:33], v8 offset:4096
  s_waitcnt vmcnt(12)
  v_mfma_f32_16x16x32_bf16 v[52:55], v[156:159], v[16:19], v[52:55]
  ds_read_b64_tr_b16 v[34:35], v8 offset:4608
  v_add_u32 v8, s42, v8
  s_waitcnt lgkmcnt(6)
  v_mfma_f32_16x16x32_bf16 v[60:63], v[156:159], v[20:23], v[60:63]
  ds_read_b64_tr_b16 v[36:37], v9 offset:4096
  buffer_load_dwordx4 v[144:147], v14, s[8:11], s36 offen offset:2048 sc1
  v_mfma_f32_16x16x32_bf16 v[56:59], v[152:155], v[20:23], v[56:59]
  ds_read_b64_tr_b16 v[38:39], v9 offset:4608
  v_add_u32 v9, s42, v9
  s_waitcnt lgkmcnt(6)
  v_mfma_f32_16x16x32_bf16 v[64:67], v[152:155], v[24:27], v[64:67]
  ds_read_b64_tr_b16 v[40:41], v10 offset:4096
  v_mfma_f32_16x16x32_bf16 v[68:71], v[156:159], v[24:27], v[68:71]
  ds_read_b64_tr_b16 v[42:43], v10 offset:4608
  v_add_u32 v10, s42, v10
  s_waitcnt lgkmcnt(6)
  v_mfma_f32_16x16x32_bf16 v[76:79], v[156:159], v[28:31], v[76:79]
  ds_read_b64_tr_b16 v[44:45], v11 offset:4096
  buffer_load_dwordx4 v[148:151], v14, s[8:11], s36 offen offset:3072 sc1
  v_mfma_f32_16x16x32_bf16 v[72:75], v[152:155], v[28:31], v[72:75]
  ds_read_b64_tr_b16 v[46:47], v11 offset:4608
  v_add_u32 v11, s42, v11
  s_barrier
  s_waitcnt vmcnt(13) lgkmcnt(6)
  v_mfma_f32_16x16x32_bf16 v[48:51], v[160:163], v[32:35], v[48:51]
  ds_read_b64_tr_b16 v[16:17], v8 offset:0
  s_bitcmp1_b32 s48, 6
  s_cselect_b32 s36, s50, s49
  s_waitcnt vmcnt(12)
  v_mfma_f32_16x16x32_bf16 v[52:55], v[164:167], v[32:35], v[52:55]
  ds_read_b64_tr_b16 v[18:19], v8 offset:512
  s_add_u32 s36, s36, 24576
  s_add_u32 s40, s43, 8192
  s_waitcnt lgkmcnt(6)
  v_mfma_f32_16x16x32_bf16 v[60:63], v[164:167], v[36:39], v[60:63]
  ds_read_b64_tr_b16 v[20:21], v9 offset:0
  s_cmp_eq_u32 s40, 65536
  s_cselect_b32 s40, 0, s40
  v_mfma_f32_16x16x32_bf16 v[56:59], v[160:163], v[36:39], v[56:59]
  ds_read_b64_tr_b16 v[22:23], v9 offset:512
  s_sub_u32 s42, s40, s43
  s_mov_b32 s43, s40
  s_waitcnt lgkmcnt(6)
  v_mfma_f32_16x16x32_bf16 v[64:67], v[160:163], v[40:43], v[64:67]
  ds_read_b64_tr_b16 v[24:25], v10 offset:0
  buffer_load_dwordx4 v[152:155], v14, s[8:11], s36 offen offset:0 sc1
  v_mfma_f32_16x16x32_bf16 v[68:71], v[164:167], v[40:43], v[68:71]
  ds_read_b64_tr_b16 v[26:27], v10 offset:512
  s_waitcnt lgkmcnt(6)
  v_mfma_f32_16x16x32_bf16 v[76:79], v[164:167], v[44:47], v[76:79]
  ds_read_b64_tr_b16 v[28:29], v11 offset:0
  v_mfma_f32_16x16x32_bf16 v[72:75], v[160:163], v[44:47], v[72:75]
  ds_read_b64_tr_b16 v[30:31], v11 offset:512
  buffer_load_dwordx4 v[156:159], v14, s[8:11], s36 offen offset:1024 sc1
  s_waitcnt vmcnt(13) lgkmcnt(6)
  v_mfma_f32_16x16x32_bf16 v[48:51], v[168:171], v[16:19], v[48:51]
  ds_read_b64_tr_b16 v[32:33], v8 offset:4096
  s_waitcnt vmcnt(12)
  v_mfma_f32_16x16x32_bf16 v[52:55], v[172:175], v[16:19], v[52:55]
  ds_read_b64_tr_b16 v[34:35], v8 offset:4608
  v_add_u32 v8, s42, v8
  s_waitcnt lgkmcnt(6)
  v_mfma_f32_16x16x32_bf16 v[60:63], v[172:175], v[20:23], v[60:63]
  ds_read_b64_tr_b16 v[36:37], v9 offset:4096
  buffer_load_dwordx4 v[160:163], v14, s[8:11], s36 offen offset:2048 sc1
  v_mfma_f32_16x16x32_bf16 v[56:59], v[168:171], v[20:23], v[56:59]
  ds_read_b64_tr_b16 v[38:39], v9 offset:4608
  v_add_u32 v9, s42, v9
  s_waitcnt lgkmcnt(6)
  v_mfma_f32_16x16x32_bf16 v[64:67], v[168:171], v[24:27], v[64:67]
  ds_read_b64_tr_b16 v[40:41], v10 offset:4096
  v_mfma_f32_16x16x32_bf16 v[68:71], v[172:175], v[24:27], v[68:71]
  ds_read_b64_tr_b16 v[42:43], v10 offset:4608
  v_add_u32 v10, s42, v10
  s_waitcnt lgkmcnt(6)
  v_mfma_f32_16x16x32_bf16 v[76:79], v[172:175], v[28:31], v[76:79]
  ds_read_b64_tr_b16 v[44:45], v11 offset:4096
  buffer_load_dwordx4 v[164:167], v14, s[8:11], s36 offen offset:3072 sc1
  v_mfma_f32_16x16x32_bf16 v[72:75], v[168:171], v[28:31], v[72:75]
  ds_read_b64_tr_b16 v[46:47], v11 offset:4608
  v_add_u32 v11, s42, v11
  s_barrier
  s_waitcnt vmcnt(13) lgkmcnt(6)
  v_mfma_f32_16x16x32_bf16 v[48:51], v[176:179], v[32:35], v[48:51]
  ds_read_b64_tr_b16 v[16:17], v8 offset:0
  s_bitcmp1_b32 s48, 7
  s_cselect_b32 s36, s50, s49
  s_waitcnt vmcnt(12)
  v_mfma_f32_16x16x32_bf16 v[52:55], v[180:183], v[32:35], v[52:55]
  ds_read_b64_tr_b16 v[18:19], v8 offset:512
  s_add_u32 s36, s36, 28672
  s_add_u32 s40, s43, 8192
  s_waitcnt lgkmcnt(6)
  v_mfma_f32_16x16x32_bf16 v[60:63], v[180:183], v[36:39], v[60:63]
  ds_read_b64_tr_b16 v[20:21], v9 offset:0
  s_cmp_eq_u32 s40, 65536
  s_cselect_b32 s40, 0, s40
  v_mfma_f32_16x16x32_bf16 v[56:59], v[176:179], v[36:39], v[56:59]
  ds_read_b64_tr_b16 v[22:23], v9 offset:512
  s_sub_u32 s42, s40, s43
  s_mov_b32 s43, s40
  s_waitcnt lgkmcnt(6)
  v_mfma_f32_16x16x32_bf16 v[64:67], v[176:179], v[40:43], v[64:67]
  ds_read_b64_tr_b16 v[24:25], v10 offset:0
  buffer_load_dwordx4 v[168:171], v14, s[8:11], s36 offen offset:0 sc1
  v_mfma_f32_16x16x32_bf16 v[68:71], v[180:183], v[40:43], v[68:71]
  ds_read_b64_tr_b16 v[26:27], v10 offset:512
  s_waitcnt lgkmcnt(6)
  v_mfma_f32_16x16x32_bf16 v[76:79], v[180:183], v[44:47], v[76:79]
  ds_read_b64_tr_b16 v[28:29], v11 offset:0
  v_mfma_f32_16x16x32_bf16 v[72:75], v[176:179], v[44:47], v[72:75]
  ds_read_b64_tr_b16 v[30:31], v11 offset:512
  buffer_load_dwordx4 v[172:175], v14, s[8:11], s36 offen offset:1024 sc1
  s_waitcnt vmcnt(13) lgkmcnt(6)
  v_mfma_f32_16x16x32_bf16 v[48:51], v[120:123], v[16:19], v[48:51]
  ds_read_b64_tr_b16 v[32:33], v8 offset:4096
  s_waitcnt vmcnt(12)
  v_mfma_f32_16x16x32_bf16 v[52:55], v[124:127], v[16:19], v[52:55]
  ds_read_b64_tr_b16 v[34:35], v8 offset:4608
  v_add_u32 v8, s42, v8
  s_waitcnt lgkmcnt(6)
  v_mfma_f32_16x16x32_bf16 v[60:63], v[124:127], v[20:23], v[60:63]
  ds_read_b64_tr_b16 v[36:37], v9 offset:4096
  buffer_load_dwordx4 v[176:179], v14, s[8:11], s36 offen offset:2048 sc1
  v_mfma_f32_16x16x32_bf16 v[56:59], v[120:123], v[20:23], v[56:59]
  ds_read_b64_tr_b16 v[38:39], v9 offset:4608
  v_add_u32 v9, s42, v9
  s_waitcnt lgkmcnt(6)
  v_mfma_f32_16x16x32_bf16 v[64:67], v[120:123], v[24:27], v[64:67]
  ds_read_b64_tr_b16 v[40:41], v10 offset:4096
  v_mfma_f32_16x16x32_bf16 v[68:71], v[124:127], v[24:27], v[68:71]
  ds_read_b64_tr_b16 v[42:43], v10 offset:4608
  v_add_u32 v10, s42, v10
  s_waitcnt lgkmcnt(6)
  v_mfma_f32_16x16x32_bf16 v[76:79], v[124:127], v[28:31], v[76:79]
  ds_read_b64_tr_b16 v[44:45], v11 offset:4096
  buffer_load_dwordx4 v[180:183], v14, s[8:11], s36 offen offset:3072 sc1
  v_mfma_f32_16x16x32_bf16 v[72:75], v[120:123], v[28:31], v[72:75]
  ds_read_b64_tr_b16 v[46:47], v11 offset:4608
  v_add_u32 v11, s42, v11
  s_barrier
  s_waitcnt vmcnt(13) lgkmcnt(6)
  v_mfma_f32_16x16x32_bf16 v[48:51], v[128:131], v[32:35], v[48:51]
  ds_read_b64_tr_b16 v[16:17], v8 offset:0
  s_add_u32 s40, s43, 8192
  s_cmp_eq_u32 s40, 65536
  s_waitcnt vmcnt(12)
  v_mfma_f32_16x16x32_bf16 v[52:55], v[132:135], v[32:35], v[52:55]
  ds_read_b64_tr_b16 v[18:19], v8 offset:512
  s_cselect_b32 s40, 0, s40
  s_sub_u32 s42, s40, s43
  s_waitcnt lgkmcnt(6)
  v_mfma_f32_16x16x32_bf16 v[60:63], v[132:135], v[36:39], v[60:63]
  ds_read_b64_tr_b16 v[20:21], v9 offset:0
  s_mov_b32 s43, s40
  v_mfma_f32_16x16x32_bf16 v[56:59], v[128:131], v[36:39], v[56:59]
  ds_read_b64_tr_b16 v[22:23], v9 offset:512
  s_waitcnt lgkmcnt(6)
  v_mfma_f32_16x16x32_bf16 v[64:67], v[128:131], v[40:43], v[64:67]
  ds_read_b64_tr_b16 v[24:25], v10 offset:0
  v_mfma_f32_16x16x32_bf16 v[68:71], v[132:135], v[40:43], v[68:71]
  ds_read_b64_tr_b16 v[26:27], v10 offset:512
  s_waitcnt lgkmcnt(6)
  v_mfma_f32_16x16x32_bf16 v[76:79], v[132:135], v[44:47], v[76:79]
  ds_read_b64_tr_b16 v[28:29], v11 offset:0
  v_mfma_f32_16x16x32_bf16 v[72:75], v[128:131], v[44:47], v[72:75]
  ds_read_b64_tr_b16 v[30:31], v11 offset:512
  s_waitcnt vmcnt(11) lgkmcnt(6)
  v_mfma_f32_16x16x32_bf16 v[48:51], v[136:139], v[16:19], v[48:51]
  ds_read_b64_tr_b16 v[32:33], v8 offset:4096
  s_waitcnt vmcnt(10)
  v_mfma_f32_16x16x32_bf16 v[52:55], v[140:143], v[16:19], v[52:55]
  ds_read_b64_tr_b16 v[34:35], v8 offset:4608
  v_add_u32 v8, s42, v8
  s_waitcnt lgkmcnt(6)
  v_mfma_f32_16x16x32_bf16 v[60:63], v[140:143], v[20:23], v[60:63]
  ds_read_b64_tr_b16 v[36:37], v9 offset:4096
  v_mfma_f32_16x16x32_bf16 v[56:59], v[136:139], v[20:23], v[56:59]
  ds_read_b64_tr_b16 v[38:39], v9 offset:4608
  v_add_u32 v9, s42, v9
  s_waitcnt lgkmcnt(6)
  v_mfma_f32_16x16x32_bf16 v[64:67], v[136:139], v[24:27], v[64:67]
  ds_read_b64_tr_b16 v[40:41], v10 offset:4096
  v_mfma_f32_16x16x32_bf16 v[68:71], v[140:143], v[24:27], v[68:71]
  ds_read_b64_tr_b16 v[42:43], v10 offset:4608
  v_add_u32 v10, s42, v10
  s_waitcnt lgkmcnt(6)
  v_mfma_f32_16x16x32_bf16 v[76:79], v[140:143], v[28:31], v[76:79]
  ds_read_b64_tr_b16 v[44:45], v11 offset:4096
  v_mfma_f32_16x16x32_bf16 v[72:75], v[136:139], v[28:31], v[72:75]
  ds_read_b64_tr_b16 v[46:47], v11 offset:4608
  v_add_u32 v11, s42, v11
  s_barrier
  s_waitcnt vmcnt(9) lgkmcnt(6)
  v_mfma_f32_16x16x32_bf16 v[48:51], v[144:147], v[32:35], v[48:51]
  ds_read_b64_tr_b16 v[16:17], v8 offset:0
  s_add_u32 s40, s43, 8192
  s_cmp_eq_u32 s40, 65536
  s_waitcnt vmcnt(8)
  v_mfma_f32_16x16x32_bf16 v[52:55], v[148:151], v[32:35], v[52:55]
  ds_read_b64_tr_b16 v[18:19], v8 offset:512
  s_cselect_b32 s40, 0, s40
  s_sub_u32 s42, s40, s43
  s_waitcnt lgkmcnt(6)
  v_mfma_f32_16x16x32_bf16 v[60:63], v[148:151], v[36:39], v[60:63]
  ds_read_b64_tr_b16 v[20:21], v9 offset:0
  s_mov_b32 s43, s40
  v_mfma_f32_16x16x32_bf16 v[56:59], v[144:147], v[36:39], v[56:59]
  ds_read_b64_tr_b16 v[22:23], v9 offset:512
  s_waitcnt lgkmcnt(6)
  v_mfma_f32_16x16x32_bf16 v[64:67], v[144:147], v[40:43], v[64:67]
  ds_read_b64_tr_b16 v[24:25], v10 offset:0
  v_mfma_f32_16x16x32_bf16 v[68:71], v[148:151], v[40:43], v[68:71]
  ds_read_b64_tr_b16 v[26:27], v10 offset:512
  s_waitcnt lgkmcnt(6)
  v_mfma_f32_16x16x32_bf16 v[76:79], v[148:151], v[44:47], v[76:79]
  ds_read_b64_tr_b16 v[28:29], v11 offset:0
  v_mfma_f32_16x16x32_bf16 v[72:75], v[144:147], v[44:47], v[72:75]
  ds_read_b64_tr_b16 v[30:31], v11 offset:512
  s_waitcnt vmcnt(7) lgkmcnt(6)
  v_mfma_f32_16x16x32_bf16 v[48:51], v[152:155], v[16:19], v[48:51]
  ds_read_b64_tr_b16 v[32:33], v8 offset:4096
  s_waitcnt vmcnt(6)
  v_mfma_f32_16x16x32_bf16 v[52:55], v[156:159], v[16:19], v[52:55]
  ds_read_b64_tr_b16 v[34:35], v8 offset:4608
  v_add_u32 v8, s42, v8
  s_waitcnt lgkmcnt(6)
  v_mfma_f32_16x16x32_bf16 v[60:63], v[156:159], v[20:23], v[60:63]
  ds_read_b64_tr_b16 v[36:37], v9 offset:4096
  v_mfma_f32_16x16x32_bf16 v[56:59], v[152:155], v[20:23], v[56:59]
  ds_read_b64_tr_b16 v[38:39], v9 offset:4608
  v_add_u32 v9, s42, v9
  s_waitcnt lgkmcnt(6)
  v_mfma_f32_16x16x32_bf16 v[64:67], v[152:155], v[24:27], v[64:67]
  ds_read_b64_tr_b16 v[40:41], v10 offset:4096
  v_mfma_f32_16x16x32_bf16 v[68:71], v[156:159], v[24:27], v[68:71]
  ds_read_b64_tr_b16 v[42:43], v10 offset:4608
  v_add_u32 v10, s42, v10
  s_waitcnt lgkmcnt(6)
  v_mfma_f32_16x16x32_bf16 v[76:79], v[156:159], v[28:31], v[76:79]
  ds_read_b64_tr_b16 v[44:45], v11 offset:4096
  v_mfma_f32_16x16x32_bf16 v[72:75], v[152:155], v[28:31], v[72:75]
  ds_read_b64_tr_b16 v[46:47], v11 offset:4608
  v_add_u32 v11, s42, v11
  s_barrier
  s_waitcnt vmcnt(5) lgkmcnt(6)
  v_mfma_f32_16x16x32_bf16 v[48:51], v[160:163], v[32:35], v[48:51]
  ds_read_b64_tr_b16 v[16:17], v8 offset:0
  s_add_u32 s40, s43, 8192
  s_cmp_eq_u32 s40, 65536
  s_waitcnt vmcnt(4)
  v_mfma_f32_16x16x32_bf16 v[52:55], v[164:167], v[32:35], v[52:55]
  ds_read_b64_tr_b16 v[18:19], v8 offset:512
  s_cselect_b32 s40, 0, s40
  s_sub_u32 s42, s40, s43
  s_waitcnt lgkmcnt(6)
  v_mfma_f32_16x16x32_bf16 v[60:63], v[164:167], v[36:39], v[60:63]
  ds_read_b64_tr_b16 v[20:21], v9 offset:0
  s_mov_b32 s43, s40
  v_mfma_f32_16x16x32_bf16 v[56:59], v[160:163], v[36:39], v[56:59]
  ds_read_b64_tr_b16 v[22:23], v9 offset:512
  s_waitcnt lgkmcnt(6)
  v_mfma_f32_16x16x32_bf16 v[64:67], v[160:163], v[40:43], v[64:67]
  ds_read_b64_tr_b16 v[24:25], v10 offset:0
  v_mfma_f32_16x16x32_bf16 v[68:71], v[164:167], v[40:43], v[68:71]
  ds_read_b64_tr_b16 v[26:27], v10 offset:512
  s_waitcnt lgkmcnt(6)
  v_mfma_f32_16x16x32_bf16 v[76:79], v[164:167], v[44:47], v[76:79]
  ds_read_b64_tr_b16 v[28:29], v11 offset:0
  v_mfma_f32_16x16x32_bf16 v[72:75], v[160:163], v[44:47], v[72:75]
  ds_read_b64_tr_b16 v[30:31], v11 offset:512
  s_waitcnt vmcnt(3) lgkmcnt(6)
  v_mfma_f32_16x16x32_bf16 v[48:51], v[168:171], v[16:19], v[48:51]
  ds_read_b64_tr_b16 v[32:33], v8 offset:4096
  s_waitcnt vmcnt(2)
  v_mfma_f32_16x16x32_bf16 v[52:55], v[172:175], v[16:19], v[52:55]
  ds_read_b64_tr_b16 v[34:35], v8 offset:4608
  s_waitcnt lgkmcnt(6)
  v_mfma_f32_16x16x32_bf16 v[60:63], v[172:175], v[20:23], v[60:63]
  ds_read_b64_tr_b16 v[36:37], v9 offset:4096
  v_mfma_f32_16x16x32_bf16 v[56:59], v[168:171], v[20:23], v[56:59]
  ds_read_b64_tr_b16 v[38:39], v9 offset:4608
  s_waitcnt lgkmcnt(6)
  v_mfma_f32_16x16x32_bf16 v[64:67], v[168:171], v[24:27], v[64:67]
  ds_read_b64_tr_b16 v[40:41], v10 offset:4096
  v_mfma_f32_16x16x32_bf16 v[68:71], v[172:175], v[24:27], v[68:71]
  ds_read_b64_tr_b16 v[42:43], v10 offset:4608
  s_waitcnt lgkmcnt(6)
  v_mfma_f32_16x16x32_bf16 v[76:79], v[172:175], v[28:31], v[76:79]
  ds_read_b64_tr_b16 v[44:45], v11 offset:4096
  v_mfma_f32_16x16x32_bf16 v[72:75], v[168:171], v[28:31], v[72:75]
  ds_read_b64_tr_b16 v[46:47], v11 offset:4608
  s_waitcnt vmcnt(1) lgkmcnt(6)
  v_mfma_f32_16x16x32_bf16 v[48:51], v[176:179], v[32:35], v[48:51]
  s_waitcnt vmcnt(0)
  v_mfma_f32_16x16x32_bf16 v[52:55], v[180:183], v[32:35], v[52:55]
  s_waitcnt lgkmcnt(4)
  v_mfma_f32_16x16x32_bf16 v[60:63], v[180:183], v[36:39], v[60:63]
  v_mfma_f32_16x16x32_bf16 v[56:59], v[176:179], v[36:39], v[56:59]
  s_waitcnt lgkmcnt(2)
  v_mfma_f32_16x16x32_bf16 v[64:67], v[176:179], v[40:43], v[64:67]
  v_mfma_f32_16x16x32_bf16 v[68:71], v[180:183], v[40:43], v[68:71]
  s_waitcnt lgkmcnt(0)
  v_mfma_f32_16x16x32_bf16 v[76:79], v[180:183], v[44:47], v[76:79]
  v_mfma_f32_16x16x32_bf16 v[72:75], v[176:179], v[44:47], v[72:75]
  s_waitcnt lgkmcnt(0)
  s_cmp_eq_u32 s3, 0
  s_cbranch_scc1 C_st
  v_cvt_pk_bf16_f32 v96, v48, v49
  v_cvt_pk_bf16_f32 v97, v50, v51
  v_cvt_pk_bf16_f32 v98, v52, v53
  v_cvt_pk_bf16_f32 v99, v54, v55
  buffer_store_dwordx4 v[96:99], v12, s[24:27], 0 offen sc0 sc1
  v_cvt_pk_bf16_f32 v100, v56, v57
  v_cvt_pk_bf16_f32 v101, v58, v59
  v_cvt_pk_bf16_f32 v102, v60, v61
  v_cvt_pk_bf16_f32 v103, v62, v63
  buffer_store_dwordx4 v[100:103], v12, s[24:27], s45 offen sc0 sc1
  v_cvt_pk_bf16_f32 v104, v64, v65
  v_cvt_pk_bf16_f32 v105, v66, v67
  v_cvt_pk_bf16_f32 v106, v68, v69
  v_cvt_pk_bf16_f32 v107, v70, v71
  buffer_store_dwordx4 v[104:107], v12, s[24:27], s46 offen sc0 sc1
  v_cvt_pk_bf16_f32 v108, v72, v73
  v_cvt_pk_bf16_f32 v109, v74, v75
  v_cvt_pk_bf16_f32 v110, v76, v77
  v_cvt_pk_bf16_f32 v111, v78, v79
  buffer_store_dwordx4 v[108:111], v12, s[24:27], s47 offen sc0 sc1
  s_branch C_end
C_st:
  s_nop 7
  v_pk_add_f32 v[16:17], v[48:49], v[50:51]
  v_pk_mul_f32 v[18:19], v[48:49], v[48:49]
  v_pk_fma_f32 v[18:19], v[50:51], v[50:51], v[18:19]
  v_pk_add_f32 v[16:17], v[16:17], v[52:53]
  v_pk_fma_f32 v[18:19], v[52:53], v[52:53], v[18:19]
  v_pk_add_f32 v[16:17], v[16:17], v[54:55]
  v_pk_fma_f32 v[18:19], v[54:55], v[54:55], v[18:19]
  v_add_f32 v32, v16, v17
  v_add_f32 v36, v18, v19
  v_pk_add_f32 v[20:21], v[56:57], v[58:59]
  v_pk_mul_f32 v[22:23], v[56:57], v[56:57]
  v_pk_fma_f32 v[22:23], v[58:59], v[58:59], v[22:23]
  v_pk_add_f32 v[20:21], v[20:21], v[60:61]
  v_pk_fma_f32 v[22:23], v[60:61], v[60:61], v[22:23]
  v_pk_add_f32 v[20:21], v[20:21], v[62:63]
  v_pk_fma_f32 v[22:23], v[62:63], v[62:63], v[22:23]
  v_add_f32 v33, v20, v21
  v_add_f32 v37, v22, v23
  v_pk_add_f32 v[24:25], v[64:65], v[66:67]
  v_pk_mul_f32 v[26:27], v[64:65], v[64:65]
  v_pk_fma_f32 v[26:27], v[66:67], v[66:67], v[26:27]
  v_pk_add_f32 v[24:25], v[24:25], v[68:69]
  v_pk_fma_f32 v[26:27], v[68:69], v[68:69], v[26:27]
  v_pk_add_f32 v[24:25], v[24:25], v[70:71]
  v_pk_fma_f32 v[26:27], v[70:71], v[70:71], v[26:27]
  v_add_f32 v34, v24, v25
  v_add_f32 v38, v26, v27
  v_pk_add_f32 v[28:29], v[72:73], v[74:75]
  v_pk_mul_f32 v[30:31], v[72:73], v[72:73]
  v_pk_fma_f32 v[30:31], v[74:75], v[74:75], v[30:31]
  v_pk_add_f32 v[28:29], v[28:29], v[76:77]
  v_pk_fma_f32 v[30:31], v[76:77], v[76:77], v[30:31]
  v_pk_add_f32 v[28:29], v[28:29], v[78:79]
  v_pk_fma_f32 v[30:31], v[78:79], v[78:79], v[30:31]
  v_add_f32 v35, v28, v29
  v_add_f32 v39, v30, v31
  v_permlane16_swap_b32 v32, v33
  v_permlane16_swap_b32 v34, v35
  v_permlane16_swap_b32 v36, v37
  v_permlane16_swap_b32 v38, v39
  v_add_f32 v32, v32, v33
  v_add_f32 v34, v34, v35
  v_add_f32 v36, v36, v37
  v_add_f32 v38, v38, v39
  v_permlane32_swap_b32 v32, v34
  s_nop 0
  v_permlane32_swap_b32 v36, v38
  v_add_f32 v40, v32, v34
  v_add_f32 v41, v36, v38
  ds_write_b64 v185, v[40:41]
  s_lshl_b32 s32, s28, 14
  s_lshl_b32 s40, s29, 9
  s_add_u32 s32, s32, s40
  s_waitcnt lgkmcnt(0)
  s_barrier
  s_cmp_lg_u32 s4, 0
  s_cbranch_scc1 C_nost
  ds_read_b64 v[44:45], v185 offset:512
  ds_read_b64 v[46:47], v185 offset:1024
  ds_read_b64 v[18:19], v185 offset:1536
  s_waitcnt lgkmcnt(0)
  v_pk_add_f32 v[40:41], v[40:41], v[44:45]
  v_pk_add_f32 v[46:47], v[46:47], v[18:19]
  v_pk_add_f32 v[40:41], v[40:41], v[46:47]
  buffer_store_dwordx2 v[40:41], v184, s[12:15], s32 offen sc0 sc1
C_nost:
  s_nop 1
  v_cvt_pk_bf16_f32 v96, v48, v49
  v_cvt_pk_bf16_f32 v97, v50, v51
  v_cvt_pk_bf16_f32 v98, v52, v53
  v_cvt_pk_bf16_f32 v99, v54, v55
  buffer_store_dwordx4 v[96:99], v12, s[24:27], 0 offen sc0 sc1
  v_cvt_pk_bf16_f32 v100, v56, v57
  v_cvt_pk_bf16_f32 v101, v58, v59
  v_cvt_pk_bf16_f32 v102, v60, v61
  v_cvt_pk_bf16_f32 v103, v62, v63
  buffer_store_dwordx4 v[100:103], v12, s[24:27], s45 offen sc0 sc1
  v_cvt_pk_bf16_f32 v104, v64, v65
  v_cvt_pk_bf16_f32 v105, v66, v67
  v_cvt_pk_bf16_f32 v106, v68, v69
  v_cvt_pk_bf16_f32 v107, v70, v71
  buffer_store_dwordx4 v[104:107], v12, s[24:27], s46 offen sc0 sc1
  v_cvt_pk_bf16_f32 v108, v72, v73
  v_cvt_pk_bf16_f32 v109, v74, v75
  v_cvt_pk_bf16_f32 v110, v76, v77
  v_cvt_pk_bf16_f32 v111, v78, v79
  buffer_store_dwordx4 v[108:111], v12, s[24:27], s47 offen sc0 sc1
  s_lshr_b32 s32, s2, 3
  s_lshr_b32 s5, s32, 3
  s_and_b32 s6, s32, 7
  s_lshl_b32 s7, s5, 1
  s_add_u32 s7, s7, s6
  s_and_b32 s7, s7, 7
  s_and_b32 s32, s2, 7
  s_lshr_b32 s28, s32, 1
  s_lshl_b32 s28, s28, 2
  s_add_u32 s28, s28, s5
  s_and_b32 s29, s32, 1
  s_mul_i32 s29, s29, 8
  s_add_u32 s29, s29, s6
  s_mov_b32 s30, 7
  s_mov_b32 s31, -1
  v_and_b32 v4, 15, v0
  v_lshrrev_b32 v5, 4, v0
  v_lshrrev_b32 v6, 2, v4
  v_and_b32 v7, 3, v0
  v_lshrrev_b32 v3, 5, v0
  v_and_b32 v2, 1, v5
  v_lshl_or_b32 v3, v2, 1, v3
  v_lshl_add_u32 v21, v5, 3, v6
  v_lshlrev_b32 v21, 7, v21
  v_lshl_add_u32 v21, v7, 3, v21
  v_lshrrev_b32 v22, 1, v6
  v_lshl_or_b32 v22, v2, 1, v22
  v_lshl_add_u32 v21, v22, 5, v21
  v_add_u32 v21, 18432, v21
  v_xor_b32 v8, 0, v21
  s_lshl_b32 s32, s4, 5
  v_xor_b32 v8, s32, v8
  v_lshrrev_b32 v21, 1, v4
  v_xor_b32 v21, v21, v5
  v_lshlrev_b32 v21, 4, v21
  v_lshlrev_b32 v22, 7, v4
  v_add_u32 v9, v21, v22
  v_xor_b32 v10, 64, v9
  v_and_b32 v21, 1, v4
  v_mul_u32_u24 v21, 28800, v21
  v_lshrrev_b32 v22, 1, v4
  v_mul_u32_u24 v22, 400, v22
  v_lshlrev_b32 v23, 3, v5
  v_add3_u32 v11, v21, v22, v23
  s_add_u32 s32, s32, 43008
  v_add_u32 v11, s32, v11
  v_lshlrev_b32 v12, 3, v4
  v_add_u32 v12, 129024, v12
  v_mov_b64 v[112:113], 0
  v_mov_b64 v[114:115], 0
  v_mov_b64 v[116:117], 0
  v_mov_b64 v[118:119], 0
  v_mov_b64 v[120:121], 0
  v_mov_b64 v[122:123], 0
  v_mov_b64 v[124:125], 0
  v_mov_b64 v[126:127], 0
  v_mov_b64 v[128:129], 0
  v_mov_b64 v[130:131], 0
  v_mov_b64 v[132:133], 0
  v_mov_b64 v[134:135], 0
  v_mov_b64 v[136:137], 0
  v_mov_b64 v[138:139], 0
  v_mov_b64 v[140:141], 0
  v_mov_b64 v[142:143], 0
  v_mov_b64 v[144:145], 0
  v_mov_b64 v[146:147], 0
  v_mov_b64 v[148:149], 0
  v_mov_b64 v[150:151], 0
  v_mov_b64 v[152:153], 0
  v_mov_b64 v[154:155], 0
  v_mov_b64 v[156:157], 0
  v_mov_b64 v[158:159], 0
  v_mov_b64 v[160:161], 0
  v_mov_b64 v[162:163], 0
  v_mov_b64 v[164:165], 0
  v_mov_b64 v[166:167], 0
  v_mov_b64 v[168:169], 0
  v_mov_b64 v[170:171], 0
  v_mov_b64 v[172:173], 0
  v_mov_b64 v[174:175], 0
  v_mov_b64 v[176:177], 0
  v_mov_b64 v[178:179], 0
  v_mov_b64 v[180:181], 0
  v_mov_b64 v[182:183], 0
  v_mov_b64 v[184:185], 0
  v_mov_b64 v[186:187], 0
  v_mov_b64 v[188:189], 0
  v_mov_b64 v[190:191], 0
  v_mov_b64 v[192:193], 0
  v_mov_b64 v[194:195], 0
  v_mov_b64 v[196:197], 0
  v_mov_b64 v[198:199], 0
  v_mov_b64 v[200:201], 0
  v_mov_b64 v[202:203], 0
  v_mov_b64 v[204:205], 0
  v_mov_b64 v[206:207], 0
  v_mov_b64 v[208:209], 0
  v_mov_b64 v[210:211], 0
  v_mov_b64 v[212:213], 0
  v_mov_b64 v[214:215], 0
  v_mov_b64 v[216:217], 0
  v_mov_b64 v[218:219], 0
  s_waitcnt vmcnt(0)
  s_barrier
  s_barrier
  s_mov_b32 s3, 1
  s_mov_b32 s51, 9
  s_add_u32 s82, s84, 33554432
  s_addc_u32 s83, s85, 0
  s_branch C_top1
C_end:
  s_endpgm
L_start:
  s_nop 7
  s_nop 7
  s_sub_u32 s57, s4, 4
  v_and_b32 v134, 3, v0
  v_lshlrev_b32 v134, 6, v134
  s_lshr_b32 s32, s2, 3
  s_lshr_b32 s5, s32, 3
  s_and_b32 s6, s32, 7
  s_lshl_b32 s7, s5, 1
  s_add_u32 s7, s7, s6
  s_and_b32 s7, s7, 7
  s_and_b32 s32, s2, 7
  s_lshr_b32 s28, s32, 1
  s_lshl_b32 s28, s28, 2
  s_add_u32 s28, s28, s5
  s_and_b32 s29, s32, 1
  s_mul_i32 s29, s29, 8
  s_add_u32 s29, s29, s6
  s_mov_b32 s30, 7
  s_mov_b32 s31, -1
  s_mov_b32 s41, s57
  s_mul_i32 s32, s41, 16
  s_add_u32 s32, s32, 0
  v_lshrrev_b32 v2, 3, v0
  v_add_u32 v2, s32, v2
  v_bfe_u32 v3, v2, 1, 1
  v_bfe_u32 v4, v2, 3, 1
  v_lshl_or_b32 v3, v4, 1, v3
  v_lshlrev_b32 v3, 1, v3
  v_and_b32 v4, 7, v0
  v_xor_b32 v3, v3, v4
  v_lshlrev_b32 v3, 4, v3
  s_mov_b32 s32, 6144
  v_mul_lo_u32 v2, v2, s32
  v_add_u32 v13, v2, v3
  s_mul_i32 s32, s41, 16
  s_add_u32 s32, s32, 8
  v_lshrrev_b32 v2, 3, v0
  v_add_u32 v2, s32, v2
  v_bfe_u32 v3, v2, 1, 1
  v_bfe_u32 v4, v2, 3, 1
  v_lshl_or_b32 v3, v4, 1, v3
  v_lshlrev_b32 v3, 1, v3
  v_and_b32 v4, 7, v0
  v_xor_b32 v3, v3, v4
  v_lshlrev_b32 v3, 4, v3
  s_mov_b32 s32, 6144
  v_mul_lo_u32 v2, v2, s32
  v_add_u32 v14, v2, v3
  v_subrev_u32 v14, 1024, v14
  v_add_u32 v15, 2048, v13
  v_add_u32 v16, 2048, v14
  v_add_u32 v17, 4096, v13
  v_add_u32 v18, 4096, v14
  s_lshl_b32 s46, s41, 11
  s_add_u32 s46, s46, 18432
  s_add_u32 s47, s46, 8192
  s_add_u32 s48, s46, 16384
  s_lshl_b32 s35, s29, 7
  s_lshl_b32 s40, s28, 7
  s_sub_u32 s40, s40, 16
  s_lshl_b32 s32, s41, 5
  s_add_u32 s32, s32, 16
  v_lshrrev_b32 v2, 3, v0
  v_add_u32 v2, s32, v2
  v_bfe_u32 v3, v2, 1, 3
  v_and_b32 v4, 7, v0
  v_xor_b32 v3, v3, v4
  v_lshlrev_b32 v3, 4, v3
  v_add_u32 v2, s40, v2
  v_max_i32 v2, 0, v2
  v_lshlrev_b32 v2, 11, v2
  v_add_u32 v8, v2, v3
  v_add_u32 v10, 30720, v8
  s_lshl_b32 s32, s41, 5
  s_add_u32 s32, s32, 24
  v_lshrrev_b32 v2, 3, v0
  v_add_u32 v2, s32, v2
  v_bfe_u32 v3, v2, 1, 3
  v_and_b32 v4, 7, v0
  v_xor_b32 v3, v3, v4
  v_lshlrev_b32 v3, 4, v3
  v_add_u32 v2, s40, v2
  v_max_i32 v2, 0, v2
  v_lshlrev_b32 v2, 11, v2
  v_add_u32 v9, v2, v3
  v_subrev_u32 v9, 1024, v9
  v_add_u32 v11, 30720, v9
  s_lshl_b32 s32, s41, 3
  v_lshrrev_b32 v2, 3, v0
  v_add_u32 v2, s32, v2
  v_bfe_u32 v3, v2, 1, 3
  v_and_b32 v4, 7, v0
  v_xor_b32 v3, v3, v4
  v_lshlrev_b32 v3, 4, v3
  v_add_u32 v2, s40, v2
  v_max_i32 v2, 0, v2
  v_lshlrev_b32 v2, 11, v2
  v_add_u32 v12, v2, v3
  s_lshl_b32 s44, s41, 12
  s_add_u32 s44, s44, 2048
  s_lshl_b32 s45, s41, 10
  s_mov_b32 s34, 0
  s_cmp_eq_u32 s41, 0
  s_cselect_b32 s52, 0xffffff00, -1
  s_mov_b32 s53, -1
  v_mov_b32 v20, 0x3f803f80
  v_mov_b32 v21, v20
  v_mov_b32 v22, v20
  v_mov_b32 v23, v20
  v_lshlrev_b32 v24, 4, v0
  v_add_u32 v25, 86016, v24
  s_mov_b64 exec, 0xff
  ds_write_b128 v24, v[20:23]
  ds_write_b128 v24, v[20:23] offset:43008
  ds_write_b128 v25, v[20:23]
  s_mov_b64 exec, -1
  s_lshl_b32 s32, s41, 6
  v_add_u32 v26, s32, v0
  v_min_u32 v26, 143, v26
  v_add_u32 v27, s40, v26
  v_max_i32 v27, 0, v27
  v_lshlrev_b32 v27, 3, v27
  v_lshlrev_b32 v26, 3, v26
  v_add_u32 v26, 129024, v26
  s_lshl_b32 s32, s2, 3
  s_lshl_b32 s40, s57, 1
  s_add_u32 s32, s32, s40
  v_lshrrev_b32 v72, 5, v0
  v_add_u32 v72, s32, v72
  v_lshlrev_b32 v46, 11, v72
  v_and_b32 v2, 31, v0
  v_lshl_add_u32 v46, v2, 4, v46
  v_lshlrev_b32 v72, 3, v72
  v_add_u32 v72, 22020096, v72
  s_cmp_eq_u32 s57, 0
  s_cselect_b32 s58, 0, -1
  v_mov_b32 v64, s58
  v_mov_b32 v65, s58
  v_mov_b32 v66, s58
  v_mov_b32 v67, s58
  v_lshrrev_b32 v2, 3, v0
  v_lshlrev_b32 v2, 15, v2
  v_and_b32 v3, 7, v0
  v_lshl_add_u32 v2, v3, 4, v2
  v_lshlrev_b32 v3, 4, v0
  s_cselect_b64 vcc, -1, 0
  s_lshl_b32 s58, s2, 7
  s_add_u32 s58, s58, 29360128
  s_lshl_b32 s59, s2, 10
  s_add_u32 s59, s59, 20971520
  s_cmp_eq_u32 s57, 0
  s_cselect_b32 s58, s58, s59
  s_add_u32 s59, s59, 33554432
  s_cmp_eq_u32 s57, 2
  s_cselect_b32 s58, s59, s58
  s_cmp_eq_u32 s57, 3
  s_cselect_b32 s58, 134217728, s58
  v_cndmask_b32 v47, v3, v2, vcc
  s_and_b32 s59, s2, 3
  s_lshl_b32 s59, s59, 6
  v_mov_b32 v73, s59
  v_mov_b32 v74, 1
  s_lshl_b32 s56, s3, 10
  s_mul_i32 s32, s28, 16
  s_add_u32 s56, s56, s32
  s_add_u32 s56, s56, s29
  s_add_u32 s56, s56, 0
  s_lshl_b32 s56, s56, 7
  s_mov_b32 s38, 0
  s_waitcnt lgkmcnt(0)
  s_mov_b32 s8, s64
  s_mov_b32 s9, s65
  s_mov_b32 s10, 4194304
  s_mov_b32 s11, 0x20000
  s_mov_b32 s12, s66
  s_mov_b32 s13, s67
  s_mov_b32 s14, 6291456
  s_mov_b32 s15, 0x20000
  s_branch L_first
L_top:
  s_nop 7
  s_nop 7
  s_lshl_b32 s56, s3, 10
  s_mul_i32 s32, s28, 16
  s_add_u32 s56, s56, s32
  s_add_u32 s56, s56, s29
  s_add_u32 s56, s56, 0
  s_lshl_b32 s56, s56, 7
  s_mov_b32 s24, s72
  s_mov_b32 s25, s73
  s_mov_b32 s26, 14680064
  s_mov_b32 s27, 0x20000
  s_lshl_b32 s54, s2, 2
  s_add_u32 s54, s54, s57
  s_mul_i32 s54, s54, 0
  s_add_u32 s54, s54, 0
  s_cmp_ge_u32 s57, 2
  s_cbranch_scc1 L_k1B
  s_mov_b32 s30, 7
  s_mov_b32 s31, -1
  s_mov_b32 s38, 0
  s_add_u32 s30, s30, 1
  s_and_b32 s30, s30, 7
  s_cselect_b32 s32, 0, 1
  s_add_u32 s31, s31, s32
  s_sub_u32 s32, s30, s7
  s_and_b32 s32, s32, 7
  s_cmp_lt_u32 s32, 2
  s_cselect_b32 s32, 1, 0
  s_add_u32 s32, s32, s31
  s_cmp_ge_u32 s32, 2
  s_cselect_b32 s32, 0, s32
  s_lshl_b32 s33, s32, 3
  s_add_u32 s33, s33, s30
  s_mul_i32 s36, s33, 128
  s_add_u32 s36, s36, s34
  s_add_u32 m0, s38, s45
  s_mov_b64 exec, s[52:53]
  buffer_load_dwordx4 v12, s[8:11], s36 offen offset:0 sc1 lds
  s_mov_b64 exec, -1
  s_add_u32 m0, s38, s44
  s_nop 0
  buffer_load_dwordx4 v8, s[8:11], s36 offen offset:0 sc1 lds
  buffer_load_dwordx4 v9, s[8:11], s36 offen offset:1024 sc1 lds
  buffer_load_dwordx4 v10, s[8:11], s36 offen offset:2048 sc1 lds
  buffer_load_dwordx4 v11, s[8:11], s36 offen offset:3072 sc1 lds
  s_add_u32 s38, s38, 43008
  s_cmp_eq_u32 s38, 129024
  s_cselect_b32 s38, 0, s38
  s_add_u32 s30, s30, 1
  s_and_b32 s30, s30, 7
  s_cselect_b32 s32, 0, 1
  s_add_u32 s31, s31, s32
  s_sub_u32 s32, s30, s7
  s_and_b32 s32, s32, 7
  s_cmp_lt_u32 s32, 2
  s_cselect_b32 s32, 1, 0
  s_add_u32 s32, s32, s31
  s_cmp_ge_u32 s32, 2
  s_cselect_b32 s32, 0, s32
  s_lshl_b32 s33, s32, 3
  s_add_u32 s33, s33, s30
  s_mul_i32 s36, s33, 128
  s_add_u32 s36, s36, s34
  s_add_u32 m0, s38, s45
  s_mov_b64 exec, s[52:53]
  buffer_load_dwordx4 v12, s[8:11], s36 offen offset:0 sc1 lds
  s_mov_b64 exec, -1
  s_add_u32 m0, s38, s44
  s_nop 0
  buffer_load_dwordx4 v8, s[8:11], s36 offen offset:0 sc1 lds
  buffer_load_dwordx4 v9, s[8:11], s36 offen offset:1024 sc1 lds
  buffer_load_dwordx4 v10, s[8:11], s36 offen offset:2048 sc1 lds
  buffer_load_dwordx4 v11, s[8:11], s36 offen offset:3072 sc1 lds
  s_add_u32 s38, s38, 43008
  s_cmp_eq_u32 s38, 129024
  s_cselect_b32 s38, 0, s38
  s_waitcnt vmcnt(5)
  s_barrier
  s_add_u32 s30, s30, 1
  s_and_b32 s30, s30, 7
  s_cselect_b32 s32, 0, 1
  s_add_u32 s31, s31, s32
  s_sub_u32 s32, s30, s7
  s_and_b32 s32, s32, 7
  s_cmp_lt_u32 s32, 2
  s_cselect_b32 s32, 1, 0
  s_add_u32 s32, s32, s31
  s_cmp_ge_u32 s32, 2
  s_cselect_b32 s32, 0, s32
  s_lshl_b32 s33, s32, 3
  s_add_u32 s33, s33, s30
  s_mul_i32 s36, s33, 128
  s_add_u32 s36, s36, s34
  s_mul_i32 s37, s33, 393216
  s_add_u32 s37, s37, s35
  s_add_u32 m0, s38, s45
  s_mov_b64 exec, s[52:53]
  buffer_load_dwordx4 v12, s[8:11], s36 offen offset:0 sc1 lds
  s_mov_b64 exec, -1
  s_add_u32 m0, s38, s44
  s_nop 0
  buffer_load_dwordx4 v8, s[8:11], s36 offen offset:0 sc1 lds
  buffer_load_dwordx4 v9, s[8:11], s36 offen offset:1024 sc1 lds
  buffer_load_dwordx4 v10, s[8:11], s36 offen offset:2048 sc1 lds
  buffer_load_dwordx4 v11, s[8:11], s36 offen offset:3072 sc1 lds
  s_add_u32 m0, s38, s46
  s_nop 0
  buffer_load_dwordx4 v13, s[12:15], s37 offen offset:0  lds
  buffer_load_dwordx4 v14, s[12:15], s37 offen offset:1024  lds
  s_add_u32 m0, s38, s47
  s_nop 0
  buffer_load_dwordx4 v15, s[12:15], s37 offen offset:0  lds
  buffer_load_dwordx4 v16, s[12:15], s37 offen offset:1024  lds
  s_add_u32 m0, s38, s48
  s_nop 0
  buffer_load_dwordx4 v17, s[12:15], s37 offen offset:0  lds
  buffer_load_dwordx4 v18, s[12:15], s37 offen offset:1024  lds
  s_add_u32 s38, s38, 43008
  s_cmp_eq_u32 s38, 129024
  s_cselect_b32 s38, 0, s38
L_jA:
  s_nop 1
  s_waitcnt vmcnt(11)
  s_barrier
  s_add_u32 s30, s30, 1
  s_and_b32 s30, s30, 7
  s_cselect_b32 s32, 0, 1
  s_add_u32 s31, s31, s32
  s_sub_u32 s32, s30, s7
  s_and_b32 s32, s32, 7
  s_cmp_lt_u32 s32, 2
  s_cselect_b32 s32, 1, 0
  s_add_u32 s32, s32, s31
  s_cmp_ge_u32 s32, 2
  s_cselect_b32 s32, 0, s32
  s_lshl_b32 s33, s32, 3
  s_add_u32 s33, s33, s30
  s_mul_i32 s36, s33, 128
  s_add_u32 s36, s36, s34
  s_mul_i32 s37, s33, 393216
  s_add_u32 s37, s37, s35
  s_add_u32 m0, s38, s45
  s_mov_b64 exec, s[52:53]
  buffer_load_dwordx4 v12, s[8:11], s36 offen offset:0 sc1 lds
  s_mov_b64 exec, -1
  s_add_u32 m0, s38, s44
  s_nop 0
  buffer_load_dwordx4 v8, s[8:11], s36 offen offset:0 sc1 lds
  buffer_load_dwordx4 v9, s[8:11], s36 offen offset:1024 sc1 lds
  buffer_load_dwordx4 v10, s[8:11], s36 offen offset:2048 sc1 lds
  buffer_load_dwordx4 v11, s[8:11], s36 offen offset:3072 sc1 lds
  s_add_u32 m0, s38, s46
  s_nop 0
  buffer_load_dwordx4 v13, s[12:15], s37 offen offset:0  lds
  buffer_load_dwordx4 v14, s[12:15], s37 offen offset:1024  lds
  s_add_u32 m0, s38, s47
  s_nop 0
  buffer_load_dwordx4 v15, s[12:15], s37 offen offset:0  lds
  buffer_load_dwordx4 v16, s[12:15], s37 offen offset:1024  lds
  s_add_u32 m0, s38, s48
  s_nop 0
  buffer_load_dwordx4 v17, s[12:15], s37 offen offset:0  lds
  buffer_load_dwordx4 v18, s[12:15], s37 offen offset:1024  lds
  s_add_u32 s38, s38, 43008
  s_cmp_eq_u32 s38, 129024
  s_cselect_b32 s38, 0, s38
  s_waitcnt vmcnt(11)
  s_barrier
  s_add_u32 s30, s30, 1
  s_and_b32 s30, s30, 7
  s_cselect_b32 s32, 0, 1
  s_add_u32 s31, s31, s32
  s_sub_u32 s32, s30, s7
  s_and_b32 s32, s32, 7
  s_cmp_lt_u32 s32, 2
  s_cselect_b32 s32, 1, 0
  s_add_u32 s32, s32, s31
  s_cmp_ge_u32 s32, 2
  s_cselect_b32 s32, 0, s32
  s_lshl_b32 s33, s32, 3
  s_add_u32 s33, s33, s30
  s_mul_i32 s36, s33, 128
  s_add_u32 s36, s36, s34
  s_mul_i32 s37, s33, 393216
  s_add_u32 s37, s37, s35
  s_add_u32 m0, s38, s45
  s_mov_b64 exec, s[52:53]
  buffer_load_dwordx4 v12, s[8:11], s36 offen offset:0 sc1 lds
  s_mov_b64 exec, -1
  s_add_u32 m0, s38, s44
  s_nop 0
  buffer_load_dwordx4 v8, s[8:11], s36 offen offset:0 sc1 lds
  buffer_load_dwordx4 v9, s[8:11], s36 offen offset:1024 sc1 lds
  buffer_load_dwordx4 v10, s[8:11], s36 offen offset:2048 sc1 lds
  buffer_load_dwordx4 v11, s[8:11], s36 offen offset:3072 sc1 lds
  s_add_u32 m0, s38, s46
  s_nop 0
  buffer_load_dwordx4 v13, s[12:15], s37 offen offset:0  lds
  buffer_load_dwordx4 v14, s[12:15], s37 offen offset:1024  lds
  s_add_u32 m0, s38, s47
  s_nop 0
  buffer_load_dwordx4 v15, s[12:15], s37 offen offset:0  lds
  buffer_load_dwordx4 v16, s[12:15], s37 offen offset:1024  lds
  s_add_u32 m0, s38, s48
  s_nop 0
  buffer_load_dwordx4 v17, s[12:15], s37 offen offset:0  lds
  buffer_load_dwordx4 v18, s[12:15], s37 offen offset:1024  lds
  s_add_u32 s38, s38, 43008
  s_cmp_eq_u32 s38, 129024
  s_cselect_b32 s38, 0, s38
  s_cmp_lg_u32 s3, 0
  s_cbranch_scc1 e7
  s_cmp_lg_u32 s57, 0
  s_cbranch_scc1 g8
  s_mov_b64 exec, 1
  global_atomic_add v73, v74, s[62:63] sc1
  s_mov_b64 exec, -1
g8:
e7:
  s_nop 1
  s_mov_b32 s39, 9
ll9:
  s_waitcnt vmcnt(11)
  s_barrier
  s_add_u32 s30, s30, 1
  s_and_b32 s30, s30, 7
  s_cselect_b32 s32, 0, 1
  s_add_u32 s31, s31, s32
  s_sub_u32 s32, s30, s7
  s_and_b32 s32, s32, 7
  s_cmp_lt_u32 s32, 2
  s_cselect_b32 s32, 1, 0
  s_add_u32 s32, s32, s31
  s_cmp_ge_u32 s32, 2
  s_cselect_b32 s32, 0, s32
  s_lshl_b32 s33, s32, 3
  s_add_u32 s33, s33, s30
  s_mul_i32 s36, s33, 128
  s_add_u32 s36, s36, s34
  s_mul_i32 s37, s33, 393216
  s_add_u32 s37, s37, s35
  s_add_u32 m0, s38, s45
  s_mov_b64 exec, s[52:53]
  buffer_load_dwordx4 v12, s[8:11], s36 offen offset:0 sc1 lds
  s_mov_b64 exec, -1
  s_add_u32 m0, s38, s44
  s_nop 0
  buffer_load_dwordx4 v8, s[8:11], s36 offen offset:0 sc1 lds
  buffer_load_dwordx4 v9, s[8:11], s36 offen offset:1024 sc1 lds
  buffer_load_dwordx4 v10, s[8:11], s36 offen offset:2048 sc1 lds
  buffer_load_dwordx4 v11, s[8:11], s36 offen offset:3072 sc1 lds
  s_add_u32 m0, s38, s46
  s_nop 0
  buffer_load_dwordx4 v13, s[12:15], s37 offen offset:0  lds
  buffer_load_dwordx4 v14, s[12:15], s37 offen offset:1024  lds
  s_add_u32 m0, s38, s47
  s_nop 0
  buffer_load_dwordx4 v15, s[12:15], s37 offen offset:0  lds
  buffer_load_dwordx4 v16, s[12:15], s37 offen offset:1024  lds
  s_add_u32 m0, s38, s48
  s_nop 0
  buffer_load_dwordx4 v17, s[12:15], s37 offen offset:0  lds
  buffer_load_dwordx4 v18, s[12:15], s37 offen offset:1024  lds
  s_add_u32 s38, s38, 43008
  s_cmp_eq_u32 s38, 129024
  s_cselect_b32 s38, 0, s38
  s_sub_u32 s39, s39, 1
  s_cmp_lg_u32 s39, 0
  s_cbranch_scc1 ll9
  s_waitcnt vmcnt(11)
  s_barrier
  s_add_u32 s30, s30, 1
  s_and_b32 s30, s30, 7
  s_cselect_b32 s32, 0, 1
  s_add_u32 s31, s31, s32
  s_sub_u32 s32, s30, s7
  s_and_b32 s32, s32, 7
  s_cmp_lt_u32 s32, 2
  s_cselect_b32 s32, 1, 0
  s_add_u32 s32, s32, s31
  s_cmp_ge_u32 s32, 2
  s_cselect_b32 s32, 0, s32
  s_lshl_b32 s33, s32, 3
  s_add_u32 s33, s33, s30
  s_mul_i32 s36, s33, 128
  s_add_u32 s36, s36, s34
  s_mul_i32 s37, s33, 393216
  s_add_u32 s37, s37, s35
  s_add_u32 m0, s38, s45
  s_mov_b64 exec, s[52:53]
  buffer_load_dwordx4 v12, s[8:11], s36 offen offset:0 sc1 lds
  s_mov_b64 exec, -1
  s_add_u32 m0, s38, s44
  s_nop 0
  buffer_load_dwordx4 v8, s[8:11], s36 offen offset:0 sc1 lds
  buffer_load_dwordx4 v9, s[8:11], s36 offen offset:1024 sc1 lds
  buffer_load_dwordx4 v10, s[8:11], s36 offen offset:2048 sc1 lds
  buffer_load_dwordx4 v11, s[8:11], s36 offen offset:3072 sc1 lds
  s_add_u32 m0, s38, s46
  s_nop 0
  buffer_load_dwordx4 v13, s[12:15], s37 offen offset:0  lds
  buffer_load_dwordx4 v14, s[12:15], s37 offen offset:1024  lds
  s_add_u32 m0, s38, s47
  s_nop 0
  buffer_load_dwordx4 v15, s[12:15], s37 offen offset:0  lds
  buffer_load_dwordx4 v16, s[12:15], s37 offen offset:1024  lds
  s_add_u32 m0, s38, s48
  s_nop 0
  buffer_load_dwordx4 v17, s[12:15], s37 offen offset:0  lds
  buffer_load_dwordx4 v18, s[12:15], s37 offen offset:1024  lds
  s_add_u32 s38, s38, 43008
  s_cmp_eq_u32 s38, 129024
  s_cselect_b32 s38, 0, s38
  global_load_dword v29, v134, s[62:63] sc0 sc1
  s_waitcnt vmcnt(11)
  s_barrier
  s_add_u32 s30, s30, 1
  s_and_b32 s30, s30, 7
  s_cselect_b32 s32, 0, 1
  s_add_u32 s31, s31, s32
  s_sub_u32 s32, s30, s7
  s_and_b32 s32, s32, 7
  s_cmp_lt_u32 s32, 2
  s_cselect_b32 s32, 1, 0
  s_add_u32 s32, s32, s31
  s_cmp_ge_u32 s32, 2
  s_cselect_b32 s32, 0, s32
  s_lshl_b32 s33, s32, 3
  s_add_u32 s33, s33, s30
  s_mul_i32 s36, s33, 128
  s_add_u32 s36, s36, s34
  s_mul_i32 s37, s33, 393216
  s_add_u32 s37, s37, s35
  s_add_u32 m0, s38, s45
  s_mov_b64 exec, s[52:53]
  buffer_load_dwordx4 v12, s[8:11], s36 offen offset:0 sc1 lds
  s_mov_b64 exec, -1
  s_add_u32 m0, s38, s44
  s_nop 0
  buffer_load_dwordx4 v8, s[8:11], s36 offen offset:0 sc1 lds
  buffer_load_dwordx4 v9, s[8:11], s36 offen offset:1024 sc1 lds
  buffer_load_dwordx4 v10, s[8:11], s36 offen offset:2048 sc1 lds
  buffer_load_dwordx4 v11, s[8:11], s36 offen offset:3072 sc1 lds
  s_add_u32 m0, s38, s46
  s_nop 0
  buffer_load_dwordx4 v13, s[12:15], s37 offen offset:0  lds
  buffer_load_dwordx4 v14, s[12:15], s37 offen offset:1024  lds
  s_add_u32 m0, s38, s47
  s_nop 0
  buffer_load_dwordx4 v15, s[12:15], s37 offen offset:0  lds
  buffer_load_dwordx4 v16, s[12:15], s37 offen offset:1024  lds
  s_add_u32 m0, s38, s48
  s_nop 0
  buffer_load_dwordx4 v17, s[12:15], s37 offen offset:0  lds
  buffer_load_dwordx4 v18, s[12:15], s37 offen offset:1024  lds
  s_add_u32 s38, s38, 43008
  s_cmp_eq_u32 s38, 129024
  s_cselect_b32 s38, 0, s38
  s_cmp_lg_u32 s3, 0
  s_cbranch_scc1 st10g
  s_waitcnt vmcnt(11)
  s_mov_b32 s61, 0
st10p:
  v_cmp_gt_u32 vcc, 64, v29
  s_add_u32 s61, s61, 1
  s_cmp_gt_u32 s61, 1000000
  s_cbranch_scc1 st10g
  s_cbranch_vccz st10g
  global_load_dword v29, v134, s[62:63] sc0 sc1
  s_waitcnt vmcnt(0)
  s_branch st10p
st10g:
  buffer_load_dwordx2 v[30:31], v27, s[20:23], 0 offen sc1
  s_mov_b32 s32, 16384
  buffer_load_dwordx2 v[32:33], v27, s[20:23], s32 offen sc1
  s_mov_b32 s32, 32768
  buffer_load_dwordx2 v[34:35], v27, s[20:23], s32 offen sc1
  s_mov_b32 s32, 49152
  buffer_load_dwordx2 v[36:37], v27, s[20:23], s32 offen sc1
  s_mov_b32 s32, 65536
  buffer_load_dwordx2 v[38:39], v27, s[20:23], s32 offen sc1
  s_mov_b32 s32, 81920
  buffer_load_dwordx2 v[40:41], v27, s[20:23], s32 offen sc1
  s_mov_b32 s32, 98304
  buffer_load_dwordx2 v[42:43], v27, s[20:23], s32 offen sc1
  s_mov_b32 s32, 114688
  buffer_load_dwordx2 v[44:45], v27, s[20:23], s32 offen sc1
  s_waitcnt vmcnt(19)
  s_barrier
  s_branch L_k1t
L_k1B:
  s_nop 7
  s_nop 7
  s_mov_b32 s30, 7
  s_mov_b32 s31, -1
  s_mov_b32 s38, 0
  s_add_u32 s30, s30, 1
  s_and_b32 s30, s30, 7
  s_cselect_b32 s32, 0, 1
  s_add_u32 s31, s31, s32
  s_sub_u32 s32, s30, s7
  s_and_b32 s32, s32, 7
  s_cmp_lt_u32 s32, 2
  s_cselect_b32 s32, 1, 0
  s_add_u32 s32, s32, s31
  s_cmp_ge_u32 s32, 2
  s_cselect_b32 s32, 0, s32
  s_lshl_b32 s33, s32, 3
  s_add_u32 s33, s33, s30
  s_mul_i32 s36, s33, 128
  s_add_u32 s36, s36, s34
  s_add_u32 m0, s38, s44
  s_nop 0
  buffer_load_dwordx4 v8, s[8:11], s36 offen offset:0 sc1 lds
  buffer_load_dwordx4 v9, s[8:11], s36 offen offset:1024 sc1 lds
  buffer_load_dwordx4 v10, s[8:11], s36 offen offset:2048 sc1 lds
  buffer_load_dwordx4 v11, s[8:11], s36 offen offset:3072 sc1 lds
  s_add_u32 s38, s38, 43008
  s_cmp_eq_u32 s38, 129024
  s_cselect_b32 s38, 0, s38
  s_add_u32 s30, s30, 1
  s_and_b32 s30, s30, 7
  s_cselect_b32 s32, 0, 1
  s_add_u32 s31, s31, s32
  s_sub_u32 s32, s30, s7
  s_and_b32 s32, s32, 7
  s_cmp_lt_u32 s32, 2
  s_cselect_b32 s32, 1, 0
  s_add_u32 s32, s32, s31
  s_cmp_ge_u32 s32, 2
  s_cselect_b32 s32, 0, s32
  s_lshl_b32 s33, s32, 3
  s_add_u32 s33, s33, s30
  s_mul_i32 s36, s33, 128
  s_add_u32 s36, s36, s34
  s_add_u32 m0, s38, s44
  s_nop 0
  buffer_load_dwordx4 v8, s[8:11], s36 offen offset:0 sc1 lds
  buffer_load_dwordx4 v9, s[8:11], s36 offen offset:1024 sc1 lds
  buffer_load_dwordx4 v10, s[8:11], s36 offen offset:2048 sc1 lds
  buffer_load_dwordx4 v11, s[8:11], s36 offen offset:3072 sc1 lds
  s_add_u32 s38, s38, 43008
  s_cmp_eq_u32 s38, 129024
  s_cselect_b32 s38, 0, s38
  s_waitcnt vmcnt(4)
  s_barrier
  s_add_u32 s30, s30, 1
  s_and_b32 s30, s30, 7
  s_cselect_b32 s32, 0, 1
  s_add_u32 s31, s31, s32
  s_sub_u32 s32, s30, s7
  s_and_b32 s32, s32, 7
  s_cmp_lt_u32 s32, 2
  s_cselect_b32 s32, 1, 0
  s_add_u32 s32, s32, s31
  s_cmp_ge_u32 s32, 2
  s_cselect_b32 s32, 0, s32
  s_lshl_b32 s33, s32, 3
  s_add_u32 s33, s33, s30
  s_mul_i32 s36, s33, 128
  s_add_u32 s36, s36, s34
  s_mul_i32 s37, s33, 393216
  s_add_u32 s37, s37, s35
  s_add_u32 m0, s38, s44
  s_nop 0
  buffer_load_dwordx4 v8, s[8:11], s36 offen offset:0 sc1 lds
  buffer_load_dwordx4 v9, s[8:11], s36 offen offset:1024 sc1 lds
  buffer_load_dwordx4 v10, s[8:11], s36 offen offset:2048 sc1 lds
  buffer_load_dwordx4 v11, s[8:11], s36 offen offset:3072 sc1 lds
  s_add_u32 m0, s38, s46
  s_nop 0
  buffer_load_dwordx4 v13, s[12:15], s37 offen offset:0  lds
  buffer_load_dwordx4 v14, s[12:15], s37 offen offset:1024  lds
  s_add_u32 m0, s38, s47
  s_nop 0
  buffer_load_dwordx4 v15, s[12:15], s37 offen offset:0  lds
  buffer_load_dwordx4 v16, s[12:15], s37 offen offset:1024  lds
  s_add_u32 m0, s38, s48
  s_nop 0
  buffer_load_dwordx4 v17, s[12:15], s37 offen offset:0  lds
  buffer_load_dwordx4 v18, s[12:15], s37 offen offset:1024  lds
  s_add_u32 s38, s38, 43008
  s_cmp_eq_u32 s38, 129024
  s_cselect_b32 s38, 0, s38
L_jB:
  s_nop 1
  s_waitcnt vmcnt(10)
  s_barrier
  s_add_u32 s30, s30, 1
  s_and_b32 s30, s30, 7
  s_cselect_b32 s32, 0, 1
  s_add_u32 s31, s31, s32
  s_sub_u32 s32, s30, s7
  s_and_b32 s32, s32, 7
  s_cmp_lt_u32 s32, 2
  s_cselect_b32 s32, 1, 0
  s_add_u32 s32, s32, s31
  s_cmp_ge_u32 s32, 2
  s_cselect_b32 s32, 0, s32
  s_lshl_b32 s33, s32, 3
  s_add_u32 s33, s33, s30
  s_mul_i32 s36, s33, 128
  s_add_u32 s36, s36, s34
  s_mul_i32 s37, s33, 393216
  s_add_u32 s37, s37, s35
  s_add_u32 m0, s38, s44
  s_nop 0
  buffer_load_dwordx4 v8, s[8:11], s36 offen offset:0 sc1 lds
  buffer_load_dwordx4 v9, s[8:11], s36 offen offset:1024 sc1 lds
  buffer_load_dwordx4 v10, s[8:11], s36 offen offset:2048 sc1 lds
  buffer_load_dwordx4 v11, s[8:11], s36 offen offset:3072 sc1 lds
  s_add_u32 m0, s38, s46
  s_nop 0
  buffer_load_dwordx4 v13, s[12:15], s37 offen offset:0  lds
  buffer_load_dwordx4 v14, s[12:15], s37 offen offset:1024  lds
  s_add_u32 m0, s38, s47
  s_nop 0
  buffer_load_dwordx4 v15, s[12:15], s37 offen offset:0  lds
  buffer_load_dwordx4 v16, s[12:15], s37 offen offset:1024  lds
  s_add_u32 m0, s38, s48
  s_nop 0
  buffer_load_dwordx4 v17, s[12:15], s37 offen offset:0  lds
  buffer_load_dwordx4 v18, s[12:15], s37 offen offset:1024  lds
  s_add_u32 s38, s38, 43008
  s_cmp_eq_u32 s38, 129024
  s_cselect_b32 s38, 0, s38
  s_waitcnt vmcnt(10)
  s_barrier
  s_add_u32 s30, s30, 1
  s_and_b32 s30, s30, 7
  s_cselect_b32 s32, 0, 1
  s_add_u32 s31, s31, s32
  s_sub_u32 s32, s30, s7
  s_and_b32 s32, s32, 7
  s_cmp_lt_u32 s32, 2
  s_cselect_b32 s32, 1, 0
  s_add_u32 s32, s32, s31
  s_cmp_ge_u32 s32, 2
  s_cselect_b32 s32, 0, s32
  s_lshl_b32 s33, s32, 3
  s_add_u32 s33, s33, s30
  s_mul_i32 s36, s33, 128
  s_add_u32 s36, s36, s34
  s_mul_i32 s37, s33, 393216
  s_add_u32 s37, s37, s35
  s_add_u32 m0, s38, s44
  s_nop 0
  buffer_load_dwordx4 v8, s[8:11], s36 offen offset:0 sc1 lds
  buffer_load_dwordx4 v9, s[8:11], s36 offen offset:1024 sc1 lds
  buffer_load_dwordx4 v10, s[8:11], s36 offen offset:2048 sc1 lds
  buffer_load_dwordx4 v11, s[8:11], s36 offen offset:3072 sc1 lds
  s_add_u32 m0, s38, s46
  s_nop 0
  buffer_load_dwordx4 v13, s[12:15], s37 offen offset:0  lds
  buffer_load_dwordx4 v14, s[12:15], s37 offen offset:1024  lds
  s_add_u32 m0, s38, s47
  s_nop 0
  buffer_load_dwordx4 v15, s[12:15], s37 offen offset:0  lds
  buffer_load_dwordx4 v16, s[12:15], s37 offen offset:1024  lds
  s_add_u32 m0, s38, s48
  s_nop 0
  buffer_load_dwordx4 v17, s[12:15], s37 offen offset:0  lds
  buffer_load_dwordx4 v18, s[12:15], s37 offen offset:1024  lds
  s_add_u32 s38, s38, 43008
  s_cmp_eq_u32 s38, 129024
  s_cselect_b32 s38, 0, s38
  s_cmp_lg_u32 s3, 0
  s_cbranch_scc1 e11
  s_cmp_lg_u32 s57, 0
  s_cbranch_scc1 g12
  s_mov_b64 exec, 1
  global_atomic_add v73, v74, s[62:63] sc1
  s_mov_b64 exec, -1
g12:
e11:
  s_nop 1
  s_mov_b32 s39, 9
ll13:
  s_waitcnt vmcnt(10)
  s_barrier
  s_add_u32 s30, s30, 1
  s_and_b32 s30, s30, 7
  s_cselect_b32 s32, 0, 1
  s_add_u32 s31, s31, s32
  s_sub_u32 s32, s30, s7
  s_and_b32 s32, s32, 7
  s_cmp_lt_u32 s32, 2
  s_cselect_b32 s32, 1, 0
  s_add_u32 s32, s32, s31
  s_cmp_ge_u32 s32, 2
  s_cselect_b32 s32, 0, s32
  s_lshl_b32 s33, s32, 3
  s_add_u32 s33, s33, s30
  s_mul_i32 s36, s33, 128
  s_add_u32 s36, s36, s34
  s_mul_i32 s37, s33, 393216
  s_add_u32 s37, s37, s35
  s_add_u32 m0, s38, s44
  s_nop 0
  buffer_load_dwordx4 v8, s[8:11], s36 offen offset:0 sc1 lds
  buffer_load_dwordx4 v9, s[8:11], s36 offen offset:1024 sc1 lds
  buffer_load_dwordx4 v10, s[8:11], s36 offen offset:2048 sc1 lds
  buffer_load_dwordx4 v11, s[8:11], s36 offen offset:3072 sc1 lds
  s_add_u32 m0, s38, s46
  s_nop 0
  buffer_load_dwordx4 v13, s[12:15], s37 offen offset:0  lds
  buffer_load_dwordx4 v14, s[12:15], s37 offen offset:1024  lds
  s_add_u32 m0, s38, s47
  s_nop 0
  buffer_load_dwordx4 v15, s[12:15], s37 offen offset:0  lds
  buffer_load_dwordx4 v16, s[12:15], s37 offen offset:1024  lds
  s_add_u32 m0, s38, s48
  s_nop 0
  buffer_load_dwordx4 v17, s[12:15], s37 offen offset:0  lds
  buffer_load_dwordx4 v18, s[12:15], s37 offen offset:1024  lds
  s_add_u32 s38, s38, 43008
  s_cmp_eq_u32 s38, 129024
  s_cselect_b32 s38, 0, s38
  s_sub_u32 s39, s39, 1
  s_cmp_lg_u32 s39, 0
  s_cbranch_scc1 ll13
  s_waitcnt vmcnt(10)
  s_barrier
  s_add_u32 s30, s30, 1
  s_and_b32 s30, s30, 7
  s_cselect_b32 s32, 0, 1
  s_add_u32 s31, s31, s32
  s_sub_u32 s32, s30, s7
  s_and_b32 s32, s32, 7
  s_cmp_lt_u32 s32, 2
  s_cselect_b32 s32, 1, 0
  s_add_u32 s32, s32, s31
  s_cmp_ge_u32 s32, 2
  s_cselect_b32 s32, 0, s32
  s_lshl_b32 s33, s32, 3
  s_add_u32 s33, s33, s30
  s_mul_i32 s36, s33, 128
  s_add_u32 s36, s36, s34
  s_mul_i32 s37, s33, 393216
  s_add_u32 s37, s37, s35
  s_add_u32 m0, s38, s44
  s_nop 0
  buffer_load_dwordx4 v8, s[8:11], s36 offen offset:0 sc1 lds
  buffer_load_dwordx4 v9, s[8:11], s36 offen offset:1024 sc1 lds
  buffer_load_dwordx4 v10, s[8:11], s36 offen offset:2048 sc1 lds
  buffer_load_dwordx4 v11, s[8:11], s36 offen offset:3072 sc1 lds
  s_add_u32 m0, s38, s46
  s_nop 0
  buffer_load_dwordx4 v13, s[12:15], s37 offen offset:0  lds
  buffer_load_dwordx4 v14, s[12:15], s37 offen offset:1024  lds
  s_add_u32 m0, s38, s47
  s_nop 0
  buffer_load_dwordx4 v15, s[12:15], s37 offen offset:0  lds
  buffer_load_dwordx4 v16, s[12:15], s37 offen offset:1024  lds
  s_add_u32 m0, s38, s48
  s_nop 0
  buffer_load_dwordx4 v17, s[12:15], s37 offen offset:0  lds
  buffer_load_dwordx4 v18, s[12:15], s37 offen offset:1024  lds
  s_add_u32 s38, s38, 43008
  s_cmp_eq_u32 s38, 129024
  s_cselect_b32 s38, 0, s38
  global_load_dword v29, v134, s[62:63] sc0 sc1
  s_waitcnt vmcnt(10)
  s_barrier
  s_add_u32 s30, s30, 1
  s_and_b32 s30, s30, 7
  s_cselect_b32 s32, 0, 1
  s_add_u32 s31, s31, s32
  s_sub_u32 s32, s30, s7
  s_and_b32 s32, s32, 7
  s_cmp_lt_u32 s32, 2
  s_cselect_b32 s32, 1, 0
  s_add_u32 s32, s32, s31
  s_cmp_ge_u32 s32, 2
  s_cselect_b32 s32, 0, s32
  s_lshl_b32 s33, s32, 3
  s_add_u32 s33, s33, s30
  s_mul_i32 s36, s33, 128
  s_add_u32 s36, s36, s34
  s_mul_i32 s37, s33, 393216
  s_add_u32 s37, s37, s35
  s_add_u32 m0, s38, s44
  s_nop 0
  buffer_load_dwordx4 v8, s[8:11], s36 offen offset:0 sc1 lds
  buffer_load_dwordx4 v9, s[8:11], s36 offen offset:1024 sc1 lds
  buffer_load_dwordx4 v10, s[8:11], s36 offen offset:2048 sc1 lds
  buffer_load_dwordx4 v11, s[8:11], s36 offen offset:3072 sc1 lds
  s_add_u32 m0, s38, s46
  s_nop 0
  buffer_load_dwordx4 v13, s[12:15], s37 offen offset:0  lds
  buffer_load_dwordx4 v14, s[12:15], s37 offen offset:1024  lds
  s_add_u32 m0, s38, s47
  s_nop 0
  buffer_load_dwordx4 v15, s[12:15], s37 offen offset:0  lds
  buffer_load_dwordx4 v16, s[12:15], s37 offen offset:1024  lds
  s_add_u32 m0, s38, s48
  s_nop 0
  buffer_load_dwordx4 v17, s[12:15], s37 offen offset:0  lds
  buffer_load_dwordx4 v18, s[12:15], s37 offen offset:1024  lds
  s_add_u32 s38, s38, 43008
  s_cmp_eq_u32 s38, 129024
  s_cselect_b32 s38, 0, s38
  s_cmp_lg_u32 s3, 0
  s_cbranch_scc1 st14g
  s_waitcnt vmcnt(10)
  s_mov_b32 s61, 0
st14p:
  v_cmp_gt_u32 vcc, 64, v29
  s_add_u32 s61, s61, 1
  s_cmp_gt_u32 s61, 1000000
  s_cbranch_scc1 st14g
  s_cbranch_vccz st14g
  global_load_dword v29, v134, s[62:63] sc0 sc1
  s_waitcnt vmcnt(0)
  s_branch st14p
st14g:
  buffer_load_dwordx2 v[30:31], v27, s[20:23], 0 offen sc1
  s_mov_b32 s32, 16384
  buffer_load_dwordx2 v[32:33], v27, s[20:23], s32 offen sc1
  s_mov_b32 s32, 32768
  buffer_load_dwordx2 v[34:35], v27, s[20:23], s32 offen sc1
  s_mov_b32 s32, 49152
  buffer_load_dwordx2 v[36:37], v27, s[20:23], s32 offen sc1
  s_mov_b32 s32, 65536
  buffer_load_dwordx2 v[38:39], v27, s[20:23], s32 offen sc1
  s_mov_b32 s32, 81920
  buffer_load_dwordx2 v[40:41], v27, s[20:23], s32 offen sc1
  s_mov_b32 s32, 98304
  buffer_load_dwordx2 v[42:43], v27, s[20:23], s32 offen sc1
  s_mov_b32 s32, 114688
  buffer_load_dwordx2 v[44:45], v27, s[20:23], s32 offen sc1
  s_waitcnt vmcnt(18)
  s_barrier
  s_branch L_k1t
L_first:
  s_nop 7
  s_nop 7
  s_cmp_ge_u32 s57, 2
  s_cbranch_scc1 L_firstB
  s_add_u32 s30, s30, 1
  s_and_b32 s30, s30, 7
  s_cselect_b32 s32, 0, 1
  s_add_u32 s31, s31, s32
  s_sub_u32 s32, s30, s7
  s_and_b32 s32, s32, 7
  s_cmp_lt_u32 s32, 2
  s_cselect_b32 s32, 1, 0
  s_add_u32 s32, s32, s31
  s_cmp_ge_u32 s32, 2
  s_cselect_b32 s32, 0, s32
  s_lshl_b32 s33, s32, 3
  s_add_u32 s33, s33, s30
  s_mul_i32 s36, s33, 128
  s_add_u32 s36, s36, s34
  s_mul_i32 s37, s33, 393216
  s_add_u32 s37, s37, s35
  s_add_u32 m0, s38, s45
  s_mov_b64 exec, s[52:53]
  buffer_load_dwordx4 v12, s[8:11], s36 offen offset:0 sc1 lds
  s_mov_b64 exec, -1
  s_add_u32 m0, s38, s44
  s_nop 0
  buffer_load_dwordx4 v8, s[8:11], s36 offen offset:0 sc1 lds
  buffer_load_dwordx4 v9, s[8:11], s36 offen offset:1024 sc1 lds
  buffer_load_dwordx4 v10, s[8:11], s36 offen offset:2048 sc1 lds
  buffer_load_dwordx4 v11, s[8:11], s36 offen offset:3072 sc1 lds
  s_add_u32 m0, s38, s46
  s_nop 0
  buffer_load_dwordx4 v13, s[12:15], s37 offen offset:0  lds
  buffer_load_dwordx4 v14, s[12:15], s37 offen offset:1024  lds
  s_add_u32 m0, s38, s47
  s_nop 0
  buffer_load_dwordx4 v15, s[12:15], s37 offen offset:0  lds
  buffer_load_dwordx4 v16, s[12:15], s37 offen offset:1024  lds
  s_add_u32 m0, s38, s48
  s_nop 0
  buffer_load_dwordx4 v17, s[12:15], s37 offen offset:0  lds
  buffer_load_dwordx4 v18, s[12:15], s37 offen offset:1024  lds
  s_add_u32 s38, s38, 43008
  s_cmp_eq_u32 s38, 129024
  s_cselect_b32 s38, 0, s38
  s_mov_b32 s16, s84
  s_mov_b32 s17, s85
  s_mov_b32 s18, 67108864
  s_mov_b32 s19, 0x20000
  s_add_u32 s20, s84, 22020096
  s_addc_u32 s21, s85, 0
  s_mov_b32 s22, 16384
  s_mov_b32 s23, 0x20000
  s_mov_b32 s82, s84
  s_mov_b32 s83, s85
  s_add_u32 s30, s30, 1
  s_and_b32 s30, s30, 7
  s_cselect_b32 s32, 0, 1
  s_add_u32 s31, s31, s32
  s_sub_u32 s32, s30, s7
  s_and_b32 s32, s32, 7
  s_cmp_lt_u32 s32, 2
  s_cselect_b32 s32, 1, 0
  s_add_u32 s32, s32, s31
  s_cmp_ge_u32 s32, 2
  s_cselect_b32 s32, 0, s32
  s_lshl_b32 s33, s32, 3
  s_add_u32 s33, s33, s30
  s_mul_i32 s36, s33, 128
  s_add_u32 s36, s36, s34
  s_mul_i32 s37, s33, 393216
  s_add_u32 s37, s37, s35
  s_add_u32 m0, s38, s45
  s_mov_b64 exec, s[52:53]
  buffer_load_dwordx4 v12, s[8:11], s36 offen offset:0 sc1 lds
  s_mov_b64 exec, -1
  s_add_u32 m0, s38, s44
  s_nop 0
  buffer_load_dwordx4 v8, s[8:11], s36 offen offset:0 sc1 lds
  buffer_load_dwordx4 v9, s[8:11], s36 offen offset:1024 sc1 lds
  buffer_load_dwordx4 v10, s[8:11], s36 offen offset:2048 sc1 lds
  buffer_load_dwordx4 v11, s[8:11], s36 offen offset:3072 sc1 lds
  s_add_u32 m0, s38, s46
  s_nop 0
  buffer_load_dwordx4 v13, s[12:15], s37 offen offset:0  lds
  buffer_load_dwordx4 v14, s[12:15], s37 offen offset:1024  lds
  s_add_u32 m0, s38, s47
  s_nop 0
  buffer_load_dwordx4 v15, s[12:15], s37 offen offset:0  lds
  buffer_load_dwordx4 v16, s[12:15], s37 offen offset:1024  lds
  s_add_u32 m0, s38, s48
  s_nop 0
  buffer_load_dwordx4 v17, s[12:15], s37 offen offset:0  lds
  buffer_load_dwordx4 v18, s[12:15], s37 offen offset:1024  lds
  s_add_u32 s38, s38, 43008
  s_cmp_eq_u32 s38, 129024
  s_cselect_b32 s38, 0, s38
  buffer_load_dwordx4 v[48:51], v46, s[8:11], 0 offen offset:0
  buffer_load_dwordx4 v[52:55], v46, s[8:11], 0 offen offset:512
  buffer_load_dwordx4 v[56:59], v46, s[8:11], 0 offen offset:1024
  buffer_load_dwordx4 v[60:63], v46, s[8:11], 0 offen offset:1536
  buffer_store_dwordx4 v[64:67], v47, s[16:19], s58 offen sc0 sc1
  s_barrier
  s_waitcnt vmcnt(16)
  s_barrier
  s_add_u32 s30, s30, 1
  s_and_b32 s30, s30, 7
  s_cselect_b32 s32, 0, 1
  s_add_u32 s31, s31, s32
  s_sub_u32 s32, s30, s7
  s_and_b32 s32, s32, 7
  s_cmp_lt_u32 s32, 2
  s_cselect_b32 s32, 1, 0
  s_add_u32 s32, s32, s31
  s_cmp_ge_u32 s32, 2
  s_cselect_b32 s32, 0, s32
  s_lshl_b32 s33, s32, 3
  s_add_u32 s33, s33, s30
  s_mul_i32 s36, s33, 128
  s_add_u32 s36, s36, s34
  s_mul_i32 s37, s33, 393216
  s_add_u32 s37, s37, s35
  s_add_u32 m0, s38, s45
  s_mov_b64 exec, s[52:53]
  buffer_load_dwordx4 v12, s[8:11], s36 offen offset:0 sc1 lds
  s_mov_b64 exec, -1
  s_add_u32 m0, s38, s44
  s_nop 0
  buffer_load_dwordx4 v8, s[8:11], s36 offen offset:0 sc1 lds
  buffer_load_dwordx4 v9, s[8:11], s36 offen offset:1024 sc1 lds
  buffer_load_dwordx4 v10, s[8:11], s36 offen offset:2048 sc1 lds
  buffer_load_dwordx4 v11, s[8:11], s36 offen offset:3072 sc1 lds
  s_add_u32 m0, s38, s46
  s_nop 0
  buffer_load_dwordx4 v13, s[12:15], s37 offen offset:0  lds
  buffer_load_dwordx4 v14, s[12:15], s37 offen offset:1024  lds
  s_add_u32 m0, s38, s47
  s_nop 0
  buffer_load_dwordx4 v15, s[12:15], s37 offen offset:0  lds
  buffer_load_dwordx4 v16, s[12:15], s37 offen offset:1024  lds
  s_add_u32 m0, s38, s48
  s_nop 0
  buffer_load_dwordx4 v17, s[12:15], s37 offen offset:0  lds
  buffer_load_dwordx4 v18, s[12:15], s37 offen offset:1024  lds
  s_add_u32 s38, s38, 43008
  s_cmp_eq_u32 s38, 129024
  s_cselect_b32 s38, 0, s38
  v_mov_b32 v68, 0
  v_mov_b32 v69, 0
  v_mov_b32 v70, 0x3f803f80
  s_waitcnt vmcnt(12)
  v_dot2c_f32_bf16 v68, v70, v48
  v_dot2c_f32_bf16 v69, v48, v48
  v_dot2c_f32_bf16 v68, v70, v49
  v_dot2c_f32_bf16 v69, v49, v49
  v_dot2c_f32_bf16 v68, v70, v50
  v_dot2c_f32_bf16 v69, v50, v50
  v_dot2c_f32_bf16 v68, v70, v51
  v_dot2c_f32_bf16 v69, v51, v51
  v_dot2c_f32_bf16 v68, v70, v52
  v_dot2c_f32_bf16 v69, v52, v52
  v_dot2c_f32_bf16 v68, v70, v53
  v_dot2c_f32_bf16 v69, v53, v53
  v_dot2c_f32_bf16 v68, v70, v54
  v_dot2c_f32_bf16 v69, v54, v54
  v_dot2c_f32_bf16 v68, v70, v55
  v_dot2c_f32_bf16 v69, v55, v55
  v_dot2c_f32_bf16 v68, v70, v56
  v_dot2c_f32_bf16 v69, v56, v56
  v_dot2c_f32_bf16 v68, v70, v57
  v_dot2c_f32_bf16 v69, v57, v57
  v_dot2c_f32_bf16 v68, v70, v58
  v_dot2c_f32_bf16 v69, v58, v58
  v_dot2c_f32_bf16 v68, v70, v59
  v_dot2c_f32_bf16 v69, v59, v59
  v_dot2c_f32_bf16 v68, v70, v60
  v_dot2c_f32_bf16 v69, v60, v60
  v_dot2c_f32_bf16 v68, v70, v61
  v_dot2c_f32_bf16 v69, v61, v61
  v_dot2c_f32_bf16 v68, v70, v62
  v_dot2c_f32_bf16 v69, v62, v62
  v_dot2c_f32_bf16 v68, v70, v63
  v_dot2c_f32_bf16 v69, v63, v63
  s_nop 1
  v_add_f32_dpp v68, v68, v68 quad_perm:[1,0,3,2] row_mask:0xf bank_mask:0xf
  v_add_f32_dpp v69, v69, v69 quad_perm:[1,0,3,2] row_mask:0xf bank_mask:0xf
  s_nop 0
  v_add_f32_dpp v68, v68, v68 quad_perm:[2,3,0,1] row_mask:0xf bank_mask:0xf
  v_add_f32_dpp v69, v69, v69 quad_perm:[2,3,0,1] row_mask:0xf bank_mask:0xf
  s_nop 0
  v_add_f32_dpp v68, v68, v68 row_half_mirror row_mask:0xf bank_mask:0xf
  v_add_f32_dpp v69, v69, v69 row_half_mirror row_mask:0xf bank_mask:0xf
  s_nop 0
  v_add_f32_dpp v68, v68, v68 row_mirror row_mask:0xf bank_mask:0xf
  v_add_f32_dpp v69, v69, v69 row_mirror row_mask:0xf bank_mask:0xf
  v_mov_b32 v70, v68
  v_mov_b32 v71, v69
  s_nop 0
  v_permlane16_swap_b32 v68, v70
  v_permlane16_swap_b32 v69, v71
  v_add_f32 v68, v68, v70
  v_add_f32 v69, v69, v71
  s_mov_b32 exec_lo, 1
  s_mov_b32 exec_hi, 1
  buffer_store_dwordx2 v[68:69], v72, s[16:19], 0 offen sc0 sc1
  s_mov_b64 exec, -1
  s_branch L_jA
L_firstB:
  s_nop 7
  s_nop 7
  s_add_u32 s30, s30, 1
  s_and_b32 s30, s30, 7
  s_cselect_b32 s32, 0, 1
  s_add_u32 s31, s31, s32
  s_sub_u32 s32, s30, s7
  s_and_b32 s32, s32, 7
  s_cmp_lt_u32 s32, 2
  s_cselect_b32 s32, 1, 0
  s_add_u32 s32, s32, s31
  s_cmp_ge_u32 s32, 2
  s_cselect_b32 s32, 0, s32
  s_lshl_b32 s33, s32, 3
  s_add_u32 s33, s33, s30
  s_mul_i32 s36, s33, 128
  s_add_u32 s36, s36, s34
  s_mul_i32 s37, s33, 393216
  s_add_u32 s37, s37, s35
  s_add_u32 m0, s38, s44
  s_nop 0
  buffer_load_dwordx4 v8, s[8:11], s36 offen offset:0 sc1 lds
  buffer_load_dwordx4 v9, s[8:11], s36 offen offset:1024 sc1 lds
  buffer_load_dwordx4 v10, s[8:11], s36 offen offset:2048 sc1 lds
  buffer_load_dwordx4 v11, s[8:11], s36 offen offset:3072 sc1 lds
  s_add_u32 m0, s38, s46
  s_nop 0
  buffer_load_dwordx4 v13, s[12:15], s37 offen offset:0  lds
  buffer_load_dwordx4 v14, s[12:15], s37 offen offset:1024  lds
  s_add_u32 m0, s38, s47
  s_nop 0
  buffer_load_dwordx4 v15, s[12:15], s37 offen offset:0  lds
  buffer_load_dwordx4 v16, s[12:15], s37 offen offset:1024  lds
  s_add_u32 m0, s38, s48
  s_nop 0
  buffer_load_dwordx4 v17, s[12:15], s37 offen offset:0  lds
  buffer_load_dwordx4 v18, s[12:15], s37 offen offset:1024  lds
  s_add_u32 s38, s38, 43008
  s_cmp_eq_u32 s38, 129024
  s_cselect_b32 s38, 0, s38
  s_mov_b32 s16, s84
  s_mov_b32 s17, s85
  s_mov_b32 s18, 67108864
  s_mov_b32 s19, 0x20000
  s_add_u32 s20, s84, 22020096
  s_addc_u32 s21, s85, 0
  s_mov_b32 s22, 16384
  s_mov_b32 s23, 0x20000
  s_mov_b32 s82, s84
  s_mov_b32 s83, s85
  s_add_u32 s30, s30, 1
  s_and_b32 s30, s30, 7
  s_cselect_b32 s32, 0, 1
  s_add_u32 s31, s31, s32
  s_sub_u32 s32, s30, s7
  s_and_b32 s32, s32, 7
  s_cmp_lt_u32 s32, 2
  s_cselect_b32 s32, 1, 0
  s_add_u32 s32, s32, s31
  s_cmp_ge_u32 s32, 2
  s_cselect_b32 s32, 0, s32
  s_lshl_b32 s33, s32, 3
  s_add_u32 s33, s33, s30
  s_mul_i32 s36, s33, 128
  s_add_u32 s36, s36, s34
  s_mul_i32 s37, s33, 393216
  s_add_u32 s37, s37, s35
  s_add_u32 m0, s38, s44
  s_nop 0
  buffer_load_dwordx4 v8, s[8:11], s36 offen offset:0 sc1 lds
  buffer_load_dwordx4 v9, s[8:11], s36 offen offset:1024 sc1 lds
  buffer_load_dwordx4 v10, s[8:11], s36 offen offset:2048 sc1 lds
  buffer_load_dwordx4 v11, s[8:11], s36 offen offset:3072 sc1 lds
  s_add_u32 m0, s38, s46
  s_nop 0
  buffer_load_dwordx4 v13, s[12:15], s37 offen offset:0  lds
  buffer_load_dwordx4 v14, s[12:15], s37 offen offset:1024  lds
  s_add_u32 m0, s38, s47
  s_nop 0
  buffer_load_dwordx4 v15, s[12:15], s37 offen offset:0  lds
  buffer_load_dwordx4 v16, s[12:15], s37 offen offset:1024  lds
  s_add_u32 m0, s38, s48
  s_nop 0
  buffer_load_dwordx4 v17, s[12:15], s37 offen offset:0  lds
  buffer_load_dwordx4 v18, s[12:15], s37 offen offset:1024  lds
  s_add_u32 s38, s38, 43008
  s_cmp_eq_u32 s38, 129024
  s_cselect_b32 s38, 0, s38
  buffer_load_dwordx4 v[48:51], v46, s[8:11], 0 offen offset:0
  buffer_load_dwordx4 v[52:55], v46, s[8:11], 0 offen offset:512
  buffer_load_dwordx4 v[56:59], v46, s[8:11], 0 offen offset:1024
  buffer_load_dwordx4 v[60:63], v46, s[8:11], 0 offen offset:1536
  buffer_store_dwordx4 v[64:67], v47, s[16:19], s58 offen sc0 sc1
  s_barrier
  s_waitcnt vmcnt(15)
  s_barrier
  s_add_u32 s30, s30, 1
  s_and_b32 s30, s30, 7
  s_cselect_b32 s32, 0, 1
  s_add_u32 s31, s31, s32
  s_sub_u32 s32, s30, s7
  s_and_b32 s32, s32, 7
  s_cmp_lt_u32 s32, 2
  s_cselect_b32 s32, 1, 0
  s_add_u32 s32, s32, s31
  s_cmp_ge_u32 s32, 2
  s_cselect_b32 s32, 0, s32
  s_lshl_b32 s33, s32, 3
  s_add_u32 s33, s33, s30
  s_mul_i32 s36, s33, 128
  s_add_u32 s36, s36, s34
  s_mul_i32 s37, s33, 393216
  s_add_u32 s37, s37, s35
  s_add_u32 m0, s38, s44
  s_nop 0
  buffer_load_dwordx4 v8, s[8:11], s36 offen offset:0 sc1 lds
  buffer_load_dwordx4 v9, s[8:11], s36 offen offset:1024 sc1 lds
  buffer_load_dwordx4 v10, s[8:11], s36 offen offset:2048 sc1 lds
  buffer_load_dwordx4 v11, s[8:11], s36 offen offset:3072 sc1 lds
  s_add_u32 m0, s38, s46
  s_nop 0
  buffer_load_dwordx4 v13, s[12:15], s37 offen offset:0  lds
  buffer_load_dwordx4 v14, s[12:15], s37 offen offset:1024  lds
  s_add_u32 m0, s38, s47
  s_nop 0
  buffer_load_dwordx4 v15, s[12:15], s37 offen offset:0  lds
  buffer_load_dwordx4 v16, s[12:15], s37 offen offset:1024  lds
  s_add_u32 m0, s38, s48
  s_nop 0
  buffer_load_dwordx4 v17, s[12:15], s37 offen offset:0  lds
  buffer_load_dwordx4 v18, s[12:15], s37 offen offset:1024  lds
  s_add_u32 s38, s38, 43008
  s_cmp_eq_u32 s38, 129024
  s_cselect_b32 s38, 0, s38
  v_mov_b32 v68, 0
  v_mov_b32 v69, 0
  v_mov_b32 v70, 0x3f803f80
  s_waitcnt vmcnt(11)
  v_dot2c_f32_bf16 v68, v70, v48
  v_dot2c_f32_bf16 v69, v48, v48
  v_dot2c_f32_bf16 v68, v70, v49
  v_dot2c_f32_bf16 v69, v49, v49
  v_dot2c_f32_bf16 v68, v70, v50
  v_dot2c_f32_bf16 v69, v50, v50
  v_dot2c_f32_bf16 v68, v70, v51
  v_dot2c_f32_bf16 v69, v51, v51
  v_dot2c_f32_bf16 v68, v70, v52
  v_dot2c_f32_bf16 v69, v52, v52
  v_dot2c_f32_bf16 v68, v70, v53
  v_dot2c_f32_bf16 v69, v53, v53
  v_dot2c_f32_bf16 v68, v70, v54
  v_dot2c_f32_bf16 v69, v54, v54
  v_dot2c_f32_bf16 v68, v70, v55
  v_dot2c_f32_bf16 v69, v55, v55
  v_dot2c_f32_bf16 v68, v70, v56
  v_dot2c_f32_bf16 v69, v56, v56
  v_dot2c_f32_bf16 v68, v70, v57
  v_dot2c_f32_bf16 v69, v57, v57
  v_dot2c_f32_bf16 v68, v70, v58
  v_dot2c_f32_bf16 v69, v58, v58
  v_dot2c_f32_bf16 v68, v70, v59
  v_dot2c_f32_bf16 v69, v59, v59
  v_dot2c_f32_bf16 v68, v70, v60
  v_dot2c_f32_bf16 v69, v60, v60
  v_dot2c_f32_bf16 v68, v70, v61
  v_dot2c_f32_bf16 v69, v61, v61
  v_dot2c_f32_bf16 v68, v70, v62
  v_dot2c_f32_bf16 v69, v62, v62
  v_dot2c_f32_bf16 v68, v70, v63
  v_dot2c_f32_bf16 v69, v63, v63
  s_nop 1
  v_add_f32_dpp v68, v68, v68 quad_perm:[1,0,3,2] row_mask:0xf bank_mask:0xf
  v_add_f32_dpp v69, v69, v69 quad_perm:[1,0,3,2] row_mask:0xf bank_mask:0xf
  s_nop 0
  v_add_f32_dpp v68, v68, v68 quad_perm:[2,3,0,1] row_mask:0xf bank_mask:0xf
  v_add_f32_dpp v69, v69, v69 quad_perm:[2,3,0,1] row_mask:0xf bank_mask:0xf
  s_nop 0
  v_add_f32_dpp v68, v68, v68 row_half_mirror row_mask:0xf bank_mask:0xf
  v_add_f32_dpp v69, v69, v69 row_half_mirror row_mask:0xf bank_mask:0xf
  s_nop 0
  v_add_f32_dpp v68, v68, v68 row_mirror row_mask:0xf bank_mask:0xf
  v_add_f32_dpp v69, v69, v69 row_mirror row_mask:0xf bank_mask:0xf
  v_mov_b32 v70, v68
  v_mov_b32 v71, v69
  s_nop 0
  v_permlane16_swap_b32 v68, v70
  v_permlane16_swap_b32 v69, v71
  v_add_f32 v68, v68, v70
  v_add_f32 v69, v69, v71
  s_mov_b32 exec_lo, 1
  s_mov_b32 exec_hi, 1
  buffer_store_dwordx2 v[68:69], v72, s[16:19], 0 offen sc0 sc1
  s_mov_b64 exec, -1
  s_branch L_jB
L_k1t:
  s_nop 7
  s_nop 7
  s_waitcnt vmcnt(0)
  v_pk_add_f32 v[30:31], v[30:31], v[32:33]
  v_pk_add_f32 v[34:35], v[34:35], v[36:37]
  v_pk_add_f32 v[38:39], v[38:39], v[40:41]
  v_pk_add_f32 v[42:43], v[42:43], v[44:45]
  v_pk_add_f32 v[30:31], v[30:31], v[34:35]
  v_pk_add_f32 v[38:39], v[38:39], v[42:43]
  v_pk_add_f32 v[30:31], v[30:31], v[38:39]
  v_mul_f32 v30, 0x3a800000, v30
  v_mul_f32 v31, 0x3a800000, v31
  v_fma_f32 v31, -v30, v30, v31
  v_max_f32 v31, 0, v31
  v_mov_b32 v32, v31
  v_cvt_pk_bf16_f32 v32, v32, v32
  v_lshlrev_b32 v32, 16, v32
  v_add_f32 v32, 0x3727c5ac, v32
  v_cvt_pk_bf16_f32 v32, v32, v32
  v_lshlrev_b32 v32, 16, v32
  v_sqrt_f32 v32, v32
  s_nop 0
  v_cvt_pk_bf16_f32 v32, v32, v32
  v_lshlrev_b32 v32, 16, v32
  v_rcp_f32 v32, v32
  v_cvt_pk_bf16_f32 v30, v30, v30
  v_lshlrev_b32 v30, 16, v30
  v_mov_b32 v31, v32
  ds_write_b64 v26, v[30:31]
  s_waitcnt lgkmcnt(0)
  s_mov_b32 s41, s57
  s_mul_i32 s32, s41, 16
  s_add_u32 s32, s32, 0
  v_lshrrev_b32 v2, 3, v0
  v_add_u32 v2, s32, v2
  v_bfe_u32 v3, v2, 1, 1
  v_bfe_u32 v4, v2, 3, 1
  v_lshl_or_b32 v3, v4, 1, v3
  v_lshlrev_b32 v3, 1, v3
  v_and_b32 v4, 7, v0
  v_xor_b32 v3, v3, v4
  v_lshlrev_b32 v3, 4, v3
  s_mov_b32 s32, 2048
  v_mul_lo_u32 v2, v2, s32
  v_add_u32 v130, v2, v3
  s_mul_i32 s32, s41, 16
  s_add_u32 s32, s32, 8
  v_lshrrev_b32 v2, 3, v0
  v_add_u32 v2, s32, v2
  v_bfe_u32 v3, v2, 1, 1
  v_bfe_u32 v4, v2, 3, 1
  v_lshl_or_b32 v3, v4, 1, v3
  v_lshlrev_b32 v3, 1, v3
  v_and_b32 v4, 7, v0
  v_xor_b32 v3, v3, v4
  v_lshlrev_b32 v3, 4, v3
  s_mov_b32 s32, 2048
  v_mul_lo_u32 v2, v2, s32
  v_add_u32 v131, v2, v3
  v_subrev_u32 v131, 1024, v131
  s_mov_b32 s12, s68
  s_mov_b32 s13, s69
  s_mov_b32 s14, 2097152
  s_mov_b32 s15, 0x20000
  s_mov_b32 s30, 7
  s_mov_b32 s31, -1
  s_lshl_b32 s52, s57, 11
  s_add_u32 s30, s30, 1
  s_and_b32 s30, s30, 7
  s_cselect_b32 s32, 0, 1
  s_add_u32 s31, s31, s32
  s_sub_u32 s32, s30, s7
  s_and_b32 s32, s32, 7
  s_cmp_lt_u32 s32, 2
  s_cselect_b32 s32, 1, 0
  s_add_u32 s32, s32, s31
  s_cmp_ge_u32 s32, 2
  s_cselect_b32 s32, 0, s32
  s_lshl_b32 s33, s32, 3
  s_add_u32 s33, s33, s30
  s_lshl_b32 s37, s33, 17
  s_add_u32 s37, s37, s35
  s_add_u32 m0, s52, 131072
  s_nop 0
  buffer_load_dwordx4 v130, s[12:15], s37 offen lds
  buffer_load_dwordx4 v131, s[12:15], s37 offen offset:1024 lds
  s_add_u32 s30, s30, 1
  s_and_b32 s30, s30, 7
  s_cselect_b32 s32, 0, 1
  s_add_u32 s31, s31, s32
  s_sub_u32 s32, s30, s7
  s_and_b32 s32, s32, 7
  s_cmp_lt_u32 s32, 2
  s_cselect_b32 s32, 1, 0
  s_add_u32 s32, s32, s31
  s_cmp_ge_u32 s32, 2
  s_cselect_b32 s32, 0, s32
  s_lshl_b32 s33, s32, 3
  s_add_u32 s33, s33, s30
  s_lshl_b32 s37, s33, 17
  s_add_u32 s37, s37, s35
  s_add_u32 m0, s52, 139264
  s_nop 0
  buffer_load_dwordx4 v130, s[12:15], s37 offen lds
  buffer_load_dwordx4 v131, s[12:15], s37 offen offset:1024 lds
  s_add_u32 s30, s30, 1
  s_and_b32 s30, s30, 7
  s_cselect_b32 s32, 0, 1
  s_add_u32 s31, s31, s32
  s_sub_u32 s32, s30, s7
  s_and_b32 s32, s32, 7
  s_cmp_lt_u32 s32, 2
  s_cselect_b32 s32, 1, 0
  s_add_u32 s32, s32, s31
  s_cmp_ge_u32 s32, 2
  s_cselect_b32 s32, 0, s32
  s_lshl_b32 s33, s32, 3
  s_add_u32 s33, s33, s30
  s_lshl_b32 s37, s33, 17
  s_add_u32 s37, s37, s35
  s_add_u32 m0, s52, 147456
  s_nop 0
  buffer_load_dwordx4 v130, s[12:15], s37 offen lds
  buffer_load_dwordx4 v131, s[12:15], s37 offen offset:1024 lds
  s_add_u32 s30, s30, 1
  s_and_b32 s30, s30, 7
  s_cselect_b32 s32, 0, 1
  s_add_u32 s31, s31, s32
  s_sub_u32 s32, s30, s7
  s_and_b32 s32, s32, 7
  s_cmp_lt_u32 s32, 2
  s_cselect_b32 s32, 1, 0
  s_add_u32 s32, s32, s31
  s_cmp_ge_u32 s32, 2
  s_cselect_b32 s32, 0, s32
  s_lshl_b32 s33, s32, 3
  s_add_u32 s33, s33, s30
  s_lshl_b32 s37, s33, 17
  s_add_u32 s37, s37, s35
  s_add_u32 m0, s52, 155648
  s_nop 0
  buffer_load_dwordx4 v130, s[12:15], s37 offen lds
  buffer_load_dwordx4 v131, s[12:15], s37 offen offset:1024 lds
  s_waitcnt vmcnt(8)
  s_barrier
  s_add_u32 s30, s30, 1
  s_and_b32 s30, s30, 7
  s_cselect_b32 s32, 0, 1
  s_add_u32 s31, s31, s32
  s_sub_u32 s32, s30, s7
  s_and_b32 s32, s32, 7
  s_cmp_lt_u32 s32, 2
  s_cselect_b32 s32, 1, 0
  s_add_u32 s32, s32, s31
  s_cmp_ge_u32 s32, 2
  s_cselect_b32 s32, 0, s32
  s_lshl_b32 s33, s32, 3
  s_add_u32 s33, s33, s30
  s_lshl_b32 s37, s33, 17
  s_add_u32 s37, s37, s35
  s_add_u32 m0, s52, 100608
  s_nop 0
  buffer_load_dwordx4 v130, s[12:15], s37 offen lds
  buffer_load_dwordx4 v131, s[12:15], s37 offen offset:1024 lds
  s_add_u32 s30, s30, 1
  s_and_b32 s30, s30, 7
  s_cselect_b32 s32, 0, 1
  s_add_u32 s31, s31, s32
  s_sub_u32 s32, s30, s7
  s_and_b32 s32, s32, 7
  s_cmp_lt_u32 s32, 2
  s_cselect_b32 s32, 1, 0
  s_add_u32 s32, s32, s31
  s_cmp_ge_u32 s32, 2
  s_cselect_b32 s32, 0, s32
  s_lshl_b32 s33, s32, 3
  s_add_u32 s33, s33, s30
  s_lshl_b32 s37, s33, 17
  s_add_u32 s37, s37, s35
  s_add_u32 m0, s52, 108800
  s_nop 0
  buffer_load_dwordx4 v130, s[12:15], s37 offen lds
  buffer_load_dwordx4 v131, s[12:15], s37 offen offset:1024 lds
  s_add_u32 s30, s30, 1
  s_and_b32 s30, s30, 7
  s_cselect_b32 s32, 0, 1
  s_add_u32 s31, s31, s32
  s_sub_u32 s32, s30, s7
  s_and_b32 s32, s32, 7
  s_cmp_lt_u32 s32, 2
  s_cselect_b32 s32, 1, 0
  s_add_u32 s32, s32, s31
  s_cmp_ge_u32 s32, 2
  s_cselect_b32 s32, 0, s32
  s_lshl_b32 s33, s32, 3
  s_add_u32 s33, s33, s30
  s_lshl_b32 s37, s33, 17
  s_add_u32 s37, s37, s35
  s_add_u32 m0, s52, 116992
  s_nop 0
  buffer_load_dwordx4 v130, s[12:15], s37 offen lds
  buffer_load_dwordx4 v131, s[12:15], s37 offen offset:1024 lds
  s_cmp_lg_u32 s3, 0
  s_cbranch_scc1 e15
  v_and_b32 v4, 15, v0
  v_lshrrev_b32 v5, 4, v0
  v_lshrrev_b32 v6, 2, v4
  v_and_b32 v7, 3, v0
  v_lshrrev_b32 v3, 5, v0
  v_and_b32 v2, 1, v5
  v_lshl_or_b32 v3, v2, 1, v3
  s_lshr_b32 s40, s4, 1
  s_and_b32 s41, s4, 1
  s_mul_i32 s32, s41, 28800
  s_add_u32 s32, s32, 43008
  s_lshl_b32 s49, s40, 4
  v_add_u32 v76, s49, v4
  v_lshlrev_b32 v77, 4, v5
  v_add_u32 v77, s32, v77
  v_mul_u32_u24 v78, 400, v76
  v_add_u32 v220, v78, v77
  v_add_u32 v223, 3200, v220
  v_add_u32 v220, 128, v220
  v_add_u32 v76, 16, v76
  v_min_u32 v76, 71, v76
  v_mul_u32_u24 v78, 400, v76
  v_add3_u32 v221, v78, v77, 64
  v_add_u32 v221, 64, v221
  v_lshl_add_u32 v76, v5, 2, v6
  v_add_u32 v76, s49, v76
  v_lshlrev_b32 v77, 4, v7
  v_add_u32 v77, s32, v77
  v_add_u32 v77, 256, v77
  v_mul_u32_u24 v78, 400, v76
  v_add_u32 v222, v78, v77
  v_add_u32 v76, 16, v76
  v_min_u32 v76, 71, v76
  v_mul_u32_u24 v78, 400, v76
  v_add_u32 v254, v78, v77
  s_lshl_b32 s50, s28, 2
  s_add_u32 s50, s50, s40
  s_lshl_b32 s50, s50, 16
  s_lshl_b32 s51, s29, 12
  s_add_u32 s50, s50, s51
  s_lshl_b32 s51, s41, 10
  s_add_u32 s50, s50, s51
  v_lshlrev_b32 v1, 4, v0
  v_add_u32 v1, s50, v1
  v_lshlrev_b32 v76, 2, v5
  v_sub_u32 v76, v76, v4
  s_or_b32 s51, s28, s40
  s_cmp_eq_u32 s51, 0
  s_cselect_b32 s51, 0, -1
  v_add_u32 v77, -1, v76
  v_cmp_gt_u32 s[86:87], 8, v77
  v_add_u32 v77, 0, v76
  v_cmp_gt_u32 s[88:89], 8, v77
  v_add_u32 v77, 1, v76
  v_cmp_gt_u32 s[90:91], 8, v77
  v_add_u32 v77, 2, v76
  v_cmp_gt_u32 s[92:93], 8, v77
  v_add_u32 v77, 15, v76
  v_cmp_gt_u32 s[94:95], 8, v77
  v_add_u32 v77, 16, v76
  v_cmp_gt_u32 s[96:97], 8, v77
  v_add_u32 v77, 17, v76
  v_cmp_gt_u32 s[98:99], 8, v77
  v_add_u32 v77, 18, v76
  v_cmp_gt_u32 s[100:101], 8, v77
  s_and_b32 s86, s86, s51
  s_and_b32 s88, s88, s51
  s_and_b32 s90, s90, s51
  s_and_b32 s92, s92, s51
e15:
  s_nop 1
  s_waitcnt lgkmcnt(0)
  s_barrier
  s_add_u32 s30, s30, 1
  s_and_b32 s30, s30, 7
  s_cselect_b32 s32, 0, 1
  s_add_u32 s31, s31, s32
  s_sub_u32 s32, s30, s7
  s_and_b32 s32, s32, 7
  s_cmp_lt_u32 s32, 2
  s_cselect_b32 s32, 1, 0
  s_add_u32 s32, s32, s31
  s_cmp_ge_u32 s32, 2
  s_cselect_b32 s32, 0, s32
  s_lshl_b32 s33, s32, 3
  s_add_u32 s33, s33, s30
  s_lshl_b32 s37, s33, 17
  s_add_u32 s37, s37, s35
  s_add_u32 m0, s52, 0
  s_nop 0
  buffer_load_dwordx4 v130, s[12:15], s37 offen lds
  buffer_load_dwordx4 v131, s[12:15], s37 offen offset:1024 lds
  s_add_u32 s30, s30, 1
  s_and_b32 s30, s30, 7
  s_cselect_b32 s32, 0, 1
  s_add_u32 s31, s31, s32
  s_sub_u32 s32, s30, s7
  s_and_b32 s32, s32, 7
  s_cmp_lt_u32 s32, 2
  s_cselect_b32 s32, 1, 0
  s_add_u32 s32, s32, s31
  s_cmp_ge_u32 s32, 2
  s_cselect_b32 s32, 0, s32
  s_lshl_b32 s33, s32, 3
  s_add_u32 s33, s33, s30
  s_lshl_b32 s37, s33, 17
  s_add_u32 s37, s37, s35
  s_add_u32 m0, s52, 8192
  s_nop 0
  buffer_load_dwordx4 v130, s[12:15], s37 offen lds
  buffer_load_dwordx4 v131, s[12:15], s37 offen offset:1024 lds
  s_add_u32 s30, s30, 1
  s_and_b32 s30, s30, 7
  s_cselect_b32 s32, 0, 1
  s_add_u32 s31, s31, s32
  s_sub_u32 s32, s30, s7
  s_and_b32 s32, s32, 7
  s_cmp_lt_u32 s32, 2
  s_cselect_b32 s32, 1, 0
  s_add_u32 s32, s32, s31
  s_cmp_ge_u32 s32, 2
  s_cselect_b32 s32, 0, s32
  s_lshl_b32 s33, s32, 3
  s_add_u32 s33, s33, s30
  s_lshl_b32 s37, s33, 17
  s_add_u32 s37, s37, s35
  s_add_u32 m0, s52, 16384
  s_nop 0
  buffer_load_dwordx4 v130, s[12:15], s37 offen lds
  buffer_load_dwordx4 v131, s[12:15], s37 offen offset:1024 lds
  s_add_u32 s30, s30, 1
  s_and_b32 s30, s30, 7
  s_cselect_b32 s32, 0, 1
  s_add_u32 s31, s31, s32
  s_sub_u32 s32, s30, s7
  s_and_b32 s32, s32, 7
  s_cmp_lt_u32 s32, 2
  s_cselect_b32 s32, 1, 0
  s_add_u32 s32, s32, s31
  s_cmp_ge_u32 s32, 2
  s_cselect_b32 s32, 0, s32
  s_lshl_b32 s33, s32, 3
  s_add_u32 s33, s33, s30
  s_lshl_b32 s37, s33, 17
  s_add_u32 s37, s37, s35
  s_add_u32 m0, s52, 24576
  s_nop 0
  buffer_load_dwordx4 v130, s[12:15], s37 offen lds
  buffer_load_dwordx4 v131, s[12:15], s37 offen offset:1024 lds
  s_add_u32 s30, s30, 1
  s_and_b32 s30, s30, 7
  s_cselect_b32 s32, 0, 1
  s_add_u32 s31, s31, s32
  s_sub_u32 s32, s30, s7
  s_and_b32 s32, s32, 7
  s_cmp_lt_u32 s32, 2
  s_cselect_b32 s32, 1, 0
  s_add_u32 s32, s32, s31
  s_cmp_ge_u32 s32, 2
  s_cselect_b32 s32, 0, s32
  s_lshl_b32 s33, s32, 3
  s_add_u32 s33, s33, s30
  s_lshl_b32 s37, s33, 17
  s_add_u32 s37, s37, s35
  s_add_u32 m0, s52, 32768
  s_nop 0
  buffer_load_dwordx4 v130, s[12:15], s37 offen lds
  buffer_load_dwordx4 v131, s[12:15], s37 offen offset:1024 lds
  s_branch attn
L_k1done:
  s_nop 7
  s_nop 7
  s_add_u32 s24, s84, 29360128
  s_addc_u32 s25, s85, 0
  s_mov_b32 s26, 262144
  s_mov_b32 s27, 0x20000
  v_mov_b32 v136, 0
  v_mov_b32 v137, 1
  s_cmp_eq_u32 s57, 0
  s_cselect_b32 s26, s26, 0
  s_waitcnt vmcnt(0)
  s_barrier
  s_mov_b64 exec, 1
  buffer_store_dword v137, v136, s[24:27], s56 offen sc0 sc1
  s_mov_b64 exec, -1
  s_add_u32 s30, s30, 1
  s_and_b32 s30, s30, 7
  s_cselect_b32 s32, 0, 1
  s_add_u32 s31, s31, s32
  s_sub_u32 s32, s30, s7
  s_and_b32 s32, s32, 7
  s_cmp_lt_u32 s32, 2
  s_cselect_b32 s32, 1, 0
  s_add_u32 s32, s32, s31
  s_cmp_ge_u32 s32, 2
  s_cselect_b32 s32, 0, s32
  s_lshl_b32 s33, s32, 3
  s_add_u32 s33, s33, s30
  s_lshl_b32 s37, s33, 17
  s_add_u32 s37, s37, s35
  s_add_u32 m0, s52, 43008
  s_nop 0
  buffer_load_dwordx4 v130, s[12:15], s37 offen lds
  buffer_load_dwordx4 v131, s[12:15], s37 offen offset:1024 lds
  s_add_u32 s30, s30, 1
  s_and_b32 s30, s30, 7
  s_cselect_b32 s32, 0, 1
  s_add_u32 s31, s31, s32
  s_sub_u32 s32, s30, s7
  s_and_b32 s32, s32, 7
  s_cmp_lt_u32 s32, 2
  s_cselect_b32 s32, 1, 0
  s_add_u32 s32, s32, s31
  s_cmp_ge_u32 s32, 2
  s_cselect_b32 s32, 0, s32
  s_lshl_b32 s33, s32, 3
  s_add_u32 s33, s33, s30
  s_lshl_b32 s37, s33, 17
  s_add_u32 s37, s37, s35
  s_add_u32 m0, s52, 51200
  s_nop 0
  buffer_load_dwordx4 v130, s[12:15], s37 offen lds
  buffer_load_dwordx4 v131, s[12:15], s37 offen offset:1024 lds
  s_add_u32 s30, s30, 1
  s_and_b32 s30, s30, 7
  s_cselect_b32 s32, 0, 1
  s_add_u32 s31, s31, s32
  s_sub_u32 s32, s30, s7
  s_and_b32 s32, s32, 7
  s_cmp_lt_u32 s32, 2
  s_cselect_b32 s32, 1, 0
  s_add_u32 s32, s32, s31
  s_cmp_ge_u32 s32, 2
  s_cselect_b32 s32, 0, s32
  s_lshl_b32 s33, s32, 3
  s_add_u32 s33, s33, s30
  s_lshl_b32 s37, s33, 17
  s_add_u32 s37, s37, s35
  s_add_u32 m0, s52, 59392
  s_nop 0
  buffer_load_dwordx4 v130, s[12:15], s37 offen lds
  buffer_load_dwordx4 v131, s[12:15], s37 offen offset:1024 lds
  s_add_u32 s30, s30, 1
  s_and_b32 s30, s30, 7
  s_cselect_b32 s32, 0, 1
  s_add_u32 s31, s31, s32
  s_sub_u32 s32, s30, s7
  s_and_b32 s32, s32, 7
  s_cmp_lt_u32 s32, 2
  s_cselect_b32 s32, 1, 0
  s_add_u32 s32, s32, s31
  s_cmp_ge_u32 s32, 2
  s_cselect_b32 s32, 0, s32
  s_lshl_b32 s33, s32, 3
  s_add_u32 s33, s33, s30
  s_lshl_b32 s37, s33, 17
  s_add_u32 s37, s37, s35
  s_add_u32 m0, s52, 67584
  s_nop 0
  buffer_load_dwordx4 v130, s[12:15], s37 offen lds
  buffer_load_dwordx4 v131, s[12:15], s37 offen offset:1024 lds
  s_lshl_b32 s56, s3, 10
  s_mul_i32 s32, s29, 16
  s_add_u32 s56, s56, s32
  s_add_u32 s56, s56, s28
  s_add_u32 s56, s56, 256
  s_lshl_b32 s56, s56, 7
  s_barrier
  s_waitcnt vmcnt(0)
  s_barrier
  s_cmp_ge_u32 s2, 224
  s_cbranch_scc1 L_k3skip
  s_lshr_b32 s32, s2, 3
  s_mul_i32 s5, s32, 9363
  s_lshr_b32 s5, s5, 16
  s_mul_i32 s6, s5, 7
  s_sub_u32 s6, s32, s6
  s_lshl_b32 s7, s5, 1
  s_add_u32 s7, s7, s6
  s_and_b32 s7, s7, 7
  s_and_b32 s32, s2, 7
  s_lshr_b32 s28, s32, 2
  s_lshl_b32 s28, s28, 2
  s_add_u32 s28, s28, s5
  s_and_b32 s29, s32, 3
  s_mul_i32 s29, s29, 7
  s_add_u32 s29, s29, s6
  s_mov_b32 s30, 7
  s_mov_b32 s31, -1
  s_lshl_b32 s44, s57, 12
  s_add_u32 s45, s44, 16384
  v_lshlrev_b32 v8, 4, v0
  v_add_u32 v13, 63488, v8
  v_lshrrev_b32 v2, 4, v0
  v_lshlrev_b32 v3, 1, v2
  v_and_b32 v4, 15, v0
  v_xor_b32 v3, v3, v4
  v_lshlrev_b32 v3, 4, v3
  s_lshl_b32 s32, s57, 4
  v_add_u32 v2, s32, v2
  s_mov_b32 s32, 7168
  v_mul_lo_u32 v2, v2, s32
  v_add_u32 v9, v2, v3
  v_xor_b32 v3, 128, v3
  v_add_u32 v11, v2, v3
  v_add_u32 v10, 27648, v9
  v_add_u32 v12, 82944, v11
  v_add_u32 v11, 55296, v11
  s_lshl_b32 s34, s28, 2
  s_add_u32 s34, s34, s57
  s_lshl_b32 s34, s34, 17
  s_lshl_b32 s35, s29, 8
  s_add_u32 s8, s82, 8388608
  s_addc_u32 s9, s83, 0
  s_mov_b32 s10, 4194304
  s_mov_b32 s11, 0x20000
  s_mov_b32 s12, s72
  s_mov_b32 s13, s73
  s_mov_b32 s14, 14680064
  s_mov_b32 s15, 0x20000
  s_add_u32 s16, s84, 29360128
  s_addc_u32 s17, s85, 0
  s_mov_b32 s18, 262144
  s_mov_b32 s19, 0x20000
  s_lshl_b32 s32, s28, 5
  v_min_u32 v14, 31, v0
  v_add_u32 v14, s32, v14
  v_max_i32 v14, 0, v14
  v_lshlrev_b32 v14, 7, v14
  s_lshl_b32 s55, s3, 17
  s_add_u32 s55, s55, 32768
  s_lshr_b32 s32, s2, 3
  s_add_u32 s32, s32, 0
  s_lshl_b32 s32, s32, 2
  s_add_u32 s32, s32, s57
  s_lshl_b32 s32, s32, 6
  v_add_u32 v2, s32, v0
  v_mul_u32_u24 v3, 74899, v2
  v_lshrrev_b32 v3, 20, v3
  v_mul_u32_u24 v4, 14, v3
  v_sub_u32 v4, v2, v4
  v_add_u32 v3, 192, v3
  v_mul_u32_u24 v3, 7168, v3
  v_lshl_add_u32 v3, v4, 7, v3
  s_and_b32 s32, s2, 3
  s_mul_i32 s32, s32, 1792
  s_lshl_b32 s40, s3, 30
  s_add_u32 s32, s32, s40
  v_add_u32 v16, s32, v3
  s_barrier
  s_barrier
  s_mov_b64 exec, 1
  buffer_store_dword v137, v136, s[24:27], s56 offen sc0 sc1
  s_mov_b64 exec, -1
  s_mov_b32 s30, 7
  s_mov_b32 s31, -1
  s_mov_b32 s38, 0
  s_add_u32 s30, s30, 1
  s_and_b32 s30, s30, 7
  s_cselect_b32 s32, 0, 1
  s_add_u32 s31, s31, s32
  s_sub_u32 s32, s30, s7
  s_and_b32 s32, s32, 7
  s_cmp_lt_u32 s32, 2
  s_cselect_b32 s32, 1, 0
  s_add_u32 s32, s32, s31
  s_cmp_ge_u32 s32, 4
  s_cselect_b32 s32, 0, s32
  s_lshl_b32 s33, s32, 3
  s_add_u32 s33, s33, s30
  s_mul_i32 s37, s33, 458752
  s_add_u32 s37, s37, s35
  s_add_u32 m0, s38, s45
  s_nop 0
  buffer_load_dwordx4 v9, s[12:15], s37 offen offset:0  lds
  buffer_load_dwordx4 v10, s[12:15], s37 offen offset:1024  lds
  buffer_load_dwordx4 v11, s[12:15], s37 offen offset:2048  lds
  buffer_load_dwordx4 v12, s[12:15], s37 offen offset:3072  lds
  s_add_u32 s38, s38, 32768
  s_cmp_eq_u32 s38, 163840
  s_cselect_b32 s38, 0, s38
  s_add_u32 s30, s30, 1
  s_and_b32 s30, s30, 7
  s_cselect_b32 s32, 0, 1
  s_add_u32 s31, s31, s32
  s_sub_u32 s32, s30, s7
  s_and_b32 s32, s32, 7
  s_cmp_lt_u32 s32, 2
  s_cselect_b32 s32, 1, 0
  s_add_u32 s32, s32, s31
  s_cmp_ge_u32 s32, 4
  s_cselect_b32 s32, 0, s32
  s_lshl_b32 s33, s32, 3
  s_add_u32 s33, s33, s30
  s_mul_i32 s37, s33, 458752
  s_add_u32 s37, s37, s35
  s_add_u32 m0, s38, s45
  s_nop 0
  buffer_load_dwordx4 v9, s[12:15], s37 offen offset:0  lds
  buffer_load_dwordx4 v10, s[12:15], s37 offen offset:1024  lds
  buffer_load_dwordx4 v11, s[12:15], s37 offen offset:2048  lds
  buffer_load_dwordx4 v12, s[12:15], s37 offen offset:3072  lds
  s_add_u32 s38, s38, 32768
  s_cmp_eq_u32 s38, 163840
  s_cselect_b32 s38, 0, s38
  s_add_u32 s30, s30, 1
  s_and_b32 s30, s30, 7
  s_cselect_b32 s32, 0, 1
  s_add_u32 s31, s31, s32
  s_sub_u32 s32, s30, s7
  s_and_b32 s32, s32, 7
  s_cmp_lt_u32 s32, 2
  s_cselect_b32 s32, 1, 0
  s_add_u32 s32, s32, s31
  s_cmp_ge_u32 s32, 4
  s_cselect_b32 s32, 0, s32
  s_lshl_b32 s33, s32, 3
  s_add_u32 s33, s33, s30
  s_mul_i32 s37, s33, 458752
  s_add_u32 s37, s37, s35
  s_add_u32 m0, s38, s45
  s_nop 0
  buffer_load_dwordx4 v9, s[12:15], s37 offen offset:0  lds
  buffer_load_dwordx4 v10, s[12:15], s37 offen offset:1024  lds
  buffer_load_dwordx4 v11, s[12:15], s37 offen offset:2048  lds
  buffer_load_dwordx4 v12, s[12:15], s37 offen offset:3072  lds
  s_add_u32 s38, s38, 32768
  s_cmp_eq_u32 s38, 163840
  s_cselect_b32 s38, 0, s38
  buffer_load_dword v135, v16, s[12:15], 0 offen
  s_lshl_b32 s56, s3, 10
  s_mul_i32 s32, s28, 32
  s_add_u32 s56, s56, s32
  s_add_u32 s56, s56, s29
  s_add_u32 s56, s56, 512
  s_lshl_b32 s56, s56, 7
  s_mov_b32 s39, 0
  s_and_b32 s32, s4, 3
  s_cmp_lg_u32 s32, 0
  s_cbranch_scc1 poll16d
  s_sleep 8
poll16:
  buffer_load_dword v15, v14, s[16:19], s55 offen sc0 sc1
  s_waitcnt vmcnt(0)
  v_cmp_eq_u32 vcc, 0, v15
  s_add_u32 s39, s39, 1
  s_cmp_gt_u32 s39, 1000000
  s_cbranch_scc1 poll16d
  s_cbranch_vccnz poll16
poll16d:
  s_barrier
  s_mov_b32 s30, 7
  s_mov_b32 s31, -1
  s_mov_b32 s38, 0
  s_add_u32 s30, s30, 1
  s_and_b32 s30, s30, 7
  s_cselect_b32 s32, 0, 1
  s_add_u32 s31, s31, s32
  s_sub_u32 s32, s30, s7
  s_and_b32 s32, s32, 7
  s_cmp_lt_u32 s32, 2
  s_cselect_b32 s32, 1, 0
  s_add_u32 s32, s32, s31
  s_cmp_ge_u32 s32, 4
  s_cselect_b32 s32, 0, s32
  s_lshl_b32 s33, s32, 3
  s_add_u32 s33, s33, s30
  s_mul_i32 s36, s33, 2048
  s_add_u32 s36, s36, s34
  s_add_u32 m0, s38, s44
  s_nop 0
  buffer_load_dwordx4 v8, s[8:11], s36 offen offset:0 sc1 lds
  buffer_load_dwordx4 v8, s[8:11], s36 offen offset:1024 sc1 lds
  buffer_load_dwordx4 v13, s[8:11], s36 offen offset:2048 sc1 lds
  buffer_load_dwordx4 v13, s[8:11], s36 offen offset:3072 sc1 lds
  s_add_u32 s38, s38, 32768
  s_cmp_eq_u32 s38, 163840
  s_cselect_b32 s38, 0, s38
  s_add_u32 s30, s30, 1
  s_and_b32 s30, s30, 7
  s_cselect_b32 s32, 0, 1
  s_add_u32 s31, s31, s32
  s_sub_u32 s32, s30, s7
  s_and_b32 s32, s32, 7
  s_cmp_lt_u32 s32, 2
  s_cselect_b32 s32, 1, 0
  s_add_u32 s32, s32, s31
  s_cmp_ge_u32 s32, 4
  s_cselect_b32 s32, 0, s32
  s_lshl_b32 s33, s32, 3
  s_add_u32 s33, s33, s30
  s_mul_i32 s36, s33, 2048
  s_add_u32 s36, s36, s34
  s_add_u32 m0, s38, s44
  s_nop 0
  buffer_load_dwordx4 v8, s[8:11], s36 offen offset:0 sc1 lds
  buffer_load_dwordx4 v8, s[8:11], s36 offen offset:1024 sc1 lds
  buffer_load_dwordx4 v13, s[8:11], s36 offen offset:2048 sc1 lds
  buffer_load_dwordx4 v13, s[8:11], s36 offen offset:3072 sc1 lds
  s_add_u32 s38, s38, 32768
  s_cmp_eq_u32 s38, 163840
  s_cselect_b32 s38, 0, s38
  s_add_u32 s30, s30, 1
  s_and_b32 s30, s30, 7
  s_cselect_b32 s32, 0, 1
  s_add_u32 s31, s31, s32
  s_sub_u32 s32, s30, s7
  s_and_b32 s32, s32, 7
  s_cmp_lt_u32 s32, 2
  s_cselect_b32 s32, 1, 0
  s_add_u32 s32, s32, s31
  s_cmp_ge_u32 s32, 4
  s_cselect_b32 s32, 0, s32
  s_lshl_b32 s33, s32, 3
  s_add_u32 s33, s33, s30
  s_mul_i32 s36, s33, 2048
  s_add_u32 s36, s36, s34
  s_add_u32 m0, s38, s44
  s_nop 0
  buffer_load_dwordx4 v8, s[8:11], s36 offen offset:0 sc1 lds
  buffer_load_dwordx4 v8, s[8:11], s36 offen offset:1024 sc1 lds
  buffer_load_dwordx4 v13, s[8:11], s36 offen offset:2048 sc1 lds
  buffer_load_dwordx4 v13, s[8:11], s36 offen offset:3072 sc1 lds
  s_add_u32 s38, s38, 32768
  s_cmp_eq_u32 s38, 163840
  s_cselect_b32 s38, 0, s38
  s_waitcnt vmcnt(8)
  s_barrier
  s_add_u32 s30, s30, 1
  s_and_b32 s30, s30, 7
  s_cselect_b32 s32, 0, 1
  s_add_u32 s31, s31, s32
  s_sub_u32 s32, s30, s7
  s_and_b32 s32, s32, 7
  s_cmp_lt_u32 s32, 2
  s_cselect_b32 s32, 1, 0
  s_add_u32 s32, s32, s31
  s_cmp_ge_u32 s32, 4
  s_cselect_b32 s32, 0, s32
  s_lshl_b32 s33, s32, 3
  s_add_u32 s33, s33, s30
  s_mul_i32 s36, s33, 2048
  s_add_u32 s36, s36, s34
  s_mul_i32 s37, s33, 458752
  s_add_u32 s37, s37, s35
  s_add_u32 m0, s38, s44
  s_nop 0
  buffer_load_dwordx4 v8, s[8:11], s36 offen offset:0 sc1 lds
  buffer_load_dwordx4 v8, s[8:11], s36 offen offset:1024 sc1 lds
  buffer_load_dwordx4 v13, s[8:11], s36 offen offset:2048 sc1 lds
  buffer_load_dwordx4 v13, s[8:11], s36 offen offset:3072 sc1 lds
  s_add_u32 m0, s38, s45
  s_nop 0
  buffer_load_dwordx4 v9, s[12:15], s37 offen offset:0  lds
  buffer_load_dwordx4 v10, s[12:15], s37 offen offset:1024  lds
  buffer_load_dwordx4 v11, s[12:15], s37 offen offset:2048  lds
  buffer_load_dwordx4 v12, s[12:15], s37 offen offset:3072  lds
  s_add_u32 s38, s38, 32768
  s_cmp_eq_u32 s38, 163840
  s_cselect_b32 s38, 0, s38
  s_waitcnt vmcnt(12)
  s_barrier
  s_add_u32 s30, s30, 1
  s_and_b32 s30, s30, 7
  s_cselect_b32 s32, 0, 1
  s_add_u32 s31, s31, s32
  s_sub_u32 s32, s30, s7
  s_and_b32 s32, s32, 7
  s_cmp_lt_u32 s32, 2
  s_cselect_b32 s32, 1, 0
  s_add_u32 s32, s32, s31
  s_cmp_ge_u32 s32, 4
  s_cselect_b32 s32, 0, s32
  s_lshl_b32 s33, s32, 3
  s_add_u32 s33, s33, s30
  s_mul_i32 s36, s33, 2048
  s_add_u32 s36, s36, s34
  s_mul_i32 s37, s33, 458752
  s_add_u32 s37, s37, s35
  s_add_u32 m0, s38, s44
  s_nop 0
  buffer_load_dwordx4 v8, s[8:11], s36 offen offset:0 sc1 lds
  buffer_load_dwordx4 v8, s[8:11], s36 offen offset:1024 sc1 lds
  buffer_load_dwordx4 v13, s[8:11], s36 offen offset:2048 sc1 lds
  buffer_load_dwordx4 v13, s[8:11], s36 offen offset:3072 sc1 lds
  s_add_u32 m0, s38, s45
  s_nop 0
  buffer_load_dwordx4 v9, s[12:15], s37 offen offset:0  lds
  buffer_load_dwordx4 v10, s[12:15], s37 offen offset:1024  lds
  buffer_load_dwordx4 v11, s[12:15], s37 offen offset:2048  lds
  buffer_load_dwordx4 v12, s[12:15], s37 offen offset:3072  lds
  s_add_u32 s38, s38, 32768
  s_cmp_eq_u32 s38, 163840
  s_cselect_b32 s38, 0, s38
  s_mov_b32 s39, 27
ll17:
  s_waitcnt vmcnt(16)
  s_barrier
  s_add_u32 s30, s30, 1
  s_and_b32 s30, s30, 7
  s_cselect_b32 s32, 0, 1
  s_add_u32 s31, s31, s32
  s_sub_u32 s32, s30, s7
  s_and_b32 s32, s32, 7
  s_cmp_lt_u32 s32, 2
  s_cselect_b32 s32, 1, 0
  s_add_u32 s32, s32, s31
  s_cmp_ge_u32 s32, 4
  s_cselect_b32 s32, 0, s32
  s_lshl_b32 s33, s32, 3
  s_add_u32 s33, s33, s30
  s_mul_i32 s36, s33, 2048
  s_add_u32 s36, s36, s34
  s_mul_i32 s37, s33, 458752
  s_add_u32 s37, s37, s35
  s_add_u32 m0, s38, s44
  s_nop 0
  buffer_load_dwordx4 v8, s[8:11], s36 offen offset:0 sc1 lds
  buffer_load_dwordx4 v8, s[8:11], s36 offen offset:1024 sc1 lds
  buffer_load_dwordx4 v13, s[8:11], s36 offen offset:2048 sc1 lds
  buffer_load_dwordx4 v13, s[8:11], s36 offen offset:3072 sc1 lds
  s_add_u32 m0, s38, s45
  s_nop 0
  buffer_load_dwordx4 v9, s[12:15], s37 offen offset:0  lds
  buffer_load_dwordx4 v10, s[12:15], s37 offen offset:1024  lds
  buffer_load_dwordx4 v11, s[12:15], s37 offen offset:2048  lds
  buffer_load_dwordx4 v12, s[12:15], s37 offen offset:3072  lds
  s_add_u32 s38, s38, 32768
  s_cmp_eq_u32 s38, 163840
  s_cselect_b32 s38, 0, s38
  s_sub_u32 s39, s39, 1
  s_cmp_lg_u32 s39, 0
  s_cbranch_scc1 ll17
  s_waitcnt vmcnt(16)
  s_barrier
  s_waitcnt vmcnt(8)
  s_barrier
  s_waitcnt vmcnt(0)
  s_barrier
  s_lshr_b32 s32, s2, 3
  s_lshr_b32 s5, s32, 3
  s_and_b32 s6, s32, 7
  s_lshl_b32 s7, s5, 1
  s_add_u32 s7, s7, s6
  s_and_b32 s7, s7, 7
  s_and_b32 s32, s2, 7
  s_lshr_b32 s28, s32, 2
  s_lshl_b32 s28, s28, 2
  s_add_u32 s28, s28, s5
  s_and_b32 s29, s32, 3
  s_mul_i32 s29, s29, 8
  s_add_u32 s29, s29, s6
  s_mov_b32 s30, 7
  s_mov_b32 s31, -1
  s_mov_b32 s41, s57
  s_lshl_b32 s45, s41, 11
  s_mul_i32 s32, s41, 16
  s_add_u32 s32, s32, 0
  v_lshrrev_b32 v2, 3, v0
  v_add_u32 v2, s32, v2
  v_bfe_u32 v3, v2, 1, 1
  v_bfe_u32 v4, v2, 3, 1
  v_lshl_or_b32 v3, v4, 1, v3
  v_lshlrev_b32 v3, 1, v3
  v_and_b32 v4, 7, v0
  v_xor_b32 v3, v3, v4
  v_lshlrev_b32 v3, 4, v3
  s_mov_b32 s32, 4096
  v_mul_lo_u32 v2, v2, s32
  v_add_u32 v9, v2, v3
  s_mul_i32 s32, s41, 16
  s_add_u32 s32, s32, 8
  v_lshrrev_b32 v2, 3, v0
  v_add_u32 v2, s32, v2
  v_bfe_u32 v3, v2, 1, 1
  v_bfe_u32 v4, v2, 3, 1
  v_lshl_or_b32 v3, v4, 1, v3
  v_lshlrev_b32 v3, 1, v3
  v_and_b32 v4, 7, v0
  v_xor_b32 v3, v3, v4
  v_lshlrev_b32 v3, 4, v3
  s_mov_b32 s32, 4096
  v_mul_lo_u32 v2, v2, s32
  v_add_u32 v10, v2, v3
  v_subrev_u32 v10, 1024, v10
  s_lshl_b32 s35, s29, 7
  s_mov_b32 s12, s76
  s_mov_b32 s13, s77
  s_mov_b32 s14, 14680064
  s_mov_b32 s15, 0x20000
  s_branch L_k4
L_k3skip:
  s_nop 7
  s_nop 7
  s_lshr_b32 s32, s2, 3
  s_lshr_b32 s5, s32, 3
  s_and_b32 s6, s32, 7
  s_lshl_b32 s7, s5, 1
  s_add_u32 s7, s7, s6
  s_and_b32 s7, s7, 7
  s_and_b32 s32, s2, 7
  s_lshr_b32 s28, s32, 2
  s_lshl_b32 s28, s28, 2
  s_add_u32 s28, s28, s5
  s_and_b32 s29, s32, 3
  s_mul_i32 s29, s29, 8
  s_add_u32 s29, s29, s6
  s_mov_b32 s30, 7
  s_mov_b32 s31, -1
  s_mov_b32 s41, s57
  s_lshl_b32 s45, s41, 11
  s_mul_i32 s32, s41, 16
  s_add_u32 s32, s32, 0
  v_lshrrev_b32 v2, 3, v0
  v_add_u32 v2, s32, v2
  v_bfe_u32 v3, v2, 1, 1
  v_bfe_u32 v4, v2, 3, 1
  v_lshl_or_b32 v3, v4, 1, v3
  v_lshlrev_b32 v3, 1, v3
  v_and_b32 v4, 7, v0
  v_xor_b32 v3, v3, v4
  v_lshlrev_b32 v3, 4, v3
  s_mov_b32 s32, 4096
  v_mul_lo_u32 v2, v2, s32
  v_add_u32 v9, v2, v3
  s_mul_i32 s32, s41, 16
  s_add_u32 s32, s32, 8
  v_lshrrev_b32 v2, 3, v0
  v_add_u32 v2, s32, v2
  v_bfe_u32 v3, v2, 1, 1
  v_bfe_u32 v4, v2, 3, 1
  v_lshl_or_b32 v3, v4, 1, v3
  v_lshlrev_b32 v3, 1, v3
  v_and_b32 v4, 7, v0
  v_xor_b32 v3, v3, v4
  v_lshlrev_b32 v3, 4, v3
  s_mov_b32 s32, 4096
  v_mul_lo_u32 v2, v2, s32
  v_add_u32 v10, v2, v3
  v_subrev_u32 v10, 1024, v10
  s_lshl_b32 s35, s29, 7
  s_mov_b32 s12, s76
  s_mov_b32 s13, s77
  s_mov_b32 s14, 14680064
  s_mov_b32 s15, 0x20000
  s_barrier
L_k4:
  s_nop 7
  s_nop 7
  s_mov_b32 s30, 7
  s_mov_b32 s31, -1
  s_mov_b32 s38, 98304
  s_add_u32 s30, s30, 1
  s_and_b32 s30, s30, 7
  s_cselect_b32 s32, 0, 1
  s_add_u32 s31, s31, s32
  s_sub_u32 s32, s30, s7
  s_and_b32 s32, s32, 7
  s_cmp_lt_u32 s32, 2
  s_cselect_b32 s32, 1, 0
  s_add_u32 s32, s32, s31
  s_cmp_ge_u32 s32, 7
  s_cselect_b32 s32, 0, s32
  s_lshl_b32 s33, s32, 3
  s_add_u32 s33, s33, s30
  s_mul_i32 s37, s33, 262144
  s_add_u32 s37, s37, s35
  s_add_u32 m0, s38, s45
  s_nop 0
  buffer_load_dwordx4 v9, s[12:15], s37 offen offset:0  lds
  buffer_load_dwordx4 v10, s[12:15], s37 offen offset:1024  lds
  s_add_u32 s38, s38, 8192
  s_cmp_eq_u32 s38, 163840
  s_cselect_b32 s38, 98304, s38
  s_add_u32 s30, s30, 1
  s_and_b32 s30, s30, 7
  s_cselect_b32 s32, 0, 1
  s_add_u32 s31, s31, s32
  s_sub_u32 s32, s30, s7
  s_and_b32 s32, s32, 7
  s_cmp_lt_u32 s32, 2
  s_cselect_b32 s32, 1, 0
  s_add_u32 s32, s32, s31
  s_cmp_ge_u32 s32, 7
  s_cselect_b32 s32, 0, s32
  s_lshl_b32 s33, s32, 3
  s_add_u32 s33, s33, s30
  s_mul_i32 s37, s33, 262144
  s_add_u32 s37, s37, s35
  s_add_u32 m0, s38, s45
  s_nop 0
  buffer_load_dwordx4 v9, s[12:15], s37 offen offset:0  lds
  buffer_load_dwordx4 v10, s[12:15], s37 offen offset:1024  lds
  s_add_u32 s38, s38, 8192
  s_cmp_eq_u32 s38, 163840
  s_cselect_b32 s38, 98304, s38
  s_add_u32 s30, s30, 1
  s_and_b32 s30, s30, 7
  s_cselect_b32 s32, 0, 1
  s_add_u32 s31, s31, s32
  s_sub_u32 s32, s30, s7
  s_and_b32 s32, s32, 7
  s_cmp_lt_u32 s32, 2
  s_cselect_b32 s32, 1, 0
  s_add_u32 s32, s32, s31
  s_cmp_ge_u32 s32, 7
  s_cselect_b32 s32, 0, s32
  s_lshl_b32 s33, s32, 3
  s_add_u32 s33, s33, s30
  s_mul_i32 s37, s33, 262144
  s_add_u32 s37, s37, s35
  s_add_u32 m0, s38, s45
  s_nop 0
  buffer_load_dwordx4 v9, s[12:15], s37 offen offset:0  lds
  buffer_load_dwordx4 v10, s[12:15], s37 offen offset:1024  lds
  s_add_u32 s38, s38, 8192
  s_cmp_eq_u32 s38, 163840
  s_cselect_b32 s38, 98304, s38
  s_add_u32 s30, s30, 1
  s_and_b32 s30, s30, 7
  s_cselect_b32 s32, 0, 1
  s_add_u32 s31, s31, s32
  s_sub_u32 s32, s30, s7
  s_and_b32 s32, s32, 7
  s_cmp_lt_u32 s32, 2
  s_cselect_b32 s32, 1, 0
  s_add_u32 s32, s32, s31
  s_cmp_ge_u32 s32, 7
  s_cselect_b32 s32, 0, s32
  s_lshl_b32 s33, s32, 3
  s_add_u32 s33, s33, s30
  s_mul_i32 s37, s33, 262144
  s_add_u32 s37, s37, s35
  s_add_u32 m0, s38, s45
  s_nop 0
  buffer_load_dwordx4 v9, s[12:15], s37 offen offset:0  lds
  buffer_load_dwordx4 v10, s[12:15], s37 offen offset:1024  lds
  s_add_u32 s38, s38, 8192
  s_cmp_eq_u32 s38, 163840
  s_cselect_b32 s38, 98304, s38
  s_add_u32 s30, s30, 1
  s_and_b32 s30, s30, 7
  s_cselect_b32 s32, 0, 1
  s_add_u32 s31, s31, s32
  s_sub_u32 s32, s30, s7
  s_and_b32 s32, s32, 7
  s_cmp_lt_u32 s32, 2
  s_cselect_b32 s32, 1, 0
  s_add_u32 s32, s32, s31
  s_cmp_ge_u32 s32, 7
  s_cselect_b32 s32, 0, s32
  s_lshl_b32 s33, s32, 3
  s_add_u32 s33, s33, s30
  s_mul_i32 s37, s33, 262144
  s_add_u32 s37, s37, s35
  s_add_u32 m0, s38, s45
  s_nop 0
  buffer_load_dwordx4 v9, s[12:15], s37 offen offset:0  lds
  buffer_load_dwordx4 v10, s[12:15], s37 offen offset:1024  lds
  s_add_u32 s38, s38, 8192
  s_cmp_eq_u32 s38, 163840
  s_cselect_b32 s38, 98304, s38
  s_add_u32 s30, s30, 1
  s_and_b32 s30, s30, 7
  s_cselect_b32 s32, 0, 1
  s_add_u32 s31, s31, s32
  s_sub_u32 s32, s30, s7
  s_and_b32 s32, s32, 7
  s_cmp_lt_u32 s32, 2
  s_cselect_b32 s32, 1, 0
  s_add_u32 s32, s32, s31
  s_cmp_ge_u32 s32, 7
  s_cselect_b32 s32, 0, s32
  s_lshl_b32 s33, s32, 3
  s_add_u32 s33, s33, s30
  s_mul_i32 s37, s33, 262144
  s_add_u32 s37, s37, s35
  s_add_u32 m0, s38, s45
  s_nop 0
  buffer_load_dwordx4 v9, s[12:15], s37 offen offset:0  lds
  buffer_load_dwordx4 v10, s[12:15], s37 offen offset:1024  lds
  s_add_u32 s38, s38, 8192
  s_cmp_eq_u32 s38, 163840
  s_cselect_b32 s38, 98304, s38
  s_barrier
  s_mov_b64 exec, 1
  buffer_store_dword v137, v136, s[24:27], s56 offen sc0 sc1
  s_mov_b64 exec, -1
  s_lshl_b32 s56, s3, 10
  s_mul_i32 s32, s29, 8
  s_add_u32 s56, s56, s32
  s_add_u32 s56, s56, s28
  s_add_u32 s56, s56, 768
  s_lshl_b32 s56, s56, 7
  s_barrier
  s_mov_b32 s39, 50
ll18:
  s_waitcnt vmcnt(10)
  s_barrier
  s_add_u32 s30, s30, 1
  s_and_b32 s30, s30, 7
  s_cselect_b32 s32, 0, 1
  s_add_u32 s31, s31, s32
  s_sub_u32 s32, s30, s7
  s_and_b32 s32, s32, 7
  s_cmp_lt_u32 s32, 2
  s_cselect_b32 s32, 1, 0
  s_add_u32 s32, s32, s31
  s_cmp_ge_u32 s32, 7
  s_cselect_b32 s32, 0, s32
  s_lshl_b32 s33, s32, 3
  s_add_u32 s33, s33, s30
  s_mul_i32 s37, s33, 262144
  s_add_u32 s37, s37, s35
  s_add_u32 m0, s38, s45
  s_nop 0
  buffer_load_dwordx4 v9, s[12:15], s37 offen offset:0  lds
  buffer_load_dwordx4 v10, s[12:15], s37 offen offset:1024  lds
  s_add_u32 s38, s38, 8192
  s_cmp_eq_u32 s38, 163840
  s_cselect_b32 s38, 98304, s38
  s_sub_u32 s39, s39, 1
  s_cmp_lg_u32 s39, 0
  s_cbranch_scc1 ll18
  s_waitcnt vmcnt(10)
  s_barrier
  s_waitcnt vmcnt(8)
  s_barrier
  s_waitcnt vmcnt(6)
  s_barrier
  s_waitcnt vmcnt(4)
  s_barrier
  s_waitcnt vmcnt(2)
  s_barrier
  s_waitcnt vmcnt(0)
  s_barrier
  s_cmp_lg_u32 s3, 0
  s_cbranch_scc1 L_end
  s_lshr_b32 s32, s2, 3
  s_lshr_b32 s5, s32, 3
  s_and_b32 s6, s32, 7
  s_lshl_b32 s7, s5, 1
  s_add_u32 s7, s7, s6
  s_and_b32 s7, s7, 7
  s_and_b32 s32, s2, 7
  s_lshr_b32 s28, s32, 1
  s_lshl_b32 s28, s28, 2
  s_add_u32 s28, s28, s5
  s_and_b32 s29, s32, 1
  s_mul_i32 s29, s29, 8
  s_add_u32 s29, s29, s6
  s_mov_b32 s30, 7
  s_mov_b32 s31, -1
  s_mov_b32 s41, s57
  s_mul_i32 s32, s41, 16
  s_add_u32 s32, s32, 0
  v_lshrrev_b32 v2, 3, v0
  v_add_u32 v2, s32, v2
  v_bfe_u32 v3, v2, 1, 1
  v_bfe_u32 v4, v2, 3, 1
  v_lshl_or_b32 v3, v4, 1, v3
  v_lshlrev_b32 v3, 1, v3
  v_and_b32 v4, 7, v0
  v_xor_b32 v3, v3, v4
  v_lshlrev_b32 v3, 4, v3
  s_mov_b32 s32, 6144
  v_mul_lo_u32 v2, v2, s32
  v_add_u32 v13, v2, v3
  s_mul_i32 s32, s41, 16
  s_add_u32 s32, s32, 8
  v_lshrrev_b32 v2, 3, v0
  v_add_u32 v2, s32, v2
  v_bfe_u32 v3, v2, 1, 1
  v_bfe_u32 v4, v2, 3, 1
  v_lshl_or_b32 v3, v4, 1, v3
  v_lshlrev_b32 v3, 1, v3
  v_and_b32 v4, 7, v0
  v_xor_b32 v3, v3, v4
  v_lshlrev_b32 v3, 4, v3
  s_mov_b32 s32, 6144
  v_mul_lo_u32 v2, v2, s32
  v_add_u32 v14, v2, v3
  v_subrev_u32 v14, 1024, v14
  v_add_u32 v15, 2048, v13
  v_add_u32 v16, 2048, v14
  v_add_u32 v17, 4096, v13
  v_add_u32 v18, 4096, v14
  s_lshl_b32 s46, s41, 11
  s_add_u32 s46, s46, 18432
  s_add_u32 s47, s46, 8192
  s_add_u32 s48, s46, 16384
  s_lshl_b32 s35, s29, 7
  s_mov_b32 s12, s66
  s_mov_b32 s13, s67
  s_mov_b32 s14, 6291456
  s_mov_b32 s15, 0x20000
  s_mov_b32 s30, 7
  s_mov_b32 s31, -1
  s_mov_b32 s38, 0
  s_add_u32 s30, s30, 1
  s_and_b32 s30, s30, 7
  s_cselect_b32 s32, 0, 1
  s_add_u32 s31, s31, s32
  s_sub_u32 s32, s30, s7
  s_and_b32 s32, s32, 7
  s_cmp_lt_u32 s32, 2
  s_cselect_b32 s32, 1, 0
  s_add_u32 s32, s32, s31
  s_cmp_ge_u32 s32, 2
  s_cselect_b32 s32, 0, s32
  s_lshl_b32 s33, s32, 3
  s_add_u32 s33, s33, s30
  s_mul_i32 s37, s33, 393216
  s_add_u32 s37, s37, s35
  s_add_u32 m0, s38, s46
  s_nop 0
  buffer_load_dwordx4 v13, s[12:15], s37 offen offset:0  lds
  buffer_load_dwordx4 v14, s[12:15], s37 offen offset:1024  lds
  s_add_u32 m0, s38, s47
  s_nop 0
  buffer_load_dwordx4 v15, s[12:15], s37 offen offset:0  lds
  buffer_load_dwordx4 v16, s[12:15], s37 offen offset:1024  lds
  s_add_u32 m0, s38, s48
  s_nop 0
  buffer_load_dwordx4 v17, s[12:15], s37 offen offset:0  lds
  buffer_load_dwordx4 v18, s[12:15], s37 offen offset:1024  lds
  s_add_u32 s38, s38, 43008
  s_cmp_eq_u32 s38, 129024
  s_cselect_b32 s38, 0, s38
  s_add_u32 s30, s30, 1
  s_and_b32 s30, s30, 7
  s_cselect_b32 s32, 0, 1
  s_add_u32 s31, s31, s32
  s_sub_u32 s32, s30, s7
  s_and_b32 s32, s32, 7
  s_cmp_lt_u32 s32, 2
  s_cselect_b32 s32, 1, 0
  s_add_u32 s32, s32, s31
  s_cmp_ge_u32 s32, 2
  s_cselect_b32 s32, 0, s32
  s_lshl_b32 s33, s32, 3
  s_add_u32 s33, s33, s30
  s_mul_i32 s37, s33, 393216
  s_add_u32 s37, s37, s35
  s_add_u32 m0, s38, s46
  s_nop 0
  buffer_load_dwordx4 v13, s[12:15], s37 offen offset:0  lds
  buffer_load_dwordx4 v14, s[12:15], s37 offen offset:1024  lds
  s_add_u32 m0, s38, s47
  s_nop 0
  buffer_load_dwordx4 v15, s[12:15], s37 offen offset:0  lds
  buffer_load_dwordx4 v16, s[12:15], s37 offen offset:1024  lds
  s_add_u32 m0, s38, s48
  s_nop 0
  buffer_load_dwordx4 v17, s[12:15], s37 offen offset:0  lds
  buffer_load_dwordx4 v18, s[12:15], s37 offen offset:1024  lds
  s_add_u32 s38, s38, 43008
  s_cmp_eq_u32 s38, 129024
  s_cselect_b32 s38, 0, s38
  s_lshl_b32 s40, s28, 7
  s_sub_u32 s40, s40, 16
  s_lshl_b32 s32, s41, 5
  s_add_u32 s32, s32, 16
  v_lshrrev_b32 v2, 3, v0
  v_add_u32 v2, s32, v2
  v_bfe_u32 v3, v2, 1, 3
  v_and_b32 v4, 7, v0
  v_xor_b32 v3, v3, v4
  v_lshlrev_b32 v3, 4, v3
  v_add_u32 v2, s40, v2
  v_max_i32 v2, 0, v2
  v_lshlrev_b32 v2, 11, v2
  v_add_u32 v8, v2, v3
  v_add_u32 v10, 30720, v8
  s_lshl_b32 s32, s41, 5
  s_add_u32 s32, s32, 24
  v_lshrrev_b32 v2, 3, v0
  v_add_u32 v2, s32, v2
  v_bfe_u32 v3, v2, 1, 3
  v_and_b32 v4, 7, v0
  v_xor_b32 v3, v3, v4
  v_lshlrev_b32 v3, 4, v3
  v_add_u32 v2, s40, v2
  v_max_i32 v2, 0, v2
  v_lshlrev_b32 v2, 11, v2
  v_add_u32 v9, v2, v3
  v_subrev_u32 v9, 1024, v9
  v_add_u32 v11, 30720, v9
  s_lshl_b32 s32, s41, 3
  v_lshrrev_b32 v2, 3, v0
  v_add_u32 v2, s32, v2
  v_bfe_u32 v3, v2, 1, 3
  v_and_b32 v4, 7, v0
  v_xor_b32 v3, v3, v4
  v_lshlrev_b32 v3, 4, v3
  v_add_u32 v2, s40, v2
  v_max_i32 v2, 0, v2
  v_lshlrev_b32 v2, 11, v2
  v_add_u32 v12, v2, v3
  s_lshl_b32 s44, s41, 12
  s_add_u32 s44, s44, 2048
  s_lshl_b32 s45, s41, 10
  s_mov_b32 s34, 0
  s_cmp_eq_u32 s41, 0
  s_cselect_b32 s52, 0xffffff00, -1
  s_mov_b32 s53, -1
  v_mov_b32 v20, 0x3f803f80
  v_mov_b32 v21, v20
  v_mov_b32 v22, v20
  v_mov_b32 v23, v20
  v_lshlrev_b32 v24, 4, v0
  v_add_u32 v25, 86016, v24
  s_mov_b64 exec, 0xff
  ds_write_b128 v24, v[20:23]
  ds_write_b128 v24, v[20:23] offset:43008
  ds_write_b128 v25, v[20:23]
  s_mov_b64 exec, -1
  s_lshl_b32 s32, s41, 6
  v_add_u32 v26, s32, v0
  v_min_u32 v26, 143, v26
  v_add_u32 v27, s40, v26
  v_max_i32 v27, 0, v27
  v_lshlrev_b32 v27, 3, v27
  v_lshlrev_b32 v26, 3, v26
  v_add_u32 v26, 129024, v26
  s_add_u32 s8, s84, 25165824
  s_addc_u32 s9, s85, 0
  s_mov_b32 s10, 4194304
  s_mov_b32 s11, 0x20000
  s_add_u32 s20, s84, 55574528
  s_addc_u32 s21, s85, 0
  s_mov_b32 s22, 131072
  s_mov_b32 s23, 0x20000
  s_waitcnt lgkmcnt(0)
  s_add_u32 s16, s84, 29360128
  s_addc_u32 s17, s85, 0
  s_mov_b32 s18, 262144
  s_mov_b32 s19, 0x20000
  s_lshl_b32 s32, s28, 4
  s_sub_u32 s32, s32, 8
  v_min_u32 v28, 23, v0
  v_add_u32 v28, s32, v28
  v_max_i32 v28, 0, v28
  v_lshlrev_b32 v28, 7, v28
  s_lshl_b32 s55, s3, 17
  s_add_u32 s55, s55, 98304
  s_barrier
  s_barrier
  s_mov_b64 exec, 1
  buffer_store_dword v137, v136, s[24:27], s56 offen sc0 sc1
  s_mov_b64 exec, -1
  s_mov_b32 s39, 0
  s_and_b32 s32, s4, 3
  s_cmp_lg_u32 s32, 0
  s_cbranch_scc1 poll19d
  s_sleep 8
poll19:
  buffer_load_dword v29, v28, s[16:19], s55 offen sc0 sc1
  s_waitcnt vmcnt(0)
  v_cmp_eq_u32 vcc, 0, v29
  s_add_u32 s39, s39, 1
  s_cmp_gt_u32 s39, 1000000
  s_cbranch_scc1 poll19d
  s_cbranch_vccnz poll19
poll19d:
  s_barrier
  s_mov_b32 s3, 1
  s_add_u32 s82, s84, 33554432
  s_addc_u32 s83, s85, 0
  s_branch L_top
L_end:
mega_end:
  s_endpgm
.section .rodata,"a"
.p2align 6
.amdhsa_kernel interleave_layers__sliding_local_dilated__mixer_token_mlp__prompt_kernel
  .amdhsa_next_free_vgpr 256
  .amdhsa_next_free_sgpr 102
  .amdhsa_accum_offset 256
  .amdhsa_group_segment_fixed_size 0
  .amdhsa_kernarg_size 88
  .amdhsa_user_sgpr_count 2
  .amdhsa_user_sgpr_kernarg_segment_ptr 1
  .amdhsa_system_sgpr_workgroup_id_x 1
.end_amdhsa_kernel
```

```asm
; @launch grid=(256,1,1) block=(512,1,1) lds=163840
.amdgcn_target "amdgcn-amd-amdhsa--gfx950"
.text
.globl interleave_layers__sliding_local_dilated__mixer_token_mlp__prompt_kernel
.type interleave_layers__sliding_local_dilated__mixer_token_mlp__prompt_kernel,@function
.p2align 8
interleave_layers__sliding_local_dilated__mixer_token_mlp__prompt_kernel:
  s_cmp_ge_u32 s2, 256
  s_cbranch_scc1 mega_end
  s_load_dwordx16 s[64:79], s[0:1], 0
  s_load_dwordx2 s[80:81], s[0:1], 64
  s_load_dwordx2 s[84:85], s[0:1], 80
  s_load_dwordx2 s[62:63], s[0:1], 72
  v_lshrrev_b32 v1, 6, v0
  v_and_b32 v0, 63, v0
  v_readfirstlane_b32 s4, v1
  s_mov_b32 s3, 0
  v_mov_b32 v130, 0
  v_mov_b32 v131, 0
  v_mov_b32 v134, 0
  s_cmp_ge_u32 s4, 4
  s_cbranch_scc1 L_start
  s_lshr_b32 s32, s2, 3
  s_lshr_b32 s5, s32, 3
  s_and_b32 s6, s32, 7
  s_lshl_b32 s7, s5, 1
  s_add_u32 s7, s7, s6
  s_and_b32 s7, s7, 7
  s_and_b32 s32, s2, 7
  s_lshr_b32 s28, s32, 1
  s_lshl_b32 s28, s28, 2
  s_add_u32 s28, s28, s5
  s_and_b32 s29, s32, 1
  s_mul_i32 s29, s29, 8
  s_add_u32 s29, s29, s6
  s_mov_b32 s30, 7
  s_mov_b32 s31, -1
  v_and_b32 v4, 15, v0
  v_lshrrev_b32 v5, 4, v0
  v_lshrrev_b32 v6, 2, v4
  v_and_b32 v7, 3, v0
  v_lshrrev_b32 v3, 5, v0
  v_and_b32 v2, 1, v5
  v_lshl_or_b32 v3, v2, 1, v3
  v_lshl_add_u32 v21, v5, 3, v6
  v_lshlrev_b32 v21, 7, v21
  v_lshl_add_u32 v21, v7, 3, v21
  v_lshrrev_b32 v22, 1, v6
  v_lshl_or_b32 v22, v2, 1, v22
  v_lshl_add_u32 v21, v22, 5, v21
  v_add_u32 v21, 18432, v21
  v_xor_b32 v8, 0, v21
  s_lshl_b32 s32, s4, 5
  v_xor_b32 v8, s32, v8
  v_lshrrev_b32 v21, 1, v4
  v_xor_b32 v21, v21, v5
  v_lshlrev_b32 v21, 4, v21
  v_lshlrev_b32 v22, 7, v4
  v_add_u32 v9, v21, v22
  v_xor_b32 v10, 64, v9
  v_and_b32 v21, 1, v4
  v_mul_u32_u24 v21, 28800, v21
  v_lshrrev_b32 v22, 1, v4
  v_mul_u32_u24 v22, 400, v22
  v_lshlrev_b32 v23, 3, v5
  v_add3_u32 v11, v21, v22, v23
  s_add_u32 s32, s32, 43008
  v_add_u32 v11, s32, v11
  v_lshlrev_b32 v12, 3, v4
  v_add_u32 v12, 129024, v12
  v_mov_b64 v[112:113], 0
  v_mov_b64 v[114:115], 0
  v_mov_b64 v[116:117], 0
  v_mov_b64 v[118:119], 0
  v_mov_b64 v[120:121], 0
  v_mov_b64 v[122:123], 0
  v_mov_b64 v[124:125], 0
  v_mov_b64 v[126:127], 0
  v_mov_b64 v[128:129], 0
  v_mov_b64 v[130:131], 0
  v_mov_b64 v[132:133], 0
  v_mov_b64 v[134:135], 0
  v_mov_b64 v[136:137], 0
  v_mov_b64 v[138:139], 0
  v_mov_b64 v[140:141], 0
  v_mov_b64 v[142:143], 0
  v_mov_b64 v[144:145], 0
  v_mov_b64 v[146:147], 0
  v_mov_b64 v[148:149], 0
  v_mov_b64 v[150:151], 0
  v_mov_b64 v[152:153], 0
  v_mov_b64 v[154:155], 0
  v_mov_b64 v[156:157], 0
  v_mov_b64 v[158:159], 0
  v_mov_b64 v[160:161], 0
  v_mov_b64 v[162:163], 0
  v_mov_b64 v[164:165], 0
  v_mov_b64 v[166:167], 0
  v_mov_b64 v[168:169], 0
  v_mov_b64 v[170:171], 0
  v_mov_b64 v[172:173], 0
  v_mov_b64 v[174:175], 0
  v_mov_b64 v[176:177], 0
  v_mov_b64 v[178:179], 0
  v_mov_b64 v[180:181], 0
  v_mov_b64 v[182:183], 0
  v_mov_b64 v[184:185], 0
  v_mov_b64 v[186:187], 0
  v_mov_b64 v[188:189], 0
  v_mov_b64 v[190:191], 0
  v_mov_b64 v[192:193], 0
  v_mov_b64 v[194:195], 0
  v_mov_b64 v[196:197], 0
  v_mov_b64 v[198:199], 0
  v_mov_b64 v[200:201], 0
  v_mov_b64 v[202:203], 0
  v_mov_b64 v[204:205], 0
  v_mov_b64 v[206:207], 0
  v_mov_b64 v[208:209], 0
  v_mov_b64 v[210:211], 0
  v_mov_b64 v[212:213], 0
  v_mov_b64 v[214:215], 0
  v_mov_b64 v[216:217], 0
  v_mov_b64 v[218:219], 0
  s_lshr_b32 s40, s4, 1
  s_and_b32 s41, s4, 1
  s_mul_i32 s32, s41, 28800
  s_add_u32 s32, s32, 43008
  s_lshl_b32 s49, s40, 4
  v_add_u32 v76, s49, v4
  v_lshlrev_b32 v77, 4, v5
  v_add_u32 v77, s32, v77
  v_mul_u32_u24 v78, 400, v76
  v_add_u32 v220, v78, v77
  v_add_u32 v223, 3200, v220
  v_add_u32 v220, 128, v220
  v_add_u32 v76, 16, v76
  v_min_u32 v76, 71, v76
  v_mul_u32_u24 v78, 400, v76
  v_add3_u32 v221, v78, v77, 64
  v_add_u32 v221, 64, v221
  v_lshl_add_u32 v76, v5, 2, v6
  v_add_u32 v76, s49, v76
  v_lshlrev_b32 v77, 4, v7
  v_add_u32 v77, s32, v77
  v_add_u32 v77, 256, v77
  v_mul_u32_u24 v78, 400, v76
  v_add_u32 v222, v78, v77
  v_add_u32 v76, 16, v76
  v_min_u32 v76, 71, v76
  v_mul_u32_u24 v78, 400, v76
  v_add_u32 v254, v78, v77
  s_lshl_b32 s50, s28, 2
  s_add_u32 s50, s50, s40
  s_lshl_b32 s50, s50, 17
  s_lshl_b32 s51, s29, 13
  s_add_u32 s50, s50, s51
  s_lshl_b32 s51, s41, 11
  s_add_u32 s50, s50, s51
  s_and_b32 s51, s40, 1
  s_lshl_b32 s32, s51, 1
  s_add_u32 s32, s32, s41
  s_cmp_eq_u32 s32, 3
  s_addc_u32 s32, s32, 5
  s_lshl_b32 s32, s32, 7
  s_mov_b32 vcc_lo, 0xff000000
  s_mov_b32 vcc_hi, 0
  v_mov_b32 v1, s32
  v_cndmask_b32 v1, 0, v1, vcc
  v_lshl_add_u32 v1, v0, 4, v1
  v_add_u32 v1, s50, v1
  v_lshlrev_b32 v76, 2, v5
  v_sub_u32 v76, v76, v4
  s_or_b32 s51, s28, s40
  s_cmp_eq_u32 s51, 0
  s_cselect_b32 s51, 0, -1
  v_add_u32 v77, -1, v76
  v_cmp_gt_u32 s[86:87], 8, v77
  v_add_u32 v77, 0, v76
  v_cmp_gt_u32 s[88:89], 8, v77
  v_add_u32 v77, 1, v76
  v_cmp_gt_u32 s[90:91], 8, v77
  v_add_u32 v77, 2, v76
  v_cmp_gt_u32 s[92:93], 8, v77
  v_add_u32 v77, 15, v76
  v_cmp_gt_u32 s[94:95], 8, v77
  v_add_u32 v77, 16, v76
  v_cmp_gt_u32 s[96:97], 8, v77
  v_add_u32 v77, 17, v76
  v_cmp_gt_u32 s[98:99], 8, v77
  v_add_u32 v77, 18, v76
  v_cmp_gt_u32 s[100:101], 8, v77
  s_and_b32 s86, s86, s51
  s_and_b32 s88, s88, s51
  s_and_b32 s90, s90, s51
  s_and_b32 s92, s92, s51
  s_waitcnt lgkmcnt(0)
  s_mov_b32 s82, s84
  s_mov_b32 s83, s85
  s_mov_b32 s12, s84
  s_mov_b32 s13, s85
  s_mov_b32 s14, 0
  s_mov_b32 s15, 0x20000
  s_mov_b32 s20, s66
  s_mov_b32 s21, s67
  s_mov_b32 s22, 6291456
  s_mov_b32 s23, 0x20000
  s_cmp_eq_u32 s4, 3
  s_cselect_b32 s20, s68, s20
  s_cselect_b32 s21, s69, s21
  s_cselect_b32 s22, 2097152, s22
  s_cselect_b32 s47, 0, s4
  s_lshl_b32 s47, s47, 8
  s_add_u32 s47, s47, s2
  s_lshl_b32 s47, s47, 13
  v_lshlrev_b32 v13, 7, v0
  s_barrier
  s_mov_b32 s51, s4
  s_cmp_lg_u32 s51, 0
  s_cbranch_scc1 C_wm0
  buffer_load_dword v15, v13, s[20:23], s47 offen
C_wm0:
  s_mov_b32 s16, s66
  s_mov_b32 s17, s67
  s_mov_b32 s18, 6291456
  s_mov_b32 s19, 0x20000
  s_lshr_b32 s32, s2, 3
  s_lshl_b32 s32, s32, 1
  s_add_u32 s32, s32, s4
  s_sub_u32 s32, s32, 1
  s_lshl_b32 s32, s32, 6
  v_add_u32 v16, s32, v0
  v_mul_u32_u24 v17, 21846, v16
  v_lshrrev_b32 v17, 16, v17
  v_mul_u32_u24 v18, 3, v17
  v_sub_u32 v18, v16, v18
  v_mul_u32_u24 v17, 6144, v17
  v_lshl_add_u32 v14, v18, 11, v17
  s_and_b32 s32, s2, 1
  s_lshl_b32 s32, s32, 10
  s_add_u32 s32, s32, 384
  s_sub_u32 s40, s4, 1
  s_cmp_lt_u32 s40, 2
  s_cselect_b32 s18, s18, 0
  buffer_load_dword v15, v14, s[16:19], s32 offen
C_top:
  s_nop 7
  s_nop 7
  s_mov_b32 s43, 0
  s_mov_b32 s39, 12
  s_barrier
  ds_read_b64_tr_b16 v[16:17], v8 offset:0
  ds_read_b64_tr_b16 v[18:19], v8 offset:512
  ds_read_b128 v[28:31], v9 offset:0
  ds_read_b64_tr_b16 v[20:21], v8 offset:8192
  ds_read_b64_tr_b16 v[22:23], v8 offset:8704
  ds_read_b64_tr_b16 v[24:25], v8 offset:16384
  ds_read_b64_tr_b16 v[26:27], v8 offset:16896
  ds_read_b128 v[32:35], v9 offset:2048
  ds_read_b128 v[36:39], v9 offset:4096
  ds_read_b128 v[40:43], v9 offset:6144
  ds_read_b128 v[44:47], v9 offset:8192
  ds_read_b128 v[48:51], v9 offset:10240
  ds_read_b128 v[52:55], v9 offset:12288
  ds_read_b128 v[56:59], v9 offset:14336
  ds_read_b128 v[60:63], v9 offset:16384
  s_add_u32 s40, s43, 43008
  s_cmp_eq_u32 s40, 129024
  s_cselect_b32 s40, 0, s40
  s_sub_u32 s42, s40, s43
  s_mov_b32 s43, s40
  s_waitcnt lgkmcnt(12)
  v_mfma_f32_16x16x32_bf16 v[112:115], v[16:19], v[28:31], v[112:115]
  ds_read_b64_tr_b16 v[64:65], v8 offset:4096
  s_waitcnt lgkmcnt(11)
  v_mfma_f32_16x16x32_bf16 v[148:151], v[20:23], v[28:31], v[148:151]
  ds_read_b64_tr_b16 v[66:67], v8 offset:4608
  s_waitcnt lgkmcnt(10)
  v_mfma_f32_16x16x32_bf16 v[184:187], v[24:27], v[28:31], v[184:187]
  ds_read_b128 v[76:79], v10 offset:0
  s_waitcnt lgkmcnt(10)
  v_mfma_f32_16x16x32_bf16 v[188:191], v[24:27], v[32:35], v[188:191]
  ds_read_b64_tr_b16 v[68:69], v8 offset:12288
  v_mfma_f32_16x16x32_bf16 v[152:155], v[20:23], v[32:35], v[152:155]
  ds_read_b64_tr_b16 v[70:71], v8 offset:12800
  v_mfma_f32_16x16x32_bf16 v[116:119], v[16:19], v[32:35], v[116:119]
  ds_read_b64_tr_b16 v[72:73], v8 offset:20480
  s_waitcnt lgkmcnt(12)
  v_mfma_f32_16x16x32_bf16 v[120:123], v[16:19], v[36:39], v[120:123]
  ds_read_b64_tr_b16 v[74:75], v8 offset:20992
  v_add_u32 v8, s42, v8
  v_mfma_f32_16x16x32_bf16 v[156:159], v[20:23], v[36:39], v[156:159]
  ds_read_b128 v[80:83], v10 offset:2048
  v_mfma_f32_16x16x32_bf16 v[192:195], v[24:27], v[36:39], v[192:195]
  ds_read_b128 v[84:87], v10 offset:4096
  s_waitcnt lgkmcnt(14)
  v_mfma_f32_16x16x32_bf16 v[196:199], v[24:27], v[40:43], v[196:199]
  ds_read_b128 v[88:91], v10 offset:6144
  v_mfma_f32_16x16x32_bf16 v[160:163], v[20:23], v[40:43], v[160:163]
  ds_read_b128 v[92:95], v10 offset:8192
  v_mfma_f32_16x16x32_bf16 v[124:127], v[16:19], v[40:43], v[124:127]
  ds_read_b128 v[96:99], v10 offset:10240
  s_waitcnt lgkmcnt(14)
  v_mfma_f32_16x16x32_bf16 v[128:131], v[16:19], v[44:47], v[128:131]
  ds_read_b128 v[100:103], v10 offset:12288
  v_mfma_f32_16x16x32_bf16 v[164:167], v[20:23], v[44:47], v[164:167]
  ds_read_b128 v[104:107], v10 offset:14336
  v_mfma_f32_16x16x32_bf16 v[200:203], v[24:27], v[44:47], v[200:203]
  ds_read_b128 v[108:111], v10 offset:16384
  v_add_u32 v9, s42, v9
  v_add_u32 v10, s42, v10
  v_mfma_f32_16x16x32_bf16 v[204:207], v[24:27], v[48:51], v[204:207]
  v_mfma_f32_16x16x32_bf16 v[168:171], v[20:23], v[48:51], v[168:171]
  v_mfma_f32_16x16x32_bf16 v[132:135], v[16:19], v[48:51], v[132:135]
  v_mfma_f32_16x16x32_bf16 v[136:139], v[16:19], v[52:55], v[136:139]
  v_mfma_f32_16x16x32_bf16 v[172:175], v[20:23], v[52:55], v[172:175]
  v_mfma_f32_16x16x32_bf16 v[208:211], v[24:27], v[52:55], v[208:211]
  s_waitcnt lgkmcnt(14)
  v_mfma_f32_16x16x32_bf16 v[212:215], v[24:27], v[56:59], v[212:215]
  v_mfma_f32_16x16x32_bf16 v[176:179], v[20:23], v[56:59], v[176:179]
  v_mfma_f32_16x16x32_bf16 v[140:143], v[16:19], v[56:59], v[140:143]
  v_mfma_f32_16x16x32_bf16 v[144:147], v[16:19], v[60:63], v[144:147]
  v_mfma_f32_16x16x32_bf16 v[180:183], v[20:23], v[60:63], v[180:183]
  v_mfma_f32_16x16x32_bf16 v[216:219], v[24:27], v[60:63], v[216:219]
  s_waitcnt lgkmcnt(0)
  s_barrier
  s_cmp_lg_u32 s51, 1
  s_cbranch_scc1 C_wm1
  buffer_load_dword v15, v13, s[20:23], s47 offen
C_wm1:
  v_mfma_f32_16x16x32_bf16 v[112:115], v[64:67], v[76:79], v[112:115]
  ds_read_b64_tr_b16 v[16:17], v8 offset:0
  s_add_u32 s40, s43, 43008
  v_mfma_f32_16x16x32_bf16 v[148:151], v[68:71], v[76:79], v[148:151]
  ds_read_b64_tr_b16 v[18:19], v8 offset:512
  s_cmp_eq_u32 s40, 129024
  v_mfma_f32_16x16x32_bf16 v[184:187], v[72:75], v[76:79], v[184:187]
  ds_read_b128 v[28:31], v9 offset:0
  s_cselect_b32 s40, 0, s40
  v_mfma_f32_16x16x32_bf16 v[188:191], v[72:75], v[80:83], v[188:191]
  ds_read_b64_tr_b16 v[20:21], v8 offset:8192
  s_sub_u32 s42, s40, s43
  v_mfma_f32_16x16x32_bf16 v[152:155], v[68:71], v[80:83], v[152:155]
  ds_read_b64_tr_b16 v[22:23], v8 offset:8704
  s_mov_b32 s43, s40
  v_mfma_f32_16x16x32_bf16 v[116:119], v[64:67], v[80:83], v[116:119]
  ds_read_b64_tr_b16 v[24:25], v8 offset:16384
  v_mfma_f32_16x16x32_bf16 v[120:123], v[64:67], v[84:87], v[120:123]
  ds_read_b64_tr_b16 v[26:27], v8 offset:16896
  v_mfma_f32_16x16x32_bf16 v[156:159], v[68:71], v[84:87], v[156:159]
  ds_read_b128 v[32:35], v9 offset:2048
  v_mfma_f32_16x16x32_bf16 v[192:195], v[72:75], v[84:87], v[192:195]
  ds_read_b128 v[36:39], v9 offset:4096
  v_mfma_f32_16x16x32_bf16 v[196:199], v[72:75], v[88:91], v[196:199]
  ds_read_b128 v[40:43], v9 offset:6144
  v_mfma_f32_16x16x32_bf16 v[160:163], v[68:71], v[88:91], v[160:163]
  ds_read_b128 v[44:47], v9 offset:8192
  v_mfma_f32_16x16x32_bf16 v[124:127], v[64:67], v[88:91], v[124:127]
  ds_read_b128 v[48:51], v9 offset:10240
  v_mfma_f32_16x16x32_bf16 v[128:131], v[64:67], v[92:95], v[128:131]
  ds_read_b128 v[52:55], v9 offset:12288
  v_mfma_f32_16x16x32_bf16 v[164:167], v[68:71], v[92:95], v[164:167]
  ds_read_b128 v[56:59], v9 offset:14336
  v_mfma_f32_16x16x32_bf16 v[200:203], v[72:75], v[92:95], v[200:203]
  ds_read_b128 v[60:63], v9 offset:16384
  v_mfma_f32_16x16x32_bf16 v[204:207], v[72:75], v[96:99], v[204:207]
  v_mfma_f32_16x16x32_bf16 v[168:171], v[68:71], v[96:99], v[168:171]
  v_mfma_f32_16x16x32_bf16 v[132:135], v[64:67], v[96:99], v[132:135]
  v_mfma_f32_16x16x32_bf16 v[136:139], v[64:67], v[100:103], v[136:139]
  v_mfma_f32_16x16x32_bf16 v[172:175], v[68:71], v[100:103], v[172:175]
  v_mfma_f32_16x16x32_bf16 v[208:211], v[72:75], v[100:103], v[208:211]
  v_mfma_f32_16x16x32_bf16 v[212:215], v[72:75], v[104:107], v[212:215]
  v_mfma_f32_16x16x32_bf16 v[176:179], v[68:71], v[104:107], v[176:179]
  v_mfma_f32_16x16x32_bf16 v[140:143], v[64:67], v[104:107], v[140:143]
  v_mfma_f32_16x16x32_bf16 v[144:147], v[64:67], v[108:111], v[144:147]
  v_mfma_f32_16x16x32_bf16 v[180:183], v[68:71], v[108:111], v[180:183]
  v_mfma_f32_16x16x32_bf16 v[216:219], v[72:75], v[108:111], v[216:219]
  s_waitcnt lgkmcnt(12)
  v_mfma_f32_16x16x32_bf16 v[112:115], v[16:19], v[28:31], v[112:115]
  ds_read_b64_tr_b16 v[64:65], v8 offset:4096
  s_waitcnt lgkmcnt(11)
  v_mfma_f32_16x16x32_bf16 v[148:151], v[20:23], v[28:31], v[148:151]
  ds_read_b64_tr_b16 v[66:67], v8 offset:4608
  s_waitcnt lgkmcnt(10)
  v_mfma_f32_16x16x32_bf16 v[184:187], v[24:27], v[28:31], v[184:187]
  ds_read_b128 v[76:79], v10 offset:0
  s_waitcnt lgkmcnt(10)
  v_mfma_f32_16x16x32_bf16 v[188:191], v[24:27], v[32:35], v[188:191]
  ds_read_b64_tr_b16 v[68:69], v8 offset:12288
  v_mfma_f32_16x16x32_bf16 v[152:155], v[20:23], v[32:35], v[152:155]
  ds_read_b64_tr_b16 v[70:71], v8 offset:12800
  v_mfma_f32_16x16x32_bf16 v[116:119], v[16:19], v[32:35], v[116:119]
  ds_read_b64_tr_b16 v[72:73], v8 offset:20480
  s_waitcnt lgkmcnt(12)
  v_mfma_f32_16x16x32_bf16 v[120:123], v[16:19], v[36:39], v[120:123]
  ds_read_b64_tr_b16 v[74:75], v8 offset:20992
  v_add_u32 v8, s42, v8
  v_mfma_f32_16x16x32_bf16 v[156:159], v[20:23], v[36:39], v[156:159]
  ds_read_b128 v[80:83], v10 offset:2048
  v_mfma_f32_16x16x32_bf16 v[192:195], v[24:27], v[36:39], v[192:195]
  ds_read_b128 v[84:87], v10 offset:4096
  s_waitcnt lgkmcnt(14)
  v_mfma_f32_16x16x32_bf16 v[196:199], v[24:27], v[40:43], v[196:199]
  ds_read_b128 v[88:91], v10 offset:6144
  v_mfma_f32_16x16x32_bf16 v[160:163], v[20:23], v[40:43], v[160:163]
  ds_read_b128 v[92:95], v10 offset:8192
  v_mfma_f32_16x16x32_bf16 v[124:127], v[16:19], v[40:43], v[124:127]
  ds_read_b128 v[96:99], v10 offset:10240
  s_waitcnt lgkmcnt(14)
  v_mfma_f32_16x16x32_bf16 v[128:131], v[16:19], v[44:47], v[128:131]
  ds_read_b128 v[100:103], v10 offset:12288
  v_mfma_f32_16x16x32_bf16 v[164:167], v[20:23], v[44:47], v[164:167]
  ds_read_b128 v[104:107], v10 offset:14336
  v_mfma_f32_16x16x32_bf16 v[200:203], v[24:27], v[44:47], v[200:203]
  ds_read_b128 v[108:111], v10 offset:16384
  v_add_u32 v9, s42, v9
  v_add_u32 v10, s42, v10
  v_mfma_f32_16x16x32_bf16 v[204:207], v[24:27], v[48:51], v[204:207]
  v_mfma_f32_16x16x32_bf16 v[168:171], v[20:23], v[48:51], v[168:171]
  v_mfma_f32_16x16x32_bf16 v[132:135], v[16:19], v[48:51], v[132:135]
  v_mfma_f32_16x16x32_bf16 v[136:139], v[16:19], v[52:55], v[136:139]
  v_mfma_f32_16x16x32_bf16 v[172:175], v[20:23], v[52:55], v[172:175]
  v_mfma_f32_16x16x32_bf16 v[208:211], v[24:27], v[52:55], v[208:211]
  s_waitcnt lgkmcnt(14)
  v_mfma_f32_16x16x32_bf16 v[212:215], v[24:27], v[56:59], v[212:215]
  v_mfma_f32_16x16x32_bf16 v[176:179], v[20:23], v[56:59], v[176:179]
  v_mfma_f32_16x16x32_bf16 v[140:143], v[16:19], v[56:59], v[140:143]
  v_mfma_f32_16x16x32_bf16 v[144:147], v[16:19], v[60:63], v[144:147]
  v_mfma_f32_16x16x32_bf16 v[180:183], v[20:23], v[60:63], v[180:183]
  v_mfma_f32_16x16x32_bf16 v[216:219], v[24:27], v[60:63], v[216:219]
  s_waitcnt lgkmcnt(0)
  s_barrier
  s_cmp_lg_u32 s51, 2
  s_cbranch_scc1 C_wm2
  buffer_load_dword v15, v13, s[20:23], s47 offen
C_wm2:
  v_mfma_f32_16x16x32_bf16 v[112:115], v[64:67], v[76:79], v[112:115]
  ds_read_b64_tr_b16 v[16:17], v8 offset:0
  s_add_u32 s40, s43, 43008
  v_mfma_f32_16x16x32_bf16 v[148:151], v[68:71], v[76:79], v[148:151]
  ds_read_b64_tr_b16 v[18:19], v8 offset:512
  s_cmp_eq_u32 s40, 129024
  v_mfma_f32_16x16x32_bf16 v[184:187], v[72:75], v[76:79], v[184:187]
  ds_read_b128 v[28:31], v9 offset:0
  s_cselect_b32 s40, 0, s40
  v_mfma_f32_16x16x32_bf16 v[188:191], v[72:75], v[80:83], v[188:191]
  ds_read_b64_tr_b16 v[20:21], v8 offset:8192
  s_sub_u32 s42, s40, s43
  v_mfma_f32_16x16x32_bf16 v[152:155], v[68:71], v[80:83], v[152:155]
  ds_read_b64_tr_b16 v[22:23], v8 offset:8704
  s_mov_b32 s43, s40
  v_mfma_f32_16x16x32_bf16 v[116:119], v[64:67], v[80:83], v[116:119]
  ds_read_b64_tr_b16 v[24:25], v8 offset:16384
  v_mfma_f32_16x16x32_bf16 v[120:123], v[64:67], v[84:87], v[120:123]
  ds_read_b64_tr_b16 v[26:27], v8 offset:16896
  v_mfma_f32_16x16x32_bf16 v[156:159], v[68:71], v[84:87], v[156:159]
  ds_read_b128 v[32:35], v9 offset:2048
  v_mfma_f32_16x16x32_bf16 v[192:195], v[72:75], v[84:87], v[192:195]
  ds_read_b128 v[36:39], v9 offset:4096
  v_mfma_f32_16x16x32_bf16 v[196:199], v[72:75], v[88:91], v[196:199]
  ds_read_b128 v[40:43], v9 offset:6144
  v_mfma_f32_16x16x32_bf16 v[160:163], v[68:71], v[88:91], v[160:163]
  ds_read_b128 v[44:47], v9 offset:8192
  v_mfma_f32_16x16x32_bf16 v[124:127], v[64:67], v[88:91], v[124:127]
  ds_read_b128 v[48:51], v9 offset:10240
  v_mfma_f32_16x16x32_bf16 v[128:131], v[64:67], v[92:95], v[128:131]
  ds_read_b128 v[52:55], v9 offset:12288
  v_mfma_f32_16x16x32_bf16 v[164:167], v[68:71], v[92:95], v[164:167]
  ds_read_b128 v[56:59], v9 offset:14336
  v_mfma_f32_16x16x32_bf16 v[200:203], v[72:75], v[92:95], v[200:203]
  ds_read_b128 v[60:63], v9 offset:16384
  v_mfma_f32_16x16x32_bf16 v[204:207], v[72:75], v[96:99], v[204:207]
  v_mfma_f32_16x16x32_bf16 v[168:171], v[68:71], v[96:99], v[168:171]
  v_mfma_f32_16x16x32_bf16 v[132:135], v[64:67], v[96:99], v[132:135]
  v_mfma_f32_16x16x32_bf16 v[136:139], v[64:67], v[100:103], v[136:139]
  v_mfma_f32_16x16x32_bf16 v[172:175], v[68:71], v[100:103], v[172:175]
  v_mfma_f32_16x16x32_bf16 v[208:211], v[72:75], v[100:103], v[208:211]
  v_mfma_f32_16x16x32_bf16 v[212:215], v[72:75], v[104:107], v[212:215]
  v_mfma_f32_16x16x32_bf16 v[176:179], v[68:71], v[104:107], v[176:179]
  v_mfma_f32_16x16x32_bf16 v[140:143], v[64:67], v[104:107], v[140:143]
  v_mfma_f32_16x16x32_bf16 v[144:147], v[64:67], v[108:111], v[144:147]
  v_mfma_f32_16x16x32_bf16 v[180:183], v[68:71], v[108:111], v[180:183]
  v_mfma_f32_16x16x32_bf16 v[216:219], v[72:75], v[108:111], v[216:219]
  s_waitcnt lgkmcnt(12)
  v_mfma_f32_16x16x32_bf16 v[112:115], v[16:19], v[28:31], v[112:115]
  ds_read_b64_tr_b16 v[64:65], v8 offset:4096
  s_waitcnt lgkmcnt(11)
  v_mfma_f32_16x16x32_bf16 v[148:151], v[20:23], v[28:31], v[148:151]
  ds_read_b64_tr_b16 v[66:67], v8 offset:4608
  s_waitcnt lgkmcnt(10)
  v_mfma_f32_16x16x32_bf16 v[184:187], v[24:27], v[28:31], v[184:187]
  ds_read_b128 v[76:79], v10 offset:0
  s_waitcnt lgkmcnt(10)
  v_mfma_f32_16x16x32_bf16 v[188:191], v[24:27], v[32:35], v[188:191]
  ds_read_b64_tr_b16 v[68:69], v8 offset:12288
  v_mfma_f32_16x16x32_bf16 v[152:155], v[20:23], v[32:35], v[152:155]
  ds_read_b64_tr_b16 v[70:71], v8 offset:12800
  v_mfma_f32_16x16x32_bf16 v[116:119], v[16:19], v[32:35], v[116:119]
  ds_read_b64_tr_b16 v[72:73], v8 offset:20480
  s_waitcnt lgkmcnt(12)
  v_mfma_f32_16x16x32_bf16 v[120:123], v[16:19], v[36:39], v[120:123]
  ds_read_b64_tr_b16 v[74:75], v8 offset:20992
  v_add_u32 v8, s42, v8
  v_mfma_f32_16x16x32_bf16 v[156:159], v[20:23], v[36:39], v[156:159]
  ds_read_b128 v[80:83], v10 offset:2048
  v_mfma_f32_16x16x32_bf16 v[192:195], v[24:27], v[36:39], v[192:195]
  ds_read_b128 v[84:87], v10 offset:4096
  s_waitcnt lgkmcnt(14)
  v_mfma_f32_16x16x32_bf16 v[196:199], v[24:27], v[40:43], v[196:199]
  ds_read_b128 v[88:91], v10 offset:6144
  v_mfma_f32_16x16x32_bf16 v[160:163], v[20:23], v[40:43], v[160:163]
  ds_read_b128 v[92:95], v10 offset:8192
  v_mfma_f32_16x16x32_bf16 v[124:127], v[16:19], v[40:43], v[124:127]
  ds_read_b128 v[96:99], v10 offset:10240
  s_waitcnt lgkmcnt(14)
  v_mfma_f32_16x16x32_bf16 v[128:131], v[16:19], v[44:47], v[128:131]
  ds_read_b128 v[100:103], v10 offset:12288
  v_mfma_f32_16x16x32_bf16 v[164:167], v[20:23], v[44:47], v[164:167]
  ds_read_b128 v[104:107], v10 offset:14336
  v_mfma_f32_16x16x32_bf16 v[200:203], v[24:27], v[44:47], v[200:203]
  ds_read_b128 v[108:111], v10 offset:16384
  v_add_u32 v9, s42, v9
  v_add_u32 v10, s42, v10
  v_mfma_f32_16x16x32_bf16 v[204:207], v[24:27], v[48:51], v[204:207]
  v_mfma_f32_16x16x32_bf16 v[168:171], v[20:23], v[48:51], v[168:171]
  v_mfma_f32_16x16x32_bf16 v[132:135], v[16:19], v[48:51], v[132:135]
  v_mfma_f32_16x16x32_bf16 v[136:139], v[16:19], v[52:55], v[136:139]
  v_mfma_f32_16x16x32_bf16 v[172:175], v[20:23], v[52:55], v[172:175]
  v_mfma_f32_16x16x32_bf16 v[208:211], v[24:27], v[52:55], v[208:211]
  s_waitcnt lgkmcnt(14)
  v_mfma_f32_16x16x32_bf16 v[212:215], v[24:27], v[56:59], v[212:215]
  v_mfma_f32_16x16x32_bf16 v[176:179], v[20:23], v[56:59], v[176:179]
  v_mfma_f32_16x16x32_bf16 v[140:143], v[16:19], v[56:59], v[140:143]
  v_mfma_f32_16x16x32_bf16 v[144:147], v[16:19], v[60:63], v[144:147]
  v_mfma_f32_16x16x32_bf16 v[180:183], v[20:23], v[60:63], v[180:183]
  v_mfma_f32_16x16x32_bf16 v[216:219], v[24:27], v[60:63], v[216:219]
  s_waitcnt lgkmcnt(0)
  s_barrier
  s_cmp_lg_u32 s51, 3
  s_cbranch_scc1 C_wm3
  buffer_load_dword v15, v13, s[20:23], s47 offen
C_wm3:
  v_mfma_f32_16x16x32_bf16 v[112:115], v[64:67], v[76:79], v[112:115]
  ds_read_b64_tr_b16 v[16:17], v8 offset:0
  s_add_u32 s40, s43, 43008
  v_mfma_f32_16x16x32_bf16 v[148:151], v[68:71], v[76:79], v[148:151]
  ds_read_b64_tr_b16 v[18:19], v8 offset:512
  s_cmp_eq_u32 s40, 129024
  v_mfma_f32_16x16x32_bf16 v[184:187], v[72:75], v[76:79], v[184:187]
  ds_read_b128 v[28:31], v9 offset:0
  s_cselect_b32 s40, 0, s40
  v_mfma_f32_16x16x32_bf16 v[188:191], v[72:75], v[80:83], v[188:191]
  ds_read_b64_tr_b16 v[20:21], v8 offset:8192
  s_sub_u32 s42, s40, s43
  v_mfma_f32_16x16x32_bf16 v[152:155], v[68:71], v[80:83], v[152:155]
  ds_read_b64_tr_b16 v[22:23], v8 offset:8704
  s_mov_b32 s43, s40
  v_mfma_f32_16x16x32_bf16 v[116:119], v[64:67], v[80:83], v[116:119]
  ds_read_b64_tr_b16 v[24:25], v8 offset:16384
  v_mfma_f32_16x16x32_bf16 v[120:123], v[64:67], v[84:87], v[120:123]
  ds_read_b64_tr_b16 v[26:27], v8 offset:16896
  v_mfma_f32_16x16x32_bf16 v[156:159], v[68:71], v[84:87], v[156:159]
  ds_read_b128 v[32:35], v9 offset:2048
  v_mfma_f32_16x16x32_bf16 v[192:195], v[72:75], v[84:87], v[192:195]
  ds_read_b128 v[36:39], v9 offset:4096
  v_mfma_f32_16x16x32_bf16 v[196:199], v[72:75], v[88:91], v[196:199]
  ds_read_b128 v[40:43], v9 offset:6144
  v_mfma_f32_16x16x32_bf16 v[160:163], v[68:71], v[88:91], v[160:163]
  ds_read_b128 v[44:47], v9 offset:8192
  v_mfma_f32_16x16x32_bf16 v[124:127], v[64:67], v[88:91], v[124:127]
  ds_read_b128 v[48:51], v9 offset:10240
  v_mfma_f32_16x16x32_bf16 v[128:131], v[64:67], v[92:95], v[128:131]
  ds_read_b128 v[52:55], v9 offset:12288
  v_mfma_f32_16x16x32_bf16 v[164:167], v[68:71], v[92:95], v[164:167]
  ds_read_b128 v[56:59], v9 offset:14336
  v_mfma_f32_16x16x32_bf16 v[200:203], v[72:75], v[92:95], v[200:203]
  ds_read_b128 v[60:63], v9 offset:16384
  v_mfma_f32_16x16x32_bf16 v[204:207], v[72:75], v[96:99], v[204:207]
  v_mfma_f32_16x16x32_bf16 v[168:171], v[68:71], v[96:99], v[168:171]
  v_mfma_f32_16x16x32_bf16 v[132:135], v[64:67], v[96:99], v[132:135]
  v_mfma_f32_16x16x32_bf16 v[136:139], v[64:67], v[100:103], v[136:139]
  v_mfma_f32_16x16x32_bf16 v[172:175], v[68:71], v[100:103], v[172:175]
  v_mfma_f32_16x16x32_bf16 v[208:211], v[72:75], v[100:103], v[208:211]
  v_mfma_f32_16x16x32_bf16 v[212:215], v[72:75], v[104:107], v[212:215]
  v_mfma_f32_16x16x32_bf16 v[176:179], v[68:71], v[104:107], v[176:179]
  v_mfma_f32_16x16x32_bf16 v[140:143], v[64:67], v[104:107], v[140:143]
  v_mfma_f32_16x16x32_bf16 v[144:147], v[64:67], v[108:111], v[144:147]
  v_mfma_f32_16x16x32_bf16 v[180:183], v[68:71], v[108:111], v[180:183]
  v_mfma_f32_16x16x32_bf16 v[216:219], v[72:75], v[108:111], v[216:219]
cl1:
  s_waitcnt lgkmcnt(12)
  v_mfma_f32_16x16x32_bf16 v[112:115], v[16:19], v[28:31], v[112:115]
  ds_read_b64_tr_b16 v[64:65], v8 offset:4096
  s_waitcnt lgkmcnt(11)
  v_mfma_f32_16x16x32_bf16 v[148:151], v[20:23], v[28:31], v[148:151]
  ds_read_b64_tr_b16 v[66:67], v8 offset:4608
  s_waitcnt lgkmcnt(10)
  v_mfma_f32_16x16x32_bf16 v[184:187], v[24:27], v[28:31], v[184:187]
  ds_read_b128 v[76:79], v10 offset:0
  s_waitcnt lgkmcnt(10)
  v_mfma_f32_16x16x32_bf16 v[188:191], v[24:27], v[32:35], v[188:191]
  ds_read_b64_tr_b16 v[68:69], v8 offset:12288
  v_mfma_f32_16x16x32_bf16 v[152:155], v[20:23], v[32:35], v[152:155]
  ds_read_b64_tr_b16 v[70:71], v8 offset:12800
  v_mfma_f32_16x16x32_bf16 v[116:119], v[16:19], v[32:35], v[116:119]
  ds_read_b64_tr_b16 v[72:73], v8 offset:20480
  s_waitcnt lgkmcnt(12)
  v_mfma_f32_16x16x32_bf16 v[120:123], v[16:19], v[36:39], v[120:123]
  ds_read_b64_tr_b16 v[74:75], v8 offset:20992
  v_add_u32 v8, s42, v8
  v_mfma_f32_16x16x32_bf16 v[156:159], v[20:23], v[36:39], v[156:159]
  ds_read_b128 v[80:83], v10 offset:2048
  v_mfma_f32_16x16x32_bf16 v[192:195], v[24:27], v[36:39], v[192:195]
  ds_read_b128 v[84:87], v10 offset:4096
  s_waitcnt lgkmcnt(14)
  v_mfma_f32_16x16x32_bf16 v[196:199], v[24:27], v[40:43], v[196:199]
  ds_read_b128 v[88:91], v10 offset:6144
  v_mfma_f32_16x16x32_bf16 v[160:163], v[20:23], v[40:43], v[160:163]
  ds_read_b128 v[92:95], v10 offset:8192
  v_mfma_f32_16x16x32_bf16 v[124:127], v[16:19], v[40:43], v[124:127]
  ds_read_b128 v[96:99], v10 offset:10240
  s_waitcnt lgkmcnt(14)
  v_mfma_f32_16x16x32_bf16 v[128:131], v[16:19], v[44:47], v[128:131]
  ds_read_b128 v[100:103], v10 offset:12288
  v_mfma_f32_16x16x32_bf16 v[164:167], v[20:23], v[44:47], v[164:167]
  ds_read_b128 v[104:107], v10 offset:14336
  v_mfma_f32_16x16x32_bf16 v[200:203], v[24:27], v[44:47], v[200:203]
  ds_read_b128 v[108:111], v10 offset:16384
  v_add_u32 v9, s42, v9
  v_add_u32 v10, s42, v10
  v_mfma_f32_16x16x32_bf16 v[204:207], v[24:27], v[48:51], v[204:207]
  v_mfma_f32_16x16x32_bf16 v[168:171], v[20:23], v[48:51], v[168:171]
  v_mfma_f32_16x16x32_bf16 v[132:135], v[16:19], v[48:51], v[132:135]
  v_mfma_f32_16x16x32_bf16 v[136:139], v[16:19], v[52:55], v[136:139]
  v_mfma_f32_16x16x32_bf16 v[172:175], v[20:23], v[52:55], v[172:175]
  v_mfma_f32_16x16x32_bf16 v[208:211], v[24:27], v[52:55], v[208:211]
  s_waitcnt lgkmcnt(14)
  v_mfma_f32_16x16x32_bf16 v[212:215], v[24:27], v[56:59], v[212:215]
  v_mfma_f32_16x16x32_bf16 v[176:179], v[20:23], v[56:59], v[176:179]
  v_mfma_f32_16x16x32_bf16 v[140:143], v[16:19], v[56:59], v[140:143]
  v_mfma_f32_16x16x32_bf16 v[144:147], v[16:19], v[60:63], v[144:147]
  v_mfma_f32_16x16x32_bf16 v[180:183], v[20:23], v[60:63], v[180:183]
  v_mfma_f32_16x16x32_bf16 v[216:219], v[24:27], v[60:63], v[216:219]
  s_waitcnt lgkmcnt(0)
  s_barrier
  v_mfma_f32_16x16x32_bf16 v[112:115], v[64:67], v[76:79], v[112:115]
  ds_read_b64_tr_b16 v[16:17], v8 offset:0
  s_add_u32 s40, s43, 43008
  v_mfma_f32_16x16x32_bf16 v[148:151], v[68:71], v[76:79], v[148:151]
  ds_read_b64_tr_b16 v[18:19], v8 offset:512
  s_cmp_eq_u32 s40, 129024
  v_mfma_f32_16x16x32_bf16 v[184:187], v[72:75], v[76:79], v[184:187]
  ds_read_b128 v[28:31], v9 offset:0
  s_cselect_b32 s40, 0, s40
  v_mfma_f32_16x16x32_bf16 v[188:191], v[72:75], v[80:83], v[188:191]
  ds_read_b64_tr_b16 v[20:21], v8 offset:8192
  s_sub_u32 s42, s40, s43
  v_mfma_f32_16x16x32_bf16 v[152:155], v[68:71], v[80:83], v[152:155]
  ds_read_b64_tr_b16 v[22:23], v8 offset:8704
  s_mov_b32 s43, s40
  v_mfma_f32_16x16x32_bf16 v[116:119], v[64:67], v[80:83], v[116:119]
  ds_read_b64_tr_b16 v[24:25], v8 offset:16384
  v_mfma_f32_16x16x32_bf16 v[120:123], v[64:67], v[84:87], v[120:123]
  ds_read_b64_tr_b16 v[26:27], v8 offset:16896
  v_mfma_f32_16x16x32_bf16 v[156:159], v[68:71], v[84:87], v[156:159]
  ds_read_b128 v[32:35], v9 offset:2048
  v_mfma_f32_16x16x32_bf16 v[192:195], v[72:75], v[84:87], v[192:195]
  ds_read_b128 v[36:39], v9 offset:4096
  v_mfma_f32_16x16x32_bf16 v[196:199], v[72:75], v[88:91], v[196:199]
  ds_read_b128 v[40:43], v9 offset:6144
  v_mfma_f32_16x16x32_bf16 v[160:163], v[68:71], v[88:91], v[160:163]
  ds_read_b128 v[44:47], v9 offset:8192
  v_mfma_f32_16x16x32_bf16 v[124:127], v[64:67], v[88:91], v[124:127]
  ds_read_b128 v[48:51], v9 offset:10240
  v_mfma_f32_16x16x32_bf16 v[128:131], v[64:67], v[92:95], v[128:131]
  ds_read_b128 v[52:55], v9 offset:12288
  v_mfma_f32_16x16x32_bf16 v[164:167], v[68:71], v[92:95], v[164:167]
  ds_read_b128 v[56:59], v9 offset:14336
  v_mfma_f32_16x16x32_bf16 v[200:203], v[72:75], v[92:95], v[200:203]
  ds_read_b128 v[60:63], v9 offset:16384
  v_mfma_f32_16x16x32_bf16 v[204:207], v[72:75], v[96:99], v[204:207]
  v_mfma_f32_16x16x32_bf16 v[168:171], v[68:71], v[96:99], v[168:171]
  v_mfma_f32_16x16x32_bf16 v[132:135], v[64:67], v[96:99], v[132:135]
  v_mfma_f32_16x16x32_bf16 v[136:139], v[64:67], v[100:103], v[136:139]
  v_mfma_f32_16x16x32_bf16 v[172:175], v[68:71], v[100:103], v[172:175]
  v_mfma_f32_16x16x32_bf16 v[208:211], v[72:75], v[100:103], v[208:211]
  v_mfma_f32_16x16x32_bf16 v[212:215], v[72:75], v[104:107], v[212:215]
  v_mfma_f32_16x16x32_bf16 v[176:179], v[68:71], v[104:107], v[176:179]
  v_mfma_f32_16x16x32_bf16 v[140:143], v[64:67], v[104:107], v[140:143]
  v_mfma_f32_16x16x32_bf16 v[144:147], v[64:67], v[108:111], v[144:147]
  v_mfma_f32_16x16x32_bf16 v[180:183], v[68:71], v[108:111], v[180:183]
  v_mfma_f32_16x16x32_bf16 v[216:219], v[72:75], v[108:111], v[216:219]
  s_sub_u32 s39, s39, 1
  s_cmp_lg_u32 s39, 0
  s_cbranch_scc1 cl1
  s_waitcnt lgkmcnt(12)
  v_mfma_f32_16x16x32_bf16 v[112:115], v[16:19], v[28:31], v[112:115]
  ds_read_b64_tr_b16 v[64:65], v8 offset:4096
  s_waitcnt lgkmcnt(11)
  v_mfma_f32_16x16x32_bf16 v[148:151], v[20:23], v[28:31], v[148:151]
  ds_read_b64_tr_b16 v[66:67], v8 offset:4608
  s_waitcnt lgkmcnt(10)
  v_mfma_f32_16x16x32_bf16 v[184:187], v[24:27], v[28:31], v[184:187]
  ds_read_b128 v[76:79], v10 offset:0
  s_waitcnt lgkmcnt(10)
  v_mfma_f32_16x16x32_bf16 v[188:191], v[24:27], v[32:35], v[188:191]
  ds_read_b64_tr_b16 v[68:69], v8 offset:12288
  v_mfma_f32_16x16x32_bf16 v[152:155], v[20:23], v[32:35], v[152:155]
  ds_read_b64_tr_b16 v[70:71], v8 offset:12800
  v_mfma_f32_16x16x32_bf16 v[116:119], v[16:19], v[32:35], v[116:119]
  ds_read_b64_tr_b16 v[72:73], v8 offset:20480
  s_waitcnt lgkmcnt(12)
  v_mfma_f32_16x16x32_bf16 v[120:123], v[16:19], v[36:39], v[120:123]
  ds_read_b64_tr_b16 v[74:75], v8 offset:20992
  v_mfma_f32_16x16x32_bf16 v[156:159], v[20:23], v[36:39], v[156:159]
  ds_read_b128 v[80:83], v10 offset:2048
  v_mfma_f32_16x16x32_bf16 v[192:195], v[24:27], v[36:39], v[192:195]
  ds_read_b128 v[84:87], v10 offset:4096
  s_waitcnt lgkmcnt(14)
  v_mfma_f32_16x16x32_bf16 v[196:199], v[24:27], v[40:43], v[196:199]
  ds_read_b128 v[88:91], v10 offset:6144
  v_mfma_f32_16x16x32_bf16 v[160:163], v[20:23], v[40:43], v[160:163]
  ds_read_b128 v[92:95], v10 offset:8192
  v_mfma_f32_16x16x32_bf16 v[124:127], v[16:19], v[40:43], v[124:127]
  ds_read_b128 v[96:99], v10 offset:10240
  s_waitcnt lgkmcnt(14)
  v_mfma_f32_16x16x32_bf16 v[128:131], v[16:19], v[44:47], v[128:131]
  ds_read_b128 v[100:103], v10 offset:12288
  v_mfma_f32_16x16x32_bf16 v[164:167], v[20:23], v[44:47], v[164:167]
  ds_read_b128 v[104:107], v10 offset:14336
  v_mfma_f32_16x16x32_bf16 v[200:203], v[24:27], v[44:47], v[200:203]
  ds_read_b128 v[108:111], v10 offset:16384
  v_mfma_f32_16x16x32_bf16 v[204:207], v[24:27], v[48:51], v[204:207]
  ds_read_b64 v[224:225], v12 offset:0
  v_mfma_f32_16x16x32_bf16 v[168:171], v[20:23], v[48:51], v[168:171]
  ds_read_b64 v[226:227], v12 offset:128
  v_mfma_f32_16x16x32_bf16 v[132:135], v[16:19], v[48:51], v[132:135]
  ds_read_b64 v[228:229], v12 offset:256
  v_mfma_f32_16x16x32_bf16 v[136:139], v[16:19], v[52:55], v[136:139]
  ds_read_b64 v[230:231], v12 offset:384
  v_mfma_f32_16x16x32_bf16 v[172:175], v[20:23], v[52:55], v[172:175]
  ds_read_b64 v[232:233], v12 offset:512
  v_mfma_f32_16x16x32_bf16 v[208:211], v[24:27], v[52:55], v[208:211]
  ds_read_b64 v[234:235], v12 offset:640
  s_waitcnt lgkmcnt(14)
  v_mfma_f32_16x16x32_bf16 v[212:215], v[24:27], v[56:59], v[212:215]
  ds_read_b64 v[236:237], v12 offset:768
  v_mfma_f32_16x16x32_bf16 v[176:179], v[20:23], v[56:59], v[176:179]
  ds_read_b64 v[238:239], v12 offset:896
  v_mfma_f32_16x16x32_bf16 v[140:143], v[16:19], v[56:59], v[140:143]
  ds_read_b64 v[240:241], v12 offset:1024
  v_mfma_f32_16x16x32_bf16 v[144:147], v[16:19], v[60:63], v[144:147]
  v_mfma_f32_16x16x32_bf16 v[180:183], v[20:23], v[60:63], v[180:183]
  v_mfma_f32_16x16x32_bf16 v[216:219], v[24:27], v[60:63], v[216:219]
  s_waitcnt lgkmcnt(0)
  v_mfma_f32_16x16x32_bf16 v[112:115], v[64:67], v[76:79], v[112:115]
  v_mfma_f32_16x16x32_bf16 v[148:151], v[68:71], v[76:79], v[148:151]
  v_mfma_f32_16x16x32_bf16 v[184:187], v[72:75], v[76:79], v[184:187]
  v_mfma_f32_16x16x32_bf16 v[188:191], v[72:75], v[80:83], v[188:191]
  s_nop 4
  v_mov_b32_dpp v242, v112 row_newbcast:0 row_mask:0xf bank_mask:0xf
  v_mov_b32_dpp v243, v113 row_newbcast:0 row_mask:0xf bank_mask:0xf
  v_mov_b32_dpp v244, v114 row_newbcast:0 row_mask:0xf bank_mask:0xf
  v_mov_b32_dpp v245, v115 row_newbcast:0 row_mask:0xf bank_mask:0xf
  v_mov_b32_dpp v246, v148 row_newbcast:0 row_mask:0xf bank_mask:0xf
  v_mov_b32_dpp v247, v149 row_newbcast:0 row_mask:0xf bank_mask:0xf
  v_mov_b32_dpp v248, v150 row_newbcast:0 row_mask:0xf bank_mask:0xf
  v_mfma_f32_16x16x32_bf16 v[152:155], v[68:71], v[80:83], v[152:155]
  v_mov_b32_dpp v249, v151 row_newbcast:0 row_mask:0xf bank_mask:0xf
  v_mov_b32_dpp v250, v184 row_newbcast:0 row_mask:0xf bank_mask:0xf
  v_mov_b32_dpp v251, v185 row_newbcast:0 row_mask:0xf bank_mask:0xf
  v_mov_b32_dpp v252, v186 row_newbcast:0 row_mask:0xf bank_mask:0xf
  v_mov_b32_dpp v253, v187 row_newbcast:0 row_mask:0xf bank_mask:0xf
  v_pk_fma_f32 v[148:149], v[246:247], v[224:225], v[148:149] op_sel_hi:[1,0,1] neg_lo:[0,1,0] neg_hi:[0,1,0]
  v_pk_fma_f32 v[150:151], v[248:249], v[224:225], v[150:151] op_sel_hi:[1,0,1] neg_lo:[0,1,0] neg_hi:[0,1,0]
  v_mfma_f32_16x16x32_bf16 v[116:119], v[64:67], v[80:83], v[116:119]
  v_pk_fma_f32 v[184:185], v[250:251], v[224:225], v[184:185] op_sel_hi:[1,0,1] neg_lo:[0,1,0] neg_hi:[0,1,0]
  v_pk_fma_f32 v[186:187], v[252:253], v[224:225], v[186:187] op_sel_hi:[1,0,1] neg_lo:[0,1,0] neg_hi:[0,1,0]
  v_pk_mul_f32 v[148:149], v[148:149], v[224:225] op_sel:[0,1] op_sel_hi:[1,1]
  v_pk_mul_f32 v[150:151], v[150:151], v[224:225] op_sel:[0,1] op_sel_hi:[1,1]
  v_pk_mul_f32 v[184:185], v[184:185], v[224:225] op_sel:[0,1] op_sel_hi:[1,1]
  v_pk_mul_f32 v[186:187], v[186:187], v[224:225] op_sel:[0,1] op_sel_hi:[1,1]
  v_cvt_pk_bf16_f32 v16, v148, v149
  v_mfma_f32_16x16x32_bf16 v[120:123], v[64:67], v[84:87], v[120:123]
  v_cvt_pk_bf16_f32 v17, v150, v151
  ds_write_b64 v11, v[16:17] offset:128
  v_cvt_pk_bf16_f32 v18, v184, v185
  v_cvt_pk_bf16_f32 v19, v186, v187
  ds_write_b64 v11, v[18:19] offset:256
  v_pk_fma_f32 v[116:117], v[242:243], v[226:227], v[116:117] op_sel_hi:[1,0,1] neg_lo:[0,1,0] neg_hi:[0,1,0]
  v_pk_fma_f32 v[118:119], v[244:245], v[226:227], v[118:119] op_sel_hi:[1,0,1] neg_lo:[0,1,0] neg_hi:[0,1,0]
  v_mfma_f32_16x16x32_bf16 v[156:159], v[68:71], v[84:87], v[156:159]
  v_pk_fma_f32 v[152:153], v[246:247], v[226:227], v[152:153] op_sel_hi:[1,0,1] neg_lo:[0,1,0] neg_hi:[0,1,0]
  v_pk_fma_f32 v[154:155], v[248:249], v[226:227], v[154:155] op_sel_hi:[1,0,1] neg_lo:[0,1,0] neg_hi:[0,1,0]
  v_pk_fma_f32 v[188:189], v[250:251], v[226:227], v[188:189] op_sel_hi:[1,0,1] neg_lo:[0,1,0] neg_hi:[0,1,0]
  v_pk_fma_f32 v[190:191], v[252:253], v[226:227], v[190:191] op_sel_hi:[1,0,1] neg_lo:[0,1,0] neg_hi:[0,1,0]
  v_pk_mul_f32 v[116:117], v[116:117], v[226:227] op_sel:[0,1] op_sel_hi:[1,1]
  v_pk_mul_f32 v[118:119], v[118:119], v[226:227] op_sel:[0,1] op_sel_hi:[1,1]
  v_pk_mul_f32 v[152:153], v[152:153], v[226:227] op_sel:[0,1] op_sel_hi:[1,1]
  v_mfma_f32_16x16x32_bf16 v[192:195], v[72:75], v[84:87], v[192:195]
  v_pk_mul_f32 v[154:155], v[154:155], v[226:227] op_sel:[0,1] op_sel_hi:[1,1]
  v_pk_mul_f32 v[188:189], v[188:189], v[226:227] op_sel:[0,1] op_sel_hi:[1,1]
  v_pk_mul_f32 v[190:191], v[190:191], v[226:227] op_sel:[0,1] op_sel_hi:[1,1]
  v_cvt_pk_bf16_f32 v22, v116, v117
  v_cvt_pk_bf16_f32 v23, v118, v119
  ds_write_b64 v11, v[22:23] offset:3200
  v_cvt_pk_bf16_f32 v24, v152, v153
  v_mfma_f32_16x16x32_bf16 v[196:199], v[72:75], v[88:91], v[196:199]
  v_cvt_pk_bf16_f32 v25, v154, v155
  ds_write_b64 v11, v[24:25] offset:3328
  v_cvt_pk_bf16_f32 v26, v188, v189
  v_cvt_pk_bf16_f32 v27, v190, v191
  ds_write_b64 v11, v[26:27] offset:3456
  v_pk_fma_f32 v[120:121], v[242:243], v[228:229], v[120:121] op_sel_hi:[1,0,1] neg_lo:[0,1,0] neg_hi:[0,1,0]
  v_pk_fma_f32 v[122:123], v[244:245], v[228:229], v[122:123] op_sel_hi:[1,0,1] neg_lo:[0,1,0] neg_hi:[0,1,0]
  v_mfma_f32_16x16x32_bf16 v[160:163], v[68:71], v[88:91], v[160:163]
  v_pk_fma_f32 v[156:157], v[246:247], v[228:229], v[156:157] op_sel_hi:[1,0,1] neg_lo:[0,1,0] neg_hi:[0,1,0]
  v_pk_fma_f32 v[158:159], v[248:249], v[228:229], v[158:159] op_sel_hi:[1,0,1] neg_lo:[0,1,0] neg_hi:[0,1,0]
  v_pk_fma_f32 v[192:193], v[250:251], v[228:229], v[192:193] op_sel_hi:[1,0,1] neg_lo:[0,1,0] neg_hi:[0,1,0]
  v_pk_fma_f32 v[194:195], v[252:253], v[228:229], v[194:195] op_sel_hi:[1,0,1] neg_lo:[0,1,0] neg_hi:[0,1,0]
  v_pk_mul_f32 v[120:121], v[120:121], v[228:229] op_sel:[0,1] op_sel_hi:[1,1]
  v_pk_mul_f32 v[122:123], v[122:123], v[228:229] op_sel:[0,1] op_sel_hi:[1,1]
  v_pk_mul_f32 v[156:157], v[156:157], v[228:229] op_sel:[0,1] op_sel_hi:[1,1]
  v_mfma_f32_16x16x32_bf16 v[124:127], v[64:67], v[88:91], v[124:127]
  v_pk_mul_f32 v[158:159], v[158:159], v[228:229] op_sel:[0,1] op_sel_hi:[1,1]
  v_pk_mul_f32 v[192:193], v[192:193], v[228:229] op_sel:[0,1] op_sel_hi:[1,1]
  v_pk_mul_f32 v[194:195], v[194:195], v[228:229] op_sel:[0,1] op_sel_hi:[1,1]
  v_cvt_pk_bf16_f32 v28, v120, v121
  v_cvt_pk_bf16_f32 v29, v122, v123
  ds_write_b64 v11, v[28:29] offset:6400
  v_cvt_pk_bf16_f32 v30, v156, v157
  v_mfma_f32_16x16x32_bf16 v[128:131], v[64:67], v[92:95], v[128:131]
  v_cvt_pk_bf16_f32 v31, v158, v159
  ds_write_b64 v11, v[30:31] offset:6528
  v_cvt_pk_bf16_f32 v32, v192, v193
  v_cvt_pk_bf16_f32 v33, v194, v195
  ds_write_b64 v11, v[32:33] offset:6656
  v_pk_fma_f32 v[124:125], v[242:243], v[230:231], v[124:125] op_sel_hi:[1,0,1] neg_lo:[0,1,0] neg_hi:[0,1,0]
  v_pk_fma_f32 v[126:127], v[244:245], v[230:231], v[126:127] op_sel_hi:[1,0,1] neg_lo:[0,1,0] neg_hi:[0,1,0]
  v_mfma_f32_16x16x32_bf16 v[164:167], v[68:71], v[92:95], v[164:167]
  v_pk_fma_f32 v[160:161], v[246:247], v[230:231], v[160:161] op_sel_hi:[1,0,1] neg_lo:[0,1,0] neg_hi:[0,1,0]
  v_pk_fma_f32 v[162:163], v[248:249], v[230:231], v[162:163] op_sel_hi:[1,0,1] neg_lo:[0,1,0] neg_hi:[0,1,0]
  v_pk_fma_f32 v[196:197], v[250:251], v[230:231], v[196:197] op_sel_hi:[1,0,1] neg_lo:[0,1,0] neg_hi:[0,1,0]
  v_pk_fma_f32 v[198:199], v[252:253], v[230:231], v[198:199] op_sel_hi:[1,0,1] neg_lo:[0,1,0] neg_hi:[0,1,0]
  v_pk_mul_f32 v[124:125], v[124:125], v[230:231] op_sel:[0,1] op_sel_hi:[1,1]
  v_pk_mul_f32 v[126:127], v[126:127], v[230:231] op_sel:[0,1] op_sel_hi:[1,1]
  v_pk_mul_f32 v[160:161], v[160:161], v[230:231] op_sel:[0,1] op_sel_hi:[1,1]
  v_mfma_f32_16x16x32_bf16 v[200:203], v[72:75], v[92:95], v[200:203]
  v_pk_mul_f32 v[162:163], v[162:163], v[230:231] op_sel:[0,1] op_sel_hi:[1,1]
  v_pk_mul_f32 v[196:197], v[196:197], v[230:231] op_sel:[0,1] op_sel_hi:[1,1]
  v_pk_mul_f32 v[198:199], v[198:199], v[230:231] op_sel:[0,1] op_sel_hi:[1,1]
  v_cvt_pk_bf16_f32 v34, v124, v125
  v_cvt_pk_bf16_f32 v35, v126, v127
  ds_write_b64 v11, v[34:35] offset:9600
  v_cvt_pk_bf16_f32 v36, v160, v161
  v_mfma_f32_16x16x32_bf16 v[204:207], v[72:75], v[96:99], v[204:207]
  v_cvt_pk_bf16_f32 v37, v162, v163
  ds_write_b64 v11, v[36:37] offset:9728
  v_cvt_pk_bf16_f32 v38, v196, v197
  v_cvt_pk_bf16_f32 v39, v198, v199
  ds_write_b64 v11, v[38:39] offset:9856
  v_pk_fma_f32 v[128:129], v[242:243], v[232:233], v[128:129] op_sel_hi:[1,0,1] neg_lo:[0,1,0] neg_hi:[0,1,0]
  v_pk_fma_f32 v[130:131], v[244:245], v[232:233], v[130:131] op_sel_hi:[1,0,1] neg_lo:[0,1,0] neg_hi:[0,1,0]
  v_mfma_f32_16x16x32_bf16 v[168:171], v[68:71], v[96:99], v[168:171]
  v_pk_fma_f32 v[164:165], v[246:247], v[232:233], v[164:165] op_sel_hi:[1,0,1] neg_lo:[0,1,0] neg_hi:[0,1,0]
  v_pk_fma_f32 v[166:167], v[248:249], v[232:233], v[166:167] op_sel_hi:[1,0,1] neg_lo:[0,1,0] neg_hi:[0,1,0]
  v_pk_fma_f32 v[200:201], v[250:251], v[232:233], v[200:201] op_sel_hi:[1,0,1] neg_lo:[0,1,0] neg_hi:[0,1,0]
  v_pk_fma_f32 v[202:203], v[252:253], v[232:233], v[202:203] op_sel_hi:[1,0,1] neg_lo:[0,1,0] neg_hi:[0,1,0]
  v_pk_mul_f32 v[128:129], v[128:129], v[232:233] op_sel:[0,1] op_sel_hi:[1,1]
  v_pk_mul_f32 v[130:131], v[130:131], v[232:233] op_sel:[0,1] op_sel_hi:[1,1]
  v_pk_mul_f32 v[164:165], v[164:165], v[232:233] op_sel:[0,1] op_sel_hi:[1,1]
  v_mfma_f32_16x16x32_bf16 v[132:135], v[64:67], v[96:99], v[132:135]
  v_pk_mul_f32 v[166:167], v[166:167], v[232:233] op_sel:[0,1] op_sel_hi:[1,1]
  v_pk_mul_f32 v[200:201], v[200:201], v[232:233] op_sel:[0,1] op_sel_hi:[1,1]
  v_pk_mul_f32 v[202:203], v[202:203], v[232:233] op_sel:[0,1] op_sel_hi:[1,1]
  v_cvt_pk_bf16_f32 v40, v128, v129
  v_cvt_pk_bf16_f32 v41, v130, v131
  ds_write_b64 v11, v[40:41] offset:12800
  v_cvt_pk_bf16_f32 v42, v164, v165
  v_mfma_f32_16x16x32_bf16 v[136:139], v[64:67], v[100:103], v[136:139]
  v_cvt_pk_bf16_f32 v43, v166, v167
  ds_write_b64 v11, v[42:43] offset:12928
  v_cvt_pk_bf16_f32 v44, v200, v201
  v_cvt_pk_bf16_f32 v45, v202, v203
  ds_write_b64 v11, v[44:45] offset:13056
  v_pk_fma_f32 v[132:133], v[242:243], v[234:235], v[132:133] op_sel_hi:[1,0,1] neg_lo:[0,1,0] neg_hi:[0,1,0]
  v_pk_fma_f32 v[134:135], v[244:245], v[234:235], v[134:135] op_sel_hi:[1,0,1] neg_lo:[0,1,0] neg_hi:[0,1,0]
  v_mfma_f32_16x16x32_bf16 v[172:175], v[68:71], v[100:103], v[172:175]
  v_pk_fma_f32 v[168:169], v[246:247], v[234:235], v[168:169] op_sel_hi:[1,0,1] neg_lo:[0,1,0] neg_hi:[0,1,0]
  v_pk_fma_f32 v[170:171], v[248:249], v[234:235], v[170:171] op_sel_hi:[1,0,1] neg_lo:[0,1,0] neg_hi:[0,1,0]
  v_pk_fma_f32 v[204:205], v[250:251], v[234:235], v[204:205] op_sel_hi:[1,0,1] neg_lo:[0,1,0] neg_hi:[0,1,0]
  v_pk_fma_f32 v[206:207], v[252:253], v[234:235], v[206:207] op_sel_hi:[1,0,1] neg_lo:[0,1,0] neg_hi:[0,1,0]
  v_pk_mul_f32 v[132:133], v[132:133], v[234:235] op_sel:[0,1] op_sel_hi:[1,1]
  v_pk_mul_f32 v[134:135], v[134:135], v[234:235] op_sel:[0,1] op_sel_hi:[1,1]
  v_pk_mul_f32 v[168:169], v[168:169], v[234:235] op_sel:[0,1] op_sel_hi:[1,1]
  v_mfma_f32_16x16x32_bf16 v[208:211], v[72:75], v[100:103], v[208:211]
  v_pk_mul_f32 v[170:171], v[170:171], v[234:235] op_sel:[0,1] op_sel_hi:[1,1]
  v_pk_mul_f32 v[204:205], v[204:205], v[234:235] op_sel:[0,1] op_sel_hi:[1,1]
  v_pk_mul_f32 v[206:207], v[206:207], v[234:235] op_sel:[0,1] op_sel_hi:[1,1]
  v_cvt_pk_bf16_f32 v46, v132, v133
  v_cvt_pk_bf16_f32 v47, v134, v135
  ds_write_b64 v11, v[46:47] offset:16000
  v_cvt_pk_bf16_f32 v48, v168, v169
  v_mfma_f32_16x16x32_bf16 v[212:215], v[72:75], v[104:107], v[212:215]
  v_cvt_pk_bf16_f32 v49, v170, v171
  ds_write_b64 v11, v[48:49] offset:16128
  v_cvt_pk_bf16_f32 v50, v204, v205
  v_cvt_pk_bf16_f32 v51, v206, v207
  ds_write_b64 v11, v[50:51] offset:16256
  v_pk_fma_f32 v[136:137], v[242:243], v[236:237], v[136:137] op_sel_hi:[1,0,1] neg_lo:[0,1,0] neg_hi:[0,1,0]
  v_pk_fma_f32 v[138:139], v[244:245], v[236:237], v[138:139] op_sel_hi:[1,0,1] neg_lo:[0,1,0] neg_hi:[0,1,0]
  v_mfma_f32_16x16x32_bf16 v[176:179], v[68:71], v[104:107], v[176:179]
  v_pk_fma_f32 v[172:173], v[246:247], v[236:237], v[172:173] op_sel_hi:[1,0,1] neg_lo:[0,1,0] neg_hi:[0,1,0]
  v_pk_fma_f32 v[174:175], v[248:249], v[236:237], v[174:175] op_sel_hi:[1,0,1] neg_lo:[0,1,0] neg_hi:[0,1,0]
  v_pk_fma_f32 v[208:209], v[250:251], v[236:237], v[208:209] op_sel_hi:[1,0,1] neg_lo:[0,1,0] neg_hi:[0,1,0]
  v_pk_fma_f32 v[210:211], v[252:253], v[236:237], v[210:211] op_sel_hi:[1,0,1] neg_lo:[0,1,0] neg_hi:[0,1,0]
  v_pk_mul_f32 v[136:137], v[136:137], v[236:237] op_sel:[0,1] op_sel_hi:[1,1]
  v_pk_mul_f32 v[138:139], v[138:139], v[236:237] op_sel:[0,1] op_sel_hi:[1,1]
  v_pk_mul_f32 v[172:173], v[172:173], v[236:237] op_sel:[0,1] op_sel_hi:[1,1]
  v_mfma_f32_16x16x32_bf16 v[140:143], v[64:67], v[104:107], v[140:143]
  v_pk_mul_f32 v[174:175], v[174:175], v[236:237] op_sel:[0,1] op_sel_hi:[1,1]
  v_pk_mul_f32 v[208:209], v[208:209], v[236:237] op_sel:[0,1] op_sel_hi:[1,1]
  v_pk_mul_f32 v[210:211], v[210:211], v[236:237] op_sel:[0,1] op_sel_hi:[1,1]
  v_cvt_pk_bf16_f32 v52, v136, v137
  v_cvt_pk_bf16_f32 v53, v138, v139
  ds_write_b64 v11, v[52:53] offset:19200
  v_cvt_pk_bf16_f32 v54, v172, v173
  v_mfma_f32_16x16x32_bf16 v[144:147], v[64:67], v[108:111], v[144:147]
  v_cvt_pk_bf16_f32 v55, v174, v175
  ds_write_b64 v11, v[54:55] offset:19328
  v_cvt_pk_bf16_f32 v56, v208, v209
  v_cvt_pk_bf16_f32 v57, v210, v211
  ds_write_b64 v11, v[56:57] offset:19456
  v_pk_fma_f32 v[140:141], v[242:243], v[238:239], v[140:141] op_sel_hi:[1,0,1] neg_lo:[0,1,0] neg_hi:[0,1,0]
  v_pk_fma_f32 v[142:143], v[244:245], v[238:239], v[142:143] op_sel_hi:[1,0,1] neg_lo:[0,1,0] neg_hi:[0,1,0]
  v_mfma_f32_16x16x32_bf16 v[180:183], v[68:71], v[108:111], v[180:183]
  v_pk_fma_f32 v[176:177], v[246:247], v[238:239], v[176:177] op_sel_hi:[1,0,1] neg_lo:[0,1,0] neg_hi:[0,1,0]
  v_pk_fma_f32 v[178:179], v[248:249], v[238:239], v[178:179] op_sel_hi:[1,0,1] neg_lo:[0,1,0] neg_hi:[0,1,0]
  v_pk_fma_f32 v[212:213], v[250:251], v[238:239], v[212:213] op_sel_hi:[1,0,1] neg_lo:[0,1,0] neg_hi:[0,1,0]
  v_pk_fma_f32 v[214:215], v[252:253], v[238:239], v[214:215] op_sel_hi:[1,0,1] neg_lo:[0,1,0] neg_hi:[0,1,0]
  v_pk_mul_f32 v[140:141], v[140:141], v[238:239] op_sel:[0,1] op_sel_hi:[1,1]
  v_pk_mul_f32 v[142:143], v[142:143], v[238:239] op_sel:[0,1] op_sel_hi:[1,1]
  v_pk_mul_f32 v[176:177], v[176:177], v[238:239] op_sel:[0,1] op_sel_hi:[1,1]
  v_mfma_f32_16x16x32_bf16 v[216:219], v[72:75], v[108:111], v[216:219]
  v_pk_mul_f32 v[178:179], v[178:179], v[238:239] op_sel:[0,1] op_sel_hi:[1,1]
  v_pk_mul_f32 v[212:213], v[212:213], v[238:239] op_sel:[0,1] op_sel_hi:[1,1]
  v_pk_mul_f32 v[214:215], v[214:215], v[238:239] op_sel:[0,1] op_sel_hi:[1,1]
  v_cvt_pk_bf16_f32 v58, v140, v141
  v_cvt_pk_bf16_f32 v59, v142, v143
  ds_write_b64 v11, v[58:59] offset:22400
  v_cvt_pk_bf16_f32 v60, v176, v177
  s_barrier
  v_cvt_pk_bf16_f32 v61, v178, v179
  ds_write_b64 v11, v[60:61] offset:22528
  v_cvt_pk_bf16_f32 v62, v212, v213
  v_cvt_pk_bf16_f32 v63, v214, v215
  ds_write_b64 v11, v[62:63] offset:22656
  v_pk_fma_f32 v[144:145], v[242:243], v[240:241], v[144:145] op_sel_hi:[1,0,1] neg_lo:[0,1,0] neg_hi:[0,1,0]
  v_pk_fma_f32 v[146:147], v[244:245], v[240:241], v[146:147] op_sel_hi:[1,0,1] neg_lo:[0,1,0] neg_hi:[0,1,0]
  v_pk_fma_f32 v[180:181], v[246:247], v[240:241], v[180:181] op_sel_hi:[1,0,1] neg_lo:[0,1,0] neg_hi:[0,1,0]
  v_pk_fma_f32 v[182:183], v[248:249], v[240:241], v[182:183] op_sel_hi:[1,0,1] neg_lo:[0,1,0] neg_hi:[0,1,0]
  v_pk_fma_f32 v[216:217], v[250:251], v[240:241], v[216:217] op_sel_hi:[1,0,1] neg_lo:[0,1,0] neg_hi:[0,1,0]
  v_pk_fma_f32 v[218:219], v[252:253], v[240:241], v[218:219] op_sel_hi:[1,0,1] neg_lo:[0,1,0] neg_hi:[0,1,0]
  v_pk_mul_f32 v[144:145], v[144:145], v[240:241] op_sel:[0,1] op_sel_hi:[1,1]
  v_pk_mul_f32 v[146:147], v[146:147], v[240:241] op_sel:[0,1] op_sel_hi:[1,1]
  v_pk_mul_f32 v[180:181], v[180:181], v[240:241] op_sel:[0,1] op_sel_hi:[1,1]
  v_pk_mul_f32 v[182:183], v[182:183], v[240:241] op_sel:[0,1] op_sel_hi:[1,1]
  v_pk_mul_f32 v[216:217], v[216:217], v[240:241] op_sel:[0,1] op_sel_hi:[1,1]
  v_pk_mul_f32 v[218:219], v[218:219], v[240:241] op_sel:[0,1] op_sel_hi:[1,1]
  v_cvt_pk_bf16_f32 v16, v144, v145
  v_cvt_pk_bf16_f32 v17, v146, v147
  ds_write_b64 v11, v[16:17] offset:25600
  v_cvt_pk_bf16_f32 v18, v180, v181
  v_cvt_pk_bf16_f32 v19, v182, v183
  ds_write_b64 v11, v[18:19] offset:25728
  v_cvt_pk_bf16_f32 v20, v216, v217
  v_cvt_pk_bf16_f32 v21, v218, v219
  ds_write_b64 v11, v[20:21] offset:25856
  s_branch attn
C_top1:
  s_nop 7
  s_nop 7
  s_mov_b32 s43, 0
  s_mov_b32 s39, 15
  s_barrier
  ds_read_b64_tr_b16 v[16:17], v8 offset:0
  ds_read_b64_tr_b16 v[18:19], v8 offset:512
  ds_read_b128 v[28:31], v9 offset:0
  ds_read_b64_tr_b16 v[20:21], v8 offset:8192
  ds_read_b64_tr_b16 v[22:23], v8 offset:8704
  ds_read_b64_tr_b16 v[24:25], v8 offset:16384
  ds_read_b64_tr_b16 v[26:27], v8 offset:16896
  ds_read_b128 v[32:35], v9 offset:2048
  ds_read_b128 v[36:39], v9 offset:4096
  ds_read_b128 v[40:43], v9 offset:6144
  ds_read_b128 v[44:47], v9 offset:8192
  ds_read_b128 v[48:51], v9 offset:10240
  ds_read_b128 v[52:55], v9 offset:12288
  ds_read_b128 v[56:59], v9 offset:14336
  ds_read_b128 v[60:63], v9 offset:16384
  s_add_u32 s40, s43, 43008
  s_cmp_eq_u32 s40, 129024
  s_cselect_b32 s40, 0, s40
  s_sub_u32 s42, s40, s43
  s_mov_b32 s43, s40
cl2:
  s_waitcnt lgkmcnt(10)
  v_mfma_f32_16x16x32_bf16 v[148:151], v[20:23], v[28:31], v[148:151]
  ds_read_b64_tr_b16 v[64:65], v8 offset:4096
  s_waitcnt lgkmcnt(9)
  v_mfma_f32_16x16x32_bf16 v[184:187], v[24:27], v[28:31], v[184:187]
  ds_read_b64_tr_b16 v[66:67], v8 offset:4608
  s_waitcnt lgkmcnt(9)
  v_mfma_f32_16x16x32_bf16 v[188:191], v[24:27], v[32:35], v[188:191]
  ds_read_b128 v[76:79], v10 offset:0
  v_mfma_f32_16x16x32_bf16 v[152:155], v[20:23], v[32:35], v[152:155]
  ds_read_b64_tr_b16 v[68:69], v8 offset:12288
  v_mfma_f32_16x16x32_bf16 v[116:119], v[16:19], v[32:35], v[116:119]
  ds_read_b64_tr_b16 v[70:71], v8 offset:12800
  s_waitcnt lgkmcnt(11)
  v_mfma_f32_16x16x32_bf16 v[120:123], v[16:19], v[36:39], v[120:123]
  ds_read_b64_tr_b16 v[72:73], v8 offset:20480
  v_mfma_f32_16x16x32_bf16 v[156:159], v[20:23], v[36:39], v[156:159]
  ds_read_b64_tr_b16 v[74:75], v8 offset:20992
  v_add_u32 v8, s42, v8
  v_mfma_f32_16x16x32_bf16 v[192:195], v[24:27], v[36:39], v[192:195]
  ds_read_b128 v[80:83], v10 offset:2048
  s_waitcnt lgkmcnt(13)
  v_mfma_f32_16x16x32_bf16 v[196:199], v[24:27], v[40:43], v[196:199]
  ds_read_b128 v[84:87], v10 offset:4096
  v_mfma_f32_16x16x32_bf16 v[160:163], v[20:23], v[40:43], v[160:163]
  ds_read_b128 v[88:91], v10 offset:6144
  v_mfma_f32_16x16x32_bf16 v[124:127], v[16:19], v[40:43], v[124:127]
  ds_read_b128 v[92:95], v10 offset:8192
  s_waitcnt lgkmcnt(14)
  v_mfma_f32_16x16x32_bf16 v[128:131], v[16:19], v[44:47], v[128:131]
  ds_read_b128 v[96:99], v10 offset:10240
  v_mfma_f32_16x16x32_bf16 v[164:167], v[20:23], v[44:47], v[164:167]
  ds_read_b128 v[100:103], v10 offset:12288
  v_mfma_f32_16x16x32_bf16 v[200:203], v[24:27], v[44:47], v[200:203]
  ds_read_b128 v[104:107], v10 offset:14336
  v_mfma_f32_16x16x32_bf16 v[204:207], v[24:27], v[48:51], v[204:207]
  ds_read_b128 v[108:111], v10 offset:16384
  v_add_u32 v9, s42, v9
  v_add_u32 v10, s42, v10
  v_mfma_f32_16x16x32_bf16 v[168:171], v[20:23], v[48:51], v[168:171]
  v_mfma_f32_16x16x32_bf16 v[132:135], v[16:19], v[48:51], v[132:135]
  s_waitcnt lgkmcnt(14)
  v_mfma_f32_16x16x32_bf16 v[136:139], v[16:19], v[52:55], v[136:139]
  v_mfma_f32_16x16x32_bf16 v[172:175], v[20:23], v[52:55], v[172:175]
  v_mfma_f32_16x16x32_bf16 v[208:211], v[24:27], v[52:55], v[208:211]
  v_mfma_f32_16x16x32_bf16 v[212:215], v[24:27], v[56:59], v[212:215]
  v_mfma_f32_16x16x32_bf16 v[176:179], v[20:23], v[56:59], v[176:179]
  v_mfma_f32_16x16x32_bf16 v[140:143], v[16:19], v[56:59], v[140:143]
  v_mfma_f32_16x16x32_bf16 v[144:147], v[16:19], v[60:63], v[144:147]
  v_mfma_f32_16x16x32_bf16 v[180:183], v[20:23], v[60:63], v[180:183]
  v_mfma_f32_16x16x32_bf16 v[216:219], v[24:27], v[60:63], v[216:219]
  s_waitcnt lgkmcnt(0)
  s_barrier
  v_mfma_f32_16x16x32_bf16 v[148:151], v[68:71], v[76:79], v[148:151]
  ds_read_b64_tr_b16 v[16:17], v8 offset:0
  s_add_u32 s40, s43, 43008
  v_mfma_f32_16x16x32_bf16 v[184:187], v[72:75], v[76:79], v[184:187]
  ds_read_b64_tr_b16 v[18:19], v8 offset:512
  s_cmp_eq_u32 s40, 129024
  v_mfma_f32_16x16x32_bf16 v[188:191], v[72:75], v[80:83], v[188:191]
  ds_read_b128 v[28:31], v9 offset:0
  s_cselect_b32 s40, 0, s40
  v_mfma_f32_16x16x32_bf16 v[152:155], v[68:71], v[80:83], v[152:155]
  ds_read_b64_tr_b16 v[20:21], v8 offset:8192
  s_sub_u32 s42, s40, s43
  v_mfma_f32_16x16x32_bf16 v[116:119], v[64:67], v[80:83], v[116:119]
  ds_read_b64_tr_b16 v[22:23], v8 offset:8704
  s_mov_b32 s43, s40
  v_mfma_f32_16x16x32_bf16 v[120:123], v[64:67], v[84:87], v[120:123]
  ds_read_b64_tr_b16 v[24:25], v8 offset:16384
  v_mfma_f32_16x16x32_bf16 v[156:159], v[68:71], v[84:87], v[156:159]
  ds_read_b64_tr_b16 v[26:27], v8 offset:16896
  v_mfma_f32_16x16x32_bf16 v[192:195], v[72:75], v[84:87], v[192:195]
  ds_read_b128 v[32:35], v9 offset:2048
  v_mfma_f32_16x16x32_bf16 v[196:199], v[72:75], v[88:91], v[196:199]
  ds_read_b128 v[36:39], v9 offset:4096
  v_mfma_f32_16x16x32_bf16 v[160:163], v[68:71], v[88:91], v[160:163]
  ds_read_b128 v[40:43], v9 offset:6144
  v_mfma_f32_16x16x32_bf16 v[124:127], v[64:67], v[88:91], v[124:127]
  ds_read_b128 v[44:47], v9 offset:8192
  v_mfma_f32_16x16x32_bf16 v[128:131], v[64:67], v[92:95], v[128:131]
  ds_read_b128 v[48:51], v9 offset:10240
  v_mfma_f32_16x16x32_bf16 v[164:167], v[68:71], v[92:95], v[164:167]
  ds_read_b128 v[52:55], v9 offset:12288
  v_mfma_f32_16x16x32_bf16 v[200:203], v[72:75], v[92:95], v[200:203]
  ds_read_b128 v[56:59], v9 offset:14336
  v_mfma_f32_16x16x32_bf16 v[204:207], v[72:75], v[96:99], v[204:207]
  ds_read_b128 v[60:63], v9 offset:16384
  v_mfma_f32_16x16x32_bf16 v[168:171], v[68:71], v[96:99], v[168:171]
  v_mfma_f32_16x16x32_bf16 v[132:135], v[64:67], v[96:99], v[132:135]
  v_mfma_f32_16x16x32_bf16 v[136:139], v[64:67], v[100:103], v[136:139]
  v_mfma_f32_16x16x32_bf16 v[172:175], v[68:71], v[100:103], v[172:175]
  v_mfma_f32_16x16x32_bf16 v[208:211], v[72:75], v[100:103], v[208:211]
  v_mfma_f32_16x16x32_bf16 v[212:215], v[72:75], v[104:107], v[212:215]
  v_mfma_f32_16x16x32_bf16 v[176:179], v[68:71], v[104:107], v[176:179]
  v_mfma_f32_16x16x32_bf16 v[140:143], v[64:67], v[104:107], v[140:143]
  v_mfma_f32_16x16x32_bf16 v[144:147], v[64:67], v[108:111], v[144:147]
  v_mfma_f32_16x16x32_bf16 v[180:183], v[68:71], v[108:111], v[180:183]
  v_mfma_f32_16x16x32_bf16 v[216:219], v[72:75], v[108:111], v[216:219]
  s_sub_u32 s39, s39, 1
  s_cmp_lg_u32 s39, 0
  s_cbranch_scc1 cl2
  s_waitcnt lgkmcnt(10)
  v_mfma_f32_16x16x32_bf16 v[148:151], v[20:23], v[28:31], v[148:151]
  ds_read_b64_tr_b16 v[64:65], v8 offset:4096
  s_waitcnt lgkmcnt(9)
  v_mfma_f32_16x16x32_bf16 v[184:187], v[24:27], v[28:31], v[184:187]
  ds_read_b64_tr_b16 v[66:67], v8 offset:4608
  s_waitcnt lgkmcnt(9)
  v_mfma_f32_16x16x32_bf16 v[188:191], v[24:27], v[32:35], v[188:191]
  ds_read_b128 v[76:79], v10 offset:0
  v_mfma_f32_16x16x32_bf16 v[152:155], v[20:23], v[32:35], v[152:155]
  ds_read_b64_tr_b16 v[68:69], v8 offset:12288
  v_mfma_f32_16x16x32_bf16 v[116:119], v[16:19], v[32:35], v[116:119]
  ds_read_b64_tr_b16 v[70:71], v8 offset:12800
  s_waitcnt lgkmcnt(11)
  v_mfma_f32_16x16x32_bf16 v[120:123], v[16:19], v[36:39], v[120:123]
  ds_read_b64_tr_b16 v[72:73], v8 offset:20480
  v_mfma_f32_16x16x32_bf16 v[156:159], v[20:23], v[36:39], v[156:159]
  ds_read_b64_tr_b16 v[74:75], v8 offset:20992
  v_mfma_f32_16x16x32_bf16 v[192:195], v[24:27], v[36:39], v[192:195]
  ds_read_b128 v[80:83], v10 offset:2048
  s_waitcnt lgkmcnt(13)
  v_mfma_f32_16x16x32_bf16 v[196:199], v[24:27], v[40:43], v[196:199]
  ds_read_b128 v[84:87], v10 offset:4096
  v_mfma_f32_16x16x32_bf16 v[160:163], v[20:23], v[40:43], v[160:163]
  ds_read_b128 v[88:91], v10 offset:6144
  v_mfma_f32_16x16x32_bf16 v[124:127], v[16:19], v[40:43], v[124:127]
  ds_read_b128 v[92:95], v10 offset:8192
  s_waitcnt lgkmcnt(14)
  v_mfma_f32_16x16x32_bf16 v[128:131], v[16:19], v[44:47], v[128:131]
  ds_read_b128 v[96:99], v10 offset:10240
  v_mfma_f32_16x16x32_bf16 v[164:167], v[20:23], v[44:47], v[164:167]
  ds_read_b128 v[100:103], v10 offset:12288
  v_mfma_f32_16x16x32_bf16 v[200:203], v[24:27], v[44:47], v[200:203]
  ds_read_b128 v[104:107], v10 offset:14336
  v_mfma_f32_16x16x32_bf16 v[204:207], v[24:27], v[48:51], v[204:207]
  ds_read_b128 v[108:111], v10 offset:16384
  v_mfma_f32_16x16x32_bf16 v[168:171], v[20:23], v[48:51], v[168:171]
  ds_read_b64 v[224:225], v12 offset:0
  v_mfma_f32_16x16x32_bf16 v[132:135], v[16:19], v[48:51], v[132:135]
  ds_read_b64 v[226:227], v12 offset:128
  s_waitcnt lgkmcnt(14)
  v_mfma_f32_16x16x32_bf16 v[136:139], v[16:19], v[52:55], v[136:139]
  ds_read_b64 v[228:229], v12 offset:256
  v_mfma_f32_16x16x32_bf16 v[172:175], v[20:23], v[52:55], v[172:175]
  ds_read_b64 v[230:231], v12 offset:384
  v_mfma_f32_16x16x32_bf16 v[208:211], v[24:27], v[52:55], v[208:211]
  ds_read_b64 v[232:233], v12 offset:512
  v_mfma_f32_16x16x32_bf16 v[212:215], v[24:27], v[56:59], v[212:215]
  ds_read_b64 v[234:235], v12 offset:640
  v_mfma_f32_16x16x32_bf16 v[176:179], v[20:23], v[56:59], v[176:179]
  ds_read_b64 v[236:237], v12 offset:768
  v_mfma_f32_16x16x32_bf16 v[140:143], v[16:19], v[56:59], v[140:143]
  ds_read_b64 v[238:239], v12 offset:896
  v_mfma_f32_16x16x32_bf16 v[144:147], v[16:19], v[60:63], v[144:147]
  ds_read_b64 v[240:241], v12 offset:1024
  v_mfma_f32_16x16x32_bf16 v[180:183], v[20:23], v[60:63], v[180:183]
  v_mfma_f32_16x16x32_bf16 v[216:219], v[24:27], v[60:63], v[216:219]
  s_waitcnt lgkmcnt(0)
  v_mfma_f32_16x16x32_bf16 v[148:151], v[68:71], v[76:79], v[148:151]
  v_mfma_f32_16x16x32_bf16 v[184:187], v[72:75], v[76:79], v[184:187]
  v_mfma_f32_16x16x32_bf16 v[188:191], v[72:75], v[80:83], v[188:191]
  s_nop 5
  v_mov_b32_dpp v246, v148 row_newbcast:0 row_mask:0xf bank_mask:0xf
  v_mov_b32_dpp v247, v149 row_newbcast:0 row_mask:0xf bank_mask:0xf
  v_mov_b32_dpp v248, v150 row_newbcast:0 row_mask:0xf bank_mask:0xf
  v_mov_b32_dpp v249, v151 row_newbcast:0 row_mask:0xf bank_mask:0xf
  v_mov_b32_dpp v250, v184 row_newbcast:0 row_mask:0xf bank_mask:0xf
  v_mov_b32_dpp v251, v185 row_newbcast:0 row_mask:0xf bank_mask:0xf
  v_mov_b32_dpp v252, v186 row_newbcast:0 row_mask:0xf bank_mask:0xf
  v_mfma_f32_16x16x32_bf16 v[152:155], v[68:71], v[80:83], v[152:155]
  v_mov_b32_dpp v253, v187 row_newbcast:0 row_mask:0xf bank_mask:0xf
  v_pk_fma_f32 v[148:149], v[246:247], v[224:225], v[148:149] op_sel_hi:[1,0,1] neg_lo:[0,1,0] neg_hi:[0,1,0]
  v_pk_fma_f32 v[150:151], v[248:249], v[224:225], v[150:151] op_sel_hi:[1,0,1] neg_lo:[0,1,0] neg_hi:[0,1,0]
  v_pk_fma_f32 v[184:185], v[250:251], v[224:225], v[184:185] op_sel_hi:[1,0,1] neg_lo:[0,1,0] neg_hi:[0,1,0]
  v_pk_fma_f32 v[186:187], v[252:253], v[224:225], v[186:187] op_sel_hi:[1,0,1] neg_lo:[0,1,0] neg_hi:[0,1,0]
  v_pk_mul_f32 v[148:149], v[148:149], v[224:225] op_sel:[0,1] op_sel_hi:[1,1]
  v_pk_mul_f32 v[150:151], v[150:151], v[224:225] op_sel:[0,1] op_sel_hi:[1,1]
  v_mfma_f32_16x16x32_bf16 v[116:119], v[64:67], v[80:83], v[116:119]
  v_pk_mul_f32 v[184:185], v[184:185], v[224:225] op_sel:[0,1] op_sel_hi:[1,1]
  v_pk_mul_f32 v[186:187], v[186:187], v[224:225] op_sel:[0,1] op_sel_hi:[1,1]
  v_cvt_pk_bf16_f32 v16, v148, v149
  v_cvt_pk_bf16_f32 v17, v150, v151
  ds_write_b64 v11, v[16:17] offset:128
  v_cvt_pk_bf16_f32 v18, v184, v185
  v_cvt_pk_bf16_f32 v19, v186, v187
  v_mfma_f32_16x16x32_bf16 v[120:123], v[64:67], v[84:87], v[120:123]
  ds_write_b64 v11, v[18:19] offset:256
  v_pk_fma_f32 v[116:117], v[242:243], v[226:227], v[116:117] op_sel_hi:[1,0,1] neg_lo:[0,1,0] neg_hi:[0,1,0]
  v_pk_fma_f32 v[118:119], v[244:245], v[226:227], v[118:119] op_sel_hi:[1,0,1] neg_lo:[0,1,0] neg_hi:[0,1,0]
  v_pk_fma_f32 v[152:153], v[246:247], v[226:227], v[152:153] op_sel_hi:[1,0,1] neg_lo:[0,1,0] neg_hi:[0,1,0]
  v_pk_fma_f32 v[154:155], v[248:249], v[226:227], v[154:155] op_sel_hi:[1,0,1] neg_lo:[0,1,0] neg_hi:[0,1,0]
  v_pk_fma_f32 v[188:189], v[250:251], v[226:227], v[188:189] op_sel_hi:[1,0,1] neg_lo:[0,1,0] neg_hi:[0,1,0]
  v_pk_fma_f32 v[190:191], v[252:253], v[226:227], v[190:191] op_sel_hi:[1,0,1] neg_lo:[0,1,0] neg_hi:[0,1,0]
  v_mfma_f32_16x16x32_bf16 v[156:159], v[68:71], v[84:87], v[156:159]
  v_pk_mul_f32 v[116:117], v[116:117], v[226:227] op_sel:[0,1] op_sel_hi:[1,1]
  v_pk_mul_f32 v[118:119], v[118:119], v[226:227] op_sel:[0,1] op_sel_hi:[1,1]
  v_pk_mul_f32 v[152:153], v[152:153], v[226:227] op_sel:[0,1] op_sel_hi:[1,1]
  v_pk_mul_f32 v[154:155], v[154:155], v[226:227] op_sel:[0,1] op_sel_hi:[1,1]
  v_pk_mul_f32 v[188:189], v[188:189], v[226:227] op_sel:[0,1] op_sel_hi:[1,1]
  v_pk_mul_f32 v[190:191], v[190:191], v[226:227] op_sel:[0,1] op_sel_hi:[1,1]
  v_cvt_pk_bf16_f32 v22, v116, v117
  v_mfma_f32_16x16x32_bf16 v[192:195], v[72:75], v[84:87], v[192:195]
  v_cvt_pk_bf16_f32 v23, v118, v119
  ds_write_b64 v11, v[22:23] offset:3200
  v_cvt_pk_bf16_f32 v24, v152, v153
  v_cvt_pk_bf16_f32 v25, v154, v155
  ds_write_b64 v11, v[24:25] offset:3328
  v_cvt_pk_bf16_f32 v26, v188, v189
  v_cvt_pk_bf16_f32 v27, v190, v191
  v_mfma_f32_16x16x32_bf16 v[196:199], v[72:75], v[88:91], v[196:199]
  ds_write_b64 v11, v[26:27] offset:3456
  v_pk_fma_f32 v[120:121], v[242:243], v[228:229], v[120:121] op_sel_hi:[1,0,1] neg_lo:[0,1,0] neg_hi:[0,1,0]
  v_pk_fma_f32 v[122:123], v[244:245], v[228:229], v[122:123] op_sel_hi:[1,0,1] neg_lo:[0,1,0] neg_hi:[0,1,0]
  v_pk_fma_f32 v[156:157], v[246:247], v[228:229], v[156:157] op_sel_hi:[1,0,1] neg_lo:[0,1,0] neg_hi:[0,1,0]
  v_pk_fma_f32 v[158:159], v[248:249], v[228:229], v[158:159] op_sel_hi:[1,0,1] neg_lo:[0,1,0] neg_hi:[0,1,0]
  v_pk_fma_f32 v[192:193], v[250:251], v[228:229], v[192:193] op_sel_hi:[1,0,1] neg_lo:[0,1,0] neg_hi:[0,1,0]
  v_pk_fma_f32 v[194:195], v[252:253], v[228:229], v[194:195] op_sel_hi:[1,0,1] neg_lo:[0,1,0] neg_hi:[0,1,0]
  v_mfma_f32_16x16x32_bf16 v[160:163], v[68:71], v[88:91], v[160:163]
  v_pk_mul_f32 v[120:121], v[120:121], v[228:229] op_sel:[0,1] op_sel_hi:[1,1]
  v_pk_mul_f32 v[122:123], v[122:123], v[228:229] op_sel:[0,1] op_sel_hi:[1,1]
  v_pk_mul_f32 v[156:157], v[156:157], v[228:229] op_sel:[0,1] op_sel_hi:[1,1]
  v_pk_mul_f32 v[158:159], v[158:159], v[228:229] op_sel:[0,1] op_sel_hi:[1,1]
  v_pk_mul_f32 v[192:193], v[192:193], v[228:229] op_sel:[0,1] op_sel_hi:[1,1]
  v_pk_mul_f32 v[194:195], v[194:195], v[228:229] op_sel:[0,1] op_sel_hi:[1,1]
  v_cvt_pk_bf16_f32 v28, v120, v121
  v_mfma_f32_16x16x32_bf16 v[124:127], v[64:67], v[88:91], v[124:127]
  v_cvt_pk_bf16_f32 v29, v122, v123
  ds_write_b64 v11, v[28:29] offset:6400
  v_cvt_pk_bf16_f32 v30, v156, v157
  v_cvt_pk_bf16_f32 v31, v158, v159
  ds_write_b64 v11, v[30:31] offset:6528
  v_cvt_pk_bf16_f32 v32, v192, v193
  v_cvt_pk_bf16_f32 v33, v194, v195
  v_mfma_f32_16x16x32_bf16 v[128:131], v[64:67], v[92:95], v[128:131]
  ds_write_b64 v11, v[32:33] offset:6656
  v_pk_fma_f32 v[124:125], v[242:243], v[230:231], v[124:125] op_sel_hi:[1,0,1] neg_lo:[0,1,0] neg_hi:[0,1,0]
  v_pk_fma_f32 v[126:127], v[244:245], v[230:231], v[126:127] op_sel_hi:[1,0,1] neg_lo:[0,1,0] neg_hi:[0,1,0]
  v_pk_fma_f32 v[160:161], v[246:247], v[230:231], v[160:161] op_sel_hi:[1,0,1] neg_lo:[0,1,0] neg_hi:[0,1,0]
  v_pk_fma_f32 v[162:163], v[248:249], v[230:231], v[162:163] op_sel_hi:[1,0,1] neg_lo:[0,1,0] neg_hi:[0,1,0]
  v_pk_fma_f32 v[196:197], v[250:251], v[230:231], v[196:197] op_sel_hi:[1,0,1] neg_lo:[0,1,0] neg_hi:[0,1,0]
  v_pk_fma_f32 v[198:199], v[252:253], v[230:231], v[198:199] op_sel_hi:[1,0,1] neg_lo:[0,1,0] neg_hi:[0,1,0]
  v_mfma_f32_16x16x32_bf16 v[164:167], v[68:71], v[92:95], v[164:167]
  v_pk_mul_f32 v[124:125], v[124:125], v[230:231] op_sel:[0,1] op_sel_hi:[1,1]
  v_pk_mul_f32 v[126:127], v[126:127], v[230:231] op_sel:[0,1] op_sel_hi:[1,1]
  v_pk_mul_f32 v[160:161], v[160:161], v[230:231] op_sel:[0,1] op_sel_hi:[1,1]
  v_pk_mul_f32 v[162:163], v[162:163], v[230:231] op_sel:[0,1] op_sel_hi:[1,1]
  v_pk_mul_f32 v[196:197], v[196:197], v[230:231] op_sel:[0,1] op_sel_hi:[1,1]
  v_pk_mul_f32 v[198:199], v[198:199], v[230:231] op_sel:[0,1] op_sel_hi:[1,1]
  v_cvt_pk_bf16_f32 v34, v124, v125
  v_mfma_f32_16x16x32_bf16 v[200:203], v[72:75], v[92:95], v[200:203]
  v_cvt_pk_bf16_f32 v35, v126, v127
  ds_write_b64 v11, v[34:35] offset:9600
  v_cvt_pk_bf16_f32 v36, v160, v161
  v_cvt_pk_bf16_f32 v37, v162, v163
  ds_write_b64 v11, v[36:37] offset:9728
  v_cvt_pk_bf16_f32 v38, v196, v197
  v_cvt_pk_bf16_f32 v39, v198, v199
  v_mfma_f32_16x16x32_bf16 v[204:207], v[72:75], v[96:99], v[204:207]
  ds_write_b64 v11, v[38:39] offset:9856
  v_pk_fma_f32 v[128:129], v[242:243], v[232:233], v[128:129] op_sel_hi:[1,0,1] neg_lo:[0,1,0] neg_hi:[0,1,0]
  v_pk_fma_f32 v[130:131], v[244:245], v[232:233], v[130:131] op_sel_hi:[1,0,1] neg_lo:[0,1,0] neg_hi:[0,1,0]
  v_pk_fma_f32 v[164:165], v[246:247], v[232:233], v[164:165] op_sel_hi:[1,0,1] neg_lo:[0,1,0] neg_hi:[0,1,0]
  v_pk_fma_f32 v[166:167], v[248:249], v[232:233], v[166:167] op_sel_hi:[1,0,1] neg_lo:[0,1,0] neg_hi:[0,1,0]
  v_pk_fma_f32 v[200:201], v[250:251], v[232:233], v[200:201] op_sel_hi:[1,0,1] neg_lo:[0,1,0] neg_hi:[0,1,0]
  v_pk_fma_f32 v[202:203], v[252:253], v[232:233], v[202:203] op_sel_hi:[1,0,1] neg_lo:[0,1,0] neg_hi:[0,1,0]
  v_mfma_f32_16x16x32_bf16 v[168:171], v[68:71], v[96:99], v[168:171]
  v_pk_mul_f32 v[128:129], v[128:129], v[232:233] op_sel:[0,1] op_sel_hi:[1,1]
  v_pk_mul_f32 v[130:131], v[130:131], v[232:233] op_sel:[0,1] op_sel_hi:[1,1]
  v_pk_mul_f32 v[164:165], v[164:165], v[232:233] op_sel:[0,1] op_sel_hi:[1,1]
  v_pk_mul_f32 v[166:167], v[166:167], v[232:233] op_sel:[0,1] op_sel_hi:[1,1]
  v_pk_mul_f32 v[200:201], v[200:201], v[232:233] op_sel:[0,1] op_sel_hi:[1,1]
  v_pk_mul_f32 v[202:203], v[202:203], v[232:233] op_sel:[0,1] op_sel_hi:[1,1]
  v_cvt_pk_bf16_f32 v40, v128, v129
  v_mfma_f32_16x16x32_bf16 v[132:135], v[64:67], v[96:99], v[132:135]
  v_cvt_pk_bf16_f32 v41, v130, v131
  ds_write_b64 v11, v[40:41] offset:12800
  v_cvt_pk_bf16_f32 v42, v164, v165
  v_cvt_pk_bf16_f32 v43, v166, v167
  ds_write_b64 v11, v[42:43] offset:12928
  v_cvt_pk_bf16_f32 v44, v200, v201
  v_cvt_pk_bf16_f32 v45, v202, v203
  v_mfma_f32_16x16x32_bf16 v[136:139], v[64:67], v[100:103], v[136:139]
  ds_write_b64 v11, v[44:45] offset:13056
  v_pk_fma_f32 v[132:133], v[242:243], v[234:235], v[132:133] op_sel_hi:[1,0,1] neg_lo:[0,1,0] neg_hi:[0,1,0]
  v_pk_fma_f32 v[134:135], v[244:245], v[234:235], v[134:135] op_sel_hi:[1,0,1] neg_lo:[0,1,0] neg_hi:[0,1,0]
  v_pk_fma_f32 v[168:169], v[246:247], v[234:235], v[168:169] op_sel_hi:[1,0,1] neg_lo:[0,1,0] neg_hi:[0,1,0]
  v_pk_fma_f32 v[170:171], v[248:249], v[234:235], v[170:171] op_sel_hi:[1,0,1] neg_lo:[0,1,0] neg_hi:[0,1,0]
  v_pk_fma_f32 v[204:205], v[250:251], v[234:235], v[204:205] op_sel_hi:[1,0,1] neg_lo:[0,1,0] neg_hi:[0,1,0]
  v_pk_fma_f32 v[206:207], v[252:253], v[234:235], v[206:207] op_sel_hi:[1,0,1] neg_lo:[0,1,0] neg_hi:[0,1,0]
  v_mfma_f32_16x16x32_bf16 v[172:175], v[68:71], v[100:103], v[172:175]
  v_pk_mul_f32 v[132:133], v[132:133], v[234:235] op_sel:[0,1] op_sel_hi:[1,1]
  v_pk_mul_f32 v[134:135], v[134:135], v[234:235] op_sel:[0,1] op_sel_hi:[1,1]
  v_pk_mul_f32 v[168:169], v[168:169], v[234:235] op_sel:[0,1] op_sel_hi:[1,1]
  v_pk_mul_f32 v[170:171], v[170:171], v[234:235] op_sel:[0,1] op_sel_hi:[1,1]
  v_pk_mul_f32 v[204:205], v[204:205], v[234:235] op_sel:[0,1] op_sel_hi:[1,1]
  v_pk_mul_f32 v[206:207], v[206:207], v[234:235] op_sel:[0,1] op_sel_hi:[1,1]
  v_cvt_pk_bf16_f32 v46, v132, v133
  v_mfma_f32_16x16x32_bf16 v[208:211], v[72:75], v[100:103], v[208:211]
  v_cvt_pk_bf16_f32 v47, v134, v135
  ds_write_b64 v11, v[46:47] offset:16000
  v_cvt_pk_bf16_f32 v48, v168, v169
  v_cvt_pk_bf16_f32 v49, v170, v171
  ds_write_b64 v11, v[48:49] offset:16128
  v_cvt_pk_bf16_f32 v50, v204, v205
  v_cvt_pk_bf16_f32 v51, v206, v207
  v_mfma_f32_16x16x32_bf16 v[212:215], v[72:75], v[104:107], v[212:215]
  ds_write_b64 v11, v[50:51] offset:16256
  v_pk_fma_f32 v[136:137], v[242:243], v[236:237], v[136:137] op_sel_hi:[1,0,1] neg_lo:[0,1,0] neg_hi:[0,1,0]
  v_pk_fma_f32 v[138:139], v[244:245], v[236:237], v[138:139] op_sel_hi:[1,0,1] neg_lo:[0,1,0] neg_hi:[0,1,0]
  v_pk_fma_f32 v[172:173], v[246:247], v[236:237], v[172:173] op_sel_hi:[1,0,1] neg_lo:[0,1,0] neg_hi:[0,1,0]
  v_pk_fma_f32 v[174:175], v[248:249], v[236:237], v[174:175] op_sel_hi:[1,0,1] neg_lo:[0,1,0] neg_hi:[0,1,0]
  v_pk_fma_f32 v[208:209], v[250:251], v[236:237], v[208:209] op_sel_hi:[1,0,1] neg_lo:[0,1,0] neg_hi:[0,1,0]
  v_pk_fma_f32 v[210:211], v[252:253], v[236:237], v[210:211] op_sel_hi:[1,0,1] neg_lo:[0,1,0] neg_hi:[0,1,0]
  v_mfma_f32_16x16x32_bf16 v[176:179], v[68:71], v[104:107], v[176:179]
  v_pk_mul_f32 v[136:137], v[136:137], v[236:237] op_sel:[0,1] op_sel_hi:[1,1]
  v_pk_mul_f32 v[138:139], v[138:139], v[236:237] op_sel:[0,1] op_sel_hi:[1,1]
  v_pk_mul_f32 v[172:173], v[172:173], v[236:237] op_sel:[0,1] op_sel_hi:[1,1]
  v_pk_mul_f32 v[174:175], v[174:175], v[236:237] op_sel:[0,1] op_sel_hi:[1,1]
  v_pk_mul_f32 v[208:209], v[208:209], v[236:237] op_sel:[0,1] op_sel_hi:[1,1]
  v_pk_mul_f32 v[210:211], v[210:211], v[236:237] op_sel:[0,1] op_sel_hi:[1,1]
  v_cvt_pk_bf16_f32 v52, v136, v137
  v_mfma_f32_16x16x32_bf16 v[140:143], v[64:67], v[104:107], v[140:143]
  v_cvt_pk_bf16_f32 v53, v138, v139
  ds_write_b64 v11, v[52:53] offset:19200
  v_cvt_pk_bf16_f32 v54, v172, v173
  v_cvt_pk_bf16_f32 v55, v174, v175
  ds_write_b64 v11, v[54:55] offset:19328
  v_cvt_pk_bf16_f32 v56, v208, v209
  v_cvt_pk_bf16_f32 v57, v210, v211
  v_mfma_f32_16x16x32_bf16 v[144:147], v[64:67], v[108:111], v[144:147]
  ds_write_b64 v11, v[56:57] offset:19456
  v_pk_fma_f32 v[140:141], v[242:243], v[238:239], v[140:141] op_sel_hi:[1,0,1] neg_lo:[0,1,0] neg_hi:[0,1,0]
  v_pk_fma_f32 v[142:143], v[244:245], v[238:239], v[142:143] op_sel_hi:[1,0,1] neg_lo:[0,1,0] neg_hi:[0,1,0]
  v_pk_fma_f32 v[176:177], v[246:247], v[238:239], v[176:177] op_sel_hi:[1,0,1] neg_lo:[0,1,0] neg_hi:[0,1,0]
  v_pk_fma_f32 v[178:179], v[248:249], v[238:239], v[178:179] op_sel_hi:[1,0,1] neg_lo:[0,1,0] neg_hi:[0,1,0]
  v_pk_fma_f32 v[212:213], v[250:251], v[238:239], v[212:213] op_sel_hi:[1,0,1] neg_lo:[0,1,0] neg_hi:[0,1,0]
  v_pk_fma_f32 v[214:215], v[252:253], v[238:239], v[214:215] op_sel_hi:[1,0,1] neg_lo:[0,1,0] neg_hi:[0,1,0]
  v_mfma_f32_16x16x32_bf16 v[180:183], v[68:71], v[108:111], v[180:183]
  v_pk_mul_f32 v[140:141], v[140:141], v[238:239] op_sel:[0,1] op_sel_hi:[1,1]
  v_pk_mul_f32 v[142:143], v[142:143], v[238:239] op_sel:[0,1] op_sel_hi:[1,1]
  v_pk_mul_f32 v[176:177], v[176:177], v[238:239] op_sel:[0,1] op_sel_hi:[1,1]
  v_pk_mul_f32 v[178:179], v[178:179], v[238:239] op_sel:[0,1] op_sel_hi:[1,1]
  v_pk_mul_f32 v[212:213], v[212:213], v[238:239] op_sel:[0,1] op_sel_hi:[1,1]
  v_pk_mul_f32 v[214:215], v[214:215], v[238:239] op_sel:[0,1] op_sel_hi:[1,1]
  v_cvt_pk_bf16_f32 v58, v140, v141
  v_mfma_f32_16x16x32_bf16 v[216:219], v[72:75], v[108:111], v[216:219]
  v_cvt_pk_bf16_f32 v59, v142, v143
  ds_write_b64 v11, v[58:59] offset:22400
  v_cvt_pk_bf16_f32 v60, v176, v177
  v_cvt_pk_bf16_f32 v61, v178, v179
  ds_write_b64 v11, v[60:61] offset:22528
  v_cvt_pk_bf16_f32 v62, v212, v213
  v_cvt_pk_bf16_f32 v63, v214, v215
  s_barrier
  ds_write_b64 v11, v[62:63] offset:22656
  v_pk_fma_f32 v[144:145], v[242:243], v[240:241], v[144:145] op_sel_hi:[1,0,1] neg_lo:[0,1,0] neg_hi:[0,1,0]
  v_pk_fma_f32 v[146:147], v[244:245], v[240:241], v[146:147] op_sel_hi:[1,0,1] neg_lo:[0,1,0] neg_hi:[0,1,0]
  v_pk_fma_f32 v[180:181], v[246:247], v[240:241], v[180:181] op_sel_hi:[1,0,1] neg_lo:[0,1,0] neg_hi:[0,1,0]
  v_pk_fma_f32 v[182:183], v[248:249], v[240:241], v[182:183] op_sel_hi:[1,0,1] neg_lo:[0,1,0] neg_hi:[0,1,0]
  v_pk_fma_f32 v[216:217], v[250:251], v[240:241], v[216:217] op_sel_hi:[1,0,1] neg_lo:[0,1,0] neg_hi:[0,1,0]
  v_pk_fma_f32 v[218:219], v[252:253], v[240:241], v[218:219] op_sel_hi:[1,0,1] neg_lo:[0,1,0] neg_hi:[0,1,0]
  v_pk_mul_f32 v[144:145], v[144:145], v[240:241] op_sel:[0,1] op_sel_hi:[1,1]
  v_pk_mul_f32 v[146:147], v[146:147], v[240:241] op_sel:[0,1] op_sel_hi:[1,1]
  v_pk_mul_f32 v[180:181], v[180:181], v[240:241] op_sel:[0,1] op_sel_hi:[1,1]
  v_pk_mul_f32 v[182:183], v[182:183], v[240:241] op_sel:[0,1] op_sel_hi:[1,1]
  v_pk_mul_f32 v[216:217], v[216:217], v[240:241] op_sel:[0,1] op_sel_hi:[1,1]
  v_pk_mul_f32 v[218:219], v[218:219], v[240:241] op_sel:[0,1] op_sel_hi:[1,1]
  v_cvt_pk_bf16_f32 v16, v144, v145
  v_cvt_pk_bf16_f32 v17, v146, v147
  ds_write_b64 v11, v[16:17] offset:25600
  v_cvt_pk_bf16_f32 v18, v180, v181
  v_cvt_pk_bf16_f32 v19, v182, v183
  ds_write_b64 v11, v[18:19] offset:25728
  v_cvt_pk_bf16_f32 v20, v216, v217
  v_cvt_pk_bf16_f32 v21, v218, v219
  ds_write_b64 v11, v[20:21] offset:25856
attn:
  s_nop 7
  s_nop 7
  v_mov_b32 v18, 0x3e8293ee
  v_mov_b32 v19, 0xff800000
  s_mov_b32 s20, s82
  s_mov_b32 s21, s83
  s_mov_b32 s22, 8388608
  s_mov_b32 s23, 0x20000
  s_mov_b32 s49, 4096
  s_waitcnt lgkmcnt(0)
  s_barrier
  ds_read_b128 v[32:35], v223 offset:0
  ds_read_b128 v[36:39], v220 offset:0
  ds_read_b128 v[40:43], v221 offset:0
  ds_read_b128 v[80:83], v223 offset:64
  ds_read_b128 v[84:87], v220 offset:64
  ds_read_b128 v[88:91], v221 offset:64
  ds_read_b64_tr_b16 v[44:45], v222 offset:0
  ds_read_b64_tr_b16 v[46:47], v254 offset:0
  ds_read_b64_tr_b16 v[48:49], v222 offset:8
  ds_read_b64_tr_b16 v[50:51], v254 offset:8
  ds_read_b64_tr_b16 v[92:93], v222 offset:64
  ds_read_b64_tr_b16 v[94:95], v254 offset:64
  ds_read_b64_tr_b16 v[96:97], v222 offset:72
  ds_read_b64_tr_b16 v[98:99], v254 offset:72
  s_waitcnt lgkmcnt(11)
  v_mfma_f32_16x16x32_bf16 v[52:55], v[36:39], v[32:35], 0
  v_mfma_f32_16x16x32_bf16 v[56:59], v[40:43], v[32:35], 0
  s_waitcnt lgkmcnt(8)
  v_mfma_f32_16x16x32_bf16 v[100:103], v[84:87], v[80:83], 0
  v_mfma_f32_16x16x32_bf16 v[104:107], v[88:91], v[80:83], 0
  s_nop 3
  v_cndmask_b32 v52, v19, v52, s[86:87]
  s_nop 1
  v_cndmask_b32 v100, v19, v100, s[86:87]
  v_cndmask_b32 v53, v19, v53, s[88:89]
  v_cndmask_b32 v101, v19, v101, s[88:89]
  v_cndmask_b32 v54, v19, v54, s[90:91]
  v_cndmask_b32 v102, v19, v102, s[90:91]
  v_cndmask_b32 v55, v19, v55, s[92:93]
  v_cndmask_b32 v103, v19, v103, s[92:93]
  v_cndmask_b32 v56, v19, v56, s[94:95]
  v_cndmask_b32 v104, v19, v104, s[94:95]
  v_cndmask_b32 v57, v19, v57, s[96:97]
  v_cndmask_b32 v105, v19, v105, s[96:97]
  v_cndmask_b32 v58, v19, v58, s[98:99]
  v_cndmask_b32 v106, v19, v106, s[98:99]
  v_cndmask_b32 v59, v19, v59, s[100:101]
  v_cndmask_b32 v107, v19, v107, s[100:101]
  v_max3_f32 v60, v52, v53, v54
  v_max3_f32 v108, v100, v101, v102
  v_max3_f32 v61, v55, v56, v57
  v_max3_f32 v109, v103, v104, v105
  v_max3_f32 v60, v60, v58, v59
  v_max3_f32 v108, v108, v106, v107
  v_max_f32 v60, v60, v61
  v_max_f32 v108, v108, v109
  v_mov_b32 v61, v60
  v_mov_b32 v109, v108
  s_nop 0
  v_permlane16_swap_b32 v60, v61
  v_permlane16_swap_b32 v108, v109
  v_max_f32 v60, v60, v61
  v_max_f32 v108, v108, v109
  v_mov_b32 v61, v60
  v_mov_b32 v109, v108
  s_nop 0
  v_permlane32_swap_b32 v60, v61
  v_permlane32_swap_b32 v108, v109
  v_max_f32 v60, v60, v61
  v_max_f32 v108, v108, v109
  v_mul_f32 v60, v18, v60
  v_mul_f32 v108, v18, v108
  v_fma_f32 v52, v52, v18, -v60
  v_fma_f32 v100, v100, v18, -v108
  v_fma_f32 v53, v53, v18, -v60
  v_fma_f32 v101, v101, v18, -v108
  v_fma_f32 v54, v54, v18, -v60
  v_fma_f32 v102, v102, v18, -v108
  v_fma_f32 v55, v55, v18, -v60
  v_fma_f32 v103, v103, v18, -v108
  v_fma_f32 v56, v56, v18, -v60
  v_fma_f32 v104, v104, v18, -v108
  v_fma_f32 v57, v57, v18, -v60
  v_fma_f32 v105, v105, v18, -v108
  v_fma_f32 v58, v58, v18, -v60
  v_fma_f32 v106, v106, v18, -v108
  v_fma_f32 v59, v59, v18, -v60
  v_fma_f32 v107, v107, v18, -v108
  v_exp_f32 v52, v52
  v_exp_f32 v100, v100
  v_exp_f32 v53, v53
  v_exp_f32 v101, v101
  v_exp_f32 v54, v54
  v_exp_f32 v102, v102
  v_exp_f32 v55, v55
  v_exp_f32 v103, v103
  v_exp_f32 v56, v56
  v_exp_f32 v104, v104
  v_exp_f32 v57, v57
  v_exp_f32 v105, v105
  v_exp_f32 v58, v58
  v_exp_f32 v106, v106
  v_exp_f32 v59, v59
  v_exp_f32 v107, v107
  v_pk_add_f32 v[60:61], v[52:53], v[54:55]
  v_pk_add_f32 v[108:109], v[100:101], v[102:103]
  v_pk_add_f32 v[62:63], v[56:57], v[58:59]
  v_pk_add_f32 v[110:111], v[104:105], v[106:107]
  v_pk_add_f32 v[60:61], v[60:61], v[62:63]
  v_pk_add_f32 v[108:109], v[108:109], v[110:111]
  v_add_f32 v60, v60, v61
  v_add_f32 v108, v108, v109
  v_mov_b32 v61, v60
  v_mov_b32 v109, v108
  s_nop 0
  v_permlane16_swap_b32 v60, v61
  v_permlane16_swap_b32 v108, v109
  v_add_f32 v60, v60, v61
  v_add_f32 v108, v108, v109
  v_mov_b32 v61, v60
  v_mov_b32 v109, v108
  s_nop 0
  v_permlane32_swap_b32 v60, v61
  v_permlane32_swap_b32 v108, v109
  v_add_f32 v60, v60, v61
  v_add_f32 v108, v108, v109
  v_rcp_f32 v60, v60
  v_rcp_f32 v108, v108
  v_pk_mul_f32 v[52:53], v[52:53], v[60:61] op_sel_hi:[1,0]
  v_pk_mul_f32 v[100:101], v[100:101], v[108:109] op_sel_hi:[1,0]
  v_pk_mul_f32 v[54:55], v[54:55], v[60:61] op_sel_hi:[1,0]
  v_pk_mul_f32 v[102:103], v[102:103], v[108:109] op_sel_hi:[1,0]
  v_pk_mul_f32 v[56:57], v[56:57], v[60:61] op_sel_hi:[1,0]
  v_pk_mul_f32 v[104:105], v[104:105], v[108:109] op_sel_hi:[1,0]
  v_pk_mul_f32 v[58:59], v[58:59], v[60:61] op_sel_hi:[1,0]
  v_pk_mul_f32 v[106:107], v[106:107], v[108:109] op_sel_hi:[1,0]
  v_cvt_pk_bf16_f32 v64, v52, v53
  v_cvt_pk_bf16_f32 v112, v100, v101
  v_cvt_pk_bf16_f32 v65, v54, v55
  v_cvt_pk_bf16_f32 v113, v102, v103
  v_cvt_pk_bf16_f32 v66, v56, v57
  v_cvt_pk_bf16_f32 v114, v104, v105
  v_cvt_pk_bf16_f32 v67, v58, v59
  v_cvt_pk_bf16_f32 v115, v106, v107
  s_waitcnt lgkmcnt(0)
  v_mfma_f32_16x16x32_bf16 v[68:71], v[44:47], v[64:67], 0
  v_mfma_f32_16x16x32_bf16 v[116:119], v[92:95], v[112:115], 0
  v_mfma_f32_16x16x32_bf16 v[72:75], v[48:51], v[64:67], 0
  v_mfma_f32_16x16x32_bf16 v[120:123], v[96:99], v[112:115], 0
  s_nop 4
  v_cvt_pk_bf16_f32 v32, v68, v69
  v_cvt_pk_bf16_f32 v80, v116, v117
  v_cvt_pk_bf16_f32 v33, v70, v71
  v_cvt_pk_bf16_f32 v81, v118, v119
  v_cvt_pk_bf16_f32 v34, v72, v73
  v_cvt_pk_bf16_f32 v82, v120, v121
  v_cvt_pk_bf16_f32 v35, v74, v75
  v_cvt_pk_bf16_f32 v83, v122, v123
  buffer_store_dwordx4 v[32:35], v1, s[20:23], 0 offen sc0 sc1
  buffer_store_dwordx4 v[80:83], v1, s[20:23], s49 offen sc0 sc1
  s_cmp_ge_u32 s4, 4
  s_cbranch_scc1 L_k1done
  s_lshl_b32 s32, s28, 2
  s_add_u32 s32, s32, s4
  s_lshl_b32 s34, s32, 17
  s_lshl_b32 s40, s32, 5
  s_lshl_b32 s52, s32, 8
  v_lshlrev_b32 v13, 1, v4
  v_add_u32 v13, s40, v13
  v_lshlrev_b32 v12, 11, v13
  v_lshl_add_u32 v12, v3, 4, v12
  s_lshl_b32 s32, s29, 7
  v_add_u32 v12, s32, v12
  v_lshlrev_b32 v14, 4, v0
  v_lshlrev_b32 v87, 8, v13
  v_lshl_add_u32 v87, v3, 4, v87
  s_lshl_b32 s32, s29, 19
  v_add_u32 v87, s32, v87
  s_mov_b32 s8, s82
  s_mov_b32 s9, s83
  s_mov_b32 s10, 8388608
  s_mov_b32 s11, 0x20000
  s_cmp_eq_u32 s3, 0
  s_cselect_b32 s16, s64, s84
  s_cselect_b32 s17, s65, s85
  s_cselect_b32 s18, 0, 100663296
  s_add_u32 s16, s16, s18
  s_addc_u32 s17, s17, 0
  s_mov_b32 s18, 4194304
  s_mov_b32 s19, 0x20000
  s_lshl_b32 s18, s18, s3
  s_cmp_eq_u32 s3, 0
  s_cselect_b32 s12, s84, s84
  s_cselect_b32 s13, s85, s85
  s_cselect_b32 s14, 0, 50331648
  s_add_u32 s12, s12, s14
  s_addc_u32 s13, s13, 0
  s_mov_b32 s14, 0
  s_mov_b32 s15, 0x20000
  s_add_u32 s12, s12, 41943040
  s_addc_u32 s13, s13, 0
  s_mov_b32 s14, 524288
  v_lshl_add_u32 v16, v5, 3, v6
  v_lshlrev_b32 v16, 7, v16
  v_lshl_add_u32 v16, v7, 3, v16
  v_lshrrev_b32 v17, 1, v6
  v_lshl_or_b32 v17, v2, 1, v17
  v_lshl_add_u32 v16, v17, 5, v16
  v_add_u32 v16, 131072, v16
  v_xor_b32 v8, 0, v16
  v_xor_b32 v9, 32, v16
  v_xor_b32 v10, 64, v16
  v_xor_b32 v11, 96, v16
  v_lshl_add_u32 v16, v4, 1, v2
  v_lshlrev_b32 v16, 3, v16
  v_add_u32 v16, s52, v16
  s_lshl_b32 s32, s29, 14
  v_add_u32 v112, s32, v16
  v_lshrrev_b32 v17, 5, v0
  v_lshlrev_b32 v17, 17, v17
  v_add_u32 v113, v16, v17
  s_lshl_b32 s32, s4, 12
  v_lshlrev_b32 v16, 8, v4
  v_lshl_add_u32 v16, v5, 3, v16
  v_add_u32 v16, s32, v16
  v_and_b32 v17, 1, v4
  v_bfe_u32 v18, v4, 2, 1
  v_lshl_or_b32 v17, v18, 1, v17
  v_lshl_add_u32 v114, v17, 5, v16
  s_lshl_b32 s44, s29, 8
  s_lshl_b32 s40, s28, 2
  s_add_u32 s44, s44, s40
  s_add_u32 s44, s44, s4
  s_lshl_b32 s44, s44, 11
  v_lshl_add_u32 v16, v5, 3, v6
  v_lshlrev_b32 v16, 7, v16
  v_lshl_add_u32 v16, v7, 3, v16
  v_lshrrev_b32 v17, 1, v6
  v_lshl_or_b32 v17, v2, 1, v17
  v_lshl_add_u32 v16, v17, 5, v16
  v_xor_b32 v115, 0, v16
  v_add_u32 v115, s32, v115
  s_add_u32 s45, s44, 131072
  s_add_u32 s46, s44, 262144
  s_add_u32 s47, s44, 393216
  v_add_u32 v80, 16384, v113
  v_add_u32 v81, 32768, v113
  v_add_u32 v82, 49152, v113
  v_add_u32 v83, 65536, v113
  v_add_u32 v84, 81920, v113
  v_add_u32 v85, 98304, v113
  v_add_u32 v86, 114688, v113
  s_lshl_b32 s48, 0x303, s7
  s_lshr_b32 s48, s48, 8
  s_mov_b32 s49, s34
  s_add_u32 s50, s34, 65536
  s_add_u32 s41, s34, 131072
  s_and_b32 s40, s4, 1
  s_lshl_b32 s32, s40, 1
  s_add_u32 s32, s32, 0
  s_cmp_eq_u32 s32, 3
  s_addc_u32 s32, s32, 5
  s_lshl_b32 s32, s32, 7
  s_mov_b32 vcc_lo, 0xff000000
  s_mov_b32 vcc_hi, 0
  v_mov_b32 v88, s32
  v_cndmask_b32 v88, 0, v88, vcc
  v_lshl_add_u32 v88, v0, 4, v88
  v_add_u32 v90, 4096, v88
  s_lshl_b32 s32, s40, 1
  s_add_u32 s32, s32, 1
  s_cmp_eq_u32 s32, 3
  s_addc_u32 s32, s32, 5
  s_lshl_b32 s32, s32, 7
  s_mov_b32 vcc_lo, 0xff000000
  s_mov_b32 vcc_hi, 0
  v_mov_b32 v89, s32
  v_cndmask_b32 v89, 0, v89, vcc
  v_lshl_add_u32 v89, v0, 4, v89
  v_add_u32 v89, 2048, v89
  v_add_u32 v91, 4096, v89
  s_lshl_b32 s32, s40, 1
  s_add_u32 s32, s32, 0
  s_cmp_eq_u32 s32, 3
  s_addc_u32 s32, s32, 5
  s_lshl_b32 s32, s32, 7
  s_mov_b32 vcc_lo, 0xff000000
  s_mov_b32 vcc_hi, 0
  v_mov_b32 v92, s32
  v_cndmask_b32 v92, 0, v92, vcc
  v_lshl_add_u32 v92, v0, 4, v92
  s_lshl_b32 s32, s40, 1
  s_add_u32 s32, s32, 1
  s_cmp_eq_u32 s32, 3
  s_addc_u32 s32, s32, 5
  s_lshl_b32 s32, s32, 7
  s_mov_b32 vcc_lo, 0xff000000
  s_mov_b32 vcc_hi, 0
  v_mov_b32 v93, s32
  v_cndmask_b32 v93, 0, v93, vcc
  v_lshl_add_u32 v93, v0, 4, v93
  s_lshl_b32 s32, 0, 1
  s_add_u32 s32, s32, 0
  s_cmp_eq_u32 s32, 3
  s_addc_u32 s32, s32, 5
  s_lshl_b32 s32, s32, 7
  s_mov_b32 vcc_lo, 0xff000000
  s_mov_b32 vcc_hi, 0
  v_mov_b32 v192, s32
  v_cndmask_b32 v192, 0, v192, vcc
  v_lshl_add_u32 v192, v0, 4, v192
  s_lshl_b32 s32, 0, 1
  s_add_u32 s32, s32, 1
  s_cmp_eq_u32 s32, 3
  s_addc_u32 s32, s32, 5
  s_lshl_b32 s32, s32, 7
  s_mov_b32 vcc_lo, 0xff000000
  s_mov_b32 vcc_hi, 0
  v_mov_b32 v193, s32
  v_cndmask_b32 v193, 0, v193, vcc
  v_lshl_add_u32 v193, v0, 4, v193
  v_add_u32 v193, 2048, v193
  s_lshl_b32 s32, 1, 1
  s_add_u32 s32, s32, 0
  s_cmp_eq_u32 s32, 3
  s_addc_u32 s32, s32, 5
  s_lshl_b32 s32, s32, 7
  s_mov_b32 vcc_lo, 0xff000000
  s_mov_b32 vcc_hi, 0
  v_mov_b32 v194, s32
  v_cndmask_b32 v194, 0, v194, vcc
  v_lshl_add_u32 v194, v0, 4, v194
  v_add_u32 v194, 4096, v194
  s_lshl_b32 s32, 1, 1
  s_add_u32 s32, s32, 1
  s_cmp_eq_u32 s32, 3
  s_addc_u32 s32, s32, 5
  s_lshl_b32 s32, s32, 7
  s_mov_b32 vcc_lo, 0xff000000
  s_mov_b32 vcc_hi, 0
  v_mov_b32 v195, s32
  v_cndmask_b32 v195, 0, v195, vcc
  v_lshl_add_u32 v195, v0, 4, v195
  v_add_u32 v195, 6144, v195
  s_lshl_b32 s53, s29, 13
  s_add_u32 s53, s53, s34
  s_add_u32 s24, s84, 109051904
  s_addc_u32 s25, s85, 0
  s_mov_b32 s26, 524288
  s_mov_b32 s27, 0x20000
  s_lshl_b32 s32, s28, 4
  v_min_u32 v119, 15, v0
  v_add_u32 v119, s32, v119
  v_max_i32 v119, 0, v119
  v_lshlrev_b32 v119, 7, v119
  s_lshl_b32 s55, s3, 17
  s_add_u32 s55, s55, 0
  s_waitcnt vmcnt(0)
  s_barrier
  s_cmp_lg_u32 s3, 0
  s_cbranch_scc1 C_r1
  buffer_load_dwordx4 v[96:99], v12, s[16:19], 0 offen offset:0
  buffer_load_dwordx4 v[100:103], v12, s[16:19], 0 offen offset:64
  buffer_load_dwordx4 v[104:107], v12, s[16:19], 0 offen offset:2048
  buffer_load_dwordx4 v[108:111], v12, s[16:19], 0 offen offset:2112
  s_branch C_r2
C_r1:
  buffer_load_dwordx4 v[96:99], v87, s[16:19], 0 offen offset:0 sc1
  buffer_load_dwordx4 v[100:103], v87, s[16:19], 0 offen offset:64 sc1
  buffer_load_dwordx4 v[104:107], v87, s[16:19], 0 offen offset:256 sc1
  buffer_load_dwordx4 v[108:111], v87, s[16:19], 0 offen offset:320 sc1
C_r2:
  s_mov_b32 s39, 0
  s_and_b32 s32, s4, 3
  s_cmp_lg_u32 s32, 0
  s_cbranch_scc1 poll3d
  s_sleep 8
poll3:
  buffer_load_dword v16, v119, s[24:27], s55 offen sc0 sc1
  s_waitcnt vmcnt(0)
  v_cmp_eq_u32 vcc, 0, v16
  s_add_u32 s39, s39, 1
  s_cmp_gt_u32 s39, 1000000
  s_cbranch_scc1 poll3d
  s_cbranch_vccnz poll3
poll3d:
  s_barrier
  s_bitcmp1_b32 s48, 0
  s_cselect_b32 s36, s50, s49
  s_add_u32 s36, s36, 0
  buffer_load_dwordx4 v[120:123], v88, s[8:11], s36 offen sc1
  buffer_load_dwordx4 v[124:127], v89, s[8:11], s36 offen sc1
  buffer_load_dwordx4 v[128:131], v90, s[8:11], s36 offen sc1
  buffer_load_dwordx4 v[132:135], v91, s[8:11], s36 offen sc1
  s_bitcmp1_b32 s48, 1
  s_cselect_b32 s36, s50, s49
  s_add_u32 s36, s36, 8192
  buffer_load_dwordx4 v[136:139], v88, s[8:11], s36 offen sc1
  buffer_load_dwordx4 v[140:143], v89, s[8:11], s36 offen sc1
  buffer_load_dwordx4 v[144:147], v90, s[8:11], s36 offen sc1
  buffer_load_dwordx4 v[148:151], v91, s[8:11], s36 offen sc1
  s_bitcmp1_b32 s48, 2
  s_cselect_b32 s36, s50, s49
  s_add_u32 s36, s36, 16384
  buffer_load_dwordx4 v[152:155], v88, s[8:11], s36 offen sc1
  buffer_load_dwordx4 v[156:159], v89, s[8:11], s36 offen sc1
  buffer_load_dwordx4 v[160:163], v90, s[8:11], s36 offen sc1
  buffer_load_dwordx4 v[164:167], v91, s[8:11], s36 offen sc1
  s_bitcmp1_b32 s48, 3
  s_cselect_b32 s36, s50, s49
  s_add_u32 s36, s36, 24576
  buffer_load_dwordx4 v[168:171], v88, s[8:11], s36 offen sc1
  buffer_load_dwordx4 v[172:175], v89, s[8:11], s36 offen sc1
  s_waitcnt vmcnt(14)
  v_permlane16_swap_b32 v96, v98
  v_permlane16_swap_b32 v97, v99
  v_permlane16_swap_b32 v100, v102
  v_permlane16_swap_b32 v101, v103
  v_permlane16_swap_b32 v104, v106
  v_permlane16_swap_b32 v105, v107
  v_permlane16_swap_b32 v108, v110
  v_permlane16_swap_b32 v109, v111
  v_lshlrev_b32 v48, 16, v96
  v_and_b32 v49, 0xffff0000, v96
  v_lshlrev_b32 v50, 16, v97
  v_and_b32 v51, 0xffff0000, v97
  v_lshlrev_b32 v52, 16, v98
  v_and_b32 v53, 0xffff0000, v98
  v_lshlrev_b32 v54, 16, v99
  v_and_b32 v55, 0xffff0000, v99
  v_lshlrev_b32 v56, 16, v100
  v_and_b32 v57, 0xffff0000, v100
  v_lshlrev_b32 v58, 16, v101
  v_and_b32 v59, 0xffff0000, v101
  v_lshlrev_b32 v60, 16, v102
  v_and_b32 v61, 0xffff0000, v102
  v_lshlrev_b32 v62, 16, v103
  v_and_b32 v63, 0xffff0000, v103
  v_lshlrev_b32 v64, 16, v104
  v_and_b32 v65, 0xffff0000, v104
  v_lshlrev_b32 v66, 16, v105
  v_and_b32 v67, 0xffff0000, v105
  v_lshlrev_b32 v68, 16, v106
  v_and_b32 v69, 0xffff0000, v106
  v_lshlrev_b32 v70, 16, v107
  v_and_b32 v71, 0xffff0000, v107
  v_lshlrev_b32 v72, 16, v108
  v_and_b32 v73, 0xffff0000, v108
  v_lshlrev_b32 v74, 16, v109
  v_and_b32 v75, 0xffff0000, v109
  v_lshlrev_b32 v76, 16, v110
  v_and_b32 v77, 0xffff0000, v110
  v_lshlrev_b32 v78, 16, v111
  v_and_b32 v79, 0xffff0000, v111
  s_mov_b32 s43, 0
  s_mov_b32 s39, 1
  s_barrier
  ds_read_b64_tr_b16 v[16:17], v8 offset:0
  ds_read_b64_tr_b16 v[18:19], v8 offset:512
  ds_read_b64_tr_b16 v[20:21], v9 offset:0
  ds_read_b64_tr_b16 v[22:23], v9 offset:512
  ds_read_b64_tr_b16 v[24:25], v10 offset:0
  ds_read_b64_tr_b16 v[26:27], v10 offset:512
  ds_read_b64_tr_b16 v[28:29], v11 offset:0
  ds_read_b64_tr_b16 v[30:31], v11 offset:512
  s_waitcnt vmcnt(13) lgkmcnt(6)
  v_mfma_f32_16x16x32_bf16 v[48:51], v[16:19], v[120:123], v[48:51]
  ds_read_b64_tr_b16 v[32:33], v8 offset:4096
  s_waitcnt vmcnt(12)
  v_mfma_f32_16x16x32_bf16 v[64:67], v[16:19], v[124:127], v[64:67]
  ds_read_b64_tr_b16 v[34:35], v8 offset:4608
  v_add_u32 v8, 8192, v8
  s_waitcnt lgkmcnt(6)
  v_mfma_f32_16x16x32_bf16 v[68:71], v[20:23], v[124:127], v[68:71]
  ds_read_b64_tr_b16 v[36:37], v9 offset:4096
  buffer_load_dwordx4 v[176:179], v90, s[8:11], s36 offen sc1
  v_mfma_f32_16x16x32_bf16 v[52:55], v[20:23], v[120:123], v[52:55]
  ds_read_b64_tr_b16 v[38:39], v9 offset:4608
  v_add_u32 v9, 8192, v9
  s_waitcnt lgkmcnt(6)
  v_mfma_f32_16x16x32_bf16 v[56:59], v[24:27], v[120:123], v[56:59]
  ds_read_b64_tr_b16 v[40:41], v10 offset:4096
  v_mfma_f32_16x16x32_bf16 v[72:75], v[24:27], v[124:127], v[72:75]
  ds_read_b64_tr_b16 v[42:43], v10 offset:4608
  v_add_u32 v10, 8192, v10
  s_waitcnt lgkmcnt(6)
  v_mfma_f32_16x16x32_bf16 v[76:79], v[28:31], v[124:127], v[76:79]
  ds_read_b64_tr_b16 v[44:45], v11 offset:4096
  buffer_load_dwordx4 v[180:183], v91, s[8:11], s36 offen sc1
  v_mfma_f32_16x16x32_bf16 v[60:63], v[28:31], v[120:123], v[60:63]
  ds_read_b64_tr_b16 v[46:47], v11 offset:4608
  v_add_u32 v11, 8192, v11
  s_waitcnt vmcnt(13) lgkmcnt(6)
  v_mfma_f32_16x16x32_bf16 v[48:51], v[32:35], v[128:131], v[48:51]
  ds_read_b64_tr_b16 v[16:17], v8 offset:0
  s_bitcmp1_b32 s48, 4
  s_cselect_b32 s36, s50, s49
  s_waitcnt vmcnt(12)
  v_mfma_f32_16x16x32_bf16 v[64:67], v[32:35], v[132:135], v[64:67]
  ds_read_b64_tr_b16 v[18:19], v8 offset:512
  s_add_u32 s36, s36, 32768
  s_waitcnt lgkmcnt(6)
  v_mfma_f32_16x16x32_bf16 v[68:71], v[36:39], v[132:135], v[68:71]
  ds_read_b64_tr_b16 v[20:21], v9 offset:0
  v_mfma_f32_16x16x32_bf16 v[52:55], v[36:39], v[128:131], v[52:55]
  ds_read_b64_tr_b16 v[22:23], v9 offset:512
  s_waitcnt lgkmcnt(6)
  v_mfma_f32_16x16x32_bf16 v[56:59], v[40:43], v[128:131], v[56:59]
  ds_read_b64_tr_b16 v[24:25], v10 offset:0
  buffer_load_dwordx4 v[120:123], v88, s[8:11], s36 offen sc1
  v_mfma_f32_16x16x32_bf16 v[72:75], v[40:43], v[132:135], v[72:75]
  ds_read_b64_tr_b16 v[26:27], v10 offset:512
  s_waitcnt lgkmcnt(6)
  v_mfma_f32_16x16x32_bf16 v[76:79], v[44:47], v[132:135], v[76:79]
  ds_read_b64_tr_b16 v[28:29], v11 offset:0
  v_mfma_f32_16x16x32_bf16 v[60:63], v[44:47], v[128:131], v[60:63]
  ds_read_b64_tr_b16 v[30:31], v11 offset:512
  buffer_load_dwordx4 v[124:127], v89, s[8:11], s36 offen sc1
  s_waitcnt vmcnt(13) lgkmcnt(6)
  v_mfma_f32_16x16x32_bf16 v[48:51], v[16:19], v[136:139], v[48:51]
  ds_read_b64_tr_b16 v[32:33], v8 offset:4096
  s_waitcnt vmcnt(12)
  v_mfma_f32_16x16x32_bf16 v[64:67], v[16:19], v[140:143], v[64:67]
  ds_read_b64_tr_b16 v[34:35], v8 offset:4608
  v_add_u32 v8, 8192, v8
  s_waitcnt lgkmcnt(6)
  v_mfma_f32_16x16x32_bf16 v[68:71], v[20:23], v[140:143], v[68:71]
  ds_read_b64_tr_b16 v[36:37], v9 offset:4096
  buffer_load_dwordx4 v[128:131], v90, s[8:11], s36 offen sc1
  v_mfma_f32_16x16x32_bf16 v[52:55], v[20:23], v[136:139], v[52:55]
  ds_read_b64_tr_b16 v[38:39], v9 offset:4608
  v_add_u32 v9, 8192, v9
  s_waitcnt lgkmcnt(6)
  v_mfma_f32_16x16x32_bf16 v[56:59], v[24:27], v[136:139], v[56:59]
  ds_read_b64_tr_b16 v[40:41], v10 offset:4096
  v_mfma_f32_16x16x32_bf16 v[72:75], v[24:27], v[140:143], v[72:75]
  ds_read_b64_tr_b16 v[42:43], v10 offset:4608
  v_add_u32 v10, 8192, v10
  s_waitcnt lgkmcnt(6)
  v_mfma_f32_16x16x32_bf16 v[76:79], v[28:31], v[140:143], v[76:79]
  ds_read_b64_tr_b16 v[44:45], v11 offset:4096
  buffer_load_dwordx4 v[132:135], v91, s[8:11], s36 offen sc1
  v_mfma_f32_16x16x32_bf16 v[60:63], v[28:31], v[136:139], v[60:63]
  ds_read_b64_tr_b16 v[46:47], v11 offset:4608
  v_add_u32 v11, 8192, v11
  s_waitcnt vmcnt(13) lgkmcnt(6)
  v_mfma_f32_16x16x32_bf16 v[48:51], v[32:35], v[144:147], v[48:51]
  ds_read_b64_tr_b16 v[16:17], v8 offset:0
  s_bitcmp1_b32 s48, 5
  s_cselect_b32 s36, s50, s49
  s_waitcnt vmcnt(12)
  v_mfma_f32_16x16x32_bf16 v[64:67], v[32:35], v[148:151], v[64:67]
  ds_read_b64_tr_b16 v[18:19], v8 offset:512
  s_add_u32 s36, s36, 40960
  s_waitcnt lgkmcnt(6)
  v_mfma_f32_16x16x32_bf16 v[68:71], v[36:39], v[148:151], v[68:71]
  ds_read_b64_tr_b16 v[20:21], v9 offset:0
  v_mfma_f32_16x16x32_bf16 v[52:55], v[36:39], v[144:147], v[52:55]
  ds_read_b64_tr_b16 v[22:23], v9 offset:512
  s_waitcnt lgkmcnt(6)
  v_mfma_f32_16x16x32_bf16 v[56:59], v[40:43], v[144:147], v[56:59]
  ds_read_b64_tr_b16 v[24:25], v10 offset:0
  buffer_load_dwordx4 v[136:139], v88, s[8:11], s36 offen sc1
  v_mfma_f32_16x16x32_bf16 v[72:75], v[40:43], v[148:151], v[72:75]
  ds_read_b64_tr_b16 v[26:27], v10 offset:512
  s_waitcnt lgkmcnt(6)
  v_mfma_f32_16x16x32_bf16 v[76:79], v[44:47], v[148:151], v[76:79]
  ds_read_b64_tr_b16 v[28:29], v11 offset:0
  v_mfma_f32_16x16x32_bf16 v[60:63], v[44:47], v[144:147], v[60:63]
  ds_read_b64_tr_b16 v[30:31], v11 offset:512
  buffer_load_dwordx4 v[140:143], v89, s[8:11], s36 offen sc1
  s_waitcnt vmcnt(13) lgkmcnt(6)
  v_mfma_f32_16x16x32_bf16 v[48:51], v[16:19], v[152:155], v[48:51]
  ds_read_b64_tr_b16 v[32:33], v8 offset:4096
  s_waitcnt vmcnt(12)
  v_mfma_f32_16x16x32_bf16 v[64:67], v[16:19], v[156:159], v[64:67]
  ds_read_b64_tr_b16 v[34:35], v8 offset:4608
  v_add_u32 v8, 8192, v8
  s_waitcnt lgkmcnt(6)
  v_mfma_f32_16x16x32_bf16 v[68:71], v[20:23], v[156:159], v[68:71]
  ds_read_b64_tr_b16 v[36:37], v9 offset:4096
  buffer_load_dwordx4 v[144:147], v90, s[8:11], s36 offen sc1
  v_mfma_f32_16x16x32_bf16 v[52:55], v[20:23], v[152:155], v[52:55]
  ds_read_b64_tr_b16 v[38:39], v9 offset:4608
  v_add_u32 v9, 8192, v9
  s_waitcnt lgkmcnt(6)
  v_mfma_f32_16x16x32_bf16 v[56:59], v[24:27], v[152:155], v[56:59]
  ds_read_b64_tr_b16 v[40:41], v10 offset:4096
  v_mfma_f32_16x16x32_bf16 v[72:75], v[24:27], v[156:159], v[72:75]
  ds_read_b64_tr_b16 v[42:43], v10 offset:4608
  v_add_u32 v10, 8192, v10
  s_waitcnt lgkmcnt(6)
  v_mfma_f32_16x16x32_bf16 v[76:79], v[28:31], v[156:159], v[76:79]
  ds_read_b64_tr_b16 v[44:45], v11 offset:4096
  buffer_load_dwordx4 v[148:151], v91, s[8:11], s36 offen sc1
  v_mfma_f32_16x16x32_bf16 v[60:63], v[28:31], v[152:155], v[60:63]
  ds_read_b64_tr_b16 v[46:47], v11 offset:4608
  v_add_u32 v11, 8192, v11
  s_waitcnt vmcnt(13) lgkmcnt(6)
  v_mfma_f32_16x16x32_bf16 v[48:51], v[32:35], v[160:163], v[48:51]
  ds_read_b64_tr_b16 v[16:17], v8 offset:0
  s_bitcmp1_b32 s48, 6
  s_cselect_b32 s36, s50, s49
  s_waitcnt vmcnt(12)
  v_mfma_f32_16x16x32_bf16 v[64:67], v[32:35], v[164:167], v[64:67]
  ds_read_b64_tr_b16 v[18:19], v8 offset:512
  s_add_u32 s36, s36, 49152
  s_waitcnt lgkmcnt(6)
  v_mfma_f32_16x16x32_bf16 v[68:71], v[36:39], v[164:167], v[68:71]
  ds_read_b64_tr_b16 v[20:21], v9 offset:0
  v_mfma_f32_16x16x32_bf16 v[52:55], v[36:39], v[160:163], v[52:55]
  ds_read_b64_tr_b16 v[22:23], v9 offset:512
  s_waitcnt lgkmcnt(6)
  v_mfma_f32_16x16x32_bf16 v[56:59], v[40:43], v[160:163], v[56:59]
  ds_read_b64_tr_b16 v[24:25], v10 offset:0
  buffer_load_dwordx4 v[152:155], v88, s[8:11], s36 offen sc1
  v_mfma_f32_16x16x32_bf16 v[72:75], v[40:43], v[164:167], v[72:75]
  ds_read_b64_tr_b16 v[26:27], v10 offset:512
  s_waitcnt lgkmcnt(6)
  v_mfma_f32_16x16x32_bf16 v[76:79], v[44:47], v[164:167], v[76:79]
  ds_read_b64_tr_b16 v[28:29], v11 offset:0
  v_mfma_f32_16x16x32_bf16 v[60:63], v[44:47], v[160:163], v[60:63]
  ds_read_b64_tr_b16 v[30:31], v11 offset:512
  buffer_load_dwordx4 v[156:159], v89, s[8:11], s36 offen sc1
  s_waitcnt vmcnt(13) lgkmcnt(6)
  v_mfma_f32_16x16x32_bf16 v[48:51], v[16:19], v[168:171], v[48:51]
  ds_read_b64_tr_b16 v[32:33], v8 offset:4096
  s_waitcnt vmcnt(12)
  v_mfma_f32_16x16x32_bf16 v[64:67], v[16:19], v[172:175], v[64:67]
  ds_read_b64_tr_b16 v[34:35], v8 offset:4608
  v_add_u32 v8, 4294912256, v8
  s_waitcnt lgkmcnt(6)
  v_mfma_f32_16x16x32_bf16 v[68:71], v[20:23], v[172:175], v[68:71]
  ds_read_b64_tr_b16 v[36:37], v9 offset:4096
  buffer_load_dwordx4 v[160:163], v90, s[8:11], s36 offen sc1
  v_mfma_f32_16x16x32_bf16 v[52:55], v[20:23], v[168:171], v[52:55]
  ds_read_b64_tr_b16 v[38:39], v9 offset:4608
  v_add_u32 v9, 4294912256, v9
  s_waitcnt lgkmcnt(6)
  v_mfma_f32_16x16x32_bf16 v[56:59], v[24:27], v[168:171], v[56:59]
  ds_read_b64_tr_b16 v[40:41], v10 offset:4096
  v_mfma_f32_16x16x32_bf16 v[72:75], v[24:27], v[172:175], v[72:75]
  ds_read_b64_tr_b16 v[42:43], v10 offset:4608
  v_add_u32 v10, 4294912256, v10
  s_waitcnt lgkmcnt(6)
  v_mfma_f32_16x16x32_bf16 v[76:79], v[28:31], v[172:175], v[76:79]
  ds_read_b64_tr_b16 v[44:45], v11 offset:4096
  buffer_load_dwordx4 v[164:167], v91, s[8:11], s36 offen sc1
  v_mfma_f32_16x16x32_bf16 v[60:63], v[28:31], v[168:171], v[60:63]
  ds_read_b64_tr_b16 v[46:47], v11 offset:4608
  v_add_u32 v11, 4294912256, v11
  s_waitcnt vmcnt(13) lgkmcnt(6)
  v_mfma_f32_16x16x32_bf16 v[48:51], v[32:35], v[176:179], v[48:51]
  ds_read_b64_tr_b16 v[16:17], v8 offset:0
  s_bitcmp1_b32 s48, 7
  s_cselect_b32 s36, s50, s49
  s_waitcnt vmcnt(12)
  v_mfma_f32_16x16x32_bf16 v[64:67], v[32:35], v[180:183], v[64:67]
  ds_read_b64_tr_b16 v[18:19], v8 offset:512
  s_add_u32 s36, s36, 57344
  s_waitcnt lgkmcnt(6)
  v_mfma_f32_16x16x32_bf16 v[68:71], v[36:39], v[180:183], v[68:71]
  ds_read_b64_tr_b16 v[20:21], v9 offset:0
  v_mfma_f32_16x16x32_bf16 v[52:55], v[36:39], v[176:179], v[52:55]
  ds_read_b64_tr_b16 v[22:23], v9 offset:512
  s_waitcnt lgkmcnt(6)
  v_mfma_f32_16x16x32_bf16 v[56:59], v[40:43], v[176:179], v[56:59]
  ds_read_b64_tr_b16 v[24:25], v10 offset:0
  buffer_load_dwordx4 v[168:171], v88, s[8:11], s36 offen sc1
  v_mfma_f32_16x16x32_bf16 v[72:75], v[40:43], v[180:183], v[72:75]
  ds_read_b64_tr_b16 v[26:27], v10 offset:512
  s_waitcnt lgkmcnt(6)
  v_mfma_f32_16x16x32_bf16 v[76:79], v[44:47], v[180:183], v[76:79]
  ds_read_b64_tr_b16 v[28:29], v11 offset:0
  v_mfma_f32_16x16x32_bf16 v[60:63], v[44:47], v[176:179], v[60:63]
  ds_read_b64_tr_b16 v[30:31], v11 offset:512
  buffer_load_dwordx4 v[172:175], v89, s[8:11], s36 offen sc1
  s_waitcnt vmcnt(13) lgkmcnt(6)
  v_mfma_f32_16x16x32_bf16 v[48:51], v[16:19], v[120:123], v[48:51]
  ds_read_b64_tr_b16 v[32:33], v8 offset:4096
  s_waitcnt vmcnt(12)
  v_mfma_f32_16x16x32_bf16 v[64:67], v[16:19], v[124:127], v[64:67]
  ds_read_b64_tr_b16 v[34:35], v8 offset:4608
  v_add_u32 v8, 8192, v8
  s_waitcnt lgkmcnt(6)
  v_mfma_f32_16x16x32_bf16 v[68:71], v[20:23], v[124:127], v[68:71]
  ds_read_b64_tr_b16 v[36:37], v9 offset:4096
  buffer_load_dwordx4 v[176:179], v90, s[8:11], s36 offen sc1
  v_mfma_f32_16x16x32_bf16 v[52:55], v[20:23], v[120:123], v[52:55]
  ds_read_b64_tr_b16 v[38:39], v9 offset:4608
  v_add_u32 v9, 8192, v9
  s_waitcnt lgkmcnt(6)
  v_mfma_f32_16x16x32_bf16 v[56:59], v[24:27], v[120:123], v[56:59]
  ds_read_b64_tr_b16 v[40:41], v10 offset:4096
  v_mfma_f32_16x16x32_bf16 v[72:75], v[24:27], v[124:127], v[72:75]
  ds_read_b64_tr_b16 v[42:43], v10 offset:4608
  v_add_u32 v10, 8192, v10
  s_waitcnt lgkmcnt(6)
  v_mfma_f32_16x16x32_bf16 v[76:79], v[28:31], v[124:127], v[76:79]
  ds_read_b64_tr_b16 v[44:45], v11 offset:4096
  buffer_load_dwordx4 v[180:183], v91, s[8:11], s36 offen sc1
  v_mfma_f32_16x16x32_bf16 v[60:63], v[28:31], v[120:123], v[60:63]
  ds_read_b64_tr_b16 v[46:47], v11 offset:4608
  v_add_u32 v11, 8192, v11
  s_waitcnt vmcnt(13) lgkmcnt(6)
  v_mfma_f32_16x16x32_bf16 v[48:51], v[32:35], v[128:131], v[48:51]
  ds_read_b64_tr_b16 v[16:17], v8 offset:0
  s_mov_b32 s49, s50
  s_add_u32 s50, s50, 65536
  s_waitcnt vmcnt(12)
  v_mfma_f32_16x16x32_bf16 v[64:67], v[32:35], v[132:135], v[64:67]
  ds_read_b64_tr_b16 v[18:19], v8 offset:512
  s_cmp_eq_u32 s50, s41
  s_cselect_b32 s50, s34, s50
  s_waitcnt lgkmcnt(6)
  v_mfma_f32_16x16x32_bf16 v[68:71], v[36:39], v[132:135], v[68:71]
  ds_read_b64_tr_b16 v[20:21], v9 offset:0
  s_bitcmp1_b32 s48, 0
  s_cselect_b32 s36, s50, s49
  v_mfma_f32_16x16x32_bf16 v[52:55], v[36:39], v[128:131], v[52:55]
  ds_read_b64_tr_b16 v[22:23], v9 offset:512
  s_add_u32 s36, s36, 0
  s_waitcnt lgkmcnt(6)
  v_mfma_f32_16x16x32_bf16 v[56:59], v[40:43], v[128:131], v[56:59]
  ds_read_b64_tr_b16 v[24:25], v10 offset:0
  buffer_load_dwordx4 v[120:123], v88, s[8:11], s36 offen sc1
  v_mfma_f32_16x16x32_bf16 v[72:75], v[40:43], v[132:135], v[72:75]
  ds_read_b64_tr_b16 v[26:27], v10 offset:512
  s_waitcnt lgkmcnt(6)
  v_mfma_f32_16x16x32_bf16 v[76:79], v[44:47], v[132:135], v[76:79]
  ds_read_b64_tr_b16 v[28:29], v11 offset:0
  v_mfma_f32_16x16x32_bf16 v[60:63], v[44:47], v[128:131], v[60:63]
  ds_read_b64_tr_b16 v[30:31], v11 offset:512
  buffer_load_dwordx4 v[124:127], v89, s[8:11], s36 offen sc1
  s_waitcnt vmcnt(13) lgkmcnt(6)
  v_mfma_f32_16x16x32_bf16 v[48:51], v[16:19], v[136:139], v[48:51]
  ds_read_b64_tr_b16 v[32:33], v8 offset:4096
  s_waitcnt vmcnt(12)
  v_mfma_f32_16x16x32_bf16 v[64:67], v[16:19], v[140:143], v[64:67]
  ds_read_b64_tr_b16 v[34:35], v8 offset:4608
  v_add_u32 v8, 8192, v8
  s_waitcnt lgkmcnt(6)
  v_mfma_f32_16x16x32_bf16 v[68:71], v[20:23], v[140:143], v[68:71]
  ds_read_b64_tr_b16 v[36:37], v9 offset:4096
  buffer_load_dwordx4 v[128:131], v90, s[8:11], s36 offen sc1
  v_mfma_f32_16x16x32_bf16 v[52:55], v[20:23], v[136:139], v[52:55]
  ds_read_b64_tr_b16 v[38:39], v9 offset:4608
  v_add_u32 v9, 8192, v9
  s_waitcnt lgkmcnt(6)
  v_mfma_f32_16x16x32_bf16 v[56:59], v[24:27], v[136:139], v[56:59]
  ds_read_b64_tr_b16 v[40:41], v10 offset:4096
  v_mfma_f32_16x16x32_bf16 v[72:75], v[24:27], v[140:143], v[72:75]
  ds_read_b64_tr_b16 v[42:43], v10 offset:4608
  v_add_u32 v10, 8192, v10
  s_waitcnt lgkmcnt(6)
  v_mfma_f32_16x16x32_bf16 v[76:79], v[28:31], v[140:143], v[76:79]
  ds_read_b64_tr_b16 v[44:45], v11 offset:4096
  buffer_load_dwordx4 v[132:135], v91, s[8:11], s36 offen sc1
  v_mfma_f32_16x16x32_bf16 v[60:63], v[28:31], v[136:139], v[60:63]
  ds_read_b64_tr_b16 v[46:47], v11 offset:4608
  v_add_u32 v11, 8192, v11
  s_waitcnt vmcnt(13) lgkmcnt(6)
  v_mfma_f32_16x16x32_bf16 v[48:51], v[32:35], v[144:147], v[48:51]
  ds_read_b64_tr_b16 v[16:17], v8 offset:0
  s_bitcmp1_b32 s48, 1
  s_cselect_b32 s36, s50, s49
  s_waitcnt vmcnt(12)
  v_mfma_f32_16x16x32_bf16 v[64:67], v[32:35], v[148:151], v[64:67]
  ds_read_b64_tr_b16 v[18:19], v8 offset:512
  s_add_u32 s36, s36, 8192
  s_waitcnt lgkmcnt(6)
  v_mfma_f32_16x16x32_bf16 v[68:71], v[36:39], v[148:151], v[68:71]
  ds_read_b64_tr_b16 v[20:21], v9 offset:0
  v_mfma_f32_16x16x32_bf16 v[52:55], v[36:39], v[144:147], v[52:55]
  ds_read_b64_tr_b16 v[22:23], v9 offset:512
  s_waitcnt lgkmcnt(6)
  v_mfma_f32_16x16x32_bf16 v[56:59], v[40:43], v[144:147], v[56:59]
  ds_read_b64_tr_b16 v[24:25], v10 offset:0
  buffer_load_dwordx4 v[136:139], v88, s[8:11], s36 offen sc1
  v_mfma_f32_16x16x32_bf16 v[72:75], v[40:43], v[148:151], v[72:75]
  ds_read_b64_tr_b16 v[26:27], v10 offset:512
  s_waitcnt lgkmcnt(6)
  v_mfma_f32_16x16x32_bf16 v[76:79], v[44:47], v[148:151], v[76:79]
  ds_read_b64_tr_b16 v[28:29], v11 offset:0
  v_mfma_f32_16x16x32_bf16 v[60:63], v[44:47], v[144:147], v[60:63]
  ds_read_b64_tr_b16 v[30:31], v11 offset:512
  buffer_load_dwordx4 v[140:143], v89, s[8:11], s36 offen sc1
  s_waitcnt vmcnt(13) lgkmcnt(6)
  v_mfma_f32_16x16x32_bf16 v[48:51], v[16:19], v[152:155], v[48:51]
  ds_read_b64_tr_b16 v[32:33], v8 offset:4096
  s_waitcnt vmcnt(12)
  v_mfma_f32_16x16x32_bf16 v[64:67], v[16:19], v[156:159], v[64:67]
  ds_read_b64_tr_b16 v[34:35], v8 offset:4608
  v_add_u32 v8, 4294850304, v8
  s_waitcnt lgkmcnt(6)
  v_mfma_f32_16x16x32_bf16 v[68:71], v[20:23], v[156:159], v[68:71]
  ds_read_b64_tr_b16 v[36:37], v9 offset:4096
  buffer_load_dwordx4 v[144:147], v90, s[8:11], s36 offen sc1
  v_mfma_f32_16x16x32_bf16 v[52:55], v[20:23], v[152:155], v[52:55]
  ds_read_b64_tr_b16 v[38:39], v9 offset:4608
  v_add_u32 v9, 4294850304, v9
  s_waitcnt lgkmcnt(6)
  v_mfma_f32_16x16x32_bf16 v[56:59], v[24:27], v[152:155], v[56:59]
  ds_read_b64_tr_b16 v[40:41], v10 offset:4096
  v_mfma_f32_16x16x32_bf16 v[72:75], v[24:27], v[156:159], v[72:75]
  ds_read_b64_tr_b16 v[42:43], v10 offset:4608
  v_add_u32 v10, 4294850304, v10
  s_waitcnt lgkmcnt(6)
  v_mfma_f32_16x16x32_bf16 v[76:79], v[28:31], v[156:159], v[76:79]
  ds_read_b64_tr_b16 v[44:45], v11 offset:4096
  buffer_load_dwordx4 v[148:151], v91, s[8:11], s36 offen sc1
  v_mfma_f32_16x16x32_bf16 v[60:63], v[28:31], v[152:155], v[60:63]
  ds_read_b64_tr_b16 v[46:47], v11 offset:4608
  v_add_u32 v11, 4294850304, v11
  s_waitcnt vmcnt(13) lgkmcnt(6)
  v_mfma_f32_16x16x32_bf16 v[48:51], v[32:35], v[160:163], v[48:51]
  ds_read_b64_tr_b16 v[16:17], v8 offset:0
  s_bitcmp1_b32 s48, 2
  s_cselect_b32 s36, s50, s49
  s_waitcnt vmcnt(12)
  v_mfma_f32_16x16x32_bf16 v[64:67], v[32:35], v[164:167], v[64:67]
  ds_read_b64_tr_b16 v[18:19], v8 offset:512
  s_add_u32 s36, s36, 16384
  s_waitcnt lgkmcnt(6)
  v_mfma_f32_16x16x32_bf16 v[68:71], v[36:39], v[164:167], v[68:71]
  ds_read_b64_tr_b16 v[20:21], v9 offset:0
  v_mfma_f32_16x16x32_bf16 v[52:55], v[36:39], v[160:163], v[52:55]
  ds_read_b64_tr_b16 v[22:23], v9 offset:512
  s_waitcnt lgkmcnt(6)
  v_mfma_f32_16x16x32_bf16 v[56:59], v[40:43], v[160:163], v[56:59]
  ds_read_b64_tr_b16 v[24:25], v10 offset:0
  buffer_load_dwordx4 v[152:155], v88, s[8:11], s36 offen sc1
  v_mfma_f32_16x16x32_bf16 v[72:75], v[40:43], v[164:167], v[72:75]
  ds_read_b64_tr_b16 v[26:27], v10 offset:512
  s_waitcnt lgkmcnt(6)
  v_mfma_f32_16x16x32_bf16 v[76:79], v[44:47], v[164:167], v[76:79]
  ds_read_b64_tr_b16 v[28:29], v11 offset:0
  v_mfma_f32_16x16x32_bf16 v[60:63], v[44:47], v[160:163], v[60:63]
  ds_read_b64_tr_b16 v[30:31], v11 offset:512
  buffer_load_dwordx4 v[156:159], v89, s[8:11], s36 offen sc1
  s_waitcnt vmcnt(13) lgkmcnt(6)
  v_mfma_f32_16x16x32_bf16 v[48:51], v[16:19], v[168:171], v[48:51]
  ds_read_b64_tr_b16 v[32:33], v8 offset:4096
  s_waitcnt vmcnt(12)
  v_mfma_f32_16x16x32_bf16 v[64:67], v[16:19], v[172:175], v[64:67]
  ds_read_b64_tr_b16 v[34:35], v8 offset:4608
  v_add_u32 v8, 8192, v8
  s_waitcnt lgkmcnt(6)
  v_mfma_f32_16x16x32_bf16 v[68:71], v[20:23], v[172:175], v[68:71]
  ds_read_b64_tr_b16 v[36:37], v9 offset:4096
  buffer_load_dwordx4 v[160:163], v90, s[8:11], s36 offen sc1
  v_mfma_f32_16x16x32_bf16 v[52:55], v[20:23], v[168:171], v[52:55]
  ds_read_b64_tr_b16 v[38:39], v9 offset:4608
  v_add_u32 v9, 8192, v9
  s_waitcnt lgkmcnt(6)
  v_mfma_f32_16x16x32_bf16 v[56:59], v[24:27], v[168:171], v[56:59]
  ds_read_b64_tr_b16 v[40:41], v10 offset:4096
  v_mfma_f32_16x16x32_bf16 v[72:75], v[24:27], v[172:175], v[72:75]
  ds_read_b64_tr_b16 v[42:43], v10 offset:4608
  v_add_u32 v10, 8192, v10
  s_waitcnt lgkmcnt(6)
  v_mfma_f32_16x16x32_bf16 v[76:79], v[28:31], v[172:175], v[76:79]
  ds_read_b64_tr_b16 v[44:45], v11 offset:4096
  buffer_load_dwordx4 v[164:167], v91, s[8:11], s36 offen sc1
  v_mfma_f32_16x16x32_bf16 v[60:63], v[28:31], v[168:171], v[60:63]
  ds_read_b64_tr_b16 v[46:47], v11 offset:4608
  v_add_u32 v11, 8192, v11
  s_waitcnt vmcnt(13) lgkmcnt(6)
  v_mfma_f32_16x16x32_bf16 v[48:51], v[32:35], v[176:179], v[48:51]
  ds_read_b64_tr_b16 v[16:17], v8 offset:0
  s_bitcmp1_b32 s48, 3
  s_cselect_b32 s36, s50, s49
  s_waitcnt vmcnt(12)
  v_mfma_f32_16x16x32_bf16 v[64:67], v[32:35], v[180:183], v[64:67]
  ds_read_b64_tr_b16 v[18:19], v8 offset:512
  s_add_u32 s36, s36, 24576
  s_waitcnt lgkmcnt(6)
  v_mfma_f32_16x16x32_bf16 v[68:71], v[36:39], v[180:183], v[68:71]
  ds_read_b64_tr_b16 v[20:21], v9 offset:0
  v_mfma_f32_16x16x32_bf16 v[52:55], v[36:39], v[176:179], v[52:55]
  ds_read_b64_tr_b16 v[22:23], v9 offset:512
  s_waitcnt lgkmcnt(6)
  v_mfma_f32_16x16x32_bf16 v[56:59], v[40:43], v[176:179], v[56:59]
  ds_read_b64_tr_b16 v[24:25], v10 offset:0
  buffer_load_dwordx4 v[168:171], v88, s[8:11], s36 offen sc1
  v_mfma_f32_16x16x32_bf16 v[72:75], v[40:43], v[180:183], v[72:75]
  ds_read_b64_tr_b16 v[26:27], v10 offset:512
  s_waitcnt lgkmcnt(6)
  v_mfma_f32_16x16x32_bf16 v[76:79], v[44:47], v[180:183], v[76:79]
  ds_read_b64_tr_b16 v[28:29], v11 offset:0
  v_mfma_f32_16x16x32_bf16 v[60:63], v[44:47], v[176:179], v[60:63]
  ds_read_b64_tr_b16 v[30:31], v11 offset:512
  buffer_load_dwordx4 v[172:175], v89, s[8:11], s36 offen sc1
  s_waitcnt vmcnt(13) lgkmcnt(6)
  v_mfma_f32_16x16x32_bf16 v[48:51], v[16:19], v[120:123], v[48:51]
  ds_read_b64_tr_b16 v[32:33], v8 offset:4096
  s_waitcnt vmcnt(12)
  v_mfma_f32_16x16x32_bf16 v[64:67], v[16:19], v[124:127], v[64:67]
  ds_read_b64_tr_b16 v[34:35], v8 offset:4608
  v_add_u32 v8, 8192, v8
  s_waitcnt lgkmcnt(6)
  v_mfma_f32_16x16x32_bf16 v[68:71], v[20:23], v[124:127], v[68:71]
  ds_read_b64_tr_b16 v[36:37], v9 offset:4096
  buffer_load_dwordx4 v[176:179], v90, s[8:11], s36 offen sc1
  v_mfma_f32_16x16x32_bf16 v[52:55], v[20:23], v[120:123], v[52:55]
  ds_read_b64_tr_b16 v[38:39], v9 offset:4608
  v_add_u32 v9, 8192, v9
  s_waitcnt lgkmcnt(6)
  v_mfma_f32_16x16x32_bf16 v[56:59], v[24:27], v[120:123], v[56:59]
  ds_read_b64_tr_b16 v[40:41], v10 offset:4096
  v_mfma_f32_16x16x32_bf16 v[72:75], v[24:27], v[124:127], v[72:75]
  ds_read_b64_tr_b16 v[42:43], v10 offset:4608
  v_add_u32 v10, 8192, v10
  s_waitcnt lgkmcnt(6)
  v_mfma_f32_16x16x32_bf16 v[76:79], v[28:31], v[124:127], v[76:79]
  ds_read_b64_tr_b16 v[44:45], v11 offset:4096
  buffer_load_dwordx4 v[180:183], v91, s[8:11], s36 offen sc1
  v_mfma_f32_16x16x32_bf16 v[60:63], v[28:31], v[120:123], v[60:63]
  ds_read_b64_tr_b16 v[46:47], v11 offset:4608
  v_add_u32 v11, 8192, v11
  s_waitcnt vmcnt(13) lgkmcnt(6)
  v_mfma_f32_16x16x32_bf16 v[48:51], v[32:35], v[128:131], v[48:51]
  ds_read_b64_tr_b16 v[16:17], v8 offset:0
  s_bitcmp1_b32 s48, 4
  s_cselect_b32 s36, s50, s49
  s_waitcnt vmcnt(12)
  v_mfma_f32_16x16x32_bf16 v[64:67], v[32:35], v[132:135], v[64:67]
  ds_read_b64_tr_b16 v[18:19], v8 offset:512
  s_add_u32 s36, s36, 32768
  s_waitcnt lgkmcnt(6)
  v_mfma_f32_16x16x32_bf16 v[68:71], v[36:39], v[132:135], v[68:71]
  ds_read_b64_tr_b16 v[20:21], v9 offset:0
  v_mfma_f32_16x16x32_bf16 v[52:55], v[36:39], v[128:131], v[52:55]
  ds_read_b64_tr_b16 v[22:23], v9 offset:512
  s_waitcnt lgkmcnt(6)
  v_mfma_f32_16x16x32_bf16 v[56:59], v[40:43], v[128:131], v[56:59]
  ds_read_b64_tr_b16 v[24:25], v10 offset:0
  buffer_load_dwordx4 v[120:123], v88, s[8:11], s36 offen sc1
  v_mfma_f32_16x16x32_bf16 v[72:75], v[40:43], v[132:135], v[72:75]
  ds_read_b64_tr_b16 v[26:27], v10 offset:512
  s_waitcnt lgkmcnt(6)
  v_mfma_f32_16x16x32_bf16 v[76:79], v[44:47], v[132:135], v[76:79]
  ds_read_b64_tr_b16 v[28:29], v11 offset:0
  v_mfma_f32_16x16x32_bf16 v[60:63], v[44:47], v[128:131], v[60:63]
  ds_read_b64_tr_b16 v[30:31], v11 offset:512
  buffer_load_dwordx4 v[124:127], v89, s[8:11], s36 offen sc1
  s_waitcnt vmcnt(13) lgkmcnt(6)
  v_mfma_f32_16x16x32_bf16 v[48:51], v[16:19], v[136:139], v[48:51]
  ds_read_b64_tr_b16 v[32:33], v8 offset:4096
  s_waitcnt vmcnt(12)
  v_mfma_f32_16x16x32_bf16 v[64:67], v[16:19], v[140:143], v[64:67]
  ds_read_b64_tr_b16 v[34:35], v8 offset:4608
  v_add_u32 v8, 8192, v8
  s_waitcnt lgkmcnt(6)
  v_mfma_f32_16x16x32_bf16 v[68:71], v[20:23], v[140:143], v[68:71]
  ds_read_b64_tr_b16 v[36:37], v9 offset:4096
  buffer_load_dwordx4 v[128:131], v90, s[8:11], s36 offen sc1
  v_mfma_f32_16x16x32_bf16 v[52:55], v[20:23], v[136:139], v[52:55]
  ds_read_b64_tr_b16 v[38:39], v9 offset:4608
  v_add_u32 v9, 8192, v9
  s_waitcnt lgkmcnt(6)
  v_mfma_f32_16x16x32_bf16 v[56:59], v[24:27], v[136:139], v[56:59]
  ds_read_b64_tr_b16 v[40:41], v10 offset:4096
  v_mfma_f32_16x16x32_bf16 v[72:75], v[24:27], v[140:143], v[72:75]
  ds_read_b64_tr_b16 v[42:43], v10 offset:4608
  v_add_u32 v10, 8192, v10
  s_waitcnt lgkmcnt(6)
  v_mfma_f32_16x16x32_bf16 v[76:79], v[28:31], v[140:143], v[76:79]
  ds_read_b64_tr_b16 v[44:45], v11 offset:4096
  buffer_load_dwordx4 v[132:135], v91, s[8:11], s36 offen sc1
  v_mfma_f32_16x16x32_bf16 v[60:63], v[28:31], v[136:139], v[60:63]
  ds_read_b64_tr_b16 v[46:47], v11 offset:4608
  v_add_u32 v11, 8192, v11
  s_waitcnt vmcnt(13) lgkmcnt(6)
  v_mfma_f32_16x16x32_bf16 v[48:51], v[32:35], v[144:147], v[48:51]
  ds_read_b64_tr_b16 v[16:17], v8 offset:0
  s_bitcmp1_b32 s48, 5
  s_cselect_b32 s36, s50, s49
  s_waitcnt vmcnt(12)
  v_mfma_f32_16x16x32_bf16 v[64:67], v[32:35], v[148:151], v[64:67]
  ds_read_b64_tr_b16 v[18:19], v8 offset:512
  s_add_u32 s36, s36, 40960
  s_waitcnt lgkmcnt(6)
  v_mfma_f32_16x16x32_bf16 v[68:71], v[36:39], v[148:151], v[68:71]
  ds_read_b64_tr_b16 v[20:21], v9 offset:0
  v_mfma_f32_16x16x32_bf16 v[52:55], v[36:39], v[144:147], v[52:55]
  ds_read_b64_tr_b16 v[22:23], v9 offset:512
  s_waitcnt lgkmcnt(6)
  v_mfma_f32_16x16x32_bf16 v[56:59], v[40:43], v[144:147], v[56:59]
  ds_read_b64_tr_b16 v[24:25], v10 offset:0
  buffer_load_dwordx4 v[136:139], v88, s[8:11], s36 offen sc1
  v_mfma_f32_16x16x32_bf16 v[72:75], v[40:43], v[148:151], v[72:75]
  ds_read_b64_tr_b16 v[26:27], v10 offset:512
  s_waitcnt lgkmcnt(6)
  v_mfma_f32_16x16x32_bf16 v[76:79], v[44:47], v[148:151], v[76:79]
  ds_read_b64_tr_b16 v[28:29], v11 offset:0
  v_mfma_f32_16x16x32_bf16 v[60:63], v[44:47], v[144:147], v[60:63]
  ds_read_b64_tr_b16 v[30:31], v11 offset:512
  buffer_load_dwordx4 v[140:143], v89, s[8:11], s36 offen sc1
  s_waitcnt vmcnt(13) lgkmcnt(6)
  v_mfma_f32_16x16x32_bf16 v[48:51], v[16:19], v[152:155], v[48:51]
  ds_read_b64_tr_b16 v[32:33], v8 offset:4096
  s_waitcnt vmcnt(12)
  v_mfma_f32_16x16x32_bf16 v[64:67], v[16:19], v[156:159], v[64:67]
  ds_read_b64_tr_b16 v[34:35], v8 offset:4608
  v_add_u32 v8, 8192, v8
  s_waitcnt lgkmcnt(6)
  v_mfma_f32_16x16x32_bf16 v[68:71], v[20:23], v[156:159], v[68:71]
  ds_read_b64_tr_b16 v[36:37], v9 offset:4096
  buffer_load_dwordx4 v[144:147], v90, s[8:11], s36 offen sc1
  v_mfma_f32_16x16x32_bf16 v[52:55], v[20:23], v[152:155], v[52:55]
  ds_read_b64_tr_b16 v[38:39], v9 offset:4608
  v_add_u32 v9, 8192, v9
  s_waitcnt lgkmcnt(6)
  v_mfma_f32_16x16x32_bf16 v[56:59], v[24:27], v[152:155], v[56:59]
  ds_read_b64_tr_b16 v[40:41], v10 offset:4096
  v_mfma_f32_16x16x32_bf16 v[72:75], v[24:27], v[156:159], v[72:75]
  ds_read_b64_tr_b16 v[42:43], v10 offset:4608
  v_add_u32 v10, 8192, v10
  s_waitcnt lgkmcnt(6)
  v_mfma_f32_16x16x32_bf16 v[76:79], v[28:31], v[156:159], v[76:79]
  ds_read_b64_tr_b16 v[44:45], v11 offset:4096
  buffer_load_dwordx4 v[148:151], v91, s[8:11], s36 offen sc1
  v_mfma_f32_16x16x32_bf16 v[60:63], v[28:31], v[152:155], v[60:63]
  ds_read_b64_tr_b16 v[46:47], v11 offset:4608
  v_add_u32 v11, 8192, v11
  s_waitcnt vmcnt(13) lgkmcnt(6)
  v_mfma_f32_16x16x32_bf16 v[48:51], v[32:35], v[160:163], v[48:51]
  ds_read_b64_tr_b16 v[16:17], v8 offset:0
  s_bitcmp1_b32 s48, 6
  s_cselect_b32 s36, s50, s49
  s_waitcnt vmcnt(12)
  v_mfma_f32_16x16x32_bf16 v[64:67], v[32:35], v[164:167], v[64:67]
  ds_read_b64_tr_b16 v[18:19], v8 offset:512
  s_add_u32 s36, s36, 49152
  s_waitcnt lgkmcnt(6)
  v_mfma_f32_16x16x32_bf16 v[68:71], v[36:39], v[164:167], v[68:71]
  ds_read_b64_tr_b16 v[20:21], v9 offset:0
  v_mfma_f32_16x16x32_bf16 v[52:55], v[36:39], v[160:163], v[52:55]
  ds_read_b64_tr_b16 v[22:23], v9 offset:512
  s_waitcnt lgkmcnt(6)
  v_mfma_f32_16x16x32_bf16 v[56:59], v[40:43], v[160:163], v[56:59]
  ds_read_b64_tr_b16 v[24:25], v10 offset:0
  buffer_load_dwordx4 v[152:155], v88, s[8:11], s36 offen sc1
  v_mfma_f32_16x16x32_bf16 v[72:75], v[40:43], v[164:167], v[72:75]
  ds_read_b64_tr_b16 v[26:27], v10 offset:512
  s_waitcnt lgkmcnt(6)
  v_mfma_f32_16x16x32_bf16 v[76:79], v[44:47], v[164:167], v[76:79]
  ds_read_b64_tr_b16 v[28:29], v11 offset:0
  v_mfma_f32_16x16x32_bf16 v[60:63], v[44:47], v[160:163], v[60:63]
  ds_read_b64_tr_b16 v[30:31], v11 offset:512
  buffer_load_dwordx4 v[156:159], v89, s[8:11], s36 offen sc1
  s_waitcnt vmcnt(13) lgkmcnt(6)
  v_mfma_f32_16x16x32_bf16 v[48:51], v[16:19], v[168:171], v[48:51]
  ds_read_b64_tr_b16 v[32:33], v8 offset:4096
  s_waitcnt vmcnt(12)
  v_mfma_f32_16x16x32_bf16 v[64:67], v[16:19], v[172:175], v[64:67]
  ds_read_b64_tr_b16 v[34:35], v8 offset:4608
  v_add_u32 v8, 10240, v8
  s_waitcnt lgkmcnt(6)
  v_mfma_f32_16x16x32_bf16 v[68:71], v[20:23], v[172:175], v[68:71]
  ds_read_b64_tr_b16 v[36:37], v9 offset:4096
  buffer_load_dwordx4 v[160:163], v90, s[8:11], s36 offen sc1
  v_mfma_f32_16x16x32_bf16 v[52:55], v[20:23], v[168:171], v[52:55]
  ds_read_b64_tr_b16 v[38:39], v9 offset:4608
  v_add_u32 v9, 10240, v9
  s_waitcnt lgkmcnt(6)
  v_mfma_f32_16x16x32_bf16 v[56:59], v[24:27], v[168:171], v[56:59]
  ds_read_b64_tr_b16 v[40:41], v10 offset:4096
  v_mfma_f32_16x16x32_bf16 v[72:75], v[24:27], v[172:175], v[72:75]
  ds_read_b64_tr_b16 v[42:43], v10 offset:4608
  v_add_u32 v10, 10240, v10
  s_waitcnt lgkmcnt(6)
  v_mfma_f32_16x16x32_bf16 v[76:79], v[28:31], v[172:175], v[76:79]
  ds_read_b64_tr_b16 v[44:45], v11 offset:4096
  buffer_load_dwordx4 v[164:167], v91, s[8:11], s36 offen sc1
  v_mfma_f32_16x16x32_bf16 v[60:63], v[28:31], v[168:171], v[60:63]
  ds_read_b64_tr_b16 v[46:47], v11 offset:4608
  v_add_u32 v11, 10240, v11
  s_waitcnt vmcnt(13) lgkmcnt(6)
  v_mfma_f32_16x16x32_bf16 v[48:51], v[32:35], v[176:179], v[48:51]
  ds_read_b64_tr_b16 v[16:17], v8 offset:0
  s_bitcmp1_b32 s48, 7
  s_cselect_b32 s36, s50, s49
  s_waitcnt vmcnt(12)
  v_mfma_f32_16x16x32_bf16 v[64:67], v[32:35], v[180:183], v[64:67]
  ds_read_b64_tr_b16 v[18:19], v8 offset:512
  s_add_u32 s36, s36, 57344
  s_waitcnt lgkmcnt(6)
  v_mfma_f32_16x16x32_bf16 v[68:71], v[36:39], v[180:183], v[68:71]
  ds_read_b64_tr_b16 v[20:21], v9 offset:0
  v_mfma_f32_16x16x32_bf16 v[52:55], v[36:39], v[176:179], v[52:55]
  ds_read_b64_tr_b16 v[22:23], v9 offset:512
  s_waitcnt lgkmcnt(6)
  v_mfma_f32_16x16x32_bf16 v[56:59], v[40:43], v[176:179], v[56:59]
  ds_read_b64_tr_b16 v[24:25], v10 offset:0
  buffer_load_dwordx4 v[168:171], v88, s[8:11], s36 offen sc1
  v_mfma_f32_16x16x32_bf16 v[72:75], v[40:43], v[180:183], v[72:75]
  ds_read_b64_tr_b16 v[26:27], v10 offset:512
  s_waitcnt lgkmcnt(6)
  v_mfma_f32_16x16x32_bf16 v[76:79], v[44:47], v[180:183], v[76:79]
  ds_read_b64_tr_b16 v[28:29], v11 offset:0
  v_mfma_f32_16x16x32_bf16 v[60:63], v[44:47], v[176:179], v[60:63]
  ds_read_b64_tr_b16 v[30:31], v11 offset:512
  buffer_load_dwordx4 v[172:175], v89, s[8:11], s36 offen sc1
  s_waitcnt vmcnt(13) lgkmcnt(6)
  v_mfma_f32_16x16x32_bf16 v[48:51], v[16:19], v[120:123], v[48:51]
  ds_read_b64_tr_b16 v[32:33], v8 offset:4096
  s_waitcnt vmcnt(12)
  v_mfma_f32_16x16x32_bf16 v[64:67], v[16:19], v[124:127], v[64:67]
  ds_read_b64_tr_b16 v[34:35], v8 offset:4608
  v_add_u32 v8, 8192, v8
  s_waitcnt lgkmcnt(6)
  v_mfma_f32_16x16x32_bf16 v[68:71], v[20:23], v[124:127], v[68:71]
  ds_read_b64_tr_b16 v[36:37], v9 offset:4096
  buffer_load_dwordx4 v[176:179], v90, s[8:11], s36 offen sc1
  v_mfma_f32_16x16x32_bf16 v[52:55], v[20:23], v[120:123], v[52:55]
  ds_read_b64_tr_b16 v[38:39], v9 offset:4608
  v_add_u32 v9, 8192, v9
  s_waitcnt lgkmcnt(6)
  v_mfma_f32_16x16x32_bf16 v[56:59], v[24:27], v[120:123], v[56:59]
  ds_read_b64_tr_b16 v[40:41], v10 offset:4096
  v_mfma_f32_16x16x32_bf16 v[72:75], v[24:27], v[124:127], v[72:75]
  ds_read_b64_tr_b16 v[42:43], v10 offset:4608
  v_add_u32 v10, 8192, v10
  s_waitcnt lgkmcnt(6)
  v_mfma_f32_16x16x32_bf16 v[76:79], v[28:31], v[124:127], v[76:79]
  ds_read_b64_tr_b16 v[44:45], v11 offset:4096
  buffer_load_dwordx4 v[180:183], v91, s[8:11], s36 offen sc1
  v_mfma_f32_16x16x32_bf16 v[60:63], v[28:31], v[120:123], v[60:63]
  ds_read_b64_tr_b16 v[46:47], v11 offset:4608
  v_add_u32 v11, 8192, v11
  s_waitcnt vmcnt(13) lgkmcnt(6)
  v_mfma_f32_16x16x32_bf16 v[48:51], v[32:35], v[128:131], v[48:51]
  ds_read_b64_tr_b16 v[16:17], v8 offset:0
  s_waitcnt vmcnt(12)
  v_mfma_f32_16x16x32_bf16 v[64:67], v[32:35], v[132:135], v[64:67]
  ds_read_b64_tr_b16 v[18:19], v8 offset:512
  s_waitcnt lgkmcnt(6)
  v_mfma_f32_16x16x32_bf16 v[68:71], v[36:39], v[132:135], v[68:71]
  ds_read_b64_tr_b16 v[20:21], v9 offset:0
  v_mfma_f32_16x16x32_bf16 v[52:55], v[36:39], v[128:131], v[52:55]
  ds_read_b64_tr_b16 v[22:23], v9 offset:512
  s_waitcnt lgkmcnt(6)
  v_mfma_f32_16x16x32_bf16 v[56:59], v[40:43], v[128:131], v[56:59]
  ds_read_b64_tr_b16 v[24:25], v10 offset:0
  v_mfma_f32_16x16x32_bf16 v[72:75], v[40:43], v[132:135], v[72:75]
  ds_read_b64_tr_b16 v[26:27], v10 offset:512
  s_waitcnt lgkmcnt(6)
  v_mfma_f32_16x16x32_bf16 v[76:79], v[44:47], v[132:135], v[76:79]
  ds_read_b64_tr_b16 v[28:29], v11 offset:0
  v_mfma_f32_16x16x32_bf16 v[60:63], v[44:47], v[128:131], v[60:63]
  ds_read_b64_tr_b16 v[30:31], v11 offset:512
  s_waitcnt vmcnt(11) lgkmcnt(6)
  v_mfma_f32_16x16x32_bf16 v[48:51], v[16:19], v[136:139], v[48:51]
  ds_read_b64_tr_b16 v[32:33], v8 offset:4096
  s_waitcnt vmcnt(10)
  v_mfma_f32_16x16x32_bf16 v[64:67], v[16:19], v[140:143], v[64:67]
  ds_read_b64_tr_b16 v[34:35], v8 offset:4608
  v_add_u32 v8, 8192, v8
  s_waitcnt lgkmcnt(6)
  v_mfma_f32_16x16x32_bf16 v[68:71], v[20:23], v[140:143], v[68:71]
  ds_read_b64_tr_b16 v[36:37], v9 offset:4096
  v_mfma_f32_16x16x32_bf16 v[52:55], v[20:23], v[136:139], v[52:55]
  ds_read_b64_tr_b16 v[38:39], v9 offset:4608
  v_add_u32 v9, 8192, v9
  s_waitcnt lgkmcnt(6)
  v_mfma_f32_16x16x32_bf16 v[56:59], v[24:27], v[136:139], v[56:59]
  ds_read_b64_tr_b16 v[40:41], v10 offset:4096
  v_mfma_f32_16x16x32_bf16 v[72:75], v[24:27], v[140:143], v[72:75]
  ds_read_b64_tr_b16 v[42:43], v10 offset:4608
  v_add_u32 v10, 8192, v10
  s_waitcnt lgkmcnt(6)
  v_mfma_f32_16x16x32_bf16 v[76:79], v[28:31], v[140:143], v[76:79]
  ds_read_b64_tr_b16 v[44:45], v11 offset:4096
  v_mfma_f32_16x16x32_bf16 v[60:63], v[28:31], v[136:139], v[60:63]
  ds_read_b64_tr_b16 v[46:47], v11 offset:4608
  v_add_u32 v11, 8192, v11
  s_waitcnt vmcnt(9) lgkmcnt(6)
  v_mfma_f32_16x16x32_bf16 v[48:51], v[32:35], v[144:147], v[48:51]
  ds_read_b64_tr_b16 v[16:17], v8 offset:0
  s_waitcnt vmcnt(8)
  v_mfma_f32_16x16x32_bf16 v[64:67], v[32:35], v[148:151], v[64:67]
  ds_read_b64_tr_b16 v[18:19], v8 offset:512
  s_waitcnt lgkmcnt(6)
  v_mfma_f32_16x16x32_bf16 v[68:71], v[36:39], v[148:151], v[68:71]
  ds_read_b64_tr_b16 v[20:21], v9 offset:0
  v_mfma_f32_16x16x32_bf16 v[52:55], v[36:39], v[144:147], v[52:55]
  ds_read_b64_tr_b16 v[22:23], v9 offset:512
  s_waitcnt lgkmcnt(6)
  v_mfma_f32_16x16x32_bf16 v[56:59], v[40:43], v[144:147], v[56:59]
  ds_read_b64_tr_b16 v[24:25], v10 offset:0
  v_mfma_f32_16x16x32_bf16 v[72:75], v[40:43], v[148:151], v[72:75]
  ds_read_b64_tr_b16 v[26:27], v10 offset:512
  s_waitcnt lgkmcnt(6)
  v_mfma_f32_16x16x32_bf16 v[76:79], v[44:47], v[148:151], v[76:79]
  ds_read_b64_tr_b16 v[28:29], v11 offset:0
  v_mfma_f32_16x16x32_bf16 v[60:63], v[44:47], v[144:147], v[60:63]
  ds_read_b64_tr_b16 v[30:31], v11 offset:512
  s_waitcnt vmcnt(7) lgkmcnt(6)
  v_mfma_f32_16x16x32_bf16 v[48:51], v[16:19], v[152:155], v[48:51]
  ds_read_b64_tr_b16 v[32:33], v8 offset:4096
  s_waitcnt vmcnt(6)
  v_mfma_f32_16x16x32_bf16 v[64:67], v[16:19], v[156:159], v[64:67]
  ds_read_b64_tr_b16 v[34:35], v8 offset:4608
  v_add_u32 v8, 8192, v8
  s_waitcnt lgkmcnt(6)
  v_mfma_f32_16x16x32_bf16 v[68:71], v[20:23], v[156:159], v[68:71]
  ds_read_b64_tr_b16 v[36:37], v9 offset:4096
  v_mfma_f32_16x16x32_bf16 v[52:55], v[20:23], v[152:155], v[52:55]
  ds_read_b64_tr_b16 v[38:39], v9 offset:4608
  v_add_u32 v9, 8192, v9
  s_waitcnt lgkmcnt(6)
  v_mfma_f32_16x16x32_bf16 v[56:59], v[24:27], v[152:155], v[56:59]
  ds_read_b64_tr_b16 v[40:41], v10 offset:4096
  v_mfma_f32_16x16x32_bf16 v[72:75], v[24:27], v[156:159], v[72:75]
  ds_read_b64_tr_b16 v[42:43], v10 offset:4608
  v_add_u32 v10, 8192, v10
  s_waitcnt lgkmcnt(6)
  v_mfma_f32_16x16x32_bf16 v[76:79], v[28:31], v[156:159], v[76:79]
  ds_read_b64_tr_b16 v[44:45], v11 offset:4096
  v_mfma_f32_16x16x32_bf16 v[60:63], v[28:31], v[152:155], v[60:63]
  ds_read_b64_tr_b16 v[46:47], v11 offset:4608
  v_add_u32 v11, 8192, v11
  s_waitcnt vmcnt(5) lgkmcnt(6)
  v_mfma_f32_16x16x32_bf16 v[48:51], v[32:35], v[160:163], v[48:51]
  ds_read_b64_tr_b16 v[16:17], v8 offset:0
  s_waitcnt vmcnt(4)
  v_mfma_f32_16x16x32_bf16 v[64:67], v[32:35], v[164:167], v[64:67]
  ds_read_b64_tr_b16 v[18:19], v8 offset:512
  s_waitcnt lgkmcnt(6)
  v_mfma_f32_16x16x32_bf16 v[68:71], v[36:39], v[164:167], v[68:71]
  ds_read_b64_tr_b16 v[20:21], v9 offset:0
  v_mfma_f32_16x16x32_bf16 v[52:55], v[36:39], v[160:163], v[52:55]
  ds_read_b64_tr_b16 v[22:23], v9 offset:512
  s_waitcnt lgkmcnt(6)
  v_mfma_f32_16x16x32_bf16 v[56:59], v[40:43], v[160:163], v[56:59]
  ds_read_b64_tr_b16 v[24:25], v10 offset:0
  v_mfma_f32_16x16x32_bf16 v[72:75], v[40:43], v[164:167], v[72:75]
  ds_read_b64_tr_b16 v[26:27], v10 offset:512
  s_waitcnt lgkmcnt(6)
  v_mfma_f32_16x16x32_bf16 v[76:79], v[44:47], v[164:167], v[76:79]
  ds_read_b64_tr_b16 v[28:29], v11 offset:0
  v_mfma_f32_16x16x32_bf16 v[60:63], v[44:47], v[160:163], v[60:63]
  ds_read_b64_tr_b16 v[30:31], v11 offset:512
  s_waitcnt vmcnt(3) lgkmcnt(6)
  v_mfma_f32_16x16x32_bf16 v[48:51], v[16:19], v[168:171], v[48:51]
  ds_read_b64_tr_b16 v[32:33], v8 offset:4096
  s_waitcnt vmcnt(2)
  v_mfma_f32_16x16x32_bf16 v[64:67], v[16:19], v[172:175], v[64:67]
  ds_read_b64_tr_b16 v[34:35], v8 offset:4608
  s_waitcnt lgkmcnt(6)
  v_mfma_f32_16x16x32_bf16 v[68:71], v[20:23], v[172:175], v[68:71]
  ds_read_b64_tr_b16 v[36:37], v9 offset:4096
  v_mfma_f32_16x16x32_bf16 v[52:55], v[20:23], v[168:171], v[52:55]
  ds_read_b64_tr_b16 v[38:39], v9 offset:4608
  s_waitcnt lgkmcnt(6)
  v_mfma_f32_16x16x32_bf16 v[56:59], v[24:27], v[168:171], v[56:59]
  ds_read_b64_tr_b16 v[40:41], v10 offset:4096
  v_mfma_f32_16x16x32_bf16 v[72:75], v[24:27], v[172:175], v[72:75]
  ds_read_b64_tr_b16 v[42:43], v10 offset:4608
  s_waitcnt lgkmcnt(6)
  v_mfma_f32_16x16x32_bf16 v[76:79], v[28:31], v[172:175], v[76:79]
  ds_read_b64_tr_b16 v[44:45], v11 offset:4096
  v_mfma_f32_16x16x32_bf16 v[60:63], v[28:31], v[168:171], v[60:63]
  ds_read_b64_tr_b16 v[46:47], v11 offset:4608
  s_waitcnt vmcnt(1) lgkmcnt(6)
  v_mfma_f32_16x16x32_bf16 v[48:51], v[32:35], v[176:179], v[48:51]
  s_waitcnt vmcnt(0)
  v_mfma_f32_16x16x32_bf16 v[64:67], v[32:35], v[180:183], v[64:67]
  s_waitcnt lgkmcnt(4)
  v_mfma_f32_16x16x32_bf16 v[68:71], v[36:39], v[180:183], v[68:71]
  v_mfma_f32_16x16x32_bf16 v[52:55], v[36:39], v[176:179], v[52:55]
  s_waitcnt lgkmcnt(2)
  v_mfma_f32_16x16x32_bf16 v[56:59], v[40:43], v[176:179], v[56:59]
  v_mfma_f32_16x16x32_bf16 v[72:75], v[40:43], v[180:183], v[72:75]
  s_waitcnt lgkmcnt(0)
  v_mfma_f32_16x16x32_bf16 v[76:79], v[44:47], v[180:183], v[76:79]
  v_mfma_f32_16x16x32_bf16 v[60:63], v[44:47], v[176:179], v[60:63]
  s_waitcnt lgkmcnt(0)
  s_barrier
  s_add_u32 s20, s82, 8388608
  s_addc_u32 s21, s83, 0
  s_mov_b32 s22, 8388608
  s_mov_b32 s23, 0x20000
  s_add_u32 s24, s82, 16777216
  s_addc_u32 s25, s83, 0
  s_mov_b32 s26, 8388608
  s_mov_b32 s27, 0x20000
  v_pk_add_f32 v[16:17], v[48:49], v[50:51]
  v_pk_mul_f32 v[18:19], v[48:49], v[48:49]
  v_pk_fma_f32 v[18:19], v[50:51], v[50:51], v[18:19]
  v_pk_add_f32 v[16:17], v[16:17], v[52:53]
  v_pk_fma_f32 v[18:19], v[52:53], v[52:53], v[18:19]
  v_pk_add_f32 v[16:17], v[16:17], v[54:55]
  v_pk_fma_f32 v[18:19], v[54:55], v[54:55], v[18:19]
  v_pk_add_f32 v[16:17], v[16:17], v[56:57]
  v_pk_fma_f32 v[18:19], v[56:57], v[56:57], v[18:19]
  v_pk_add_f32 v[16:17], v[16:17], v[58:59]
  v_pk_fma_f32 v[18:19], v[58:59], v[58:59], v[18:19]
  v_pk_add_f32 v[16:17], v[16:17], v[60:61]
  v_pk_fma_f32 v[18:19], v[60:61], v[60:61], v[18:19]
  v_pk_add_f32 v[16:17], v[16:17], v[62:63]
  v_pk_fma_f32 v[18:19], v[62:63], v[62:63], v[18:19]
  v_add_f32 v24, v16, v17
  v_add_f32 v26, v18, v19
  v_pk_add_f32 v[20:21], v[64:65], v[66:67]
  v_pk_mul_f32 v[22:23], v[64:65], v[64:65]
  v_pk_fma_f32 v[22:23], v[66:67], v[66:67], v[22:23]
  v_pk_add_f32 v[20:21], v[20:21], v[68:69]
  v_pk_fma_f32 v[22:23], v[68:69], v[68:69], v[22:23]
  v_pk_add_f32 v[20:21], v[20:21], v[70:71]
  v_pk_fma_f32 v[22:23], v[70:71], v[70:71], v[22:23]
  v_pk_add_f32 v[20:21], v[20:21], v[72:73]
  v_pk_fma_f32 v[22:23], v[72:73], v[72:73], v[22:23]
  v_pk_add_f32 v[20:21], v[20:21], v[74:75]
  v_pk_fma_f32 v[22:23], v[74:75], v[74:75], v[22:23]
  v_pk_add_f32 v[20:21], v[20:21], v[76:77]
  v_pk_fma_f32 v[22:23], v[76:77], v[76:77], v[22:23]
  v_pk_add_f32 v[20:21], v[20:21], v[78:79]
  v_pk_fma_f32 v[22:23], v[78:79], v[78:79], v[22:23]
  v_add_f32 v25, v20, v21
  v_add_f32 v27, v22, v23
  s_nop 0
  v_permlane16_swap_b32 v24, v25
  v_permlane16_swap_b32 v26, v27
  v_add_f32 v28, v24, v25
  v_add_f32 v29, v26, v27
  v_mov_b32 v30, v28
  v_mov_b32 v31, v29
  s_nop 0
  v_permlane32_swap_b32 v28, v30
  v_permlane32_swap_b32 v29, v31
  v_add_f32 v28, v28, v30
  v_add_f32 v29, v29, v31
  v_and_b32 v29, 0x7fffffff, v29
  s_mov_b32 exec_hi, 0
  buffer_store_dwordx2 v[28:29], v112, s[12:15], 0 offen sc0 sc1
  s_mov_b64 exec, -1
  v_cvt_pk_bf16_f32 v96, v48, v49
  v_cvt_pk_bf16_f32 v97, v50, v51
  v_cvt_pk_bf16_f32 v98, v52, v53
  v_cvt_pk_bf16_f32 v99, v54, v55
  v_cvt_pk_bf16_f32 v100, v56, v57
  v_cvt_pk_bf16_f32 v101, v58, v59
  v_cvt_pk_bf16_f32 v102, v60, v61
  v_cvt_pk_bf16_f32 v103, v62, v63
  v_cvt_pk_bf16_f32 v104, v64, v65
  v_cvt_pk_bf16_f32 v105, v66, v67
  v_cvt_pk_bf16_f32 v106, v68, v69
  v_cvt_pk_bf16_f32 v107, v70, v71
  v_cvt_pk_bf16_f32 v108, v72, v73
  v_cvt_pk_bf16_f32 v109, v74, v75
  v_cvt_pk_bf16_f32 v110, v76, v77
  v_cvt_pk_bf16_f32 v111, v78, v79
  v_permlane16_swap_b32 v96, v98
  v_permlane16_swap_b32 v97, v99
  v_permlane16_swap_b32 v100, v102
  v_permlane16_swap_b32 v101, v103
  v_permlane16_swap_b32 v104, v106
  v_permlane16_swap_b32 v105, v107
  v_permlane16_swap_b32 v108, v110
  v_permlane16_swap_b32 v109, v111
  v_xor_b32 v116, 32, v115
  v_xor_b32 v121, 32, v114
  v_xor_b32 v117, 64, v115
  v_xor_b32 v122, 64, v114
  v_xor_b32 v118, 96, v115
  v_xor_b32 v123, 96, v114
  v_mov_b32 v120, v114
  s_mov_b32 s39, 0
k2_poll:
  buffer_load_dwordx2 v[32:33], v113, s[12:15], 0 offen sc0 sc1
  buffer_load_dwordx2 v[34:35], v80, s[12:15], 0 offen sc0 sc1
  buffer_load_dwordx2 v[36:37], v81, s[12:15], 0 offen sc0 sc1
  buffer_load_dwordx2 v[38:39], v82, s[12:15], 0 offen sc0 sc1
  buffer_load_dwordx2 v[40:41], v83, s[12:15], 0 offen sc0 sc1
  buffer_load_dwordx2 v[42:43], v84, s[12:15], 0 offen sc0 sc1
  buffer_load_dwordx2 v[44:45], v85, s[12:15], 0 offen sc0 sc1
  buffer_load_dwordx2 v[46:47], v86, s[12:15], 0 offen sc0 sc1
  s_waitcnt vmcnt(0)
  v_min3_i32 v16, v33, v35, v37
  v_min3_i32 v17, v39, v41, v43
  v_min3_i32 v16, v16, v45, v47
  v_min_i32 v16, v16, v17
  v_cmp_gt_i32 vcc, 0, v16
  s_add_u32 s39, s39, 1
  s_cmp_gt_u32 s39, 1000000
  s_cbranch_scc1 k2_pdone
  s_cbranch_vccnz k2_poll
k2_pdone:
  buffer_store_dwordx4 v[96:99], v192, s[20:23], s53 offen sc0 sc1
  buffer_store_dwordx4 v[100:103], v194, s[20:23], s53 offen sc0 sc1
  buffer_store_dwordx4 v[104:107], v193, s[20:23], s53 offen sc0 sc1
  buffer_store_dwordx4 v[108:111], v195, s[20:23], s53 offen sc0 sc1
  v_pk_add_f32 v[32:33], v[32:33], v[34:35]
  v_pk_add_f32 v[36:37], v[36:37], v[38:39]
  v_pk_add_f32 v[40:41], v[40:41], v[42:43]
  v_pk_add_f32 v[44:45], v[44:45], v[46:47]
  v_pk_add_f32 v[32:33], v[32:33], v[36:37]
  v_pk_add_f32 v[40:41], v[40:41], v[44:45]
  v_pk_add_f32 v[32:33], v[32:33], v[40:41]
  v_mov_b32 v34, v32
  v_mov_b32 v35, v33
  s_nop 0
  v_permlane32_swap_b32 v32, v34
  v_permlane32_swap_b32 v33, v35
  v_add_f32 v32, v32, v34
  v_add_f32 v33, v33, v35
  v_mul_f32 v32, 0x3a800000, v32
  v_mul_f32 v33, 0x3a800000, v33
  v_fma_f32 v33, -v32, v32, v33
  v_max_f32 v33, 0, v33
  v_mov_b32 v36, v33
  v_cvt_pk_bf16_f32 v36, v36, v36
  v_lshlrev_b32 v36, 16, v36
  v_add_f32 v36, 0x3727c5ac, v36
  v_cvt_pk_bf16_f32 v36, v36, v36
  v_lshlrev_b32 v36, 16, v36
  v_sqrt_f32 v36, v36
  s_nop 0
  v_cvt_pk_bf16_f32 v36, v36, v36
  v_lshlrev_b32 v36, 16, v36
  v_rcp_f32 v36, v36
  s_nop 0
  v_mul_f32 v33, v33, v36
  v_mul_f32 v33, v33, v36
  v_cvt_pk_bf16_f32 v33, v33, v33
  v_lshlrev_b32 v33, 16, v33
  v_add_f32 v33, 0x3727c5ac, v33
  v_cvt_pk_bf16_f32 v33, v33, v33
  v_lshlrev_b32 v33, 16, v33
  v_sqrt_f32 v33, v33
  s_nop 0
  v_cvt_pk_bf16_f32 v33, v33, v33
  v_lshlrev_b32 v33, 16, v33
  v_rcp_f32 v33, v33
  s_nop 0
  v_mul_f32 v33, v33, v36
  v_mov_b32 v34, v32
  v_mov_b32 v35, v33
  s_nop 0
  v_permlane16_swap_b32 v32, v34
  v_permlane16_swap_b32 v33, v35
  v_pk_add_f32 v[48:49], v[48:49], v[32:33] op_sel_hi:[1,0] neg_lo:[0,1] neg_hi:[0,1]
  v_pk_add_f32 v[50:51], v[50:51], v[32:33] op_sel_hi:[1,0] neg_lo:[0,1] neg_hi:[0,1]
  v_pk_add_f32 v[52:53], v[52:53], v[32:33] op_sel_hi:[1,0] neg_lo:[0,1] neg_hi:[0,1]
  v_pk_add_f32 v[54:55], v[54:55], v[32:33] op_sel_hi:[1,0] neg_lo:[0,1] neg_hi:[0,1]
  v_pk_add_f32 v[56:57], v[56:57], v[32:33] op_sel_hi:[1,0] neg_lo:[0,1] neg_hi:[0,1]
  v_pk_add_f32 v[58:59], v[58:59], v[32:33] op_sel_hi:[1,0] neg_lo:[0,1] neg_hi:[0,1]
  v_pk_add_f32 v[60:61], v[60:61], v[32:33] op_sel_hi:[1,0] neg_lo:[0,1] neg_hi:[0,1]
  v_pk_add_f32 v[62:63], v[62:63], v[32:33] op_sel_hi:[1,0] neg_lo:[0,1] neg_hi:[0,1]
  v_pk_mul_f32 v[48:49], v[48:49], v[32:33] op_sel:[0,1] op_sel_hi:[1,1]
  v_pk_mul_f32 v[50:51], v[50:51], v[32:33] op_sel:[0,1] op_sel_hi:[1,1]
  v_pk_mul_f32 v[52:53], v[52:53], v[32:33] op_sel:[0,1] op_sel_hi:[1,1]
  v_pk_mul_f32 v[54:55], v[54:55], v[32:33] op_sel:[0,1] op_sel_hi:[1,1]
  v_pk_mul_f32 v[56:57], v[56:57], v[32:33] op_sel:[0,1] op_sel_hi:[1,1]
  v_pk_mul_f32 v[58:59], v[58:59], v[32:33] op_sel:[0,1] op_sel_hi:[1,1]
  v_pk_mul_f32 v[60:61], v[60:61], v[32:33] op_sel:[0,1] op_sel_hi:[1,1]
  v_pk_mul_f32 v[62:63], v[62:63], v[32:33] op_sel:[0,1] op_sel_hi:[1,1]
  v_cvt_pk_bf16_f32 v160, v48, v49
  v_cvt_pk_bf16_f32 v161, v50, v51
  ds_write_b64 v120, v[160:161] offset:0
  v_cvt_pk_bf16_f32 v162, v52, v53
  v_cvt_pk_bf16_f32 v163, v54, v55
  ds_write_b64 v121, v[162:163] offset:0
  v_cvt_pk_bf16_f32 v164, v56, v57
  v_cvt_pk_bf16_f32 v165, v58, v59
  ds_write_b64 v122, v[164:165] offset:0
  v_cvt_pk_bf16_f32 v166, v60, v61
  v_cvt_pk_bf16_f32 v167, v62, v63
  ds_write_b64 v123, v[166:167] offset:0
  v_pk_add_f32 v[64:65], v[64:65], v[34:35] op_sel_hi:[1,0] neg_lo:[0,1] neg_hi:[0,1]
  v_pk_add_f32 v[66:67], v[66:67], v[34:35] op_sel_hi:[1,0] neg_lo:[0,1] neg_hi:[0,1]
  v_pk_add_f32 v[68:69], v[68:69], v[34:35] op_sel_hi:[1,0] neg_lo:[0,1] neg_hi:[0,1]
  v_pk_add_f32 v[70:71], v[70:71], v[34:35] op_sel_hi:[1,0] neg_lo:[0,1] neg_hi:[0,1]
  v_pk_add_f32 v[72:73], v[72:73], v[34:35] op_sel_hi:[1,0] neg_lo:[0,1] neg_hi:[0,1]
  v_pk_add_f32 v[74:75], v[74:75], v[34:35] op_sel_hi:[1,0] neg_lo:[0,1] neg_hi:[0,1]
  v_pk_add_f32 v[76:77], v[76:77], v[34:35] op_sel_hi:[1,0] neg_lo:[0,1] neg_hi:[0,1]
  v_pk_add_f32 v[78:79], v[78:79], v[34:35] op_sel_hi:[1,0] neg_lo:[0,1] neg_hi:[0,1]
  v_pk_mul_f32 v[64:65], v[64:65], v[34:35] op_sel:[0,1] op_sel_hi:[1,1]
  v_pk_mul_f32 v[66:67], v[66:67], v[34:35] op_sel:[0,1] op_sel_hi:[1,1]
  v_pk_mul_f32 v[68:69], v[68:69], v[34:35] op_sel:[0,1] op_sel_hi:[1,1]
  v_pk_mul_f32 v[70:71], v[70:71], v[34:35] op_sel:[0,1] op_sel_hi:[1,1]
  v_pk_mul_f32 v[72:73], v[72:73], v[34:35] op_sel:[0,1] op_sel_hi:[1,1]
  v_pk_mul_f32 v[74:75], v[74:75], v[34:35] op_sel:[0,1] op_sel_hi:[1,1]
  v_pk_mul_f32 v[76:77], v[76:77], v[34:35] op_sel:[0,1] op_sel_hi:[1,1]
  v_pk_mul_f32 v[78:79], v[78:79], v[34:35] op_sel:[0,1] op_sel_hi:[1,1]
  v_cvt_pk_bf16_f32 v168, v64, v65
  v_cvt_pk_bf16_f32 v169, v66, v67
  ds_write_b64 v120, v[168:169] offset:128
  v_cvt_pk_bf16_f32 v170, v68, v69
  v_cvt_pk_bf16_f32 v171, v70, v71
  ds_write_b64 v121, v[170:171] offset:128
  v_cvt_pk_bf16_f32 v172, v72, v73
  v_cvt_pk_bf16_f32 v173, v74, v75
  ds_write_b64 v122, v[172:173] offset:128
  v_cvt_pk_bf16_f32 v174, v76, v77
  v_cvt_pk_bf16_f32 v175, v78, v79
  ds_write_b64 v123, v[174:175] offset:128
  s_waitcnt lgkmcnt(0)
  ds_read_b64_tr_b16 v[176:177], v115
  ds_read_b64_tr_b16 v[178:179], v115 offset:512
  ds_read_b64_tr_b16 v[180:181], v116
  ds_read_b64_tr_b16 v[182:183], v116 offset:512
  ds_read_b64_tr_b16 v[184:185], v117
  ds_read_b64_tr_b16 v[186:187], v117 offset:512
  ds_read_b64_tr_b16 v[188:189], v118
  ds_read_b64_tr_b16 v[190:191], v118 offset:512
  s_waitcnt lgkmcnt(6)
  buffer_store_dwordx4 v[176:179], v92, s[24:27], s44 offen sc0 sc1
  s_waitcnt lgkmcnt(4)
  buffer_store_dwordx4 v[180:183], v93, s[24:27], s45 offen sc0 sc1
  s_waitcnt lgkmcnt(2)
  buffer_store_dwordx4 v[184:187], v92, s[24:27], s46 offen sc0 sc1
  s_waitcnt lgkmcnt(0)
  buffer_store_dwordx4 v[188:191], v93, s[24:27], s47 offen sc0 sc1
  s_cmp_ge_u32 s2, 224
  s_cbranch_scc1 C_k3skip
  s_lshr_b32 s32, s2, 3
  s_mul_i32 s5, s32, 9363
  s_lshr_b32 s5, s5, 16
  s_mul_i32 s6, s5, 7
  s_sub_u32 s6, s32, s6
  s_lshl_b32 s7, s5, 1
  s_add_u32 s7, s7, s6
  s_and_b32 s7, s7, 7
  s_and_b32 s32, s2, 7
  s_lshr_b32 s28, s32, 2
  s_lshl_b32 s28, s28, 2
  s_add_u32 s28, s28, s5
  s_and_b32 s29, s32, 3
  s_mul_i32 s29, s29, 7
  s_add_u32 s29, s29, s6
  s_mov_b32 s30, 7
  s_mov_b32 s31, -1
  s_and_b32 s46, s4, 1
  s_lshr_b32 s41, s4, 1
  s_lshl_b32 s32, s29, 8
  s_lshl_b32 s44, s46, 7
  s_add_u32 s32, s32, s44
  v_lshlrev_b32 v16, 3, v5
  v_add_u32 v16, s32, v16
  s_mov_b32 s16, s74
  s_mov_b32 s17, s75
  s_mov_b32 s18, 7168
  s_mov_b32 s19, 0x20000
  v_mov_b32 v155, v16
  s_add_u32 s20, s82, 25165824
  s_addc_u32 s21, s83, 0
  s_mov_b32 s22, 14680064
  s_mov_b32 s23, 0x20000
  v_lshl_add_u32 v17, v5, 3, v6
  v_lshlrev_b32 v17, 8, v17
  v_lshl_add_u32 v17, v7, 3, v17
  v_lshl_or_b32 v18, v2, 2, v6
  v_lshl_add_u32 v17, v18, 5, v17
  s_lshl_b32 s32, s46, 7
  s_add_u32 s32, s32, 16384
  v_xor_b32 v18, s32, v17
  s_lshl_b32 s32, s41, 13
  v_add_u32 v12, s32, v14
  v_xor_b32 v8, 0, v18
  v_xor_b32 v9, 32, v18
  v_xor_b32 v10, 64, v18
  v_xor_b32 v11, 96, v18
  v_bfe_u32 v19, v4, 2, 1
  v_lshlrev_b32 v17, 11, v19
  v_lshl_add_u32 v17, v3, 8, v17
  v_lshrrev_b32 v18, 3, v4
  v_lshl_add_u32 v17, v18, 6, v17
  v_lshl_add_u32 v152, v7, 4, v17
  v_add_u32 v153, 128, v152
  v_cmp_eq_u32 vcc, 1, v3
  v_lshlrev_b32 v17, 7, v19
  v_add_u32 v18, 640, v17
  v_lshlrev_b32 v17, 8, v19
  v_add_u32 v17, 896, v17
  v_cndmask_b32 v18, 0, v18, vcc
  v_cndmask_b32 v17, 0, v17, vcc
  v_add_u32 v154, v153, v17
  v_add_u32 v153, v153, v18
  s_lshl_b32 s32, s28, 1
  s_add_u32 s32, s32, s41
  s_mul_i32 s32, s32, 224
  s_lshl_b32 s44, s29, 2
  s_add_u32 s32, s32, s44
  s_lshl_b32 s44, s46, 1
  s_add_u32 s32, s32, s44
  s_lshl_b32 s44, s32, 12
  s_add_u32 s45, s44, 458752
  s_add_u32 s46, s44, 4096
  s_add_u32 s47, s45, 4096
  s_waitcnt vmcnt(0)
  s_barrier
  buffer_load_dwordx2 v[144:145], v155, s[16:19], 0 offen offset:0
  buffer_load_dwordx2 v[146:147], v155, s[16:19], 0 offen offset:32
  buffer_load_dwordx2 v[148:149], v155, s[16:19], 0 offen offset:64
  buffer_load_dwordx2 v[150:151], v155, s[16:19], 0 offen offset:96
  s_waitcnt vmcnt(0)
  v_lshlrev_b32 v80, 16, v144
  v_and_b32 v81, 0xffff0000, v144
  v_lshlrev_b32 v82, 16, v145
  v_and_b32 v83, 0xffff0000, v145
  v_mov_b64 v[96:97], v[80:81]
  v_mov_b64 v[98:99], v[82:83]
  v_mov_b64 v[112:113], v[80:81]
  v_mov_b64 v[114:115], v[82:83]
  v_mov_b64 v[128:129], v[80:81]
  v_mov_b64 v[130:131], v[82:83]
  v_lshlrev_b32 v84, 16, v146
  v_and_b32 v85, 0xffff0000, v146
  v_lshlrev_b32 v86, 16, v147
  v_and_b32 v87, 0xffff0000, v147
  v_mov_b64 v[100:101], v[84:85]
  v_mov_b64 v[102:103], v[86:87]
  v_mov_b64 v[116:117], v[84:85]
  v_mov_b64 v[118:119], v[86:87]
  v_mov_b64 v[132:133], v[84:85]
  v_mov_b64 v[134:135], v[86:87]
  v_lshlrev_b32 v88, 16, v148
  v_and_b32 v89, 0xffff0000, v148
  v_lshlrev_b32 v90, 16, v149
  v_and_b32 v91, 0xffff0000, v149
  v_mov_b64 v[104:105], v[88:89]
  v_mov_b64 v[106:107], v[90:91]
  v_mov_b64 v[120:121], v[88:89]
  v_mov_b64 v[122:123], v[90:91]
  v_mov_b64 v[136:137], v[88:89]
  v_mov_b64 v[138:139], v[90:91]
  v_lshlrev_b32 v92, 16, v150
  v_and_b32 v93, 0xffff0000, v150
  v_lshlrev_b32 v94, 16, v151
  v_and_b32 v95, 0xffff0000, v151
  v_mov_b64 v[108:109], v[92:93]
  v_mov_b64 v[110:111], v[94:95]
  v_mov_b64 v[124:125], v[92:93]
  v_mov_b64 v[126:127], v[94:95]
  v_mov_b64 v[140:141], v[92:93]
  v_mov_b64 v[142:143], v[94:95]
  s_barrier
  s_mov_b32 s43, 0
  s_mov_b32 s39, 15
  s_add_u32 s40, s43, 32768
  s_cmp_eq_u32 s40, 163840
  s_cselect_b32 s40, 0, s40
  s_sub_u32 s42, s40, s43
  s_mov_b32 s43, s40
  s_barrier
  ds_read_b64_tr_b16 v[16:17], v8 offset:0
  ds_read_b64_tr_b16 v[18:19], v8 offset:1024
  ds_read_b128 v[32:35], v12 offset:0
  ds_read_b64_tr_b16 v[48:49], v8 offset:8192
  ds_read_b64_tr_b16 v[50:51], v8 offset:9216
  ds_read_b128 v[64:67], v12 offset:1024
  ds_read_b128 v[68:71], v12 offset:3072
  ds_read_b128 v[36:39], v12 offset:2048
  ds_read_b64_tr_b16 v[20:21], v9 offset:0
  ds_read_b64_tr_b16 v[22:23], v9 offset:1024
  ds_read_b64_tr_b16 v[52:53], v9 offset:8192
  ds_read_b64_tr_b16 v[54:55], v9 offset:9216
  ds_read_b64_tr_b16 v[24:25], v10 offset:0
  ds_read_b64_tr_b16 v[26:27], v10 offset:1024
  ds_read_b64_tr_b16 v[56:57], v10 offset:8192
  ds_read_b64_tr_b16 v[58:59], v10 offset:9216
  ds_read_b128 v[40:43], v12 offset:4096
  ds_read_b128 v[72:75], v12 offset:5120
  ds_read_b128 v[76:79], v12 offset:7168
  ds_read_b128 v[44:47], v12 offset:6144
  ds_read_b64_tr_b16 v[28:29], v11 offset:0
  ds_read_b64_tr_b16 v[30:31], v11 offset:1024
  ds_read_b64_tr_b16 v[60:61], v11 offset:8192
  ds_read_b64_tr_b16 v[62:63], v11 offset:9216
  v_add_u32 v8, s42, v8
  v_add_u32 v9, s42, v9
  v_add_u32 v10, s42, v10
  v_add_u32 v11, s42, v11
  v_add_u32 v12, s42, v12
cf4:
  s_barrier
  s_waitcnt lgkmcnt(14)
  v_mfma_f32_16x16x32_bf16 v[80:83], v[16:19], v[32:35], v[80:83]
  ds_read_b64_tr_b16 v[156:157], v8 offset:0
  s_add_u32 s40, s43, 32768
  s_cmp_eq_u32 s40, 163840
  v_mfma_f32_16x16x32_bf16 v[80:83], v[48:51], v[64:67], v[80:83]
  ds_read_b64_tr_b16 v[158:159], v8 offset:1024
  s_cselect_b32 s40, 0, s40
  s_sub_u32 s42, s40, s43
  v_mfma_f32_16x16x32_bf16 v[96:99], v[48:51], v[68:71], v[96:99]
  ds_read_b128 v[172:175], v12 offset:0
  s_mov_b32 s43, s40
  v_mfma_f32_16x16x32_bf16 v[96:99], v[16:19], v[36:39], v[96:99]
  ds_read_b64_tr_b16 v[188:189], v8 offset:8192
  v_mfma_f32_16x16x32_bf16 v[100:103], v[20:23], v[36:39], v[100:103]
  ds_read_b64_tr_b16 v[190:191], v8 offset:9216
  v_add_u32 v8, s42, v8
  s_waitcnt lgkmcnt(14)
  v_mfma_f32_16x16x32_bf16 v[100:103], v[52:55], v[68:71], v[100:103]
  ds_read_b128 v[204:207], v12 offset:1024
  v_mfma_f32_16x16x32_bf16 v[84:87], v[52:55], v[64:67], v[84:87]
  ds_read_b128 v[208:211], v12 offset:3072
  v_mfma_f32_16x16x32_bf16 v[84:87], v[20:23], v[32:35], v[84:87]
  ds_read_b128 v[176:179], v12 offset:2048
  v_mfma_f32_16x16x32_bf16 v[88:91], v[24:27], v[32:35], v[88:91]
  ds_read_b64_tr_b16 v[160:161], v9 offset:0
  s_waitcnt lgkmcnt(14)
  v_mfma_f32_16x16x32_bf16 v[88:91], v[56:59], v[64:67], v[88:91]
  ds_read_b64_tr_b16 v[162:163], v9 offset:1024
  v_mfma_f32_16x16x32_bf16 v[104:107], v[56:59], v[68:71], v[104:107]
  ds_read_b64_tr_b16 v[192:193], v9 offset:8192
  v_mfma_f32_16x16x32_bf16 v[104:107], v[24:27], v[36:39], v[104:107]
  ds_read_b64_tr_b16 v[194:195], v9 offset:9216
  v_add_u32 v9, s42, v9
  v_mfma_f32_16x16x32_bf16 v[120:123], v[24:27], v[40:43], v[120:123]
  ds_read_b64_tr_b16 v[164:165], v10 offset:0
  v_mfma_f32_16x16x32_bf16 v[120:123], v[56:59], v[72:75], v[120:123]
  ds_read_b64_tr_b16 v[166:167], v10 offset:1024
  v_mfma_f32_16x16x32_bf16 v[116:119], v[52:55], v[72:75], v[116:119]
  ds_read_b64_tr_b16 v[196:197], v10 offset:8192
  v_mfma_f32_16x16x32_bf16 v[116:119], v[20:23], v[40:43], v[116:119]
  ds_read_b64_tr_b16 v[198:199], v10 offset:9216
  v_add_u32 v10, s42, v10
  v_mfma_f32_16x16x32_bf16 v[112:115], v[16:19], v[40:43], v[112:115]
  ds_read_b128 v[180:183], v12 offset:4096
  v_mfma_f32_16x16x32_bf16 v[112:115], v[48:51], v[72:75], v[112:115]
  ds_read_b128 v[212:215], v12 offset:5120
  v_mfma_f32_16x16x32_bf16 v[128:131], v[48:51], v[76:79], v[128:131]
  ds_read_b128 v[216:219], v12 offset:7168
  s_waitcnt lgkmcnt(14)
  v_mfma_f32_16x16x32_bf16 v[128:131], v[16:19], v[44:47], v[128:131]
  ds_read_b128 v[184:187], v12 offset:6144
  v_add_u32 v12, s42, v12
  v_mfma_f32_16x16x32_bf16 v[132:135], v[20:23], v[44:47], v[132:135]
  ds_read_b64_tr_b16 v[168:169], v11 offset:0
  v_mfma_f32_16x16x32_bf16 v[132:135], v[52:55], v[76:79], v[132:135]
  ds_read_b64_tr_b16 v[170:171], v11 offset:1024
  v_mfma_f32_16x16x32_bf16 v[136:139], v[56:59], v[76:79], v[136:139]
  ds_read_b64_tr_b16 v[200:201], v11 offset:8192
  v_mfma_f32_16x16x32_bf16 v[136:139], v[24:27], v[44:47], v[136:139]
  ds_read_b64_tr_b16 v[202:203], v11 offset:9216
  v_add_u32 v11, s42, v11
  v_mfma_f32_16x16x32_bf16 v[140:143], v[28:31], v[44:47], v[140:143]
  v_mfma_f32_16x16x32_bf16 v[140:143], v[60:63], v[76:79], v[140:143]
  v_mfma_f32_16x16x32_bf16 v[124:127], v[60:63], v[72:75], v[124:127]
  v_mfma_f32_16x16x32_bf16 v[124:127], v[28:31], v[40:43], v[124:127]
  v_mfma_f32_16x16x32_bf16 v[108:111], v[28:31], v[36:39], v[108:111]
  v_mfma_f32_16x16x32_bf16 v[108:111], v[60:63], v[68:71], v[108:111]
  v_mfma_f32_16x16x32_bf16 v[92:95], v[60:63], v[64:67], v[92:95]
  v_mfma_f32_16x16x32_bf16 v[92:95], v[28:31], v[32:35], v[92:95]
  s_barrier
  s_waitcnt lgkmcnt(14)
  v_mfma_f32_16x16x32_bf16 v[80:83], v[156:159], v[172:175], v[80:83]
  ds_read_b64_tr_b16 v[16:17], v8 offset:0
  s_add_u32 s40, s43, 32768
  s_cmp_eq_u32 s40, 163840
  v_mfma_f32_16x16x32_bf16 v[80:83], v[188:191], v[204:207], v[80:83]
  ds_read_b64_tr_b16 v[18:19], v8 offset:1024
  s_cselect_b32 s40, 0, s40
  s_sub_u32 s42, s40, s43
  v_mfma_f32_16x16x32_bf16 v[96:99], v[188:191], v[208:211], v[96:99]
  ds_read_b128 v[32:35], v12 offset:0
  s_mov_b32 s43, s40
  v_mfma_f32_16x16x32_bf16 v[96:99], v[156:159], v[176:179], v[96:99]
  ds_read_b64_tr_b16 v[48:49], v8 offset:8192
  v_mfma_f32_16x16x32_bf16 v[100:103], v[160:163], v[176:179], v[100:103]
  ds_read_b64_tr_b16 v[50:51], v8 offset:9216
  v_add_u32 v8, s42, v8
  s_waitcnt lgkmcnt(14)
  v_mfma_f32_16x16x32_bf16 v[100:103], v[192:195], v[208:211], v[100:103]
  ds_read_b128 v[64:67], v12 offset:1024
  v_mfma_f32_16x16x32_bf16 v[84:87], v[192:195], v[204:207], v[84:87]
  ds_read_b128 v[68:71], v12 offset:3072
  v_mfma_f32_16x16x32_bf16 v[84:87], v[160:163], v[172:175], v[84:87]
  ds_read_b128 v[36:39], v12 offset:2048
  v_mfma_f32_16x16x32_bf16 v[88:91], v[164:167], v[172:175], v[88:91]
  ds_read_b64_tr_b16 v[20:21], v9 offset:0
  s_waitcnt lgkmcnt(14)
  v_mfma_f32_16x16x32_bf16 v[88:91], v[196:199], v[204:207], v[88:91]
  ds_read_b64_tr_b16 v[22:23], v9 offset:1024
  v_mfma_f32_16x16x32_bf16 v[104:107], v[196:199], v[208:211], v[104:107]
  ds_read_b64_tr_b16 v[52:53], v9 offset:8192
  v_mfma_f32_16x16x32_bf16 v[104:107], v[164:167], v[176:179], v[104:107]
  ds_read_b64_tr_b16 v[54:55], v9 offset:9216
  v_add_u32 v9, s42, v9
  v_mfma_f32_16x16x32_bf16 v[120:123], v[164:167], v[180:183], v[120:123]
  ds_read_b64_tr_b16 v[24:25], v10 offset:0
  v_mfma_f32_16x16x32_bf16 v[120:123], v[196:199], v[212:215], v[120:123]
  ds_read_b64_tr_b16 v[26:27], v10 offset:1024
  v_mfma_f32_16x16x32_bf16 v[116:119], v[192:195], v[212:215], v[116:119]
  ds_read_b64_tr_b16 v[56:57], v10 offset:8192
  v_mfma_f32_16x16x32_bf16 v[116:119], v[160:163], v[180:183], v[116:119]
  ds_read_b64_tr_b16 v[58:59], v10 offset:9216
  v_add_u32 v10, s42, v10
  v_mfma_f32_16x16x32_bf16 v[112:115], v[156:159], v[180:183], v[112:115]
  ds_read_b128 v[40:43], v12 offset:4096
  v_mfma_f32_16x16x32_bf16 v[112:115], v[188:191], v[212:215], v[112:115]
  ds_read_b128 v[72:75], v12 offset:5120
  v_mfma_f32_16x16x32_bf16 v[128:131], v[188:191], v[216:219], v[128:131]
  ds_read_b128 v[76:79], v12 offset:7168
  s_waitcnt lgkmcnt(14)
  v_mfma_f32_16x16x32_bf16 v[128:131], v[156:159], v[184:187], v[128:131]
  ds_read_b128 v[44:47], v12 offset:6144
  v_add_u32 v12, s42, v12
  v_mfma_f32_16x16x32_bf16 v[132:135], v[160:163], v[184:187], v[132:135]
  ds_read_b64_tr_b16 v[28:29], v11 offset:0
  v_mfma_f32_16x16x32_bf16 v[132:135], v[192:195], v[216:219], v[132:135]
  ds_read_b64_tr_b16 v[30:31], v11 offset:1024
  v_mfma_f32_16x16x32_bf16 v[136:139], v[196:199], v[216:219], v[136:139]
  ds_read_b64_tr_b16 v[60:61], v11 offset:8192
  v_mfma_f32_16x16x32_bf16 v[136:139], v[164:167], v[184:187], v[136:139]
  ds_read_b64_tr_b16 v[62:63], v11 offset:9216
  v_add_u32 v11, s42, v11
  v_mfma_f32_16x16x32_bf16 v[140:143], v[168:171], v[184:187], v[140:143]
  v_mfma_f32_16x16x32_bf16 v[140:143], v[200:203], v[216:219], v[140:143]
  v_mfma_f32_16x16x32_bf16 v[124:127], v[200:203], v[212:215], v[124:127]
  v_mfma_f32_16x16x32_bf16 v[124:127], v[168:171], v[180:183], v[124:127]
  v_mfma_f32_16x16x32_bf16 v[108:111], v[168:171], v[176:179], v[108:111]
  v_mfma_f32_16x16x32_bf16 v[108:111], v[200:203], v[208:211], v[108:111]
  v_mfma_f32_16x16x32_bf16 v[92:95], v[200:203], v[204:207], v[92:95]
  v_mfma_f32_16x16x32_bf16 v[92:95], v[168:171], v[172:175], v[92:95]
  s_sub_u32 s39, s39, 1
  s_cmp_lg_u32 s39, 0
  s_cbranch_scc1 cf4
  s_barrier
  s_waitcnt lgkmcnt(14)
  v_mfma_f32_16x16x32_bf16 v[80:83], v[16:19], v[32:35], v[80:83]
  ds_read_b64_tr_b16 v[156:157], v8 offset:0
  s_add_u32 s40, s43, 32768
  s_cmp_eq_u32 s40, 163840
  v_mfma_f32_16x16x32_bf16 v[80:83], v[48:51], v[64:67], v[80:83]
  ds_read_b64_tr_b16 v[158:159], v8 offset:1024
  s_cselect_b32 s40, 0, s40
  s_sub_u32 s42, s40, s43
  v_mfma_f32_16x16x32_bf16 v[96:99], v[48:51], v[68:71], v[96:99]
  ds_read_b128 v[172:175], v12 offset:0
  s_mov_b32 s43, s40
  v_mfma_f32_16x16x32_bf16 v[96:99], v[16:19], v[36:39], v[96:99]
  ds_read_b64_tr_b16 v[188:189], v8 offset:8192
  v_mfma_f32_16x16x32_bf16 v[100:103], v[20:23], v[36:39], v[100:103]
  ds_read_b64_tr_b16 v[190:191], v8 offset:9216
  v_add_u32 v8, s42, v8
  s_waitcnt lgkmcnt(14)
  v_mfma_f32_16x16x32_bf16 v[100:103], v[52:55], v[68:71], v[100:103]
  ds_read_b128 v[204:207], v12 offset:1024
  v_mfma_f32_16x16x32_bf16 v[84:87], v[52:55], v[64:67], v[84:87]
  ds_read_b128 v[208:211], v12 offset:3072
  v_mfma_f32_16x16x32_bf16 v[84:87], v[20:23], v[32:35], v[84:87]
  ds_read_b128 v[176:179], v12 offset:2048
  v_mfma_f32_16x16x32_bf16 v[88:91], v[24:27], v[32:35], v[88:91]
  ds_read_b64_tr_b16 v[160:161], v9 offset:0
  s_waitcnt lgkmcnt(14)
  v_mfma_f32_16x16x32_bf16 v[88:91], v[56:59], v[64:67], v[88:91]
  ds_read_b64_tr_b16 v[162:163], v9 offset:1024
  v_mfma_f32_16x16x32_bf16 v[104:107], v[56:59], v[68:71], v[104:107]
  ds_read_b64_tr_b16 v[192:193], v9 offset:8192
  v_mfma_f32_16x16x32_bf16 v[104:107], v[24:27], v[36:39], v[104:107]
  ds_read_b64_tr_b16 v[194:195], v9 offset:9216
  v_add_u32 v9, s42, v9
  v_mfma_f32_16x16x32_bf16 v[120:123], v[24:27], v[40:43], v[120:123]
  ds_read_b64_tr_b16 v[164:165], v10 offset:0
  v_mfma_f32_16x16x32_bf16 v[120:123], v[56:59], v[72:75], v[120:123]
  ds_read_b64_tr_b16 v[166:167], v10 offset:1024
  v_mfma_f32_16x16x32_bf16 v[116:119], v[52:55], v[72:75], v[116:119]
  ds_read_b64_tr_b16 v[196:197], v10 offset:8192
  v_mfma_f32_16x16x32_bf16 v[116:119], v[20:23], v[40:43], v[116:119]
  ds_read_b64_tr_b16 v[198:199], v10 offset:9216
  v_add_u32 v10, s42, v10
  v_mfma_f32_16x16x32_bf16 v[112:115], v[16:19], v[40:43], v[112:115]
  ds_read_b128 v[180:183], v12 offset:4096
  v_mfma_f32_16x16x32_bf16 v[112:115], v[48:51], v[72:75], v[112:115]
  ds_read_b128 v[212:215], v12 offset:5120
  v_mfma_f32_16x16x32_bf16 v[128:131], v[48:51], v[76:79], v[128:131]
  ds_read_b128 v[216:219], v12 offset:7168
  s_waitcnt lgkmcnt(14)
  v_mfma_f32_16x16x32_bf16 v[128:131], v[16:19], v[44:47], v[128:131]
  ds_read_b128 v[184:187], v12 offset:6144
  v_add_u32 v12, s42, v12
  v_mfma_f32_16x16x32_bf16 v[132:135], v[20:23], v[44:47], v[132:135]
  ds_read_b64_tr_b16 v[168:169], v11 offset:0
  v_mfma_f32_16x16x32_bf16 v[132:135], v[52:55], v[76:79], v[132:135]
  ds_read_b64_tr_b16 v[170:171], v11 offset:1024
  v_mfma_f32_16x16x32_bf16 v[136:139], v[56:59], v[76:79], v[136:139]
  ds_read_b64_tr_b16 v[200:201], v11 offset:8192
  v_mfma_f32_16x16x32_bf16 v[136:139], v[24:27], v[44:47], v[136:139]
  ds_read_b64_tr_b16 v[202:203], v11 offset:9216
  v_add_u32 v11, s42, v11
  v_mfma_f32_16x16x32_bf16 v[140:143], v[28:31], v[44:47], v[140:143]
  v_mfma_f32_16x16x32_bf16 v[140:143], v[60:63], v[76:79], v[140:143]
  v_mfma_f32_16x16x32_bf16 v[124:127], v[60:63], v[72:75], v[124:127]
  v_mfma_f32_16x16x32_bf16 v[124:127], v[28:31], v[40:43], v[124:127]
  v_mfma_f32_16x16x32_bf16 v[108:111], v[28:31], v[36:39], v[108:111]
  v_mfma_f32_16x16x32_bf16 v[108:111], v[60:63], v[68:71], v[108:111]
  v_mfma_f32_16x16x32_bf16 v[92:95], v[60:63], v[64:67], v[92:95]
  v_mfma_f32_16x16x32_bf16 v[92:95], v[28:31], v[32:35], v[92:95]
  s_waitcnt lgkmcnt(14)
  v_mfma_f32_16x16x32_bf16 v[80:83], v[156:159], v[172:175], v[80:83]
  v_mfma_f32_16x16x32_bf16 v[80:83], v[188:191], v[204:207], v[80:83]
  v_mfma_f32_16x16x32_bf16 v[96:99], v[188:191], v[208:211], v[96:99]
  v_mfma_f32_16x16x32_bf16 v[96:99], v[156:159], v[176:179], v[96:99]
  v_mfma_f32_16x16x32_bf16 v[100:103], v[160:163], v[176:179], v[100:103]
  s_waitcnt lgkmcnt(12)
  v_mfma_f32_16x16x32_bf16 v[100:103], v[192:195], v[208:211], v[100:103]
  v_mfma_f32_16x16x32_bf16 v[84:87], v[192:195], v[204:207], v[84:87]
  v_mfma_f32_16x16x32_bf16 v[84:87], v[160:163], v[172:175], v[84:87]
  s_waitcnt lgkmcnt(10)
  v_mfma_f32_16x16x32_bf16 v[88:91], v[164:167], v[172:175], v[88:91]
  s_waitcnt lgkmcnt(8)
  v_mfma_f32_16x16x32_bf16 v[88:91], v[196:199], v[204:207], v[88:91]
  v_mfma_f32_16x16x32_bf16 v[104:107], v[196:199], v[208:211], v[104:107]
  v_mfma_f32_16x16x32_bf16 v[104:107], v[164:167], v[176:179], v[104:107]
  s_waitcnt lgkmcnt(7)
  v_mfma_f32_16x16x32_bf16 v[120:123], v[164:167], v[180:183], v[120:123]
  s_waitcnt lgkmcnt(6)
  v_mfma_f32_16x16x32_bf16 v[120:123], v[196:199], v[212:215], v[120:123]
  v_mfma_f32_16x16x32_bf16 v[116:119], v[192:195], v[212:215], v[116:119]
  v_mfma_f32_16x16x32_bf16 v[116:119], v[160:163], v[180:183], v[116:119]
  v_mfma_f32_16x16x32_bf16 v[112:115], v[156:159], v[180:183], v[112:115]
  v_mfma_f32_16x16x32_bf16 v[112:115], v[188:191], v[212:215], v[112:115]
  s_waitcnt lgkmcnt(5)
  v_mfma_f32_16x16x32_bf16 v[128:131], v[188:191], v[216:219], v[128:131]
  s_waitcnt lgkmcnt(4)
  v_mfma_f32_16x16x32_bf16 v[128:131], v[156:159], v[184:187], v[128:131]
  v_mfma_f32_16x16x32_bf16 v[132:135], v[160:163], v[184:187], v[132:135]
  v_mfma_f32_16x16x32_bf16 v[132:135], v[192:195], v[216:219], v[132:135]
  v_mfma_f32_16x16x32_bf16 v[136:139], v[196:199], v[216:219], v[136:139]
  v_mfma_f32_16x16x32_bf16 v[136:139], v[164:167], v[184:187], v[136:139]
  s_waitcnt lgkmcnt(2)
  v_mfma_f32_16x16x32_bf16 v[140:143], v[168:171], v[184:187], v[140:143]
  s_waitcnt lgkmcnt(0)
  v_mfma_f32_16x16x32_bf16 v[140:143], v[200:203], v[216:219], v[140:143]
  v_mfma_f32_16x16x32_bf16 v[124:127], v[200:203], v[212:215], v[124:127]
  v_mfma_f32_16x16x32_bf16 v[124:127], v[168:171], v[180:183], v[124:127]
  v_mfma_f32_16x16x32_bf16 v[108:111], v[168:171], v[176:179], v[108:111]
  v_mfma_f32_16x16x32_bf16 v[108:111], v[200:203], v[208:211], v[108:111]
  v_mfma_f32_16x16x32_bf16 v[92:95], v[200:203], v[204:207], v[92:95]
  v_mfma_f32_16x16x32_bf16 v[92:95], v[168:171], v[172:175], v[92:95]
  s_waitcnt lgkmcnt(0)
  v_mov_b32 v16, 0xc0135761
  v_mov_b32 v17, 0xbdd2d3e8
  v_pk_mul_f32 v[24:25], v[80:81], v[80:81]
  v_pk_mul_f32 v[26:27], v[82:83], v[82:83]
  v_pk_mul_f32 v[28:29], v[84:85], v[84:85]
  v_pk_mul_f32 v[30:31], v[86:87], v[86:87]
  v_pk_fma_f32 v[24:25], v[24:25], v[16:17], v[16:17] op_sel:[0,1,0] op_sel_hi:[1,1,0]
  v_pk_fma_f32 v[26:27], v[26:27], v[16:17], v[16:17] op_sel:[0,1,0] op_sel_hi:[1,1,0]
  v_pk_fma_f32 v[28:29], v[28:29], v[16:17], v[16:17] op_sel:[0,1,0] op_sel_hi:[1,1,0]
  v_pk_fma_f32 v[30:31], v[30:31], v[16:17], v[16:17] op_sel:[0,1,0] op_sel_hi:[1,1,0]
  v_pk_mul_f32 v[24:25], v[24:25], v[80:81]
  v_pk_mul_f32 v[26:27], v[26:27], v[82:83]
  v_pk_mul_f32 v[28:29], v[28:29], v[84:85]
  v_pk_mul_f32 v[30:31], v[30:31], v[86:87]
  v_exp_f32 v24, v24
  v_exp_f32 v25, v25
  v_exp_f32 v26, v26
  v_exp_f32 v27, v27
  v_exp_f32 v28, v28
  v_exp_f32 v29, v29
  v_exp_f32 v30, v30
  v_exp_f32 v31, v31
  v_pk_add_f32 v[24:25], v[24:25], 1.0 op_sel_hi:[1,0]
  v_pk_add_f32 v[26:27], v[26:27], 1.0 op_sel_hi:[1,0]
  v_pk_add_f32 v[28:29], v[28:29], 1.0 op_sel_hi:[1,0]
  v_pk_add_f32 v[30:31], v[30:31], 1.0 op_sel_hi:[1,0]
  v_rcp_f32 v24, v24
  v_rcp_f32 v25, v25
  v_rcp_f32 v26, v26
  v_rcp_f32 v27, v27
  v_rcp_f32 v28, v28
  v_rcp_f32 v29, v29
  v_rcp_f32 v30, v30
  v_rcp_f32 v31, v31
  v_pk_mul_f32 v[24:25], v[24:25], v[80:81]
  v_pk_mul_f32 v[26:27], v[26:27], v[82:83]
  v_pk_mul_f32 v[28:29], v[28:29], v[84:85]
  v_pk_mul_f32 v[30:31], v[30:31], v[86:87]
  v_cvt_pk_bf16_f32 v164, v24, v25
  v_cvt_pk_bf16_f32 v165, v26, v27
  v_cvt_pk_bf16_f32 v166, v28, v29
  v_cvt_pk_bf16_f32 v167, v30, v31
  s_nop 0
  v_permlane16_swap_b32 v164, v166
  v_permlane16_swap_b32 v165, v167
  buffer_store_dwordx4 v[164:167], v152, s[20:23], s44 offen sc0 sc1
  v_pk_mul_f32 v[40:41], v[88:89], v[88:89]
  v_pk_mul_f32 v[42:43], v[90:91], v[90:91]
  v_pk_mul_f32 v[44:45], v[92:93], v[92:93]
  v_pk_mul_f32 v[46:47], v[94:95], v[94:95]
  v_pk_fma_f32 v[40:41], v[40:41], v[16:17], v[16:17] op_sel:[0,1,0] op_sel_hi:[1,1,0]
  v_pk_fma_f32 v[42:43], v[42:43], v[16:17], v[16:17] op_sel:[0,1,0] op_sel_hi:[1,1,0]
  v_pk_fma_f32 v[44:45], v[44:45], v[16:17], v[16:17] op_sel:[0,1,0] op_sel_hi:[1,1,0]
  v_pk_fma_f32 v[46:47], v[46:47], v[16:17], v[16:17] op_sel:[0,1,0] op_sel_hi:[1,1,0]
  v_pk_mul_f32 v[40:41], v[40:41], v[88:89]
  v_pk_mul_f32 v[42:43], v[42:43], v[90:91]
  v_pk_mul_f32 v[44:45], v[44:45], v[92:93]
  v_pk_mul_f32 v[46:47], v[46:47], v[94:95]
  v_exp_f32 v40, v40
  v_exp_f32 v41, v41
  v_exp_f32 v42, v42
  v_exp_f32 v43, v43
  v_exp_f32 v44, v44
  v_exp_f32 v45, v45
  v_exp_f32 v46, v46
  v_exp_f32 v47, v47
  v_pk_add_f32 v[40:41], v[40:41], 1.0 op_sel_hi:[1,0]
  v_pk_add_f32 v[42:43], v[42:43], 1.0 op_sel_hi:[1,0]
  v_pk_add_f32 v[44:45], v[44:45], 1.0 op_sel_hi:[1,0]
  v_pk_add_f32 v[46:47], v[46:47], 1.0 op_sel_hi:[1,0]
  v_rcp_f32 v40, v40
  v_rcp_f32 v41, v41
  v_rcp_f32 v42, v42
  v_rcp_f32 v43, v43
  v_rcp_f32 v44, v44
  v_rcp_f32 v45, v45
  v_rcp_f32 v46, v46
  v_rcp_f32 v47, v47
  v_pk_mul_f32 v[40:41], v[40:41], v[88:89]
  v_pk_mul_f32 v[42:43], v[42:43], v[90:91]
  v_pk_mul_f32 v[44:45], v[44:45], v[92:93]
  v_pk_mul_f32 v[46:47], v[46:47], v[94:95]
  v_cvt_pk_bf16_f32 v168, v40, v41
  v_cvt_pk_bf16_f32 v169, v42, v43
  v_cvt_pk_bf16_f32 v170, v44, v45
  v_cvt_pk_bf16_f32 v171, v46, v47
  s_nop 0
  v_permlane16_swap_b32 v168, v170
  v_permlane16_swap_b32 v169, v171
  buffer_store_dwordx4 v[168:171], v152, s[20:23], s46 offen sc0 sc1
  v_pk_mul_f32 v[24:25], v[96:97], v[96:97]
  v_pk_mul_f32 v[26:27], v[98:99], v[98:99]
  v_pk_mul_f32 v[28:29], v[100:101], v[100:101]
  v_pk_mul_f32 v[30:31], v[102:103], v[102:103]
  v_pk_fma_f32 v[24:25], v[24:25], v[16:17], v[16:17] op_sel:[0,1,0] op_sel_hi:[1,1,0]
  v_pk_fma_f32 v[26:27], v[26:27], v[16:17], v[16:17] op_sel:[0,1,0] op_sel_hi:[1,1,0]
  v_pk_fma_f32 v[28:29], v[28:29], v[16:17], v[16:17] op_sel:[0,1,0] op_sel_hi:[1,1,0]
  v_pk_fma_f32 v[30:31], v[30:31], v[16:17], v[16:17] op_sel:[0,1,0] op_sel_hi:[1,1,0]
  v_pk_mul_f32 v[24:25], v[24:25], v[96:97]
  v_pk_mul_f32 v[26:27], v[26:27], v[98:99]
  v_pk_mul_f32 v[28:29], v[28:29], v[100:101]
  v_pk_mul_f32 v[30:31], v[30:31], v[102:103]
  v_exp_f32 v24, v24
  v_exp_f32 v25, v25
  v_exp_f32 v26, v26
  v_exp_f32 v27, v27
  v_exp_f32 v28, v28
  v_exp_f32 v29, v29
  v_exp_f32 v30, v30
  v_exp_f32 v31, v31
  v_pk_add_f32 v[24:25], v[24:25], 1.0 op_sel_hi:[1,0]
  v_pk_add_f32 v[26:27], v[26:27], 1.0 op_sel_hi:[1,0]
  v_pk_add_f32 v[28:29], v[28:29], 1.0 op_sel_hi:[1,0]
  v_pk_add_f32 v[30:31], v[30:31], 1.0 op_sel_hi:[1,0]
  v_rcp_f32 v24, v24
  v_rcp_f32 v25, v25
  v_rcp_f32 v26, v26
  v_rcp_f32 v27, v27
  v_rcp_f32 v28, v28
  v_rcp_f32 v29, v29
  v_rcp_f32 v30, v30
  v_rcp_f32 v31, v31
  v_pk_mul_f32 v[24:25], v[24:25], v[96:97]
  v_pk_mul_f32 v[26:27], v[26:27], v[98:99]
  v_pk_mul_f32 v[28:29], v[28:29], v[100:101]
  v_pk_mul_f32 v[30:31], v[30:31], v[102:103]
  v_cvt_pk_bf16_f32 v172, v24, v25
  v_cvt_pk_bf16_f32 v173, v26, v27
  v_cvt_pk_bf16_f32 v174, v28, v29
  v_cvt_pk_bf16_f32 v175, v30, v31
  s_nop 0
  v_permlane16_swap_b32 v172, v174
  v_permlane16_swap_b32 v173, v175
  buffer_store_dwordx4 v[172:175], v153, s[20:23], s44 offen sc0 sc1
  v_pk_mul_f32 v[40:41], v[104:105], v[104:105]
  v_pk_mul_f32 v[42:43], v[106:107], v[106:107]
  v_pk_mul_f32 v[44:45], v[108:109], v[108:109]
  v_pk_mul_f32 v[46:47], v[110:111], v[110:111]
  v_pk_fma_f32 v[40:41], v[40:41], v[16:17], v[16:17] op_sel:[0,1,0] op_sel_hi:[1,1,0]
  v_pk_fma_f32 v[42:43], v[42:43], v[16:17], v[16:17] op_sel:[0,1,0] op_sel_hi:[1,1,0]
  v_pk_fma_f32 v[44:45], v[44:45], v[16:17], v[16:17] op_sel:[0,1,0] op_sel_hi:[1,1,0]
  v_pk_fma_f32 v[46:47], v[46:47], v[16:17], v[16:17] op_sel:[0,1,0] op_sel_hi:[1,1,0]
  v_pk_mul_f32 v[40:41], v[40:41], v[104:105]
  v_pk_mul_f32 v[42:43], v[42:43], v[106:107]
  v_pk_mul_f32 v[44:45], v[44:45], v[108:109]
  v_pk_mul_f32 v[46:47], v[46:47], v[110:111]
  v_exp_f32 v40, v40
  v_exp_f32 v41, v41
  v_exp_f32 v42, v42
  v_exp_f32 v43, v43
  v_exp_f32 v44, v44
  v_exp_f32 v45, v45
  v_exp_f32 v46, v46
  v_exp_f32 v47, v47
  v_pk_add_f32 v[40:41], v[40:41], 1.0 op_sel_hi:[1,0]
  v_pk_add_f32 v[42:43], v[42:43], 1.0 op_sel_hi:[1,0]
  v_pk_add_f32 v[44:45], v[44:45], 1.0 op_sel_hi:[1,0]
  v_pk_add_f32 v[46:47], v[46:47], 1.0 op_sel_hi:[1,0]
  v_rcp_f32 v40, v40
  v_rcp_f32 v41, v41
  v_rcp_f32 v42, v42
  v_rcp_f32 v43, v43
  v_rcp_f32 v44, v44
  v_rcp_f32 v45, v45
  v_rcp_f32 v46, v46
  v_rcp_f32 v47, v47
  v_pk_mul_f32 v[40:41], v[40:41], v[104:105]
  v_pk_mul_f32 v[42:43], v[42:43], v[106:107]
  v_pk_mul_f32 v[44:45], v[44:45], v[108:109]
  v_pk_mul_f32 v[46:47], v[46:47], v[110:111]
  v_cvt_pk_bf16_f32 v176, v40, v41
  v_cvt_pk_bf16_f32 v177, v42, v43
  v_cvt_pk_bf16_f32 v178, v44, v45
  v_cvt_pk_bf16_f32 v179, v46, v47
  s_nop 0
  v_permlane16_swap_b32 v176, v178
  v_permlane16_swap_b32 v177, v179
  buffer_store_dwordx4 v[176:179], v153, s[20:23], s46 offen sc0 sc1
  v_pk_mul_f32 v[24:25], v[112:113], v[112:113]
  v_pk_mul_f32 v[26:27], v[114:115], v[114:115]
  v_pk_mul_f32 v[28:29], v[116:117], v[116:117]
  v_pk_mul_f32 v[30:31], v[118:119], v[118:119]
  v_pk_fma_f32 v[24:25], v[24:25], v[16:17], v[16:17] op_sel:[0,1,0] op_sel_hi:[1,1,0]
  v_pk_fma_f32 v[26:27], v[26:27], v[16:17], v[16:17] op_sel:[0,1,0] op_sel_hi:[1,1,0]
  v_pk_fma_f32 v[28:29], v[28:29], v[16:17], v[16:17] op_sel:[0,1,0] op_sel_hi:[1,1,0]
  v_pk_fma_f32 v[30:31], v[30:31], v[16:17], v[16:17] op_sel:[0,1,0] op_sel_hi:[1,1,0]
  v_pk_mul_f32 v[24:25], v[24:25], v[112:113]
  v_pk_mul_f32 v[26:27], v[26:27], v[114:115]
  v_pk_mul_f32 v[28:29], v[28:29], v[116:117]
  v_pk_mul_f32 v[30:31], v[30:31], v[118:119]
  v_exp_f32 v24, v24
  v_exp_f32 v25, v25
  v_exp_f32 v26, v26
  v_exp_f32 v27, v27
  v_exp_f32 v28, v28
  v_exp_f32 v29, v29
  v_exp_f32 v30, v30
  v_exp_f32 v31, v31
  v_pk_add_f32 v[24:25], v[24:25], 1.0 op_sel_hi:[1,0]
  v_pk_add_f32 v[26:27], v[26:27], 1.0 op_sel_hi:[1,0]
  v_pk_add_f32 v[28:29], v[28:29], 1.0 op_sel_hi:[1,0]
  v_pk_add_f32 v[30:31], v[30:31], 1.0 op_sel_hi:[1,0]
  v_rcp_f32 v24, v24
  v_rcp_f32 v25, v25
  v_rcp_f32 v26, v26
  v_rcp_f32 v27, v27
  v_rcp_f32 v28, v28
  v_rcp_f32 v29, v29
  v_rcp_f32 v30, v30
  v_rcp_f32 v31, v31
  v_pk_mul_f32 v[24:25], v[24:25], v[112:113]
  v_pk_mul_f32 v[26:27], v[26:27], v[114:115]
  v_pk_mul_f32 v[28:29], v[28:29], v[116:117]
  v_pk_mul_f32 v[30:31], v[30:31], v[118:119]
  v_cvt_pk_bf16_f32 v180, v24, v25
  v_cvt_pk_bf16_f32 v181, v26, v27
  v_cvt_pk_bf16_f32 v182, v28, v29
  v_cvt_pk_bf16_f32 v183, v30, v31
  s_nop 0
  v_permlane16_swap_b32 v180, v182
  v_permlane16_swap_b32 v181, v183
  buffer_store_dwordx4 v[180:183], v152, s[20:23], s45 offen sc0 sc1
  v_pk_mul_f32 v[40:41], v[120:121], v[120:121]
  v_pk_mul_f32 v[42:43], v[122:123], v[122:123]
  v_pk_mul_f32 v[44:45], v[124:125], v[124:125]
  v_pk_mul_f32 v[46:47], v[126:127], v[126:127]
  v_pk_fma_f32 v[40:41], v[40:41], v[16:17], v[16:17] op_sel:[0,1,0] op_sel_hi:[1,1,0]
  v_pk_fma_f32 v[42:43], v[42:43], v[16:17], v[16:17] op_sel:[0,1,0] op_sel_hi:[1,1,0]
  v_pk_fma_f32 v[44:45], v[44:45], v[16:17], v[16:17] op_sel:[0,1,0] op_sel_hi:[1,1,0]
  v_pk_fma_f32 v[46:47], v[46:47], v[16:17], v[16:17] op_sel:[0,1,0] op_sel_hi:[1,1,0]
  v_pk_mul_f32 v[40:41], v[40:41], v[120:121]
  v_pk_mul_f32 v[42:43], v[42:43], v[122:123]
  v_pk_mul_f32 v[44:45], v[44:45], v[124:125]
  v_pk_mul_f32 v[46:47], v[46:47], v[126:127]
  v_exp_f32 v40, v40
  v_exp_f32 v41, v41
  v_exp_f32 v42, v42
  v_exp_f32 v43, v43
  v_exp_f32 v44, v44
  v_exp_f32 v45, v45
  v_exp_f32 v46, v46
  v_exp_f32 v47, v47
  v_pk_add_f32 v[40:41], v[40:41], 1.0 op_sel_hi:[1,0]
  v_pk_add_f32 v[42:43], v[42:43], 1.0 op_sel_hi:[1,0]
  v_pk_add_f32 v[44:45], v[44:45], 1.0 op_sel_hi:[1,0]
  v_pk_add_f32 v[46:47], v[46:47], 1.0 op_sel_hi:[1,0]
  v_rcp_f32 v40, v40
  v_rcp_f32 v41, v41
  v_rcp_f32 v42, v42
  v_rcp_f32 v43, v43
  v_rcp_f32 v44, v44
  v_rcp_f32 v45, v45
  v_rcp_f32 v46, v46
  v_rcp_f32 v47, v47
  v_pk_mul_f32 v[40:41], v[40:41], v[120:121]
  v_pk_mul_f32 v[42:43], v[42:43], v[122:123]
  v_pk_mul_f32 v[44:45], v[44:45], v[124:125]
  v_pk_mul_f32 v[46:47], v[46:47], v[126:127]
  v_cvt_pk_bf16_f32 v184, v40, v41
  v_cvt_pk_bf16_f32 v185, v42, v43
  v_cvt_pk_bf16_f32 v186, v44, v45
  v_cvt_pk_bf16_f32 v187, v46, v47
  s_nop 0
  v_permlane16_swap_b32 v184, v186
  v_permlane16_swap_b32 v185, v187
  buffer_store_dwordx4 v[184:187], v152, s[20:23], s47 offen sc0 sc1
  v_pk_mul_f32 v[24:25], v[128:129], v[128:129]
  v_pk_mul_f32 v[26:27], v[130:131], v[130:131]
  v_pk_mul_f32 v[28:29], v[132:133], v[132:133]
  v_pk_mul_f32 v[30:31], v[134:135], v[134:135]
  v_pk_fma_f32 v[24:25], v[24:25], v[16:17], v[16:17] op_sel:[0,1,0] op_sel_hi:[1,1,0]
  v_pk_fma_f32 v[26:27], v[26:27], v[16:17], v[16:17] op_sel:[0,1,0] op_sel_hi:[1,1,0]
  v_pk_fma_f32 v[28:29], v[28:29], v[16:17], v[16:17] op_sel:[0,1,0] op_sel_hi:[1,1,0]
  v_pk_fma_f32 v[30:31], v[30:31], v[16:17], v[16:17] op_sel:[0,1,0] op_sel_hi:[1,1,0]
  v_pk_mul_f32 v[24:25], v[24:25], v[128:129]
  v_pk_mul_f32 v[26:27], v[26:27], v[130:131]
  v_pk_mul_f32 v[28:29], v[28:29], v[132:133]
  v_pk_mul_f32 v[30:31], v[30:31], v[134:135]
  v_exp_f32 v24, v24
  v_exp_f32 v25, v25
  v_exp_f32 v26, v26
  v_exp_f32 v27, v27
  v_exp_f32 v28, v28
  v_exp_f32 v29, v29
  v_exp_f32 v30, v30
  v_exp_f32 v31, v31
  v_pk_add_f32 v[24:25], v[24:25], 1.0 op_sel_hi:[1,0]
  v_pk_add_f32 v[26:27], v[26:27], 1.0 op_sel_hi:[1,0]
  v_pk_add_f32 v[28:29], v[28:29], 1.0 op_sel_hi:[1,0]
  v_pk_add_f32 v[30:31], v[30:31], 1.0 op_sel_hi:[1,0]
  v_rcp_f32 v24, v24
  v_rcp_f32 v25, v25
  v_rcp_f32 v26, v26
  v_rcp_f32 v27, v27
  v_rcp_f32 v28, v28
  v_rcp_f32 v29, v29
  v_rcp_f32 v30, v30
  v_rcp_f32 v31, v31
  v_pk_mul_f32 v[24:25], v[24:25], v[128:129]
  v_pk_mul_f32 v[26:27], v[26:27], v[130:131]
  v_pk_mul_f32 v[28:29], v[28:29], v[132:133]
  v_pk_mul_f32 v[30:31], v[30:31], v[134:135]
  v_cvt_pk_bf16_f32 v188, v24, v25
  v_cvt_pk_bf16_f32 v189, v26, v27
  v_cvt_pk_bf16_f32 v190, v28, v29
  v_cvt_pk_bf16_f32 v191, v30, v31
  s_nop 0
  v_permlane16_swap_b32 v188, v190
  v_permlane16_swap_b32 v189, v191
  buffer_store_dwordx4 v[188:191], v154, s[20:23], s45 offen sc0 sc1
  v_pk_mul_f32 v[40:41], v[136:137], v[136:137]
  v_pk_mul_f32 v[42:43], v[138:139], v[138:139]
  v_pk_mul_f32 v[44:45], v[140:141], v[140:141]
  v_pk_mul_f32 v[46:47], v[142:143], v[142:143]
  v_pk_fma_f32 v[40:41], v[40:41], v[16:17], v[16:17] op_sel:[0,1,0] op_sel_hi:[1,1,0]
  v_pk_fma_f32 v[42:43], v[42:43], v[16:17], v[16:17] op_sel:[0,1,0] op_sel_hi:[1,1,0]
  v_pk_fma_f32 v[44:45], v[44:45], v[16:17], v[16:17] op_sel:[0,1,0] op_sel_hi:[1,1,0]
  v_pk_fma_f32 v[46:47], v[46:47], v[16:17], v[16:17] op_sel:[0,1,0] op_sel_hi:[1,1,0]
  v_pk_mul_f32 v[40:41], v[40:41], v[136:137]
  v_pk_mul_f32 v[42:43], v[42:43], v[138:139]
  v_pk_mul_f32 v[44:45], v[44:45], v[140:141]
  v_pk_mul_f32 v[46:47], v[46:47], v[142:143]
  v_exp_f32 v40, v40
  v_exp_f32 v41, v41
  v_exp_f32 v42, v42
  v_exp_f32 v43, v43
  v_exp_f32 v44, v44
  v_exp_f32 v45, v45
  v_exp_f32 v46, v46
  v_exp_f32 v47, v47
  v_pk_add_f32 v[40:41], v[40:41], 1.0 op_sel_hi:[1,0]
  v_pk_add_f32 v[42:43], v[42:43], 1.0 op_sel_hi:[1,0]
  v_pk_add_f32 v[44:45], v[44:45], 1.0 op_sel_hi:[1,0]
  v_pk_add_f32 v[46:47], v[46:47], 1.0 op_sel_hi:[1,0]
  v_rcp_f32 v40, v40
  v_rcp_f32 v41, v41
  v_rcp_f32 v42, v42
  v_rcp_f32 v43, v43
  v_rcp_f32 v44, v44
  v_rcp_f32 v45, v45
  v_rcp_f32 v46, v46
  v_rcp_f32 v47, v47
  v_pk_mul_f32 v[40:41], v[40:41], v[136:137]
  v_pk_mul_f32 v[42:43], v[42:43], v[138:139]
  v_pk_mul_f32 v[44:45], v[44:45], v[140:141]
  v_pk_mul_f32 v[46:47], v[46:47], v[142:143]
  v_cvt_pk_bf16_f32 v192, v40, v41
  v_cvt_pk_bf16_f32 v193, v42, v43
  v_cvt_pk_bf16_f32 v194, v44, v45
  v_cvt_pk_bf16_f32 v195, v46, v47
  s_nop 0
  v_permlane16_swap_b32 v192, v194
  v_permlane16_swap_b32 v193, v195
  buffer_store_dwordx4 v[192:195], v154, s[20:23], s47 offen sc0 sc1
C_k3skip:
  s_nop 7
  s_nop 7
  s_lshr_b32 s32, s2, 3
  s_lshr_b32 s5, s32, 3
  s_and_b32 s6, s32, 7
  s_lshl_b32 s7, s5, 1
  s_add_u32 s7, s7, s6
  s_and_b32 s7, s7, 7
  s_and_b32 s32, s2, 7
  s_lshr_b32 s28, s32, 2
  s_lshl_b32 s28, s28, 2
  s_add_u32 s28, s28, s5
  s_and_b32 s29, s32, 3
  s_mul_i32 s29, s29, 8
  s_add_u32 s29, s29, s6
  s_mov_b32 s30, 7
  s_mov_b32 s31, -1
  s_lshl_b32 s32, s29, 6
  v_add_u32 v13, s32, v4
  v_lshlrev_b32 v13, 1, v13
  s_lshl_b32 s40, s4, 4
  s_add_u32 s32, s32, s40
  v_add_u32 v16, s32, v5
  v_lshlrev_b32 v12, 11, v16
  v_lshl_add_u32 v12, v4, 4, v12
  s_lshl_b32 s32, s28, 8
  v_add_u32 v12, s32, v12
  v_lshlrev_b32 v186, 8, v16
  v_and_b32 v17, 7, v0
  v_lshl_add_u32 v186, v17, 4, v186
  v_lshrrev_b32 v17, 3, v4
  v_lshl_add_u32 v186, v17, 19, v186
  s_lshl_b32 s32, s28, 20
  v_add_u32 v186, s32, v186
  v_mul_u32_u24 v189, 272, v4
  v_lshl_add_u32 v189, v5, 4, v189
  s_lshl_b32 s32, s4, 6
  s_add_u32 s32, s32, 1024
  v_add_u32 v189, s32, v189
  v_add_u32 v16, s40, v5
  v_mul_u32_u24 v190, 272, v16
  v_lshl_add_u32 v190, v4, 4, v190
  v_add_u32 v190, 1024, v190
  s_lshl_b32 s34, s28, 2
  s_add_u32 s34, s34, s4
  s_mul_i32 s34, s34, 458752
  s_mov_b32 s45, 8192
  s_mov_b32 s46, 16384
  s_mov_b32 s47, 24576
  v_lshrrev_b32 v16, 1, v4
  v_lshlrev_b32 v16, 4, v16
  v_lshl_add_u32 v16, v3, 8, v16
  v_and_b32 v17, 1, v4
  v_lshl_add_u32 v187, v17, 11, v16
  s_and_b32 s32, s4, 1
  s_lshl_b32 s32, s32, 1
  v_add_u32 v17, s32, v17
  v_cmp_eq_u32 vcc, 3, v17
  s_nop 1
  v_addc_co_u32 v17, vcc, 5, v17, vcc
  v_lshlrev_b32 v17, 7, v17
  v_cmp_eq_u32 vcc, 1, v3
  v_add_u32 v188, 128, v187
  s_nop 0
  v_cndmask_b32 v17, 0, v17, vcc
  v_add_u32 v188, v188, v17
  s_lshl_b32 s44, s29, 6
  s_lshl_b32 s32, s28, 2
  s_add_u32 s44, s44, s32
  s_add_u32 s44, s44, s4
  s_lshl_b32 s44, s44, 12
  s_add_u32 s51, s44, 131072
  s_add_u32 s8, s82, 25165824
  s_addc_u32 s9, s83, 0
  s_mov_b32 s10, 14680064
  s_mov_b32 s11, 0x20000
  s_add_u32 s16, s82, 8388608
  s_addc_u32 s17, s83, 0
  s_mov_b32 s18, 8388608
  s_mov_b32 s19, 0x20000
  s_mov_b32 s12, s78
  s_mov_b32 s13, s79
  s_mov_b32 s14, 4096
  s_mov_b32 s15, 0x20000
  v_lshl_add_u32 v16, v5, 3, v6
  v_lshlrev_b32 v16, 7, v16
  v_lshl_add_u32 v16, v7, 3, v16
  v_lshrrev_b32 v17, 1, v6
  v_lshl_or_b32 v17, v2, 1, v17
  v_lshl_add_u32 v16, v17, 5, v16
  v_add_u32 v16, 98304, v16
  v_xor_b32 v8, 0, v16
  v_xor_b32 v9, 32, v16
  v_xor_b32 v10, 64, v16
  v_xor_b32 v11, 96, v16
  s_lshl_b32 s48, 0x303, s7
  s_lshr_b32 s48, s48, 8
  s_mov_b32 s49, s34
  s_add_u32 s50, s34, 65536
  s_add_u32 s41, s34, 458752
  s_and_b32 s40, s4, 1
  s_lshl_b32 s32, s40, 1
  s_add_u32 s32, s32, 0
  s_cmp_eq_u32 s32, 3
  s_addc_u32 s32, s32, 5
  s_lshl_b32 s32, s32, 7
  s_mov_b32 vcc_lo, 0xff000000
  s_mov_b32 vcc_hi, 0
  v_mov_b32 v88, s32
  v_cndmask_b32 v88, 0, v88, vcc
  v_lshl_add_u32 v88, v0, 4, v88
  v_add_u32 v90, 4096, v88
  s_lshl_b32 s32, s40, 1
  s_add_u32 s32, s32, 1
  s_cmp_eq_u32 s32, 3
  s_addc_u32 s32, s32, 5
  s_lshl_b32 s32, s32, 7
  s_mov_b32 vcc_lo, 0xff000000
  s_mov_b32 vcc_hi, 0
  v_mov_b32 v89, s32
  v_cndmask_b32 v89, 0, v89, vcc
  v_lshl_add_u32 v89, v0, 4, v89
  v_add_u32 v89, 2048, v89
  v_add_u32 v91, 4096, v89
  v_lshlrev_b32 v184, 3, v0
  s_lshl_b32 s32, s4, 9
  s_add_u32 s32, s32, 90112
  v_add_u32 v185, s32, v184
  s_add_u32 s24, s84, 109051904
  s_addc_u32 s25, s85, 0
  s_mov_b32 s26, 524288
  s_mov_b32 s27, 0x20000
  s_lshl_b32 s32, s28, 5
  v_min_u32 v15, 27, v0
  v_add_u32 v15, s32, v15
  v_max_i32 v15, 0, v15
  v_lshlrev_b32 v15, 7, v15
  s_lshl_b32 s55, s3, 17
  s_add_u32 s55, s55, 65536
  s_waitcnt vmcnt(0)
  s_barrier
  buffer_load_ushort v112, v13, s[12:15], 0 offen offset:0
  buffer_load_ushort v114, v13, s[12:15], 0 offen offset:32
  buffer_load_ushort v116, v13, s[12:15], 0 offen offset:64
  buffer_load_ushort v118, v13, s[12:15], 0 offen offset:96
  s_cmp_lt_u32 s2, 224
  s_cbranch_scc1 C_nopf
  s_cmp_lg_u32 s3, 0
  s_cbranch_scc1 C_nopf
  s_mov_b32 s20, s76
  s_mov_b32 s21, s77
  s_mov_b32 s22, 14680064
  s_mov_b32 s23, 0x20000
  s_sub_u32 s32, s2, 224
  s_lshl_b32 s32, s32, 2
  s_add_u32 s32, s32, s4
  s_lshl_b32 s32, s32, 13
  v_lshlrev_b32 v17, 7, v0
  s_sleep 127
  buffer_load_dword v18, v17, s[20:23], s32 offen
  s_add_u32 s32, s32, 1048576
  buffer_load_dword v18, v17, s[20:23], s32 offen
  s_add_u32 s32, s32, 1048576
  s_waitcnt vmcnt(1)
  buffer_load_dword v18, v17, s[20:23], s32 offen
  s_add_u32 s32, s32, 1048576
  s_waitcnt vmcnt(1)
  buffer_load_dword v18, v17, s[20:23], s32 offen
  s_add_u32 s32, s32, 1048576
  s_waitcnt vmcnt(1)
  buffer_load_dword v18, v17, s[20:23], s32 offen
  s_add_u32 s32, s32, 1048576
  s_waitcnt vmcnt(1)
  buffer_load_dword v18, v17, s[20:23], s32 offen
  s_add_u32 s32, s32, 1048576
  s_waitcnt vmcnt(1)
  buffer_load_dword v18, v17, s[20:23], s32 offen
  s_add_u32 s32, s32, 1048576
  s_waitcnt vmcnt(1)
  buffer_load_dword v18, v17, s[20:23], s32 offen
  s_add_u32 s32, s32, 1048576
  s_waitcnt vmcnt(1)
  buffer_load_dword v18, v17, s[20:23], s32 offen
  s_add_u32 s32, s32, 1048576
  s_waitcnt vmcnt(1)
  buffer_load_dword v18, v17, s[20:23], s32 offen
  s_add_u32 s32, s32, 1048576
  s_waitcnt vmcnt(1)
  buffer_load_dword v18, v17, s[20:23], s32 offen
  s_add_u32 s32, s32, 1048576
  s_waitcnt vmcnt(1)
  buffer_load_dword v18, v17, s[20:23], s32 offen
  s_add_u32 s32, s32, 1048576
  s_waitcnt vmcnt(1)
  buffer_load_dword v18, v17, s[20:23], s32 offen
  s_add_u32 s32, s32, 1048576
  s_waitcnt vmcnt(1)
  buffer_load_dword v18, v17, s[20:23], s32 offen
  s_add_u32 s32, s32, 1048576
  s_waitcnt vmcnt(1)
C_nopf:
  s_mov_b32 s39, 0
  s_and_b32 s32, s4, 3
  s_cmp_lg_u32 s32, 0
  s_cbranch_scc1 poll5d
  s_sleep 8
poll5:
  buffer_load_dword v16, v15, s[24:27], s55 offen sc0 sc1
  s_waitcnt vmcnt(0)
  v_cmp_eq_u32 vcc, 0, v16
  s_add_u32 s39, s39, 1
  s_cmp_gt_u32 s39, 1000000
  s_cbranch_scc1 poll5d
  s_cbranch_vccnz poll5
poll5d:
  s_barrier
  buffer_load_dwordx4 v[96:99], v187, s[16:19], s44 offen sc1
  buffer_load_dwordx4 v[100:103], v188, s[16:19], s44 offen sc1
  buffer_load_dwordx4 v[104:107], v187, s[16:19], s51 offen sc1
  buffer_load_dwordx4 v[108:111], v188, s[16:19], s51 offen sc1
  s_cmp_eq_u32 s3, 0
  s_cselect_b32 s24, s84, s80
  s_cselect_b32 s25, s85, s81
  s_cselect_b32 s26, 100663296, 0
  s_add_u32 s24, s24, s26
  s_addc_u32 s25, s25, 0
  s_mov_b32 s26, 8388608
  s_mov_b32 s27, 0x20000
  s_lshr_b32 s26, s26, s3
  s_add_u32 s12, s84, 93323264
  s_addc_u32 s13, s85, 0
  s_mov_b32 s14, 262144
  s_mov_b32 s15, 0x20000
  s_bitcmp1_b32 s48, 0
  s_cselect_b32 s36, s50, s49
  s_add_u32 s36, s36, 0
  buffer_load_dwordx4 v[120:123], v88, s[8:11], s36 offen sc1
  buffer_load_dwordx4 v[124:127], v89, s[8:11], s36 offen sc1
  buffer_load_dwordx4 v[128:131], v90, s[8:11], s36 offen sc1
  buffer_load_dwordx4 v[132:135], v91, s[8:11], s36 offen sc1
  s_bitcmp1_b32 s48, 1
  s_cselect_b32 s36, s50, s49
  s_add_u32 s36, s36, 8192
  buffer_load_dwordx4 v[136:139], v88, s[8:11], s36 offen sc1
  buffer_load_dwordx4 v[140:143], v89, s[8:11], s36 offen sc1
  buffer_load_dwordx4 v[144:147], v90, s[8:11], s36 offen sc1
  buffer_load_dwordx4 v[148:151], v91, s[8:11], s36 offen sc1
  s_bitcmp1_b32 s48, 2
  s_cselect_b32 s36, s50, s49
  s_add_u32 s36, s36, 16384
  buffer_load_dwordx4 v[152:155], v88, s[8:11], s36 offen sc1
  buffer_load_dwordx4 v[156:159], v89, s[8:11], s36 offen sc1
  buffer_load_dwordx4 v[160:163], v90, s[8:11], s36 offen sc1
  buffer_load_dwordx4 v[164:167], v91, s[8:11], s36 offen sc1
  s_bitcmp1_b32 s48, 3
  s_cselect_b32 s36, s50, s49
  s_add_u32 s36, s36, 24576
  buffer_load_dwordx4 v[168:171], v88, s[8:11], s36 offen sc1
  buffer_load_dwordx4 v[172:175], v89, s[8:11], s36 offen sc1
  s_waitcnt vmcnt(14)
  v_lshlrev_b32 v112, 16, v112
  v_lshlrev_b32 v48, 16, v96
  v_and_b32 v49, 0xffff0000, v96
  v_lshlrev_b32 v50, 16, v97
  v_and_b32 v51, 0xffff0000, v97
  v_lshlrev_b32 v52, 16, v98
  v_and_b32 v53, 0xffff0000, v98
  v_lshlrev_b32 v54, 16, v99
  v_and_b32 v55, 0xffff0000, v99
  v_pk_add_f32 v[48:49], v[48:49], v[112:113] op_sel_hi:[1,0]
  v_pk_add_f32 v[50:51], v[50:51], v[112:113] op_sel_hi:[1,0]
  v_pk_add_f32 v[52:53], v[52:53], v[112:113] op_sel_hi:[1,0]
  v_pk_add_f32 v[54:55], v[54:55], v[112:113] op_sel_hi:[1,0]
  v_lshlrev_b32 v114, 16, v114
  v_lshlrev_b32 v56, 16, v100
  v_and_b32 v57, 0xffff0000, v100
  v_lshlrev_b32 v58, 16, v101
  v_and_b32 v59, 0xffff0000, v101
  v_lshlrev_b32 v60, 16, v102
  v_and_b32 v61, 0xffff0000, v102
  v_lshlrev_b32 v62, 16, v103
  v_and_b32 v63, 0xffff0000, v103
  v_pk_add_f32 v[56:57], v[56:57], v[114:115] op_sel_hi:[1,0]
  v_pk_add_f32 v[58:59], v[58:59], v[114:115] op_sel_hi:[1,0]
  v_pk_add_f32 v[60:61], v[60:61], v[114:115] op_sel_hi:[1,0]
  v_pk_add_f32 v[62:63], v[62:63], v[114:115] op_sel_hi:[1,0]
  v_lshlrev_b32 v116, 16, v116
  v_lshlrev_b32 v64, 16, v104
  v_and_b32 v65, 0xffff0000, v104
  v_lshlrev_b32 v66, 16, v105
  v_and_b32 v67, 0xffff0000, v105
  v_lshlrev_b32 v68, 16, v106
  v_and_b32 v69, 0xffff0000, v106
  v_lshlrev_b32 v70, 16, v107
  v_and_b32 v71, 0xffff0000, v107
  v_pk_add_f32 v[64:65], v[64:65], v[116:117] op_sel_hi:[1,0]
  v_pk_add_f32 v[66:67], v[66:67], v[116:117] op_sel_hi:[1,0]
  v_pk_add_f32 v[68:69], v[68:69], v[116:117] op_sel_hi:[1,0]
  v_pk_add_f32 v[70:71], v[70:71], v[116:117] op_sel_hi:[1,0]
  v_lshlrev_b32 v118, 16, v118
  v_lshlrev_b32 v72, 16, v108
  v_and_b32 v73, 0xffff0000, v108
  v_lshlrev_b32 v74, 16, v109
  v_and_b32 v75, 0xffff0000, v109
  v_lshlrev_b32 v76, 16, v110
  v_and_b32 v77, 0xffff0000, v110
  v_lshlrev_b32 v78, 16, v111
  v_and_b32 v79, 0xffff0000, v111
  v_pk_add_f32 v[72:73], v[72:73], v[118:119] op_sel_hi:[1,0]
  v_pk_add_f32 v[74:75], v[74:75], v[118:119] op_sel_hi:[1,0]
  v_pk_add_f32 v[76:77], v[76:77], v[118:119] op_sel_hi:[1,0]
  v_pk_add_f32 v[78:79], v[78:79], v[118:119] op_sel_hi:[1,0]
  s_mov_b32 s43, 0
  s_mov_b32 s39, 6
  s_barrier
  ds_read_b64_tr_b16 v[16:17], v8 offset:0
  ds_read_b64_tr_b16 v[18:19], v8 offset:512
  ds_read_b64_tr_b16 v[20:21], v9 offset:0
  ds_read_b64_tr_b16 v[22:23], v9 offset:512
  ds_read_b64_tr_b16 v[24:25], v10 offset:0
  ds_read_b64_tr_b16 v[26:27], v10 offset:512
  ds_read_b64_tr_b16 v[28:29], v11 offset:0
  ds_read_b64_tr_b16 v[30:31], v11 offset:512
  s_add_u32 s40, s43, 8192
  s_cmp_eq_u32 s40, 65536
  s_cselect_b32 s40, 0, s40
  s_sub_u32 s42, s40, s43
  s_mov_b32 s43, s40
cd6:
  s_waitcnt vmcnt(13) lgkmcnt(6)
  v_mfma_f32_16x16x32_bf16 v[48:51], v[120:123], v[16:19], v[48:51]
  ds_read_b64_tr_b16 v[32:33], v8 offset:4096
  s_waitcnt vmcnt(12)
  v_mfma_f32_16x16x32_bf16 v[52:55], v[124:127], v[16:19], v[52:55]
  ds_read_b64_tr_b16 v[34:35], v8 offset:4608
  v_add_u32 v8, s42, v8
  s_waitcnt lgkmcnt(6)
  v_mfma_f32_16x16x32_bf16 v[60:63], v[124:127], v[20:23], v[60:63]
  ds_read_b64_tr_b16 v[36:37], v9 offset:4096
  buffer_load_dwordx4 v[176:179], v90, s[8:11], s36 offen sc1
  v_mfma_f32_16x16x32_bf16 v[56:59], v[120:123], v[20:23], v[56:59]
  ds_read_b64_tr_b16 v[38:39], v9 offset:4608
  v_add_u32 v9, s42, v9
  s_waitcnt lgkmcnt(6)
  v_mfma_f32_16x16x32_bf16 v[64:67], v[120:123], v[24:27], v[64:67]
  ds_read_b64_tr_b16 v[40:41], v10 offset:4096
  v_mfma_f32_16x16x32_bf16 v[68:71], v[124:127], v[24:27], v[68:71]
  ds_read_b64_tr_b16 v[42:43], v10 offset:4608
  v_add_u32 v10, s42, v10
  s_waitcnt lgkmcnt(6)
  v_mfma_f32_16x16x32_bf16 v[76:79], v[124:127], v[28:31], v[76:79]
  ds_read_b64_tr_b16 v[44:45], v11 offset:4096
  buffer_load_dwordx4 v[180:183], v91, s[8:11], s36 offen sc1
  v_mfma_f32_16x16x32_bf16 v[72:75], v[120:123], v[28:31], v[72:75]
  ds_read_b64_tr_b16 v[46:47], v11 offset:4608
  v_add_u32 v11, s42, v11
  s_barrier
  s_waitcnt vmcnt(13) lgkmcnt(6)
  v_mfma_f32_16x16x32_bf16 v[48:51], v[128:131], v[32:35], v[48:51]
  ds_read_b64_tr_b16 v[16:17], v8 offset:0
  s_bitcmp1_b32 s48, 4
  s_cselect_b32 s36, s50, s49
  s_waitcnt vmcnt(12)
  v_mfma_f32_16x16x32_bf16 v[52:55], v[132:135], v[32:35], v[52:55]
  ds_read_b64_tr_b16 v[18:19], v8 offset:512
  s_add_u32 s36, s36, 32768
  s_add_u32 s40, s43, 8192
  s_waitcnt lgkmcnt(6)
  v_mfma_f32_16x16x32_bf16 v[60:63], v[132:135], v[36:39], v[60:63]
  ds_read_b64_tr_b16 v[20:21], v9 offset:0
  s_cmp_eq_u32 s40, 65536
  s_cselect_b32 s40, 0, s40
  v_mfma_f32_16x16x32_bf16 v[56:59], v[128:131], v[36:39], v[56:59]
  ds_read_b64_tr_b16 v[22:23], v9 offset:512
  s_sub_u32 s42, s40, s43
  s_mov_b32 s43, s40
  s_waitcnt lgkmcnt(6)
  v_mfma_f32_16x16x32_bf16 v[64:67], v[128:131], v[40:43], v[64:67]
  ds_read_b64_tr_b16 v[24:25], v10 offset:0
  buffer_load_dwordx4 v[120:123], v88, s[8:11], s36 offen sc1
  v_mfma_f32_16x16x32_bf16 v[68:71], v[132:135], v[40:43], v[68:71]
  ds_read_b64_tr_b16 v[26:27], v10 offset:512
  s_waitcnt lgkmcnt(6)
  v_mfma_f32_16x16x32_bf16 v[76:79], v[132:135], v[44:47], v[76:79]
  ds_read_b64_tr_b16 v[28:29], v11 offset:0
  v_mfma_f32_16x16x32_bf16 v[72:75], v[128:131], v[44:47], v[72:75]
  ds_read_b64_tr_b16 v[30:31], v11 offset:512
  buffer_load_dwordx4 v[124:127], v89, s[8:11], s36 offen sc1
  s_waitcnt vmcnt(13) lgkmcnt(6)
  v_mfma_f32_16x16x32_bf16 v[48:51], v[136:139], v[16:19], v[48:51]
  ds_read_b64_tr_b16 v[32:33], v8 offset:4096
  s_waitcnt vmcnt(12)
  v_mfma_f32_16x16x32_bf16 v[52:55], v[140:143], v[16:19], v[52:55]
  ds_read_b64_tr_b16 v[34:35], v8 offset:4608
  v_add_u32 v8, s42, v8
  s_waitcnt lgkmcnt(6)
  v_mfma_f32_16x16x32_bf16 v[60:63], v[140:143], v[20:23], v[60:63]
  ds_read_b64_tr_b16 v[36:37], v9 offset:4096
  buffer_load_dwordx4 v[128:131], v90, s[8:11], s36 offen sc1
  v_mfma_f32_16x16x32_bf16 v[56:59], v[136:139], v[20:23], v[56:59]
  ds_read_b64_tr_b16 v[38:39], v9 offset:4608
  v_add_u32 v9, s42, v9
  s_waitcnt lgkmcnt(6)
  v_mfma_f32_16x16x32_bf16 v[64:67], v[136:139], v[24:27], v[64:67]
  ds_read_b64_tr_b16 v[40:41], v10 offset:4096
  v_mfma_f32_16x16x32_bf16 v[68:71], v[140:143], v[24:27], v[68:71]
  ds_read_b64_tr_b16 v[42:43], v10 offset:4608
  v_add_u32 v10, s42, v10
  s_waitcnt lgkmcnt(6)
  v_mfma_f32_16x16x32_bf16 v[76:79], v[140:143], v[28:31], v[76:79]
  ds_read_b64_tr_b16 v[44:45], v11 offset:4096
  buffer_load_dwordx4 v[132:135], v91, s[8:11], s36 offen sc1
  v_mfma_f32_16x16x32_bf16 v[72:75], v[136:139], v[28:31], v[72:75]
  ds_read_b64_tr_b16 v[46:47], v11 offset:4608
  v_add_u32 v11, s42, v11
  s_barrier
  s_waitcnt vmcnt(13) lgkmcnt(6)
  v_mfma_f32_16x16x32_bf16 v[48:51], v[144:147], v[32:35], v[48:51]
  ds_read_b64_tr_b16 v[16:17], v8 offset:0
  s_bitcmp1_b32 s48, 5
  s_cselect_b32 s36, s50, s49
  s_waitcnt vmcnt(12)
  v_mfma_f32_16x16x32_bf16 v[52:55], v[148:151], v[32:35], v[52:55]
  ds_read_b64_tr_b16 v[18:19], v8 offset:512
  s_add_u32 s36, s36, 40960
  s_add_u32 s40, s43, 8192
  s_waitcnt lgkmcnt(6)
  v_mfma_f32_16x16x32_bf16 v[60:63], v[148:151], v[36:39], v[60:63]
  ds_read_b64_tr_b16 v[20:21], v9 offset:0
  s_cmp_eq_u32 s40, 65536
  s_cselect_b32 s40, 0, s40
  v_mfma_f32_16x16x32_bf16 v[56:59], v[144:147], v[36:39], v[56:59]
  ds_read_b64_tr_b16 v[22:23], v9 offset:512
  s_sub_u32 s42, s40, s43
  s_mov_b32 s43, s40
  s_waitcnt lgkmcnt(6)
  v_mfma_f32_16x16x32_bf16 v[64:67], v[144:147], v[40:43], v[64:67]
  ds_read_b64_tr_b16 v[24:25], v10 offset:0
  buffer_load_dwordx4 v[136:139], v88, s[8:11], s36 offen sc1
  v_mfma_f32_16x16x32_bf16 v[68:71], v[148:151], v[40:43], v[68:71]
  ds_read_b64_tr_b16 v[26:27], v10 offset:512
  s_waitcnt lgkmcnt(6)
  v_mfma_f32_16x16x32_bf16 v[76:79], v[148:151], v[44:47], v[76:79]
  ds_read_b64_tr_b16 v[28:29], v11 offset:0
  v_mfma_f32_16x16x32_bf16 v[72:75], v[144:147], v[44:47], v[72:75]
  ds_read_b64_tr_b16 v[30:31], v11 offset:512
  buffer_load_dwordx4 v[140:143], v89, s[8:11], s36 offen sc1
  s_waitcnt vmcnt(13) lgkmcnt(6)
  v_mfma_f32_16x16x32_bf16 v[48:51], v[152:155], v[16:19], v[48:51]
  ds_read_b64_tr_b16 v[32:33], v8 offset:4096
  s_waitcnt vmcnt(12)
  v_mfma_f32_16x16x32_bf16 v[52:55], v[156:159], v[16:19], v[52:55]
  ds_read_b64_tr_b16 v[34:35], v8 offset:4608
  v_add_u32 v8, s42, v8
  s_waitcnt lgkmcnt(6)
  v_mfma_f32_16x16x32_bf16 v[60:63], v[156:159], v[20:23], v[60:63]
  ds_read_b64_tr_b16 v[36:37], v9 offset:4096
  buffer_load_dwordx4 v[144:147], v90, s[8:11], s36 offen sc1
  v_mfma_f32_16x16x32_bf16 v[56:59], v[152:155], v[20:23], v[56:59]
  ds_read_b64_tr_b16 v[38:39], v9 offset:4608
  v_add_u32 v9, s42, v9
  s_waitcnt lgkmcnt(6)
  v_mfma_f32_16x16x32_bf16 v[64:67], v[152:155], v[24:27], v[64:67]
  ds_read_b64_tr_b16 v[40:41], v10 offset:4096
  v_mfma_f32_16x16x32_bf16 v[68:71], v[156:159], v[24:27], v[68:71]
  ds_read_b64_tr_b16 v[42:43], v10 offset:4608
  v_add_u32 v10, s42, v10
  s_waitcnt lgkmcnt(6)
  v_mfma_f32_16x16x32_bf16 v[76:79], v[156:159], v[28:31], v[76:79]
  ds_read_b64_tr_b16 v[44:45], v11 offset:4096
  buffer_load_dwordx4 v[148:151], v91, s[8:11], s36 offen sc1
  v_mfma_f32_16x16x32_bf16 v[72:75], v[152:155], v[28:31], v[72:75]
  ds_read_b64_tr_b16 v[46:47], v11 offset:4608
  v_add_u32 v11, s42, v11
  s_barrier
  s_waitcnt vmcnt(13) lgkmcnt(6)
  v_mfma_f32_16x16x32_bf16 v[48:51], v[160:163], v[32:35], v[48:51]
  ds_read_b64_tr_b16 v[16:17], v8 offset:0
  s_bitcmp1_b32 s48, 6
  s_cselect_b32 s36, s50, s49
  s_waitcnt vmcnt(12)
  v_mfma_f32_16x16x32_bf16 v[52:55], v[164:167], v[32:35], v[52:55]
  ds_read_b64_tr_b16 v[18:19], v8 offset:512
  s_add_u32 s36, s36, 49152
  s_add_u32 s40, s43, 8192
  s_waitcnt lgkmcnt(6)
  v_mfma_f32_16x16x32_bf16 v[60:63], v[164:167], v[36:39], v[60:63]
  ds_read_b64_tr_b16 v[20:21], v9 offset:0
  s_cmp_eq_u32 s40, 65536
  s_cselect_b32 s40, 0, s40
  v_mfma_f32_16x16x32_bf16 v[56:59], v[160:163], v[36:39], v[56:59]
  ds_read_b64_tr_b16 v[22:23], v9 offset:512
  s_sub_u32 s42, s40, s43
  s_mov_b32 s43, s40
  s_waitcnt lgkmcnt(6)
  v_mfma_f32_16x16x32_bf16 v[64:67], v[160:163], v[40:43], v[64:67]
  ds_read_b64_tr_b16 v[24:25], v10 offset:0
  buffer_load_dwordx4 v[152:155], v88, s[8:11], s36 offen sc1
  v_mfma_f32_16x16x32_bf16 v[68:71], v[164:167], v[40:43], v[68:71]
  ds_read_b64_tr_b16 v[26:27], v10 offset:512
  s_waitcnt lgkmcnt(6)
  v_mfma_f32_16x16x32_bf16 v[76:79], v[164:167], v[44:47], v[76:79]
  ds_read_b64_tr_b16 v[28:29], v11 offset:0
  v_mfma_f32_16x16x32_bf16 v[72:75], v[160:163], v[44:47], v[72:75]
  ds_read_b64_tr_b16 v[30:31], v11 offset:512
  buffer_load_dwordx4 v[156:159], v89, s[8:11], s36 offen sc1
  s_waitcnt vmcnt(13) lgkmcnt(6)
  v_mfma_f32_16x16x32_bf16 v[48:51], v[168:171], v[16:19], v[48:51]
  ds_read_b64_tr_b16 v[32:33], v8 offset:4096
  s_waitcnt vmcnt(12)
  v_mfma_f32_16x16x32_bf16 v[52:55], v[172:175], v[16:19], v[52:55]
  ds_read_b64_tr_b16 v[34:35], v8 offset:4608
  v_add_u32 v8, s42, v8
  s_waitcnt lgkmcnt(6)
  v_mfma_f32_16x16x32_bf16 v[60:63], v[172:175], v[20:23], v[60:63]
  ds_read_b64_tr_b16 v[36:37], v9 offset:4096
  buffer_load_dwordx4 v[160:163], v90, s[8:11], s36 offen sc1
  v_mfma_f32_16x16x32_bf16 v[56:59], v[168:171], v[20:23], v[56:59]
  ds_read_b64_tr_b16 v[38:39], v9 offset:4608
  v_add_u32 v9, s42, v9
  s_waitcnt lgkmcnt(6)
  v_mfma_f32_16x16x32_bf16 v[64:67], v[168:171], v[24:27], v[64:67]
  ds_read_b64_tr_b16 v[40:41], v10 offset:4096
  v_mfma_f32_16x16x32_bf16 v[68:71], v[172:175], v[24:27], v[68:71]
  ds_read_b64_tr_b16 v[42:43], v10 offset:4608
  v_add_u32 v10, s42, v10
  s_waitcnt lgkmcnt(6)
  v_mfma_f32_16x16x32_bf16 v[76:79], v[172:175], v[28:31], v[76:79]
  ds_read_b64_tr_b16 v[44:45], v11 offset:4096
  buffer_load_dwordx4 v[164:167], v91, s[8:11], s36 offen sc1
  v_mfma_f32_16x16x32_bf16 v[72:75], v[168:171], v[28:31], v[72:75]
  ds_read_b64_tr_b16 v[46:47], v11 offset:4608
  v_add_u32 v11, s42, v11
  s_barrier
  s_waitcnt vmcnt(13) lgkmcnt(6)
  v_mfma_f32_16x16x32_bf16 v[48:51], v[176:179], v[32:35], v[48:51]
  ds_read_b64_tr_b16 v[16:17], v8 offset:0
  s_bitcmp1_b32 s48, 7
  s_cselect_b32 s36, s50, s49
  s_waitcnt vmcnt(12)
  v_mfma_f32_16x16x32_bf16 v[52:55], v[180:183], v[32:35], v[52:55]
  ds_read_b64_tr_b16 v[18:19], v8 offset:512
  s_add_u32 s36, s36, 57344
  s_add_u32 s40, s43, 8192
  s_waitcnt lgkmcnt(6)
  v_mfma_f32_16x16x32_bf16 v[60:63], v[180:183], v[36:39], v[60:63]
  ds_read_b64_tr_b16 v[20:21], v9 offset:0
  s_cmp_eq_u32 s40, 65536
  s_cselect_b32 s40, 0, s40
  v_mfma_f32_16x16x32_bf16 v[56:59], v[176:179], v[36:39], v[56:59]
  ds_read_b64_tr_b16 v[22:23], v9 offset:512
  s_sub_u32 s42, s40, s43
  s_mov_b32 s43, s40
  s_waitcnt lgkmcnt(6)
  v_mfma_f32_16x16x32_bf16 v[64:67], v[176:179], v[40:43], v[64:67]
  ds_read_b64_tr_b16 v[24:25], v10 offset:0
  buffer_load_dwordx4 v[168:171], v88, s[8:11], s36 offen sc1
  v_mfma_f32_16x16x32_bf16 v[68:71], v[180:183], v[40:43], v[68:71]
  ds_read_b64_tr_b16 v[26:27], v10 offset:512
  s_waitcnt lgkmcnt(6)
  v_mfma_f32_16x16x32_bf16 v[76:79], v[180:183], v[44:47], v[76:79]
  ds_read_b64_tr_b16 v[28:29], v11 offset:0
  v_mfma_f32_16x16x32_bf16 v[72:75], v[176:179], v[44:47], v[72:75]
  ds_read_b64_tr_b16 v[30:31], v11 offset:512
  buffer_load_dwordx4 v[172:175], v89, s[8:11], s36 offen sc1
  s_waitcnt vmcnt(13) lgkmcnt(6)
  v_mfma_f32_16x16x32_bf16 v[48:51], v[120:123], v[16:19], v[48:51]
  ds_read_b64_tr_b16 v[32:33], v8 offset:4096
  s_waitcnt vmcnt(12)
  v_mfma_f32_16x16x32_bf16 v[52:55], v[124:127], v[16:19], v[52:55]
  ds_read_b64_tr_b16 v[34:35], v8 offset:4608
  v_add_u32 v8, s42, v8
  s_waitcnt lgkmcnt(6)
  v_mfma_f32_16x16x32_bf16 v[60:63], v[124:127], v[20:23], v[60:63]
  ds_read_b64_tr_b16 v[36:37], v9 offset:4096
  buffer_load_dwordx4 v[176:179], v90, s[8:11], s36 offen sc1
  v_mfma_f32_16x16x32_bf16 v[56:59], v[120:123], v[20:23], v[56:59]
  ds_read_b64_tr_b16 v[38:39], v9 offset:4608
  v_add_u32 v9, s42, v9
  s_waitcnt lgkmcnt(6)
  v_mfma_f32_16x16x32_bf16 v[64:67], v[120:123], v[24:27], v[64:67]
  ds_read_b64_tr_b16 v[40:41], v10 offset:4096
  v_mfma_f32_16x16x32_bf16 v[68:71], v[124:127], v[24:27], v[68:71]
  ds_read_b64_tr_b16 v[42:43], v10 offset:4608
  v_add_u32 v10, s42, v10
  s_waitcnt lgkmcnt(6)
  v_mfma_f32_16x16x32_bf16 v[76:79], v[124:127], v[28:31], v[76:79]
  ds_read_b64_tr_b16 v[44:45], v11 offset:4096
  buffer_load_dwordx4 v[180:183], v91, s[8:11], s36 offen sc1
  v_mfma_f32_16x16x32_bf16 v[72:75], v[120:123], v[28:31], v[72:75]
  ds_read_b64_tr_b16 v[46:47], v11 offset:4608
  v_add_u32 v11, s42, v11
  s_barrier
  s_waitcnt vmcnt(13) lgkmcnt(6)
  v_mfma_f32_16x16x32_bf16 v[48:51], v[128:131], v[32:35], v[48:51]
  ds_read_b64_tr_b16 v[16:17], v8 offset:0
  s_mov_b32 s49, s50
  s_add_u32 s50, s50, 65536
  s_waitcnt vmcnt(12)
  v_mfma_f32_16x16x32_bf16 v[52:55], v[132:135], v[32:35], v[52:55]
  ds_read_b64_tr_b16 v[18:19], v8 offset:512
  s_cmp_eq_u32 s50, s41
  s_cselect_b32 s50, s34, s50
  s_waitcnt lgkmcnt(6)
  v_mfma_f32_16x16x32_bf16 v[60:63], v[132:135], v[36:39], v[60:63]
  ds_read_b64_tr_b16 v[20:21], v9 offset:0
  s_bitcmp1_b32 s48, 0
  s_cselect_b32 s36, s50, s49
  v_mfma_f32_16x16x32_bf16 v[56:59], v[128:131], v[36:39], v[56:59]
  ds_read_b64_tr_b16 v[22:23], v9 offset:512
  s_add_u32 s36, s36, 0
  s_add_u32 s40, s43, 8192
  s_waitcnt lgkmcnt(6)
  v_mfma_f32_16x16x32_bf16 v[64:67], v[128:131], v[40:43], v[64:67]
  ds_read_b64_tr_b16 v[24:25], v10 offset:0
  s_cmp_eq_u32 s40, 65536
  s_cselect_b32 s40, 0, s40
  buffer_load_dwordx4 v[120:123], v88, s[8:11], s36 offen sc1
  v_mfma_f32_16x16x32_bf16 v[68:71], v[132:135], v[40:43], v[68:71]
  ds_read_b64_tr_b16 v[26:27], v10 offset:512
  s_sub_u32 s42, s40, s43
  s_mov_b32 s43, s40
  s_waitcnt lgkmcnt(6)
  v_mfma_f32_16x16x32_bf16 v[76:79], v[132:135], v[44:47], v[76:79]
  ds_read_b64_tr_b16 v[28:29], v11 offset:0
  v_mfma_f32_16x16x32_bf16 v[72:75], v[128:131], v[44:47], v[72:75]
  ds_read_b64_tr_b16 v[30:31], v11 offset:512
  buffer_load_dwordx4 v[124:127], v89, s[8:11], s36 offen sc1
  s_waitcnt vmcnt(13) lgkmcnt(6)
  v_mfma_f32_16x16x32_bf16 v[48:51], v[136:139], v[16:19], v[48:51]
  ds_read_b64_tr_b16 v[32:33], v8 offset:4096
  s_waitcnt vmcnt(12)
  v_mfma_f32_16x16x32_bf16 v[52:55], v[140:143], v[16:19], v[52:55]
  ds_read_b64_tr_b16 v[34:35], v8 offset:4608
  v_add_u32 v8, s42, v8
  s_waitcnt lgkmcnt(6)
  v_mfma_f32_16x16x32_bf16 v[60:63], v[140:143], v[20:23], v[60:63]
  ds_read_b64_tr_b16 v[36:37], v9 offset:4096
  buffer_load_dwordx4 v[128:131], v90, s[8:11], s36 offen sc1
  v_mfma_f32_16x16x32_bf16 v[56:59], v[136:139], v[20:23], v[56:59]
  ds_read_b64_tr_b16 v[38:39], v9 offset:4608
  v_add_u32 v9, s42, v9
  s_waitcnt lgkmcnt(6)
  v_mfma_f32_16x16x32_bf16 v[64:67], v[136:139], v[24:27], v[64:67]
  ds_read_b64_tr_b16 v[40:41], v10 offset:4096
  v_mfma_f32_16x16x32_bf16 v[68:71], v[140:143], v[24:27], v[68:71]
  ds_read_b64_tr_b16 v[42:43], v10 offset:4608
  v_add_u32 v10, s42, v10
  s_waitcnt lgkmcnt(6)
  v_mfma_f32_16x16x32_bf16 v[76:79], v[140:143], v[28:31], v[76:79]
  ds_read_b64_tr_b16 v[44:45], v11 offset:4096
  buffer_load_dwordx4 v[132:135], v91, s[8:11], s36 offen sc1
  v_mfma_f32_16x16x32_bf16 v[72:75], v[136:139], v[28:31], v[72:75]
  ds_read_b64_tr_b16 v[46:47], v11 offset:4608
  v_add_u32 v11, s42, v11
  s_barrier
  s_waitcnt vmcnt(13) lgkmcnt(6)
  v_mfma_f32_16x16x32_bf16 v[48:51], v[144:147], v[32:35], v[48:51]
  ds_read_b64_tr_b16 v[16:17], v8 offset:0
  s_bitcmp1_b32 s48, 1
  s_cselect_b32 s36, s50, s49
  s_waitcnt vmcnt(12)
  v_mfma_f32_16x16x32_bf16 v[52:55], v[148:151], v[32:35], v[52:55]
  ds_read_b64_tr_b16 v[18:19], v8 offset:512
  s_add_u32 s36, s36, 8192
  s_add_u32 s40, s43, 8192
  s_waitcnt lgkmcnt(6)
  v_mfma_f32_16x16x32_bf16 v[60:63], v[148:151], v[36:39], v[60:63]
  ds_read_b64_tr_b16 v[20:21], v9 offset:0
  s_cmp_eq_u32 s40, 65536
  s_cselect_b32 s40, 0, s40
  v_mfma_f32_16x16x32_bf16 v[56:59], v[144:147], v[36:39], v[56:59]
  ds_read_b64_tr_b16 v[22:23], v9 offset:512
  s_sub_u32 s42, s40, s43
  s_mov_b32 s43, s40
  s_waitcnt lgkmcnt(6)
  v_mfma_f32_16x16x32_bf16 v[64:67], v[144:147], v[40:43], v[64:67]
  ds_read_b64_tr_b16 v[24:25], v10 offset:0
  buffer_load_dwordx4 v[136:139], v88, s[8:11], s36 offen sc1
  v_mfma_f32_16x16x32_bf16 v[68:71], v[148:151], v[40:43], v[68:71]
  ds_read_b64_tr_b16 v[26:27], v10 offset:512
  s_waitcnt lgkmcnt(6)
  v_mfma_f32_16x16x32_bf16 v[76:79], v[148:151], v[44:47], v[76:79]
  ds_read_b64_tr_b16 v[28:29], v11 offset:0
  v_mfma_f32_16x16x32_bf16 v[72:75], v[144:147], v[44:47], v[72:75]
  ds_read_b64_tr_b16 v[30:31], v11 offset:512
  buffer_load_dwordx4 v[140:143], v89, s[8:11], s36 offen sc1
  s_waitcnt vmcnt(13) lgkmcnt(6)
  v_mfma_f32_16x16x32_bf16 v[48:51], v[152:155], v[16:19], v[48:51]
  ds_read_b64_tr_b16 v[32:33], v8 offset:4096
  s_waitcnt vmcnt(12)
  v_mfma_f32_16x16x32_bf16 v[52:55], v[156:159], v[16:19], v[52:55]
  ds_read_b64_tr_b16 v[34:35], v8 offset:4608
  v_add_u32 v8, s42, v8
  s_waitcnt lgkmcnt(6)
  v_mfma_f32_16x16x32_bf16 v[60:63], v[156:159], v[20:23], v[60:63]
  ds_read_b64_tr_b16 v[36:37], v9 offset:4096
  buffer_load_dwordx4 v[144:147], v90, s[8:11], s36 offen sc1
  v_mfma_f32_16x16x32_bf16 v[56:59], v[152:155], v[20:23], v[56:59]
  ds_read_b64_tr_b16 v[38:39], v9 offset:4608
  v_add_u32 v9, s42, v9
  s_waitcnt lgkmcnt(6)
  v_mfma_f32_16x16x32_bf16 v[64:67], v[152:155], v[24:27], v[64:67]
  ds_read_b64_tr_b16 v[40:41], v10 offset:4096
  v_mfma_f32_16x16x32_bf16 v[68:71], v[156:159], v[24:27], v[68:71]
  ds_read_b64_tr_b16 v[42:43], v10 offset:4608
  v_add_u32 v10, s42, v10
  s_waitcnt lgkmcnt(6)
  v_mfma_f32_16x16x32_bf16 v[76:79], v[156:159], v[28:31], v[76:79]
  ds_read_b64_tr_b16 v[44:45], v11 offset:4096
  buffer_load_dwordx4 v[148:151], v91, s[8:11], s36 offen sc1
  v_mfma_f32_16x16x32_bf16 v[72:75], v[152:155], v[28:31], v[72:75]
  ds_read_b64_tr_b16 v[46:47], v11 offset:4608
  v_add_u32 v11, s42, v11
  s_barrier
  s_waitcnt vmcnt(13) lgkmcnt(6)
  v_mfma_f32_16x16x32_bf16 v[48:51], v[160:163], v[32:35], v[48:51]
  ds_read_b64_tr_b16 v[16:17], v8 offset:0
  s_bitcmp1_b32 s48, 2
  s_cselect_b32 s36, s50, s49
  s_waitcnt vmcnt(12)
  v_mfma_f32_16x16x32_bf16 v[52:55], v[164:167], v[32:35], v[52:55]
  ds_read_b64_tr_b16 v[18:19], v8 offset:512
  s_add_u32 s36, s36, 16384
  s_add_u32 s40, s43, 8192
  s_waitcnt lgkmcnt(6)
  v_mfma_f32_16x16x32_bf16 v[60:63], v[164:167], v[36:39], v[60:63]
  ds_read_b64_tr_b16 v[20:21], v9 offset:0
  s_cmp_eq_u32 s40, 65536
  s_cselect_b32 s40, 0, s40
  v_mfma_f32_16x16x32_bf16 v[56:59], v[160:163], v[36:39], v[56:59]
  ds_read_b64_tr_b16 v[22:23], v9 offset:512
  s_sub_u32 s42, s40, s43
  s_mov_b32 s43, s40
  s_waitcnt lgkmcnt(6)
  v_mfma_f32_16x16x32_bf16 v[64:67], v[160:163], v[40:43], v[64:67]
  ds_read_b64_tr_b16 v[24:25], v10 offset:0
  buffer_load_dwordx4 v[152:155], v88, s[8:11], s36 offen sc1
  v_mfma_f32_16x16x32_bf16 v[68:71], v[164:167], v[40:43], v[68:71]
  ds_read_b64_tr_b16 v[26:27], v10 offset:512
  s_waitcnt lgkmcnt(6)
  v_mfma_f32_16x16x32_bf16 v[76:79], v[164:167], v[44:47], v[76:79]
  ds_read_b64_tr_b16 v[28:29], v11 offset:0
  v_mfma_f32_16x16x32_bf16 v[72:75], v[160:163], v[44:47], v[72:75]
  ds_read_b64_tr_b16 v[30:31], v11 offset:512
  buffer_load_dwordx4 v[156:159], v89, s[8:11], s36 offen sc1
  s_waitcnt vmcnt(13) lgkmcnt(6)
  v_mfma_f32_16x16x32_bf16 v[48:51], v[168:171], v[16:19], v[48:51]
  ds_read_b64_tr_b16 v[32:33], v8 offset:4096
  s_waitcnt vmcnt(12)
  v_mfma_f32_16x16x32_bf16 v[52:55], v[172:175], v[16:19], v[52:55]
  ds_read_b64_tr_b16 v[34:35], v8 offset:4608
  v_add_u32 v8, s42, v8
  s_waitcnt lgkmcnt(6)
  v_mfma_f32_16x16x32_bf16 v[60:63], v[172:175], v[20:23], v[60:63]
  ds_read_b64_tr_b16 v[36:37], v9 offset:4096
  buffer_load_dwordx4 v[160:163], v90, s[8:11], s36 offen sc1
  v_mfma_f32_16x16x32_bf16 v[56:59], v[168:171], v[20:23], v[56:59]
  ds_read_b64_tr_b16 v[38:39], v9 offset:4608
  v_add_u32 v9, s42, v9
  s_waitcnt lgkmcnt(6)
  v_mfma_f32_16x16x32_bf16 v[64:67], v[168:171], v[24:27], v[64:67]
  ds_read_b64_tr_b16 v[40:41], v10 offset:4096
  v_mfma_f32_16x16x32_bf16 v[68:71], v[172:175], v[24:27], v[68:71]
  ds_read_b64_tr_b16 v[42:43], v10 offset:4608
  v_add_u32 v10, s42, v10
  s_waitcnt lgkmcnt(6)
  v_mfma_f32_16x16x32_bf16 v[76:79], v[172:175], v[28:31], v[76:79]
  ds_read_b64_tr_b16 v[44:45], v11 offset:4096
  buffer_load_dwordx4 v[164:167], v91, s[8:11], s36 offen sc1
  v_mfma_f32_16x16x32_bf16 v[72:75], v[168:171], v[28:31], v[72:75]
  ds_read_b64_tr_b16 v[46:47], v11 offset:4608
  v_add_u32 v11, s42, v11
  s_barrier
  s_waitcnt vmcnt(13) lgkmcnt(6)
  v_mfma_f32_16x16x32_bf16 v[48:51], v[176:179], v[32:35], v[48:51]
  ds_read_b64_tr_b16 v[16:17], v8 offset:0
  s_bitcmp1_b32 s48, 3
  s_cselect_b32 s36, s50, s49
  s_waitcnt vmcnt(12)
  v_mfma_f32_16x16x32_bf16 v[52:55], v[180:183], v[32:35], v[52:55]
  ds_read_b64_tr_b16 v[18:19], v8 offset:512
  s_add_u32 s36, s36, 24576
  s_add_u32 s40, s43, 8192
  s_waitcnt lgkmcnt(6)
  v_mfma_f32_16x16x32_bf16 v[60:63], v[180:183], v[36:39], v[60:63]
  ds_read_b64_tr_b16 v[20:21], v9 offset:0
  s_cmp_eq_u32 s40, 65536
  s_cselect_b32 s40, 0, s40
  v_mfma_f32_16x16x32_bf16 v[56:59], v[176:179], v[36:39], v[56:59]
  ds_read_b64_tr_b16 v[22:23], v9 offset:512
  s_sub_u32 s42, s40, s43
  s_mov_b32 s43, s40
  s_waitcnt lgkmcnt(6)
  v_mfma_f32_16x16x32_bf16 v[64:67], v[176:179], v[40:43], v[64:67]
  ds_read_b64_tr_b16 v[24:25], v10 offset:0
  buffer_load_dwordx4 v[168:171], v88, s[8:11], s36 offen sc1
  v_mfma_f32_16x16x32_bf16 v[68:71], v[180:183], v[40:43], v[68:71]
  ds_read_b64_tr_b16 v[26:27], v10 offset:512
  s_waitcnt lgkmcnt(6)
  v_mfma_f32_16x16x32_bf16 v[76:79], v[180:183], v[44:47], v[76:79]
  ds_read_b64_tr_b16 v[28:29], v11 offset:0
  v_mfma_f32_16x16x32_bf16 v[72:75], v[176:179], v[44:47], v[72:75]
  ds_read_b64_tr_b16 v[30:31], v11 offset:512
  buffer_load_dwordx4 v[172:175], v89, s[8:11], s36 offen sc1
  s_sub_u32 s39, s39, 1
  s_cmp_lg_u32 s39, 0
  s_cbranch_scc1 cd6
  s_waitcnt vmcnt(13) lgkmcnt(6)
  v_mfma_f32_16x16x32_bf16 v[48:51], v[120:123], v[16:19], v[48:51]
  ds_read_b64_tr_b16 v[32:33], v8 offset:4096
  s_waitcnt vmcnt(12)
  v_mfma_f32_16x16x32_bf16 v[52:55], v[124:127], v[16:19], v[52:55]
  ds_read_b64_tr_b16 v[34:35], v8 offset:4608
  v_add_u32 v8, s42, v8
  s_waitcnt lgkmcnt(6)
  v_mfma_f32_16x16x32_bf16 v[60:63], v[124:127], v[20:23], v[60:63]
  ds_read_b64_tr_b16 v[36:37], v9 offset:4096
  buffer_load_dwordx4 v[176:179], v90, s[8:11], s36 offen sc1
  v_mfma_f32_16x16x32_bf16 v[56:59], v[120:123], v[20:23], v[56:59]
  ds_read_b64_tr_b16 v[38:39], v9 offset:4608
  v_add_u32 v9, s42, v9
  s_waitcnt lgkmcnt(6)
  v_mfma_f32_16x16x32_bf16 v[64:67], v[120:123], v[24:27], v[64:67]
  ds_read_b64_tr_b16 v[40:41], v10 offset:4096
  v_mfma_f32_16x16x32_bf16 v[68:71], v[124:127], v[24:27], v[68:71]
  ds_read_b64_tr_b16 v[42:43], v10 offset:4608
  v_add_u32 v10, s42, v10
  s_waitcnt lgkmcnt(6)
  v_mfma_f32_16x16x32_bf16 v[76:79], v[124:127], v[28:31], v[76:79]
  ds_read_b64_tr_b16 v[44:45], v11 offset:4096
  buffer_load_dwordx4 v[180:183], v91, s[8:11], s36 offen sc1
  v_mfma_f32_16x16x32_bf16 v[72:75], v[120:123], v[28:31], v[72:75]
  ds_read_b64_tr_b16 v[46:47], v11 offset:4608
  v_add_u32 v11, s42, v11
  s_barrier
  s_waitcnt vmcnt(13) lgkmcnt(6)
  v_mfma_f32_16x16x32_bf16 v[48:51], v[128:131], v[32:35], v[48:51]
  ds_read_b64_tr_b16 v[16:17], v8 offset:0
  s_bitcmp1_b32 s48, 4
  s_cselect_b32 s36, s50, s49
  s_waitcnt vmcnt(12)
  v_mfma_f32_16x16x32_bf16 v[52:55], v[132:135], v[32:35], v[52:55]
  ds_read_b64_tr_b16 v[18:19], v8 offset:512
  s_add_u32 s36, s36, 32768
  s_add_u32 s40, s43, 8192
  s_waitcnt lgkmcnt(6)
  v_mfma_f32_16x16x32_bf16 v[60:63], v[132:135], v[36:39], v[60:63]
  ds_read_b64_tr_b16 v[20:21], v9 offset:0
  s_cmp_eq_u32 s40, 65536
  s_cselect_b32 s40, 0, s40
  v_mfma_f32_16x16x32_bf16 v[56:59], v[128:131], v[36:39], v[56:59]
  ds_read_b64_tr_b16 v[22:23], v9 offset:512
  s_sub_u32 s42, s40, s43
  s_mov_b32 s43, s40
  s_waitcnt lgkmcnt(6)
  v_mfma_f32_16x16x32_bf16 v[64:67], v[128:131], v[40:43], v[64:67]
  ds_read_b64_tr_b16 v[24:25], v10 offset:0
  buffer_load_dwordx4 v[120:123], v88, s[8:11], s36 offen sc1
  v_mfma_f32_16x16x32_bf16 v[68:71], v[132:135], v[40:43], v[68:71]
  ds_read_b64_tr_b16 v[26:27], v10 offset:512
  s_waitcnt lgkmcnt(6)
  v_mfma_f32_16x16x32_bf16 v[76:79], v[132:135], v[44:47], v[76:79]
  ds_read_b64_tr_b16 v[28:29], v11 offset:0
  v_mfma_f32_16x16x32_bf16 v[72:75], v[128:131], v[44:47], v[72:75]
  ds_read_b64_tr_b16 v[30:31], v11 offset:512
  buffer_load_dwordx4 v[124:127], v89, s[8:11], s36 offen sc1
  s_waitcnt vmcnt(13) lgkmcnt(6)
  v_mfma_f32_16x16x32_bf16 v[48:51], v[136:139], v[16:19], v[48:51]
  ds_read_b64_tr_b16 v[32:33], v8 offset:4096
  s_waitcnt vmcnt(12)
  v_mfma_f32_16x16x32_bf16 v[52:55], v[140:143], v[16:19], v[52:55]
  ds_read_b64_tr_b16 v[34:35], v8 offset:4608
  v_add_u32 v8, s42, v8
  s_waitcnt lgkmcnt(6)
  v_mfma_f32_16x16x32_bf16 v[60:63], v[140:143], v[20:23], v[60:63]
  ds_read_b64_tr_b16 v[36:37], v9 offset:4096
  buffer_load_dwordx4 v[128:131], v90, s[8:11], s36 offen sc1
  v_mfma_f32_16x16x32_bf16 v[56:59], v[136:139], v[20:23], v[56:59]
  ds_read_b64_tr_b16 v[38:39], v9 offset:4608
  v_add_u32 v9, s42, v9
  s_waitcnt lgkmcnt(6)
  v_mfma_f32_16x16x32_bf16 v[64:67], v[136:139], v[24:27], v[64:67]
  ds_read_b64_tr_b16 v[40:41], v10 offset:4096
  v_mfma_f32_16x16x32_bf16 v[68:71], v[140:143], v[24:27], v[68:71]
  ds_read_b64_tr_b16 v[42:43], v10 offset:4608
  v_add_u32 v10, s42, v10
  s_waitcnt lgkmcnt(6)
  v_mfma_f32_16x16x32_bf16 v[76:79], v[140:143], v[28:31], v[76:79]
  ds_read_b64_tr_b16 v[44:45], v11 offset:4096
  buffer_load_dwordx4 v[132:135], v91, s[8:11], s36 offen sc1
  v_mfma_f32_16x16x32_bf16 v[72:75], v[136:139], v[28:31], v[72:75]
  ds_read_b64_tr_b16 v[46:47], v11 offset:4608
  v_add_u32 v11, s42, v11
  s_barrier
  s_waitcnt vmcnt(13) lgkmcnt(6)
  v_mfma_f32_16x16x32_bf16 v[48:51], v[144:147], v[32:35], v[48:51]
  ds_read_b64_tr_b16 v[16:17], v8 offset:0
  s_bitcmp1_b32 s48, 5
  s_cselect_b32 s36, s50, s49
  s_waitcnt vmcnt(12)
  v_mfma_f32_16x16x32_bf16 v[52:55], v[148:151], v[32:35], v[52:55]
  ds_read_b64_tr_b16 v[18:19], v8 offset:512
  s_add_u32 s36, s36, 40960
  s_add_u32 s40, s43, 8192
  s_waitcnt lgkmcnt(6)
  v_mfma_f32_16x16x32_bf16 v[60:63], v[148:151], v[36:39], v[60:63]
  ds_read_b64_tr_b16 v[20:21], v9 offset:0
  s_cmp_eq_u32 s40, 65536
  s_cselect_b32 s40, 0, s40
  v_mfma_f32_16x16x32_bf16 v[56:59], v[144:147], v[36:39], v[56:59]
  ds_read_b64_tr_b16 v[22:23], v9 offset:512
  s_sub_u32 s42, s40, s43
  s_mov_b32 s43, s40
  s_waitcnt lgkmcnt(6)
  v_mfma_f32_16x16x32_bf16 v[64:67], v[144:147], v[40:43], v[64:67]
  ds_read_b64_tr_b16 v[24:25], v10 offset:0
  buffer_load_dwordx4 v[136:139], v88, s[8:11], s36 offen sc1
  v_mfma_f32_16x16x32_bf16 v[68:71], v[148:151], v[40:43], v[68:71]
  ds_read_b64_tr_b16 v[26:27], v10 offset:512
  s_waitcnt lgkmcnt(6)
  v_mfma_f32_16x16x32_bf16 v[76:79], v[148:151], v[44:47], v[76:79]
  ds_read_b64_tr_b16 v[28:29], v11 offset:0
  v_mfma_f32_16x16x32_bf16 v[72:75], v[144:147], v[44:47], v[72:75]
  ds_read_b64_tr_b16 v[30:31], v11 offset:512
  buffer_load_dwordx4 v[140:143], v89, s[8:11], s36 offen sc1
  s_waitcnt vmcnt(13) lgkmcnt(6)
  v_mfma_f32_16x16x32_bf16 v[48:51], v[152:155], v[16:19], v[48:51]
  ds_read_b64_tr_b16 v[32:33], v8 offset:4096
  s_waitcnt vmcnt(12)
  v_mfma_f32_16x16x32_bf16 v[52:55], v[156:159], v[16:19], v[52:55]
  ds_read_b64_tr_b16 v[34:35], v8 offset:4608
  v_add_u32 v8, s42, v8
  s_waitcnt lgkmcnt(6)
  v_mfma_f32_16x16x32_bf16 v[60:63], v[156:159], v[20:23], v[60:63]
  ds_read_b64_tr_b16 v[36:37], v9 offset:4096
  buffer_load_dwordx4 v[144:147], v90, s[8:11], s36 offen sc1
  v_mfma_f32_16x16x32_bf16 v[56:59], v[152:155], v[20:23], v[56:59]
  ds_read_b64_tr_b16 v[38:39], v9 offset:4608
  v_add_u32 v9, s42, v9
  s_waitcnt lgkmcnt(6)
  v_mfma_f32_16x16x32_bf16 v[64:67], v[152:155], v[24:27], v[64:67]
  ds_read_b64_tr_b16 v[40:41], v10 offset:4096
  v_mfma_f32_16x16x32_bf16 v[68:71], v[156:159], v[24:27], v[68:71]
  ds_read_b64_tr_b16 v[42:43], v10 offset:4608
  v_add_u32 v10, s42, v10
  s_waitcnt lgkmcnt(6)
  v_mfma_f32_16x16x32_bf16 v[76:79], v[156:159], v[28:31], v[76:79]
  ds_read_b64_tr_b16 v[44:45], v11 offset:4096
  buffer_load_dwordx4 v[148:151], v91, s[8:11], s36 offen sc1
  v_mfma_f32_16x16x32_bf16 v[72:75], v[152:155], v[28:31], v[72:75]
  ds_read_b64_tr_b16 v[46:47], v11 offset:4608
  v_add_u32 v11, s42, v11
  s_barrier
  s_waitcnt vmcnt(13) lgkmcnt(6)
  v_mfma_f32_16x16x32_bf16 v[48:51], v[160:163], v[32:35], v[48:51]
  ds_read_b64_tr_b16 v[16:17], v8 offset:0
  s_bitcmp1_b32 s48, 6
  s_cselect_b32 s36, s50, s49
  s_waitcnt vmcnt(12)
  v_mfma_f32_16x16x32_bf16 v[52:55], v[164:167], v[32:35], v[52:55]
  ds_read_b64_tr_b16 v[18:19], v8 offset:512
  s_add_u32 s36, s36, 49152
  s_add_u32 s40, s43, 8192
  s_waitcnt lgkmcnt(6)
  v_mfma_f32_16x16x32_bf16 v[60:63], v[164:167], v[36:39], v[60:63]
  ds_read_b64_tr_b16 v[20:21], v9 offset:0
  s_cmp_eq_u32 s40, 65536
  s_cselect_b32 s40, 0, s40
  v_mfma_f32_16x16x32_bf16 v[56:59], v[160:163], v[36:39], v[56:59]
  ds_read_b64_tr_b16 v[22:23], v9 offset:512
  s_sub_u32 s42, s40, s43
  s_mov_b32 s43, s40
  s_waitcnt lgkmcnt(6)
  v_mfma_f32_16x16x32_bf16 v[64:67], v[160:163], v[40:43], v[64:67]
  ds_read_b64_tr_b16 v[24:25], v10 offset:0
  buffer_load_dwordx4 v[152:155], v88, s[8:11], s36 offen sc1
  v_mfma_f32_16x16x32_bf16 v[68:71], v[164:167], v[40:43], v[68:71]
  ds_read_b64_tr_b16 v[26:27], v10 offset:512
  s_waitcnt lgkmcnt(6)
  v_mfma_f32_16x16x32_bf16 v[76:79], v[164:167], v[44:47], v[76:79]
  ds_read_b64_tr_b16 v[28:29], v11 offset:0
  v_mfma_f32_16x16x32_bf16 v[72:75], v[160:163], v[44:47], v[72:75]
  ds_read_b64_tr_b16 v[30:31], v11 offset:512
  buffer_load_dwordx4 v[156:159], v89, s[8:11], s36 offen sc1
  s_waitcnt vmcnt(13) lgkmcnt(6)
  v_mfma_f32_16x16x32_bf16 v[48:51], v[168:171], v[16:19], v[48:51]
  ds_read_b64_tr_b16 v[32:33], v8 offset:4096
  s_waitcnt vmcnt(12)
  v_mfma_f32_16x16x32_bf16 v[52:55], v[172:175], v[16:19], v[52:55]
  ds_read_b64_tr_b16 v[34:35], v8 offset:4608
  v_add_u32 v8, s42, v8
  s_waitcnt lgkmcnt(6)
  v_mfma_f32_16x16x32_bf16 v[60:63], v[172:175], v[20:23], v[60:63]
  ds_read_b64_tr_b16 v[36:37], v9 offset:4096
  buffer_load_dwordx4 v[160:163], v90, s[8:11], s36 offen sc1
  v_mfma_f32_16x16x32_bf16 v[56:59], v[168:171], v[20:23], v[56:59]
  ds_read_b64_tr_b16 v[38:39], v9 offset:4608
  v_add_u32 v9, s42, v9
  s_waitcnt lgkmcnt(6)
  v_mfma_f32_16x16x32_bf16 v[64:67], v[168:171], v[24:27], v[64:67]
  ds_read_b64_tr_b16 v[40:41], v10 offset:4096
  v_mfma_f32_16x16x32_bf16 v[68:71], v[172:175], v[24:27], v[68:71]
  ds_read_b64_tr_b16 v[42:43], v10 offset:4608
  v_add_u32 v10, s42, v10
  s_waitcnt lgkmcnt(6)
  v_mfma_f32_16x16x32_bf16 v[76:79], v[172:175], v[28:31], v[76:79]
  ds_read_b64_tr_b16 v[44:45], v11 offset:4096
  buffer_load_dwordx4 v[164:167], v91, s[8:11], s36 offen sc1
  v_mfma_f32_16x16x32_bf16 v[72:75], v[168:171], v[28:31], v[72:75]
  ds_read_b64_tr_b16 v[46:47], v11 offset:4608
  v_add_u32 v11, s42, v11
  s_barrier
  s_waitcnt vmcnt(13) lgkmcnt(6)
  v_mfma_f32_16x16x32_bf16 v[48:51], v[176:179], v[32:35], v[48:51]
  ds_read_b64_tr_b16 v[16:17], v8 offset:0
  s_bitcmp1_b32 s48, 7
  s_cselect_b32 s36, s50, s49
  s_waitcnt vmcnt(12)
  v_mfma_f32_16x16x32_bf16 v[52:55], v[180:183], v[32:35], v[52:55]
  ds_read_b64_tr_b16 v[18:19], v8 offset:512
  s_add_u32 s36, s36, 57344
  s_add_u32 s40, s43, 8192
  s_waitcnt lgkmcnt(6)
  v_mfma_f32_16x16x32_bf16 v[60:63], v[180:183], v[36:39], v[60:63]
  ds_read_b64_tr_b16 v[20:21], v9 offset:0
  s_cmp_eq_u32 s40, 65536
  s_cselect_b32 s40, 0, s40
  v_mfma_f32_16x16x32_bf16 v[56:59], v[176:179], v[36:39], v[56:59]
  ds_read_b64_tr_b16 v[22:23], v9 offset:512
  s_sub_u32 s42, s40, s43
  s_mov_b32 s43, s40
  s_waitcnt lgkmcnt(6)
  v_mfma_f32_16x16x32_bf16 v[64:67], v[176:179], v[40:43], v[64:67]
  ds_read_b64_tr_b16 v[24:25], v10 offset:0
  buffer_load_dwordx4 v[168:171], v88, s[8:11], s36 offen sc1
  v_mfma_f32_16x16x32_bf16 v[68:71], v[180:183], v[40:43], v[68:71]
  ds_read_b64_tr_b16 v[26:27], v10 offset:512
  s_waitcnt lgkmcnt(6)
  v_mfma_f32_16x16x32_bf16 v[76:79], v[180:183], v[44:47], v[76:79]
  ds_read_b64_tr_b16 v[28:29], v11 offset:0
  v_mfma_f32_16x16x32_bf16 v[72:75], v[176:179], v[44:47], v[72:75]
  ds_read_b64_tr_b16 v[30:31], v11 offset:512
  buffer_load_dwordx4 v[172:175], v89, s[8:11], s36 offen sc1
  s_waitcnt vmcnt(13) lgkmcnt(6)
  v_mfma_f32_16x16x32_bf16 v[48:51], v[120:123], v[16:19], v[48:51]
  ds_read_b64_tr_b16 v[32:33], v8 offset:4096
  s_waitcnt vmcnt(12)
  v_mfma_f32_16x16x32_bf16 v[52:55], v[124:127], v[16:19], v[52:55]
  ds_read_b64_tr_b16 v[34:35], v8 offset:4608
  v_add_u32 v8, s42, v8
  s_waitcnt lgkmcnt(6)
  v_mfma_f32_16x16x32_bf16 v[60:63], v[124:127], v[20:23], v[60:63]
  ds_read_b64_tr_b16 v[36:37], v9 offset:4096
  buffer_load_dwordx4 v[176:179], v90, s[8:11], s36 offen sc1
  v_mfma_f32_16x16x32_bf16 v[56:59], v[120:123], v[20:23], v[56:59]
  ds_read_b64_tr_b16 v[38:39], v9 offset:4608
  v_add_u32 v9, s42, v9
  s_waitcnt lgkmcnt(6)
  v_mfma_f32_16x16x32_bf16 v[64:67], v[120:123], v[24:27], v[64:67]
  ds_read_b64_tr_b16 v[40:41], v10 offset:4096
  v_mfma_f32_16x16x32_bf16 v[68:71], v[124:127], v[24:27], v[68:71]
  ds_read_b64_tr_b16 v[42:43], v10 offset:4608
  v_add_u32 v10, s42, v10
  s_waitcnt lgkmcnt(6)
  v_mfma_f32_16x16x32_bf16 v[76:79], v[124:127], v[28:31], v[76:79]
  ds_read_b64_tr_b16 v[44:45], v11 offset:4096
  buffer_load_dwordx4 v[180:183], v91, s[8:11], s36 offen sc1
  v_mfma_f32_16x16x32_bf16 v[72:75], v[120:123], v[28:31], v[72:75]
  ds_read_b64_tr_b16 v[46:47], v11 offset:4608
  v_add_u32 v11, s42, v11
  s_barrier
  s_waitcnt vmcnt(13) lgkmcnt(6)
  v_mfma_f32_16x16x32_bf16 v[48:51], v[128:131], v[32:35], v[48:51]
  ds_read_b64_tr_b16 v[16:17], v8 offset:0
  s_add_u32 s40, s43, 8192
  s_cmp_eq_u32 s40, 65536
  s_waitcnt vmcnt(12)
  v_mfma_f32_16x16x32_bf16 v[52:55], v[132:135], v[32:35], v[52:55]
  ds_read_b64_tr_b16 v[18:19], v8 offset:512
  s_cselect_b32 s40, 0, s40
  s_sub_u32 s42, s40, s43
  s_waitcnt lgkmcnt(6)
  v_mfma_f32_16x16x32_bf16 v[60:63], v[132:135], v[36:39], v[60:63]
  ds_read_b64_tr_b16 v[20:21], v9 offset:0
  s_mov_b32 s43, s40
  v_mfma_f32_16x16x32_bf16 v[56:59], v[128:131], v[36:39], v[56:59]
  ds_read_b64_tr_b16 v[22:23], v9 offset:512
  s_waitcnt lgkmcnt(6)
  v_mfma_f32_16x16x32_bf16 v[64:67], v[128:131], v[40:43], v[64:67]
  ds_read_b64_tr_b16 v[24:25], v10 offset:0
  v_mfma_f32_16x16x32_bf16 v[68:71], v[132:135], v[40:43], v[68:71]
  ds_read_b64_tr_b16 v[26:27], v10 offset:512
  s_waitcnt lgkmcnt(6)
  v_mfma_f32_16x16x32_bf16 v[76:79], v[132:135], v[44:47], v[76:79]
  ds_read_b64_tr_b16 v[28:29], v11 offset:0
  v_mfma_f32_16x16x32_bf16 v[72:75], v[128:131], v[44:47], v[72:75]
  ds_read_b64_tr_b16 v[30:31], v11 offset:512
  s_waitcnt vmcnt(11) lgkmcnt(6)
  v_mfma_f32_16x16x32_bf16 v[48:51], v[136:139], v[16:19], v[48:51]
  ds_read_b64_tr_b16 v[32:33], v8 offset:4096
  s_waitcnt vmcnt(10)
  v_mfma_f32_16x16x32_bf16 v[52:55], v[140:143], v[16:19], v[52:55]
  ds_read_b64_tr_b16 v[34:35], v8 offset:4608
  v_add_u32 v8, s42, v8
  s_waitcnt lgkmcnt(6)
  v_mfma_f32_16x16x32_bf16 v[60:63], v[140:143], v[20:23], v[60:63]
  ds_read_b64_tr_b16 v[36:37], v9 offset:4096
  v_mfma_f32_16x16x32_bf16 v[56:59], v[136:139], v[20:23], v[56:59]
  ds_read_b64_tr_b16 v[38:39], v9 offset:4608
  v_add_u32 v9, s42, v9
  s_waitcnt lgkmcnt(6)
  v_mfma_f32_16x16x32_bf16 v[64:67], v[136:139], v[24:27], v[64:67]
  ds_read_b64_tr_b16 v[40:41], v10 offset:4096
  v_mfma_f32_16x16x32_bf16 v[68:71], v[140:143], v[24:27], v[68:71]
  ds_read_b64_tr_b16 v[42:43], v10 offset:4608
  v_add_u32 v10, s42, v10
  s_waitcnt lgkmcnt(6)
  v_mfma_f32_16x16x32_bf16 v[76:79], v[140:143], v[28:31], v[76:79]
  ds_read_b64_tr_b16 v[44:45], v11 offset:4096
  v_mfma_f32_16x16x32_bf16 v[72:75], v[136:139], v[28:31], v[72:75]
  ds_read_b64_tr_b16 v[46:47], v11 offset:4608
  v_add_u32 v11, s42, v11
  s_barrier
  s_waitcnt vmcnt(9) lgkmcnt(6)
  v_mfma_f32_16x16x32_bf16 v[48:51], v[144:147], v[32:35], v[48:51]
  ds_read_b64_tr_b16 v[16:17], v8 offset:0
  s_add_u32 s40, s43, 8192
  s_cmp_eq_u32 s40, 65536
  s_waitcnt vmcnt(8)
  v_mfma_f32_16x16x32_bf16 v[52:55], v[148:151], v[32:35], v[52:55]
  ds_read_b64_tr_b16 v[18:19], v8 offset:512
  s_cselect_b32 s40, 0, s40
  s_sub_u32 s42, s40, s43
  s_waitcnt lgkmcnt(6)
  v_mfma_f32_16x16x32_bf16 v[60:63], v[148:151], v[36:39], v[60:63]
  ds_read_b64_tr_b16 v[20:21], v9 offset:0
  s_mov_b32 s43, s40
  v_mfma_f32_16x16x32_bf16 v[56:59], v[144:147], v[36:39], v[56:59]
  ds_read_b64_tr_b16 v[22:23], v9 offset:512
  s_waitcnt lgkmcnt(6)
  v_mfma_f32_16x16x32_bf16 v[64:67], v[144:147], v[40:43], v[64:67]
  ds_read_b64_tr_b16 v[24:25], v10 offset:0
  v_mfma_f32_16x16x32_bf16 v[68:71], v[148:151], v[40:43], v[68:71]
  ds_read_b64_tr_b16 v[26:27], v10 offset:512
  s_waitcnt lgkmcnt(6)
  v_mfma_f32_16x16x32_bf16 v[76:79], v[148:151], v[44:47], v[76:79]
  ds_read_b64_tr_b16 v[28:29], v11 offset:0
  v_mfma_f32_16x16x32_bf16 v[72:75], v[144:147], v[44:47], v[72:75]
  ds_read_b64_tr_b16 v[30:31], v11 offset:512
  s_waitcnt vmcnt(7) lgkmcnt(6)
  v_mfma_f32_16x16x32_bf16 v[48:51], v[152:155], v[16:19], v[48:51]
  ds_read_b64_tr_b16 v[32:33], v8 offset:4096
  s_waitcnt vmcnt(6)
  v_mfma_f32_16x16x32_bf16 v[52:55], v[156:159], v[16:19], v[52:55]
  ds_read_b64_tr_b16 v[34:35], v8 offset:4608
  v_add_u32 v8, s42, v8
  s_waitcnt lgkmcnt(6)
  v_mfma_f32_16x16x32_bf16 v[60:63], v[156:159], v[20:23], v[60:63]
  ds_read_b64_tr_b16 v[36:37], v9 offset:4096
  v_mfma_f32_16x16x32_bf16 v[56:59], v[152:155], v[20:23], v[56:59]
  ds_read_b64_tr_b16 v[38:39], v9 offset:4608
  v_add_u32 v9, s42, v9
  s_waitcnt lgkmcnt(6)
  v_mfma_f32_16x16x32_bf16 v[64:67], v[152:155], v[24:27], v[64:67]
  ds_read_b64_tr_b16 v[40:41], v10 offset:4096
  v_mfma_f32_16x16x32_bf16 v[68:71], v[156:159], v[24:27], v[68:71]
  ds_read_b64_tr_b16 v[42:43], v10 offset:4608
  v_add_u32 v10, s42, v10
  s_waitcnt lgkmcnt(6)
  v_mfma_f32_16x16x32_bf16 v[76:79], v[156:159], v[28:31], v[76:79]
  ds_read_b64_tr_b16 v[44:45], v11 offset:4096
  v_mfma_f32_16x16x32_bf16 v[72:75], v[152:155], v[28:31], v[72:75]
  ds_read_b64_tr_b16 v[46:47], v11 offset:4608
  v_add_u32 v11, s42, v11
  s_barrier
  s_waitcnt vmcnt(5) lgkmcnt(6)
  v_mfma_f32_16x16x32_bf16 v[48:51], v[160:163], v[32:35], v[48:51]
  ds_read_b64_tr_b16 v[16:17], v8 offset:0
  s_add_u32 s40, s43, 8192
  s_cmp_eq_u32 s40, 65536
  s_waitcnt vmcnt(4)
  v_mfma_f32_16x16x32_bf16 v[52:55], v[164:167], v[32:35], v[52:55]
  ds_read_b64_tr_b16 v[18:19], v8 offset:512
  s_cselect_b32 s40, 0, s40
  s_sub_u32 s42, s40, s43
  s_waitcnt lgkmcnt(6)
  v_mfma_f32_16x16x32_bf16 v[60:63], v[164:167], v[36:39], v[60:63]
  ds_read_b64_tr_b16 v[20:21], v9 offset:0
  s_mov_b32 s43, s40
  v_mfma_f32_16x16x32_bf16 v[56:59], v[160:163], v[36:39], v[56:59]
  ds_read_b64_tr_b16 v[22:23], v9 offset:512
  s_waitcnt lgkmcnt(6)
  v_mfma_f32_16x16x32_bf16 v[64:67], v[160:163], v[40:43], v[64:67]
  ds_read_b64_tr_b16 v[24:25], v10 offset:0
  v_mfma_f32_16x16x32_bf16 v[68:71], v[164:167], v[40:43], v[68:71]
  ds_read_b64_tr_b16 v[26:27], v10 offset:512
  s_waitcnt lgkmcnt(6)
  v_mfma_f32_16x16x32_bf16 v[76:79], v[164:167], v[44:47], v[76:79]
  ds_read_b64_tr_b16 v[28:29], v11 offset:0
  v_mfma_f32_16x16x32_bf16 v[72:75], v[160:163], v[44:47], v[72:75]
  ds_read_b64_tr_b16 v[30:31], v11 offset:512
  s_waitcnt vmcnt(3) lgkmcnt(6)
  v_mfma_f32_16x16x32_bf16 v[48:51], v[168:171], v[16:19], v[48:51]
  ds_read_b64_tr_b16 v[32:33], v8 offset:4096
  s_waitcnt vmcnt(2)
  v_mfma_f32_16x16x32_bf16 v[52:55], v[172:175], v[16:19], v[52:55]
  ds_read_b64_tr_b16 v[34:35], v8 offset:4608
  s_waitcnt lgkmcnt(6)
  v_mfma_f32_16x16x32_bf16 v[60:63], v[172:175], v[20:23], v[60:63]
  ds_read_b64_tr_b16 v[36:37], v9 offset:4096
  v_mfma_f32_16x16x32_bf16 v[56:59], v[168:171], v[20:23], v[56:59]
  ds_read_b64_tr_b16 v[38:39], v9 offset:4608
  s_waitcnt lgkmcnt(6)
  v_mfma_f32_16x16x32_bf16 v[64:67], v[168:171], v[24:27], v[64:67]
  ds_read_b64_tr_b16 v[40:41], v10 offset:4096
  v_mfma_f32_16x16x32_bf16 v[68:71], v[172:175], v[24:27], v[68:71]
  ds_read_b64_tr_b16 v[42:43], v10 offset:4608
  s_waitcnt lgkmcnt(6)
  v_mfma_f32_16x16x32_bf16 v[76:79], v[172:175], v[28:31], v[76:79]
  ds_read_b64_tr_b16 v[44:45], v11 offset:4096
  v_mfma_f32_16x16x32_bf16 v[72:75], v[168:171], v[28:31], v[72:75]
  ds_read_b64_tr_b16 v[46:47], v11 offset:4608
  s_waitcnt vmcnt(1) lgkmcnt(6)
  v_mfma_f32_16x16x32_bf16 v[48:51], v[176:179], v[32:35], v[48:51]
  s_waitcnt vmcnt(0)
  v_mfma_f32_16x16x32_bf16 v[52:55], v[180:183], v[32:35], v[52:55]
  s_waitcnt lgkmcnt(4)
  v_mfma_f32_16x16x32_bf16 v[60:63], v[180:183], v[36:39], v[60:63]
  v_mfma_f32_16x16x32_bf16 v[56:59], v[176:179], v[36:39], v[56:59]
  s_waitcnt lgkmcnt(2)
  v_mfma_f32_16x16x32_bf16 v[64:67], v[176:179], v[40:43], v[64:67]
  v_mfma_f32_16x16x32_bf16 v[68:71], v[180:183], v[40:43], v[68:71]
  s_waitcnt lgkmcnt(0)
  v_mfma_f32_16x16x32_bf16 v[76:79], v[180:183], v[44:47], v[76:79]
  v_mfma_f32_16x16x32_bf16 v[72:75], v[176:179], v[44:47], v[72:75]
  s_waitcnt lgkmcnt(0)
  s_cmp_eq_u32 s3, 0
  s_cbranch_scc1 C_st
  v_cvt_pk_bf16_f32 v96, v48, v49
  v_cvt_pk_bf16_f32 v97, v50, v51
  v_cvt_pk_bf16_f32 v98, v52, v53
  v_cvt_pk_bf16_f32 v99, v54, v55
  ds_write_b128 v189, v[96:99] offset:0
  v_cvt_pk_bf16_f32 v100, v56, v57
  v_cvt_pk_bf16_f32 v101, v58, v59
  v_cvt_pk_bf16_f32 v102, v60, v61
  v_cvt_pk_bf16_f32 v103, v62, v63
  ds_write_b128 v189, v[100:103] offset:4352
  v_cvt_pk_bf16_f32 v104, v64, v65
  v_cvt_pk_bf16_f32 v105, v66, v67
  v_cvt_pk_bf16_f32 v106, v68, v69
  v_cvt_pk_bf16_f32 v107, v70, v71
  ds_write_b128 v189, v[104:107] offset:8704
  v_cvt_pk_bf16_f32 v108, v72, v73
  v_cvt_pk_bf16_f32 v109, v74, v75
  v_cvt_pk_bf16_f32 v110, v76, v77
  v_cvt_pk_bf16_f32 v111, v78, v79
  ds_write_b128 v189, v[108:111] offset:13056
  s_waitcnt lgkmcnt(0)
  s_barrier
  ds_read_b128 v[96:99], v190 offset:0
  ds_read_b128 v[100:103], v190 offset:1088
  ds_read_b128 v[104:107], v190 offset:2176
  ds_read_b128 v[108:111], v190 offset:3264
  s_waitcnt lgkmcnt(3)
  buffer_store_dwordx4 v[96:99], v12, s[24:27], 0 offen
  s_waitcnt lgkmcnt(2)
  buffer_store_dwordx4 v[100:103], v12, s[24:27], s45 offen
  s_waitcnt lgkmcnt(1)
  buffer_store_dwordx4 v[104:107], v12, s[24:27], s46 offen
  s_waitcnt lgkmcnt(0)
  buffer_store_dwordx4 v[108:111], v12, s[24:27], s47 offen
  s_branch C_end
C_st:
  s_nop 7
  v_pk_add_f32 v[16:17], v[48:49], v[50:51]
  v_pk_mul_f32 v[18:19], v[48:49], v[48:49]
  v_pk_fma_f32 v[18:19], v[50:51], v[50:51], v[18:19]
  v_pk_add_f32 v[16:17], v[16:17], v[52:53]
  v_pk_fma_f32 v[18:19], v[52:53], v[52:53], v[18:19]
  v_pk_add_f32 v[16:17], v[16:17], v[54:55]
  v_pk_fma_f32 v[18:19], v[54:55], v[54:55], v[18:19]
  v_add_f32 v32, v16, v17
  v_add_f32 v36, v18, v19
  v_pk_add_f32 v[20:21], v[56:57], v[58:59]
  v_pk_mul_f32 v[22:23], v[56:57], v[56:57]
  v_pk_fma_f32 v[22:23], v[58:59], v[58:59], v[22:23]
  v_pk_add_f32 v[20:21], v[20:21], v[60:61]
  v_pk_fma_f32 v[22:23], v[60:61], v[60:61], v[22:23]
  v_pk_add_f32 v[20:21], v[20:21], v[62:63]
  v_pk_fma_f32 v[22:23], v[62:63], v[62:63], v[22:23]
  v_add_f32 v33, v20, v21
  v_add_f32 v37, v22, v23
  v_pk_add_f32 v[24:25], v[64:65], v[66:67]
  v_pk_mul_f32 v[26:27], v[64:65], v[64:65]
  v_pk_fma_f32 v[26:27], v[66:67], v[66:67], v[26:27]
  v_pk_add_f32 v[24:25], v[24:25], v[68:69]
  v_pk_fma_f32 v[26:27], v[68:69], v[68:69], v[26:27]
  v_pk_add_f32 v[24:25], v[24:25], v[70:71]
  v_pk_fma_f32 v[26:27], v[70:71], v[70:71], v[26:27]
  v_add_f32 v34, v24, v25
  v_add_f32 v38, v26, v27
  v_pk_add_f32 v[28:29], v[72:73], v[74:75]
  v_pk_mul_f32 v[30:31], v[72:73], v[72:73]
  v_pk_fma_f32 v[30:31], v[74:75], v[74:75], v[30:31]
  v_pk_add_f32 v[28:29], v[28:29], v[76:77]
  v_pk_fma_f32 v[30:31], v[76:77], v[76:77], v[30:31]
  v_pk_add_f32 v[28:29], v[28:29], v[78:79]
  v_pk_fma_f32 v[30:31], v[78:79], v[78:79], v[30:31]
  v_add_f32 v35, v28, v29
  v_add_f32 v39, v30, v31
  v_permlane16_swap_b32 v32, v33
  v_permlane16_swap_b32 v34, v35
  v_permlane16_swap_b32 v36, v37
  v_permlane16_swap_b32 v38, v39
  v_add_f32 v32, v32, v33
  v_add_f32 v34, v34, v35
  v_add_f32 v36, v36, v37
  v_add_f32 v38, v38, v39
  v_permlane32_swap_b32 v32, v34
  s_nop 0
  v_permlane32_swap_b32 v36, v38
  v_add_f32 v40, v32, v34
  v_add_f32 v41, v36, v38
  ds_write_b64 v185, v[40:41]
  s_lshl_b32 s32, s28, 15
  s_lshl_b32 s40, s29, 10
  s_add_u32 s32, s32, s40
  s_add_u32 s32, s32, 512
  v_cvt_pk_bf16_f32 v96, v48, v49
  v_cvt_pk_bf16_f32 v97, v50, v51
  v_cvt_pk_bf16_f32 v98, v52, v53
  v_cvt_pk_bf16_f32 v99, v54, v55
  ds_write_b128 v189, v[96:99] offset:0
  v_cvt_pk_bf16_f32 v100, v56, v57
  v_cvt_pk_bf16_f32 v101, v58, v59
  v_cvt_pk_bf16_f32 v102, v60, v61
  v_cvt_pk_bf16_f32 v103, v62, v63
  ds_write_b128 v189, v[100:103] offset:4352
  v_cvt_pk_bf16_f32 v104, v64, v65
  v_cvt_pk_bf16_f32 v105, v66, v67
  v_cvt_pk_bf16_f32 v106, v68, v69
  v_cvt_pk_bf16_f32 v107, v70, v71
  ds_write_b128 v189, v[104:107] offset:8704
  v_cvt_pk_bf16_f32 v108, v72, v73
  v_cvt_pk_bf16_f32 v109, v74, v75
  v_cvt_pk_bf16_f32 v110, v76, v77
  v_cvt_pk_bf16_f32 v111, v78, v79
  ds_write_b128 v189, v[108:111] offset:13056
  s_waitcnt lgkmcnt(0)
  s_barrier
  s_cmp_lg_u32 s4, 0
  s_cbranch_scc1 C_nost
  ds_read_b64 v[44:45], v185 offset:512
  ds_read_b64 v[46:47], v185 offset:1024
  ds_read_b64 v[18:19], v185 offset:1536
  s_waitcnt lgkmcnt(0)
  v_pk_add_f32 v[40:41], v[40:41], v[44:45]
  v_pk_add_f32 v[46:47], v[46:47], v[18:19]
  v_pk_add_f32 v[40:41], v[40:41], v[46:47]
  buffer_store_dwordx2 v[40:41], v184, s[12:15], s32 offen sc0 sc1
C_nost:
  s_nop 1
  ds_read_b128 v[96:99], v190 offset:0
  ds_read_b128 v[100:103], v190 offset:1088
  ds_read_b128 v[104:107], v190 offset:2176
  ds_read_b128 v[108:111], v190 offset:3264
  s_waitcnt lgkmcnt(3)
  buffer_store_dwordx4 v[96:99], v186, s[24:27], 0 offen offset:0 sc0 sc1
  s_waitcnt lgkmcnt(2)
  buffer_store_dwordx4 v[100:103], v186, s[24:27], 0 offen offset:1024 sc0 sc1
  s_waitcnt lgkmcnt(1)
  buffer_store_dwordx4 v[104:107], v186, s[24:27], 0 offen offset:2048 sc0 sc1
  s_waitcnt lgkmcnt(0)
  buffer_store_dwordx4 v[108:111], v186, s[24:27], 0 offen offset:3072 sc0 sc1
  s_lshr_b32 s32, s2, 3
  s_lshr_b32 s5, s32, 3
  s_and_b32 s6, s32, 7
  s_lshl_b32 s7, s5, 1
  s_add_u32 s7, s7, s6
  s_and_b32 s7, s7, 7
  s_and_b32 s32, s2, 7
  s_lshr_b32 s28, s32, 1
  s_lshl_b32 s28, s28, 2
  s_add_u32 s28, s28, s5
  s_and_b32 s29, s32, 1
  s_mul_i32 s29, s29, 8
  s_add_u32 s29, s29, s6
  s_mov_b32 s30, 7
  s_mov_b32 s31, -1
  v_and_b32 v4, 15, v0
  v_lshrrev_b32 v5, 4, v0
  v_lshrrev_b32 v6, 2, v4
  v_and_b32 v7, 3, v0
  v_lshrrev_b32 v3, 5, v0
  v_and_b32 v2, 1, v5
  v_lshl_or_b32 v3, v2, 1, v3
  v_lshl_add_u32 v21, v5, 3, v6
  v_lshlrev_b32 v21, 7, v21
  v_lshl_add_u32 v21, v7, 3, v21
  v_lshrrev_b32 v22, 1, v6
  v_lshl_or_b32 v22, v2, 1, v22
  v_lshl_add_u32 v21, v22, 5, v21
  v_add_u32 v21, 18432, v21
  v_xor_b32 v8, 0, v21
  s_lshl_b32 s32, s4, 5
  v_xor_b32 v8, s32, v8
  v_lshrrev_b32 v21, 1, v4
  v_xor_b32 v21, v21, v5
  v_lshlrev_b32 v21, 4, v21
  v_lshlrev_b32 v22, 7, v4
  v_add_u32 v9, v21, v22
  v_xor_b32 v10, 64, v9
  v_and_b32 v21, 1, v4
  v_mul_u32_u24 v21, 28800, v21
  v_lshrrev_b32 v22, 1, v4
  v_mul_u32_u24 v22, 400, v22
  v_lshlrev_b32 v23, 3, v5
  v_add3_u32 v11, v21, v22, v23
  s_add_u32 s32, s32, 43008
  v_add_u32 v11, s32, v11
  v_lshlrev_b32 v12, 3, v4
  v_add_u32 v12, 129024, v12
  v_mov_b64 v[112:113], 0
  v_mov_b64 v[114:115], 0
  v_mov_b64 v[116:117], 0
  v_mov_b64 v[118:119], 0
  v_mov_b64 v[120:121], 0
  v_mov_b64 v[122:123], 0
  v_mov_b64 v[124:125], 0
  v_mov_b64 v[126:127], 0
  v_mov_b64 v[128:129], 0
  v_mov_b64 v[130:131], 0
  v_mov_b64 v[132:133], 0
  v_mov_b64 v[134:135], 0
  v_mov_b64 v[136:137], 0
  v_mov_b64 v[138:139], 0
  v_mov_b64 v[140:141], 0
  v_mov_b64 v[142:143], 0
  v_mov_b64 v[144:145], 0
  v_mov_b64 v[146:147], 0
  v_mov_b64 v[148:149], 0
  v_mov_b64 v[150:151], 0
  v_mov_b64 v[152:153], 0
  v_mov_b64 v[154:155], 0
  v_mov_b64 v[156:157], 0
  v_mov_b64 v[158:159], 0
  v_mov_b64 v[160:161], 0
  v_mov_b64 v[162:163], 0
  v_mov_b64 v[164:165], 0
  v_mov_b64 v[166:167], 0
  v_mov_b64 v[168:169], 0
  v_mov_b64 v[170:171], 0
  v_mov_b64 v[172:173], 0
  v_mov_b64 v[174:175], 0
  v_mov_b64 v[176:177], 0
  v_mov_b64 v[178:179], 0
  v_mov_b64 v[180:181], 0
  v_mov_b64 v[182:183], 0
  v_mov_b64 v[184:185], 0
  v_mov_b64 v[186:187], 0
  v_mov_b64 v[188:189], 0
  v_mov_b64 v[190:191], 0
  v_mov_b64 v[192:193], 0
  v_mov_b64 v[194:195], 0
  v_mov_b64 v[196:197], 0
  v_mov_b64 v[198:199], 0
  v_mov_b64 v[200:201], 0
  v_mov_b64 v[202:203], 0
  v_mov_b64 v[204:205], 0
  v_mov_b64 v[206:207], 0
  v_mov_b64 v[208:209], 0
  v_mov_b64 v[210:211], 0
  v_mov_b64 v[212:213], 0
  v_mov_b64 v[214:215], 0
  v_mov_b64 v[216:217], 0
  v_mov_b64 v[218:219], 0
  s_waitcnt vmcnt(0)
  s_barrier
  s_mov_b32 s16, s66
  s_mov_b32 s17, s67
  s_mov_b32 s18, 6291456
  s_mov_b32 s19, 0x20000
  s_lshr_b32 s32, s2, 3
  s_lshl_b32 s32, s32, 1
  s_add_u32 s32, s32, s4
  s_sub_u32 s32, s32, 1
  s_lshl_b32 s32, s32, 6
  v_add_u32 v16, s32, v0
  v_mul_u32_u24 v17, 21846, v16
  v_lshrrev_b32 v17, 16, v17
  v_mul_u32_u24 v18, 3, v17
  v_sub_u32 v18, v16, v18
  v_mul_u32_u24 v17, 6144, v17
  v_lshl_add_u32 v14, v18, 11, v17
  s_and_b32 s32, s2, 1
  s_lshl_b32 s32, s32, 10
  s_add_u32 s32, s32, 384
  s_sub_u32 s40, s4, 1
  s_cmp_lt_u32 s40, 2
  s_cselect_b32 s18, s18, 0
  buffer_load_dword v15, v14, s[16:19], s32 offen
  s_barrier
  s_mov_b32 s3, 1
  s_mov_b32 s51, 9
  s_add_u32 s82, s84, 50331648
  s_addc_u32 s83, s85, 0
  s_branch C_top1
C_end:
  s_endpgm
L_start:
  s_nop 7
  s_nop 7
  s_sub_u32 s57, s4, 4
  v_and_b32 v134, 3, v0
  v_lshlrev_b32 v134, 6, v134
  s_lshr_b32 s32, s2, 3
  s_lshr_b32 s5, s32, 3
  s_and_b32 s6, s32, 7
  s_lshl_b32 s7, s5, 1
  s_add_u32 s7, s7, s6
  s_and_b32 s7, s7, 7
  s_and_b32 s32, s2, 7
  s_lshr_b32 s28, s32, 1
  s_lshl_b32 s28, s28, 2
  s_add_u32 s28, s28, s5
  s_and_b32 s29, s32, 1
  s_mul_i32 s29, s29, 8
  s_add_u32 s29, s29, s6
  s_mov_b32 s30, 7
  s_mov_b32 s31, -1
  s_mov_b32 s41, s57
  s_mul_i32 s32, s41, 16
  s_add_u32 s32, s32, 0
  v_lshrrev_b32 v2, 3, v0
  v_add_u32 v2, s32, v2
  v_bfe_u32 v3, v2, 1, 1
  v_bfe_u32 v4, v2, 3, 1
  v_lshl_or_b32 v3, v4, 1, v3
  v_lshlrev_b32 v3, 1, v3
  v_and_b32 v4, 7, v0
  v_xor_b32 v3, v3, v4
  v_lshlrev_b32 v3, 4, v3
  s_mov_b32 s32, 6144
  v_mul_lo_u32 v2, v2, s32
  v_add_u32 v13, v2, v3
  s_mul_i32 s32, s41, 16
  s_add_u32 s32, s32, 8
  v_lshrrev_b32 v2, 3, v0
  v_add_u32 v2, s32, v2
  v_bfe_u32 v3, v2, 1, 1
  v_bfe_u32 v4, v2, 3, 1
  v_lshl_or_b32 v3, v4, 1, v3
  v_lshlrev_b32 v3, 1, v3
  v_and_b32 v4, 7, v0
  v_xor_b32 v3, v3, v4
  v_lshlrev_b32 v3, 4, v3
  s_mov_b32 s32, 6144
  v_mul_lo_u32 v2, v2, s32
  v_add_u32 v14, v2, v3
  v_subrev_u32 v14, 1024, v14
  v_add_u32 v15, 2048, v13
  v_add_u32 v16, 2048, v14
  v_add_u32 v17, 4096, v13
  v_add_u32 v18, 4096, v14
  s_lshl_b32 s46, s41, 11
  s_add_u32 s46, s46, 18432
  s_add_u32 s47, s46, 8192
  s_add_u32 s48, s46, 16384
  s_lshl_b32 s35, s29, 7
  s_lshl_b32 s40, s28, 7
  s_sub_u32 s40, s40, 16
  s_lshl_b32 s32, s41, 5
  s_add_u32 s32, s32, 16
  v_lshrrev_b32 v2, 3, v0
  v_add_u32 v2, s32, v2
  v_bfe_u32 v3, v2, 1, 3
  v_and_b32 v4, 7, v0
  v_xor_b32 v3, v3, v4
  v_lshlrev_b32 v3, 4, v3
  v_add_u32 v2, s40, v2
  v_max_i32 v2, 0, v2
  v_lshlrev_b32 v2, 11, v2
  v_add_u32 v8, v2, v3
  v_add_u32 v10, 30720, v8
  s_lshl_b32 s32, s41, 5
  s_add_u32 s32, s32, 24
  v_lshrrev_b32 v2, 3, v0
  v_add_u32 v2, s32, v2
  v_bfe_u32 v3, v2, 1, 3
  v_and_b32 v4, 7, v0
  v_xor_b32 v3, v3, v4
  v_lshlrev_b32 v3, 4, v3
  v_add_u32 v2, s40, v2
  v_max_i32 v2, 0, v2
  v_lshlrev_b32 v2, 11, v2
  v_add_u32 v9, v2, v3
  v_subrev_u32 v9, 1024, v9
  v_add_u32 v11, 30720, v9
  s_lshl_b32 s32, s41, 3
  v_lshrrev_b32 v2, 3, v0
  v_add_u32 v2, s32, v2
  v_bfe_u32 v3, v2, 1, 3
  v_and_b32 v4, 7, v0
  v_xor_b32 v3, v3, v4
  v_lshlrev_b32 v3, 4, v3
  v_add_u32 v2, s40, v2
  v_max_i32 v2, 0, v2
  v_lshlrev_b32 v2, 11, v2
  v_add_u32 v12, v2, v3
  s_lshl_b32 s44, s41, 12
  s_add_u32 s44, s44, 2048
  s_lshl_b32 s45, s41, 10
  s_mov_b32 s34, 0
  s_mov_b32 s54, 128
  s_cmp_eq_u32 s41, 0
  s_cselect_b32 s52, 0xffffff00, -1
  s_mov_b32 s53, -1
  v_mov_b32 v20, 0x3f803f80
  v_mov_b32 v21, v20
  v_mov_b32 v22, v20
  v_mov_b32 v23, v20
  v_lshlrev_b32 v24, 4, v0
  v_add_u32 v25, 86016, v24
  s_mov_b64 exec, 0xff
  ds_write_b128 v24, v[20:23]
  ds_write_b128 v24, v[20:23] offset:43008
  ds_write_b128 v25, v[20:23]
  s_mov_b64 exec, -1
  s_lshl_b32 s32, s41, 6
  v_add_u32 v26, s32, v0
  v_min_u32 v26, 143, v26
  v_add_u32 v27, s40, v26
  v_max_i32 v27, 0, v27
  v_lshrrev_b32 v2, 6, v27
  v_and_b32 v27, 63, v27
  v_lshlrev_b32 v27, 3, v27
  v_lshl_add_u32 v27, v2, 10, v27
  v_add_u32 v27, 512, v27
  v_lshlrev_b32 v26, 3, v26
  v_add_u32 v26, 129024, v26
  s_lshl_b32 s32, s2, 3
  s_lshl_b32 s40, s57, 1
  s_add_u32 s32, s32, s40
  v_lshrrev_b32 v72, 5, v0
  v_add_u32 v72, s32, v72
  v_lshlrev_b32 v46, 11, v72
  v_and_b32 v2, 31, v0
  v_lshl_add_u32 v46, v2, 4, v46
  v_lshrrev_b32 v2, 6, v72
  v_and_b32 v72, 63, v72
  v_lshlrev_b32 v72, 3, v72
  v_lshl_add_u32 v72, v2, 10, v72
  v_add_u32 v72, 42992128, v72
  s_cmp_eq_u32 s57, 0
  s_cselect_b32 s58, 0, -1
  v_mov_b32 v64, s58
  v_mov_b32 v65, s58
  v_mov_b32 v66, s58
  v_mov_b32 v67, s58
  v_lshrrev_b32 v2, 3, v0
  v_lshlrev_b32 v2, 15, v2
  v_and_b32 v3, 7, v0
  v_lshl_add_u32 v2, v3, 4, v2
  v_lshrrev_b32 v4, 4, v0
  v_and_b32 v3, 15, v0
  v_lshlrev_b32 v3, 4, v3
  v_lshl_add_u32 v3, v4, 8, v3
  s_cselect_b64 vcc, -1, 0
  s_lshl_b32 s58, s2, 7
  s_add_u32 s58, s58, 109051904
  s_lshl_b32 s59, s2, 10
  s_add_u32 s59, s59, 41943040
  s_cmp_eq_u32 s57, 0
  s_cselect_b32 s58, s58, s59
  s_add_u32 s59, s59, 50331648
  s_cmp_eq_u32 s57, 2
  s_cselect_b32 s58, s59, s58
  s_cmp_eq_u32 s57, 3
  s_cselect_b32 s58, 134217728, s58
  v_cndmask_b32 v47, v3, v2, vcc
  s_and_b32 s59, s2, 3
  s_lshl_b32 s59, s59, 6
  v_mov_b32 v73, s59
  v_mov_b32 v74, 1
  s_lshl_b32 s56, s3, 10
  s_mul_i32 s32, s28, 16
  s_add_u32 s56, s56, s32
  s_add_u32 s56, s56, s29
  s_add_u32 s56, s56, 0
  s_lshl_b32 s56, s56, 7
  s_mov_b32 s38, 0
  s_waitcnt lgkmcnt(0)
  s_mov_b32 s8, s64
  s_mov_b32 s9, s65
  s_mov_b32 s10, 4194304
  s_mov_b32 s11, 0x20000
  s_mov_b32 s12, s66
  s_mov_b32 s13, s67
  s_mov_b32 s14, 6291456
  s_mov_b32 s15, 0x20000
  s_branch L_first
L_top:
  s_nop 7
  s_nop 7
  s_lshl_b32 s56, s3, 10
  s_mul_i32 s32, s28, 16
  s_add_u32 s56, s56, s32
  s_add_u32 s56, s56, s29
  s_add_u32 s56, s56, 0
  s_lshl_b32 s56, s56, 7
  s_mov_b32 s24, s72
  s_mov_b32 s25, s73
  s_mov_b32 s26, 14680064
  s_mov_b32 s27, 0x20000
  s_cmp_ge_u32 s57, 2
  s_cbranch_scc1 L_k1B
  s_mov_b32 s30, 7
  s_mov_b32 s31, -1
  s_mov_b32 s38, 0
  s_add_u32 s30, s30, 1
  s_and_b32 s30, s30, 7
  s_cselect_b32 s32, 0, 1
  s_add_u32 s31, s31, s32
  s_sub_u32 s32, s30, s7
  s_and_b32 s32, s32, 7
  s_cmp_lt_u32 s32, 2
  s_cselect_b32 s32, 1, 0
  s_add_u32 s32, s32, s31
  s_cmp_ge_u32 s32, 2
  s_cselect_b32 s32, 0, s32
  s_lshl_b32 s33, s32, 3
  s_add_u32 s33, s33, s30
  s_mul_i32 s36, s33, s54
  s_add_u32 s36, s36, s34
  s_add_u32 m0, s38, s45
  s_mov_b64 exec, s[52:53]
  buffer_load_dwordx4 v12, s[8:11], s36 offen offset:0 sc1 lds
  s_mov_b64 exec, -1
  s_add_u32 m0, s38, s44
  s_nop 0
  buffer_load_dwordx4 v8, s[8:11], s36 offen offset:0 sc1 lds
  buffer_load_dwordx4 v9, s[8:11], s36 offen offset:1024 sc1 lds
  buffer_load_dwordx4 v10, s[8:11], s36 offen offset:2048 sc1 lds
  buffer_load_dwordx4 v11, s[8:11], s36 offen offset:3072 sc1 lds
  s_add_u32 s38, s38, 43008
  s_cmp_eq_u32 s38, 129024
  s_cselect_b32 s38, 0, s38
  s_add_u32 s30, s30, 1
  s_and_b32 s30, s30, 7
  s_cselect_b32 s32, 0, 1
  s_add_u32 s31, s31, s32
  s_sub_u32 s32, s30, s7
  s_and_b32 s32, s32, 7
  s_cmp_lt_u32 s32, 2
  s_cselect_b32 s32, 1, 0
  s_add_u32 s32, s32, s31
  s_cmp_ge_u32 s32, 2
  s_cselect_b32 s32, 0, s32
  s_lshl_b32 s33, s32, 3
  s_add_u32 s33, s33, s30
  s_mul_i32 s36, s33, s54
  s_add_u32 s36, s36, s34
  s_add_u32 m0, s38, s45
  s_mov_b64 exec, s[52:53]
  buffer_load_dwordx4 v12, s[8:11], s36 offen offset:0 sc1 lds
  s_mov_b64 exec, -1
  s_add_u32 m0, s38, s44
  s_nop 0
  buffer_load_dwordx4 v8, s[8:11], s36 offen offset:0 sc1 lds
  buffer_load_dwordx4 v9, s[8:11], s36 offen offset:1024 sc1 lds
  buffer_load_dwordx4 v10, s[8:11], s36 offen offset:2048 sc1 lds
  buffer_load_dwordx4 v11, s[8:11], s36 offen offset:3072 sc1 lds
  s_add_u32 s38, s38, 43008
  s_cmp_eq_u32 s38, 129024
  s_cselect_b32 s38, 0, s38
  s_waitcnt vmcnt(5)
  s_barrier
  s_add_u32 s30, s30, 1
  s_and_b32 s30, s30, 7
  s_cselect_b32 s32, 0, 1
  s_add_u32 s31, s31, s32
  s_sub_u32 s32, s30, s7
  s_and_b32 s32, s32, 7
  s_cmp_lt_u32 s32, 2
  s_cselect_b32 s32, 1, 0
  s_add_u32 s32, s32, s31
  s_cmp_ge_u32 s32, 2
  s_cselect_b32 s32, 0, s32
  s_lshl_b32 s33, s32, 3
  s_add_u32 s33, s33, s30
  s_mul_i32 s36, s33, s54
  s_add_u32 s36, s36, s34
  s_mul_i32 s37, s33, 393216
  s_add_u32 s37, s37, s35
  s_add_u32 m0, s38, s45
  s_mov_b64 exec, s[52:53]
  buffer_load_dwordx4 v12, s[8:11], s36 offen offset:0 sc1 lds
  s_mov_b64 exec, -1
  s_add_u32 m0, s38, s44
  s_nop 0
  buffer_load_dwordx4 v8, s[8:11], s36 offen offset:0 sc1 lds
  buffer_load_dwordx4 v9, s[8:11], s36 offen offset:1024 sc1 lds
  buffer_load_dwordx4 v10, s[8:11], s36 offen offset:2048 sc1 lds
  buffer_load_dwordx4 v11, s[8:11], s36 offen offset:3072 sc1 lds
  s_add_u32 m0, s38, s46
  s_nop 0
  buffer_load_dwordx4 v13, s[12:15], s37 offen offset:0  lds
  buffer_load_dwordx4 v14, s[12:15], s37 offen offset:1024  lds
  s_add_u32 m0, s38, s47
  s_nop 0
  buffer_load_dwordx4 v15, s[12:15], s37 offen offset:0  lds
  buffer_load_dwordx4 v16, s[12:15], s37 offen offset:1024  lds
  s_add_u32 m0, s38, s48
  s_nop 0
  buffer_load_dwordx4 v17, s[12:15], s37 offen offset:0  lds
  buffer_load_dwordx4 v18, s[12:15], s37 offen offset:1024  lds
  s_add_u32 s38, s38, 43008
  s_cmp_eq_u32 s38, 129024
  s_cselect_b32 s38, 0, s38
L_jA:
  s_nop 1
  s_waitcnt vmcnt(11)
  s_barrier
  s_add_u32 s30, s30, 1
  s_and_b32 s30, s30, 7
  s_cselect_b32 s32, 0, 1
  s_add_u32 s31, s31, s32
  s_sub_u32 s32, s30, s7
  s_and_b32 s32, s32, 7
  s_cmp_lt_u32 s32, 2
  s_cselect_b32 s32, 1, 0
  s_add_u32 s32, s32, s31
  s_cmp_ge_u32 s32, 2
  s_cselect_b32 s32, 0, s32
  s_lshl_b32 s33, s32, 3
  s_add_u32 s33, s33, s30
  s_mul_i32 s36, s33, s54
  s_add_u32 s36, s36, s34
  s_mul_i32 s37, s33, 393216
  s_add_u32 s37, s37, s35
  s_add_u32 m0, s38, s45
  s_mov_b64 exec, s[52:53]
  buffer_load_dwordx4 v12, s[8:11], s36 offen offset:0 sc1 lds
  s_mov_b64 exec, -1
  s_add_u32 m0, s38, s44
  s_nop 0
  buffer_load_dwordx4 v8, s[8:11], s36 offen offset:0 sc1 lds
  buffer_load_dwordx4 v9, s[8:11], s36 offen offset:1024 sc1 lds
  buffer_load_dwordx4 v10, s[8:11], s36 offen offset:2048 sc1 lds
  buffer_load_dwordx4 v11, s[8:11], s36 offen offset:3072 sc1 lds
  s_add_u32 m0, s38, s46
  s_nop 0
  buffer_load_dwordx4 v13, s[12:15], s37 offen offset:0  lds
  buffer_load_dwordx4 v14, s[12:15], s37 offen offset:1024  lds
  s_add_u32 m0, s38, s47
  s_nop 0
  buffer_load_dwordx4 v15, s[12:15], s37 offen offset:0  lds
  buffer_load_dwordx4 v16, s[12:15], s37 offen offset:1024  lds
  s_add_u32 m0, s38, s48
  s_nop 0
  buffer_load_dwordx4 v17, s[12:15], s37 offen offset:0  lds
  buffer_load_dwordx4 v18, s[12:15], s37 offen offset:1024  lds
  s_add_u32 s38, s38, 43008
  s_cmp_eq_u32 s38, 129024
  s_cselect_b32 s38, 0, s38
  s_waitcnt vmcnt(11)
  s_barrier
  s_add_u32 s30, s30, 1
  s_and_b32 s30, s30, 7
  s_cselect_b32 s32, 0, 1
  s_add_u32 s31, s31, s32
  s_sub_u32 s32, s30, s7
  s_and_b32 s32, s32, 7
  s_cmp_lt_u32 s32, 2
  s_cselect_b32 s32, 1, 0
  s_add_u32 s32, s32, s31
  s_cmp_ge_u32 s32, 2
  s_cselect_b32 s32, 0, s32
  s_lshl_b32 s33, s32, 3
  s_add_u32 s33, s33, s30
  s_mul_i32 s36, s33, s54
  s_add_u32 s36, s36, s34
  s_mul_i32 s37, s33, 393216
  s_add_u32 s37, s37, s35
  s_add_u32 m0, s38, s45
  s_mov_b64 exec, s[52:53]
  buffer_load_dwordx4 v12, s[8:11], s36 offen offset:0 sc1 lds
  s_mov_b64 exec, -1
  s_add_u32 m0, s38, s44
  s_nop 0
  buffer_load_dwordx4 v8, s[8:11], s36 offen offset:0 sc1 lds
  buffer_load_dwordx4 v9, s[8:11], s36 offen offset:1024 sc1 lds
  buffer_load_dwordx4 v10, s[8:11], s36 offen offset:2048 sc1 lds
  buffer_load_dwordx4 v11, s[8:11], s36 offen offset:3072 sc1 lds
  s_add_u32 m0, s38, s46
  s_nop 0
  buffer_load_dwordx4 v13, s[12:15], s37 offen offset:0  lds
  buffer_load_dwordx4 v14, s[12:15], s37 offen offset:1024  lds
  s_add_u32 m0, s38, s47
  s_nop 0
  buffer_load_dwordx4 v15, s[12:15], s37 offen offset:0  lds
  buffer_load_dwordx4 v16, s[12:15], s37 offen offset:1024  lds
  s_add_u32 m0, s38, s48
  s_nop 0
  buffer_load_dwordx4 v17, s[12:15], s37 offen offset:0  lds
  buffer_load_dwordx4 v18, s[12:15], s37 offen offset:1024  lds
  s_add_u32 s38, s38, 43008
  s_cmp_eq_u32 s38, 129024
  s_cselect_b32 s38, 0, s38
  s_cmp_lg_u32 s3, 0
  s_cbranch_scc1 e7
  s_cmp_lg_u32 s57, 0
  s_cbranch_scc1 g8
  s_mov_b64 exec, 1
  global_atomic_add v73, v74, s[62:63] sc1
  s_mov_b64 exec, -1
g8:
e7:
  s_nop 1
  s_mov_b32 s39, 9
ll9:
  s_waitcnt vmcnt(11)
  s_barrier
  s_add_u32 s30, s30, 1
  s_and_b32 s30, s30, 7
  s_cselect_b32 s32, 0, 1
  s_add_u32 s31, s31, s32
  s_sub_u32 s32, s30, s7
  s_and_b32 s32, s32, 7
  s_cmp_lt_u32 s32, 2
  s_cselect_b32 s32, 1, 0
  s_add_u32 s32, s32, s31
  s_cmp_ge_u32 s32, 2
  s_cselect_b32 s32, 0, s32
  s_lshl_b32 s33, s32, 3
  s_add_u32 s33, s33, s30
  s_mul_i32 s36, s33, s54
  s_add_u32 s36, s36, s34
  s_mul_i32 s37, s33, 393216
  s_add_u32 s37, s37, s35
  s_add_u32 m0, s38, s45
  s_mov_b64 exec, s[52:53]
  buffer_load_dwordx4 v12, s[8:11], s36 offen offset:0 sc1 lds
  s_mov_b64 exec, -1
  s_add_u32 m0, s38, s44
  s_nop 0
  buffer_load_dwordx4 v8, s[8:11], s36 offen offset:0 sc1 lds
  buffer_load_dwordx4 v9, s[8:11], s36 offen offset:1024 sc1 lds
  buffer_load_dwordx4 v10, s[8:11], s36 offen offset:2048 sc1 lds
  buffer_load_dwordx4 v11, s[8:11], s36 offen offset:3072 sc1 lds
  s_add_u32 m0, s38, s46
  s_nop 0
  buffer_load_dwordx4 v13, s[12:15], s37 offen offset:0  lds
  buffer_load_dwordx4 v14, s[12:15], s37 offen offset:1024  lds
  s_add_u32 m0, s38, s47
  s_nop 0
  buffer_load_dwordx4 v15, s[12:15], s37 offen offset:0  lds
  buffer_load_dwordx4 v16, s[12:15], s37 offen offset:1024  lds
  s_add_u32 m0, s38, s48
  s_nop 0
  buffer_load_dwordx4 v17, s[12:15], s37 offen offset:0  lds
  buffer_load_dwordx4 v18, s[12:15], s37 offen offset:1024  lds
  s_add_u32 s38, s38, 43008
  s_cmp_eq_u32 s38, 129024
  s_cselect_b32 s38, 0, s38
  s_sub_u32 s39, s39, 1
  s_cmp_lg_u32 s39, 0
  s_cbranch_scc1 ll9
  s_waitcnt vmcnt(11)
  s_barrier
  s_add_u32 s30, s30, 1
  s_and_b32 s30, s30, 7
  s_cselect_b32 s32, 0, 1
  s_add_u32 s31, s31, s32
  s_sub_u32 s32, s30, s7
  s_and_b32 s32, s32, 7
  s_cmp_lt_u32 s32, 2
  s_cselect_b32 s32, 1, 0
  s_add_u32 s32, s32, s31
  s_cmp_ge_u32 s32, 2
  s_cselect_b32 s32, 0, s32
  s_lshl_b32 s33, s32, 3
  s_add_u32 s33, s33, s30
  s_mul_i32 s36, s33, s54
  s_add_u32 s36, s36, s34
  s_mul_i32 s37, s33, 393216
  s_add_u32 s37, s37, s35
  s_add_u32 m0, s38, s45
  s_mov_b64 exec, s[52:53]
  buffer_load_dwordx4 v12, s[8:11], s36 offen offset:0 sc1 lds
  s_mov_b64 exec, -1
  s_add_u32 m0, s38, s44
  s_nop 0
  buffer_load_dwordx4 v8, s[8:11], s36 offen offset:0 sc1 lds
  buffer_load_dwordx4 v9, s[8:11], s36 offen offset:1024 sc1 lds
  buffer_load_dwordx4 v10, s[8:11], s36 offen offset:2048 sc1 lds
  buffer_load_dwordx4 v11, s[8:11], s36 offen offset:3072 sc1 lds
  s_add_u32 m0, s38, s46
  s_nop 0
  buffer_load_dwordx4 v13, s[12:15], s37 offen offset:0  lds
  buffer_load_dwordx4 v14, s[12:15], s37 offen offset:1024  lds
  s_add_u32 m0, s38, s47
  s_nop 0
  buffer_load_dwordx4 v15, s[12:15], s37 offen offset:0  lds
  buffer_load_dwordx4 v16, s[12:15], s37 offen offset:1024  lds
  s_add_u32 m0, s38, s48
  s_nop 0
  buffer_load_dwordx4 v17, s[12:15], s37 offen offset:0  lds
  buffer_load_dwordx4 v18, s[12:15], s37 offen offset:1024  lds
  s_add_u32 s38, s38, 43008
  s_cmp_eq_u32 s38, 129024
  s_cselect_b32 s38, 0, s38
  global_load_dword v29, v134, s[62:63] sc0 sc1
  s_waitcnt vmcnt(11)
  s_barrier
  s_add_u32 s30, s30, 1
  s_and_b32 s30, s30, 7
  s_cselect_b32 s32, 0, 1
  s_add_u32 s31, s31, s32
  s_sub_u32 s32, s30, s7
  s_and_b32 s32, s32, 7
  s_cmp_lt_u32 s32, 2
  s_cselect_b32 s32, 1, 0
  s_add_u32 s32, s32, s31
  s_cmp_ge_u32 s32, 2
  s_cselect_b32 s32, 0, s32
  s_lshl_b32 s33, s32, 3
  s_add_u32 s33, s33, s30
  s_mul_i32 s36, s33, s54
  s_add_u32 s36, s36, s34
  s_mul_i32 s37, s33, 393216
  s_add_u32 s37, s37, s35
  s_add_u32 m0, s38, s45
  s_mov_b64 exec, s[52:53]
  buffer_load_dwordx4 v12, s[8:11], s36 offen offset:0 sc1 lds
  s_mov_b64 exec, -1
  s_add_u32 m0, s38, s44
  s_nop 0
  buffer_load_dwordx4 v8, s[8:11], s36 offen offset:0 sc1 lds
  buffer_load_dwordx4 v9, s[8:11], s36 offen offset:1024 sc1 lds
  buffer_load_dwordx4 v10, s[8:11], s36 offen offset:2048 sc1 lds
  buffer_load_dwordx4 v11, s[8:11], s36 offen offset:3072 sc1 lds
  s_add_u32 m0, s38, s46
  s_nop 0
  buffer_load_dwordx4 v13, s[12:15], s37 offen offset:0  lds
  buffer_load_dwordx4 v14, s[12:15], s37 offen offset:1024  lds
  s_add_u32 m0, s38, s47
  s_nop 0
  buffer_load_dwordx4 v15, s[12:15], s37 offen offset:0  lds
  buffer_load_dwordx4 v16, s[12:15], s37 offen offset:1024  lds
  s_add_u32 m0, s38, s48
  s_nop 0
  buffer_load_dwordx4 v17, s[12:15], s37 offen offset:0  lds
  buffer_load_dwordx4 v18, s[12:15], s37 offen offset:1024  lds
  s_add_u32 s38, s38, 43008
  s_cmp_eq_u32 s38, 129024
  s_cselect_b32 s38, 0, s38
  s_cmp_lg_u32 s3, 0
  s_cbranch_scc1 st10g
  s_waitcnt vmcnt(11)
  s_mov_b32 s61, 0
st10p:
  v_cmp_gt_u32 vcc, 64, v29
  s_add_u32 s61, s61, 1
  s_cmp_gt_u32 s61, 1000000
  s_cbranch_scc1 st10g
  s_cbranch_vccz st10g
  global_load_dword v29, v134, s[62:63] sc0 sc1
  s_waitcnt vmcnt(0)
  s_branch st10p
st10g:
  buffer_load_dwordx2 v[30:31], v27, s[20:23], 0 offen sc1
  s_mov_b32 s32, 32768
  buffer_load_dwordx2 v[32:33], v27, s[20:23], s32 offen sc1
  s_mov_b32 s32, 65536
  buffer_load_dwordx2 v[34:35], v27, s[20:23], s32 offen sc1
  s_mov_b32 s32, 98304
  buffer_load_dwordx2 v[36:37], v27, s[20:23], s32 offen sc1
  s_mov_b32 s32, 131072
  buffer_load_dwordx2 v[38:39], v27, s[20:23], s32 offen sc1
  s_mov_b32 s32, 163840
  buffer_load_dwordx2 v[40:41], v27, s[20:23], s32 offen sc1
  s_mov_b32 s32, 196608
  buffer_load_dwordx2 v[42:43], v27, s[20:23], s32 offen sc1
  s_mov_b32 s32, 229376
  buffer_load_dwordx2 v[44:45], v27, s[20:23], s32 offen sc1
  s_waitcnt vmcnt(19)
  s_barrier
  s_branch L_k1t
L_k1B:
  s_nop 7
  s_nop 7
  s_mov_b32 s30, 7
  s_mov_b32 s31, -1
  s_mov_b32 s38, 0
  s_add_u32 s30, s30, 1
  s_and_b32 s30, s30, 7
  s_cselect_b32 s32, 0, 1
  s_add_u32 s31, s31, s32
  s_sub_u32 s32, s30, s7
  s_and_b32 s32, s32, 7
  s_cmp_lt_u32 s32, 2
  s_cselect_b32 s32, 1, 0
  s_add_u32 s32, s32, s31
  s_cmp_ge_u32 s32, 2
  s_cselect_b32 s32, 0, s32
  s_lshl_b32 s33, s32, 3
  s_add_u32 s33, s33, s30
  s_mul_i32 s36, s33, s54
  s_add_u32 s36, s36, s34
  s_add_u32 m0, s38, s44
  s_nop 0
  buffer_load_dwordx4 v8, s[8:11], s36 offen offset:0 sc1 lds
  buffer_load_dwordx4 v9, s[8:11], s36 offen offset:1024 sc1 lds
  buffer_load_dwordx4 v10, s[8:11], s36 offen offset:2048 sc1 lds
  buffer_load_dwordx4 v11, s[8:11], s36 offen offset:3072 sc1 lds
  s_add_u32 s38, s38, 43008
  s_cmp_eq_u32 s38, 129024
  s_cselect_b32 s38, 0, s38
  s_add_u32 s30, s30, 1
  s_and_b32 s30, s30, 7
  s_cselect_b32 s32, 0, 1
  s_add_u32 s31, s31, s32
  s_sub_u32 s32, s30, s7
  s_and_b32 s32, s32, 7
  s_cmp_lt_u32 s32, 2
  s_cselect_b32 s32, 1, 0
  s_add_u32 s32, s32, s31
  s_cmp_ge_u32 s32, 2
  s_cselect_b32 s32, 0, s32
  s_lshl_b32 s33, s32, 3
  s_add_u32 s33, s33, s30
  s_mul_i32 s36, s33, s54
  s_add_u32 s36, s36, s34
  s_add_u32 m0, s38, s44
  s_nop 0
  buffer_load_dwordx4 v8, s[8:11], s36 offen offset:0 sc1 lds
  buffer_load_dwordx4 v9, s[8:11], s36 offen offset:1024 sc1 lds
  buffer_load_dwordx4 v10, s[8:11], s36 offen offset:2048 sc1 lds
  buffer_load_dwordx4 v11, s[8:11], s36 offen offset:3072 sc1 lds
  s_add_u32 s38, s38, 43008
  s_cmp_eq_u32 s38, 129024
  s_cselect_b32 s38, 0, s38
  s_waitcnt vmcnt(4)
  s_barrier
  s_add_u32 s30, s30, 1
  s_and_b32 s30, s30, 7
  s_cselect_b32 s32, 0, 1
  s_add_u32 s31, s31, s32
  s_sub_u32 s32, s30, s7
  s_and_b32 s32, s32, 7
  s_cmp_lt_u32 s32, 2
  s_cselect_b32 s32, 1, 0
  s_add_u32 s32, s32, s31
  s_cmp_ge_u32 s32, 2
  s_cselect_b32 s32, 0, s32
  s_lshl_b32 s33, s32, 3
  s_add_u32 s33, s33, s30
  s_mul_i32 s36, s33, s54
  s_add_u32 s36, s36, s34
  s_mul_i32 s37, s33, 393216
  s_add_u32 s37, s37, s35
  s_add_u32 m0, s38, s44
  s_nop 0
  buffer_load_dwordx4 v8, s[8:11], s36 offen offset:0 sc1 lds
  buffer_load_dwordx4 v9, s[8:11], s36 offen offset:1024 sc1 lds
  buffer_load_dwordx4 v10, s[8:11], s36 offen offset:2048 sc1 lds
  buffer_load_dwordx4 v11, s[8:11], s36 offen offset:3072 sc1 lds
  s_add_u32 m0, s38, s46
  s_nop 0
  buffer_load_dwordx4 v13, s[12:15], s37 offen offset:0  lds
  buffer_load_dwordx4 v14, s[12:15], s37 offen offset:1024  lds
  s_add_u32 m0, s38, s47
  s_nop 0
  buffer_load_dwordx4 v15, s[12:15], s37 offen offset:0  lds
  buffer_load_dwordx4 v16, s[12:15], s37 offen offset:1024  lds
  s_add_u32 m0, s38, s48
  s_nop 0
  buffer_load_dwordx4 v17, s[12:15], s37 offen offset:0  lds
  buffer_load_dwordx4 v18, s[12:15], s37 offen offset:1024  lds
  s_add_u32 s38, s38, 43008
  s_cmp_eq_u32 s38, 129024
  s_cselect_b32 s38, 0, s38
L_jB:
  s_nop 1
  s_waitcnt vmcnt(10)
  s_barrier
  s_add_u32 s30, s30, 1
  s_and_b32 s30, s30, 7
  s_cselect_b32 s32, 0, 1
  s_add_u32 s31, s31, s32
  s_sub_u32 s32, s30, s7
  s_and_b32 s32, s32, 7
  s_cmp_lt_u32 s32, 2
  s_cselect_b32 s32, 1, 0
  s_add_u32 s32, s32, s31
  s_cmp_ge_u32 s32, 2
  s_cselect_b32 s32, 0, s32
  s_lshl_b32 s33, s32, 3
  s_add_u32 s33, s33, s30
  s_mul_i32 s36, s33, s54
  s_add_u32 s36, s36, s34
  s_mul_i32 s37, s33, 393216
  s_add_u32 s37, s37, s35
  s_add_u32 m0, s38, s44
  s_nop 0
  buffer_load_dwordx4 v8, s[8:11], s36 offen offset:0 sc1 lds
  buffer_load_dwordx4 v9, s[8:11], s36 offen offset:1024 sc1 lds
  buffer_load_dwordx4 v10, s[8:11], s36 offen offset:2048 sc1 lds
  buffer_load_dwordx4 v11, s[8:11], s36 offen offset:3072 sc1 lds
  s_add_u32 m0, s38, s46
  s_nop 0
  buffer_load_dwordx4 v13, s[12:15], s37 offen offset:0  lds
  buffer_load_dwordx4 v14, s[12:15], s37 offen offset:1024  lds
  s_add_u32 m0, s38, s47
  s_nop 0
  buffer_load_dwordx4 v15, s[12:15], s37 offen offset:0  lds
  buffer_load_dwordx4 v16, s[12:15], s37 offen offset:1024  lds
  s_add_u32 m0, s38, s48
  s_nop 0
  buffer_load_dwordx4 v17, s[12:15], s37 offen offset:0  lds
  buffer_load_dwordx4 v18, s[12:15], s37 offen offset:1024  lds
  s_add_u32 s38, s38, 43008
  s_cmp_eq_u32 s38, 129024
  s_cselect_b32 s38, 0, s38
  s_waitcnt vmcnt(10)
  s_barrier
  s_add_u32 s30, s30, 1
  s_and_b32 s30, s30, 7
  s_cselect_b32 s32, 0, 1
  s_add_u32 s31, s31, s32
  s_sub_u32 s32, s30, s7
  s_and_b32 s32, s32, 7
  s_cmp_lt_u32 s32, 2
  s_cselect_b32 s32, 1, 0
  s_add_u32 s32, s32, s31
  s_cmp_ge_u32 s32, 2
  s_cselect_b32 s32, 0, s32
  s_lshl_b32 s33, s32, 3
  s_add_u32 s33, s33, s30
  s_mul_i32 s36, s33, s54
  s_add_u32 s36, s36, s34
  s_mul_i32 s37, s33, 393216
  s_add_u32 s37, s37, s35
  s_add_u32 m0, s38, s44
  s_nop 0
  buffer_load_dwordx4 v8, s[8:11], s36 offen offset:0 sc1 lds
  buffer_load_dwordx4 v9, s[8:11], s36 offen offset:1024 sc1 lds
  buffer_load_dwordx4 v10, s[8:11], s36 offen offset:2048 sc1 lds
  buffer_load_dwordx4 v11, s[8:11], s36 offen offset:3072 sc1 lds
  s_add_u32 m0, s38, s46
  s_nop 0
  buffer_load_dwordx4 v13, s[12:15], s37 offen offset:0  lds
  buffer_load_dwordx4 v14, s[12:15], s37 offen offset:1024  lds
  s_add_u32 m0, s38, s47
  s_nop 0
  buffer_load_dwordx4 v15, s[12:15], s37 offen offset:0  lds
  buffer_load_dwordx4 v16, s[12:15], s37 offen offset:1024  lds
  s_add_u32 m0, s38, s48
  s_nop 0
  buffer_load_dwordx4 v17, s[12:15], s37 offen offset:0  lds
  buffer_load_dwordx4 v18, s[12:15], s37 offen offset:1024  lds
  s_add_u32 s38, s38, 43008
  s_cmp_eq_u32 s38, 129024
  s_cselect_b32 s38, 0, s38
  s_cmp_lg_u32 s3, 0
  s_cbranch_scc1 e11
  s_cmp_lg_u32 s57, 0
  s_cbranch_scc1 g12
  s_mov_b64 exec, 1
  global_atomic_add v73, v74, s[62:63] sc1
  s_mov_b64 exec, -1
g12:
e11:
  s_nop 1
  s_mov_b32 s39, 9
ll13:
  s_waitcnt vmcnt(10)
  s_barrier
  s_add_u32 s30, s30, 1
  s_and_b32 s30, s30, 7
  s_cselect_b32 s32, 0, 1
  s_add_u32 s31, s31, s32
  s_sub_u32 s32, s30, s7
  s_and_b32 s32, s32, 7
  s_cmp_lt_u32 s32, 2
  s_cselect_b32 s32, 1, 0
  s_add_u32 s32, s32, s31
  s_cmp_ge_u32 s32, 2
  s_cselect_b32 s32, 0, s32
  s_lshl_b32 s33, s32, 3
  s_add_u32 s33, s33, s30
  s_mul_i32 s36, s33, s54
  s_add_u32 s36, s36, s34
  s_mul_i32 s37, s33, 393216
  s_add_u32 s37, s37, s35
  s_add_u32 m0, s38, s44
  s_nop 0
  buffer_load_dwordx4 v8, s[8:11], s36 offen offset:0 sc1 lds
  buffer_load_dwordx4 v9, s[8:11], s36 offen offset:1024 sc1 lds
  buffer_load_dwordx4 v10, s[8:11], s36 offen offset:2048 sc1 lds
  buffer_load_dwordx4 v11, s[8:11], s36 offen offset:3072 sc1 lds
  s_add_u32 m0, s38, s46
  s_nop 0
  buffer_load_dwordx4 v13, s[12:15], s37 offen offset:0  lds
  buffer_load_dwordx4 v14, s[12:15], s37 offen offset:1024  lds
  s_add_u32 m0, s38, s47
  s_nop 0
  buffer_load_dwordx4 v15, s[12:15], s37 offen offset:0  lds
  buffer_load_dwordx4 v16, s[12:15], s37 offen offset:1024  lds
  s_add_u32 m0, s38, s48
  s_nop 0
  buffer_load_dwordx4 v17, s[12:15], s37 offen offset:0  lds
  buffer_load_dwordx4 v18, s[12:15], s37 offen offset:1024  lds
  s_add_u32 s38, s38, 43008
  s_cmp_eq_u32 s38, 129024
  s_cselect_b32 s38, 0, s38
  s_sub_u32 s39, s39, 1
  s_cmp_lg_u32 s39, 0
  s_cbranch_scc1 ll13
  s_waitcnt vmcnt(10)
  s_barrier
  s_add_u32 s30, s30, 1
  s_and_b32 s30, s30, 7
  s_cselect_b32 s32, 0, 1
  s_add_u32 s31, s31, s32
  s_sub_u32 s32, s30, s7
  s_and_b32 s32, s32, 7
  s_cmp_lt_u32 s32, 2
  s_cselect_b32 s32, 1, 0
  s_add_u32 s32, s32, s31
  s_cmp_ge_u32 s32, 2
  s_cselect_b32 s32, 0, s32
  s_lshl_b32 s33, s32, 3
  s_add_u32 s33, s33, s30
  s_mul_i32 s36, s33, s54
  s_add_u32 s36, s36, s34
  s_mul_i32 s37, s33, 393216
  s_add_u32 s37, s37, s35
  s_add_u32 m0, s38, s44
  s_nop 0
  buffer_load_dwordx4 v8, s[8:11], s36 offen offset:0 sc1 lds
  buffer_load_dwordx4 v9, s[8:11], s36 offen offset:1024 sc1 lds
  buffer_load_dwordx4 v10, s[8:11], s36 offen offset:2048 sc1 lds
  buffer_load_dwordx4 v11, s[8:11], s36 offen offset:3072 sc1 lds
  s_add_u32 m0, s38, s46
  s_nop 0
  buffer_load_dwordx4 v13, s[12:15], s37 offen offset:0  lds
  buffer_load_dwordx4 v14, s[12:15], s37 offen offset:1024  lds
  s_add_u32 m0, s38, s47
  s_nop 0
  buffer_load_dwordx4 v15, s[12:15], s37 offen offset:0  lds
  buffer_load_dwordx4 v16, s[12:15], s37 offen offset:1024  lds
  s_add_u32 m0, s38, s48
  s_nop 0
  buffer_load_dwordx4 v17, s[12:15], s37 offen offset:0  lds
  buffer_load_dwordx4 v18, s[12:15], s37 offen offset:1024  lds
  s_add_u32 s38, s38, 43008
  s_cmp_eq_u32 s38, 129024
  s_cselect_b32 s38, 0, s38
  global_load_dword v29, v134, s[62:63] sc0 sc1
  s_waitcnt vmcnt(10)
  s_barrier
  s_add_u32 s30, s30, 1
  s_and_b32 s30, s30, 7
  s_cselect_b32 s32, 0, 1
  s_add_u32 s31, s31, s32
  s_sub_u32 s32, s30, s7
  s_and_b32 s32, s32, 7
  s_cmp_lt_u32 s32, 2
  s_cselect_b32 s32, 1, 0
  s_add_u32 s32, s32, s31
  s_cmp_ge_u32 s32, 2
  s_cselect_b32 s32, 0, s32
  s_lshl_b32 s33, s32, 3
  s_add_u32 s33, s33, s30
  s_mul_i32 s36, s33, s54
  s_add_u32 s36, s36, s34
  s_mul_i32 s37, s33, 393216
  s_add_u32 s37, s37, s35
  s_add_u32 m0, s38, s44
  s_nop 0
  buffer_load_dwordx4 v8, s[8:11], s36 offen offset:0 sc1 lds
  buffer_load_dwordx4 v9, s[8:11], s36 offen offset:1024 sc1 lds
  buffer_load_dwordx4 v10, s[8:11], s36 offen offset:2048 sc1 lds
  buffer_load_dwordx4 v11, s[8:11], s36 offen offset:3072 sc1 lds
  s_add_u32 m0, s38, s46
  s_nop 0
  buffer_load_dwordx4 v13, s[12:15], s37 offen offset:0  lds
  buffer_load_dwordx4 v14, s[12:15], s37 offen offset:1024  lds
  s_add_u32 m0, s38, s47
  s_nop 0
  buffer_load_dwordx4 v15, s[12:15], s37 offen offset:0  lds
  buffer_load_dwordx4 v16, s[12:15], s37 offen offset:1024  lds
  s_add_u32 m0, s38, s48
  s_nop 0
  buffer_load_dwordx4 v17, s[12:15], s37 offen offset:0  lds
  buffer_load_dwordx4 v18, s[12:15], s37 offen offset:1024  lds
  s_add_u32 s38, s38, 43008
  s_cmp_eq_u32 s38, 129024
  s_cselect_b32 s38, 0, s38
  s_cmp_lg_u32 s3, 0
  s_cbranch_scc1 st14g
  s_waitcnt vmcnt(10)
  s_mov_b32 s61, 0
st14p:
  v_cmp_gt_u32 vcc, 64, v29
  s_add_u32 s61, s61, 1
  s_cmp_gt_u32 s61, 1000000
  s_cbranch_scc1 st14g
  s_cbranch_vccz st14g
  global_load_dword v29, v134, s[62:63] sc0 sc1
  s_waitcnt vmcnt(0)
  s_branch st14p
st14g:
  buffer_load_dwordx2 v[30:31], v27, s[20:23], 0 offen sc1
  s_mov_b32 s32, 32768
  buffer_load_dwordx2 v[32:33], v27, s[20:23], s32 offen sc1
  s_mov_b32 s32, 65536
  buffer_load_dwordx2 v[34:35], v27, s[20:23], s32 offen sc1
  s_mov_b32 s32, 98304
  buffer_load_dwordx2 v[36:37], v27, s[20:23], s32 offen sc1
  s_mov_b32 s32, 131072
  buffer_load_dwordx2 v[38:39], v27, s[20:23], s32 offen sc1
  s_mov_b32 s32, 163840
  buffer_load_dwordx2 v[40:41], v27, s[20:23], s32 offen sc1
  s_mov_b32 s32, 196608
  buffer_load_dwordx2 v[42:43], v27, s[20:23], s32 offen sc1
  s_mov_b32 s32, 229376
  buffer_load_dwordx2 v[44:45], v27, s[20:23], s32 offen sc1
  s_waitcnt vmcnt(18)
  s_barrier
  s_branch L_k1t
L_first:
  s_nop 7
  s_nop 7
  s_cmp_ge_u32 s57, 2
  s_cbranch_scc1 L_firstB
  s_add_u32 s30, s30, 1
  s_and_b32 s30, s30, 7
  s_cselect_b32 s32, 0, 1
  s_add_u32 s31, s31, s32
  s_sub_u32 s32, s30, s7
  s_and_b32 s32, s32, 7
  s_cmp_lt_u32 s32, 2
  s_cselect_b32 s32, 1, 0
  s_add_u32 s32, s32, s31
  s_cmp_ge_u32 s32, 2
  s_cselect_b32 s32, 0, s32
  s_lshl_b32 s33, s32, 3
  s_add_u32 s33, s33, s30
  s_mul_i32 s36, s33, s54
  s_add_u32 s36, s36, s34
  s_mul_i32 s37, s33, 393216
  s_add_u32 s37, s37, s35
  s_add_u32 m0, s38, s45
  s_mov_b64 exec, s[52:53]
  buffer_load_dwordx4 v12, s[8:11], s36 offen offset:0 sc1 lds
  s_mov_b64 exec, -1
  s_add_u32 m0, s38, s44
  s_nop 0
  buffer_load_dwordx4 v8, s[8:11], s36 offen offset:0 sc1 lds
  buffer_load_dwordx4 v9, s[8:11], s36 offen offset:1024 sc1 lds
  buffer_load_dwordx4 v10, s[8:11], s36 offen offset:2048 sc1 lds
  buffer_load_dwordx4 v11, s[8:11], s36 offen offset:3072 sc1 lds
  s_add_u32 m0, s38, s46
  s_nop 0
  buffer_load_dwordx4 v13, s[12:15], s37 offen offset:0  lds
  buffer_load_dwordx4 v14, s[12:15], s37 offen offset:1024  lds
  s_add_u32 m0, s38, s47
  s_nop 0
  buffer_load_dwordx4 v15, s[12:15], s37 offen offset:0  lds
  buffer_load_dwordx4 v16, s[12:15], s37 offen offset:1024  lds
  s_add_u32 m0, s38, s48
  s_nop 0
  buffer_load_dwordx4 v17, s[12:15], s37 offen offset:0  lds
  buffer_load_dwordx4 v18, s[12:15], s37 offen offset:1024  lds
  s_add_u32 s38, s38, 43008
  s_cmp_eq_u32 s38, 129024
  s_cselect_b32 s38, 0, s38
  s_mov_b32 s16, s84
  s_mov_b32 s17, s85
  s_mov_b32 s18, 117440512
  s_mov_b32 s19, 0x20000
  s_add_u32 s20, s84, 42991616
  s_addc_u32 s21, s85, 0
  s_mov_b32 s22, 32768
  s_mov_b32 s23, 0x20000
  s_mov_b32 s82, s84
  s_mov_b32 s83, s85
  s_add_u32 s30, s30, 1
  s_and_b32 s30, s30, 7
  s_cselect_b32 s32, 0, 1
  s_add_u32 s31, s31, s32
  s_sub_u32 s32, s30, s7
  s_and_b32 s32, s32, 7
  s_cmp_lt_u32 s32, 2
  s_cselect_b32 s32, 1, 0
  s_add_u32 s32, s32, s31
  s_cmp_ge_u32 s32, 2
  s_cselect_b32 s32, 0, s32
  s_lshl_b32 s33, s32, 3
  s_add_u32 s33, s33, s30
  s_mul_i32 s36, s33, s54
  s_add_u32 s36, s36, s34
  s_mul_i32 s37, s33, 393216
  s_add_u32 s37, s37, s35
  s_add_u32 m0, s38, s45
  s_mov_b64 exec, s[52:53]
  buffer_load_dwordx4 v12, s[8:11], s36 offen offset:0 sc1 lds
  s_mov_b64 exec, -1
  s_add_u32 m0, s38, s44
  s_nop 0
  buffer_load_dwordx4 v8, s[8:11], s36 offen offset:0 sc1 lds
  buffer_load_dwordx4 v9, s[8:11], s36 offen offset:1024 sc1 lds
  buffer_load_dwordx4 v10, s[8:11], s36 offen offset:2048 sc1 lds
  buffer_load_dwordx4 v11, s[8:11], s36 offen offset:3072 sc1 lds
  s_add_u32 m0, s38, s46
  s_nop 0
  buffer_load_dwordx4 v13, s[12:15], s37 offen offset:0  lds
  buffer_load_dwordx4 v14, s[12:15], s37 offen offset:1024  lds
  s_add_u32 m0, s38, s47
  s_nop 0
  buffer_load_dwordx4 v15, s[12:15], s37 offen offset:0  lds
  buffer_load_dwordx4 v16, s[12:15], s37 offen offset:1024  lds
  s_add_u32 m0, s38, s48
  s_nop 0
  buffer_load_dwordx4 v17, s[12:15], s37 offen offset:0  lds
  buffer_load_dwordx4 v18, s[12:15], s37 offen offset:1024  lds
  s_add_u32 s38, s38, 43008
  s_cmp_eq_u32 s38, 129024
  s_cselect_b32 s38, 0, s38
  buffer_load_dwordx4 v[48:51], v46, s[8:11], 0 offen offset:0
  buffer_load_dwordx4 v[52:55], v46, s[8:11], 0 offen offset:512
  buffer_load_dwordx4 v[56:59], v46, s[8:11], 0 offen offset:1024
  buffer_load_dwordx4 v[60:63], v46, s[8:11], 0 offen offset:1536
  buffer_store_dwordx4 v[64:67], v47, s[16:19], s58 offen sc0 sc1
  s_barrier
  s_waitcnt vmcnt(16)
  s_barrier
  s_add_u32 s30, s30, 1
  s_and_b32 s30, s30, 7
  s_cselect_b32 s32, 0, 1
  s_add_u32 s31, s31, s32
  s_sub_u32 s32, s30, s7
  s_and_b32 s32, s32, 7
  s_cmp_lt_u32 s32, 2
  s_cselect_b32 s32, 1, 0
  s_add_u32 s32, s32, s31
  s_cmp_ge_u32 s32, 2
  s_cselect_b32 s32, 0, s32
  s_lshl_b32 s33, s32, 3
  s_add_u32 s33, s33, s30
  s_mul_i32 s36, s33, s54
  s_add_u32 s36, s36, s34
  s_mul_i32 s37, s33, 393216
  s_add_u32 s37, s37, s35
  s_add_u32 m0, s38, s45
  s_mov_b64 exec, s[52:53]
  buffer_load_dwordx4 v12, s[8:11], s36 offen offset:0 sc1 lds
  s_mov_b64 exec, -1
  s_add_u32 m0, s38, s44
  s_nop 0
  buffer_load_dwordx4 v8, s[8:11], s36 offen offset:0 sc1 lds
  buffer_load_dwordx4 v9, s[8:11], s36 offen offset:1024 sc1 lds
  buffer_load_dwordx4 v10, s[8:11], s36 offen offset:2048 sc1 lds
  buffer_load_dwordx4 v11, s[8:11], s36 offen offset:3072 sc1 lds
  s_add_u32 m0, s38, s46
  s_nop 0
  buffer_load_dwordx4 v13, s[12:15], s37 offen offset:0  lds
  buffer_load_dwordx4 v14, s[12:15], s37 offen offset:1024  lds
  s_add_u32 m0, s38, s47
  s_nop 0
  buffer_load_dwordx4 v15, s[12:15], s37 offen offset:0  lds
  buffer_load_dwordx4 v16, s[12:15], s37 offen offset:1024  lds
  s_add_u32 m0, s38, s48
  s_nop 0
  buffer_load_dwordx4 v17, s[12:15], s37 offen offset:0  lds
  buffer_load_dwordx4 v18, s[12:15], s37 offen offset:1024  lds
  s_add_u32 s38, s38, 43008
  s_cmp_eq_u32 s38, 129024
  s_cselect_b32 s38, 0, s38
  v_mov_b32 v68, 0
  v_mov_b32 v69, 0
  v_mov_b32 v70, 0x3f803f80
  s_waitcnt vmcnt(12)
  v_dot2c_f32_bf16 v68, v70, v48
  v_dot2c_f32_bf16 v69, v48, v48
  v_dot2c_f32_bf16 v68, v70, v49
  v_dot2c_f32_bf16 v69, v49, v49
  v_dot2c_f32_bf16 v68, v70, v50
  v_dot2c_f32_bf16 v69, v50, v50
  v_dot2c_f32_bf16 v68, v70, v51
  v_dot2c_f32_bf16 v69, v51, v51
  v_dot2c_f32_bf16 v68, v70, v52
  v_dot2c_f32_bf16 v69, v52, v52
  v_dot2c_f32_bf16 v68, v70, v53
  v_dot2c_f32_bf16 v69, v53, v53
  v_dot2c_f32_bf16 v68, v70, v54
  v_dot2c_f32_bf16 v69, v54, v54
  v_dot2c_f32_bf16 v68, v70, v55
  v_dot2c_f32_bf16 v69, v55, v55
  v_dot2c_f32_bf16 v68, v70, v56
  v_dot2c_f32_bf16 v69, v56, v56
  v_dot2c_f32_bf16 v68, v70, v57
  v_dot2c_f32_bf16 v69, v57, v57
  v_dot2c_f32_bf16 v68, v70, v58
  v_dot2c_f32_bf16 v69, v58, v58
  v_dot2c_f32_bf16 v68, v70, v59
  v_dot2c_f32_bf16 v69, v59, v59
  v_dot2c_f32_bf16 v68, v70, v60
  v_dot2c_f32_bf16 v69, v60, v60
  v_dot2c_f32_bf16 v68, v70, v61
  v_dot2c_f32_bf16 v69, v61, v61
  v_dot2c_f32_bf16 v68, v70, v62
  v_dot2c_f32_bf16 v69, v62, v62
  v_dot2c_f32_bf16 v68, v70, v63
  v_dot2c_f32_bf16 v69, v63, v63
  s_nop 1
  v_add_f32_dpp v68, v68, v68 quad_perm:[1,0,3,2] row_mask:0xf bank_mask:0xf
  v_add_f32_dpp v69, v69, v69 quad_perm:[1,0,3,2] row_mask:0xf bank_mask:0xf
  s_nop 0
  v_add_f32_dpp v68, v68, v68 quad_perm:[2,3,0,1] row_mask:0xf bank_mask:0xf
  v_add_f32_dpp v69, v69, v69 quad_perm:[2,3,0,1] row_mask:0xf bank_mask:0xf
  s_nop 0
  v_add_f32_dpp v68, v68, v68 row_half_mirror row_mask:0xf bank_mask:0xf
  v_add_f32_dpp v69, v69, v69 row_half_mirror row_mask:0xf bank_mask:0xf
  s_nop 0
  v_add_f32_dpp v68, v68, v68 row_mirror row_mask:0xf bank_mask:0xf
  v_add_f32_dpp v69, v69, v69 row_mirror row_mask:0xf bank_mask:0xf
  v_mov_b32 v70, v68
  v_mov_b32 v71, v69
  s_nop 0
  v_permlane16_swap_b32 v68, v70
  v_permlane16_swap_b32 v69, v71
  v_add_f32 v68, v68, v70
  v_add_f32 v69, v69, v71
  s_mov_b32 exec_lo, 1
  s_mov_b32 exec_hi, 1
  buffer_store_dwordx2 v[68:69], v72, s[16:19], 0 offen sc0 sc1
  s_mov_b64 exec, -1
  s_branch L_jA
L_firstB:
  s_nop 7
  s_nop 7
  s_add_u32 s30, s30, 1
  s_and_b32 s30, s30, 7
  s_cselect_b32 s32, 0, 1
  s_add_u32 s31, s31, s32
  s_sub_u32 s32, s30, s7
  s_and_b32 s32, s32, 7
  s_cmp_lt_u32 s32, 2
  s_cselect_b32 s32, 1, 0
  s_add_u32 s32, s32, s31
  s_cmp_ge_u32 s32, 2
  s_cselect_b32 s32, 0, s32
  s_lshl_b32 s33, s32, 3
  s_add_u32 s33, s33, s30
  s_mul_i32 s36, s33, s54
  s_add_u32 s36, s36, s34
  s_mul_i32 s37, s33, 393216
  s_add_u32 s37, s37, s35
  s_add_u32 m0, s38, s44
  s_nop 0
  buffer_load_dwordx4 v8, s[8:11], s36 offen offset:0 sc1 lds
  buffer_load_dwordx4 v9, s[8:11], s36 offen offset:1024 sc1 lds
  buffer_load_dwordx4 v10, s[8:11], s36 offen offset:2048 sc1 lds
  buffer_load_dwordx4 v11, s[8:11], s36 offen offset:3072 sc1 lds
  s_add_u32 m0, s38, s46
  s_nop 0
  buffer_load_dwordx4 v13, s[12:15], s37 offen offset:0  lds
  buffer_load_dwordx4 v14, s[12:15], s37 offen offset:1024  lds
  s_add_u32 m0, s38, s47
  s_nop 0
  buffer_load_dwordx4 v15, s[12:15], s37 offen offset:0  lds
  buffer_load_dwordx4 v16, s[12:15], s37 offen offset:1024  lds
  s_add_u32 m0, s38, s48
  s_nop 0
  buffer_load_dwordx4 v17, s[12:15], s37 offen offset:0  lds
  buffer_load_dwordx4 v18, s[12:15], s37 offen offset:1024  lds
  s_add_u32 s38, s38, 43008
  s_cmp_eq_u32 s38, 129024
  s_cselect_b32 s38, 0, s38
  s_mov_b32 s16, s84
  s_mov_b32 s17, s85
  s_mov_b32 s18, 117440512
  s_mov_b32 s19, 0x20000
  s_add_u32 s20, s84, 42991616
  s_addc_u32 s21, s85, 0
  s_mov_b32 s22, 32768
  s_mov_b32 s23, 0x20000
  s_mov_b32 s82, s84
  s_mov_b32 s83, s85
  s_add_u32 s30, s30, 1
  s_and_b32 s30, s30, 7
  s_cselect_b32 s32, 0, 1
  s_add_u32 s31, s31, s32
  s_sub_u32 s32, s30, s7
  s_and_b32 s32, s32, 7
  s_cmp_lt_u32 s32, 2
  s_cselect_b32 s32, 1, 0
  s_add_u32 s32, s32, s31
  s_cmp_ge_u32 s32, 2
  s_cselect_b32 s32, 0, s32
  s_lshl_b32 s33, s32, 3
  s_add_u32 s33, s33, s30
  s_mul_i32 s36, s33, s54
  s_add_u32 s36, s36, s34
  s_mul_i32 s37, s33, 393216
  s_add_u32 s37, s37, s35
  s_add_u32 m0, s38, s44
  s_nop 0
  buffer_load_dwordx4 v8, s[8:11], s36 offen offset:0 sc1 lds
  buffer_load_dwordx4 v9, s[8:11], s36 offen offset:1024 sc1 lds
  buffer_load_dwordx4 v10, s[8:11], s36 offen offset:2048 sc1 lds
  buffer_load_dwordx4 v11, s[8:11], s36 offen offset:3072 sc1 lds
  s_add_u32 m0, s38, s46
  s_nop 0
  buffer_load_dwordx4 v13, s[12:15], s37 offen offset:0  lds
  buffer_load_dwordx4 v14, s[12:15], s37 offen offset:1024  lds
  s_add_u32 m0, s38, s47
  s_nop 0
  buffer_load_dwordx4 v15, s[12:15], s37 offen offset:0  lds
  buffer_load_dwordx4 v16, s[12:15], s37 offen offset:1024  lds
  s_add_u32 m0, s38, s48
  s_nop 0
  buffer_load_dwordx4 v17, s[12:15], s37 offen offset:0  lds
  buffer_load_dwordx4 v18, s[12:15], s37 offen offset:1024  lds
  s_add_u32 s38, s38, 43008
  s_cmp_eq_u32 s38, 129024
  s_cselect_b32 s38, 0, s38
  buffer_load_dwordx4 v[48:51], v46, s[8:11], 0 offen offset:0
  buffer_load_dwordx4 v[52:55], v46, s[8:11], 0 offen offset:512
  buffer_load_dwordx4 v[56:59], v46, s[8:11], 0 offen offset:1024
  buffer_load_dwordx4 v[60:63], v46, s[8:11], 0 offen offset:1536
  buffer_store_dwordx4 v[64:67], v47, s[16:19], s58 offen sc0 sc1
  s_barrier
  s_waitcnt vmcnt(15)
  s_barrier
  s_add_u32 s30, s30, 1
  s_and_b32 s30, s30, 7
  s_cselect_b32 s32, 0, 1
  s_add_u32 s31, s31, s32
  s_sub_u32 s32, s30, s7
  s_and_b32 s32, s32, 7
  s_cmp_lt_u32 s32, 2
  s_cselect_b32 s32, 1, 0
  s_add_u32 s32, s32, s31
  s_cmp_ge_u32 s32, 2
  s_cselect_b32 s32, 0, s32
  s_lshl_b32 s33, s32, 3
  s_add_u32 s33, s33, s30
  s_mul_i32 s36, s33, s54
  s_add_u32 s36, s36, s34
  s_mul_i32 s37, s33, 393216
  s_add_u32 s37, s37, s35
  s_add_u32 m0, s38, s44
  s_nop 0
  buffer_load_dwordx4 v8, s[8:11], s36 offen offset:0 sc1 lds
  buffer_load_dwordx4 v9, s[8:11], s36 offen offset:1024 sc1 lds
  buffer_load_dwordx4 v10, s[8:11], s36 offen offset:2048 sc1 lds
  buffer_load_dwordx4 v11, s[8:11], s36 offen offset:3072 sc1 lds
  s_add_u32 m0, s38, s46
  s_nop 0
  buffer_load_dwordx4 v13, s[12:15], s37 offen offset:0  lds
  buffer_load_dwordx4 v14, s[12:15], s37 offen offset:1024  lds
  s_add_u32 m0, s38, s47
  s_nop 0
  buffer_load_dwordx4 v15, s[12:15], s37 offen offset:0  lds
  buffer_load_dwordx4 v16, s[12:15], s37 offen offset:1024  lds
  s_add_u32 m0, s38, s48
  s_nop 0
  buffer_load_dwordx4 v17, s[12:15], s37 offen offset:0  lds
  buffer_load_dwordx4 v18, s[12:15], s37 offen offset:1024  lds
  s_add_u32 s38, s38, 43008
  s_cmp_eq_u32 s38, 129024
  s_cselect_b32 s38, 0, s38
  v_mov_b32 v68, 0
  v_mov_b32 v69, 0
  v_mov_b32 v70, 0x3f803f80
  s_waitcnt vmcnt(11)
  v_dot2c_f32_bf16 v68, v70, v48
  v_dot2c_f32_bf16 v69, v48, v48
  v_dot2c_f32_bf16 v68, v70, v49
  v_dot2c_f32_bf16 v69, v49, v49
  v_dot2c_f32_bf16 v68, v70, v50
  v_dot2c_f32_bf16 v69, v50, v50
  v_dot2c_f32_bf16 v68, v70, v51
  v_dot2c_f32_bf16 v69, v51, v51
  v_dot2c_f32_bf16 v68, v70, v52
  v_dot2c_f32_bf16 v69, v52, v52
  v_dot2c_f32_bf16 v68, v70, v53
  v_dot2c_f32_bf16 v69, v53, v53
  v_dot2c_f32_bf16 v68, v70, v54
  v_dot2c_f32_bf16 v69, v54, v54
  v_dot2c_f32_bf16 v68, v70, v55
  v_dot2c_f32_bf16 v69, v55, v55
  v_dot2c_f32_bf16 v68, v70, v56
  v_dot2c_f32_bf16 v69, v56, v56
  v_dot2c_f32_bf16 v68, v70, v57
  v_dot2c_f32_bf16 v69, v57, v57
  v_dot2c_f32_bf16 v68, v70, v58
  v_dot2c_f32_bf16 v69, v58, v58
  v_dot2c_f32_bf16 v68, v70, v59
  v_dot2c_f32_bf16 v69, v59, v59
  v_dot2c_f32_bf16 v68, v70, v60
  v_dot2c_f32_bf16 v69, v60, v60
  v_dot2c_f32_bf16 v68, v70, v61
  v_dot2c_f32_bf16 v69, v61, v61
  v_dot2c_f32_bf16 v68, v70, v62
  v_dot2c_f32_bf16 v69, v62, v62
  v_dot2c_f32_bf16 v68, v70, v63
  v_dot2c_f32_bf16 v69, v63, v63
  s_nop 1
  v_add_f32_dpp v68, v68, v68 quad_perm:[1,0,3,2] row_mask:0xf bank_mask:0xf
  v_add_f32_dpp v69, v69, v69 quad_perm:[1,0,3,2] row_mask:0xf bank_mask:0xf
  s_nop 0
  v_add_f32_dpp v68, v68, v68 quad_perm:[2,3,0,1] row_mask:0xf bank_mask:0xf
  v_add_f32_dpp v69, v69, v69 quad_perm:[2,3,0,1] row_mask:0xf bank_mask:0xf
  s_nop 0
  v_add_f32_dpp v68, v68, v68 row_half_mirror row_mask:0xf bank_mask:0xf
  v_add_f32_dpp v69, v69, v69 row_half_mirror row_mask:0xf bank_mask:0xf
  s_nop 0
  v_add_f32_dpp v68, v68, v68 row_mirror row_mask:0xf bank_mask:0xf
  v_add_f32_dpp v69, v69, v69 row_mirror row_mask:0xf bank_mask:0xf
  v_mov_b32 v70, v68
  v_mov_b32 v71, v69
  s_nop 0
  v_permlane16_swap_b32 v68, v70
  v_permlane16_swap_b32 v69, v71
  v_add_f32 v68, v68, v70
  v_add_f32 v69, v69, v71
  s_mov_b32 exec_lo, 1
  s_mov_b32 exec_hi, 1
  buffer_store_dwordx2 v[68:69], v72, s[16:19], 0 offen sc0 sc1
  s_mov_b64 exec, -1
  s_branch L_jB
L_k1t:
  s_nop 7
  s_nop 7
  s_waitcnt vmcnt(0)
  v_pk_add_f32 v[30:31], v[30:31], v[32:33]
  v_pk_add_f32 v[34:35], v[34:35], v[36:37]
  v_pk_add_f32 v[38:39], v[38:39], v[40:41]
  v_pk_add_f32 v[42:43], v[42:43], v[44:45]
  v_pk_add_f32 v[30:31], v[30:31], v[34:35]
  v_pk_add_f32 v[38:39], v[38:39], v[42:43]
  v_pk_add_f32 v[30:31], v[30:31], v[38:39]
  v_mul_f32 v30, 0x3a800000, v30
  v_mul_f32 v31, 0x3a800000, v31
  v_fma_f32 v31, -v30, v30, v31
  v_max_f32 v31, 0, v31
  v_mov_b32 v32, v31
  v_cvt_pk_bf16_f32 v32, v32, v32
  v_lshlrev_b32 v32, 16, v32
  v_add_f32 v32, 0x3727c5ac, v32
  v_cvt_pk_bf16_f32 v32, v32, v32
  v_lshlrev_b32 v32, 16, v32
  v_sqrt_f32 v32, v32
  s_nop 0
  v_cvt_pk_bf16_f32 v32, v32, v32
  v_lshlrev_b32 v32, 16, v32
  v_rcp_f32 v32, v32
  v_cvt_pk_bf16_f32 v30, v30, v30
  v_lshlrev_b32 v30, 16, v30
  v_mov_b32 v31, v32
  ds_write_b64 v26, v[30:31]
  s_waitcnt lgkmcnt(0)
  s_mov_b32 s41, s57
  s_mul_i32 s32, s41, 16
  s_add_u32 s32, s32, 0
  v_lshrrev_b32 v2, 3, v0
  v_add_u32 v2, s32, v2
  v_bfe_u32 v3, v2, 1, 1
  v_bfe_u32 v4, v2, 3, 1
  v_lshl_or_b32 v3, v4, 1, v3
  v_lshlrev_b32 v3, 1, v3
  v_and_b32 v4, 7, v0
  v_xor_b32 v3, v3, v4
  v_lshlrev_b32 v3, 4, v3
  s_mov_b32 s32, 2048
  v_mul_lo_u32 v2, v2, s32
  v_add_u32 v130, v2, v3
  s_mul_i32 s32, s41, 16
  s_add_u32 s32, s32, 8
  v_lshrrev_b32 v2, 3, v0
  v_add_u32 v2, s32, v2
  v_bfe_u32 v3, v2, 1, 1
  v_bfe_u32 v4, v2, 3, 1
  v_lshl_or_b32 v3, v4, 1, v3
  v_lshlrev_b32 v3, 1, v3
  v_and_b32 v4, 7, v0
  v_xor_b32 v3, v3, v4
  v_lshlrev_b32 v3, 4, v3
  s_mov_b32 s32, 2048
  v_mul_lo_u32 v2, v2, s32
  v_add_u32 v131, v2, v3
  v_subrev_u32 v131, 1024, v131
  s_mov_b32 s12, s68
  s_mov_b32 s13, s69
  s_mov_b32 s14, 2097152
  s_mov_b32 s15, 0x20000
  s_mov_b32 s30, 7
  s_mov_b32 s31, -1
  s_lshl_b32 s52, s57, 11
  s_add_u32 s30, s30, 1
  s_and_b32 s30, s30, 7
  s_cselect_b32 s32, 0, 1
  s_add_u32 s31, s31, s32
  s_sub_u32 s32, s30, s7
  s_and_b32 s32, s32, 7
  s_cmp_lt_u32 s32, 2
  s_cselect_b32 s32, 1, 0
  s_add_u32 s32, s32, s31
  s_cmp_ge_u32 s32, 2
  s_cselect_b32 s32, 0, s32
  s_lshl_b32 s33, s32, 3
  s_add_u32 s33, s33, s30
  s_lshl_b32 s37, s33, 17
  s_add_u32 s37, s37, s35
  s_add_u32 m0, s52, 131072
  s_nop 0
  buffer_load_dwordx4 v130, s[12:15], s37 offen lds
  buffer_load_dwordx4 v131, s[12:15], s37 offen offset:1024 lds
  s_add_u32 s30, s30, 1
  s_and_b32 s30, s30, 7
  s_cselect_b32 s32, 0, 1
  s_add_u32 s31, s31, s32
  s_sub_u32 s32, s30, s7
  s_and_b32 s32, s32, 7
  s_cmp_lt_u32 s32, 2
  s_cselect_b32 s32, 1, 0
  s_add_u32 s32, s32, s31
  s_cmp_ge_u32 s32, 2
  s_cselect_b32 s32, 0, s32
  s_lshl_b32 s33, s32, 3
  s_add_u32 s33, s33, s30
  s_lshl_b32 s37, s33, 17
  s_add_u32 s37, s37, s35
  s_add_u32 m0, s52, 139264
  s_nop 0
  buffer_load_dwordx4 v130, s[12:15], s37 offen lds
  buffer_load_dwordx4 v131, s[12:15], s37 offen offset:1024 lds
  s_add_u32 s30, s30, 1
  s_and_b32 s30, s30, 7
  s_cselect_b32 s32, 0, 1
  s_add_u32 s31, s31, s32
  s_sub_u32 s32, s30, s7
  s_and_b32 s32, s32, 7
  s_cmp_lt_u32 s32, 2
  s_cselect_b32 s32, 1, 0
  s_add_u32 s32, s32, s31
  s_cmp_ge_u32 s32, 2
  s_cselect_b32 s32, 0, s32
  s_lshl_b32 s33, s32, 3
  s_add_u32 s33, s33, s30
  s_lshl_b32 s37, s33, 17
  s_add_u32 s37, s37, s35
  s_add_u32 m0, s52, 147456
  s_nop 0
  buffer_load_dwordx4 v130, s[12:15], s37 offen lds
  buffer_load_dwordx4 v131, s[12:15], s37 offen offset:1024 lds
  s_add_u32 s30, s30, 1
  s_and_b32 s30, s30, 7
  s_cselect_b32 s32, 0, 1
  s_add_u32 s31, s31, s32
  s_sub_u32 s32, s30, s7
  s_and_b32 s32, s32, 7
  s_cmp_lt_u32 s32, 2
  s_cselect_b32 s32, 1, 0
  s_add_u32 s32, s32, s31
  s_cmp_ge_u32 s32, 2
  s_cselect_b32 s32, 0, s32
  s_lshl_b32 s33, s32, 3
  s_add_u32 s33, s33, s30
  s_lshl_b32 s37, s33, 17
  s_add_u32 s37, s37, s35
  s_add_u32 m0, s52, 155648
  s_nop 0
  buffer_load_dwordx4 v130, s[12:15], s37 offen lds
  buffer_load_dwordx4 v131, s[12:15], s37 offen offset:1024 lds
  s_waitcnt vmcnt(8)
  s_barrier
  s_add_u32 s30, s30, 1
  s_and_b32 s30, s30, 7
  s_cselect_b32 s32, 0, 1
  s_add_u32 s31, s31, s32
  s_sub_u32 s32, s30, s7
  s_and_b32 s32, s32, 7
  s_cmp_lt_u32 s32, 2
  s_cselect_b32 s32, 1, 0
  s_add_u32 s32, s32, s31
  s_cmp_ge_u32 s32, 2
  s_cselect_b32 s32, 0, s32
  s_lshl_b32 s33, s32, 3
  s_add_u32 s33, s33, s30
  s_lshl_b32 s37, s33, 17
  s_add_u32 s37, s37, s35
  s_add_u32 m0, s52, 100608
  s_nop 0
  buffer_load_dwordx4 v130, s[12:15], s37 offen lds
  buffer_load_dwordx4 v131, s[12:15], s37 offen offset:1024 lds
  s_add_u32 s30, s30, 1
  s_and_b32 s30, s30, 7
  s_cselect_b32 s32, 0, 1
  s_add_u32 s31, s31, s32
  s_sub_u32 s32, s30, s7
  s_and_b32 s32, s32, 7
  s_cmp_lt_u32 s32, 2
  s_cselect_b32 s32, 1, 0
  s_add_u32 s32, s32, s31
  s_cmp_ge_u32 s32, 2
  s_cselect_b32 s32, 0, s32
  s_lshl_b32 s33, s32, 3
  s_add_u32 s33, s33, s30
  s_lshl_b32 s37, s33, 17
  s_add_u32 s37, s37, s35
  s_add_u32 m0, s52, 108800
  s_nop 0
  buffer_load_dwordx4 v130, s[12:15], s37 offen lds
  buffer_load_dwordx4 v131, s[12:15], s37 offen offset:1024 lds
  s_add_u32 s30, s30, 1
  s_and_b32 s30, s30, 7
  s_cselect_b32 s32, 0, 1
  s_add_u32 s31, s31, s32
  s_sub_u32 s32, s30, s7
  s_and_b32 s32, s32, 7
  s_cmp_lt_u32 s32, 2
  s_cselect_b32 s32, 1, 0
  s_add_u32 s32, s32, s31
  s_cmp_ge_u32 s32, 2
  s_cselect_b32 s32, 0, s32
  s_lshl_b32 s33, s32, 3
  s_add_u32 s33, s33, s30
  s_lshl_b32 s37, s33, 17
  s_add_u32 s37, s37, s35
  s_add_u32 m0, s52, 116992
  s_nop 0
  buffer_load_dwordx4 v130, s[12:15], s37 offen lds
  buffer_load_dwordx4 v131, s[12:15], s37 offen offset:1024 lds
  s_cmp_lg_u32 s3, 0
  s_cbranch_scc1 e15
  v_and_b32 v4, 15, v0
  v_lshrrev_b32 v5, 4, v0
  v_lshrrev_b32 v6, 2, v4
  v_and_b32 v7, 3, v0
  v_lshrrev_b32 v3, 5, v0
  v_and_b32 v2, 1, v5
  v_lshl_or_b32 v3, v2, 1, v3
  s_lshr_b32 s40, s4, 1
  s_and_b32 s41, s4, 1
  s_mul_i32 s32, s41, 28800
  s_add_u32 s32, s32, 43008
  s_lshl_b32 s49, s40, 4
  v_add_u32 v76, s49, v4
  v_lshlrev_b32 v77, 4, v5
  v_add_u32 v77, s32, v77
  v_mul_u32_u24 v78, 400, v76
  v_add_u32 v220, v78, v77
  v_add_u32 v223, 3200, v220
  v_add_u32 v220, 128, v220
  v_add_u32 v76, 16, v76
  v_min_u32 v76, 71, v76
  v_mul_u32_u24 v78, 400, v76
  v_add3_u32 v221, v78, v77, 64
  v_add_u32 v221, 64, v221
  v_lshl_add_u32 v76, v5, 2, v6
  v_add_u32 v76, s49, v76
  v_lshlrev_b32 v77, 4, v7
  v_add_u32 v77, s32, v77
  v_add_u32 v77, 256, v77
  v_mul_u32_u24 v78, 400, v76
  v_add_u32 v222, v78, v77
  v_add_u32 v76, 16, v76
  v_min_u32 v76, 71, v76
  v_mul_u32_u24 v78, 400, v76
  v_add_u32 v254, v78, v77
  s_lshl_b32 s50, s28, 2
  s_add_u32 s50, s50, s40
  s_lshl_b32 s50, s50, 17
  s_lshl_b32 s51, s29, 13
  s_add_u32 s50, s50, s51
  s_lshl_b32 s51, s41, 11
  s_add_u32 s50, s50, s51
  s_and_b32 s51, s40, 1
  s_lshl_b32 s32, s51, 1
  s_add_u32 s32, s32, s41
  s_cmp_eq_u32 s32, 3
  s_addc_u32 s32, s32, 5
  s_lshl_b32 s32, s32, 7
  s_mov_b32 vcc_lo, 0xff000000
  s_mov_b32 vcc_hi, 0
  v_mov_b32 v1, s32
  v_cndmask_b32 v1, 0, v1, vcc
  v_lshl_add_u32 v1, v0, 4, v1
  v_add_u32 v1, s50, v1
  v_lshlrev_b32 v76, 2, v5
  v_sub_u32 v76, v76, v4
  s_or_b32 s51, s28, s40
  s_cmp_eq_u32 s51, 0
  s_cselect_b32 s51, 0, -1
  v_add_u32 v77, -1, v76
  v_cmp_gt_u32 s[86:87], 8, v77
  v_add_u32 v77, 0, v76
  v_cmp_gt_u32 s[88:89], 8, v77
  v_add_u32 v77, 1, v76
  v_cmp_gt_u32 s[90:91], 8, v77
  v_add_u32 v77, 2, v76
  v_cmp_gt_u32 s[92:93], 8, v77
  v_add_u32 v77, 15, v76
  v_cmp_gt_u32 s[94:95], 8, v77
  v_add_u32 v77, 16, v76
  v_cmp_gt_u32 s[96:97], 8, v77
  v_add_u32 v77, 17, v76
  v_cmp_gt_u32 s[98:99], 8, v77
  v_add_u32 v77, 18, v76
  v_cmp_gt_u32 s[100:101], 8, v77
  s_and_b32 s86, s86, s51
  s_and_b32 s88, s88, s51
  s_and_b32 s90, s90, s51
  s_and_b32 s92, s92, s51
e15:
  s_nop 1
  s_waitcnt lgkmcnt(0)
  s_barrier
  s_add_u32 s30, s30, 1
  s_and_b32 s30, s30, 7
  s_cselect_b32 s32, 0, 1
  s_add_u32 s31, s31, s32
  s_sub_u32 s32, s30, s7
  s_and_b32 s32, s32, 7
  s_cmp_lt_u32 s32, 2
  s_cselect_b32 s32, 1, 0
  s_add_u32 s32, s32, s31
  s_cmp_ge_u32 s32, 2
  s_cselect_b32 s32, 0, s32
  s_lshl_b32 s33, s32, 3
  s_add_u32 s33, s33, s30
  s_lshl_b32 s37, s33, 17
  s_add_u32 s37, s37, s35
  s_add_u32 m0, s52, 0
  s_nop 0
  buffer_load_dwordx4 v130, s[12:15], s37 offen lds
  buffer_load_dwordx4 v131, s[12:15], s37 offen offset:1024 lds
  s_add_u32 s30, s30, 1
  s_and_b32 s30, s30, 7
  s_cselect_b32 s32, 0, 1
  s_add_u32 s31, s31, s32
  s_sub_u32 s32, s30, s7
  s_and_b32 s32, s32, 7
  s_cmp_lt_u32 s32, 2
  s_cselect_b32 s32, 1, 0
  s_add_u32 s32, s32, s31
  s_cmp_ge_u32 s32, 2
  s_cselect_b32 s32, 0, s32
  s_lshl_b32 s33, s32, 3
  s_add_u32 s33, s33, s30
  s_lshl_b32 s37, s33, 17
  s_add_u32 s37, s37, s35
  s_add_u32 m0, s52, 8192
  s_nop 0
  buffer_load_dwordx4 v130, s[12:15], s37 offen lds
  buffer_load_dwordx4 v131, s[12:15], s37 offen offset:1024 lds
  s_add_u32 s30, s30, 1
  s_and_b32 s30, s30, 7
  s_cselect_b32 s32, 0, 1
  s_add_u32 s31, s31, s32
  s_sub_u32 s32, s30, s7
  s_and_b32 s32, s32, 7
  s_cmp_lt_u32 s32, 2
  s_cselect_b32 s32, 1, 0
  s_add_u32 s32, s32, s31
  s_cmp_ge_u32 s32, 2
  s_cselect_b32 s32, 0, s32
  s_lshl_b32 s33, s32, 3
  s_add_u32 s33, s33, s30
  s_lshl_b32 s37, s33, 17
  s_add_u32 s37, s37, s35
  s_add_u32 m0, s52, 16384
  s_nop 0
  buffer_load_dwordx4 v130, s[12:15], s37 offen lds
  buffer_load_dwordx4 v131, s[12:15], s37 offen offset:1024 lds
  s_add_u32 s30, s30, 1
  s_and_b32 s30, s30, 7
  s_cselect_b32 s32, 0, 1
  s_add_u32 s31, s31, s32
  s_sub_u32 s32, s30, s7
  s_and_b32 s32, s32, 7
  s_cmp_lt_u32 s32, 2
  s_cselect_b32 s32, 1, 0
  s_add_u32 s32, s32, s31
  s_cmp_ge_u32 s32, 2
  s_cselect_b32 s32, 0, s32
  s_lshl_b32 s33, s32, 3
  s_add_u32 s33, s33, s30
  s_lshl_b32 s37, s33, 17
  s_add_u32 s37, s37, s35
  s_add_u32 m0, s52, 24576
  s_nop 0
  buffer_load_dwordx4 v130, s[12:15], s37 offen lds
  buffer_load_dwordx4 v131, s[12:15], s37 offen offset:1024 lds
  s_add_u32 s30, s30, 1
  s_and_b32 s30, s30, 7
  s_cselect_b32 s32, 0, 1
  s_add_u32 s31, s31, s32
  s_sub_u32 s32, s30, s7
  s_and_b32 s32, s32, 7
  s_cmp_lt_u32 s32, 2
  s_cselect_b32 s32, 1, 0
  s_add_u32 s32, s32, s31
  s_cmp_ge_u32 s32, 2
  s_cselect_b32 s32, 0, s32
  s_lshl_b32 s33, s32, 3
  s_add_u32 s33, s33, s30
  s_lshl_b32 s37, s33, 17
  s_add_u32 s37, s37, s35
  s_add_u32 m0, s52, 32768
  s_nop 0
  buffer_load_dwordx4 v130, s[12:15], s37 offen lds
  buffer_load_dwordx4 v131, s[12:15], s37 offen offset:1024 lds
  s_branch attn
L_k1done:
  s_nop 7
  s_nop 7
  s_add_u32 s24, s84, 109051904
  s_addc_u32 s25, s85, 0
  s_mov_b32 s26, 524288
  s_mov_b32 s27, 0x20000
  v_mov_b32 v136, 0
  v_mov_b32 v137, 1
  s_cmp_eq_u32 s57, 0
  s_cselect_b32 s26, s26, 0
  s_waitcnt vmcnt(0)
  s_barrier
  s_mov_b64 exec, 1
  buffer_store_dword v137, v136, s[24:27], s56 offen sc0 sc1
  s_mov_b64 exec, -1
  s_add_u32 s30, s30, 1
  s_and_b32 s30, s30, 7
  s_cselect_b32 s32, 0, 1
  s_add_u32 s31, s31, s32
  s_sub_u32 s32, s30, s7
  s_and_b32 s32, s32, 7
  s_cmp_lt_u32 s32, 2
  s_cselect_b32 s32, 1, 0
  s_add_u32 s32, s32, s31
  s_cmp_ge_u32 s32, 2
  s_cselect_b32 s32, 0, s32
  s_lshl_b32 s33, s32, 3
  s_add_u32 s33, s33, s30
  s_lshl_b32 s37, s33, 17
  s_add_u32 s37, s37, s35
  s_add_u32 m0, s52, 43008
  s_nop 0
  buffer_load_dwordx4 v130, s[12:15], s37 offen lds
  buffer_load_dwordx4 v131, s[12:15], s37 offen offset:1024 lds
  s_add_u32 s30, s30, 1
  s_and_b32 s30, s30, 7
  s_cselect_b32 s32, 0, 1
  s_add_u32 s31, s31, s32
  s_sub_u32 s32, s30, s7
  s_and_b32 s32, s32, 7
  s_cmp_lt_u32 s32, 2
  s_cselect_b32 s32, 1, 0
  s_add_u32 s32, s32, s31
  s_cmp_ge_u32 s32, 2
  s_cselect_b32 s32, 0, s32
  s_lshl_b32 s33, s32, 3
  s_add_u32 s33, s33, s30
  s_lshl_b32 s37, s33, 17
  s_add_u32 s37, s37, s35
  s_add_u32 m0, s52, 51200
  s_nop 0
  buffer_load_dwordx4 v130, s[12:15], s37 offen lds
  buffer_load_dwordx4 v131, s[12:15], s37 offen offset:1024 lds
  s_add_u32 s30, s30, 1
  s_and_b32 s30, s30, 7
  s_cselect_b32 s32, 0, 1
  s_add_u32 s31, s31, s32
  s_sub_u32 s32, s30, s7
  s_and_b32 s32, s32, 7
  s_cmp_lt_u32 s32, 2
  s_cselect_b32 s32, 1, 0
  s_add_u32 s32, s32, s31
  s_cmp_ge_u32 s32, 2
  s_cselect_b32 s32, 0, s32
  s_lshl_b32 s33, s32, 3
  s_add_u32 s33, s33, s30
  s_lshl_b32 s37, s33, 17
  s_add_u32 s37, s37, s35
  s_add_u32 m0, s52, 59392
  s_nop 0
  buffer_load_dwordx4 v130, s[12:15], s37 offen lds
  buffer_load_dwordx4 v131, s[12:15], s37 offen offset:1024 lds
  s_add_u32 s30, s30, 1
  s_and_b32 s30, s30, 7
  s_cselect_b32 s32, 0, 1
  s_add_u32 s31, s31, s32
  s_sub_u32 s32, s30, s7
  s_and_b32 s32, s32, 7
  s_cmp_lt_u32 s32, 2
  s_cselect_b32 s32, 1, 0
  s_add_u32 s32, s32, s31
  s_cmp_ge_u32 s32, 2
  s_cselect_b32 s32, 0, s32
  s_lshl_b32 s33, s32, 3
  s_add_u32 s33, s33, s30
  s_lshl_b32 s37, s33, 17
  s_add_u32 s37, s37, s35
  s_add_u32 m0, s52, 67584
  s_nop 0
  buffer_load_dwordx4 v130, s[12:15], s37 offen lds
  buffer_load_dwordx4 v131, s[12:15], s37 offen offset:1024 lds
  s_lshl_b32 s56, s3, 10
  s_mul_i32 s32, s29, 16
  s_add_u32 s56, s56, s32
  s_add_u32 s56, s56, s28
  s_add_u32 s56, s56, 256
  s_lshl_b32 s56, s56, 7
  s_barrier
  s_waitcnt vmcnt(0)
  s_barrier
  s_cmp_ge_u32 s2, 224
  s_cbranch_scc1 L_k3skip
  s_lshr_b32 s32, s2, 3
  s_mul_i32 s5, s32, 9363
  s_lshr_b32 s5, s5, 16
  s_mul_i32 s6, s5, 7
  s_sub_u32 s6, s32, s6
  s_lshl_b32 s7, s5, 1
  s_add_u32 s7, s7, s6
  s_and_b32 s7, s7, 7
  s_and_b32 s32, s2, 7
  s_lshr_b32 s28, s32, 2
  s_lshl_b32 s28, s28, 2
  s_add_u32 s28, s28, s5
  s_and_b32 s29, s32, 3
  s_mul_i32 s29, s29, 7
  s_add_u32 s29, s29, s6
  s_mov_b32 s30, 7
  s_mov_b32 s31, -1
  s_lshl_b32 s44, s57, 12
  s_add_u32 s45, s44, 16384
  v_lshrrev_b32 v2, 4, v0
  v_lshlrev_b32 v3, 1, v2
  v_and_b32 v4, 15, v0
  v_xor_b32 v3, v3, v4
  v_lshlrev_b32 v3, 4, v3
  s_lshl_b32 s32, s57, 4
  v_add_u32 v2, s32, v2
  s_mov_b32 s32, 7168
  v_mul_lo_u32 v2, v2, s32
  v_add_u32 v9, v2, v3
  v_xor_b32 v3, 128, v3
  v_add_u32 v11, v2, v3
  v_add_u32 v10, 27648, v9
  v_add_u32 v12, 82944, v11
  v_add_u32 v11, 55296, v11
  s_lshl_b32 s34, s28, 2
  s_add_u32 s34, s34, s57
  s_lshl_b32 s34, s34, 18
  s_lshl_b32 s35, s29, 8
  s_lshl_b32 s32, 0, 1
  s_add_u32 s32, s32, 0
  s_cmp_eq_u32 s32, 3
  s_addc_u32 s32, s32, 5
  s_lshl_b32 s32, s32, 7
  s_mov_b32 vcc_lo, 0xff000000
  s_mov_b32 vcc_hi, 0
  v_mov_b32 v20, s32
  v_cndmask_b32 v20, 0, v20, vcc
  v_lshl_add_u32 v20, v0, 4, v20
  s_lshl_b32 s32, 1, 1
  s_add_u32 s32, s32, 0
  s_cmp_eq_u32 s32, 3
  s_addc_u32 s32, s32, 5
  s_lshl_b32 s32, s32, 7
  s_mov_b32 vcc_lo, 0xff000000
  s_mov_b32 vcc_hi, 0
  v_mov_b32 v21, s32
  v_cndmask_b32 v21, 0, v21, vcc
  v_lshl_add_u32 v21, v0, 4, v21
  v_add_u32 v21, 1024, v21
  s_lshl_b32 s32, 0, 1
  s_add_u32 s32, s32, 1
  s_cmp_eq_u32 s32, 3
  s_addc_u32 s32, s32, 5
  s_lshl_b32 s32, s32, 7
  s_mov_b32 vcc_lo, 0xff000000
  s_mov_b32 vcc_hi, 0
  v_mov_b32 v22, s32
  v_cndmask_b32 v22, 0, v22, vcc
  v_lshl_add_u32 v22, v0, 4, v22
  v_add_u32 v22, 129024, v22
  s_lshl_b32 s32, 1, 1
  s_add_u32 s32, s32, 1
  s_cmp_eq_u32 s32, 3
  s_addc_u32 s32, s32, 5
  s_lshl_b32 s32, s32, 7
  s_mov_b32 vcc_lo, 0xff000000
  s_mov_b32 vcc_hi, 0
  v_mov_b32 v23, s32
  v_cndmask_b32 v23, 0, v23, vcc
  v_lshl_add_u32 v23, v0, 4, v23
  v_add_u32 v23, 130048, v23
  s_add_u32 s8, s82, 16777216
  s_addc_u32 s9, s83, 0
  s_mov_b32 s10, 8388608
  s_mov_b32 s11, 0x20000
  s_mov_b32 s12, s72
  s_mov_b32 s13, s73
  s_mov_b32 s14, 14680064
  s_mov_b32 s15, 0x20000
  s_add_u32 s16, s84, 109051904
  s_addc_u32 s17, s85, 0
  s_mov_b32 s18, 524288
  s_mov_b32 s19, 0x20000
  s_lshl_b32 s32, s28, 5
  v_min_u32 v14, 31, v0
  v_add_u32 v14, s32, v14
  v_max_i32 v14, 0, v14
  v_lshlrev_b32 v14, 7, v14
  s_lshl_b32 s55, s3, 17
  s_add_u32 s55, s55, 32768
  s_lshr_b32 s32, s2, 3
  s_add_u32 s32, s32, 0
  s_lshl_b32 s32, s32, 2
  s_add_u32 s32, s32, s57
  s_lshl_b32 s32, s32, 6
  v_add_u32 v2, s32, v0
  v_mul_u32_u24 v3, 74899, v2
  v_lshrrev_b32 v3, 20, v3
  v_mul_u32_u24 v4, 14, v3
  v_sub_u32 v4, v2, v4
  v_add_u32 v3, 192, v3
  v_mul_u32_u24 v3, 7168, v3
  v_lshl_add_u32 v3, v4, 7, v3
  s_and_b32 s32, s2, 3
  s_mul_i32 s32, s32, 1792
  s_lshl_b32 s40, s3, 30
  s_add_u32 s32, s32, s40
  v_add_u32 v16, s32, v3
  s_barrier
  s_barrier
  s_mov_b64 exec, 1
  buffer_store_dword v137, v136, s[24:27], s56 offen sc0 sc1
  s_mov_b64 exec, -1
  s_mov_b32 s30, 7
  s_mov_b32 s31, -1
  s_mov_b32 s38, 0
  s_add_u32 s30, s30, 1
  s_and_b32 s30, s30, 7
  s_cselect_b32 s32, 0, 1
  s_add_u32 s31, s31, s32
  s_sub_u32 s32, s30, s7
  s_and_b32 s32, s32, 7
  s_cmp_lt_u32 s32, 2
  s_cselect_b32 s32, 1, 0
  s_add_u32 s32, s32, s31
  s_cmp_ge_u32 s32, 4
  s_cselect_b32 s32, 0, s32
  s_lshl_b32 s33, s32, 3
  s_add_u32 s33, s33, s30
  s_mul_i32 s37, s33, 458752
  s_add_u32 s37, s37, s35
  s_add_u32 m0, s38, s45
  s_nop 0
  buffer_load_dwordx4 v9, s[12:15], s37 offen offset:0  lds
  buffer_load_dwordx4 v10, s[12:15], s37 offen offset:1024  lds
  buffer_load_dwordx4 v11, s[12:15], s37 offen offset:2048  lds
  buffer_load_dwordx4 v12, s[12:15], s37 offen offset:3072  lds
  s_add_u32 s38, s38, 32768
  s_cmp_eq_u32 s38, 163840
  s_cselect_b32 s38, 0, s38
  s_add_u32 s30, s30, 1
  s_and_b32 s30, s30, 7
  s_cselect_b32 s32, 0, 1
  s_add_u32 s31, s31, s32
  s_sub_u32 s32, s30, s7
  s_and_b32 s32, s32, 7
  s_cmp_lt_u32 s32, 2
  s_cselect_b32 s32, 1, 0
  s_add_u32 s32, s32, s31
  s_cmp_ge_u32 s32, 4
  s_cselect_b32 s32, 0, s32
  s_lshl_b32 s33, s32, 3
  s_add_u32 s33, s33, s30
  s_mul_i32 s37, s33, 458752
  s_add_u32 s37, s37, s35
  s_add_u32 m0, s38, s45
  s_nop 0
  buffer_load_dwordx4 v9, s[12:15], s37 offen offset:0  lds
  buffer_load_dwordx4 v10, s[12:15], s37 offen offset:1024  lds
  buffer_load_dwordx4 v11, s[12:15], s37 offen offset:2048  lds
  buffer_load_dwordx4 v12, s[12:15], s37 offen offset:3072  lds
  s_add_u32 s38, s38, 32768
  s_cmp_eq_u32 s38, 163840
  s_cselect_b32 s38, 0, s38
  s_add_u32 s30, s30, 1
  s_and_b32 s30, s30, 7
  s_cselect_b32 s32, 0, 1
  s_add_u32 s31, s31, s32
  s_sub_u32 s32, s30, s7
  s_and_b32 s32, s32, 7
  s_cmp_lt_u32 s32, 2
  s_cselect_b32 s32, 1, 0
  s_add_u32 s32, s32, s31
  s_cmp_ge_u32 s32, 4
  s_cselect_b32 s32, 0, s32
  s_lshl_b32 s33, s32, 3
  s_add_u32 s33, s33, s30
  s_mul_i32 s37, s33, 458752
  s_add_u32 s37, s37, s35
  s_add_u32 m0, s38, s45
  s_nop 0
  buffer_load_dwordx4 v9, s[12:15], s37 offen offset:0  lds
  buffer_load_dwordx4 v10, s[12:15], s37 offen offset:1024  lds
  buffer_load_dwordx4 v11, s[12:15], s37 offen offset:2048  lds
  buffer_load_dwordx4 v12, s[12:15], s37 offen offset:3072  lds
  s_add_u32 s38, s38, 32768
  s_cmp_eq_u32 s38, 163840
  s_cselect_b32 s38, 0, s38
  buffer_load_dword v135, v16, s[12:15], 0 offen
  s_lshl_b32 s56, s3, 10
  s_mul_i32 s32, s28, 32
  s_add_u32 s56, s56, s32
  s_add_u32 s56, s56, s29
  s_add_u32 s56, s56, 512
  s_lshl_b32 s56, s56, 7
  s_mov_b32 s39, 0
  s_and_b32 s32, s4, 3
  s_cmp_lg_u32 s32, 0
  s_cbranch_scc1 poll16d
  s_sleep 8
poll16:
  buffer_load_dword v15, v14, s[16:19], s55 offen sc0 sc1
  s_waitcnt vmcnt(0)
  v_cmp_eq_u32 vcc, 0, v15
  s_add_u32 s39, s39, 1
  s_cmp_gt_u32 s39, 1000000
  s_cbranch_scc1 poll16d
  s_cbranch_vccnz poll16
poll16d:
  s_barrier
  s_mov_b32 s30, 7
  s_mov_b32 s31, -1
  s_mov_b32 s38, 0
  s_add_u32 s30, s30, 1
  s_and_b32 s30, s30, 7
  s_cselect_b32 s32, 0, 1
  s_add_u32 s31, s31, s32
  s_sub_u32 s32, s30, s7
  s_and_b32 s32, s32, 7
  s_cmp_lt_u32 s32, 2
  s_cselect_b32 s32, 1, 0
  s_add_u32 s32, s32, s31
  s_cmp_ge_u32 s32, 4
  s_cselect_b32 s32, 0, s32
  s_lshl_b32 s33, s32, 3
  s_add_u32 s33, s33, s30
  s_mul_i32 s36, s33, 4096
  s_add_u32 s36, s36, s34
  s_add_u32 m0, s38, s44
  s_nop 0
  buffer_load_dwordx4 v20, s[8:11], s36 offen offset:0 sc1 lds
  buffer_load_dwordx4 v21, s[8:11], s36 offen offset:1024 sc1 lds
  buffer_load_dwordx4 v22, s[8:11], s36 offen offset:2048 sc1 lds
  buffer_load_dwordx4 v23, s[8:11], s36 offen offset:3072 sc1 lds
  s_add_u32 s38, s38, 32768
  s_cmp_eq_u32 s38, 163840
  s_cselect_b32 s38, 0, s38
  s_add_u32 s30, s30, 1
  s_and_b32 s30, s30, 7
  s_cselect_b32 s32, 0, 1
  s_add_u32 s31, s31, s32
  s_sub_u32 s32, s30, s7
  s_and_b32 s32, s32, 7
  s_cmp_lt_u32 s32, 2
  s_cselect_b32 s32, 1, 0
  s_add_u32 s32, s32, s31
  s_cmp_ge_u32 s32, 4
  s_cselect_b32 s32, 0, s32
  s_lshl_b32 s33, s32, 3
  s_add_u32 s33, s33, s30
  s_mul_i32 s36, s33, 4096
  s_add_u32 s36, s36, s34
  s_add_u32 m0, s38, s44
  s_nop 0
  buffer_load_dwordx4 v20, s[8:11], s36 offen offset:0 sc1 lds
  buffer_load_dwordx4 v21, s[8:11], s36 offen offset:1024 sc1 lds
  buffer_load_dwordx4 v22, s[8:11], s36 offen offset:2048 sc1 lds
  buffer_load_dwordx4 v23, s[8:11], s36 offen offset:3072 sc1 lds
  s_add_u32 s38, s38, 32768
  s_cmp_eq_u32 s38, 163840
  s_cselect_b32 s38, 0, s38
  s_add_u32 s30, s30, 1
  s_and_b32 s30, s30, 7
  s_cselect_b32 s32, 0, 1
  s_add_u32 s31, s31, s32
  s_sub_u32 s32, s30, s7
  s_and_b32 s32, s32, 7
  s_cmp_lt_u32 s32, 2
  s_cselect_b32 s32, 1, 0
  s_add_u32 s32, s32, s31
  s_cmp_ge_u32 s32, 4
  s_cselect_b32 s32, 0, s32
  s_lshl_b32 s33, s32, 3
  s_add_u32 s33, s33, s30
  s_mul_i32 s36, s33, 4096
  s_add_u32 s36, s36, s34
  s_add_u32 m0, s38, s44
  s_nop 0
  buffer_load_dwordx4 v20, s[8:11], s36 offen offset:0 sc1 lds
  buffer_load_dwordx4 v21, s[8:11], s36 offen offset:1024 sc1 lds
  buffer_load_dwordx4 v22, s[8:11], s36 offen offset:2048 sc1 lds
  buffer_load_dwordx4 v23, s[8:11], s36 offen offset:3072 sc1 lds
  s_add_u32 s38, s38, 32768
  s_cmp_eq_u32 s38, 163840
  s_cselect_b32 s38, 0, s38
  s_waitcnt vmcnt(8)
  s_barrier
  s_add_u32 s30, s30, 1
  s_and_b32 s30, s30, 7
  s_cselect_b32 s32, 0, 1
  s_add_u32 s31, s31, s32
  s_sub_u32 s32, s30, s7
  s_and_b32 s32, s32, 7
  s_cmp_lt_u32 s32, 2
  s_cselect_b32 s32, 1, 0
  s_add_u32 s32, s32, s31
  s_cmp_ge_u32 s32, 4
  s_cselect_b32 s32, 0, s32
  s_lshl_b32 s33, s32, 3
  s_add_u32 s33, s33, s30
  s_mul_i32 s36, s33, 4096
  s_add_u32 s36, s36, s34
  s_mul_i32 s37, s33, 458752
  s_add_u32 s37, s37, s35
  s_add_u32 m0, s38, s44
  s_nop 0
  buffer_load_dwordx4 v20, s[8:11], s36 offen offset:0 sc1 lds
  buffer_load_dwordx4 v21, s[8:11], s36 offen offset:1024 sc1 lds
  buffer_load_dwordx4 v22, s[8:11], s36 offen offset:2048 sc1 lds
  buffer_load_dwordx4 v23, s[8:11], s36 offen offset:3072 sc1 lds
  s_add_u32 m0, s38, s45
  s_nop 0
  buffer_load_dwordx4 v9, s[12:15], s37 offen offset:0  lds
  buffer_load_dwordx4 v10, s[12:15], s37 offen offset:1024  lds
  buffer_load_dwordx4 v11, s[12:15], s37 offen offset:2048  lds
  buffer_load_dwordx4 v12, s[12:15], s37 offen offset:3072  lds
  s_add_u32 s38, s38, 32768
  s_cmp_eq_u32 s38, 163840
  s_cselect_b32 s38, 0, s38
  s_waitcnt vmcnt(12)
  s_barrier
  s_add_u32 s30, s30, 1
  s_and_b32 s30, s30, 7
  s_cselect_b32 s32, 0, 1
  s_add_u32 s31, s31, s32
  s_sub_u32 s32, s30, s7
  s_and_b32 s32, s32, 7
  s_cmp_lt_u32 s32, 2
  s_cselect_b32 s32, 1, 0
  s_add_u32 s32, s32, s31
  s_cmp_ge_u32 s32, 4
  s_cselect_b32 s32, 0, s32
  s_lshl_b32 s33, s32, 3
  s_add_u32 s33, s33, s30
  s_mul_i32 s36, s33, 4096
  s_add_u32 s36, s36, s34
  s_mul_i32 s37, s33, 458752
  s_add_u32 s37, s37, s35
  s_add_u32 m0, s38, s44
  s_nop 0
  buffer_load_dwordx4 v20, s[8:11], s36 offen offset:0 sc1 lds
  buffer_load_dwordx4 v21, s[8:11], s36 offen offset:1024 sc1 lds
  buffer_load_dwordx4 v22, s[8:11], s36 offen offset:2048 sc1 lds
  buffer_load_dwordx4 v23, s[8:11], s36 offen offset:3072 sc1 lds
  s_add_u32 m0, s38, s45
  s_nop 0
  buffer_load_dwordx4 v9, s[12:15], s37 offen offset:0  lds
  buffer_load_dwordx4 v10, s[12:15], s37 offen offset:1024  lds
  buffer_load_dwordx4 v11, s[12:15], s37 offen offset:2048  lds
  buffer_load_dwordx4 v12, s[12:15], s37 offen offset:3072  lds
  s_add_u32 s38, s38, 32768
  s_cmp_eq_u32 s38, 163840
  s_cselect_b32 s38, 0, s38
  s_mov_b32 s39, 27
ll17:
  s_waitcnt vmcnt(16)
  s_barrier
  s_add_u32 s30, s30, 1
  s_and_b32 s30, s30, 7
  s_cselect_b32 s32, 0, 1
  s_add_u32 s31, s31, s32
  s_sub_u32 s32, s30, s7
  s_and_b32 s32, s32, 7
  s_cmp_lt_u32 s32, 2
  s_cselect_b32 s32, 1, 0
  s_add_u32 s32, s32, s31
  s_cmp_ge_u32 s32, 4
  s_cselect_b32 s32, 0, s32
  s_lshl_b32 s33, s32, 3
  s_add_u32 s33, s33, s30
  s_mul_i32 s36, s33, 4096
  s_add_u32 s36, s36, s34
  s_mul_i32 s37, s33, 458752
  s_add_u32 s37, s37, s35
  s_add_u32 m0, s38, s44
  s_nop 0
  buffer_load_dwordx4 v20, s[8:11], s36 offen offset:0 sc1 lds
  buffer_load_dwordx4 v21, s[8:11], s36 offen offset:1024 sc1 lds
  buffer_load_dwordx4 v22, s[8:11], s36 offen offset:2048 sc1 lds
  buffer_load_dwordx4 v23, s[8:11], s36 offen offset:3072 sc1 lds
  s_add_u32 m0, s38, s45
  s_nop 0
  buffer_load_dwordx4 v9, s[12:15], s37 offen offset:0  lds
  buffer_load_dwordx4 v10, s[12:15], s37 offen offset:1024  lds
  buffer_load_dwordx4 v11, s[12:15], s37 offen offset:2048  lds
  buffer_load_dwordx4 v12, s[12:15], s37 offen offset:3072  lds
  s_add_u32 s38, s38, 32768
  s_cmp_eq_u32 s38, 163840
  s_cselect_b32 s38, 0, s38
  s_sub_u32 s39, s39, 1
  s_cmp_lg_u32 s39, 0
  s_cbranch_scc1 ll17
  s_waitcnt vmcnt(16)
  s_barrier
  s_waitcnt vmcnt(8)
  s_barrier
  s_waitcnt vmcnt(0)
  s_barrier
  s_lshr_b32 s32, s2, 3
  s_lshr_b32 s5, s32, 3
  s_and_b32 s6, s32, 7
  s_lshl_b32 s7, s5, 1
  s_add_u32 s7, s7, s6
  s_and_b32 s7, s7, 7
  s_and_b32 s32, s2, 7
  s_lshr_b32 s28, s32, 2
  s_lshl_b32 s28, s28, 2
  s_add_u32 s28, s28, s5
  s_and_b32 s29, s32, 3
  s_mul_i32 s29, s29, 8
  s_add_u32 s29, s29, s6
  s_mov_b32 s30, 7
  s_mov_b32 s31, -1
  s_mov_b32 s41, s57
  s_lshl_b32 s45, s41, 11
  s_mul_i32 s32, s41, 16
  s_add_u32 s32, s32, 0
  v_lshrrev_b32 v2, 3, v0
  v_add_u32 v2, s32, v2
  v_bfe_u32 v3, v2, 1, 1
  v_bfe_u32 v4, v2, 3, 1
  v_lshl_or_b32 v3, v4, 1, v3
  v_lshlrev_b32 v3, 1, v3
  v_and_b32 v4, 7, v0
  v_xor_b32 v3, v3, v4
  v_lshlrev_b32 v3, 4, v3
  s_mov_b32 s32, 4096
  v_mul_lo_u32 v2, v2, s32
  v_add_u32 v9, v2, v3
  s_mul_i32 s32, s41, 16
  s_add_u32 s32, s32, 8
  v_lshrrev_b32 v2, 3, v0
  v_add_u32 v2, s32, v2
  v_bfe_u32 v3, v2, 1, 1
  v_bfe_u32 v4, v2, 3, 1
  v_lshl_or_b32 v3, v4, 1, v3
  v_lshlrev_b32 v3, 1, v3
  v_and_b32 v4, 7, v0
  v_xor_b32 v3, v3, v4
  v_lshlrev_b32 v3, 4, v3
  s_mov_b32 s32, 4096
  v_mul_lo_u32 v2, v2, s32
  v_add_u32 v10, v2, v3
  v_subrev_u32 v10, 1024, v10
  s_lshl_b32 s35, s29, 7
  s_mov_b32 s12, s76
  s_mov_b32 s13, s77
  s_mov_b32 s14, 14680064
  s_mov_b32 s15, 0x20000
  s_branch L_k4
L_k3skip:
  s_nop 7
  s_nop 7
  s_lshr_b32 s32, s2, 3
  s_lshr_b32 s5, s32, 3
  s_and_b32 s6, s32, 7
  s_lshl_b32 s7, s5, 1
  s_add_u32 s7, s7, s6
  s_and_b32 s7, s7, 7
  s_and_b32 s32, s2, 7
  s_lshr_b32 s28, s32, 2
  s_lshl_b32 s28, s28, 2
  s_add_u32 s28, s28, s5
  s_and_b32 s29, s32, 3
  s_mul_i32 s29, s29, 8
  s_add_u32 s29, s29, s6
  s_mov_b32 s30, 7
  s_mov_b32 s31, -1
  s_mov_b32 s41, s57
  s_lshl_b32 s45, s41, 11
  s_mul_i32 s32, s41, 16
  s_add_u32 s32, s32, 0
  v_lshrrev_b32 v2, 3, v0
  v_add_u32 v2, s32, v2
  v_bfe_u32 v3, v2, 1, 1
  v_bfe_u32 v4, v2, 3, 1
  v_lshl_or_b32 v3, v4, 1, v3
  v_lshlrev_b32 v3, 1, v3
  v_and_b32 v4, 7, v0
  v_xor_b32 v3, v3, v4
  v_lshlrev_b32 v3, 4, v3
  s_mov_b32 s32, 4096
  v_mul_lo_u32 v2, v2, s32
  v_add_u32 v9, v2, v3
  s_mul_i32 s32, s41, 16
  s_add_u32 s32, s32, 8
  v_lshrrev_b32 v2, 3, v0
  v_add_u32 v2, s32, v2
  v_bfe_u32 v3, v2, 1, 1
  v_bfe_u32 v4, v2, 3, 1
  v_lshl_or_b32 v3, v4, 1, v3
  v_lshlrev_b32 v3, 1, v3
  v_and_b32 v4, 7, v0
  v_xor_b32 v3, v3, v4
  v_lshlrev_b32 v3, 4, v3
  s_mov_b32 s32, 4096
  v_mul_lo_u32 v2, v2, s32
  v_add_u32 v10, v2, v3
  v_subrev_u32 v10, 1024, v10
  s_lshl_b32 s35, s29, 7
  s_mov_b32 s12, s76
  s_mov_b32 s13, s77
  s_mov_b32 s14, 14680064
  s_mov_b32 s15, 0x20000
  s_barrier
L_k4:
  s_nop 7
  s_nop 7
  s_mov_b32 s30, 7
  s_mov_b32 s31, -1
  s_mov_b32 s38, 98304
  s_add_u32 s30, s30, 1
  s_and_b32 s30, s30, 7
  s_cselect_b32 s32, 0, 1
  s_add_u32 s31, s31, s32
  s_sub_u32 s32, s30, s7
  s_and_b32 s32, s32, 7
  s_cmp_lt_u32 s32, 2
  s_cselect_b32 s32, 1, 0
  s_add_u32 s32, s32, s31
  s_cmp_ge_u32 s32, 7
  s_cselect_b32 s32, 0, s32
  s_lshl_b32 s33, s32, 3
  s_add_u32 s33, s33, s30
  s_mul_i32 s37, s33, 262144
  s_add_u32 s37, s37, s35
  s_add_u32 m0, s38, s45
  s_nop 0
  buffer_load_dwordx4 v9, s[12:15], s37 offen offset:0  lds
  buffer_load_dwordx4 v10, s[12:15], s37 offen offset:1024  lds
  s_add_u32 s38, s38, 8192
  s_cmp_eq_u32 s38, 163840
  s_cselect_b32 s38, 98304, s38
  s_add_u32 s30, s30, 1
  s_and_b32 s30, s30, 7
  s_cselect_b32 s32, 0, 1
  s_add_u32 s31, s31, s32
  s_sub_u32 s32, s30, s7
  s_and_b32 s32, s32, 7
  s_cmp_lt_u32 s32, 2
  s_cselect_b32 s32, 1, 0
  s_add_u32 s32, s32, s31
  s_cmp_ge_u32 s32, 7
  s_cselect_b32 s32, 0, s32
  s_lshl_b32 s33, s32, 3
  s_add_u32 s33, s33, s30
  s_mul_i32 s37, s33, 262144
  s_add_u32 s37, s37, s35
  s_add_u32 m0, s38, s45
  s_nop 0
  buffer_load_dwordx4 v9, s[12:15], s37 offen offset:0  lds
  buffer_load_dwordx4 v10, s[12:15], s37 offen offset:1024  lds
  s_add_u32 s38, s38, 8192
  s_cmp_eq_u32 s38, 163840
  s_cselect_b32 s38, 98304, s38
  s_add_u32 s30, s30, 1
  s_and_b32 s30, s30, 7
  s_cselect_b32 s32, 0, 1
  s_add_u32 s31, s31, s32
  s_sub_u32 s32, s30, s7
  s_and_b32 s32, s32, 7
  s_cmp_lt_u32 s32, 2
  s_cselect_b32 s32, 1, 0
  s_add_u32 s32, s32, s31
  s_cmp_ge_u32 s32, 7
  s_cselect_b32 s32, 0, s32
  s_lshl_b32 s33, s32, 3
  s_add_u32 s33, s33, s30
  s_mul_i32 s37, s33, 262144
  s_add_u32 s37, s37, s35
  s_add_u32 m0, s38, s45
  s_nop 0
  buffer_load_dwordx4 v9, s[12:15], s37 offen offset:0  lds
  buffer_load_dwordx4 v10, s[12:15], s37 offen offset:1024  lds
  s_add_u32 s38, s38, 8192
  s_cmp_eq_u32 s38, 163840
  s_cselect_b32 s38, 98304, s38
  s_add_u32 s30, s30, 1
  s_and_b32 s30, s30, 7
  s_cselect_b32 s32, 0, 1
  s_add_u32 s31, s31, s32
  s_sub_u32 s32, s30, s7
  s_and_b32 s32, s32, 7
  s_cmp_lt_u32 s32, 2
  s_cselect_b32 s32, 1, 0
  s_add_u32 s32, s32, s31
  s_cmp_ge_u32 s32, 7
  s_cselect_b32 s32, 0, s32
  s_lshl_b32 s33, s32, 3
  s_add_u32 s33, s33, s30
  s_mul_i32 s37, s33, 262144
  s_add_u32 s37, s37, s35
  s_add_u32 m0, s38, s45
  s_nop 0
  buffer_load_dwordx4 v9, s[12:15], s37 offen offset:0  lds
  buffer_load_dwordx4 v10, s[12:15], s37 offen offset:1024  lds
  s_add_u32 s38, s38, 8192
  s_cmp_eq_u32 s38, 163840
  s_cselect_b32 s38, 98304, s38
  s_add_u32 s30, s30, 1
  s_and_b32 s30, s30, 7
  s_cselect_b32 s32, 0, 1
  s_add_u32 s31, s31, s32
  s_sub_u32 s32, s30, s7
  s_and_b32 s32, s32, 7
  s_cmp_lt_u32 s32, 2
  s_cselect_b32 s32, 1, 0
  s_add_u32 s32, s32, s31
  s_cmp_ge_u32 s32, 7
  s_cselect_b32 s32, 0, s32
  s_lshl_b32 s33, s32, 3
  s_add_u32 s33, s33, s30
  s_mul_i32 s37, s33, 262144
  s_add_u32 s37, s37, s35
  s_add_u32 m0, s38, s45
  s_nop 0
  buffer_load_dwordx4 v9, s[12:15], s37 offen offset:0  lds
  buffer_load_dwordx4 v10, s[12:15], s37 offen offset:1024  lds
  s_add_u32 s38, s38, 8192
  s_cmp_eq_u32 s38, 163840
  s_cselect_b32 s38, 98304, s38
  s_add_u32 s30, s30, 1
  s_and_b32 s30, s30, 7
  s_cselect_b32 s32, 0, 1
  s_add_u32 s31, s31, s32
  s_sub_u32 s32, s30, s7
  s_and_b32 s32, s32, 7
  s_cmp_lt_u32 s32, 2
  s_cselect_b32 s32, 1, 0
  s_add_u32 s32, s32, s31
  s_cmp_ge_u32 s32, 7
  s_cselect_b32 s32, 0, s32
  s_lshl_b32 s33, s32, 3
  s_add_u32 s33, s33, s30
  s_mul_i32 s37, s33, 262144
  s_add_u32 s37, s37, s35
  s_add_u32 m0, s38, s45
  s_nop 0
  buffer_load_dwordx4 v9, s[12:15], s37 offen offset:0  lds
  buffer_load_dwordx4 v10, s[12:15], s37 offen offset:1024  lds
  s_add_u32 s38, s38, 8192
  s_cmp_eq_u32 s38, 163840
  s_cselect_b32 s38, 98304, s38
  s_barrier
  s_mov_b64 exec, 1
  buffer_store_dword v137, v136, s[24:27], s56 offen sc0 sc1
  s_mov_b64 exec, -1
  s_lshl_b32 s56, s3, 10
  s_mul_i32 s32, s29, 8
  s_add_u32 s56, s56, s32
  s_add_u32 s56, s56, s28
  s_add_u32 s56, s56, 768
  s_lshl_b32 s56, s56, 7
  s_barrier
  s_mov_b32 s39, 50
ll18:
  s_waitcnt vmcnt(10)
  s_barrier
  s_add_u32 s30, s30, 1
  s_and_b32 s30, s30, 7
  s_cselect_b32 s32, 0, 1
  s_add_u32 s31, s31, s32
  s_sub_u32 s32, s30, s7
  s_and_b32 s32, s32, 7
  s_cmp_lt_u32 s32, 2
  s_cselect_b32 s32, 1, 0
  s_add_u32 s32, s32, s31
  s_cmp_ge_u32 s32, 7
  s_cselect_b32 s32, 0, s32
  s_lshl_b32 s33, s32, 3
  s_add_u32 s33, s33, s30
  s_mul_i32 s37, s33, 262144
  s_add_u32 s37, s37, s35
  s_add_u32 m0, s38, s45
  s_nop 0
  buffer_load_dwordx4 v9, s[12:15], s37 offen offset:0  lds
  buffer_load_dwordx4 v10, s[12:15], s37 offen offset:1024  lds
  s_add_u32 s38, s38, 8192
  s_cmp_eq_u32 s38, 163840
  s_cselect_b32 s38, 98304, s38
  s_sub_u32 s39, s39, 1
  s_cmp_lg_u32 s39, 0
  s_cbranch_scc1 ll18
  s_waitcnt vmcnt(10)
  s_barrier
  s_waitcnt vmcnt(8)
  s_barrier
  s_waitcnt vmcnt(6)
  s_barrier
  s_waitcnt vmcnt(4)
  s_barrier
  s_waitcnt vmcnt(2)
  s_barrier
  s_waitcnt vmcnt(0)
  s_barrier
  s_cmp_lg_u32 s3, 0
  s_cbranch_scc1 L_end
  s_lshr_b32 s32, s2, 3
  s_lshr_b32 s5, s32, 3
  s_and_b32 s6, s32, 7
  s_lshl_b32 s7, s5, 1
  s_add_u32 s7, s7, s6
  s_and_b32 s7, s7, 7
  s_and_b32 s32, s2, 7
  s_lshr_b32 s28, s32, 1
  s_lshl_b32 s28, s28, 2
  s_add_u32 s28, s28, s5
  s_and_b32 s29, s32, 1
  s_mul_i32 s29, s29, 8
  s_add_u32 s29, s29, s6
  s_mov_b32 s30, 7
  s_mov_b32 s31, -1
  s_mov_b32 s41, s57
  s_mul_i32 s32, s41, 16
  s_add_u32 s32, s32, 0
  v_lshrrev_b32 v2, 3, v0
  v_add_u32 v2, s32, v2
  v_bfe_u32 v3, v2, 1, 1
  v_bfe_u32 v4, v2, 3, 1
  v_lshl_or_b32 v3, v4, 1, v3
  v_lshlrev_b32 v3, 1, v3
  v_and_b32 v4, 7, v0
  v_xor_b32 v3, v3, v4
  v_lshlrev_b32 v3, 4, v3
  s_mov_b32 s32, 6144
  v_mul_lo_u32 v2, v2, s32
  v_add_u32 v13, v2, v3
  s_mul_i32 s32, s41, 16
  s_add_u32 s32, s32, 8
  v_lshrrev_b32 v2, 3, v0
  v_add_u32 v2, s32, v2
  v_bfe_u32 v3, v2, 1, 1
  v_bfe_u32 v4, v2, 3, 1
  v_lshl_or_b32 v3, v4, 1, v3
  v_lshlrev_b32 v3, 1, v3
  v_and_b32 v4, 7, v0
  v_xor_b32 v3, v3, v4
  v_lshlrev_b32 v3, 4, v3
  s_mov_b32 s32, 6144
  v_mul_lo_u32 v2, v2, s32
  v_add_u32 v14, v2, v3
  v_subrev_u32 v14, 1024, v14
  v_add_u32 v15, 2048, v13
  v_add_u32 v16, 2048, v14
  v_add_u32 v17, 4096, v13
  v_add_u32 v18, 4096, v14
  s_lshl_b32 s46, s41, 11
  s_add_u32 s46, s46, 18432
  s_add_u32 s47, s46, 8192
  s_add_u32 s48, s46, 16384
  s_lshl_b32 s35, s29, 7
  s_mov_b32 s12, s66
  s_mov_b32 s13, s67
  s_mov_b32 s14, 6291456
  s_mov_b32 s15, 0x20000
  s_mov_b32 s30, 7
  s_mov_b32 s31, -1
  s_mov_b32 s38, 0
  s_add_u32 s30, s30, 1
  s_and_b32 s30, s30, 7
  s_cselect_b32 s32, 0, 1
  s_add_u32 s31, s31, s32
  s_sub_u32 s32, s30, s7
  s_and_b32 s32, s32, 7
  s_cmp_lt_u32 s32, 2
  s_cselect_b32 s32, 1, 0
  s_add_u32 s32, s32, s31
  s_cmp_ge_u32 s32, 2
  s_cselect_b32 s32, 0, s32
  s_lshl_b32 s33, s32, 3
  s_add_u32 s33, s33, s30
  s_mul_i32 s37, s33, 393216
  s_add_u32 s37, s37, s35
  s_add_u32 m0, s38, s46
  s_nop 0
  buffer_load_dwordx4 v13, s[12:15], s37 offen offset:0  lds
  buffer_load_dwordx4 v14, s[12:15], s37 offen offset:1024  lds
  s_add_u32 m0, s38, s47
  s_nop 0
  buffer_load_dwordx4 v15, s[12:15], s37 offen offset:0  lds
  buffer_load_dwordx4 v16, s[12:15], s37 offen offset:1024  lds
  s_add_u32 m0, s38, s48
  s_nop 0
  buffer_load_dwordx4 v17, s[12:15], s37 offen offset:0  lds
  buffer_load_dwordx4 v18, s[12:15], s37 offen offset:1024  lds
  s_add_u32 s38, s38, 43008
  s_cmp_eq_u32 s38, 129024
  s_cselect_b32 s38, 0, s38
  s_add_u32 s30, s30, 1
  s_and_b32 s30, s30, 7
  s_cselect_b32 s32, 0, 1
  s_add_u32 s31, s31, s32
  s_sub_u32 s32, s30, s7
  s_and_b32 s32, s32, 7
  s_cmp_lt_u32 s32, 2
  s_cselect_b32 s32, 1, 0
  s_add_u32 s32, s32, s31
  s_cmp_ge_u32 s32, 2
  s_cselect_b32 s32, 0, s32
  s_lshl_b32 s33, s32, 3
  s_add_u32 s33, s33, s30
  s_mul_i32 s37, s33, 393216
  s_add_u32 s37, s37, s35
  s_add_u32 m0, s38, s46
  s_nop 0
  buffer_load_dwordx4 v13, s[12:15], s37 offen offset:0  lds
  buffer_load_dwordx4 v14, s[12:15], s37 offen offset:1024  lds
  s_add_u32 m0, s38, s47
  s_nop 0
  buffer_load_dwordx4 v15, s[12:15], s37 offen offset:0  lds
  buffer_load_dwordx4 v16, s[12:15], s37 offen offset:1024  lds
  s_add_u32 m0, s38, s48
  s_nop 0
  buffer_load_dwordx4 v17, s[12:15], s37 offen offset:0  lds
  buffer_load_dwordx4 v18, s[12:15], s37 offen offset:1024  lds
  s_add_u32 s38, s38, 43008
  s_cmp_eq_u32 s38, 129024
  s_cselect_b32 s38, 0, s38
  s_lshl_b32 s40, s28, 7
  s_sub_u32 s40, s40, 16
  s_lshl_b32 s32, s41, 5
  s_add_u32 s32, s32, 16
  v_lshrrev_b32 v2, 3, v0
  v_add_u32 v2, s32, v2
  v_bfe_u32 v3, v2, 1, 3
  v_and_b32 v4, 7, v0
  v_xor_b32 v3, v3, v4
  v_lshlrev_b32 v3, 4, v3
  v_add_u32 v2, s40, v2
  v_max_i32 v2, 0, v2
  v_lshlrev_b32 v2, 8, v2
  v_add_u32 v8, v2, v3
  v_add_u32 v10, 2048, v8
  s_lshl_b32 s32, s41, 5
  s_add_u32 s32, s32, 24
  v_lshrrev_b32 v2, 3, v0
  v_add_u32 v2, s32, v2
  v_bfe_u32 v3, v2, 1, 3
  v_and_b32 v4, 7, v0
  v_xor_b32 v3, v3, v4
  v_lshlrev_b32 v3, 4, v3
  v_add_u32 v2, s40, v2
  v_max_i32 v2, 0, v2
  v_lshlrev_b32 v2, 8, v2
  v_add_u32 v9, v2, v3
  v_subrev_u32 v9, 1024, v9
  v_add_u32 v11, 2048, v9
  s_lshl_b32 s32, s41, 3
  v_lshrrev_b32 v2, 3, v0
  v_add_u32 v2, s32, v2
  v_bfe_u32 v3, v2, 1, 3
  v_and_b32 v4, 7, v0
  v_xor_b32 v3, v3, v4
  v_lshlrev_b32 v3, 4, v3
  v_add_u32 v2, s40, v2
  v_max_i32 v2, 0, v2
  v_lshlrev_b32 v2, 8, v2
  v_add_u32 v12, v2, v3
  s_lshl_b32 s44, s41, 12
  s_add_u32 s44, s44, 2048
  s_lshl_b32 s45, s41, 10
  s_mov_b32 s34, 0
  s_mov_b32 s54, 524288
  s_cmp_eq_u32 s41, 0
  s_cselect_b32 s52, 0xffffff00, -1
  s_mov_b32 s53, -1
  v_mov_b32 v20, 0x3f803f80
  v_mov_b32 v21, v20
  v_mov_b32 v22, v20
  v_mov_b32 v23, v20
  v_lshlrev_b32 v24, 4, v0
  v_add_u32 v25, 86016, v24
  s_mov_b64 exec, 0xff
  ds_write_b128 v24, v[20:23]
  ds_write_b128 v24, v[20:23] offset:43008
  ds_write_b128 v25, v[20:23]
  s_mov_b64 exec, -1
  s_lshl_b32 s32, s41, 6
  v_add_u32 v26, s32, v0
  v_min_u32 v26, 143, v26
  v_add_u32 v27, s40, v26
  v_max_i32 v27, 0, v27
  v_lshrrev_b32 v2, 6, v27
  v_and_b32 v27, 63, v27
  v_lshlrev_b32 v27, 3, v27
  v_lshl_add_u32 v27, v2, 10, v27
  v_add_u32 v27, 512, v27
  v_lshlrev_b32 v26, 3, v26
  v_add_u32 v26, 129024, v26
  s_add_u32 s8, s84, 100663296
  s_addc_u32 s9, s85, 0
  s_mov_b32 s10, 8388608
  s_mov_b32 s11, 0x20000
  s_add_u32 s20, s84, 93323264
  s_addc_u32 s21, s85, 0
  s_mov_b32 s22, 262144
  s_mov_b32 s23, 0x20000
  s_waitcnt lgkmcnt(0)
  s_add_u32 s16, s84, 109051904
  s_addc_u32 s17, s85, 0
  s_mov_b32 s18, 524288
  s_mov_b32 s19, 0x20000
  s_lshl_b32 s32, s28, 4
  s_sub_u32 s32, s32, 8
  v_min_u32 v28, 23, v0
  v_add_u32 v28, s32, v28
  v_max_i32 v28, 0, v28
  v_lshlrev_b32 v28, 7, v28
  s_lshl_b32 s55, s3, 17
  s_add_u32 s55, s55, 98304
  s_barrier
  s_barrier
  s_mov_b64 exec, 1
  buffer_store_dword v137, v136, s[24:27], s56 offen sc0 sc1
  s_mov_b64 exec, -1
  s_mov_b32 s39, 0
  s_and_b32 s32, s4, 3
  s_cmp_lg_u32 s32, 0
  s_cbranch_scc1 poll19d
  s_sleep 8
poll19:
  buffer_load_dword v29, v28, s[16:19], s55 offen sc0 sc1
  s_waitcnt vmcnt(0)
  v_cmp_eq_u32 vcc, 0, v29
  s_add_u32 s39, s39, 1
  s_cmp_gt_u32 s39, 1000000
  s_cbranch_scc1 poll19d
  s_cbranch_vccnz poll19
poll19d:
  s_barrier
  s_mov_b32 s3, 1
  s_add_u32 s82, s84, 50331648
  s_addc_u32 s83, s85, 0
  s_branch L_top
L_end:
mega_end:
  s_endpgm
.section .rodata,"a"
.p2align 6
.amdhsa_kernel interleave_layers__sliding_local_dilated__mixer_token_mlp__prompt_kernel
  .amdhsa_next_free_vgpr 256
  .amdhsa_next_free_sgpr 102
  .amdhsa_accum_offset 256
  .amdhsa_group_segment_fixed_size 0
  .amdhsa_kernarg_size 88
  .amdhsa_user_sgpr_count 2
  .amdhsa_user_sgpr_kernarg_segment_ptr 1
  .amdhsa_system_sgpr_workgroup_id_x 1
.end_amdhsa_kernel
```

```asm
; @launch grid=(256,1,1) block=(512,1,1) lds=163840
.amdgcn_target "amdgcn-amd-amdhsa--gfx950"
.text
.globl interleave_layers__sliding_local_dilated__mixer_token_mlp__prompt_kernel
.type interleave_layers__sliding_local_dilated__mixer_token_mlp__prompt_kernel,@function
.p2align 8
interleave_layers__sliding_local_dilated__mixer_token_mlp__prompt_kernel:
  s_cmp_ge_u32 s2, 256
  s_cbranch_scc1 mega_end
  s_load_dwordx16 s[64:79], s[0:1], 0
  s_load_dwordx2 s[80:81], s[0:1], 64
  s_load_dwordx2 s[84:85], s[0:1], 80
  s_load_dwordx2 s[62:63], s[0:1], 72
  v_lshrrev_b32 v1, 6, v0
  v_and_b32 v0, 63, v0
  v_readfirstlane_b32 s4, v1
  s_mov_b32 s3, 0
  v_mov_b32 v130, 0
  v_mov_b32 v131, 0
  v_mov_b32 v134, 0
  s_cmp_ge_u32 s4, 4
  s_cbranch_scc1 L_start
  s_lshr_b32 s32, s2, 3
  s_lshr_b32 s5, s32, 3
  s_and_b32 s6, s32, 7
  s_lshl_b32 s7, s5, 1
  s_add_u32 s7, s7, s6
  s_and_b32 s7, s7, 7
  s_and_b32 s32, s2, 7
  s_lshr_b32 s28, s32, 1
  s_lshl_b32 s28, s28, 2
  s_add_u32 s28, s28, s5
  s_and_b32 s29, s32, 1
  s_mul_i32 s29, s29, 8
  s_add_u32 s29, s29, s6
  s_mov_b32 s30, 7
  s_mov_b32 s31, -1
  v_and_b32 v4, 15, v0
  v_lshrrev_b32 v5, 4, v0
  v_lshrrev_b32 v6, 2, v4
  v_and_b32 v7, 3, v0
  v_lshrrev_b32 v3, 5, v0
  v_and_b32 v2, 1, v5
  v_lshl_or_b32 v3, v2, 1, v3
  v_lshl_add_u32 v21, v5, 3, v6
  v_lshlrev_b32 v21, 7, v21
  v_lshl_add_u32 v21, v7, 3, v21
  v_lshrrev_b32 v22, 1, v6
  v_lshl_or_b32 v22, v2, 1, v22
  v_lshl_add_u32 v21, v22, 5, v21
  v_add_u32 v21, 18432, v21
  v_xor_b32 v8, 0, v21
  s_lshl_b32 s32, s4, 5
  v_xor_b32 v8, s32, v8
  v_lshrrev_b32 v21, 1, v4
  v_xor_b32 v21, v21, v5
  v_lshlrev_b32 v21, 4, v21
  v_lshlrev_b32 v22, 7, v4
  v_add_u32 v9, v21, v22
  v_xor_b32 v10, 64, v9
  v_and_b32 v21, 1, v4
  v_mul_u32_u24 v21, 28800, v21
  v_lshrrev_b32 v22, 1, v4
  v_mul_u32_u24 v22, 400, v22
  v_lshlrev_b32 v23, 3, v5
  v_add3_u32 v11, v21, v22, v23
  s_add_u32 s32, s32, 43008
  v_add_u32 v11, s32, v11
  v_lshlrev_b32 v12, 3, v4
  v_add_u32 v12, 129024, v12
  v_mov_b64 v[112:113], 0
  v_mov_b64 v[114:115], 0
  v_mov_b64 v[116:117], 0
  v_mov_b64 v[118:119], 0
  v_mov_b64 v[120:121], 0
  v_mov_b64 v[122:123], 0
  v_mov_b64 v[124:125], 0
  v_mov_b64 v[126:127], 0
  v_mov_b64 v[128:129], 0
  v_mov_b64 v[130:131], 0
  v_mov_b64 v[132:133], 0
  v_mov_b64 v[134:135], 0
  v_mov_b64 v[136:137], 0
  v_mov_b64 v[138:139], 0
  v_mov_b64 v[140:141], 0
  v_mov_b64 v[142:143], 0
  v_mov_b64 v[144:145], 0
  v_mov_b64 v[146:147], 0
  v_mov_b64 v[148:149], 0
  v_mov_b64 v[150:151], 0
  v_mov_b64 v[152:153], 0
  v_mov_b64 v[154:155], 0
  v_mov_b64 v[156:157], 0
  v_mov_b64 v[158:159], 0
  v_mov_b64 v[160:161], 0
  v_mov_b64 v[162:163], 0
  v_mov_b64 v[164:165], 0
  v_mov_b64 v[166:167], 0
  v_mov_b64 v[168:169], 0
  v_mov_b64 v[170:171], 0
  v_mov_b64 v[172:173], 0
  v_mov_b64 v[174:175], 0
  v_mov_b64 v[176:177], 0
  v_mov_b64 v[178:179], 0
  v_mov_b64 v[180:181], 0
  v_mov_b64 v[182:183], 0
  v_mov_b64 v[184:185], 0
  v_mov_b64 v[186:187], 0
  v_mov_b64 v[188:189], 0
  v_mov_b64 v[190:191], 0
  v_mov_b64 v[192:193], 0
  v_mov_b64 v[194:195], 0
  v_mov_b64 v[196:197], 0
  v_mov_b64 v[198:199], 0
  v_mov_b64 v[200:201], 0
  v_mov_b64 v[202:203], 0
  v_mov_b64 v[204:205], 0
  v_mov_b64 v[206:207], 0
  v_mov_b64 v[208:209], 0
  v_mov_b64 v[210:211], 0
  v_mov_b64 v[212:213], 0
  v_mov_b64 v[214:215], 0
  v_mov_b64 v[216:217], 0
  v_mov_b64 v[218:219], 0
  s_lshr_b32 s40, s4, 1
  s_and_b32 s41, s4, 1
  s_mul_i32 s32, s41, 28800
  s_add_u32 s32, s32, 43008
  s_lshl_b32 s49, s40, 4
  v_add_u32 v76, s49, v4
  v_lshlrev_b32 v77, 4, v5
  v_add_u32 v77, s32, v77
  v_mul_u32_u24 v78, 400, v76
  v_add_u32 v220, v78, v77
  v_add_u32 v223, 3200, v220
  v_add_u32 v220, 128, v220
  v_add_u32 v76, 16, v76
  v_min_u32 v76, 71, v76
  v_mul_u32_u24 v78, 400, v76
  v_add3_u32 v221, v78, v77, 64
  v_add_u32 v221, 64, v221
  v_lshl_add_u32 v76, v5, 2, v6
  v_add_u32 v76, s49, v76
  v_lshlrev_b32 v77, 4, v7
  v_add_u32 v77, s32, v77
  v_add_u32 v77, 256, v77
  v_mul_u32_u24 v78, 400, v76
  v_add_u32 v222, v78, v77
  v_add_u32 v76, 16, v76
  v_min_u32 v76, 71, v76
  v_mul_u32_u24 v78, 400, v76
  v_add_u32 v254, v78, v77
  s_lshl_b32 s50, s28, 2
  s_add_u32 s50, s50, s40
  s_lshl_b32 s50, s50, 17
  s_lshl_b32 s51, s29, 13
  s_add_u32 s50, s50, s51
  s_lshl_b32 s51, s41, 11
  s_add_u32 s50, s50, s51
  s_and_b32 s51, s40, 1
  s_lshl_b32 s32, s51, 1
  s_add_u32 s32, s32, s41
  s_cmp_eq_u32 s32, 3
  s_addc_u32 s32, s32, 5
  s_lshl_b32 s32, s32, 7
  s_mov_b32 vcc_lo, 0xff000000
  s_mov_b32 vcc_hi, 0
  v_mov_b32 v1, s32
  v_cndmask_b32 v1, 0, v1, vcc
  v_lshl_add_u32 v1, v0, 4, v1
  v_add_u32 v1, s50, v1
  v_lshlrev_b32 v76, 2, v5
  v_sub_u32 v76, v76, v4
  s_or_b32 s51, s28, s40
  s_cmp_eq_u32 s51, 0
  s_cselect_b32 s51, 0, -1
  v_add_u32 v77, -1, v76
  v_cmp_gt_u32 s[86:87], 8, v77
  v_add_u32 v77, 0, v76
  v_cmp_gt_u32 s[88:89], 8, v77
  v_add_u32 v77, 1, v76
  v_cmp_gt_u32 s[90:91], 8, v77
  v_add_u32 v77, 2, v76
  v_cmp_gt_u32 s[92:93], 8, v77
  v_add_u32 v77, 15, v76
  v_cmp_gt_u32 s[94:95], 8, v77
  v_add_u32 v77, 16, v76
  v_cmp_gt_u32 s[96:97], 8, v77
  v_add_u32 v77, 17, v76
  v_cmp_gt_u32 s[98:99], 8, v77
  v_add_u32 v77, 18, v76
  v_cmp_gt_u32 s[100:101], 8, v77
  s_and_b32 s86, s86, s51
  s_and_b32 s88, s88, s51
  s_and_b32 s90, s90, s51
  s_and_b32 s92, s92, s51
  s_waitcnt lgkmcnt(0)
  s_mov_b32 s82, s84
  s_mov_b32 s83, s85
  s_mov_b32 s12, s84
  s_mov_b32 s13, s85
  s_mov_b32 s14, 0
  s_mov_b32 s15, 0x20000
  s_mov_b32 s20, s66
  s_mov_b32 s21, s67
  s_mov_b32 s22, 6291456
  s_mov_b32 s23, 0x20000
  s_cmp_eq_u32 s4, 3
  s_cselect_b32 s20, s68, s20
  s_cselect_b32 s21, s69, s21
  s_cselect_b32 s22, 2097152, s22
  s_cselect_b32 s47, 0, s4
  s_lshl_b32 s47, s47, 8
  s_add_u32 s47, s47, s2
  s_lshl_b32 s47, s47, 13
  v_lshlrev_b32 v13, 7, v0
  s_mov_b32 s51, s4
  s_barrier
  s_cmp_lg_u32 s51, 0
  s_cbranch_scc1 C_wm0
  buffer_load_dword v15, v13, s[20:23], s47 offen
C_wm0:
  s_mov_b32 s16, s66
  s_mov_b32 s17, s67
  s_mov_b32 s18, 6291456
  s_mov_b32 s19, 0x20000
  s_lshr_b32 s32, s2, 3
  s_lshl_b32 s32, s32, 1
  s_add_u32 s32, s32, s4
  s_sub_u32 s32, s32, 1
  s_lshl_b32 s32, s32, 6
  v_add_u32 v16, s32, v0
  v_mul_u32_u24 v17, 21846, v16
  v_lshrrev_b32 v17, 16, v17
  v_mul_u32_u24 v18, 3, v17
  v_sub_u32 v18, v16, v18
  v_mul_u32_u24 v17, 6144, v17
  v_lshl_add_u32 v14, v18, 11, v17
  s_and_b32 s32, s2, 1
  s_lshl_b32 s32, s32, 10
  s_add_u32 s32, s32, 384
  s_sub_u32 s40, s4, 1
  s_cmp_lt_u32 s40, 2
  s_cselect_b32 s18, s18, 0
  buffer_load_dword v15, v14, s[16:19], s32 offen
C_top:
  s_nop 7
  s_nop 7
  s_mov_b32 s43, 0
  s_mov_b32 s39, 12
  s_barrier
  ds_read_b64_tr_b16 v[16:17], v8 offset:0
  ds_read_b64_tr_b16 v[18:19], v8 offset:512
  ds_read_b128 v[28:31], v9 offset:0
  ds_read_b64_tr_b16 v[20:21], v8 offset:8192
  ds_read_b64_tr_b16 v[22:23], v8 offset:8704
  ds_read_b64_tr_b16 v[24:25], v8 offset:16384
  ds_read_b64_tr_b16 v[26:27], v8 offset:16896
  ds_read_b128 v[32:35], v9 offset:2048
  ds_read_b128 v[36:39], v9 offset:4096
  ds_read_b128 v[40:43], v9 offset:6144
  ds_read_b128 v[44:47], v9 offset:8192
  ds_read_b128 v[48:51], v9 offset:10240
  ds_read_b128 v[52:55], v9 offset:12288
  ds_read_b128 v[56:59], v9 offset:14336
  ds_read_b128 v[60:63], v9 offset:16384
  s_add_u32 s40, s43, 43008
  s_cmp_eq_u32 s40, 129024
  s_cselect_b32 s40, 0, s40
  s_sub_u32 s42, s40, s43
  s_mov_b32 s43, s40
  s_waitcnt lgkmcnt(12)
  v_mfma_f32_16x16x32_bf16 v[112:115], v[16:19], v[28:31], v[112:115]
  ds_read_b64_tr_b16 v[64:65], v8 offset:4096
  s_waitcnt lgkmcnt(11)
  v_mfma_f32_16x16x32_bf16 v[148:151], v[20:23], v[28:31], v[148:151]
  ds_read_b64_tr_b16 v[66:67], v8 offset:4608
  s_waitcnt lgkmcnt(10)
  v_mfma_f32_16x16x32_bf16 v[184:187], v[24:27], v[28:31], v[184:187]
  ds_read_b128 v[76:79], v10 offset:0
  s_waitcnt lgkmcnt(10)
  v_mfma_f32_16x16x32_bf16 v[188:191], v[24:27], v[32:35], v[188:191]
  ds_read_b64_tr_b16 v[68:69], v8 offset:12288
  v_mfma_f32_16x16x32_bf16 v[152:155], v[20:23], v[32:35], v[152:155]
  ds_read_b64_tr_b16 v[70:71], v8 offset:12800
  v_mfma_f32_16x16x32_bf16 v[116:119], v[16:19], v[32:35], v[116:119]
  ds_read_b64_tr_b16 v[72:73], v8 offset:20480
  s_waitcnt lgkmcnt(12)
  v_mfma_f32_16x16x32_bf16 v[120:123], v[16:19], v[36:39], v[120:123]
  ds_read_b64_tr_b16 v[74:75], v8 offset:20992
  v_add_u32 v8, s42, v8
  v_mfma_f32_16x16x32_bf16 v[156:159], v[20:23], v[36:39], v[156:159]
  ds_read_b128 v[80:83], v10 offset:2048
  v_mfma_f32_16x16x32_bf16 v[192:195], v[24:27], v[36:39], v[192:195]
  ds_read_b128 v[84:87], v10 offset:4096
  s_waitcnt lgkmcnt(14)
  v_mfma_f32_16x16x32_bf16 v[196:199], v[24:27], v[40:43], v[196:199]
  ds_read_b128 v[88:91], v10 offset:6144
  v_mfma_f32_16x16x32_bf16 v[160:163], v[20:23], v[40:43], v[160:163]
  ds_read_b128 v[92:95], v10 offset:8192
  v_mfma_f32_16x16x32_bf16 v[124:127], v[16:19], v[40:43], v[124:127]
  ds_read_b128 v[96:99], v10 offset:10240
  s_waitcnt lgkmcnt(14)
  v_mfma_f32_16x16x32_bf16 v[128:131], v[16:19], v[44:47], v[128:131]
  ds_read_b128 v[100:103], v10 offset:12288
  v_mfma_f32_16x16x32_bf16 v[164:167], v[20:23], v[44:47], v[164:167]
  ds_read_b128 v[104:107], v10 offset:14336
  v_mfma_f32_16x16x32_bf16 v[200:203], v[24:27], v[44:47], v[200:203]
  ds_read_b128 v[108:111], v10 offset:16384
  v_add_u32 v9, s42, v9
  v_add_u32 v10, s42, v10
  v_mfma_f32_16x16x32_bf16 v[204:207], v[24:27], v[48:51], v[204:207]
  v_mfma_f32_16x16x32_bf16 v[168:171], v[20:23], v[48:51], v[168:171]
  v_mfma_f32_16x16x32_bf16 v[132:135], v[16:19], v[48:51], v[132:135]
  v_mfma_f32_16x16x32_bf16 v[136:139], v[16:19], v[52:55], v[136:139]
  v_mfma_f32_16x16x32_bf16 v[172:175], v[20:23], v[52:55], v[172:175]
  v_mfma_f32_16x16x32_bf16 v[208:211], v[24:27], v[52:55], v[208:211]
  s_waitcnt lgkmcnt(14)
  v_mfma_f32_16x16x32_bf16 v[212:215], v[24:27], v[56:59], v[212:215]
  v_mfma_f32_16x16x32_bf16 v[176:179], v[20:23], v[56:59], v[176:179]
  v_mfma_f32_16x16x32_bf16 v[140:143], v[16:19], v[56:59], v[140:143]
  v_mfma_f32_16x16x32_bf16 v[144:147], v[16:19], v[60:63], v[144:147]
  v_mfma_f32_16x16x32_bf16 v[180:183], v[20:23], v[60:63], v[180:183]
  v_mfma_f32_16x16x32_bf16 v[216:219], v[24:27], v[60:63], v[216:219]
  s_waitcnt lgkmcnt(0)
  s_barrier
  s_cmp_lg_u32 s51, 1
  s_cbranch_scc1 C_wm1
  buffer_load_dword v15, v13, s[20:23], s47 offen
C_wm1:
  v_mfma_f32_16x16x32_bf16 v[112:115], v[64:67], v[76:79], v[112:115]
  ds_read_b64_tr_b16 v[16:17], v8 offset:0
  s_add_u32 s40, s43, 43008
  v_mfma_f32_16x16x32_bf16 v[148:151], v[68:71], v[76:79], v[148:151]
  ds_read_b64_tr_b16 v[18:19], v8 offset:512
  s_cmp_eq_u32 s40, 129024
  v_mfma_f32_16x16x32_bf16 v[184:187], v[72:75], v[76:79], v[184:187]
  ds_read_b128 v[28:31], v9 offset:0
  s_cselect_b32 s40, 0, s40
  v_mfma_f32_16x16x32_bf16 v[188:191], v[72:75], v[80:83], v[188:191]
  ds_read_b64_tr_b16 v[20:21], v8 offset:8192
  s_sub_u32 s42, s40, s43
  v_mfma_f32_16x16x32_bf16 v[152:155], v[68:71], v[80:83], v[152:155]
  ds_read_b64_tr_b16 v[22:23], v8 offset:8704
  s_mov_b32 s43, s40
  v_mfma_f32_16x16x32_bf16 v[116:119], v[64:67], v[80:83], v[116:119]
  ds_read_b64_tr_b16 v[24:25], v8 offset:16384
  v_mfma_f32_16x16x32_bf16 v[120:123], v[64:67], v[84:87], v[120:123]
  ds_read_b64_tr_b16 v[26:27], v8 offset:16896
  v_mfma_f32_16x16x32_bf16 v[156:159], v[68:71], v[84:87], v[156:159]
  ds_read_b128 v[32:35], v9 offset:2048
  v_mfma_f32_16x16x32_bf16 v[192:195], v[72:75], v[84:87], v[192:195]
  ds_read_b128 v[36:39], v9 offset:4096
  v_mfma_f32_16x16x32_bf16 v[196:199], v[72:75], v[88:91], v[196:199]
  ds_read_b128 v[40:43], v9 offset:6144
  v_mfma_f32_16x16x32_bf16 v[160:163], v[68:71], v[88:91], v[160:163]
  ds_read_b128 v[44:47], v9 offset:8192
  v_mfma_f32_16x16x32_bf16 v[124:127], v[64:67], v[88:91], v[124:127]
  ds_read_b128 v[48:51], v9 offset:10240
  v_mfma_f32_16x16x32_bf16 v[128:131], v[64:67], v[92:95], v[128:131]
  ds_read_b128 v[52:55], v9 offset:12288
  v_mfma_f32_16x16x32_bf16 v[164:167], v[68:71], v[92:95], v[164:167]
  ds_read_b128 v[56:59], v9 offset:14336
  v_mfma_f32_16x16x32_bf16 v[200:203], v[72:75], v[92:95], v[200:203]
  ds_read_b128 v[60:63], v9 offset:16384
  v_mfma_f32_16x16x32_bf16 v[204:207], v[72:75], v[96:99], v[204:207]
  v_mfma_f32_16x16x32_bf16 v[168:171], v[68:71], v[96:99], v[168:171]
  v_mfma_f32_16x16x32_bf16 v[132:135], v[64:67], v[96:99], v[132:135]
  v_mfma_f32_16x16x32_bf16 v[136:139], v[64:67], v[100:103], v[136:139]
  v_mfma_f32_16x16x32_bf16 v[172:175], v[68:71], v[100:103], v[172:175]
  v_mfma_f32_16x16x32_bf16 v[208:211], v[72:75], v[100:103], v[208:211]
  v_mfma_f32_16x16x32_bf16 v[212:215], v[72:75], v[104:107], v[212:215]
  v_mfma_f32_16x16x32_bf16 v[176:179], v[68:71], v[104:107], v[176:179]
  v_mfma_f32_16x16x32_bf16 v[140:143], v[64:67], v[104:107], v[140:143]
  v_mfma_f32_16x16x32_bf16 v[144:147], v[64:67], v[108:111], v[144:147]
  v_mfma_f32_16x16x32_bf16 v[180:183], v[68:71], v[108:111], v[180:183]
  v_mfma_f32_16x16x32_bf16 v[216:219], v[72:75], v[108:111], v[216:219]
  s_waitcnt lgkmcnt(12)
  v_mfma_f32_16x16x32_bf16 v[112:115], v[16:19], v[28:31], v[112:115]
  ds_read_b64_tr_b16 v[64:65], v8 offset:4096
  s_waitcnt lgkmcnt(11)
  v_mfma_f32_16x16x32_bf16 v[148:151], v[20:23], v[28:31], v[148:151]
  ds_read_b64_tr_b16 v[66:67], v8 offset:4608
  s_waitcnt lgkmcnt(10)
  v_mfma_f32_16x16x32_bf16 v[184:187], v[24:27], v[28:31], v[184:187]
  ds_read_b128 v[76:79], v10 offset:0
  s_waitcnt lgkmcnt(10)
  v_mfma_f32_16x16x32_bf16 v[188:191], v[24:27], v[32:35], v[188:191]
  ds_read_b64_tr_b16 v[68:69], v8 offset:12288
  v_mfma_f32_16x16x32_bf16 v[152:155], v[20:23], v[32:35], v[152:155]
  ds_read_b64_tr_b16 v[70:71], v8 offset:12800
  v_mfma_f32_16x16x32_bf16 v[116:119], v[16:19], v[32:35], v[116:119]
  ds_read_b64_tr_b16 v[72:73], v8 offset:20480
  s_waitcnt lgkmcnt(12)
  v_mfma_f32_16x16x32_bf16 v[120:123], v[16:19], v[36:39], v[120:123]
  ds_read_b64_tr_b16 v[74:75], v8 offset:20992
  v_add_u32 v8, s42, v8
  v_mfma_f32_16x16x32_bf16 v[156:159], v[20:23], v[36:39], v[156:159]
  ds_read_b128 v[80:83], v10 offset:2048
  v_mfma_f32_16x16x32_bf16 v[192:195], v[24:27], v[36:39], v[192:195]
  ds_read_b128 v[84:87], v10 offset:4096
  s_waitcnt lgkmcnt(14)
  v_mfma_f32_16x16x32_bf16 v[196:199], v[24:27], v[40:43], v[196:199]
  ds_read_b128 v[88:91], v10 offset:6144
  v_mfma_f32_16x16x32_bf16 v[160:163], v[20:23], v[40:43], v[160:163]
  ds_read_b128 v[92:95], v10 offset:8192
  v_mfma_f32_16x16x32_bf16 v[124:127], v[16:19], v[40:43], v[124:127]
  ds_read_b128 v[96:99], v10 offset:10240
  s_waitcnt lgkmcnt(14)
  v_mfma_f32_16x16x32_bf16 v[128:131], v[16:19], v[44:47], v[128:131]
  ds_read_b128 v[100:103], v10 offset:12288
  v_mfma_f32_16x16x32_bf16 v[164:167], v[20:23], v[44:47], v[164:167]
  ds_read_b128 v[104:107], v10 offset:14336
  v_mfma_f32_16x16x32_bf16 v[200:203], v[24:27], v[44:47], v[200:203]
  ds_read_b128 v[108:111], v10 offset:16384
  v_add_u32 v9, s42, v9
  v_add_u32 v10, s42, v10
  v_mfma_f32_16x16x32_bf16 v[204:207], v[24:27], v[48:51], v[204:207]
  v_mfma_f32_16x16x32_bf16 v[168:171], v[20:23], v[48:51], v[168:171]
  v_mfma_f32_16x16x32_bf16 v[132:135], v[16:19], v[48:51], v[132:135]
  v_mfma_f32_16x16x32_bf16 v[136:139], v[16:19], v[52:55], v[136:139]
  v_mfma_f32_16x16x32_bf16 v[172:175], v[20:23], v[52:55], v[172:175]
  v_mfma_f32_16x16x32_bf16 v[208:211], v[24:27], v[52:55], v[208:211]
  s_waitcnt lgkmcnt(14)
  v_mfma_f32_16x16x32_bf16 v[212:215], v[24:27], v[56:59], v[212:215]
  v_mfma_f32_16x16x32_bf16 v[176:179], v[20:23], v[56:59], v[176:179]
  v_mfma_f32_16x16x32_bf16 v[140:143], v[16:19], v[56:59], v[140:143]
  v_mfma_f32_16x16x32_bf16 v[144:147], v[16:19], v[60:63], v[144:147]
  v_mfma_f32_16x16x32_bf16 v[180:183], v[20:23], v[60:63], v[180:183]
  v_mfma_f32_16x16x32_bf16 v[216:219], v[24:27], v[60:63], v[216:219]
  s_waitcnt lgkmcnt(0)
  s_barrier
  s_cmp_lg_u32 s51, 2
  s_cbranch_scc1 C_wm2
  buffer_load_dword v15, v13, s[20:23], s47 offen
C_wm2:
  v_mfma_f32_16x16x32_bf16 v[112:115], v[64:67], v[76:79], v[112:115]
  ds_read_b64_tr_b16 v[16:17], v8 offset:0
  s_add_u32 s40, s43, 43008
  v_mfma_f32_16x16x32_bf16 v[148:151], v[68:71], v[76:79], v[148:151]
  ds_read_b64_tr_b16 v[18:19], v8 offset:512
  s_cmp_eq_u32 s40, 129024
  v_mfma_f32_16x16x32_bf16 v[184:187], v[72:75], v[76:79], v[184:187]
  ds_read_b128 v[28:31], v9 offset:0
  s_cselect_b32 s40, 0, s40
  v_mfma_f32_16x16x32_bf16 v[188:191], v[72:75], v[80:83], v[188:191]
  ds_read_b64_tr_b16 v[20:21], v8 offset:8192
  s_sub_u32 s42, s40, s43
  v_mfma_f32_16x16x32_bf16 v[152:155], v[68:71], v[80:83], v[152:155]
  ds_read_b64_tr_b16 v[22:23], v8 offset:8704
  s_mov_b32 s43, s40
  v_mfma_f32_16x16x32_bf16 v[116:119], v[64:67], v[80:83], v[116:119]
  ds_read_b64_tr_b16 v[24:25], v8 offset:16384
  v_mfma_f32_16x16x32_bf16 v[120:123], v[64:67], v[84:87], v[120:123]
  ds_read_b64_tr_b16 v[26:27], v8 offset:16896
  v_mfma_f32_16x16x32_bf16 v[156:159], v[68:71], v[84:87], v[156:159]
  ds_read_b128 v[32:35], v9 offset:2048
  v_mfma_f32_16x16x32_bf16 v[192:195], v[72:75], v[84:87], v[192:195]
  ds_read_b128 v[36:39], v9 offset:4096
  v_mfma_f32_16x16x32_bf16 v[196:199], v[72:75], v[88:91], v[196:199]
  ds_read_b128 v[40:43], v9 offset:6144
  v_mfma_f32_16x16x32_bf16 v[160:163], v[68:71], v[88:91], v[160:163]
  ds_read_b128 v[44:47], v9 offset:8192
  v_mfma_f32_16x16x32_bf16 v[124:127], v[64:67], v[88:91], v[124:127]
  ds_read_b128 v[48:51], v9 offset:10240
  v_mfma_f32_16x16x32_bf16 v[128:131], v[64:67], v[92:95], v[128:131]
  ds_read_b128 v[52:55], v9 offset:12288
  v_mfma_f32_16x16x32_bf16 v[164:167], v[68:71], v[92:95], v[164:167]
  ds_read_b128 v[56:59], v9 offset:14336
  v_mfma_f32_16x16x32_bf16 v[200:203], v[72:75], v[92:95], v[200:203]
  ds_read_b128 v[60:63], v9 offset:16384
  v_mfma_f32_16x16x32_bf16 v[204:207], v[72:75], v[96:99], v[204:207]
  v_mfma_f32_16x16x32_bf16 v[168:171], v[68:71], v[96:99], v[168:171]
  v_mfma_f32_16x16x32_bf16 v[132:135], v[64:67], v[96:99], v[132:135]
  v_mfma_f32_16x16x32_bf16 v[136:139], v[64:67], v[100:103], v[136:139]
  v_mfma_f32_16x16x32_bf16 v[172:175], v[68:71], v[100:103], v[172:175]
  v_mfma_f32_16x16x32_bf16 v[208:211], v[72:75], v[100:103], v[208:211]
  v_mfma_f32_16x16x32_bf16 v[212:215], v[72:75], v[104:107], v[212:215]
  v_mfma_f32_16x16x32_bf16 v[176:179], v[68:71], v[104:107], v[176:179]
  v_mfma_f32_16x16x32_bf16 v[140:143], v[64:67], v[104:107], v[140:143]
  v_mfma_f32_16x16x32_bf16 v[144:147], v[64:67], v[108:111], v[144:147]
  v_mfma_f32_16x16x32_bf16 v[180:183], v[68:71], v[108:111], v[180:183]
  v_mfma_f32_16x16x32_bf16 v[216:219], v[72:75], v[108:111], v[216:219]
  s_waitcnt lgkmcnt(12)
  v_mfma_f32_16x16x32_bf16 v[112:115], v[16:19], v[28:31], v[112:115]
  ds_read_b64_tr_b16 v[64:65], v8 offset:4096
  s_waitcnt lgkmcnt(11)
  v_mfma_f32_16x16x32_bf16 v[148:151], v[20:23], v[28:31], v[148:151]
  ds_read_b64_tr_b16 v[66:67], v8 offset:4608
  s_waitcnt lgkmcnt(10)
  v_mfma_f32_16x16x32_bf16 v[184:187], v[24:27], v[28:31], v[184:187]
  ds_read_b128 v[76:79], v10 offset:0
  s_waitcnt lgkmcnt(10)
  v_mfma_f32_16x16x32_bf16 v[188:191], v[24:27], v[32:35], v[188:191]
  ds_read_b64_tr_b16 v[68:69], v8 offset:12288
  v_mfma_f32_16x16x32_bf16 v[152:155], v[20:23], v[32:35], v[152:155]
  ds_read_b64_tr_b16 v[70:71], v8 offset:12800
  v_mfma_f32_16x16x32_bf16 v[116:119], v[16:19], v[32:35], v[116:119]
  ds_read_b64_tr_b16 v[72:73], v8 offset:20480
  s_waitcnt lgkmcnt(12)
  v_mfma_f32_16x16x32_bf16 v[120:123], v[16:19], v[36:39], v[120:123]
  ds_read_b64_tr_b16 v[74:75], v8 offset:20992
  v_add_u32 v8, s42, v8
  v_mfma_f32_16x16x32_bf16 v[156:159], v[20:23], v[36:39], v[156:159]
  ds_read_b128 v[80:83], v10 offset:2048
  v_mfma_f32_16x16x32_bf16 v[192:195], v[24:27], v[36:39], v[192:195]
  ds_read_b128 v[84:87], v10 offset:4096
  s_waitcnt lgkmcnt(14)
  v_mfma_f32_16x16x32_bf16 v[196:199], v[24:27], v[40:43], v[196:199]
  ds_read_b128 v[88:91], v10 offset:6144
  v_mfma_f32_16x16x32_bf16 v[160:163], v[20:23], v[40:43], v[160:163]
  ds_read_b128 v[92:95], v10 offset:8192
  v_mfma_f32_16x16x32_bf16 v[124:127], v[16:19], v[40:43], v[124:127]
  ds_read_b128 v[96:99], v10 offset:10240
  s_waitcnt lgkmcnt(14)
  v_mfma_f32_16x16x32_bf16 v[128:131], v[16:19], v[44:47], v[128:131]
  ds_read_b128 v[100:103], v10 offset:12288
  v_mfma_f32_16x16x32_bf16 v[164:167], v[20:23], v[44:47], v[164:167]
  ds_read_b128 v[104:107], v10 offset:14336
  v_mfma_f32_16x16x32_bf16 v[200:203], v[24:27], v[44:47], v[200:203]
  ds_read_b128 v[108:111], v10 offset:16384
  v_add_u32 v9, s42, v9
  v_add_u32 v10, s42, v10
  v_mfma_f32_16x16x32_bf16 v[204:207], v[24:27], v[48:51], v[204:207]
  v_mfma_f32_16x16x32_bf16 v[168:171], v[20:23], v[48:51], v[168:171]
  v_mfma_f32_16x16x32_bf16 v[132:135], v[16:19], v[48:51], v[132:135]
  v_mfma_f32_16x16x32_bf16 v[136:139], v[16:19], v[52:55], v[136:139]
  v_mfma_f32_16x16x32_bf16 v[172:175], v[20:23], v[52:55], v[172:175]
  v_mfma_f32_16x16x32_bf16 v[208:211], v[24:27], v[52:55], v[208:211]
  s_waitcnt lgkmcnt(14)
  v_mfma_f32_16x16x32_bf16 v[212:215], v[24:27], v[56:59], v[212:215]
  v_mfma_f32_16x16x32_bf16 v[176:179], v[20:23], v[56:59], v[176:179]
  v_mfma_f32_16x16x32_bf16 v[140:143], v[16:19], v[56:59], v[140:143]
  v_mfma_f32_16x16x32_bf16 v[144:147], v[16:19], v[60:63], v[144:147]
  v_mfma_f32_16x16x32_bf16 v[180:183], v[20:23], v[60:63], v[180:183]
  v_mfma_f32_16x16x32_bf16 v[216:219], v[24:27], v[60:63], v[216:219]
  s_waitcnt lgkmcnt(0)
  s_barrier
  s_cmp_lg_u32 s51, 3
  s_cbranch_scc1 C_wm3
  buffer_load_dword v15, v13, s[20:23], s47 offen
C_wm3:
  v_mfma_f32_16x16x32_bf16 v[112:115], v[64:67], v[76:79], v[112:115]
  ds_read_b64_tr_b16 v[16:17], v8 offset:0
  s_add_u32 s40, s43, 43008
  v_mfma_f32_16x16x32_bf16 v[148:151], v[68:71], v[76:79], v[148:151]
  ds_read_b64_tr_b16 v[18:19], v8 offset:512
  s_cmp_eq_u32 s40, 129024
  v_mfma_f32_16x16x32_bf16 v[184:187], v[72:75], v[76:79], v[184:187]
  ds_read_b128 v[28:31], v9 offset:0
  s_cselect_b32 s40, 0, s40
  v_mfma_f32_16x16x32_bf16 v[188:191], v[72:75], v[80:83], v[188:191]
  ds_read_b64_tr_b16 v[20:21], v8 offset:8192
  s_sub_u32 s42, s40, s43
  v_mfma_f32_16x16x32_bf16 v[152:155], v[68:71], v[80:83], v[152:155]
  ds_read_b64_tr_b16 v[22:23], v8 offset:8704
  s_mov_b32 s43, s40
  v_mfma_f32_16x16x32_bf16 v[116:119], v[64:67], v[80:83], v[116:119]
  ds_read_b64_tr_b16 v[24:25], v8 offset:16384
  v_mfma_f32_16x16x32_bf16 v[120:123], v[64:67], v[84:87], v[120:123]
  ds_read_b64_tr_b16 v[26:27], v8 offset:16896
  v_mfma_f32_16x16x32_bf16 v[156:159], v[68:71], v[84:87], v[156:159]
  ds_read_b128 v[32:35], v9 offset:2048
  v_mfma_f32_16x16x32_bf16 v[192:195], v[72:75], v[84:87], v[192:195]
  ds_read_b128 v[36:39], v9 offset:4096
  v_mfma_f32_16x16x32_bf16 v[196:199], v[72:75], v[88:91], v[196:199]
  ds_read_b128 v[40:43], v9 offset:6144
  v_mfma_f32_16x16x32_bf16 v[160:163], v[68:71], v[88:91], v[160:163]
  ds_read_b128 v[44:47], v9 offset:8192
  v_mfma_f32_16x16x32_bf16 v[124:127], v[64:67], v[88:91], v[124:127]
  ds_read_b128 v[48:51], v9 offset:10240
  v_mfma_f32_16x16x32_bf16 v[128:131], v[64:67], v[92:95], v[128:131]
  ds_read_b128 v[52:55], v9 offset:12288
  v_mfma_f32_16x16x32_bf16 v[164:167], v[68:71], v[92:95], v[164:167]
  ds_read_b128 v[56:59], v9 offset:14336
  v_mfma_f32_16x16x32_bf16 v[200:203], v[72:75], v[92:95], v[200:203]
  ds_read_b128 v[60:63], v9 offset:16384
  v_mfma_f32_16x16x32_bf16 v[204:207], v[72:75], v[96:99], v[204:207]
  v_mfma_f32_16x16x32_bf16 v[168:171], v[68:71], v[96:99], v[168:171]
  v_mfma_f32_16x16x32_bf16 v[132:135], v[64:67], v[96:99], v[132:135]
  v_mfma_f32_16x16x32_bf16 v[136:139], v[64:67], v[100:103], v[136:139]
  v_mfma_f32_16x16x32_bf16 v[172:175], v[68:71], v[100:103], v[172:175]
  v_mfma_f32_16x16x32_bf16 v[208:211], v[72:75], v[100:103], v[208:211]
  v_mfma_f32_16x16x32_bf16 v[212:215], v[72:75], v[104:107], v[212:215]
  v_mfma_f32_16x16x32_bf16 v[176:179], v[68:71], v[104:107], v[176:179]
  v_mfma_f32_16x16x32_bf16 v[140:143], v[64:67], v[104:107], v[140:143]
  v_mfma_f32_16x16x32_bf16 v[144:147], v[64:67], v[108:111], v[144:147]
  v_mfma_f32_16x16x32_bf16 v[180:183], v[68:71], v[108:111], v[180:183]
  v_mfma_f32_16x16x32_bf16 v[216:219], v[72:75], v[108:111], v[216:219]
cl1:
  s_waitcnt lgkmcnt(12)
  v_mfma_f32_16x16x32_bf16 v[112:115], v[16:19], v[28:31], v[112:115]
  ds_read_b64_tr_b16 v[64:65], v8 offset:4096
  s_waitcnt lgkmcnt(11)
  v_mfma_f32_16x16x32_bf16 v[148:151], v[20:23], v[28:31], v[148:151]
  ds_read_b64_tr_b16 v[66:67], v8 offset:4608
  s_waitcnt lgkmcnt(10)
  v_mfma_f32_16x16x32_bf16 v[184:187], v[24:27], v[28:31], v[184:187]
  ds_read_b128 v[76:79], v10 offset:0
  s_waitcnt lgkmcnt(10)
  v_mfma_f32_16x16x32_bf16 v[188:191], v[24:27], v[32:35], v[188:191]
  ds_read_b64_tr_b16 v[68:69], v8 offset:12288
  v_mfma_f32_16x16x32_bf16 v[152:155], v[20:23], v[32:35], v[152:155]
  ds_read_b64_tr_b16 v[70:71], v8 offset:12800
  v_mfma_f32_16x16x32_bf16 v[116:119], v[16:19], v[32:35], v[116:119]
  ds_read_b64_tr_b16 v[72:73], v8 offset:20480
  s_waitcnt lgkmcnt(12)
  v_mfma_f32_16x16x32_bf16 v[120:123], v[16:19], v[36:39], v[120:123]
  ds_read_b64_tr_b16 v[74:75], v8 offset:20992
  v_add_u32 v8, s42, v8
  v_mfma_f32_16x16x32_bf16 v[156:159], v[20:23], v[36:39], v[156:159]
  ds_read_b128 v[80:83], v10 offset:2048
  v_mfma_f32_16x16x32_bf16 v[192:195], v[24:27], v[36:39], v[192:195]
  ds_read_b128 v[84:87], v10 offset:4096
  s_waitcnt lgkmcnt(14)
  v_mfma_f32_16x16x32_bf16 v[196:199], v[24:27], v[40:43], v[196:199]
  ds_read_b128 v[88:91], v10 offset:6144
  v_mfma_f32_16x16x32_bf16 v[160:163], v[20:23], v[40:43], v[160:163]
  ds_read_b128 v[92:95], v10 offset:8192
  v_mfma_f32_16x16x32_bf16 v[124:127], v[16:19], v[40:43], v[124:127]
  ds_read_b128 v[96:99], v10 offset:10240
  s_waitcnt lgkmcnt(14)
  v_mfma_f32_16x16x32_bf16 v[128:131], v[16:19], v[44:47], v[128:131]
  ds_read_b128 v[100:103], v10 offset:12288
  v_mfma_f32_16x16x32_bf16 v[164:167], v[20:23], v[44:47], v[164:167]
  ds_read_b128 v[104:107], v10 offset:14336
  v_mfma_f32_16x16x32_bf16 v[200:203], v[24:27], v[44:47], v[200:203]
  ds_read_b128 v[108:111], v10 offset:16384
  v_add_u32 v9, s42, v9
  v_add_u32 v10, s42, v10
  v_mfma_f32_16x16x32_bf16 v[204:207], v[24:27], v[48:51], v[204:207]
  v_mfma_f32_16x16x32_bf16 v[168:171], v[20:23], v[48:51], v[168:171]
  v_mfma_f32_16x16x32_bf16 v[132:135], v[16:19], v[48:51], v[132:135]
  v_mfma_f32_16x16x32_bf16 v[136:139], v[16:19], v[52:55], v[136:139]
  v_mfma_f32_16x16x32_bf16 v[172:175], v[20:23], v[52:55], v[172:175]
  v_mfma_f32_16x16x32_bf16 v[208:211], v[24:27], v[52:55], v[208:211]
  s_waitcnt lgkmcnt(14)
  v_mfma_f32_16x16x32_bf16 v[212:215], v[24:27], v[56:59], v[212:215]
  v_mfma_f32_16x16x32_bf16 v[176:179], v[20:23], v[56:59], v[176:179]
  v_mfma_f32_16x16x32_bf16 v[140:143], v[16:19], v[56:59], v[140:143]
  v_mfma_f32_16x16x32_bf16 v[144:147], v[16:19], v[60:63], v[144:147]
  v_mfma_f32_16x16x32_bf16 v[180:183], v[20:23], v[60:63], v[180:183]
  v_mfma_f32_16x16x32_bf16 v[216:219], v[24:27], v[60:63], v[216:219]
  s_waitcnt lgkmcnt(0)
  s_barrier
  v_mfma_f32_16x16x32_bf16 v[112:115], v[64:67], v[76:79], v[112:115]
  ds_read_b64_tr_b16 v[16:17], v8 offset:0
  s_add_u32 s40, s43, 43008
  v_mfma_f32_16x16x32_bf16 v[148:151], v[68:71], v[76:79], v[148:151]
  ds_read_b64_tr_b16 v[18:19], v8 offset:512
  s_cmp_eq_u32 s40, 129024
  v_mfma_f32_16x16x32_bf16 v[184:187], v[72:75], v[76:79], v[184:187]
  ds_read_b128 v[28:31], v9 offset:0
  s_cselect_b32 s40, 0, s40
  v_mfma_f32_16x16x32_bf16 v[188:191], v[72:75], v[80:83], v[188:191]
  ds_read_b64_tr_b16 v[20:21], v8 offset:8192
  s_sub_u32 s42, s40, s43
  v_mfma_f32_16x16x32_bf16 v[152:155], v[68:71], v[80:83], v[152:155]
  ds_read_b64_tr_b16 v[22:23], v8 offset:8704
  s_mov_b32 s43, s40
  v_mfma_f32_16x16x32_bf16 v[116:119], v[64:67], v[80:83], v[116:119]
  ds_read_b64_tr_b16 v[24:25], v8 offset:16384
  v_mfma_f32_16x16x32_bf16 v[120:123], v[64:67], v[84:87], v[120:123]
  ds_read_b64_tr_b16 v[26:27], v8 offset:16896
  v_mfma_f32_16x16x32_bf16 v[156:159], v[68:71], v[84:87], v[156:159]
  ds_read_b128 v[32:35], v9 offset:2048
  v_mfma_f32_16x16x32_bf16 v[192:195], v[72:75], v[84:87], v[192:195]
  ds_read_b128 v[36:39], v9 offset:4096
  v_mfma_f32_16x16x32_bf16 v[196:199], v[72:75], v[88:91], v[196:199]
  ds_read_b128 v[40:43], v9 offset:6144
  v_mfma_f32_16x16x32_bf16 v[160:163], v[68:71], v[88:91], v[160:163]
  ds_read_b128 v[44:47], v9 offset:8192
  v_mfma_f32_16x16x32_bf16 v[124:127], v[64:67], v[88:91], v[124:127]
  ds_read_b128 v[48:51], v9 offset:10240
  v_mfma_f32_16x16x32_bf16 v[128:131], v[64:67], v[92:95], v[128:131]
  ds_read_b128 v[52:55], v9 offset:12288
  v_mfma_f32_16x16x32_bf16 v[164:167], v[68:71], v[92:95], v[164:167]
  ds_read_b128 v[56:59], v9 offset:14336
  v_mfma_f32_16x16x32_bf16 v[200:203], v[72:75], v[92:95], v[200:203]
  ds_read_b128 v[60:63], v9 offset:16384
  v_mfma_f32_16x16x32_bf16 v[204:207], v[72:75], v[96:99], v[204:207]
  v_mfma_f32_16x16x32_bf16 v[168:171], v[68:71], v[96:99], v[168:171]
  v_mfma_f32_16x16x32_bf16 v[132:135], v[64:67], v[96:99], v[132:135]
  v_mfma_f32_16x16x32_bf16 v[136:139], v[64:67], v[100:103], v[136:139]
  v_mfma_f32_16x16x32_bf16 v[172:175], v[68:71], v[100:103], v[172:175]
  v_mfma_f32_16x16x32_bf16 v[208:211], v[72:75], v[100:103], v[208:211]
  v_mfma_f32_16x16x32_bf16 v[212:215], v[72:75], v[104:107], v[212:215]
  v_mfma_f32_16x16x32_bf16 v[176:179], v[68:71], v[104:107], v[176:179]
  v_mfma_f32_16x16x32_bf16 v[140:143], v[64:67], v[104:107], v[140:143]
  v_mfma_f32_16x16x32_bf16 v[144:147], v[64:67], v[108:111], v[144:147]
  v_mfma_f32_16x16x32_bf16 v[180:183], v[68:71], v[108:111], v[180:183]
  v_mfma_f32_16x16x32_bf16 v[216:219], v[72:75], v[108:111], v[216:219]
  s_sub_u32 s39, s39, 1
  s_cmp_lg_u32 s39, 0
  s_cbranch_scc1 cl1
  s_waitcnt lgkmcnt(12)
  v_mfma_f32_16x16x32_bf16 v[112:115], v[16:19], v[28:31], v[112:115]
  ds_read_b64_tr_b16 v[64:65], v8 offset:4096
  s_waitcnt lgkmcnt(11)
  v_mfma_f32_16x16x32_bf16 v[148:151], v[20:23], v[28:31], v[148:151]
  ds_read_b64_tr_b16 v[66:67], v8 offset:4608
  s_waitcnt lgkmcnt(10)
  v_mfma_f32_16x16x32_bf16 v[184:187], v[24:27], v[28:31], v[184:187]
  ds_read_b128 v[76:79], v10 offset:0
  s_waitcnt lgkmcnt(10)
  v_mfma_f32_16x16x32_bf16 v[188:191], v[24:27], v[32:35], v[188:191]
  ds_read_b64_tr_b16 v[68:69], v8 offset:12288
  v_mfma_f32_16x16x32_bf16 v[152:155], v[20:23], v[32:35], v[152:155]
  ds_read_b64_tr_b16 v[70:71], v8 offset:12800
  v_mfma_f32_16x16x32_bf16 v[116:119], v[16:19], v[32:35], v[116:119]
  ds_read_b64_tr_b16 v[72:73], v8 offset:20480
  s_waitcnt lgkmcnt(12)
  v_mfma_f32_16x16x32_bf16 v[120:123], v[16:19], v[36:39], v[120:123]
  ds_read_b64_tr_b16 v[74:75], v8 offset:20992
  v_mfma_f32_16x16x32_bf16 v[156:159], v[20:23], v[36:39], v[156:159]
  ds_read_b128 v[80:83], v10 offset:2048
  v_mfma_f32_16x16x32_bf16 v[192:195], v[24:27], v[36:39], v[192:195]
  ds_read_b128 v[84:87], v10 offset:4096
  s_waitcnt lgkmcnt(14)
  v_mfma_f32_16x16x32_bf16 v[196:199], v[24:27], v[40:43], v[196:199]
  ds_read_b128 v[88:91], v10 offset:6144
  v_mfma_f32_16x16x32_bf16 v[160:163], v[20:23], v[40:43], v[160:163]
  ds_read_b128 v[92:95], v10 offset:8192
  v_mfma_f32_16x16x32_bf16 v[124:127], v[16:19], v[40:43], v[124:127]
  ds_read_b128 v[96:99], v10 offset:10240
  s_waitcnt lgkmcnt(14)
  v_mfma_f32_16x16x32_bf16 v[128:131], v[16:19], v[44:47], v[128:131]
  ds_read_b128 v[100:103], v10 offset:12288
  v_mfma_f32_16x16x32_bf16 v[164:167], v[20:23], v[44:47], v[164:167]
  ds_read_b128 v[104:107], v10 offset:14336
  v_mfma_f32_16x16x32_bf16 v[200:203], v[24:27], v[44:47], v[200:203]
  ds_read_b128 v[108:111], v10 offset:16384
  v_mfma_f32_16x16x32_bf16 v[204:207], v[24:27], v[48:51], v[204:207]
  ds_read_b64 v[224:225], v12 offset:0
  v_mfma_f32_16x16x32_bf16 v[168:171], v[20:23], v[48:51], v[168:171]
  ds_read_b64 v[226:227], v12 offset:128
  v_mfma_f32_16x16x32_bf16 v[132:135], v[16:19], v[48:51], v[132:135]
  ds_read_b64 v[228:229], v12 offset:256
  v_mfma_f32_16x16x32_bf16 v[136:139], v[16:19], v[52:55], v[136:139]
  ds_read_b64 v[230:231], v12 offset:384
  v_mfma_f32_16x16x32_bf16 v[172:175], v[20:23], v[52:55], v[172:175]
  ds_read_b64 v[232:233], v12 offset:512
  v_mfma_f32_16x16x32_bf16 v[208:211], v[24:27], v[52:55], v[208:211]
  ds_read_b64 v[234:235], v12 offset:640
  s_waitcnt lgkmcnt(14)
  v_mfma_f32_16x16x32_bf16 v[212:215], v[24:27], v[56:59], v[212:215]
  ds_read_b64 v[236:237], v12 offset:768
  v_mfma_f32_16x16x32_bf16 v[176:179], v[20:23], v[56:59], v[176:179]
  ds_read_b64 v[238:239], v12 offset:896
  v_mfma_f32_16x16x32_bf16 v[140:143], v[16:19], v[56:59], v[140:143]
  ds_read_b64 v[240:241], v12 offset:1024
  v_mfma_f32_16x16x32_bf16 v[144:147], v[16:19], v[60:63], v[144:147]
  v_mfma_f32_16x16x32_bf16 v[180:183], v[20:23], v[60:63], v[180:183]
  v_mfma_f32_16x16x32_bf16 v[216:219], v[24:27], v[60:63], v[216:219]
  s_waitcnt lgkmcnt(0)
  v_mfma_f32_16x16x32_bf16 v[112:115], v[64:67], v[76:79], v[112:115]
  v_mfma_f32_16x16x32_bf16 v[148:151], v[68:71], v[76:79], v[148:151]
  v_mfma_f32_16x16x32_bf16 v[184:187], v[72:75], v[76:79], v[184:187]
  v_mfma_f32_16x16x32_bf16 v[188:191], v[72:75], v[80:83], v[188:191]
  s_nop 4
  v_mov_b32_dpp v242, v112 row_newbcast:0 row_mask:0xf bank_mask:0xf
  v_mov_b32_dpp v243, v113 row_newbcast:0 row_mask:0xf bank_mask:0xf
  v_mov_b32_dpp v244, v114 row_newbcast:0 row_mask:0xf bank_mask:0xf
  v_mov_b32_dpp v245, v115 row_newbcast:0 row_mask:0xf bank_mask:0xf
  v_mov_b32_dpp v246, v148 row_newbcast:0 row_mask:0xf bank_mask:0xf
  v_mov_b32_dpp v247, v149 row_newbcast:0 row_mask:0xf bank_mask:0xf
  v_mov_b32_dpp v248, v150 row_newbcast:0 row_mask:0xf bank_mask:0xf
  v_mfma_f32_16x16x32_bf16 v[152:155], v[68:71], v[80:83], v[152:155]
  v_mov_b32_dpp v249, v151 row_newbcast:0 row_mask:0xf bank_mask:0xf
  v_mov_b32_dpp v250, v184 row_newbcast:0 row_mask:0xf bank_mask:0xf
  v_mov_b32_dpp v251, v185 row_newbcast:0 row_mask:0xf bank_mask:0xf
  v_mov_b32_dpp v252, v186 row_newbcast:0 row_mask:0xf bank_mask:0xf
  v_mov_b32_dpp v253, v187 row_newbcast:0 row_mask:0xf bank_mask:0xf
  v_pk_fma_f32 v[148:149], v[246:247], v[224:225], v[148:149] op_sel_hi:[1,0,1] neg_lo:[0,1,0] neg_hi:[0,1,0]
  v_pk_fma_f32 v[150:151], v[248:249], v[224:225], v[150:151] op_sel_hi:[1,0,1] neg_lo:[0,1,0] neg_hi:[0,1,0]
  v_mfma_f32_16x16x32_bf16 v[116:119], v[64:67], v[80:83], v[116:119]
  v_pk_fma_f32 v[184:185], v[250:251], v[224:225], v[184:185] op_sel_hi:[1,0,1] neg_lo:[0,1,0] neg_hi:[0,1,0]
  v_pk_fma_f32 v[186:187], v[252:253], v[224:225], v[186:187] op_sel_hi:[1,0,1] neg_lo:[0,1,0] neg_hi:[0,1,0]
  v_pk_mul_f32 v[148:149], v[148:149], v[224:225] op_sel:[0,1] op_sel_hi:[1,1]
  v_pk_mul_f32 v[150:151], v[150:151], v[224:225] op_sel:[0,1] op_sel_hi:[1,1]
  v_pk_mul_f32 v[184:185], v[184:185], v[224:225] op_sel:[0,1] op_sel_hi:[1,1]
  v_pk_mul_f32 v[186:187], v[186:187], v[224:225] op_sel:[0,1] op_sel_hi:[1,1]
  v_cvt_pk_bf16_f32 v16, v148, v149
  v_mfma_f32_16x16x32_bf16 v[120:123], v[64:67], v[84:87], v[120:123]
  v_cvt_pk_bf16_f32 v17, v150, v151
  ds_write_b64 v11, v[16:17] offset:128
  v_cvt_pk_bf16_f32 v18, v184, v185
  v_cvt_pk_bf16_f32 v19, v186, v187
  ds_write_b64 v11, v[18:19] offset:256
  v_pk_fma_f32 v[116:117], v[242:243], v[226:227], v[116:117] op_sel_hi:[1,0,1] neg_lo:[0,1,0] neg_hi:[0,1,0]
  v_pk_fma_f32 v[118:119], v[244:245], v[226:227], v[118:119] op_sel_hi:[1,0,1] neg_lo:[0,1,0] neg_hi:[0,1,0]
  v_mfma_f32_16x16x32_bf16 v[156:159], v[68:71], v[84:87], v[156:159]
  v_pk_fma_f32 v[152:153], v[246:247], v[226:227], v[152:153] op_sel_hi:[1,0,1] neg_lo:[0,1,0] neg_hi:[0,1,0]
  v_pk_fma_f32 v[154:155], v[248:249], v[226:227], v[154:155] op_sel_hi:[1,0,1] neg_lo:[0,1,0] neg_hi:[0,1,0]
  v_pk_fma_f32 v[188:189], v[250:251], v[226:227], v[188:189] op_sel_hi:[1,0,1] neg_lo:[0,1,0] neg_hi:[0,1,0]
  v_pk_fma_f32 v[190:191], v[252:253], v[226:227], v[190:191] op_sel_hi:[1,0,1] neg_lo:[0,1,0] neg_hi:[0,1,0]
  v_pk_mul_f32 v[116:117], v[116:117], v[226:227] op_sel:[0,1] op_sel_hi:[1,1]
  v_pk_mul_f32 v[118:119], v[118:119], v[226:227] op_sel:[0,1] op_sel_hi:[1,1]
  v_pk_mul_f32 v[152:153], v[152:153], v[226:227] op_sel:[0,1] op_sel_hi:[1,1]
  v_mfma_f32_16x16x32_bf16 v[192:195], v[72:75], v[84:87], v[192:195]
  v_pk_mul_f32 v[154:155], v[154:155], v[226:227] op_sel:[0,1] op_sel_hi:[1,1]
  v_pk_mul_f32 v[188:189], v[188:189], v[226:227] op_sel:[0,1] op_sel_hi:[1,1]
  v_pk_mul_f32 v[190:191], v[190:191], v[226:227] op_sel:[0,1] op_sel_hi:[1,1]
  v_cvt_pk_bf16_f32 v22, v116, v117
  v_cvt_pk_bf16_f32 v23, v118, v119
  ds_write_b64 v11, v[22:23] offset:3200
  v_cvt_pk_bf16_f32 v24, v152, v153
  v_mfma_f32_16x16x32_bf16 v[196:199], v[72:75], v[88:91], v[196:199]
  v_cvt_pk_bf16_f32 v25, v154, v155
  ds_write_b64 v11, v[24:25] offset:3328
  v_cvt_pk_bf16_f32 v26, v188, v189
  v_cvt_pk_bf16_f32 v27, v190, v191
  ds_write_b64 v11, v[26:27] offset:3456
  v_pk_fma_f32 v[120:121], v[242:243], v[228:229], v[120:121] op_sel_hi:[1,0,1] neg_lo:[0,1,0] neg_hi:[0,1,0]
  v_pk_fma_f32 v[122:123], v[244:245], v[228:229], v[122:123] op_sel_hi:[1,0,1] neg_lo:[0,1,0] neg_hi:[0,1,0]
  v_mfma_f32_16x16x32_bf16 v[160:163], v[68:71], v[88:91], v[160:163]
  v_pk_fma_f32 v[156:157], v[246:247], v[228:229], v[156:157] op_sel_hi:[1,0,1] neg_lo:[0,1,0] neg_hi:[0,1,0]
  v_pk_fma_f32 v[158:159], v[248:249], v[228:229], v[158:159] op_sel_hi:[1,0,1] neg_lo:[0,1,0] neg_hi:[0,1,0]
  v_pk_fma_f32 v[192:193], v[250:251], v[228:229], v[192:193] op_sel_hi:[1,0,1] neg_lo:[0,1,0] neg_hi:[0,1,0]
  v_pk_fma_f32 v[194:195], v[252:253], v[228:229], v[194:195] op_sel_hi:[1,0,1] neg_lo:[0,1,0] neg_hi:[0,1,0]
  v_pk_mul_f32 v[120:121], v[120:121], v[228:229] op_sel:[0,1] op_sel_hi:[1,1]
  v_pk_mul_f32 v[122:123], v[122:123], v[228:229] op_sel:[0,1] op_sel_hi:[1,1]
  v_pk_mul_f32 v[156:157], v[156:157], v[228:229] op_sel:[0,1] op_sel_hi:[1,1]
  v_mfma_f32_16x16x32_bf16 v[124:127], v[64:67], v[88:91], v[124:127]
  v_pk_mul_f32 v[158:159], v[158:159], v[228:229] op_sel:[0,1] op_sel_hi:[1,1]
  v_pk_mul_f32 v[192:193], v[192:193], v[228:229] op_sel:[0,1] op_sel_hi:[1,1]
  v_pk_mul_f32 v[194:195], v[194:195], v[228:229] op_sel:[0,1] op_sel_hi:[1,1]
  v_cvt_pk_bf16_f32 v28, v120, v121
  v_cvt_pk_bf16_f32 v29, v122, v123
  ds_write_b64 v11, v[28:29] offset:6400
  v_cvt_pk_bf16_f32 v30, v156, v157
  v_mfma_f32_16x16x32_bf16 v[128:131], v[64:67], v[92:95], v[128:131]
  v_cvt_pk_bf16_f32 v31, v158, v159
  ds_write_b64 v11, v[30:31] offset:6528
  v_cvt_pk_bf16_f32 v32, v192, v193
  v_cvt_pk_bf16_f32 v33, v194, v195
  ds_write_b64 v11, v[32:33] offset:6656
  v_pk_fma_f32 v[124:125], v[242:243], v[230:231], v[124:125] op_sel_hi:[1,0,1] neg_lo:[0,1,0] neg_hi:[0,1,0]
  v_pk_fma_f32 v[126:127], v[244:245], v[230:231], v[126:127] op_sel_hi:[1,0,1] neg_lo:[0,1,0] neg_hi:[0,1,0]
  v_mfma_f32_16x16x32_bf16 v[164:167], v[68:71], v[92:95], v[164:167]
  v_pk_fma_f32 v[160:161], v[246:247], v[230:231], v[160:161] op_sel_hi:[1,0,1] neg_lo:[0,1,0] neg_hi:[0,1,0]
  v_pk_fma_f32 v[162:163], v[248:249], v[230:231], v[162:163] op_sel_hi:[1,0,1] neg_lo:[0,1,0] neg_hi:[0,1,0]
  v_pk_fma_f32 v[196:197], v[250:251], v[230:231], v[196:197] op_sel_hi:[1,0,1] neg_lo:[0,1,0] neg_hi:[0,1,0]
  v_pk_fma_f32 v[198:199], v[252:253], v[230:231], v[198:199] op_sel_hi:[1,0,1] neg_lo:[0,1,0] neg_hi:[0,1,0]
  v_pk_mul_f32 v[124:125], v[124:125], v[230:231] op_sel:[0,1] op_sel_hi:[1,1]
  v_pk_mul_f32 v[126:127], v[126:127], v[230:231] op_sel:[0,1] op_sel_hi:[1,1]
  v_pk_mul_f32 v[160:161], v[160:161], v[230:231] op_sel:[0,1] op_sel_hi:[1,1]
  v_mfma_f32_16x16x32_bf16 v[200:203], v[72:75], v[92:95], v[200:203]
  v_pk_mul_f32 v[162:163], v[162:163], v[230:231] op_sel:[0,1] op_sel_hi:[1,1]
  v_pk_mul_f32 v[196:197], v[196:197], v[230:231] op_sel:[0,1] op_sel_hi:[1,1]
  v_pk_mul_f32 v[198:199], v[198:199], v[230:231] op_sel:[0,1] op_sel_hi:[1,1]
  v_cvt_pk_bf16_f32 v34, v124, v125
  v_cvt_pk_bf16_f32 v35, v126, v127
  ds_write_b64 v11, v[34:35] offset:9600
  v_cvt_pk_bf16_f32 v36, v160, v161
  v_mfma_f32_16x16x32_bf16 v[204:207], v[72:75], v[96:99], v[204:207]
  v_cvt_pk_bf16_f32 v37, v162, v163
  ds_write_b64 v11, v[36:37] offset:9728
  v_cvt_pk_bf16_f32 v38, v196, v197
  v_cvt_pk_bf16_f32 v39, v198, v199
  ds_write_b64 v11, v[38:39] offset:9856
  v_pk_fma_f32 v[128:129], v[242:243], v[232:233], v[128:129] op_sel_hi:[1,0,1] neg_lo:[0,1,0] neg_hi:[0,1,0]
  v_pk_fma_f32 v[130:131], v[244:245], v[232:233], v[130:131] op_sel_hi:[1,0,1] neg_lo:[0,1,0] neg_hi:[0,1,0]
  v_mfma_f32_16x16x32_bf16 v[168:171], v[68:71], v[96:99], v[168:171]
  v_pk_fma_f32 v[164:165], v[246:247], v[232:233], v[164:165] op_sel_hi:[1,0,1] neg_lo:[0,1,0] neg_hi:[0,1,0]
  v_pk_fma_f32 v[166:167], v[248:249], v[232:233], v[166:167] op_sel_hi:[1,0,1] neg_lo:[0,1,0] neg_hi:[0,1,0]
  v_pk_fma_f32 v[200:201], v[250:251], v[232:233], v[200:201] op_sel_hi:[1,0,1] neg_lo:[0,1,0] neg_hi:[0,1,0]
  v_pk_fma_f32 v[202:203], v[252:253], v[232:233], v[202:203] op_sel_hi:[1,0,1] neg_lo:[0,1,0] neg_hi:[0,1,0]
  v_pk_mul_f32 v[128:129], v[128:129], v[232:233] op_sel:[0,1] op_sel_hi:[1,1]
  v_pk_mul_f32 v[130:131], v[130:131], v[232:233] op_sel:[0,1] op_sel_hi:[1,1]
  v_pk_mul_f32 v[164:165], v[164:165], v[232:233] op_sel:[0,1] op_sel_hi:[1,1]
  v_mfma_f32_16x16x32_bf16 v[132:135], v[64:67], v[96:99], v[132:135]
  v_pk_mul_f32 v[166:167], v[166:167], v[232:233] op_sel:[0,1] op_sel_hi:[1,1]
  v_pk_mul_f32 v[200:201], v[200:201], v[232:233] op_sel:[0,1] op_sel_hi:[1,1]
  v_pk_mul_f32 v[202:203], v[202:203], v[232:233] op_sel:[0,1] op_sel_hi:[1,1]
  v_cvt_pk_bf16_f32 v40, v128, v129
  v_cvt_pk_bf16_f32 v41, v130, v131
  ds_write_b64 v11, v[40:41] offset:12800
  v_cvt_pk_bf16_f32 v42, v164, v165
  v_mfma_f32_16x16x32_bf16 v[136:139], v[64:67], v[100:103], v[136:139]
  v_cvt_pk_bf16_f32 v43, v166, v167
  ds_write_b64 v11, v[42:43] offset:12928
  v_cvt_pk_bf16_f32 v44, v200, v201
  v_cvt_pk_bf16_f32 v45, v202, v203
  ds_write_b64 v11, v[44:45] offset:13056
  v_pk_fma_f32 v[132:133], v[242:243], v[234:235], v[132:133] op_sel_hi:[1,0,1] neg_lo:[0,1,0] neg_hi:[0,1,0]
  v_pk_fma_f32 v[134:135], v[244:245], v[234:235], v[134:135] op_sel_hi:[1,0,1] neg_lo:[0,1,0] neg_hi:[0,1,0]
  v_mfma_f32_16x16x32_bf16 v[172:175], v[68:71], v[100:103], v[172:175]
  v_pk_fma_f32 v[168:169], v[246:247], v[234:235], v[168:169] op_sel_hi:[1,0,1] neg_lo:[0,1,0] neg_hi:[0,1,0]
  v_pk_fma_f32 v[170:171], v[248:249], v[234:235], v[170:171] op_sel_hi:[1,0,1] neg_lo:[0,1,0] neg_hi:[0,1,0]
  v_pk_fma_f32 v[204:205], v[250:251], v[234:235], v[204:205] op_sel_hi:[1,0,1] neg_lo:[0,1,0] neg_hi:[0,1,0]
  v_pk_fma_f32 v[206:207], v[252:253], v[234:235], v[206:207] op_sel_hi:[1,0,1] neg_lo:[0,1,0] neg_hi:[0,1,0]
  v_pk_mul_f32 v[132:133], v[132:133], v[234:235] op_sel:[0,1] op_sel_hi:[1,1]
  v_pk_mul_f32 v[134:135], v[134:135], v[234:235] op_sel:[0,1] op_sel_hi:[1,1]
  v_pk_mul_f32 v[168:169], v[168:169], v[234:235] op_sel:[0,1] op_sel_hi:[1,1]
  v_mfma_f32_16x16x32_bf16 v[208:211], v[72:75], v[100:103], v[208:211]
  v_pk_mul_f32 v[170:171], v[170:171], v[234:235] op_sel:[0,1] op_sel_hi:[1,1]
  v_pk_mul_f32 v[204:205], v[204:205], v[234:235] op_sel:[0,1] op_sel_hi:[1,1]
  v_pk_mul_f32 v[206:207], v[206:207], v[234:235] op_sel:[0,1] op_sel_hi:[1,1]
  v_cvt_pk_bf16_f32 v46, v132, v133
  v_cvt_pk_bf16_f32 v47, v134, v135
  ds_write_b64 v11, v[46:47] offset:16000
  v_cvt_pk_bf16_f32 v48, v168, v169
  v_mfma_f32_16x16x32_bf16 v[212:215], v[72:75], v[104:107], v[212:215]
  v_cvt_pk_bf16_f32 v49, v170, v171
  ds_write_b64 v11, v[48:49] offset:16128
  v_cvt_pk_bf16_f32 v50, v204, v205
  v_cvt_pk_bf16_f32 v51, v206, v207
  ds_write_b64 v11, v[50:51] offset:16256
  v_pk_fma_f32 v[136:137], v[242:243], v[236:237], v[136:137] op_sel_hi:[1,0,1] neg_lo:[0,1,0] neg_hi:[0,1,0]
  v_pk_fma_f32 v[138:139], v[244:245], v[236:237], v[138:139] op_sel_hi:[1,0,1] neg_lo:[0,1,0] neg_hi:[0,1,0]
  v_mfma_f32_16x16x32_bf16 v[176:179], v[68:71], v[104:107], v[176:179]
  v_pk_fma_f32 v[172:173], v[246:247], v[236:237], v[172:173] op_sel_hi:[1,0,1] neg_lo:[0,1,0] neg_hi:[0,1,0]
  v_pk_fma_f32 v[174:175], v[248:249], v[236:237], v[174:175] op_sel_hi:[1,0,1] neg_lo:[0,1,0] neg_hi:[0,1,0]
  v_pk_fma_f32 v[208:209], v[250:251], v[236:237], v[208:209] op_sel_hi:[1,0,1] neg_lo:[0,1,0] neg_hi:[0,1,0]
  v_pk_fma_f32 v[210:211], v[252:253], v[236:237], v[210:211] op_sel_hi:[1,0,1] neg_lo:[0,1,0] neg_hi:[0,1,0]
  v_pk_mul_f32 v[136:137], v[136:137], v[236:237] op_sel:[0,1] op_sel_hi:[1,1]
  v_pk_mul_f32 v[138:139], v[138:139], v[236:237] op_sel:[0,1] op_sel_hi:[1,1]
  v_pk_mul_f32 v[172:173], v[172:173], v[236:237] op_sel:[0,1] op_sel_hi:[1,1]
  v_mfma_f32_16x16x32_bf16 v[140:143], v[64:67], v[104:107], v[140:143]
  v_pk_mul_f32 v[174:175], v[174:175], v[236:237] op_sel:[0,1] op_sel_hi:[1,1]
  v_pk_mul_f32 v[208:209], v[208:209], v[236:237] op_sel:[0,1] op_sel_hi:[1,1]
  v_pk_mul_f32 v[210:211], v[210:211], v[236:237] op_sel:[0,1] op_sel_hi:[1,1]
  v_cvt_pk_bf16_f32 v52, v136, v137
  v_cvt_pk_bf16_f32 v53, v138, v139
  ds_write_b64 v11, v[52:53] offset:19200
  v_cvt_pk_bf16_f32 v54, v172, v173
  v_mfma_f32_16x16x32_bf16 v[144:147], v[64:67], v[108:111], v[144:147]
  v_cvt_pk_bf16_f32 v55, v174, v175
  ds_write_b64 v11, v[54:55] offset:19328
  v_cvt_pk_bf16_f32 v56, v208, v209
  v_cvt_pk_bf16_f32 v57, v210, v211
  ds_write_b64 v11, v[56:57] offset:19456
  v_pk_fma_f32 v[140:141], v[242:243], v[238:239], v[140:141] op_sel_hi:[1,0,1] neg_lo:[0,1,0] neg_hi:[0,1,0]
  v_pk_fma_f32 v[142:143], v[244:245], v[238:239], v[142:143] op_sel_hi:[1,0,1] neg_lo:[0,1,0] neg_hi:[0,1,0]
  v_mfma_f32_16x16x32_bf16 v[180:183], v[68:71], v[108:111], v[180:183]
  v_pk_fma_f32 v[176:177], v[246:247], v[238:239], v[176:177] op_sel_hi:[1,0,1] neg_lo:[0,1,0] neg_hi:[0,1,0]
  v_pk_fma_f32 v[178:179], v[248:249], v[238:239], v[178:179] op_sel_hi:[1,0,1] neg_lo:[0,1,0] neg_hi:[0,1,0]
  v_pk_fma_f32 v[212:213], v[250:251], v[238:239], v[212:213] op_sel_hi:[1,0,1] neg_lo:[0,1,0] neg_hi:[0,1,0]
  v_pk_fma_f32 v[214:215], v[252:253], v[238:239], v[214:215] op_sel_hi:[1,0,1] neg_lo:[0,1,0] neg_hi:[0,1,0]
  v_pk_mul_f32 v[140:141], v[140:141], v[238:239] op_sel:[0,1] op_sel_hi:[1,1]
  v_pk_mul_f32 v[142:143], v[142:143], v[238:239] op_sel:[0,1] op_sel_hi:[1,1]
  v_pk_mul_f32 v[176:177], v[176:177], v[238:239] op_sel:[0,1] op_sel_hi:[1,1]
  v_mfma_f32_16x16x32_bf16 v[216:219], v[72:75], v[108:111], v[216:219]
  v_pk_mul_f32 v[178:179], v[178:179], v[238:239] op_sel:[0,1] op_sel_hi:[1,1]
  v_pk_mul_f32 v[212:213], v[212:213], v[238:239] op_sel:[0,1] op_sel_hi:[1,1]
  v_pk_mul_f32 v[214:215], v[214:215], v[238:239] op_sel:[0,1] op_sel_hi:[1,1]
  v_cvt_pk_bf16_f32 v58, v140, v141
  v_cvt_pk_bf16_f32 v59, v142, v143
  ds_write_b64 v11, v[58:59] offset:22400
  v_cvt_pk_bf16_f32 v60, v176, v177
  s_barrier
  v_cvt_pk_bf16_f32 v61, v178, v179
  ds_write_b64 v11, v[60:61] offset:22528
  v_cvt_pk_bf16_f32 v62, v212, v213
  v_cvt_pk_bf16_f32 v63, v214, v215
  ds_write_b64 v11, v[62:63] offset:22656
  v_pk_fma_f32 v[144:145], v[242:243], v[240:241], v[144:145] op_sel_hi:[1,0,1] neg_lo:[0,1,0] neg_hi:[0,1,0]
  v_pk_fma_f32 v[146:147], v[244:245], v[240:241], v[146:147] op_sel_hi:[1,0,1] neg_lo:[0,1,0] neg_hi:[0,1,0]
  v_pk_fma_f32 v[180:181], v[246:247], v[240:241], v[180:181] op_sel_hi:[1,0,1] neg_lo:[0,1,0] neg_hi:[0,1,0]
  v_pk_fma_f32 v[182:183], v[248:249], v[240:241], v[182:183] op_sel_hi:[1,0,1] neg_lo:[0,1,0] neg_hi:[0,1,0]
  v_pk_fma_f32 v[216:217], v[250:251], v[240:241], v[216:217] op_sel_hi:[1,0,1] neg_lo:[0,1,0] neg_hi:[0,1,0]
  v_pk_fma_f32 v[218:219], v[252:253], v[240:241], v[218:219] op_sel_hi:[1,0,1] neg_lo:[0,1,0] neg_hi:[0,1,0]
  v_pk_mul_f32 v[144:145], v[144:145], v[240:241] op_sel:[0,1] op_sel_hi:[1,1]
  v_pk_mul_f32 v[146:147], v[146:147], v[240:241] op_sel:[0,1] op_sel_hi:[1,1]
  v_pk_mul_f32 v[180:181], v[180:181], v[240:241] op_sel:[0,1] op_sel_hi:[1,1]
  v_pk_mul_f32 v[182:183], v[182:183], v[240:241] op_sel:[0,1] op_sel_hi:[1,1]
  v_pk_mul_f32 v[216:217], v[216:217], v[240:241] op_sel:[0,1] op_sel_hi:[1,1]
  v_pk_mul_f32 v[218:219], v[218:219], v[240:241] op_sel:[0,1] op_sel_hi:[1,1]
  v_cvt_pk_bf16_f32 v16, v144, v145
  v_cvt_pk_bf16_f32 v17, v146, v147
  ds_write_b64 v11, v[16:17] offset:25600
  v_cvt_pk_bf16_f32 v18, v180, v181
  v_cvt_pk_bf16_f32 v19, v182, v183
  ds_write_b64 v11, v[18:19] offset:25728
  v_cvt_pk_bf16_f32 v20, v216, v217
  v_cvt_pk_bf16_f32 v21, v218, v219
  ds_write_b64 v11, v[20:21] offset:25856
  s_branch attn
C_top1:
  s_nop 7
  s_nop 7
  s_mov_b32 s43, 0
  s_mov_b32 s39, 15
  s_barrier
  ds_read_b64_tr_b16 v[16:17], v8 offset:0
  ds_read_b64_tr_b16 v[18:19], v8 offset:512
  ds_read_b128 v[28:31], v9 offset:0
  ds_read_b64_tr_b16 v[20:21], v8 offset:8192
  ds_read_b64_tr_b16 v[22:23], v8 offset:8704
  ds_read_b64_tr_b16 v[24:25], v8 offset:16384
  ds_read_b64_tr_b16 v[26:27], v8 offset:16896
  ds_read_b128 v[32:35], v9 offset:2048
  ds_read_b128 v[36:39], v9 offset:4096
  ds_read_b128 v[40:43], v9 offset:6144
  ds_read_b128 v[44:47], v9 offset:8192
  ds_read_b128 v[48:51], v9 offset:10240
  ds_read_b128 v[52:55], v9 offset:12288
  ds_read_b128 v[56:59], v9 offset:14336
  ds_read_b128 v[60:63], v9 offset:16384
  s_add_u32 s40, s43, 43008
  s_cmp_eq_u32 s40, 129024
  s_cselect_b32 s40, 0, s40
  s_sub_u32 s42, s40, s43
  s_mov_b32 s43, s40
cl2:
  s_waitcnt lgkmcnt(10)
  v_mfma_f32_16x16x32_bf16 v[148:151], v[20:23], v[28:31], v[148:151]
  ds_read_b64_tr_b16 v[64:65], v8 offset:4096
  s_waitcnt lgkmcnt(9)
  v_mfma_f32_16x16x32_bf16 v[184:187], v[24:27], v[28:31], v[184:187]
  ds_read_b64_tr_b16 v[66:67], v8 offset:4608
  s_waitcnt lgkmcnt(9)
  v_mfma_f32_16x16x32_bf16 v[188:191], v[24:27], v[32:35], v[188:191]
  ds_read_b128 v[76:79], v10 offset:0
  v_mfma_f32_16x16x32_bf16 v[152:155], v[20:23], v[32:35], v[152:155]
  ds_read_b64_tr_b16 v[68:69], v8 offset:12288
  v_mfma_f32_16x16x32_bf16 v[116:119], v[16:19], v[32:35], v[116:119]
  ds_read_b64_tr_b16 v[70:71], v8 offset:12800
  s_waitcnt lgkmcnt(11)
  v_mfma_f32_16x16x32_bf16 v[120:123], v[16:19], v[36:39], v[120:123]
  ds_read_b64_tr_b16 v[72:73], v8 offset:20480
  v_mfma_f32_16x16x32_bf16 v[156:159], v[20:23], v[36:39], v[156:159]
  ds_read_b64_tr_b16 v[74:75], v8 offset:20992
  v_add_u32 v8, s42, v8
  v_mfma_f32_16x16x32_bf16 v[192:195], v[24:27], v[36:39], v[192:195]
  ds_read_b128 v[80:83], v10 offset:2048
  s_waitcnt lgkmcnt(13)
  v_mfma_f32_16x16x32_bf16 v[196:199], v[24:27], v[40:43], v[196:199]
  ds_read_b128 v[84:87], v10 offset:4096
  v_mfma_f32_16x16x32_bf16 v[160:163], v[20:23], v[40:43], v[160:163]
  ds_read_b128 v[88:91], v10 offset:6144
  v_mfma_f32_16x16x32_bf16 v[124:127], v[16:19], v[40:43], v[124:127]
  ds_read_b128 v[92:95], v10 offset:8192
  s_waitcnt lgkmcnt(14)
  v_mfma_f32_16x16x32_bf16 v[128:131], v[16:19], v[44:47], v[128:131]
  ds_read_b128 v[96:99], v10 offset:10240
  v_mfma_f32_16x16x32_bf16 v[164:167], v[20:23], v[44:47], v[164:167]
  ds_read_b128 v[100:103], v10 offset:12288
  v_mfma_f32_16x16x32_bf16 v[200:203], v[24:27], v[44:47], v[200:203]
  ds_read_b128 v[104:107], v10 offset:14336
  v_mfma_f32_16x16x32_bf16 v[204:207], v[24:27], v[48:51], v[204:207]
  ds_read_b128 v[108:111], v10 offset:16384
  v_add_u32 v9, s42, v9
  v_add_u32 v10, s42, v10
  v_mfma_f32_16x16x32_bf16 v[168:171], v[20:23], v[48:51], v[168:171]
  v_mfma_f32_16x16x32_bf16 v[132:135], v[16:19], v[48:51], v[132:135]
  s_waitcnt lgkmcnt(14)
  v_mfma_f32_16x16x32_bf16 v[136:139], v[16:19], v[52:55], v[136:139]
  v_mfma_f32_16x16x32_bf16 v[172:175], v[20:23], v[52:55], v[172:175]
  v_mfma_f32_16x16x32_bf16 v[208:211], v[24:27], v[52:55], v[208:211]
  v_mfma_f32_16x16x32_bf16 v[212:215], v[24:27], v[56:59], v[212:215]
  v_mfma_f32_16x16x32_bf16 v[176:179], v[20:23], v[56:59], v[176:179]
  v_mfma_f32_16x16x32_bf16 v[140:143], v[16:19], v[56:59], v[140:143]
  v_mfma_f32_16x16x32_bf16 v[144:147], v[16:19], v[60:63], v[144:147]
  v_mfma_f32_16x16x32_bf16 v[180:183], v[20:23], v[60:63], v[180:183]
  v_mfma_f32_16x16x32_bf16 v[216:219], v[24:27], v[60:63], v[216:219]
  s_waitcnt lgkmcnt(0)
  s_barrier
  v_mfma_f32_16x16x32_bf16 v[148:151], v[68:71], v[76:79], v[148:151]
  ds_read_b64_tr_b16 v[16:17], v8 offset:0
  s_add_u32 s40, s43, 43008
  v_mfma_f32_16x16x32_bf16 v[184:187], v[72:75], v[76:79], v[184:187]
  ds_read_b64_tr_b16 v[18:19], v8 offset:512
  s_cmp_eq_u32 s40, 129024
  v_mfma_f32_16x16x32_bf16 v[188:191], v[72:75], v[80:83], v[188:191]
  ds_read_b128 v[28:31], v9 offset:0
  s_cselect_b32 s40, 0, s40
  v_mfma_f32_16x16x32_bf16 v[152:155], v[68:71], v[80:83], v[152:155]
  ds_read_b64_tr_b16 v[20:21], v8 offset:8192
  s_sub_u32 s42, s40, s43
  v_mfma_f32_16x16x32_bf16 v[116:119], v[64:67], v[80:83], v[116:119]
  ds_read_b64_tr_b16 v[22:23], v8 offset:8704
  s_mov_b32 s43, s40
  v_mfma_f32_16x16x32_bf16 v[120:123], v[64:67], v[84:87], v[120:123]
  ds_read_b64_tr_b16 v[24:25], v8 offset:16384
  v_mfma_f32_16x16x32_bf16 v[156:159], v[68:71], v[84:87], v[156:159]
  ds_read_b64_tr_b16 v[26:27], v8 offset:16896
  v_mfma_f32_16x16x32_bf16 v[192:195], v[72:75], v[84:87], v[192:195]
  ds_read_b128 v[32:35], v9 offset:2048
  v_mfma_f32_16x16x32_bf16 v[196:199], v[72:75], v[88:91], v[196:199]
  ds_read_b128 v[36:39], v9 offset:4096
  v_mfma_f32_16x16x32_bf16 v[160:163], v[68:71], v[88:91], v[160:163]
  ds_read_b128 v[40:43], v9 offset:6144
  v_mfma_f32_16x16x32_bf16 v[124:127], v[64:67], v[88:91], v[124:127]
  ds_read_b128 v[44:47], v9 offset:8192
  v_mfma_f32_16x16x32_bf16 v[128:131], v[64:67], v[92:95], v[128:131]
  ds_read_b128 v[48:51], v9 offset:10240
  v_mfma_f32_16x16x32_bf16 v[164:167], v[68:71], v[92:95], v[164:167]
  ds_read_b128 v[52:55], v9 offset:12288
  v_mfma_f32_16x16x32_bf16 v[200:203], v[72:75], v[92:95], v[200:203]
  ds_read_b128 v[56:59], v9 offset:14336
  v_mfma_f32_16x16x32_bf16 v[204:207], v[72:75], v[96:99], v[204:207]
  ds_read_b128 v[60:63], v9 offset:16384
  v_mfma_f32_16x16x32_bf16 v[168:171], v[68:71], v[96:99], v[168:171]
  v_mfma_f32_16x16x32_bf16 v[132:135], v[64:67], v[96:99], v[132:135]
  v_mfma_f32_16x16x32_bf16 v[136:139], v[64:67], v[100:103], v[136:139]
  v_mfma_f32_16x16x32_bf16 v[172:175], v[68:71], v[100:103], v[172:175]
  v_mfma_f32_16x16x32_bf16 v[208:211], v[72:75], v[100:103], v[208:211]
  v_mfma_f32_16x16x32_bf16 v[212:215], v[72:75], v[104:107], v[212:215]
  v_mfma_f32_16x16x32_bf16 v[176:179], v[68:71], v[104:107], v[176:179]
  v_mfma_f32_16x16x32_bf16 v[140:143], v[64:67], v[104:107], v[140:143]
  v_mfma_f32_16x16x32_bf16 v[144:147], v[64:67], v[108:111], v[144:147]
  v_mfma_f32_16x16x32_bf16 v[180:183], v[68:71], v[108:111], v[180:183]
  v_mfma_f32_16x16x32_bf16 v[216:219], v[72:75], v[108:111], v[216:219]
  s_sub_u32 s39, s39, 1
  s_cmp_lg_u32 s39, 0
  s_cbranch_scc1 cl2
  s_waitcnt lgkmcnt(10)
  v_mfma_f32_16x16x32_bf16 v[148:151], v[20:23], v[28:31], v[148:151]
  ds_read_b64_tr_b16 v[64:65], v8 offset:4096
  s_waitcnt lgkmcnt(9)
  v_mfma_f32_16x16x32_bf16 v[184:187], v[24:27], v[28:31], v[184:187]
  ds_read_b64_tr_b16 v[66:67], v8 offset:4608
  s_waitcnt lgkmcnt(9)
  v_mfma_f32_16x16x32_bf16 v[188:191], v[24:27], v[32:35], v[188:191]
  ds_read_b128 v[76:79], v10 offset:0
  v_mfma_f32_16x16x32_bf16 v[152:155], v[20:23], v[32:35], v[152:155]
  ds_read_b64_tr_b16 v[68:69], v8 offset:12288
  v_mfma_f32_16x16x32_bf16 v[116:119], v[16:19], v[32:35], v[116:119]
  ds_read_b64_tr_b16 v[70:71], v8 offset:12800
  s_waitcnt lgkmcnt(11)
  v_mfma_f32_16x16x32_bf16 v[120:123], v[16:19], v[36:39], v[120:123]
  ds_read_b64_tr_b16 v[72:73], v8 offset:20480
  v_mfma_f32_16x16x32_bf16 v[156:159], v[20:23], v[36:39], v[156:159]
  ds_read_b64_tr_b16 v[74:75], v8 offset:20992
  v_mfma_f32_16x16x32_bf16 v[192:195], v[24:27], v[36:39], v[192:195]
  ds_read_b128 v[80:83], v10 offset:2048
  s_waitcnt lgkmcnt(13)
  v_mfma_f32_16x16x32_bf16 v[196:199], v[24:27], v[40:43], v[196:199]
  ds_read_b128 v[84:87], v10 offset:4096
  v_mfma_f32_16x16x32_bf16 v[160:163], v[20:23], v[40:43], v[160:163]
  ds_read_b128 v[88:91], v10 offset:6144
  v_mfma_f32_16x16x32_bf16 v[124:127], v[16:19], v[40:43], v[124:127]
  ds_read_b128 v[92:95], v10 offset:8192
  s_waitcnt lgkmcnt(14)
  v_mfma_f32_16x16x32_bf16 v[128:131], v[16:19], v[44:47], v[128:131]
  ds_read_b128 v[96:99], v10 offset:10240
  v_mfma_f32_16x16x32_bf16 v[164:167], v[20:23], v[44:47], v[164:167]
  ds_read_b128 v[100:103], v10 offset:12288
  v_mfma_f32_16x16x32_bf16 v[200:203], v[24:27], v[44:47], v[200:203]
  ds_read_b128 v[104:107], v10 offset:14336
  v_mfma_f32_16x16x32_bf16 v[204:207], v[24:27], v[48:51], v[204:207]
  ds_read_b128 v[108:111], v10 offset:16384
  v_mfma_f32_16x16x32_bf16 v[168:171], v[20:23], v[48:51], v[168:171]
  ds_read_b64 v[224:225], v12 offset:0
  v_mfma_f32_16x16x32_bf16 v[132:135], v[16:19], v[48:51], v[132:135]
  ds_read_b64 v[226:227], v12 offset:128
  s_waitcnt lgkmcnt(14)
  v_mfma_f32_16x16x32_bf16 v[136:139], v[16:19], v[52:55], v[136:139]
  ds_read_b64 v[228:229], v12 offset:256
  v_mfma_f32_16x16x32_bf16 v[172:175], v[20:23], v[52:55], v[172:175]
  ds_read_b64 v[230:231], v12 offset:384
  v_mfma_f32_16x16x32_bf16 v[208:211], v[24:27], v[52:55], v[208:211]
  ds_read_b64 v[232:233], v12 offset:512
  v_mfma_f32_16x16x32_bf16 v[212:215], v[24:27], v[56:59], v[212:215]
  ds_read_b64 v[234:235], v12 offset:640
  v_mfma_f32_16x16x32_bf16 v[176:179], v[20:23], v[56:59], v[176:179]
  ds_read_b64 v[236:237], v12 offset:768
  v_mfma_f32_16x16x32_bf16 v[140:143], v[16:19], v[56:59], v[140:143]
  ds_read_b64 v[238:239], v12 offset:896
  v_mfma_f32_16x16x32_bf16 v[144:147], v[16:19], v[60:63], v[144:147]
  ds_read_b64 v[240:241], v12 offset:1024
  v_mfma_f32_16x16x32_bf16 v[180:183], v[20:23], v[60:63], v[180:183]
  v_mfma_f32_16x16x32_bf16 v[216:219], v[24:27], v[60:63], v[216:219]
  s_waitcnt lgkmcnt(0)
  v_mfma_f32_16x16x32_bf16 v[148:151], v[68:71], v[76:79], v[148:151]
  v_mfma_f32_16x16x32_bf16 v[184:187], v[72:75], v[76:79], v[184:187]
  v_mfma_f32_16x16x32_bf16 v[188:191], v[72:75], v[80:83], v[188:191]
  s_nop 5
  v_mov_b32_dpp v246, v148 row_newbcast:0 row_mask:0xf bank_mask:0xf
  v_mov_b32_dpp v247, v149 row_newbcast:0 row_mask:0xf bank_mask:0xf
  v_mov_b32_dpp v248, v150 row_newbcast:0 row_mask:0xf bank_mask:0xf
  v_mov_b32_dpp v249, v151 row_newbcast:0 row_mask:0xf bank_mask:0xf
  v_mov_b32_dpp v250, v184 row_newbcast:0 row_mask:0xf bank_mask:0xf
  v_mov_b32_dpp v251, v185 row_newbcast:0 row_mask:0xf bank_mask:0xf
  v_mov_b32_dpp v252, v186 row_newbcast:0 row_mask:0xf bank_mask:0xf
  v_mfma_f32_16x16x32_bf16 v[152:155], v[68:71], v[80:83], v[152:155]
  v_mov_b32_dpp v253, v187 row_newbcast:0 row_mask:0xf bank_mask:0xf
  v_pk_fma_f32 v[148:149], v[246:247], v[224:225], v[148:149] op_sel_hi:[1,0,1] neg_lo:[0,1,0] neg_hi:[0,1,0]
  v_pk_fma_f32 v[150:151], v[248:249], v[224:225], v[150:151] op_sel_hi:[1,0,1] neg_lo:[0,1,0] neg_hi:[0,1,0]
  v_pk_fma_f32 v[184:185], v[250:251], v[224:225], v[184:185] op_sel_hi:[1,0,1] neg_lo:[0,1,0] neg_hi:[0,1,0]
  v_pk_fma_f32 v[186:187], v[252:253], v[224:225], v[186:187] op_sel_hi:[1,0,1] neg_lo:[0,1,0] neg_hi:[0,1,0]
  v_pk_mul_f32 v[148:149], v[148:149], v[224:225] op_sel:[0,1] op_sel_hi:[1,1]
  v_pk_mul_f32 v[150:151], v[150:151], v[224:225] op_sel:[0,1] op_sel_hi:[1,1]
  v_mfma_f32_16x16x32_bf16 v[116:119], v[64:67], v[80:83], v[116:119]
  v_pk_mul_f32 v[184:185], v[184:185], v[224:225] op_sel:[0,1] op_sel_hi:[1,1]
  v_pk_mul_f32 v[186:187], v[186:187], v[224:225] op_sel:[0,1] op_sel_hi:[1,1]
  v_cvt_pk_bf16_f32 v16, v148, v149
  v_cvt_pk_bf16_f32 v17, v150, v151
  ds_write_b64 v11, v[16:17] offset:128
  v_cvt_pk_bf16_f32 v18, v184, v185
  v_cvt_pk_bf16_f32 v19, v186, v187
  v_mfma_f32_16x16x32_bf16 v[120:123], v[64:67], v[84:87], v[120:123]
  ds_write_b64 v11, v[18:19] offset:256
  v_pk_fma_f32 v[116:117], v[242:243], v[226:227], v[116:117] op_sel_hi:[1,0,1] neg_lo:[0,1,0] neg_hi:[0,1,0]
  v_pk_fma_f32 v[118:119], v[244:245], v[226:227], v[118:119] op_sel_hi:[1,0,1] neg_lo:[0,1,0] neg_hi:[0,1,0]
  v_pk_fma_f32 v[152:153], v[246:247], v[226:227], v[152:153] op_sel_hi:[1,0,1] neg_lo:[0,1,0] neg_hi:[0,1,0]
  v_pk_fma_f32 v[154:155], v[248:249], v[226:227], v[154:155] op_sel_hi:[1,0,1] neg_lo:[0,1,0] neg_hi:[0,1,0]
  v_pk_fma_f32 v[188:189], v[250:251], v[226:227], v[188:189] op_sel_hi:[1,0,1] neg_lo:[0,1,0] neg_hi:[0,1,0]
  v_pk_fma_f32 v[190:191], v[252:253], v[226:227], v[190:191] op_sel_hi:[1,0,1] neg_lo:[0,1,0] neg_hi:[0,1,0]
  v_mfma_f32_16x16x32_bf16 v[156:159], v[68:71], v[84:87], v[156:159]
  v_pk_mul_f32 v[116:117], v[116:117], v[226:227] op_sel:[0,1] op_sel_hi:[1,1]
  v_pk_mul_f32 v[118:119], v[118:119], v[226:227] op_sel:[0,1] op_sel_hi:[1,1]
  v_pk_mul_f32 v[152:153], v[152:153], v[226:227] op_sel:[0,1] op_sel_hi:[1,1]
  v_pk_mul_f32 v[154:155], v[154:155], v[226:227] op_sel:[0,1] op_sel_hi:[1,1]
  v_pk_mul_f32 v[188:189], v[188:189], v[226:227] op_sel:[0,1] op_sel_hi:[1,1]
  v_pk_mul_f32 v[190:191], v[190:191], v[226:227] op_sel:[0,1] op_sel_hi:[1,1]
  v_cvt_pk_bf16_f32 v22, v116, v117
  v_mfma_f32_16x16x32_bf16 v[192:195], v[72:75], v[84:87], v[192:195]
  v_cvt_pk_bf16_f32 v23, v118, v119
  ds_write_b64 v11, v[22:23] offset:3200
  v_cvt_pk_bf16_f32 v24, v152, v153
  v_cvt_pk_bf16_f32 v25, v154, v155
  ds_write_b64 v11, v[24:25] offset:3328
  v_cvt_pk_bf16_f32 v26, v188, v189
  v_cvt_pk_bf16_f32 v27, v190, v191
  v_mfma_f32_16x16x32_bf16 v[196:199], v[72:75], v[88:91], v[196:199]
  ds_write_b64 v11, v[26:27] offset:3456
  v_pk_fma_f32 v[120:121], v[242:243], v[228:229], v[120:121] op_sel_hi:[1,0,1] neg_lo:[0,1,0] neg_hi:[0,1,0]
  v_pk_fma_f32 v[122:123], v[244:245], v[228:229], v[122:123] op_sel_hi:[1,0,1] neg_lo:[0,1,0] neg_hi:[0,1,0]
  v_pk_fma_f32 v[156:157], v[246:247], v[228:229], v[156:157] op_sel_hi:[1,0,1] neg_lo:[0,1,0] neg_hi:[0,1,0]
  v_pk_fma_f32 v[158:159], v[248:249], v[228:229], v[158:159] op_sel_hi:[1,0,1] neg_lo:[0,1,0] neg_hi:[0,1,0]
  v_pk_fma_f32 v[192:193], v[250:251], v[228:229], v[192:193] op_sel_hi:[1,0,1] neg_lo:[0,1,0] neg_hi:[0,1,0]
  v_pk_fma_f32 v[194:195], v[252:253], v[228:229], v[194:195] op_sel_hi:[1,0,1] neg_lo:[0,1,0] neg_hi:[0,1,0]
  v_mfma_f32_16x16x32_bf16 v[160:163], v[68:71], v[88:91], v[160:163]
  v_pk_mul_f32 v[120:121], v[120:121], v[228:229] op_sel:[0,1] op_sel_hi:[1,1]
  v_pk_mul_f32 v[122:123], v[122:123], v[228:229] op_sel:[0,1] op_sel_hi:[1,1]
  v_pk_mul_f32 v[156:157], v[156:157], v[228:229] op_sel:[0,1] op_sel_hi:[1,1]
  v_pk_mul_f32 v[158:159], v[158:159], v[228:229] op_sel:[0,1] op_sel_hi:[1,1]
  v_pk_mul_f32 v[192:193], v[192:193], v[228:229] op_sel:[0,1] op_sel_hi:[1,1]
  v_pk_mul_f32 v[194:195], v[194:195], v[228:229] op_sel:[0,1] op_sel_hi:[1,1]
  v_cvt_pk_bf16_f32 v28, v120, v121
  v_mfma_f32_16x16x32_bf16 v[124:127], v[64:67], v[88:91], v[124:127]
  v_cvt_pk_bf16_f32 v29, v122, v123
  ds_write_b64 v11, v[28:29] offset:6400
  v_cvt_pk_bf16_f32 v30, v156, v157
  v_cvt_pk_bf16_f32 v31, v158, v159
  ds_write_b64 v11, v[30:31] offset:6528
  v_cvt_pk_bf16_f32 v32, v192, v193
  v_cvt_pk_bf16_f32 v33, v194, v195
  v_mfma_f32_16x16x32_bf16 v[128:131], v[64:67], v[92:95], v[128:131]
  ds_write_b64 v11, v[32:33] offset:6656
  v_pk_fma_f32 v[124:125], v[242:243], v[230:231], v[124:125] op_sel_hi:[1,0,1] neg_lo:[0,1,0] neg_hi:[0,1,0]
  v_pk_fma_f32 v[126:127], v[244:245], v[230:231], v[126:127] op_sel_hi:[1,0,1] neg_lo:[0,1,0] neg_hi:[0,1,0]
  v_pk_fma_f32 v[160:161], v[246:247], v[230:231], v[160:161] op_sel_hi:[1,0,1] neg_lo:[0,1,0] neg_hi:[0,1,0]
  v_pk_fma_f32 v[162:163], v[248:249], v[230:231], v[162:163] op_sel_hi:[1,0,1] neg_lo:[0,1,0] neg_hi:[0,1,0]
  v_pk_fma_f32 v[196:197], v[250:251], v[230:231], v[196:197] op_sel_hi:[1,0,1] neg_lo:[0,1,0] neg_hi:[0,1,0]
  v_pk_fma_f32 v[198:199], v[252:253], v[230:231], v[198:199] op_sel_hi:[1,0,1] neg_lo:[0,1,0] neg_hi:[0,1,0]
  v_mfma_f32_16x16x32_bf16 v[164:167], v[68:71], v[92:95], v[164:167]
  v_pk_mul_f32 v[124:125], v[124:125], v[230:231] op_sel:[0,1] op_sel_hi:[1,1]
  v_pk_mul_f32 v[126:127], v[126:127], v[230:231] op_sel:[0,1] op_sel_hi:[1,1]
  v_pk_mul_f32 v[160:161], v[160:161], v[230:231] op_sel:[0,1] op_sel_hi:[1,1]
  v_pk_mul_f32 v[162:163], v[162:163], v[230:231] op_sel:[0,1] op_sel_hi:[1,1]
  v_pk_mul_f32 v[196:197], v[196:197], v[230:231] op_sel:[0,1] op_sel_hi:[1,1]
  v_pk_mul_f32 v[198:199], v[198:199], v[230:231] op_sel:[0,1] op_sel_hi:[1,1]
  v_cvt_pk_bf16_f32 v34, v124, v125
  v_mfma_f32_16x16x32_bf16 v[200:203], v[72:75], v[92:95], v[200:203]
  v_cvt_pk_bf16_f32 v35, v126, v127
  ds_write_b64 v11, v[34:35] offset:9600
  v_cvt_pk_bf16_f32 v36, v160, v161
  v_cvt_pk_bf16_f32 v37, v162, v163
  ds_write_b64 v11, v[36:37] offset:9728
  v_cvt_pk_bf16_f32 v38, v196, v197
  v_cvt_pk_bf16_f32 v39, v198, v199
  v_mfma_f32_16x16x32_bf16 v[204:207], v[72:75], v[96:99], v[204:207]
  ds_write_b64 v11, v[38:39] offset:9856
  v_pk_fma_f32 v[128:129], v[242:243], v[232:233], v[128:129] op_sel_hi:[1,0,1] neg_lo:[0,1,0] neg_hi:[0,1,0]
  v_pk_fma_f32 v[130:131], v[244:245], v[232:233], v[130:131] op_sel_hi:[1,0,1] neg_lo:[0,1,0] neg_hi:[0,1,0]
  v_pk_fma_f32 v[164:165], v[246:247], v[232:233], v[164:165] op_sel_hi:[1,0,1] neg_lo:[0,1,0] neg_hi:[0,1,0]
  v_pk_fma_f32 v[166:167], v[248:249], v[232:233], v[166:167] op_sel_hi:[1,0,1] neg_lo:[0,1,0] neg_hi:[0,1,0]
  v_pk_fma_f32 v[200:201], v[250:251], v[232:233], v[200:201] op_sel_hi:[1,0,1] neg_lo:[0,1,0] neg_hi:[0,1,0]
  v_pk_fma_f32 v[202:203], v[252:253], v[232:233], v[202:203] op_sel_hi:[1,0,1] neg_lo:[0,1,0] neg_hi:[0,1,0]
  v_mfma_f32_16x16x32_bf16 v[168:171], v[68:71], v[96:99], v[168:171]
  v_pk_mul_f32 v[128:129], v[128:129], v[232:233] op_sel:[0,1] op_sel_hi:[1,1]
  v_pk_mul_f32 v[130:131], v[130:131], v[232:233] op_sel:[0,1] op_sel_hi:[1,1]
  v_pk_mul_f32 v[164:165], v[164:165], v[232:233] op_sel:[0,1] op_sel_hi:[1,1]
  v_pk_mul_f32 v[166:167], v[166:167], v[232:233] op_sel:[0,1] op_sel_hi:[1,1]
  v_pk_mul_f32 v[200:201], v[200:201], v[232:233] op_sel:[0,1] op_sel_hi:[1,1]
  v_pk_mul_f32 v[202:203], v[202:203], v[232:233] op_sel:[0,1] op_sel_hi:[1,1]
  v_cvt_pk_bf16_f32 v40, v128, v129
  v_mfma_f32_16x16x32_bf16 v[132:135], v[64:67], v[96:99], v[132:135]
  v_cvt_pk_bf16_f32 v41, v130, v131
  ds_write_b64 v11, v[40:41] offset:12800
  v_cvt_pk_bf16_f32 v42, v164, v165
  v_cvt_pk_bf16_f32 v43, v166, v167
  ds_write_b64 v11, v[42:43] offset:12928
  v_cvt_pk_bf16_f32 v44, v200, v201
  v_cvt_pk_bf16_f32 v45, v202, v203
  v_mfma_f32_16x16x32_bf16 v[136:139], v[64:67], v[100:103], v[136:139]
  ds_write_b64 v11, v[44:45] offset:13056
  v_pk_fma_f32 v[132:133], v[242:243], v[234:235], v[132:133] op_sel_hi:[1,0,1] neg_lo:[0,1,0] neg_hi:[0,1,0]
  v_pk_fma_f32 v[134:135], v[244:245], v[234:235], v[134:135] op_sel_hi:[1,0,1] neg_lo:[0,1,0] neg_hi:[0,1,0]
  v_pk_fma_f32 v[168:169], v[246:247], v[234:235], v[168:169] op_sel_hi:[1,0,1] neg_lo:[0,1,0] neg_hi:[0,1,0]
  v_pk_fma_f32 v[170:171], v[248:249], v[234:235], v[170:171] op_sel_hi:[1,0,1] neg_lo:[0,1,0] neg_hi:[0,1,0]
  v_pk_fma_f32 v[204:205], v[250:251], v[234:235], v[204:205] op_sel_hi:[1,0,1] neg_lo:[0,1,0] neg_hi:[0,1,0]
  v_pk_fma_f32 v[206:207], v[252:253], v[234:235], v[206:207] op_sel_hi:[1,0,1] neg_lo:[0,1,0] neg_hi:[0,1,0]
  v_mfma_f32_16x16x32_bf16 v[172:175], v[68:71], v[100:103], v[172:175]
  v_pk_mul_f32 v[132:133], v[132:133], v[234:235] op_sel:[0,1] op_sel_hi:[1,1]
  v_pk_mul_f32 v[134:135], v[134:135], v[234:235] op_sel:[0,1] op_sel_hi:[1,1]
  v_pk_mul_f32 v[168:169], v[168:169], v[234:235] op_sel:[0,1] op_sel_hi:[1,1]
  v_pk_mul_f32 v[170:171], v[170:171], v[234:235] op_sel:[0,1] op_sel_hi:[1,1]
  v_pk_mul_f32 v[204:205], v[204:205], v[234:235] op_sel:[0,1] op_sel_hi:[1,1]
  v_pk_mul_f32 v[206:207], v[206:207], v[234:235] op_sel:[0,1] op_sel_hi:[1,1]
  v_cvt_pk_bf16_f32 v46, v132, v133
  v_mfma_f32_16x16x32_bf16 v[208:211], v[72:75], v[100:103], v[208:211]
  v_cvt_pk_bf16_f32 v47, v134, v135
  ds_write_b64 v11, v[46:47] offset:16000
  v_cvt_pk_bf16_f32 v48, v168, v169
  v_cvt_pk_bf16_f32 v49, v170, v171
  ds_write_b64 v11, v[48:49] offset:16128
  v_cvt_pk_bf16_f32 v50, v204, v205
  v_cvt_pk_bf16_f32 v51, v206, v207
  v_mfma_f32_16x16x32_bf16 v[212:215], v[72:75], v[104:107], v[212:215]
  ds_write_b64 v11, v[50:51] offset:16256
  v_pk_fma_f32 v[136:137], v[242:243], v[236:237], v[136:137] op_sel_hi:[1,0,1] neg_lo:[0,1,0] neg_hi:[0,1,0]
  v_pk_fma_f32 v[138:139], v[244:245], v[236:237], v[138:139] op_sel_hi:[1,0,1] neg_lo:[0,1,0] neg_hi:[0,1,0]
  v_pk_fma_f32 v[172:173], v[246:247], v[236:237], v[172:173] op_sel_hi:[1,0,1] neg_lo:[0,1,0] neg_hi:[0,1,0]
  v_pk_fma_f32 v[174:175], v[248:249], v[236:237], v[174:175] op_sel_hi:[1,0,1] neg_lo:[0,1,0] neg_hi:[0,1,0]
  v_pk_fma_f32 v[208:209], v[250:251], v[236:237], v[208:209] op_sel_hi:[1,0,1] neg_lo:[0,1,0] neg_hi:[0,1,0]
  v_pk_fma_f32 v[210:211], v[252:253], v[236:237], v[210:211] op_sel_hi:[1,0,1] neg_lo:[0,1,0] neg_hi:[0,1,0]
  v_mfma_f32_16x16x32_bf16 v[176:179], v[68:71], v[104:107], v[176:179]
  v_pk_mul_f32 v[136:137], v[136:137], v[236:237] op_sel:[0,1] op_sel_hi:[1,1]
  v_pk_mul_f32 v[138:139], v[138:139], v[236:237] op_sel:[0,1] op_sel_hi:[1,1]
  v_pk_mul_f32 v[172:173], v[172:173], v[236:237] op_sel:[0,1] op_sel_hi:[1,1]
  v_pk_mul_f32 v[174:175], v[174:175], v[236:237] op_sel:[0,1] op_sel_hi:[1,1]
  v_pk_mul_f32 v[208:209], v[208:209], v[236:237] op_sel:[0,1] op_sel_hi:[1,1]
  v_pk_mul_f32 v[210:211], v[210:211], v[236:237] op_sel:[0,1] op_sel_hi:[1,1]
  v_cvt_pk_bf16_f32 v52, v136, v137
  v_mfma_f32_16x16x32_bf16 v[140:143], v[64:67], v[104:107], v[140:143]
  v_cvt_pk_bf16_f32 v53, v138, v139
  ds_write_b64 v11, v[52:53] offset:19200
  v_cvt_pk_bf16_f32 v54, v172, v173
  v_cvt_pk_bf16_f32 v55, v174, v175
  ds_write_b64 v11, v[54:55] offset:19328
  v_cvt_pk_bf16_f32 v56, v208, v209
  v_cvt_pk_bf16_f32 v57, v210, v211
  v_mfma_f32_16x16x32_bf16 v[144:147], v[64:67], v[108:111], v[144:147]
  ds_write_b64 v11, v[56:57] offset:19456
  v_pk_fma_f32 v[140:141], v[242:243], v[238:239], v[140:141] op_sel_hi:[1,0,1] neg_lo:[0,1,0] neg_hi:[0,1,0]
  v_pk_fma_f32 v[142:143], v[244:245], v[238:239], v[142:143] op_sel_hi:[1,0,1] neg_lo:[0,1,0] neg_hi:[0,1,0]
  v_pk_fma_f32 v[176:177], v[246:247], v[238:239], v[176:177] op_sel_hi:[1,0,1] neg_lo:[0,1,0] neg_hi:[0,1,0]
  v_pk_fma_f32 v[178:179], v[248:249], v[238:239], v[178:179] op_sel_hi:[1,0,1] neg_lo:[0,1,0] neg_hi:[0,1,0]
  v_pk_fma_f32 v[212:213], v[250:251], v[238:239], v[212:213] op_sel_hi:[1,0,1] neg_lo:[0,1,0] neg_hi:[0,1,0]
  v_pk_fma_f32 v[214:215], v[252:253], v[238:239], v[214:215] op_sel_hi:[1,0,1] neg_lo:[0,1,0] neg_hi:[0,1,0]
  v_mfma_f32_16x16x32_bf16 v[180:183], v[68:71], v[108:111], v[180:183]
  v_pk_mul_f32 v[140:141], v[140:141], v[238:239] op_sel:[0,1] op_sel_hi:[1,1]
  v_pk_mul_f32 v[142:143], v[142:143], v[238:239] op_sel:[0,1] op_sel_hi:[1,1]
  v_pk_mul_f32 v[176:177], v[176:177], v[238:239] op_sel:[0,1] op_sel_hi:[1,1]
  v_pk_mul_f32 v[178:179], v[178:179], v[238:239] op_sel:[0,1] op_sel_hi:[1,1]
  v_pk_mul_f32 v[212:213], v[212:213], v[238:239] op_sel:[0,1] op_sel_hi:[1,1]
  v_pk_mul_f32 v[214:215], v[214:215], v[238:239] op_sel:[0,1] op_sel_hi:[1,1]
  v_cvt_pk_bf16_f32 v58, v140, v141
  v_mfma_f32_16x16x32_bf16 v[216:219], v[72:75], v[108:111], v[216:219]
  v_cvt_pk_bf16_f32 v59, v142, v143
  ds_write_b64 v11, v[58:59] offset:22400
  v_cvt_pk_bf16_f32 v60, v176, v177
  v_cvt_pk_bf16_f32 v61, v178, v179
  ds_write_b64 v11, v[60:61] offset:22528
  v_cvt_pk_bf16_f32 v62, v212, v213
  v_cvt_pk_bf16_f32 v63, v214, v215
  s_barrier
  ds_write_b64 v11, v[62:63] offset:22656
  v_pk_fma_f32 v[144:145], v[242:243], v[240:241], v[144:145] op_sel_hi:[1,0,1] neg_lo:[0,1,0] neg_hi:[0,1,0]
  v_pk_fma_f32 v[146:147], v[244:245], v[240:241], v[146:147] op_sel_hi:[1,0,1] neg_lo:[0,1,0] neg_hi:[0,1,0]
  v_pk_fma_f32 v[180:181], v[246:247], v[240:241], v[180:181] op_sel_hi:[1,0,1] neg_lo:[0,1,0] neg_hi:[0,1,0]
  v_pk_fma_f32 v[182:183], v[248:249], v[240:241], v[182:183] op_sel_hi:[1,0,1] neg_lo:[0,1,0] neg_hi:[0,1,0]
  v_pk_fma_f32 v[216:217], v[250:251], v[240:241], v[216:217] op_sel_hi:[1,0,1] neg_lo:[0,1,0] neg_hi:[0,1,0]
  v_pk_fma_f32 v[218:219], v[252:253], v[240:241], v[218:219] op_sel_hi:[1,0,1] neg_lo:[0,1,0] neg_hi:[0,1,0]
  v_pk_mul_f32 v[144:145], v[144:145], v[240:241] op_sel:[0,1] op_sel_hi:[1,1]
  v_pk_mul_f32 v[146:147], v[146:147], v[240:241] op_sel:[0,1] op_sel_hi:[1,1]
  v_pk_mul_f32 v[180:181], v[180:181], v[240:241] op_sel:[0,1] op_sel_hi:[1,1]
  v_pk_mul_f32 v[182:183], v[182:183], v[240:241] op_sel:[0,1] op_sel_hi:[1,1]
  v_pk_mul_f32 v[216:217], v[216:217], v[240:241] op_sel:[0,1] op_sel_hi:[1,1]
  v_pk_mul_f32 v[218:219], v[218:219], v[240:241] op_sel:[0,1] op_sel_hi:[1,1]
  v_cvt_pk_bf16_f32 v16, v144, v145
  v_cvt_pk_bf16_f32 v17, v146, v147
  ds_write_b64 v11, v[16:17] offset:25600
  v_cvt_pk_bf16_f32 v18, v180, v181
  v_cvt_pk_bf16_f32 v19, v182, v183
  ds_write_b64 v11, v[18:19] offset:25728
  v_cvt_pk_bf16_f32 v20, v216, v217
  v_cvt_pk_bf16_f32 v21, v218, v219
  ds_write_b64 v11, v[20:21] offset:25856
attn:
  s_nop 7
  s_nop 7
  v_mov_b32 v18, 0x3e8293ee
  v_mov_b32 v19, 0xff800000
  s_mov_b32 s20, s82
  s_mov_b32 s21, s83
  s_mov_b32 s22, 8388608
  s_mov_b32 s23, 0x20000
  s_mov_b32 s49, 4096
  s_waitcnt lgkmcnt(0)
  s_barrier
  ds_read_b128 v[32:35], v223 offset:0
  ds_read_b128 v[36:39], v220 offset:0
  ds_read_b128 v[40:43], v221 offset:0
  ds_read_b128 v[80:83], v223 offset:64
  ds_read_b128 v[84:87], v220 offset:64
  ds_read_b128 v[88:91], v221 offset:64
  ds_read_b64_tr_b16 v[44:45], v222 offset:0
  ds_read_b64_tr_b16 v[46:47], v254 offset:0
  ds_read_b64_tr_b16 v[48:49], v222 offset:8
  ds_read_b64_tr_b16 v[50:51], v254 offset:8
  ds_read_b64_tr_b16 v[92:93], v222 offset:64
  ds_read_b64_tr_b16 v[94:95], v254 offset:64
  ds_read_b64_tr_b16 v[96:97], v222 offset:72
  ds_read_b64_tr_b16 v[98:99], v254 offset:72
  s_waitcnt lgkmcnt(11)
  v_mfma_f32_16x16x32_bf16 v[52:55], v[36:39], v[32:35], 0
  v_mfma_f32_16x16x32_bf16 v[56:59], v[40:43], v[32:35], 0
  s_waitcnt lgkmcnt(8)
  v_mfma_f32_16x16x32_bf16 v[100:103], v[84:87], v[80:83], 0
  v_mfma_f32_16x16x32_bf16 v[104:107], v[88:91], v[80:83], 0
  s_nop 3
  v_cndmask_b32 v52, v19, v52, s[86:87]
  s_nop 1
  v_cndmask_b32 v100, v19, v100, s[86:87]
  v_cndmask_b32 v53, v19, v53, s[88:89]
  v_cndmask_b32 v101, v19, v101, s[88:89]
  v_cndmask_b32 v54, v19, v54, s[90:91]
  v_cndmask_b32 v102, v19, v102, s[90:91]
  v_cndmask_b32 v55, v19, v55, s[92:93]
  v_cndmask_b32 v103, v19, v103, s[92:93]
  v_cndmask_b32 v56, v19, v56, s[94:95]
  v_cndmask_b32 v104, v19, v104, s[94:95]
  v_cndmask_b32 v57, v19, v57, s[96:97]
  v_cndmask_b32 v105, v19, v105, s[96:97]
  v_cndmask_b32 v58, v19, v58, s[98:99]
  v_cndmask_b32 v106, v19, v106, s[98:99]
  v_cndmask_b32 v59, v19, v59, s[100:101]
  v_cndmask_b32 v107, v19, v107, s[100:101]
  v_max3_f32 v60, v52, v53, v54
  v_max3_f32 v108, v100, v101, v102
  v_max3_f32 v61, v55, v56, v57
  v_max3_f32 v109, v103, v104, v105
  v_max3_f32 v60, v60, v58, v59
  v_max3_f32 v108, v108, v106, v107
  v_max_f32 v60, v60, v61
  v_max_f32 v108, v108, v109
  v_mov_b32 v61, v60
  v_mov_b32 v109, v108
  s_nop 0
  v_permlane16_swap_b32 v60, v61
  v_permlane16_swap_b32 v108, v109
  v_max_f32 v60, v60, v61
  v_max_f32 v108, v108, v109
  v_mov_b32 v61, v60
  v_mov_b32 v109, v108
  s_nop 0
  v_permlane32_swap_b32 v60, v61
  v_permlane32_swap_b32 v108, v109
  v_max_f32 v60, v60, v61
  v_max_f32 v108, v108, v109
  v_mul_f32 v60, v18, v60
  v_mul_f32 v108, v18, v108
  v_fma_f32 v52, v52, v18, -v60
  v_fma_f32 v100, v100, v18, -v108
  v_fma_f32 v53, v53, v18, -v60
  v_fma_f32 v101, v101, v18, -v108
  v_fma_f32 v54, v54, v18, -v60
  v_fma_f32 v102, v102, v18, -v108
  v_fma_f32 v55, v55, v18, -v60
  v_fma_f32 v103, v103, v18, -v108
  v_fma_f32 v56, v56, v18, -v60
  v_fma_f32 v104, v104, v18, -v108
  v_fma_f32 v57, v57, v18, -v60
  v_fma_f32 v105, v105, v18, -v108
  v_fma_f32 v58, v58, v18, -v60
  v_fma_f32 v106, v106, v18, -v108
  v_fma_f32 v59, v59, v18, -v60
  v_fma_f32 v107, v107, v18, -v108
  v_exp_f32 v52, v52
  v_exp_f32 v100, v100
  v_exp_f32 v53, v53
  v_exp_f32 v101, v101
  v_exp_f32 v54, v54
  v_exp_f32 v102, v102
  v_exp_f32 v55, v55
  v_exp_f32 v103, v103
  v_exp_f32 v56, v56
  v_exp_f32 v104, v104
  v_exp_f32 v57, v57
  v_exp_f32 v105, v105
  v_exp_f32 v58, v58
  v_exp_f32 v106, v106
  v_exp_f32 v59, v59
  v_exp_f32 v107, v107
  v_pk_add_f32 v[60:61], v[52:53], v[54:55]
  v_pk_add_f32 v[108:109], v[100:101], v[102:103]
  v_pk_add_f32 v[62:63], v[56:57], v[58:59]
  v_pk_add_f32 v[110:111], v[104:105], v[106:107]
  v_pk_add_f32 v[60:61], v[60:61], v[62:63]
  v_pk_add_f32 v[108:109], v[108:109], v[110:111]
  v_add_f32 v60, v60, v61
  v_add_f32 v108, v108, v109
  v_mov_b32 v61, v60
  v_mov_b32 v109, v108
  s_nop 0
  v_permlane16_swap_b32 v60, v61
  v_permlane16_swap_b32 v108, v109
  v_add_f32 v60, v60, v61
  v_add_f32 v108, v108, v109
  v_mov_b32 v61, v60
  v_mov_b32 v109, v108
  s_nop 0
  v_permlane32_swap_b32 v60, v61
  v_permlane32_swap_b32 v108, v109
  v_add_f32 v60, v60, v61
  v_add_f32 v108, v108, v109
  v_rcp_f32 v60, v60
  v_rcp_f32 v108, v108
  v_pk_mul_f32 v[52:53], v[52:53], v[60:61] op_sel_hi:[1,0]
  v_pk_mul_f32 v[100:101], v[100:101], v[108:109] op_sel_hi:[1,0]
  v_pk_mul_f32 v[54:55], v[54:55], v[60:61] op_sel_hi:[1,0]
  v_pk_mul_f32 v[102:103], v[102:103], v[108:109] op_sel_hi:[1,0]
  v_pk_mul_f32 v[56:57], v[56:57], v[60:61] op_sel_hi:[1,0]
  v_pk_mul_f32 v[104:105], v[104:105], v[108:109] op_sel_hi:[1,0]
  v_pk_mul_f32 v[58:59], v[58:59], v[60:61] op_sel_hi:[1,0]
  v_pk_mul_f32 v[106:107], v[106:107], v[108:109] op_sel_hi:[1,0]
  v_cvt_pk_bf16_f32 v64, v52, v53
  v_cvt_pk_bf16_f32 v112, v100, v101
  v_cvt_pk_bf16_f32 v65, v54, v55
  v_cvt_pk_bf16_f32 v113, v102, v103
  v_cvt_pk_bf16_f32 v66, v56, v57
  v_cvt_pk_bf16_f32 v114, v104, v105
  v_cvt_pk_bf16_f32 v67, v58, v59
  v_cvt_pk_bf16_f32 v115, v106, v107
  s_waitcnt lgkmcnt(0)
  v_mfma_f32_16x16x32_bf16 v[68:71], v[44:47], v[64:67], 0
  v_mfma_f32_16x16x32_bf16 v[116:119], v[92:95], v[112:115], 0
  v_mfma_f32_16x16x32_bf16 v[72:75], v[48:51], v[64:67], 0
  v_mfma_f32_16x16x32_bf16 v[120:123], v[96:99], v[112:115], 0
  s_nop 4
  v_cvt_pk_bf16_f32 v32, v68, v69
  v_cvt_pk_bf16_f32 v80, v116, v117
  v_cvt_pk_bf16_f32 v33, v70, v71
  v_cvt_pk_bf16_f32 v81, v118, v119
  v_cvt_pk_bf16_f32 v34, v72, v73
  v_cvt_pk_bf16_f32 v82, v120, v121
  v_cvt_pk_bf16_f32 v35, v74, v75
  v_cvt_pk_bf16_f32 v83, v122, v123
  buffer_store_dwordx4 v[32:35], v1, s[20:23], 0 offen sc0 sc1
  buffer_store_dwordx4 v[80:83], v1, s[20:23], s49 offen sc0 sc1
  s_cmp_ge_u32 s4, 4
  s_cbranch_scc1 L_k1done
  s_lshl_b32 s32, s28, 2
  s_add_u32 s32, s32, s4
  s_lshl_b32 s34, s32, 17
  s_lshl_b32 s40, s32, 5
  s_lshl_b32 s52, s32, 8
  v_lshlrev_b32 v13, 1, v4
  v_add_u32 v13, s40, v13
  v_lshlrev_b32 v12, 11, v13
  v_lshl_add_u32 v12, v3, 4, v12
  s_lshl_b32 s32, s29, 7
  v_add_u32 v12, s32, v12
  v_lshlrev_b32 v14, 4, v0
  v_lshlrev_b32 v87, 8, v13
  v_lshl_add_u32 v87, v3, 4, v87
  s_lshl_b32 s32, s29, 19
  v_add_u32 v87, s32, v87
  s_mov_b32 s8, s82
  s_mov_b32 s9, s83
  s_mov_b32 s10, 8388608
  s_mov_b32 s11, 0x20000
  s_cmp_eq_u32 s3, 0
  s_cselect_b32 s16, s64, s84
  s_cselect_b32 s17, s65, s85
  s_cselect_b32 s18, 0, 100663296
  s_add_u32 s16, s16, s18
  s_addc_u32 s17, s17, 0
  s_mov_b32 s18, 4194304
  s_mov_b32 s19, 0x20000
  s_lshl_b32 s18, s18, s3
  s_cmp_eq_u32 s3, 0
  s_cselect_b32 s12, s84, s84
  s_cselect_b32 s13, s85, s85
  s_cselect_b32 s14, 0, 50331648
  s_add_u32 s12, s12, s14
  s_addc_u32 s13, s13, 0
  s_mov_b32 s14, 0
  s_mov_b32 s15, 0x20000
  s_add_u32 s12, s12, 41943040
  s_addc_u32 s13, s13, 0
  s_mov_b32 s14, 524288
  v_lshl_add_u32 v16, v5, 3, v6
  v_lshlrev_b32 v16, 7, v16
  v_lshl_add_u32 v16, v7, 3, v16
  v_lshrrev_b32 v17, 1, v6
  v_lshl_or_b32 v17, v2, 1, v17
  v_lshl_add_u32 v16, v17, 5, v16
  v_add_u32 v16, 131072, v16
  v_xor_b32 v8, 0, v16
  v_xor_b32 v9, 32, v16
  v_xor_b32 v10, 64, v16
  v_xor_b32 v11, 96, v16
  v_lshl_add_u32 v16, v4, 1, v2
  v_lshlrev_b32 v16, 3, v16
  v_add_u32 v16, s52, v16
  s_mul_i32 s32, s29, 16384
  v_add_u32 v112, s32, v16
  v_lshrrev_b32 v17, 5, v0
  v_mul_u32_u24 v17, 131072, v17
  v_add_u32 v113, v16, v17
  s_lshl_b32 s32, s4, 12
  v_lshlrev_b32 v16, 8, v4
  v_lshl_add_u32 v16, v5, 3, v16
  v_add_u32 v16, s32, v16
  v_and_b32 v17, 1, v4
  v_bfe_u32 v18, v4, 2, 1
  v_lshl_or_b32 v17, v18, 1, v17
  v_lshl_add_u32 v114, v17, 5, v16
  s_lshl_b32 s44, s29, 8
  s_lshl_b32 s40, s28, 2
  s_add_u32 s44, s44, s40
  s_add_u32 s44, s44, s4
  s_lshl_b32 s44, s44, 11
  v_lshl_add_u32 v16, v5, 3, v6
  v_lshlrev_b32 v16, 7, v16
  v_lshl_add_u32 v16, v7, 3, v16
  v_lshrrev_b32 v17, 1, v6
  v_lshl_or_b32 v17, v2, 1, v17
  v_lshl_add_u32 v16, v17, 5, v16
  v_xor_b32 v115, 0, v16
  v_add_u32 v115, s32, v115
  s_add_u32 s45, s44, 131072
  s_add_u32 s46, s44, 262144
  s_add_u32 s47, s44, 393216
  v_add_u32 v80, 16384, v113
  v_add_u32 v81, 32768, v113
  v_add_u32 v82, 49152, v113
  v_add_u32 v83, 65536, v113
  v_add_u32 v84, 81920, v113
  v_add_u32 v85, 98304, v113
  v_add_u32 v86, 114688, v113
  s_lshl_b32 s48, 0x303, s7
  s_lshr_b32 s48, s48, 8
  s_mov_b32 s49, s34
  s_add_u32 s50, s34, 65536
  s_add_u32 s41, s34, 131072
  s_and_b32 s40, s4, 1
  s_lshl_b32 s32, s40, 1
  s_add_u32 s32, s32, 0
  s_cmp_eq_u32 s32, 3
  s_addc_u32 s32, s32, 5
  s_lshl_b32 s32, s32, 7
  s_mov_b32 vcc_lo, 0xff000000
  s_mov_b32 vcc_hi, 0
  v_mov_b32 v88, s32
  v_cndmask_b32 v88, 0, v88, vcc
  v_lshl_add_u32 v88, v0, 4, v88
  v_add_u32 v90, 4096, v88
  s_lshl_b32 s32, s40, 1
  s_add_u32 s32, s32, 1
  s_cmp_eq_u32 s32, 3
  s_addc_u32 s32, s32, 5
  s_lshl_b32 s32, s32, 7
  s_mov_b32 vcc_lo, 0xff000000
  s_mov_b32 vcc_hi, 0
  v_mov_b32 v89, s32
  v_cndmask_b32 v89, 0, v89, vcc
  v_lshl_add_u32 v89, v0, 4, v89
  v_add_u32 v89, 2048, v89
  v_add_u32 v91, 4096, v89
  s_lshl_b32 s32, s40, 1
  s_add_u32 s32, s32, 0
  s_cmp_eq_u32 s32, 3
  s_addc_u32 s32, s32, 5
  s_lshl_b32 s32, s32, 7
  s_mov_b32 vcc_lo, 0xff000000
  s_mov_b32 vcc_hi, 0
  v_mov_b32 v92, s32
  v_cndmask_b32 v92, 0, v92, vcc
  v_lshl_add_u32 v92, v0, 4, v92
  s_lshl_b32 s32, s40, 1
  s_add_u32 s32, s32, 1
  s_cmp_eq_u32 s32, 3
  s_addc_u32 s32, s32, 5
  s_lshl_b32 s32, s32, 7
  s_mov_b32 vcc_lo, 0xff000000
  s_mov_b32 vcc_hi, 0
  v_mov_b32 v93, s32
  v_cndmask_b32 v93, 0, v93, vcc
  v_lshl_add_u32 v93, v0, 4, v93
  s_lshl_b32 s32, 0, 1
  s_add_u32 s32, s32, 0
  s_cmp_eq_u32 s32, 3
  s_addc_u32 s32, s32, 5
  s_lshl_b32 s32, s32, 7
  s_mov_b32 vcc_lo, 0xff000000
  s_mov_b32 vcc_hi, 0
  v_mov_b32 v192, s32
  v_cndmask_b32 v192, 0, v192, vcc
  v_lshl_add_u32 v192, v0, 4, v192
  s_lshl_b32 s32, 0, 1
  s_add_u32 s32, s32, 1
  s_cmp_eq_u32 s32, 3
  s_addc_u32 s32, s32, 5
  s_lshl_b32 s32, s32, 7
  s_mov_b32 vcc_lo, 0xff000000
  s_mov_b32 vcc_hi, 0
  v_mov_b32 v193, s32
  v_cndmask_b32 v193, 0, v193, vcc
  v_lshl_add_u32 v193, v0, 4, v193
  v_add_u32 v193, 2048, v193
  s_lshl_b32 s32, 1, 1
  s_add_u32 s32, s32, 0
  s_cmp_eq_u32 s32, 3
  s_addc_u32 s32, s32, 5
  s_lshl_b32 s32, s32, 7
  s_mov_b32 vcc_lo, 0xff000000
  s_mov_b32 vcc_hi, 0
  v_mov_b32 v194, s32
  v_cndmask_b32 v194, 0, v194, vcc
  v_lshl_add_u32 v194, v0, 4, v194
  v_add_u32 v194, 4096, v194
  s_lshl_b32 s32, 1, 1
  s_add_u32 s32, s32, 1
  s_cmp_eq_u32 s32, 3
  s_addc_u32 s32, s32, 5
  s_lshl_b32 s32, s32, 7
  s_mov_b32 vcc_lo, 0xff000000
  s_mov_b32 vcc_hi, 0
  v_mov_b32 v195, s32
  v_cndmask_b32 v195, 0, v195, vcc
  v_lshl_add_u32 v195, v0, 4, v195
  v_add_u32 v195, 6144, v195
  s_lshl_b32 s53, s29, 13
  s_add_u32 s53, s53, s34
  s_add_u32 s24, s84, 109051904
  s_addc_u32 s25, s85, 0
  s_mov_b32 s26, 524288
  s_mov_b32 s27, 0x20000
  v_min_u32 v119, 15, v0
  s_lshl_b32 s32, s28, 4
  v_add_u32 v119, s32, v119
  v_max_i32 v119, 0, v119
  v_lshlrev_b32 v119, 7, v119
  s_lshl_b32 s55, s3, 17
  s_add_u32 s55, s55, 0
  s_waitcnt vmcnt(0)
  s_barrier
  s_cmp_lg_u32 s3, 0
  s_cbranch_scc1 C_r1
  buffer_load_dwordx4 v[96:99], v12, s[16:19], 0 offen offset:0
  buffer_load_dwordx4 v[100:103], v12, s[16:19], 0 offen offset:64
  buffer_load_dwordx4 v[104:107], v12, s[16:19], 0 offen offset:2048
  buffer_load_dwordx4 v[108:111], v12, s[16:19], 0 offen offset:2112
  s_branch C_r2
C_r1:
  buffer_load_dwordx4 v[96:99], v87, s[16:19], 0 offen offset:0 sc1
  buffer_load_dwordx4 v[100:103], v87, s[16:19], 0 offen offset:64 sc1
  buffer_load_dwordx4 v[104:107], v87, s[16:19], 0 offen offset:256 sc1
  buffer_load_dwordx4 v[108:111], v87, s[16:19], 0 offen offset:320 sc1
C_r2:
  s_mov_b32 s39, 0
  s_and_b32 s32, s4, 3
  s_cmp_lg_u32 s32, 0
  s_cbranch_scc1 poll3d
  s_sleep 8
poll3:
  buffer_load_dword v16, v119, s[24:27], s55 offen sc0 sc1
  s_waitcnt vmcnt(0)
  v_cmp_eq_u32 vcc, 0, v16
  s_add_u32 s39, s39, 1
  s_cmp_gt_u32 s39, 1000000
  s_cbranch_scc1 poll3d
  s_cbranch_vccnz poll3
poll3d:
  s_barrier
  s_bitcmp1_b32 s48, 0
  s_cselect_b32 s36, s50, s49
  s_add_u32 s36, s36, 0
  buffer_load_dwordx4 v[120:123], v88, s[8:11], s36 offen sc1
  buffer_load_dwordx4 v[124:127], v89, s[8:11], s36 offen sc1
  buffer_load_dwordx4 v[128:131], v90, s[8:11], s36 offen sc1
  buffer_load_dwordx4 v[132:135], v91, s[8:11], s36 offen sc1
  s_bitcmp1_b32 s48, 1
  s_cselect_b32 s36, s50, s49
  s_add_u32 s36, s36, 8192
  buffer_load_dwordx4 v[136:139], v88, s[8:11], s36 offen sc1
  buffer_load_dwordx4 v[140:143], v89, s[8:11], s36 offen sc1
  buffer_load_dwordx4 v[144:147], v90, s[8:11], s36 offen sc1
  buffer_load_dwordx4 v[148:151], v91, s[8:11], s36 offen sc1
  s_bitcmp1_b32 s48, 2
  s_cselect_b32 s36, s50, s49
  s_add_u32 s36, s36, 16384
  buffer_load_dwordx4 v[152:155], v88, s[8:11], s36 offen sc1
  buffer_load_dwordx4 v[156:159], v89, s[8:11], s36 offen sc1
  buffer_load_dwordx4 v[160:163], v90, s[8:11], s36 offen sc1
  buffer_load_dwordx4 v[164:167], v91, s[8:11], s36 offen sc1
  s_bitcmp1_b32 s48, 3
  s_cselect_b32 s36, s50, s49
  s_add_u32 s36, s36, 24576
  buffer_load_dwordx4 v[168:171], v88, s[8:11], s36 offen sc1
  buffer_load_dwordx4 v[172:175], v89, s[8:11], s36 offen sc1
  s_waitcnt vmcnt(14)
  v_permlane16_swap_b32 v96, v98
  v_permlane16_swap_b32 v97, v99
  v_permlane16_swap_b32 v100, v102
  v_permlane16_swap_b32 v101, v103
  v_permlane16_swap_b32 v104, v106
  v_permlane16_swap_b32 v105, v107
  v_permlane16_swap_b32 v108, v110
  v_permlane16_swap_b32 v109, v111
  v_lshlrev_b32 v48, 16, v96
  v_and_b32 v49, 0xffff0000, v96
  v_lshlrev_b32 v50, 16, v97
  v_and_b32 v51, 0xffff0000, v97
  v_lshlrev_b32 v52, 16, v98
  v_and_b32 v53, 0xffff0000, v98
  v_lshlrev_b32 v54, 16, v99
  v_and_b32 v55, 0xffff0000, v99
  v_lshlrev_b32 v56, 16, v100
  v_and_b32 v57, 0xffff0000, v100
  v_lshlrev_b32 v58, 16, v101
  v_and_b32 v59, 0xffff0000, v101
  v_lshlrev_b32 v60, 16, v102
  v_and_b32 v61, 0xffff0000, v102
  v_lshlrev_b32 v62, 16, v103
  v_and_b32 v63, 0xffff0000, v103
  v_lshlrev_b32 v64, 16, v104
  v_and_b32 v65, 0xffff0000, v104
  v_lshlrev_b32 v66, 16, v105
  v_and_b32 v67, 0xffff0000, v105
  v_lshlrev_b32 v68, 16, v106
  v_and_b32 v69, 0xffff0000, v106
  v_lshlrev_b32 v70, 16, v107
  v_and_b32 v71, 0xffff0000, v107
  v_lshlrev_b32 v72, 16, v108
  v_and_b32 v73, 0xffff0000, v108
  v_lshlrev_b32 v74, 16, v109
  v_and_b32 v75, 0xffff0000, v109
  v_lshlrev_b32 v76, 16, v110
  v_and_b32 v77, 0xffff0000, v110
  v_lshlrev_b32 v78, 16, v111
  v_and_b32 v79, 0xffff0000, v111
  s_mov_b32 s43, 0
  s_mov_b32 s39, 1
  s_barrier
  ds_read_b64_tr_b16 v[16:17], v8 offset:0
  ds_read_b64_tr_b16 v[18:19], v8 offset:512
  ds_read_b64_tr_b16 v[20:21], v9 offset:0
  ds_read_b64_tr_b16 v[22:23], v9 offset:512
  ds_read_b64_tr_b16 v[24:25], v10 offset:0
  ds_read_b64_tr_b16 v[26:27], v10 offset:512
  ds_read_b64_tr_b16 v[28:29], v11 offset:0
  ds_read_b64_tr_b16 v[30:31], v11 offset:512
  s_waitcnt vmcnt(13) lgkmcnt(6)
  v_mfma_f32_16x16x32_bf16 v[48:51], v[16:19], v[120:123], v[48:51]
  ds_read_b64_tr_b16 v[32:33], v8 offset:4096
  s_waitcnt vmcnt(12)
  v_mfma_f32_16x16x32_bf16 v[64:67], v[16:19], v[124:127], v[64:67]
  ds_read_b64_tr_b16 v[34:35], v8 offset:4608
  v_add_u32 v8, 8192, v8
  s_waitcnt lgkmcnt(6)
  v_mfma_f32_16x16x32_bf16 v[68:71], v[20:23], v[124:127], v[68:71]
  ds_read_b64_tr_b16 v[36:37], v9 offset:4096
  buffer_load_dwordx4 v[176:179], v90, s[8:11], s36 offen sc1
  v_mfma_f32_16x16x32_bf16 v[52:55], v[20:23], v[120:123], v[52:55]
  ds_read_b64_tr_b16 v[38:39], v9 offset:4608
  v_add_u32 v9, 8192, v9
  s_waitcnt lgkmcnt(6)
  v_mfma_f32_16x16x32_bf16 v[56:59], v[24:27], v[120:123], v[56:59]
  ds_read_b64_tr_b16 v[40:41], v10 offset:4096
  v_mfma_f32_16x16x32_bf16 v[72:75], v[24:27], v[124:127], v[72:75]
  ds_read_b64_tr_b16 v[42:43], v10 offset:4608
  v_add_u32 v10, 8192, v10
  s_waitcnt lgkmcnt(6)
  v_mfma_f32_16x16x32_bf16 v[76:79], v[28:31], v[124:127], v[76:79]
  ds_read_b64_tr_b16 v[44:45], v11 offset:4096
  buffer_load_dwordx4 v[180:183], v91, s[8:11], s36 offen sc1
  v_mfma_f32_16x16x32_bf16 v[60:63], v[28:31], v[120:123], v[60:63]
  ds_read_b64_tr_b16 v[46:47], v11 offset:4608
  v_add_u32 v11, 8192, v11
  s_waitcnt vmcnt(13) lgkmcnt(6)
  v_mfma_f32_16x16x32_bf16 v[48:51], v[32:35], v[128:131], v[48:51]
  ds_read_b64_tr_b16 v[16:17], v8 offset:0
  s_bitcmp1_b32 s48, 4
  s_cselect_b32 s36, s50, s49
  s_waitcnt vmcnt(12)
  v_mfma_f32_16x16x32_bf16 v[64:67], v[32:35], v[132:135], v[64:67]
  ds_read_b64_tr_b16 v[18:19], v8 offset:512
  s_add_u32 s36, s36, 32768
  s_waitcnt lgkmcnt(6)
  v_mfma_f32_16x16x32_bf16 v[68:71], v[36:39], v[132:135], v[68:71]
  ds_read_b64_tr_b16 v[20:21], v9 offset:0
  v_mfma_f32_16x16x32_bf16 v[52:55], v[36:39], v[128:131], v[52:55]
  ds_read_b64_tr_b16 v[22:23], v9 offset:512
  s_waitcnt lgkmcnt(6)
  v_mfma_f32_16x16x32_bf16 v[56:59], v[40:43], v[128:131], v[56:59]
  ds_read_b64_tr_b16 v[24:25], v10 offset:0
  buffer_load_dwordx4 v[120:123], v88, s[8:11], s36 offen sc1
  v_mfma_f32_16x16x32_bf16 v[72:75], v[40:43], v[132:135], v[72:75]
  ds_read_b64_tr_b16 v[26:27], v10 offset:512
  s_waitcnt lgkmcnt(6)
  v_mfma_f32_16x16x32_bf16 v[76:79], v[44:47], v[132:135], v[76:79]
  ds_read_b64_tr_b16 v[28:29], v11 offset:0
  v_mfma_f32_16x16x32_bf16 v[60:63], v[44:47], v[128:131], v[60:63]
  ds_read_b64_tr_b16 v[30:31], v11 offset:512
  buffer_load_dwordx4 v[124:127], v89, s[8:11], s36 offen sc1
  s_waitcnt vmcnt(13) lgkmcnt(6)
  v_mfma_f32_16x16x32_bf16 v[48:51], v[16:19], v[136:139], v[48:51]
  ds_read_b64_tr_b16 v[32:33], v8 offset:4096
  s_waitcnt vmcnt(12)
  v_mfma_f32_16x16x32_bf16 v[64:67], v[16:19], v[140:143], v[64:67]
  ds_read_b64_tr_b16 v[34:35], v8 offset:4608
  v_add_u32 v8, 8192, v8
  s_waitcnt lgkmcnt(6)
  v_mfma_f32_16x16x32_bf16 v[68:71], v[20:23], v[140:143], v[68:71]
  ds_read_b64_tr_b16 v[36:37], v9 offset:4096
  buffer_load_dwordx4 v[128:131], v90, s[8:11], s36 offen sc1
  v_mfma_f32_16x16x32_bf16 v[52:55], v[20:23], v[136:139], v[52:55]
  ds_read_b64_tr_b16 v[38:39], v9 offset:4608
  v_add_u32 v9, 8192, v9
  s_waitcnt lgkmcnt(6)
  v_mfma_f32_16x16x32_bf16 v[56:59], v[24:27], v[136:139], v[56:59]
  ds_read_b64_tr_b16 v[40:41], v10 offset:4096
  v_mfma_f32_16x16x32_bf16 v[72:75], v[24:27], v[140:143], v[72:75]
  ds_read_b64_tr_b16 v[42:43], v10 offset:4608
  v_add_u32 v10, 8192, v10
  s_waitcnt lgkmcnt(6)
  v_mfma_f32_16x16x32_bf16 v[76:79], v[28:31], v[140:143], v[76:79]
  ds_read_b64_tr_b16 v[44:45], v11 offset:4096
  buffer_load_dwordx4 v[132:135], v91, s[8:11], s36 offen sc1
  v_mfma_f32_16x16x32_bf16 v[60:63], v[28:31], v[136:139], v[60:63]
  ds_read_b64_tr_b16 v[46:47], v11 offset:4608
  v_add_u32 v11, 8192, v11
  s_waitcnt vmcnt(13) lgkmcnt(6)
  v_mfma_f32_16x16x32_bf16 v[48:51], v[32:35], v[144:147], v[48:51]
  ds_read_b64_tr_b16 v[16:17], v8 offset:0
  s_bitcmp1_b32 s48, 5
  s_cselect_b32 s36, s50, s49
  s_waitcnt vmcnt(12)
  v_mfma_f32_16x16x32_bf16 v[64:67], v[32:35], v[148:151], v[64:67]
  ds_read_b64_tr_b16 v[18:19], v8 offset:512
  s_add_u32 s36, s36, 40960
  s_waitcnt lgkmcnt(6)
  v_mfma_f32_16x16x32_bf16 v[68:71], v[36:39], v[148:151], v[68:71]
  ds_read_b64_tr_b16 v[20:21], v9 offset:0
  v_mfma_f32_16x16x32_bf16 v[52:55], v[36:39], v[144:147], v[52:55]
  ds_read_b64_tr_b16 v[22:23], v9 offset:512
  s_waitcnt lgkmcnt(6)
  v_mfma_f32_16x16x32_bf16 v[56:59], v[40:43], v[144:147], v[56:59]
  ds_read_b64_tr_b16 v[24:25], v10 offset:0
  buffer_load_dwordx4 v[136:139], v88, s[8:11], s36 offen sc1
  v_mfma_f32_16x16x32_bf16 v[72:75], v[40:43], v[148:151], v[72:75]
  ds_read_b64_tr_b16 v[26:27], v10 offset:512
  s_waitcnt lgkmcnt(6)
  v_mfma_f32_16x16x32_bf16 v[76:79], v[44:47], v[148:151], v[76:79]
  ds_read_b64_tr_b16 v[28:29], v11 offset:0
  v_mfma_f32_16x16x32_bf16 v[60:63], v[44:47], v[144:147], v[60:63]
  ds_read_b64_tr_b16 v[30:31], v11 offset:512
  buffer_load_dwordx4 v[140:143], v89, s[8:11], s36 offen sc1
  s_waitcnt vmcnt(13) lgkmcnt(6)
  v_mfma_f32_16x16x32_bf16 v[48:51], v[16:19], v[152:155], v[48:51]
  ds_read_b64_tr_b16 v[32:33], v8 offset:4096
  s_waitcnt vmcnt(12)
  v_mfma_f32_16x16x32_bf16 v[64:67], v[16:19], v[156:159], v[64:67]
  ds_read_b64_tr_b16 v[34:35], v8 offset:4608
  v_add_u32 v8, 8192, v8
  s_waitcnt lgkmcnt(6)
  v_mfma_f32_16x16x32_bf16 v[68:71], v[20:23], v[156:159], v[68:71]
  ds_read_b64_tr_b16 v[36:37], v9 offset:4096
  buffer_load_dwordx4 v[144:147], v90, s[8:11], s36 offen sc1
  v_mfma_f32_16x16x32_bf16 v[52:55], v[20:23], v[152:155], v[52:55]
  ds_read_b64_tr_b16 v[38:39], v9 offset:4608
  v_add_u32 v9, 8192, v9
  s_waitcnt lgkmcnt(6)
  v_mfma_f32_16x16x32_bf16 v[56:59], v[24:27], v[152:155], v[56:59]
  ds_read_b64_tr_b16 v[40:41], v10 offset:4096
  v_mfma_f32_16x16x32_bf16 v[72:75], v[24:27], v[156:159], v[72:75]
  ds_read_b64_tr_b16 v[42:43], v10 offset:4608
  v_add_u32 v10, 8192, v10
  s_waitcnt lgkmcnt(6)
  v_mfma_f32_16x16x32_bf16 v[76:79], v[28:31], v[156:159], v[76:79]
  ds_read_b64_tr_b16 v[44:45], v11 offset:4096
  buffer_load_dwordx4 v[148:151], v91, s[8:11], s36 offen sc1
  v_mfma_f32_16x16x32_bf16 v[60:63], v[28:31], v[152:155], v[60:63]
  ds_read_b64_tr_b16 v[46:47], v11 offset:4608
  v_add_u32 v11, 8192, v11
  s_waitcnt vmcnt(13) lgkmcnt(6)
  v_mfma_f32_16x16x32_bf16 v[48:51], v[32:35], v[160:163], v[48:51]
  ds_read_b64_tr_b16 v[16:17], v8 offset:0
  s_bitcmp1_b32 s48, 6
  s_cselect_b32 s36, s50, s49
  s_waitcnt vmcnt(12)
  v_mfma_f32_16x16x32_bf16 v[64:67], v[32:35], v[164:167], v[64:67]
  ds_read_b64_tr_b16 v[18:19], v8 offset:512
  s_add_u32 s36, s36, 49152
  s_waitcnt lgkmcnt(6)
  v_mfma_f32_16x16x32_bf16 v[68:71], v[36:39], v[164:167], v[68:71]
  ds_read_b64_tr_b16 v[20:21], v9 offset:0
  v_mfma_f32_16x16x32_bf16 v[52:55], v[36:39], v[160:163], v[52:55]
  ds_read_b64_tr_b16 v[22:23], v9 offset:512
  s_waitcnt lgkmcnt(6)
  v_mfma_f32_16x16x32_bf16 v[56:59], v[40:43], v[160:163], v[56:59]
  ds_read_b64_tr_b16 v[24:25], v10 offset:0
  buffer_load_dwordx4 v[152:155], v88, s[8:11], s36 offen sc1
  v_mfma_f32_16x16x32_bf16 v[72:75], v[40:43], v[164:167], v[72:75]
  ds_read_b64_tr_b16 v[26:27], v10 offset:512
  s_waitcnt lgkmcnt(6)
  v_mfma_f32_16x16x32_bf16 v[76:79], v[44:47], v[164:167], v[76:79]
  ds_read_b64_tr_b16 v[28:29], v11 offset:0
  v_mfma_f32_16x16x32_bf16 v[60:63], v[44:47], v[160:163], v[60:63]
  ds_read_b64_tr_b16 v[30:31], v11 offset:512
  buffer_load_dwordx4 v[156:159], v89, s[8:11], s36 offen sc1
  s_waitcnt vmcnt(13) lgkmcnt(6)
  v_mfma_f32_16x16x32_bf16 v[48:51], v[16:19], v[168:171], v[48:51]
  ds_read_b64_tr_b16 v[32:33], v8 offset:4096
  s_waitcnt vmcnt(12)
  v_mfma_f32_16x16x32_bf16 v[64:67], v[16:19], v[172:175], v[64:67]
  ds_read_b64_tr_b16 v[34:35], v8 offset:4608
  v_add_u32 v8, 4294912256, v8
  s_waitcnt lgkmcnt(6)
  v_mfma_f32_16x16x32_bf16 v[68:71], v[20:23], v[172:175], v[68:71]
  ds_read_b64_tr_b16 v[36:37], v9 offset:4096
  buffer_load_dwordx4 v[160:163], v90, s[8:11], s36 offen sc1
  v_mfma_f32_16x16x32_bf16 v[52:55], v[20:23], v[168:171], v[52:55]
  ds_read_b64_tr_b16 v[38:39], v9 offset:4608
  v_add_u32 v9, 4294912256, v9
  s_waitcnt lgkmcnt(6)
  v_mfma_f32_16x16x32_bf16 v[56:59], v[24:27], v[168:171], v[56:59]
  ds_read_b64_tr_b16 v[40:41], v10 offset:4096
  v_mfma_f32_16x16x32_bf16 v[72:75], v[24:27], v[172:175], v[72:75]
  ds_read_b64_tr_b16 v[42:43], v10 offset:4608
  v_add_u32 v10, 4294912256, v10
  s_waitcnt lgkmcnt(6)
  v_mfma_f32_16x16x32_bf16 v[76:79], v[28:31], v[172:175], v[76:79]
  ds_read_b64_tr_b16 v[44:45], v11 offset:4096
  buffer_load_dwordx4 v[164:167], v91, s[8:11], s36 offen sc1
  v_mfma_f32_16x16x32_bf16 v[60:63], v[28:31], v[168:171], v[60:63]
  ds_read_b64_tr_b16 v[46:47], v11 offset:4608
  v_add_u32 v11, 4294912256, v11
  s_waitcnt vmcnt(13) lgkmcnt(6)
  v_mfma_f32_16x16x32_bf16 v[48:51], v[32:35], v[176:179], v[48:51]
  ds_read_b64_tr_b16 v[16:17], v8 offset:0
  s_bitcmp1_b32 s48, 7
  s_cselect_b32 s36, s50, s49
  s_waitcnt vmcnt(12)
  v_mfma_f32_16x16x32_bf16 v[64:67], v[32:35], v[180:183], v[64:67]
  ds_read_b64_tr_b16 v[18:19], v8 offset:512
  s_add_u32 s36, s36, 57344
  s_waitcnt lgkmcnt(6)
  v_mfma_f32_16x16x32_bf16 v[68:71], v[36:39], v[180:183], v[68:71]
  ds_read_b64_tr_b16 v[20:21], v9 offset:0
  v_mfma_f32_16x16x32_bf16 v[52:55], v[36:39], v[176:179], v[52:55]
  ds_read_b64_tr_b16 v[22:23], v9 offset:512
  s_waitcnt lgkmcnt(6)
  v_mfma_f32_16x16x32_bf16 v[56:59], v[40:43], v[176:179], v[56:59]
  ds_read_b64_tr_b16 v[24:25], v10 offset:0
  buffer_load_dwordx4 v[168:171], v88, s[8:11], s36 offen sc1
  v_mfma_f32_16x16x32_bf16 v[72:75], v[40:43], v[180:183], v[72:75]
  ds_read_b64_tr_b16 v[26:27], v10 offset:512
  s_waitcnt lgkmcnt(6)
  v_mfma_f32_16x16x32_bf16 v[76:79], v[44:47], v[180:183], v[76:79]
  ds_read_b64_tr_b16 v[28:29], v11 offset:0
  v_mfma_f32_16x16x32_bf16 v[60:63], v[44:47], v[176:179], v[60:63]
  ds_read_b64_tr_b16 v[30:31], v11 offset:512
  buffer_load_dwordx4 v[172:175], v89, s[8:11], s36 offen sc1
  s_waitcnt vmcnt(13) lgkmcnt(6)
  v_mfma_f32_16x16x32_bf16 v[48:51], v[16:19], v[120:123], v[48:51]
  ds_read_b64_tr_b16 v[32:33], v8 offset:4096
  s_waitcnt vmcnt(12)
  v_mfma_f32_16x16x32_bf16 v[64:67], v[16:19], v[124:127], v[64:67]
  ds_read_b64_tr_b16 v[34:35], v8 offset:4608
  v_add_u32 v8, 8192, v8
  s_waitcnt lgkmcnt(6)
  v_mfma_f32_16x16x32_bf16 v[68:71], v[20:23], v[124:127], v[68:71]
  ds_read_b64_tr_b16 v[36:37], v9 offset:4096
  buffer_load_dwordx4 v[176:179], v90, s[8:11], s36 offen sc1
  v_mfma_f32_16x16x32_bf16 v[52:55], v[20:23], v[120:123], v[52:55]
  ds_read_b64_tr_b16 v[38:39], v9 offset:4608
  v_add_u32 v9, 8192, v9
  s_waitcnt lgkmcnt(6)
  v_mfma_f32_16x16x32_bf16 v[56:59], v[24:27], v[120:123], v[56:59]
  ds_read_b64_tr_b16 v[40:41], v10 offset:4096
  v_mfma_f32_16x16x32_bf16 v[72:75], v[24:27], v[124:127], v[72:75]
  ds_read_b64_tr_b16 v[42:43], v10 offset:4608
  v_add_u32 v10, 8192, v10
  s_waitcnt lgkmcnt(6)
  v_mfma_f32_16x16x32_bf16 v[76:79], v[28:31], v[124:127], v[76:79]
  ds_read_b64_tr_b16 v[44:45], v11 offset:4096
  buffer_load_dwordx4 v[180:183], v91, s[8:11], s36 offen sc1
  v_mfma_f32_16x16x32_bf16 v[60:63], v[28:31], v[120:123], v[60:63]
  ds_read_b64_tr_b16 v[46:47], v11 offset:4608
  v_add_u32 v11, 8192, v11
  s_waitcnt vmcnt(13) lgkmcnt(6)
  v_mfma_f32_16x16x32_bf16 v[48:51], v[32:35], v[128:131], v[48:51]
  ds_read_b64_tr_b16 v[16:17], v8 offset:0
  s_mov_b32 s49, s50
  s_add_u32 s50, s50, 65536
  s_waitcnt vmcnt(12)
  v_mfma_f32_16x16x32_bf16 v[64:67], v[32:35], v[132:135], v[64:67]
  ds_read_b64_tr_b16 v[18:19], v8 offset:512
  s_cmp_eq_u32 s50, s41
  s_cselect_b32 s50, s34, s50
  s_waitcnt lgkmcnt(6)
  v_mfma_f32_16x16x32_bf16 v[68:71], v[36:39], v[132:135], v[68:71]
  ds_read_b64_tr_b16 v[20:21], v9 offset:0
  s_bitcmp1_b32 s48, 0
  s_cselect_b32 s36, s50, s49
  v_mfma_f32_16x16x32_bf16 v[52:55], v[36:39], v[128:131], v[52:55]
  ds_read_b64_tr_b16 v[22:23], v9 offset:512
  s_add_u32 s36, s36, 0
  s_waitcnt lgkmcnt(6)
  v_mfma_f32_16x16x32_bf16 v[56:59], v[40:43], v[128:131], v[56:59]
  ds_read_b64_tr_b16 v[24:25], v10 offset:0
  buffer_load_dwordx4 v[120:123], v88, s[8:11], s36 offen sc1
  v_mfma_f32_16x16x32_bf16 v[72:75], v[40:43], v[132:135], v[72:75]
  ds_read_b64_tr_b16 v[26:27], v10 offset:512
  s_waitcnt lgkmcnt(6)
  v_mfma_f32_16x16x32_bf16 v[76:79], v[44:47], v[132:135], v[76:79]
  ds_read_b64_tr_b16 v[28:29], v11 offset:0
  v_mfma_f32_16x16x32_bf16 v[60:63], v[44:47], v[128:131], v[60:63]
  ds_read_b64_tr_b16 v[30:31], v11 offset:512
  buffer_load_dwordx4 v[124:127], v89, s[8:11], s36 offen sc1
  s_waitcnt vmcnt(13) lgkmcnt(6)
  v_mfma_f32_16x16x32_bf16 v[48:51], v[16:19], v[136:139], v[48:51]
  ds_read_b64_tr_b16 v[32:33], v8 offset:4096
  s_waitcnt vmcnt(12)
  v_mfma_f32_16x16x32_bf16 v[64:67], v[16:19], v[140:143], v[64:67]
  ds_read_b64_tr_b16 v[34:35], v8 offset:4608
  v_add_u32 v8, 8192, v8
  s_waitcnt lgkmcnt(6)
  v_mfma_f32_16x16x32_bf16 v[68:71], v[20:23], v[140:143], v[68:71]
  ds_read_b64_tr_b16 v[36:37], v9 offset:4096
  buffer_load_dwordx4 v[128:131], v90, s[8:11], s36 offen sc1
  v_mfma_f32_16x16x32_bf16 v[52:55], v[20:23], v[136:139], v[52:55]
  ds_read_b64_tr_b16 v[38:39], v9 offset:4608
  v_add_u32 v9, 8192, v9
  s_waitcnt lgkmcnt(6)
  v_mfma_f32_16x16x32_bf16 v[56:59], v[24:27], v[136:139], v[56:59]
  ds_read_b64_tr_b16 v[40:41], v10 offset:4096
  v_mfma_f32_16x16x32_bf16 v[72:75], v[24:27], v[140:143], v[72:75]
  ds_read_b64_tr_b16 v[42:43], v10 offset:4608
  v_add_u32 v10, 8192, v10
  s_waitcnt lgkmcnt(6)
  v_mfma_f32_16x16x32_bf16 v[76:79], v[28:31], v[140:143], v[76:79]
  ds_read_b64_tr_b16 v[44:45], v11 offset:4096
  buffer_load_dwordx4 v[132:135], v91, s[8:11], s36 offen sc1
  v_mfma_f32_16x16x32_bf16 v[60:63], v[28:31], v[136:139], v[60:63]
  ds_read_b64_tr_b16 v[46:47], v11 offset:4608
  v_add_u32 v11, 8192, v11
  s_waitcnt vmcnt(13) lgkmcnt(6)
  v_mfma_f32_16x16x32_bf16 v[48:51], v[32:35], v[144:147], v[48:51]
  ds_read_b64_tr_b16 v[16:17], v8 offset:0
  s_bitcmp1_b32 s48, 1
  s_cselect_b32 s36, s50, s49
  s_waitcnt vmcnt(12)
  v_mfma_f32_16x16x32_bf16 v[64:67], v[32:35], v[148:151], v[64:67]
  ds_read_b64_tr_b16 v[18:19], v8 offset:512
  s_add_u32 s36, s36, 8192
  s_waitcnt lgkmcnt(6)
  v_mfma_f32_16x16x32_bf16 v[68:71], v[36:39], v[148:151], v[68:71]
  ds_read_b64_tr_b16 v[20:21], v9 offset:0
  v_mfma_f32_16x16x32_bf16 v[52:55], v[36:39], v[144:147], v[52:55]
  ds_read_b64_tr_b16 v[22:23], v9 offset:512
  s_waitcnt lgkmcnt(6)
  v_mfma_f32_16x16x32_bf16 v[56:59], v[40:43], v[144:147], v[56:59]
  ds_read_b64_tr_b16 v[24:25], v10 offset:0
  buffer_load_dwordx4 v[136:139], v88, s[8:11], s36 offen sc1
  v_mfma_f32_16x16x32_bf16 v[72:75], v[40:43], v[148:151], v[72:75]
  ds_read_b64_tr_b16 v[26:27], v10 offset:512
  s_waitcnt lgkmcnt(6)
  v_mfma_f32_16x16x32_bf16 v[76:79], v[44:47], v[148:151], v[76:79]
  ds_read_b64_tr_b16 v[28:29], v11 offset:0
  v_mfma_f32_16x16x32_bf16 v[60:63], v[44:47], v[144:147], v[60:63]
  ds_read_b64_tr_b16 v[30:31], v11 offset:512
  buffer_load_dwordx4 v[140:143], v89, s[8:11], s36 offen sc1
  s_waitcnt vmcnt(13) lgkmcnt(6)
  v_mfma_f32_16x16x32_bf16 v[48:51], v[16:19], v[152:155], v[48:51]
  ds_read_b64_tr_b16 v[32:33], v8 offset:4096
  s_waitcnt vmcnt(12)
  v_mfma_f32_16x16x32_bf16 v[64:67], v[16:19], v[156:159], v[64:67]
  ds_read_b64_tr_b16 v[34:35], v8 offset:4608
  v_add_u32 v8, 4294850304, v8
  s_waitcnt lgkmcnt(6)
  v_mfma_f32_16x16x32_bf16 v[68:71], v[20:23], v[156:159], v[68:71]
  ds_read_b64_tr_b16 v[36:37], v9 offset:4096
  buffer_load_dwordx4 v[144:147], v90, s[8:11], s36 offen sc1
  v_mfma_f32_16x16x32_bf16 v[52:55], v[20:23], v[152:155], v[52:55]
  ds_read_b64_tr_b16 v[38:39], v9 offset:4608
  v_add_u32 v9, 4294850304, v9
  s_waitcnt lgkmcnt(6)
  v_mfma_f32_16x16x32_bf16 v[56:59], v[24:27], v[152:155], v[56:59]
  ds_read_b64_tr_b16 v[40:41], v10 offset:4096
  v_mfma_f32_16x16x32_bf16 v[72:75], v[24:27], v[156:159], v[72:75]
  ds_read_b64_tr_b16 v[42:43], v10 offset:4608
  v_add_u32 v10, 4294850304, v10
  s_waitcnt lgkmcnt(6)
  v_mfma_f32_16x16x32_bf16 v[76:79], v[28:31], v[156:159], v[76:79]
  ds_read_b64_tr_b16 v[44:45], v11 offset:4096
  buffer_load_dwordx4 v[148:151], v91, s[8:11], s36 offen sc1
  v_mfma_f32_16x16x32_bf16 v[60:63], v[28:31], v[152:155], v[60:63]
  ds_read_b64_tr_b16 v[46:47], v11 offset:4608
  v_add_u32 v11, 4294850304, v11
  s_waitcnt vmcnt(13) lgkmcnt(6)
  v_mfma_f32_16x16x32_bf16 v[48:51], v[32:35], v[160:163], v[48:51]
  ds_read_b64_tr_b16 v[16:17], v8 offset:0
  s_bitcmp1_b32 s48, 2
  s_cselect_b32 s36, s50, s49
  s_waitcnt vmcnt(12)
  v_mfma_f32_16x16x32_bf16 v[64:67], v[32:35], v[164:167], v[64:67]
  ds_read_b64_tr_b16 v[18:19], v8 offset:512
  s_add_u32 s36, s36, 16384
  s_waitcnt lgkmcnt(6)
  v_mfma_f32_16x16x32_bf16 v[68:71], v[36:39], v[164:167], v[68:71]
  ds_read_b64_tr_b16 v[20:21], v9 offset:0
  v_mfma_f32_16x16x32_bf16 v[52:55], v[36:39], v[160:163], v[52:55]
  ds_read_b64_tr_b16 v[22:23], v9 offset:512
  s_waitcnt lgkmcnt(6)
  v_mfma_f32_16x16x32_bf16 v[56:59], v[40:43], v[160:163], v[56:59]
  ds_read_b64_tr_b16 v[24:25], v10 offset:0
  buffer_load_dwordx4 v[152:155], v88, s[8:11], s36 offen sc1
  v_mfma_f32_16x16x32_bf16 v[72:75], v[40:43], v[164:167], v[72:75]
  ds_read_b64_tr_b16 v[26:27], v10 offset:512
  s_waitcnt lgkmcnt(6)
  v_mfma_f32_16x16x32_bf16 v[76:79], v[44:47], v[164:167], v[76:79]
  ds_read_b64_tr_b16 v[28:29], v11 offset:0
  v_mfma_f32_16x16x32_bf16 v[60:63], v[44:47], v[160:163], v[60:63]
  ds_read_b64_tr_b16 v[30:31], v11 offset:512
  buffer_load_dwordx4 v[156:159], v89, s[8:11], s36 offen sc1
  s_waitcnt vmcnt(13) lgkmcnt(6)
  v_mfma_f32_16x16x32_bf16 v[48:51], v[16:19], v[168:171], v[48:51]
  ds_read_b64_tr_b16 v[32:33], v8 offset:4096
  s_waitcnt vmcnt(12)
  v_mfma_f32_16x16x32_bf16 v[64:67], v[16:19], v[172:175], v[64:67]
  ds_read_b64_tr_b16 v[34:35], v8 offset:4608
  v_add_u32 v8, 8192, v8
  s_waitcnt lgkmcnt(6)
  v_mfma_f32_16x16x32_bf16 v[68:71], v[20:23], v[172:175], v[68:71]
  ds_read_b64_tr_b16 v[36:37], v9 offset:4096
  buffer_load_dwordx4 v[160:163], v90, s[8:11], s36 offen sc1
  v_mfma_f32_16x16x32_bf16 v[52:55], v[20:23], v[168:171], v[52:55]
  ds_read_b64_tr_b16 v[38:39], v9 offset:4608
  v_add_u32 v9, 8192, v9
  s_waitcnt lgkmcnt(6)
  v_mfma_f32_16x16x32_bf16 v[56:59], v[24:27], v[168:171], v[56:59]
  ds_read_b64_tr_b16 v[40:41], v10 offset:4096
  v_mfma_f32_16x16x32_bf16 v[72:75], v[24:27], v[172:175], v[72:75]
  ds_read_b64_tr_b16 v[42:43], v10 offset:4608
  v_add_u32 v10, 8192, v10
  s_waitcnt lgkmcnt(6)
  v_mfma_f32_16x16x32_bf16 v[76:79], v[28:31], v[172:175], v[76:79]
  ds_read_b64_tr_b16 v[44:45], v11 offset:4096
  buffer_load_dwordx4 v[164:167], v91, s[8:11], s36 offen sc1
  v_mfma_f32_16x16x32_bf16 v[60:63], v[28:31], v[168:171], v[60:63]
  ds_read_b64_tr_b16 v[46:47], v11 offset:4608
  v_add_u32 v11, 8192, v11
  s_waitcnt vmcnt(13) lgkmcnt(6)
  v_mfma_f32_16x16x32_bf16 v[48:51], v[32:35], v[176:179], v[48:51]
  ds_read_b64_tr_b16 v[16:17], v8 offset:0
  s_bitcmp1_b32 s48, 3
  s_cselect_b32 s36, s50, s49
  s_waitcnt vmcnt(12)
  v_mfma_f32_16x16x32_bf16 v[64:67], v[32:35], v[180:183], v[64:67]
  ds_read_b64_tr_b16 v[18:19], v8 offset:512
  s_add_u32 s36, s36, 24576
  s_waitcnt lgkmcnt(6)
  v_mfma_f32_16x16x32_bf16 v[68:71], v[36:39], v[180:183], v[68:71]
  ds_read_b64_tr_b16 v[20:21], v9 offset:0
  v_mfma_f32_16x16x32_bf16 v[52:55], v[36:39], v[176:179], v[52:55]
  ds_read_b64_tr_b16 v[22:23], v9 offset:512
  s_waitcnt lgkmcnt(6)
  v_mfma_f32_16x16x32_bf16 v[56:59], v[40:43], v[176:179], v[56:59]
  ds_read_b64_tr_b16 v[24:25], v10 offset:0
  buffer_load_dwordx4 v[168:171], v88, s[8:11], s36 offen sc1
  v_mfma_f32_16x16x32_bf16 v[72:75], v[40:43], v[180:183], v[72:75]
  ds_read_b64_tr_b16 v[26:27], v10 offset:512
  s_waitcnt lgkmcnt(6)
  v_mfma_f32_16x16x32_bf16 v[76:79], v[44:47], v[180:183], v[76:79]
  ds_read_b64_tr_b16 v[28:29], v11 offset:0
  v_mfma_f32_16x16x32_bf16 v[60:63], v[44:47], v[176:179], v[60:63]
  ds_read_b64_tr_b16 v[30:31], v11 offset:512
  buffer_load_dwordx4 v[172:175], v89, s[8:11], s36 offen sc1
  s_waitcnt vmcnt(13) lgkmcnt(6)
  v_mfma_f32_16x16x32_bf16 v[48:51], v[16:19], v[120:123], v[48:51]
  ds_read_b64_tr_b16 v[32:33], v8 offset:4096
  s_waitcnt vmcnt(12)
  v_mfma_f32_16x16x32_bf16 v[64:67], v[16:19], v[124:127], v[64:67]
  ds_read_b64_tr_b16 v[34:35], v8 offset:4608
  v_add_u32 v8, 8192, v8
  s_waitcnt lgkmcnt(6)
  v_mfma_f32_16x16x32_bf16 v[68:71], v[20:23], v[124:127], v[68:71]
  ds_read_b64_tr_b16 v[36:37], v9 offset:4096
  buffer_load_dwordx4 v[176:179], v90, s[8:11], s36 offen sc1
  v_mfma_f32_16x16x32_bf16 v[52:55], v[20:23], v[120:123], v[52:55]
  ds_read_b64_tr_b16 v[38:39], v9 offset:4608
  v_add_u32 v9, 8192, v9
  s_waitcnt lgkmcnt(6)
  v_mfma_f32_16x16x32_bf16 v[56:59], v[24:27], v[120:123], v[56:59]
  ds_read_b64_tr_b16 v[40:41], v10 offset:4096
  v_mfma_f32_16x16x32_bf16 v[72:75], v[24:27], v[124:127], v[72:75]
  ds_read_b64_tr_b16 v[42:43], v10 offset:4608
  v_add_u32 v10, 8192, v10
  s_waitcnt lgkmcnt(6)
  v_mfma_f32_16x16x32_bf16 v[76:79], v[28:31], v[124:127], v[76:79]
  ds_read_b64_tr_b16 v[44:45], v11 offset:4096
  buffer_load_dwordx4 v[180:183], v91, s[8:11], s36 offen sc1
  v_mfma_f32_16x16x32_bf16 v[60:63], v[28:31], v[120:123], v[60:63]
  ds_read_b64_tr_b16 v[46:47], v11 offset:4608
  v_add_u32 v11, 8192, v11
  s_waitcnt vmcnt(13) lgkmcnt(6)
  v_mfma_f32_16x16x32_bf16 v[48:51], v[32:35], v[128:131], v[48:51]
  ds_read_b64_tr_b16 v[16:17], v8 offset:0
  s_bitcmp1_b32 s48, 4
  s_cselect_b32 s36, s50, s49
  s_waitcnt vmcnt(12)
  v_mfma_f32_16x16x32_bf16 v[64:67], v[32:35], v[132:135], v[64:67]
  ds_read_b64_tr_b16 v[18:19], v8 offset:512
  s_add_u32 s36, s36, 32768
  s_waitcnt lgkmcnt(6)
  v_mfma_f32_16x16x32_bf16 v[68:71], v[36:39], v[132:135], v[68:71]
  ds_read_b64_tr_b16 v[20:21], v9 offset:0
  v_mfma_f32_16x16x32_bf16 v[52:55], v[36:39], v[128:131], v[52:55]
  ds_read_b64_tr_b16 v[22:23], v9 offset:512
  s_waitcnt lgkmcnt(6)
  v_mfma_f32_16x16x32_bf16 v[56:59], v[40:43], v[128:131], v[56:59]
  ds_read_b64_tr_b16 v[24:25], v10 offset:0
  buffer_load_dwordx4 v[120:123], v88, s[8:11], s36 offen sc1
  v_mfma_f32_16x16x32_bf16 v[72:75], v[40:43], v[132:135], v[72:75]
  ds_read_b64_tr_b16 v[26:27], v10 offset:512
  s_waitcnt lgkmcnt(6)
  v_mfma_f32_16x16x32_bf16 v[76:79], v[44:47], v[132:135], v[76:79]
  ds_read_b64_tr_b16 v[28:29], v11 offset:0
  v_mfma_f32_16x16x32_bf16 v[60:63], v[44:47], v[128:131], v[60:63]
  ds_read_b64_tr_b16 v[30:31], v11 offset:512
  buffer_load_dwordx4 v[124:127], v89, s[8:11], s36 offen sc1
  s_waitcnt vmcnt(13) lgkmcnt(6)
  v_mfma_f32_16x16x32_bf16 v[48:51], v[16:19], v[136:139], v[48:51]
  ds_read_b64_tr_b16 v[32:33], v8 offset:4096
  s_waitcnt vmcnt(12)
  v_mfma_f32_16x16x32_bf16 v[64:67], v[16:19], v[140:143], v[64:67]
  ds_read_b64_tr_b16 v[34:35], v8 offset:4608
  v_add_u32 v8, 8192, v8
  s_waitcnt lgkmcnt(6)
  v_mfma_f32_16x16x32_bf16 v[68:71], v[20:23], v[140:143], v[68:71]
  ds_read_b64_tr_b16 v[36:37], v9 offset:4096
  buffer_load_dwordx4 v[128:131], v90, s[8:11], s36 offen sc1
  v_mfma_f32_16x16x32_bf16 v[52:55], v[20:23], v[136:139], v[52:55]
  ds_read_b64_tr_b16 v[38:39], v9 offset:4608
  v_add_u32 v9, 8192, v9
  s_waitcnt lgkmcnt(6)
  v_mfma_f32_16x16x32_bf16 v[56:59], v[24:27], v[136:139], v[56:59]
  ds_read_b64_tr_b16 v[40:41], v10 offset:4096
  v_mfma_f32_16x16x32_bf16 v[72:75], v[24:27], v[140:143], v[72:75]
  ds_read_b64_tr_b16 v[42:43], v10 offset:4608
  v_add_u32 v10, 8192, v10
  s_waitcnt lgkmcnt(6)
  v_mfma_f32_16x16x32_bf16 v[76:79], v[28:31], v[140:143], v[76:79]
  ds_read_b64_tr_b16 v[44:45], v11 offset:4096
  buffer_load_dwordx4 v[132:135], v91, s[8:11], s36 offen sc1
  v_mfma_f32_16x16x32_bf16 v[60:63], v[28:31], v[136:139], v[60:63]
  ds_read_b64_tr_b16 v[46:47], v11 offset:4608
  v_add_u32 v11, 8192, v11
  s_waitcnt vmcnt(13) lgkmcnt(6)
  v_mfma_f32_16x16x32_bf16 v[48:51], v[32:35], v[144:147], v[48:51]
  ds_read_b64_tr_b16 v[16:17], v8 offset:0
  s_bitcmp1_b32 s48, 5
  s_cselect_b32 s36, s50, s49
  s_waitcnt vmcnt(12)
  v_mfma_f32_16x16x32_bf16 v[64:67], v[32:35], v[148:151], v[64:67]
  ds_read_b64_tr_b16 v[18:19], v8 offset:512
  s_add_u32 s36, s36, 40960
  s_waitcnt lgkmcnt(6)
  v_mfma_f32_16x16x32_bf16 v[68:71], v[36:39], v[148:151], v[68:71]
  ds_read_b64_tr_b16 v[20:21], v9 offset:0
  v_mfma_f32_16x16x32_bf16 v[52:55], v[36:39], v[144:147], v[52:55]
  ds_read_b64_tr_b16 v[22:23], v9 offset:512
  s_waitcnt lgkmcnt(6)
  v_mfma_f32_16x16x32_bf16 v[56:59], v[40:43], v[144:147], v[56:59]
  ds_read_b64_tr_b16 v[24:25], v10 offset:0
  buffer_load_dwordx4 v[136:139], v88, s[8:11], s36 offen sc1
  v_mfma_f32_16x16x32_bf16 v[72:75], v[40:43], v[148:151], v[72:75]
  ds_read_b64_tr_b16 v[26:27], v10 offset:512
  s_waitcnt lgkmcnt(6)
  v_mfma_f32_16x16x32_bf16 v[76:79], v[44:47], v[148:151], v[76:79]
  ds_read_b64_tr_b16 v[28:29], v11 offset:0
  v_mfma_f32_16x16x32_bf16 v[60:63], v[44:47], v[144:147], v[60:63]
  ds_read_b64_tr_b16 v[30:31], v11 offset:512
  buffer_load_dwordx4 v[140:143], v89, s[8:11], s36 offen sc1
  s_waitcnt vmcnt(13) lgkmcnt(6)
  v_mfma_f32_16x16x32_bf16 v[48:51], v[16:19], v[152:155], v[48:51]
  ds_read_b64_tr_b16 v[32:33], v8 offset:4096
  s_waitcnt vmcnt(12)
  v_mfma_f32_16x16x32_bf16 v[64:67], v[16:19], v[156:159], v[64:67]
  ds_read_b64_tr_b16 v[34:35], v8 offset:4608
  v_add_u32 v8, 8192, v8
  s_waitcnt lgkmcnt(6)
  v_mfma_f32_16x16x32_bf16 v[68:71], v[20:23], v[156:159], v[68:71]
  ds_read_b64_tr_b16 v[36:37], v9 offset:4096
  buffer_load_dwordx4 v[144:147], v90, s[8:11], s36 offen sc1
  v_mfma_f32_16x16x32_bf16 v[52:55], v[20:23], v[152:155], v[52:55]
  ds_read_b64_tr_b16 v[38:39], v9 offset:4608
  v_add_u32 v9, 8192, v9
  s_waitcnt lgkmcnt(6)
  v_mfma_f32_16x16x32_bf16 v[56:59], v[24:27], v[152:155], v[56:59]
  ds_read_b64_tr_b16 v[40:41], v10 offset:4096
  v_mfma_f32_16x16x32_bf16 v[72:75], v[24:27], v[156:159], v[72:75]
  ds_read_b64_tr_b16 v[42:43], v10 offset:4608
  v_add_u32 v10, 8192, v10
  s_waitcnt lgkmcnt(6)
  v_mfma_f32_16x16x32_bf16 v[76:79], v[28:31], v[156:159], v[76:79]
  ds_read_b64_tr_b16 v[44:45], v11 offset:4096
  buffer_load_dwordx4 v[148:151], v91, s[8:11], s36 offen sc1
  v_mfma_f32_16x16x32_bf16 v[60:63], v[28:31], v[152:155], v[60:63]
  ds_read_b64_tr_b16 v[46:47], v11 offset:4608
  v_add_u32 v11, 8192, v11
  s_waitcnt vmcnt(13) lgkmcnt(6)
  v_mfma_f32_16x16x32_bf16 v[48:51], v[32:35], v[160:163], v[48:51]
  ds_read_b64_tr_b16 v[16:17], v8 offset:0
  s_bitcmp1_b32 s48, 6
  s_cselect_b32 s36, s50, s49
  s_waitcnt vmcnt(12)
  v_mfma_f32_16x16x32_bf16 v[64:67], v[32:35], v[164:167], v[64:67]
  ds_read_b64_tr_b16 v[18:19], v8 offset:512
  s_add_u32 s36, s36, 49152
  s_waitcnt lgkmcnt(6)
  v_mfma_f32_16x16x32_bf16 v[68:71], v[36:39], v[164:167], v[68:71]
  ds_read_b64_tr_b16 v[20:21], v9 offset:0
  v_mfma_f32_16x16x32_bf16 v[52:55], v[36:39], v[160:163], v[52:55]
  ds_read_b64_tr_b16 v[22:23], v9 offset:512
  s_waitcnt lgkmcnt(6)
  v_mfma_f32_16x16x32_bf16 v[56:59], v[40:43], v[160:163], v[56:59]
  ds_read_b64_tr_b16 v[24:25], v10 offset:0
  buffer_load_dwordx4 v[152:155], v88, s[8:11], s36 offen sc1
  v_mfma_f32_16x16x32_bf16 v[72:75], v[40:43], v[164:167], v[72:75]
  ds_read_b64_tr_b16 v[26:27], v10 offset:512
  s_waitcnt lgkmcnt(6)
  v_mfma_f32_16x16x32_bf16 v[76:79], v[44:47], v[164:167], v[76:79]
  ds_read_b64_tr_b16 v[28:29], v11 offset:0
  v_mfma_f32_16x16x32_bf16 v[60:63], v[44:47], v[160:163], v[60:63]
  ds_read_b64_tr_b16 v[30:31], v11 offset:512
  buffer_load_dwordx4 v[156:159], v89, s[8:11], s36 offen sc1
  s_waitcnt vmcnt(13) lgkmcnt(6)
  v_mfma_f32_16x16x32_bf16 v[48:51], v[16:19], v[168:171], v[48:51]
  ds_read_b64_tr_b16 v[32:33], v8 offset:4096
  s_waitcnt vmcnt(12)
  v_mfma_f32_16x16x32_bf16 v[64:67], v[16:19], v[172:175], v[64:67]
  ds_read_b64_tr_b16 v[34:35], v8 offset:4608
  v_add_u32 v8, 10240, v8
  s_waitcnt lgkmcnt(6)
  v_mfma_f32_16x16x32_bf16 v[68:71], v[20:23], v[172:175], v[68:71]
  ds_read_b64_tr_b16 v[36:37], v9 offset:4096
  buffer_load_dwordx4 v[160:163], v90, s[8:11], s36 offen sc1
  v_mfma_f32_16x16x32_bf16 v[52:55], v[20:23], v[168:171], v[52:55]
  ds_read_b64_tr_b16 v[38:39], v9 offset:4608
  v_add_u32 v9, 10240, v9
  s_waitcnt lgkmcnt(6)
  v_mfma_f32_16x16x32_bf16 v[56:59], v[24:27], v[168:171], v[56:59]
  ds_read_b64_tr_b16 v[40:41], v10 offset:4096
  v_mfma_f32_16x16x32_bf16 v[72:75], v[24:27], v[172:175], v[72:75]
  ds_read_b64_tr_b16 v[42:43], v10 offset:4608
  v_add_u32 v10, 10240, v10
  s_waitcnt lgkmcnt(6)
  v_mfma_f32_16x16x32_bf16 v[76:79], v[28:31], v[172:175], v[76:79]
  ds_read_b64_tr_b16 v[44:45], v11 offset:4096
  buffer_load_dwordx4 v[164:167], v91, s[8:11], s36 offen sc1
  v_mfma_f32_16x16x32_bf16 v[60:63], v[28:31], v[168:171], v[60:63]
  ds_read_b64_tr_b16 v[46:47], v11 offset:4608
  v_add_u32 v11, 10240, v11
  s_waitcnt vmcnt(13) lgkmcnt(6)
  v_mfma_f32_16x16x32_bf16 v[48:51], v[32:35], v[176:179], v[48:51]
  ds_read_b64_tr_b16 v[16:17], v8 offset:0
  s_bitcmp1_b32 s48, 7
  s_cselect_b32 s36, s50, s49
  s_waitcnt vmcnt(12)
  v_mfma_f32_16x16x32_bf16 v[64:67], v[32:35], v[180:183], v[64:67]
  ds_read_b64_tr_b16 v[18:19], v8 offset:512
  s_add_u32 s36, s36, 57344
  s_waitcnt lgkmcnt(6)
  v_mfma_f32_16x16x32_bf16 v[68:71], v[36:39], v[180:183], v[68:71]
  ds_read_b64_tr_b16 v[20:21], v9 offset:0
  v_mfma_f32_16x16x32_bf16 v[52:55], v[36:39], v[176:179], v[52:55]
  ds_read_b64_tr_b16 v[22:23], v9 offset:512
  s_waitcnt lgkmcnt(6)
  v_mfma_f32_16x16x32_bf16 v[56:59], v[40:43], v[176:179], v[56:59]
  ds_read_b64_tr_b16 v[24:25], v10 offset:0
  buffer_load_dwordx4 v[168:171], v88, s[8:11], s36 offen sc1
  v_mfma_f32_16x16x32_bf16 v[72:75], v[40:43], v[180:183], v[72:75]
  ds_read_b64_tr_b16 v[26:27], v10 offset:512
  s_waitcnt lgkmcnt(6)
  v_mfma_f32_16x16x32_bf16 v[76:79], v[44:47], v[180:183], v[76:79]
  ds_read_b64_tr_b16 v[28:29], v11 offset:0
  v_mfma_f32_16x16x32_bf16 v[60:63], v[44:47], v[176:179], v[60:63]
  ds_read_b64_tr_b16 v[30:31], v11 offset:512
  buffer_load_dwordx4 v[172:175], v89, s[8:11], s36 offen sc1
  s_waitcnt vmcnt(13) lgkmcnt(6)
  v_mfma_f32_16x16x32_bf16 v[48:51], v[16:19], v[120:123], v[48:51]
  ds_read_b64_tr_b16 v[32:33], v8 offset:4096
  s_waitcnt vmcnt(12)
  v_mfma_f32_16x16x32_bf16 v[64:67], v[16:19], v[124:127], v[64:67]
  ds_read_b64_tr_b16 v[34:35], v8 offset:4608
  v_add_u32 v8, 8192, v8
  s_waitcnt lgkmcnt(6)
  v_mfma_f32_16x16x32_bf16 v[68:71], v[20:23], v[124:127], v[68:71]
  ds_read_b64_tr_b16 v[36:37], v9 offset:4096
  buffer_load_dwordx4 v[176:179], v90, s[8:11], s36 offen sc1
  v_mfma_f32_16x16x32_bf16 v[52:55], v[20:23], v[120:123], v[52:55]
  ds_read_b64_tr_b16 v[38:39], v9 offset:4608
  v_add_u32 v9, 8192, v9
  s_waitcnt lgkmcnt(6)
  v_mfma_f32_16x16x32_bf16 v[56:59], v[24:27], v[120:123], v[56:59]
  ds_read_b64_tr_b16 v[40:41], v10 offset:4096
  v_mfma_f32_16x16x32_bf16 v[72:75], v[24:27], v[124:127], v[72:75]
  ds_read_b64_tr_b16 v[42:43], v10 offset:4608
  v_add_u32 v10, 8192, v10
  s_waitcnt lgkmcnt(6)
  v_mfma_f32_16x16x32_bf16 v[76:79], v[28:31], v[124:127], v[76:79]
  ds_read_b64_tr_b16 v[44:45], v11 offset:4096
  buffer_load_dwordx4 v[180:183], v91, s[8:11], s36 offen sc1
  v_mfma_f32_16x16x32_bf16 v[60:63], v[28:31], v[120:123], v[60:63]
  ds_read_b64_tr_b16 v[46:47], v11 offset:4608
  v_add_u32 v11, 8192, v11
  s_waitcnt vmcnt(13) lgkmcnt(6)
  v_mfma_f32_16x16x32_bf16 v[48:51], v[32:35], v[128:131], v[48:51]
  ds_read_b64_tr_b16 v[16:17], v8 offset:0
  s_waitcnt vmcnt(12)
  v_mfma_f32_16x16x32_bf16 v[64:67], v[32:35], v[132:135], v[64:67]
  ds_read_b64_tr_b16 v[18:19], v8 offset:512
  s_waitcnt lgkmcnt(6)
  v_mfma_f32_16x16x32_bf16 v[68:71], v[36:39], v[132:135], v[68:71]
  ds_read_b64_tr_b16 v[20:21], v9 offset:0
  v_mfma_f32_16x16x32_bf16 v[52:55], v[36:39], v[128:131], v[52:55]
  ds_read_b64_tr_b16 v[22:23], v9 offset:512
  s_waitcnt lgkmcnt(6)
  v_mfma_f32_16x16x32_bf16 v[56:59], v[40:43], v[128:131], v[56:59]
  ds_read_b64_tr_b16 v[24:25], v10 offset:0
  v_mfma_f32_16x16x32_bf16 v[72:75], v[40:43], v[132:135], v[72:75]
  ds_read_b64_tr_b16 v[26:27], v10 offset:512
  s_waitcnt lgkmcnt(6)
  v_mfma_f32_16x16x32_bf16 v[76:79], v[44:47], v[132:135], v[76:79]
  ds_read_b64_tr_b16 v[28:29], v11 offset:0
  v_mfma_f32_16x16x32_bf16 v[60:63], v[44:47], v[128:131], v[60:63]
  ds_read_b64_tr_b16 v[30:31], v11 offset:512
  s_waitcnt vmcnt(11) lgkmcnt(6)
  v_mfma_f32_16x16x32_bf16 v[48:51], v[16:19], v[136:139], v[48:51]
  ds_read_b64_tr_b16 v[32:33], v8 offset:4096
  s_waitcnt vmcnt(10)
  v_mfma_f32_16x16x32_bf16 v[64:67], v[16:19], v[140:143], v[64:67]
  ds_read_b64_tr_b16 v[34:35], v8 offset:4608
  v_add_u32 v8, 8192, v8
  s_waitcnt lgkmcnt(6)
  v_mfma_f32_16x16x32_bf16 v[68:71], v[20:23], v[140:143], v[68:71]
  ds_read_b64_tr_b16 v[36:37], v9 offset:4096
  v_mfma_f32_16x16x32_bf16 v[52:55], v[20:23], v[136:139], v[52:55]
  ds_read_b64_tr_b16 v[38:39], v9 offset:4608
  v_add_u32 v9, 8192, v9
  s_waitcnt lgkmcnt(6)
  v_mfma_f32_16x16x32_bf16 v[56:59], v[24:27], v[136:139], v[56:59]
  ds_read_b64_tr_b16 v[40:41], v10 offset:4096
  v_mfma_f32_16x16x32_bf16 v[72:75], v[24:27], v[140:143], v[72:75]
  ds_read_b64_tr_b16 v[42:43], v10 offset:4608
  v_add_u32 v10, 8192, v10
  s_waitcnt lgkmcnt(6)
  v_mfma_f32_16x16x32_bf16 v[76:79], v[28:31], v[140:143], v[76:79]
  ds_read_b64_tr_b16 v[44:45], v11 offset:4096
  v_mfma_f32_16x16x32_bf16 v[60:63], v[28:31], v[136:139], v[60:63]
  ds_read_b64_tr_b16 v[46:47], v11 offset:4608
  v_add_u32 v11, 8192, v11
  s_waitcnt vmcnt(9) lgkmcnt(6)
  v_mfma_f32_16x16x32_bf16 v[48:51], v[32:35], v[144:147], v[48:51]
  ds_read_b64_tr_b16 v[16:17], v8 offset:0
  s_waitcnt vmcnt(8)
  v_mfma_f32_16x16x32_bf16 v[64:67], v[32:35], v[148:151], v[64:67]
  ds_read_b64_tr_b16 v[18:19], v8 offset:512
  s_waitcnt lgkmcnt(6)
  v_mfma_f32_16x16x32_bf16 v[68:71], v[36:39], v[148:151], v[68:71]
  ds_read_b64_tr_b16 v[20:21], v9 offset:0
  v_mfma_f32_16x16x32_bf16 v[52:55], v[36:39], v[144:147], v[52:55]
  ds_read_b64_tr_b16 v[22:23], v9 offset:512
  s_waitcnt lgkmcnt(6)
  v_mfma_f32_16x16x32_bf16 v[56:59], v[40:43], v[144:147], v[56:59]
  ds_read_b64_tr_b16 v[24:25], v10 offset:0
  v_mfma_f32_16x16x32_bf16 v[72:75], v[40:43], v[148:151], v[72:75]
  ds_read_b64_tr_b16 v[26:27], v10 offset:512
  s_waitcnt lgkmcnt(6)
  v_mfma_f32_16x16x32_bf16 v[76:79], v[44:47], v[148:151], v[76:79]
  ds_read_b64_tr_b16 v[28:29], v11 offset:0
  v_mfma_f32_16x16x32_bf16 v[60:63], v[44:47], v[144:147], v[60:63]
  ds_read_b64_tr_b16 v[30:31], v11 offset:512
  s_waitcnt vmcnt(7) lgkmcnt(6)
  v_mfma_f32_16x16x32_bf16 v[48:51], v[16:19], v[152:155], v[48:51]
  ds_read_b64_tr_b16 v[32:33], v8 offset:4096
  s_waitcnt vmcnt(6)
  v_mfma_f32_16x16x32_bf16 v[64:67], v[16:19], v[156:159], v[64:67]
  ds_read_b64_tr_b16 v[34:35], v8 offset:4608
  v_add_u32 v8, 8192, v8
  s_waitcnt lgkmcnt(6)
  v_mfma_f32_16x16x32_bf16 v[68:71], v[20:23], v[156:159], v[68:71]
  ds_read_b64_tr_b16 v[36:37], v9 offset:4096
  v_mfma_f32_16x16x32_bf16 v[52:55], v[20:23], v[152:155], v[52:55]
  ds_read_b64_tr_b16 v[38:39], v9 offset:4608
  v_add_u32 v9, 8192, v9
  s_waitcnt lgkmcnt(6)
  v_mfma_f32_16x16x32_bf16 v[56:59], v[24:27], v[152:155], v[56:59]
  ds_read_b64_tr_b16 v[40:41], v10 offset:4096
  v_mfma_f32_16x16x32_bf16 v[72:75], v[24:27], v[156:159], v[72:75]
  ds_read_b64_tr_b16 v[42:43], v10 offset:4608
  v_add_u32 v10, 8192, v10
  s_waitcnt lgkmcnt(6)
  v_mfma_f32_16x16x32_bf16 v[76:79], v[28:31], v[156:159], v[76:79]
  ds_read_b64_tr_b16 v[44:45], v11 offset:4096
  v_mfma_f32_16x16x32_bf16 v[60:63], v[28:31], v[152:155], v[60:63]
  ds_read_b64_tr_b16 v[46:47], v11 offset:4608
  v_add_u32 v11, 8192, v11
  s_waitcnt vmcnt(5) lgkmcnt(6)
  v_mfma_f32_16x16x32_bf16 v[48:51], v[32:35], v[160:163], v[48:51]
  ds_read_b64_tr_b16 v[16:17], v8 offset:0
  s_waitcnt vmcnt(4)
  v_mfma_f32_16x16x32_bf16 v[64:67], v[32:35], v[164:167], v[64:67]
  ds_read_b64_tr_b16 v[18:19], v8 offset:512
  s_waitcnt lgkmcnt(6)
  v_mfma_f32_16x16x32_bf16 v[68:71], v[36:39], v[164:167], v[68:71]
  ds_read_b64_tr_b16 v[20:21], v9 offset:0
  v_mfma_f32_16x16x32_bf16 v[52:55], v[36:39], v[160:163], v[52:55]
  ds_read_b64_tr_b16 v[22:23], v9 offset:512
  s_waitcnt lgkmcnt(6)
  v_mfma_f32_16x16x32_bf16 v[56:59], v[40:43], v[160:163], v[56:59]
  ds_read_b64_tr_b16 v[24:25], v10 offset:0
  v_mfma_f32_16x16x32_bf16 v[72:75], v[40:43], v[164:167], v[72:75]
  ds_read_b64_tr_b16 v[26:27], v10 offset:512
  s_waitcnt lgkmcnt(6)
  v_mfma_f32_16x16x32_bf16 v[76:79], v[44:47], v[164:167], v[76:79]
  ds_read_b64_tr_b16 v[28:29], v11 offset:0
  v_mfma_f32_16x16x32_bf16 v[60:63], v[44:47], v[160:163], v[60:63]
  ds_read_b64_tr_b16 v[30:31], v11 offset:512
  s_waitcnt vmcnt(3) lgkmcnt(6)
  v_mfma_f32_16x16x32_bf16 v[48:51], v[16:19], v[168:171], v[48:51]
  ds_read_b64_tr_b16 v[32:33], v8 offset:4096
  s_waitcnt vmcnt(2)
  v_mfma_f32_16x16x32_bf16 v[64:67], v[16:19], v[172:175], v[64:67]
  ds_read_b64_tr_b16 v[34:35], v8 offset:4608
  s_waitcnt lgkmcnt(6)
  v_mfma_f32_16x16x32_bf16 v[68:71], v[20:23], v[172:175], v[68:71]
  ds_read_b64_tr_b16 v[36:37], v9 offset:4096
  v_mfma_f32_16x16x32_bf16 v[52:55], v[20:23], v[168:171], v[52:55]
  ds_read_b64_tr_b16 v[38:39], v9 offset:4608
  s_waitcnt lgkmcnt(6)
  v_mfma_f32_16x16x32_bf16 v[56:59], v[24:27], v[168:171], v[56:59]
  ds_read_b64_tr_b16 v[40:41], v10 offset:4096
  v_mfma_f32_16x16x32_bf16 v[72:75], v[24:27], v[172:175], v[72:75]
  ds_read_b64_tr_b16 v[42:43], v10 offset:4608
  s_waitcnt lgkmcnt(6)
  v_mfma_f32_16x16x32_bf16 v[76:79], v[28:31], v[172:175], v[76:79]
  ds_read_b64_tr_b16 v[44:45], v11 offset:4096
  v_mfma_f32_16x16x32_bf16 v[60:63], v[28:31], v[168:171], v[60:63]
  ds_read_b64_tr_b16 v[46:47], v11 offset:4608
  s_waitcnt vmcnt(1) lgkmcnt(6)
  v_mfma_f32_16x16x32_bf16 v[48:51], v[32:35], v[176:179], v[48:51]
  s_waitcnt vmcnt(0)
  v_mfma_f32_16x16x32_bf16 v[64:67], v[32:35], v[180:183], v[64:67]
  s_waitcnt lgkmcnt(4)
  v_mfma_f32_16x16x32_bf16 v[68:71], v[36:39], v[180:183], v[68:71]
  v_mfma_f32_16x16x32_bf16 v[52:55], v[36:39], v[176:179], v[52:55]
  s_waitcnt lgkmcnt(2)
  v_mfma_f32_16x16x32_bf16 v[56:59], v[40:43], v[176:179], v[56:59]
  v_mfma_f32_16x16x32_bf16 v[72:75], v[40:43], v[180:183], v[72:75]
  s_waitcnt lgkmcnt(0)
  v_mfma_f32_16x16x32_bf16 v[76:79], v[44:47], v[180:183], v[76:79]
  v_mfma_f32_16x16x32_bf16 v[60:63], v[44:47], v[176:179], v[60:63]
  s_waitcnt lgkmcnt(0)
  s_barrier
  s_add_u32 s20, s82, 8388608
  s_addc_u32 s21, s83, 0
  s_mov_b32 s22, 8388608
  s_mov_b32 s23, 0x20000
  s_add_u32 s24, s82, 16777216
  s_addc_u32 s25, s83, 0
  s_mov_b32 s26, 8388608
  s_mov_b32 s27, 0x20000
  v_pk_add_f32 v[16:17], v[48:49], v[50:51]
  v_pk_mul_f32 v[18:19], v[48:49], v[48:49]
  v_pk_fma_f32 v[18:19], v[50:51], v[50:51], v[18:19]
  v_pk_add_f32 v[16:17], v[16:17], v[52:53]
  v_pk_fma_f32 v[18:19], v[52:53], v[52:53], v[18:19]
  v_pk_add_f32 v[16:17], v[16:17], v[54:55]
  v_pk_fma_f32 v[18:19], v[54:55], v[54:55], v[18:19]
  v_pk_add_f32 v[16:17], v[16:17], v[56:57]
  v_pk_fma_f32 v[18:19], v[56:57], v[56:57], v[18:19]
  v_pk_add_f32 v[16:17], v[16:17], v[58:59]
  v_pk_fma_f32 v[18:19], v[58:59], v[58:59], v[18:19]
  v_pk_add_f32 v[16:17], v[16:17], v[60:61]
  v_pk_fma_f32 v[18:19], v[60:61], v[60:61], v[18:19]
  v_pk_add_f32 v[16:17], v[16:17], v[62:63]
  v_pk_fma_f32 v[18:19], v[62:63], v[62:63], v[18:19]
  v_add_f32 v24, v16, v17
  v_add_f32 v26, v18, v19
  v_pk_add_f32 v[20:21], v[64:65], v[66:67]
  v_pk_mul_f32 v[22:23], v[64:65], v[64:65]
  v_pk_fma_f32 v[22:23], v[66:67], v[66:67], v[22:23]
  v_pk_add_f32 v[20:21], v[20:21], v[68:69]
  v_pk_fma_f32 v[22:23], v[68:69], v[68:69], v[22:23]
  v_pk_add_f32 v[20:21], v[20:21], v[70:71]
  v_pk_fma_f32 v[22:23], v[70:71], v[70:71], v[22:23]
  v_pk_add_f32 v[20:21], v[20:21], v[72:73]
  v_pk_fma_f32 v[22:23], v[72:73], v[72:73], v[22:23]
  v_pk_add_f32 v[20:21], v[20:21], v[74:75]
  v_pk_fma_f32 v[22:23], v[74:75], v[74:75], v[22:23]
  v_pk_add_f32 v[20:21], v[20:21], v[76:77]
  v_pk_fma_f32 v[22:23], v[76:77], v[76:77], v[22:23]
  v_pk_add_f32 v[20:21], v[20:21], v[78:79]
  v_pk_fma_f32 v[22:23], v[78:79], v[78:79], v[22:23]
  v_add_f32 v25, v20, v21
  v_add_f32 v27, v22, v23
  s_nop 0
  v_permlane16_swap_b32 v24, v25
  v_permlane16_swap_b32 v26, v27
  v_add_f32 v28, v24, v25
  v_add_f32 v29, v26, v27
  v_mov_b32 v30, v28
  v_mov_b32 v31, v29
  s_nop 0
  v_permlane32_swap_b32 v28, v30
  v_permlane32_swap_b32 v29, v31
  v_add_f32 v28, v28, v30
  v_add_f32 v29, v29, v31
  v_and_b32 v29, 0x7fffffff, v29
  s_mov_b32 exec_hi, 0
  buffer_store_dwordx2 v[28:29], v112, s[12:15], 0 offen sc0 sc1
  s_mov_b64 exec, -1
  v_cvt_pk_bf16_f32 v96, v48, v49
  v_cvt_pk_bf16_f32 v97, v50, v51
  v_cvt_pk_bf16_f32 v98, v52, v53
  v_cvt_pk_bf16_f32 v99, v54, v55
  v_cvt_pk_bf16_f32 v100, v56, v57
  v_cvt_pk_bf16_f32 v101, v58, v59
  v_cvt_pk_bf16_f32 v102, v60, v61
  v_cvt_pk_bf16_f32 v103, v62, v63
  v_cvt_pk_bf16_f32 v104, v64, v65
  v_cvt_pk_bf16_f32 v105, v66, v67
  v_cvt_pk_bf16_f32 v106, v68, v69
  v_cvt_pk_bf16_f32 v107, v70, v71
  v_cvt_pk_bf16_f32 v108, v72, v73
  v_cvt_pk_bf16_f32 v109, v74, v75
  v_cvt_pk_bf16_f32 v110, v76, v77
  v_cvt_pk_bf16_f32 v111, v78, v79
  v_permlane16_swap_b32 v96, v98
  v_permlane16_swap_b32 v97, v99
  v_permlane16_swap_b32 v100, v102
  v_permlane16_swap_b32 v101, v103
  v_permlane16_swap_b32 v104, v106
  v_permlane16_swap_b32 v105, v107
  v_permlane16_swap_b32 v108, v110
  v_permlane16_swap_b32 v109, v111
  v_xor_b32 v116, 32, v115
  v_xor_b32 v121, 32, v114
  v_xor_b32 v117, 64, v115
  v_xor_b32 v122, 64, v114
  v_xor_b32 v118, 96, v115
  v_xor_b32 v123, 96, v114
  v_mov_b32 v120, v114
  s_mov_b32 s39, 0
k2_poll:
  buffer_load_dwordx2 v[32:33], v113, s[12:15], 0 offen sc0 sc1
  buffer_load_dwordx2 v[34:35], v80, s[12:15], 0 offen sc0 sc1
  buffer_load_dwordx2 v[36:37], v81, s[12:15], 0 offen sc0 sc1
  buffer_load_dwordx2 v[38:39], v82, s[12:15], 0 offen sc0 sc1
  buffer_load_dwordx2 v[40:41], v83, s[12:15], 0 offen sc0 sc1
  buffer_load_dwordx2 v[42:43], v84, s[12:15], 0 offen sc0 sc1
  buffer_load_dwordx2 v[44:45], v85, s[12:15], 0 offen sc0 sc1
  buffer_load_dwordx2 v[46:47], v86, s[12:15], 0 offen sc0 sc1
  s_waitcnt vmcnt(0)
  v_min3_i32 v16, v33, v35, v37
  v_min3_i32 v17, v39, v41, v43
  v_min3_i32 v16, v16, v45, v47
  v_min_i32 v16, v16, v17
  v_cmp_gt_i32 vcc, 0, v16
  s_add_u32 s39, s39, 1
  s_cmp_gt_u32 s39, 1000000
  s_cbranch_scc1 k2_pdone
  s_cbranch_vccnz k2_poll
k2_pdone:
  buffer_store_dwordx4 v[96:99], v192, s[20:23], s53 offen sc0 sc1
  buffer_store_dwordx4 v[100:103], v194, s[20:23], s53 offen sc0 sc1
  buffer_store_dwordx4 v[104:107], v193, s[20:23], s53 offen sc0 sc1
  buffer_store_dwordx4 v[108:111], v195, s[20:23], s53 offen sc0 sc1
  v_pk_add_f32 v[32:33], v[32:33], v[34:35]
  v_pk_add_f32 v[36:37], v[36:37], v[38:39]
  v_pk_add_f32 v[40:41], v[40:41], v[42:43]
  v_pk_add_f32 v[44:45], v[44:45], v[46:47]
  v_pk_add_f32 v[32:33], v[32:33], v[36:37]
  v_pk_add_f32 v[40:41], v[40:41], v[44:45]
  v_pk_add_f32 v[32:33], v[32:33], v[40:41]
  v_mov_b32 v34, v32
  v_mov_b32 v35, v33
  s_nop 0
  v_permlane32_swap_b32 v32, v34
  v_permlane32_swap_b32 v33, v35
  v_add_f32 v32, v32, v34
  v_add_f32 v33, v33, v35
  v_mul_f32 v32, 0x3a800000, v32
  v_mul_f32 v33, 0x3a800000, v33
  v_fma_f32 v33, -v32, v32, v33
  v_max_f32 v33, 0, v33
  v_mov_b32 v36, v33
  v_cvt_pk_bf16_f32 v36, v36, v36
  v_lshlrev_b32 v36, 16, v36
  v_add_f32 v36, 0x3727c5ac, v36
  v_cvt_pk_bf16_f32 v36, v36, v36
  v_lshlrev_b32 v36, 16, v36
  v_sqrt_f32 v36, v36
  s_nop 0
  v_cvt_pk_bf16_f32 v36, v36, v36
  v_lshlrev_b32 v36, 16, v36
  v_rcp_f32 v36, v36
  s_nop 0
  v_mul_f32 v33, v33, v36
  v_mul_f32 v33, v33, v36
  v_cvt_pk_bf16_f32 v33, v33, v33
  v_lshlrev_b32 v33, 16, v33
  v_add_f32 v33, 0x3727c5ac, v33
  v_cvt_pk_bf16_f32 v33, v33, v33
  v_lshlrev_b32 v33, 16, v33
  v_sqrt_f32 v33, v33
  s_nop 0
  v_cvt_pk_bf16_f32 v33, v33, v33
  v_lshlrev_b32 v33, 16, v33
  v_rcp_f32 v33, v33
  s_nop 0
  v_mul_f32 v33, v33, v36
  v_mov_b32 v34, v32
  v_mov_b32 v35, v33
  s_nop 0
  v_permlane16_swap_b32 v32, v34
  v_permlane16_swap_b32 v33, v35
  v_pk_add_f32 v[48:49], v[48:49], v[32:33] op_sel_hi:[1,0] neg_lo:[0,1] neg_hi:[0,1]
  v_pk_add_f32 v[50:51], v[50:51], v[32:33] op_sel_hi:[1,0] neg_lo:[0,1] neg_hi:[0,1]
  v_pk_add_f32 v[52:53], v[52:53], v[32:33] op_sel_hi:[1,0] neg_lo:[0,1] neg_hi:[0,1]
  v_pk_add_f32 v[54:55], v[54:55], v[32:33] op_sel_hi:[1,0] neg_lo:[0,1] neg_hi:[0,1]
  v_pk_add_f32 v[56:57], v[56:57], v[32:33] op_sel_hi:[1,0] neg_lo:[0,1] neg_hi:[0,1]
  v_pk_add_f32 v[58:59], v[58:59], v[32:33] op_sel_hi:[1,0] neg_lo:[0,1] neg_hi:[0,1]
  v_pk_add_f32 v[60:61], v[60:61], v[32:33] op_sel_hi:[1,0] neg_lo:[0,1] neg_hi:[0,1]
  v_pk_add_f32 v[62:63], v[62:63], v[32:33] op_sel_hi:[1,0] neg_lo:[0,1] neg_hi:[0,1]
  v_pk_mul_f32 v[48:49], v[48:49], v[32:33] op_sel:[0,1] op_sel_hi:[1,1]
  v_pk_mul_f32 v[50:51], v[50:51], v[32:33] op_sel:[0,1] op_sel_hi:[1,1]
  v_pk_mul_f32 v[52:53], v[52:53], v[32:33] op_sel:[0,1] op_sel_hi:[1,1]
  v_pk_mul_f32 v[54:55], v[54:55], v[32:33] op_sel:[0,1] op_sel_hi:[1,1]
  v_pk_mul_f32 v[56:57], v[56:57], v[32:33] op_sel:[0,1] op_sel_hi:[1,1]
  v_pk_mul_f32 v[58:59], v[58:59], v[32:33] op_sel:[0,1] op_sel_hi:[1,1]
  v_pk_mul_f32 v[60:61], v[60:61], v[32:33] op_sel:[0,1] op_sel_hi:[1,1]
  v_pk_mul_f32 v[62:63], v[62:63], v[32:33] op_sel:[0,1] op_sel_hi:[1,1]
  v_cvt_pk_bf16_f32 v160, v48, v49
  v_cvt_pk_bf16_f32 v161, v50, v51
  ds_write_b64 v120, v[160:161] offset:0
  v_cvt_pk_bf16_f32 v162, v52, v53
  v_cvt_pk_bf16_f32 v163, v54, v55
  ds_write_b64 v121, v[162:163] offset:0
  v_cvt_pk_bf16_f32 v164, v56, v57
  v_cvt_pk_bf16_f32 v165, v58, v59
  ds_write_b64 v122, v[164:165] offset:0
  v_cvt_pk_bf16_f32 v166, v60, v61
  v_cvt_pk_bf16_f32 v167, v62, v63
  ds_write_b64 v123, v[166:167] offset:0
  v_pk_add_f32 v[64:65], v[64:65], v[34:35] op_sel_hi:[1,0] neg_lo:[0,1] neg_hi:[0,1]
  v_pk_add_f32 v[66:67], v[66:67], v[34:35] op_sel_hi:[1,0] neg_lo:[0,1] neg_hi:[0,1]
  v_pk_add_f32 v[68:69], v[68:69], v[34:35] op_sel_hi:[1,0] neg_lo:[0,1] neg_hi:[0,1]
  v_pk_add_f32 v[70:71], v[70:71], v[34:35] op_sel_hi:[1,0] neg_lo:[0,1] neg_hi:[0,1]
  v_pk_add_f32 v[72:73], v[72:73], v[34:35] op_sel_hi:[1,0] neg_lo:[0,1] neg_hi:[0,1]
  v_pk_add_f32 v[74:75], v[74:75], v[34:35] op_sel_hi:[1,0] neg_lo:[0,1] neg_hi:[0,1]
  v_pk_add_f32 v[76:77], v[76:77], v[34:35] op_sel_hi:[1,0] neg_lo:[0,1] neg_hi:[0,1]
  v_pk_add_f32 v[78:79], v[78:79], v[34:35] op_sel_hi:[1,0] neg_lo:[0,1] neg_hi:[0,1]
  v_pk_mul_f32 v[64:65], v[64:65], v[34:35] op_sel:[0,1] op_sel_hi:[1,1]
  v_pk_mul_f32 v[66:67], v[66:67], v[34:35] op_sel:[0,1] op_sel_hi:[1,1]
  v_pk_mul_f32 v[68:69], v[68:69], v[34:35] op_sel:[0,1] op_sel_hi:[1,1]
  v_pk_mul_f32 v[70:71], v[70:71], v[34:35] op_sel:[0,1] op_sel_hi:[1,1]
  v_pk_mul_f32 v[72:73], v[72:73], v[34:35] op_sel:[0,1] op_sel_hi:[1,1]
  v_pk_mul_f32 v[74:75], v[74:75], v[34:35] op_sel:[0,1] op_sel_hi:[1,1]
  v_pk_mul_f32 v[76:77], v[76:77], v[34:35] op_sel:[0,1] op_sel_hi:[1,1]
  v_pk_mul_f32 v[78:79], v[78:79], v[34:35] op_sel:[0,1] op_sel_hi:[1,1]
  v_cvt_pk_bf16_f32 v168, v64, v65
  v_cvt_pk_bf16_f32 v169, v66, v67
  ds_write_b64 v120, v[168:169] offset:128
  v_cvt_pk_bf16_f32 v170, v68, v69
  v_cvt_pk_bf16_f32 v171, v70, v71
  ds_write_b64 v121, v[170:171] offset:128
  v_cvt_pk_bf16_f32 v172, v72, v73
  v_cvt_pk_bf16_f32 v173, v74, v75
  ds_write_b64 v122, v[172:173] offset:128
  v_cvt_pk_bf16_f32 v174, v76, v77
  v_cvt_pk_bf16_f32 v175, v78, v79
  ds_write_b64 v123, v[174:175] offset:128
  s_waitcnt lgkmcnt(0)
  ds_read_b64_tr_b16 v[176:177], v115
  ds_read_b64_tr_b16 v[178:179], v115 offset:512
  ds_read_b64_tr_b16 v[180:181], v116
  ds_read_b64_tr_b16 v[182:183], v116 offset:512
  ds_read_b64_tr_b16 v[184:185], v117
  ds_read_b64_tr_b16 v[186:187], v117 offset:512
  ds_read_b64_tr_b16 v[188:189], v118
  ds_read_b64_tr_b16 v[190:191], v118 offset:512
  s_waitcnt lgkmcnt(6)
  buffer_store_dwordx4 v[176:179], v92, s[24:27], s44 offen sc0 sc1
  s_waitcnt lgkmcnt(4)
  buffer_store_dwordx4 v[180:183], v93, s[24:27], s45 offen sc0 sc1
  s_waitcnt lgkmcnt(2)
  buffer_store_dwordx4 v[184:187], v92, s[24:27], s46 offen sc0 sc1
  s_waitcnt lgkmcnt(0)
  buffer_store_dwordx4 v[188:191], v93, s[24:27], s47 offen sc0 sc1
  s_cmp_ge_u32 s2, 224
  s_cbranch_scc1 C_k3skip
  s_lshr_b32 s32, s2, 3
  s_mul_i32 s5, s32, 9363
  s_lshr_b32 s5, s5, 16
  s_mul_i32 s6, s5, 7
  s_sub_u32 s6, s32, s6
  s_lshl_b32 s7, s5, 1
  s_add_u32 s7, s7, s6
  s_and_b32 s7, s7, 7
  s_and_b32 s32, s2, 7
  s_lshr_b32 s28, s32, 2
  s_lshl_b32 s28, s28, 2
  s_add_u32 s28, s28, s5
  s_and_b32 s29, s32, 3
  s_mul_i32 s29, s29, 7
  s_add_u32 s29, s29, s6
  s_mov_b32 s30, 7
  s_mov_b32 s31, -1
  s_and_b32 s46, s4, 1
  s_lshr_b32 s41, s4, 1
  s_lshl_b32 s32, s29, 8
  s_lshl_b32 s44, s46, 7
  s_add_u32 s32, s32, s44
  v_lshlrev_b32 v16, 3, v5
  v_add_u32 v16, s32, v16
  s_mov_b32 s16, s74
  s_mov_b32 s17, s75
  s_mov_b32 s18, 7168
  s_mov_b32 s19, 0x20000
  v_mov_b32 v155, v16
  s_add_u32 s20, s82, 25165824
  s_addc_u32 s21, s83, 0
  s_mov_b32 s22, 14680064
  s_mov_b32 s23, 0x20000
  v_lshl_add_u32 v17, v5, 3, v6
  v_lshlrev_b32 v17, 8, v17
  v_lshl_add_u32 v17, v7, 3, v17
  v_lshl_or_b32 v18, v2, 2, v6
  v_lshl_add_u32 v17, v18, 5, v17
  s_lshl_b32 s32, s46, 7
  s_add_u32 s32, s32, 16384
  v_xor_b32 v18, s32, v17
  s_lshl_b32 s32, s41, 13
  v_add_u32 v12, s32, v14
  v_xor_b32 v8, 0, v18
  v_xor_b32 v9, 32, v18
  v_xor_b32 v10, 64, v18
  v_xor_b32 v11, 96, v18
  v_bfe_u32 v19, v4, 2, 1
  v_lshlrev_b32 v17, 11, v19
  v_lshl_add_u32 v17, v3, 8, v17
  v_lshrrev_b32 v18, 3, v4
  v_lshl_add_u32 v17, v18, 6, v17
  v_lshl_add_u32 v152, v7, 4, v17
  v_add_u32 v153, 128, v152
  v_cmp_eq_u32 vcc, 1, v3
  v_lshlrev_b32 v17, 7, v19
  v_add_u32 v18, 640, v17
  v_lshlrev_b32 v17, 8, v19
  v_add_u32 v17, 896, v17
  v_cndmask_b32 v18, 0, v18, vcc
  v_cndmask_b32 v17, 0, v17, vcc
  v_add_u32 v154, v153, v17
  v_add_u32 v153, v153, v18
  s_lshl_b32 s32, s28, 1
  s_add_u32 s32, s32, s41
  s_mul_i32 s32, s32, 224
  s_lshl_b32 s44, s29, 2
  s_add_u32 s32, s32, s44
  s_lshl_b32 s44, s46, 1
  s_add_u32 s32, s32, s44
  s_lshl_b32 s44, s32, 12
  s_add_u32 s45, s44, 458752
  s_add_u32 s46, s44, 4096
  s_add_u32 s47, s45, 4096
  s_waitcnt vmcnt(0)
  s_barrier
  buffer_load_dwordx2 v[144:145], v155, s[16:19], 0 offen offset:0
  buffer_load_dwordx2 v[146:147], v155, s[16:19], 0 offen offset:32
  buffer_load_dwordx2 v[148:149], v155, s[16:19], 0 offen offset:64
  buffer_load_dwordx2 v[150:151], v155, s[16:19], 0 offen offset:96
  s_waitcnt vmcnt(0)
  v_lshlrev_b32 v80, 16, v144
  v_and_b32 v81, 0xffff0000, v144
  v_lshlrev_b32 v82, 16, v145
  v_and_b32 v83, 0xffff0000, v145
  v_mov_b64 v[96:97], v[80:81]
  v_mov_b64 v[98:99], v[82:83]
  v_mov_b64 v[112:113], v[80:81]
  v_mov_b64 v[114:115], v[82:83]
  v_mov_b64 v[128:129], v[80:81]
  v_mov_b64 v[130:131], v[82:83]
  v_lshlrev_b32 v84, 16, v146
  v_and_b32 v85, 0xffff0000, v146
  v_lshlrev_b32 v86, 16, v147
  v_and_b32 v87, 0xffff0000, v147
  v_mov_b64 v[100:101], v[84:85]
  v_mov_b64 v[102:103], v[86:87]
  v_mov_b64 v[116:117], v[84:85]
  v_mov_b64 v[118:119], v[86:87]
  v_mov_b64 v[132:133], v[84:85]
  v_mov_b64 v[134:135], v[86:87]
  v_lshlrev_b32 v88, 16, v148
  v_and_b32 v89, 0xffff0000, v148
  v_lshlrev_b32 v90, 16, v149
  v_and_b32 v91, 0xffff0000, v149
  v_mov_b64 v[104:105], v[88:89]
  v_mov_b64 v[106:107], v[90:91]
  v_mov_b64 v[120:121], v[88:89]
  v_mov_b64 v[122:123], v[90:91]
  v_mov_b64 v[136:137], v[88:89]
  v_mov_b64 v[138:139], v[90:91]
  v_lshlrev_b32 v92, 16, v150
  v_and_b32 v93, 0xffff0000, v150
  v_lshlrev_b32 v94, 16, v151
  v_and_b32 v95, 0xffff0000, v151
  v_mov_b64 v[108:109], v[92:93]
  v_mov_b64 v[110:111], v[94:95]
  v_mov_b64 v[124:125], v[92:93]
  v_mov_b64 v[126:127], v[94:95]
  v_mov_b64 v[140:141], v[92:93]
  v_mov_b64 v[142:143], v[94:95]
  s_barrier
  s_mov_b32 s43, 0
  s_mov_b32 s39, 15
  s_add_u32 s40, s43, 32768
  s_cmp_eq_u32 s40, 163840
  s_cselect_b32 s40, 0, s40
  s_sub_u32 s42, s40, s43
  s_mov_b32 s43, s40
  s_barrier
  ds_read_b64_tr_b16 v[16:17], v8 offset:0
  ds_read_b64_tr_b16 v[18:19], v8 offset:1024
  ds_read_b128 v[32:35], v12 offset:0
  ds_read_b64_tr_b16 v[48:49], v8 offset:8192
  ds_read_b64_tr_b16 v[50:51], v8 offset:9216
  ds_read_b128 v[64:67], v12 offset:1024
  ds_read_b128 v[68:71], v12 offset:3072
  ds_read_b128 v[36:39], v12 offset:2048
  ds_read_b64_tr_b16 v[20:21], v9 offset:0
  ds_read_b64_tr_b16 v[22:23], v9 offset:1024
  ds_read_b64_tr_b16 v[52:53], v9 offset:8192
  ds_read_b64_tr_b16 v[54:55], v9 offset:9216
  ds_read_b64_tr_b16 v[24:25], v10 offset:0
  ds_read_b64_tr_b16 v[26:27], v10 offset:1024
  ds_read_b64_tr_b16 v[56:57], v10 offset:8192
  ds_read_b64_tr_b16 v[58:59], v10 offset:9216
  ds_read_b128 v[40:43], v12 offset:4096
  ds_read_b128 v[72:75], v12 offset:5120
  ds_read_b128 v[76:79], v12 offset:7168
  ds_read_b128 v[44:47], v12 offset:6144
  ds_read_b64_tr_b16 v[28:29], v11 offset:0
  ds_read_b64_tr_b16 v[30:31], v11 offset:1024
  ds_read_b64_tr_b16 v[60:61], v11 offset:8192
  ds_read_b64_tr_b16 v[62:63], v11 offset:9216
  v_add_u32 v8, s42, v8
  v_add_u32 v9, s42, v9
  v_add_u32 v10, s42, v10
  v_add_u32 v11, s42, v11
  v_add_u32 v12, s42, v12
cf4:
  s_barrier
  s_waitcnt lgkmcnt(14)
  v_mfma_f32_16x16x32_bf16 v[80:83], v[16:19], v[32:35], v[80:83]
  ds_read_b64_tr_b16 v[156:157], v8 offset:0
  s_add_u32 s40, s43, 32768
  s_cmp_eq_u32 s40, 163840
  v_mfma_f32_16x16x32_bf16 v[80:83], v[48:51], v[64:67], v[80:83]
  ds_read_b64_tr_b16 v[158:159], v8 offset:1024
  s_cselect_b32 s40, 0, s40
  s_sub_u32 s42, s40, s43
  v_mfma_f32_16x16x32_bf16 v[96:99], v[48:51], v[68:71], v[96:99]
  ds_read_b128 v[172:175], v12 offset:0
  s_mov_b32 s43, s40
  v_mfma_f32_16x16x32_bf16 v[96:99], v[16:19], v[36:39], v[96:99]
  ds_read_b64_tr_b16 v[188:189], v8 offset:8192
  v_mfma_f32_16x16x32_bf16 v[100:103], v[20:23], v[36:39], v[100:103]
  ds_read_b64_tr_b16 v[190:191], v8 offset:9216
  v_add_u32 v8, s42, v8
  s_waitcnt lgkmcnt(14)
  v_mfma_f32_16x16x32_bf16 v[100:103], v[52:55], v[68:71], v[100:103]
  ds_read_b128 v[204:207], v12 offset:1024
  v_mfma_f32_16x16x32_bf16 v[84:87], v[52:55], v[64:67], v[84:87]
  ds_read_b128 v[208:211], v12 offset:3072
  v_mfma_f32_16x16x32_bf16 v[84:87], v[20:23], v[32:35], v[84:87]
  ds_read_b128 v[176:179], v12 offset:2048
  v_mfma_f32_16x16x32_bf16 v[88:91], v[24:27], v[32:35], v[88:91]
  ds_read_b64_tr_b16 v[160:161], v9 offset:0
  s_waitcnt lgkmcnt(14)
  v_mfma_f32_16x16x32_bf16 v[88:91], v[56:59], v[64:67], v[88:91]
  ds_read_b64_tr_b16 v[162:163], v9 offset:1024
  v_mfma_f32_16x16x32_bf16 v[104:107], v[56:59], v[68:71], v[104:107]
  ds_read_b64_tr_b16 v[192:193], v9 offset:8192
  v_mfma_f32_16x16x32_bf16 v[104:107], v[24:27], v[36:39], v[104:107]
  ds_read_b64_tr_b16 v[194:195], v9 offset:9216
  v_add_u32 v9, s42, v9
  v_mfma_f32_16x16x32_bf16 v[120:123], v[24:27], v[40:43], v[120:123]
  ds_read_b64_tr_b16 v[164:165], v10 offset:0
  v_mfma_f32_16x16x32_bf16 v[120:123], v[56:59], v[72:75], v[120:123]
  ds_read_b64_tr_b16 v[166:167], v10 offset:1024
  v_mfma_f32_16x16x32_bf16 v[116:119], v[52:55], v[72:75], v[116:119]
  ds_read_b64_tr_b16 v[196:197], v10 offset:8192
  v_mfma_f32_16x16x32_bf16 v[116:119], v[20:23], v[40:43], v[116:119]
  ds_read_b64_tr_b16 v[198:199], v10 offset:9216
  v_add_u32 v10, s42, v10
  v_mfma_f32_16x16x32_bf16 v[112:115], v[16:19], v[40:43], v[112:115]
  ds_read_b128 v[180:183], v12 offset:4096
  v_mfma_f32_16x16x32_bf16 v[112:115], v[48:51], v[72:75], v[112:115]
  ds_read_b128 v[212:215], v12 offset:5120
  v_mfma_f32_16x16x32_bf16 v[128:131], v[48:51], v[76:79], v[128:131]
  ds_read_b128 v[216:219], v12 offset:7168
  s_waitcnt lgkmcnt(14)
  v_mfma_f32_16x16x32_bf16 v[128:131], v[16:19], v[44:47], v[128:131]
  ds_read_b128 v[184:187], v12 offset:6144
  v_add_u32 v12, s42, v12
  v_mfma_f32_16x16x32_bf16 v[132:135], v[20:23], v[44:47], v[132:135]
  ds_read_b64_tr_b16 v[168:169], v11 offset:0
  v_mfma_f32_16x16x32_bf16 v[132:135], v[52:55], v[76:79], v[132:135]
  ds_read_b64_tr_b16 v[170:171], v11 offset:1024
  v_mfma_f32_16x16x32_bf16 v[136:139], v[56:59], v[76:79], v[136:139]
  ds_read_b64_tr_b16 v[200:201], v11 offset:8192
  v_mfma_f32_16x16x32_bf16 v[136:139], v[24:27], v[44:47], v[136:139]
  ds_read_b64_tr_b16 v[202:203], v11 offset:9216
  v_add_u32 v11, s42, v11
  v_mfma_f32_16x16x32_bf16 v[140:143], v[28:31], v[44:47], v[140:143]
  v_mfma_f32_16x16x32_bf16 v[140:143], v[60:63], v[76:79], v[140:143]
  v_mfma_f32_16x16x32_bf16 v[124:127], v[60:63], v[72:75], v[124:127]
  v_mfma_f32_16x16x32_bf16 v[124:127], v[28:31], v[40:43], v[124:127]
  v_mfma_f32_16x16x32_bf16 v[108:111], v[28:31], v[36:39], v[108:111]
  v_mfma_f32_16x16x32_bf16 v[108:111], v[60:63], v[68:71], v[108:111]
  v_mfma_f32_16x16x32_bf16 v[92:95], v[60:63], v[64:67], v[92:95]
  v_mfma_f32_16x16x32_bf16 v[92:95], v[28:31], v[32:35], v[92:95]
  s_barrier
  s_waitcnt lgkmcnt(14)
  v_mfma_f32_16x16x32_bf16 v[80:83], v[156:159], v[172:175], v[80:83]
  ds_read_b64_tr_b16 v[16:17], v8 offset:0
  s_add_u32 s40, s43, 32768
  s_cmp_eq_u32 s40, 163840
  v_mfma_f32_16x16x32_bf16 v[80:83], v[188:191], v[204:207], v[80:83]
  ds_read_b64_tr_b16 v[18:19], v8 offset:1024
  s_cselect_b32 s40, 0, s40
  s_sub_u32 s42, s40, s43
  v_mfma_f32_16x16x32_bf16 v[96:99], v[188:191], v[208:211], v[96:99]
  ds_read_b128 v[32:35], v12 offset:0
  s_mov_b32 s43, s40
  v_mfma_f32_16x16x32_bf16 v[96:99], v[156:159], v[176:179], v[96:99]
  ds_read_b64_tr_b16 v[48:49], v8 offset:8192
  v_mfma_f32_16x16x32_bf16 v[100:103], v[160:163], v[176:179], v[100:103]
  ds_read_b64_tr_b16 v[50:51], v8 offset:9216
  v_add_u32 v8, s42, v8
  s_waitcnt lgkmcnt(14)
  v_mfma_f32_16x16x32_bf16 v[100:103], v[192:195], v[208:211], v[100:103]
  ds_read_b128 v[64:67], v12 offset:1024
  v_mfma_f32_16x16x32_bf16 v[84:87], v[192:195], v[204:207], v[84:87]
  ds_read_b128 v[68:71], v12 offset:3072
  v_mfma_f32_16x16x32_bf16 v[84:87], v[160:163], v[172:175], v[84:87]
  ds_read_b128 v[36:39], v12 offset:2048
  v_mfma_f32_16x16x32_bf16 v[88:91], v[164:167], v[172:175], v[88:91]
  ds_read_b64_tr_b16 v[20:21], v9 offset:0
  s_waitcnt lgkmcnt(14)
  v_mfma_f32_16x16x32_bf16 v[88:91], v[196:199], v[204:207], v[88:91]
  ds_read_b64_tr_b16 v[22:23], v9 offset:1024
  v_mfma_f32_16x16x32_bf16 v[104:107], v[196:199], v[208:211], v[104:107]
  ds_read_b64_tr_b16 v[52:53], v9 offset:8192
  v_mfma_f32_16x16x32_bf16 v[104:107], v[164:167], v[176:179], v[104:107]
  ds_read_b64_tr_b16 v[54:55], v9 offset:9216
  v_add_u32 v9, s42, v9
  v_mfma_f32_16x16x32_bf16 v[120:123], v[164:167], v[180:183], v[120:123]
  ds_read_b64_tr_b16 v[24:25], v10 offset:0
  v_mfma_f32_16x16x32_bf16 v[120:123], v[196:199], v[212:215], v[120:123]
  ds_read_b64_tr_b16 v[26:27], v10 offset:1024
  v_mfma_f32_16x16x32_bf16 v[116:119], v[192:195], v[212:215], v[116:119]
  ds_read_b64_tr_b16 v[56:57], v10 offset:8192
  v_mfma_f32_16x16x32_bf16 v[116:119], v[160:163], v[180:183], v[116:119]
  ds_read_b64_tr_b16 v[58:59], v10 offset:9216
  v_add_u32 v10, s42, v10
  v_mfma_f32_16x16x32_bf16 v[112:115], v[156:159], v[180:183], v[112:115]
  ds_read_b128 v[40:43], v12 offset:4096
  v_mfma_f32_16x16x32_bf16 v[112:115], v[188:191], v[212:215], v[112:115]
  ds_read_b128 v[72:75], v12 offset:5120
  v_mfma_f32_16x16x32_bf16 v[128:131], v[188:191], v[216:219], v[128:131]
  ds_read_b128 v[76:79], v12 offset:7168
  s_waitcnt lgkmcnt(14)
  v_mfma_f32_16x16x32_bf16 v[128:131], v[156:159], v[184:187], v[128:131]
  ds_read_b128 v[44:47], v12 offset:6144
  v_add_u32 v12, s42, v12
  v_mfma_f32_16x16x32_bf16 v[132:135], v[160:163], v[184:187], v[132:135]
  ds_read_b64_tr_b16 v[28:29], v11 offset:0
  v_mfma_f32_16x16x32_bf16 v[132:135], v[192:195], v[216:219], v[132:135]
  ds_read_b64_tr_b16 v[30:31], v11 offset:1024
  v_mfma_f32_16x16x32_bf16 v[136:139], v[196:199], v[216:219], v[136:139]
  ds_read_b64_tr_b16 v[60:61], v11 offset:8192
  v_mfma_f32_16x16x32_bf16 v[136:139], v[164:167], v[184:187], v[136:139]
  ds_read_b64_tr_b16 v[62:63], v11 offset:9216
  v_add_u32 v11, s42, v11
  v_mfma_f32_16x16x32_bf16 v[140:143], v[168:171], v[184:187], v[140:143]
  v_mfma_f32_16x16x32_bf16 v[140:143], v[200:203], v[216:219], v[140:143]
  v_mfma_f32_16x16x32_bf16 v[124:127], v[200:203], v[212:215], v[124:127]
  v_mfma_f32_16x16x32_bf16 v[124:127], v[168:171], v[180:183], v[124:127]
  v_mfma_f32_16x16x32_bf16 v[108:111], v[168:171], v[176:179], v[108:111]
  v_mfma_f32_16x16x32_bf16 v[108:111], v[200:203], v[208:211], v[108:111]
  v_mfma_f32_16x16x32_bf16 v[92:95], v[200:203], v[204:207], v[92:95]
  v_mfma_f32_16x16x32_bf16 v[92:95], v[168:171], v[172:175], v[92:95]
  s_sub_u32 s39, s39, 1
  s_cmp_lg_u32 s39, 0
  s_cbranch_scc1 cf4
  s_barrier
  s_waitcnt lgkmcnt(14)
  v_mfma_f32_16x16x32_bf16 v[80:83], v[16:19], v[32:35], v[80:83]
  ds_read_b64_tr_b16 v[156:157], v8 offset:0
  s_add_u32 s40, s43, 32768
  s_cmp_eq_u32 s40, 163840
  v_mfma_f32_16x16x32_bf16 v[80:83], v[48:51], v[64:67], v[80:83]
  ds_read_b64_tr_b16 v[158:159], v8 offset:1024
  s_cselect_b32 s40, 0, s40
  s_sub_u32 s42, s40, s43
  v_mfma_f32_16x16x32_bf16 v[96:99], v[48:51], v[68:71], v[96:99]
  ds_read_b128 v[172:175], v12 offset:0
  s_mov_b32 s43, s40
  v_mfma_f32_16x16x32_bf16 v[96:99], v[16:19], v[36:39], v[96:99]
  ds_read_b64_tr_b16 v[188:189], v8 offset:8192
  v_mfma_f32_16x16x32_bf16 v[100:103], v[20:23], v[36:39], v[100:103]
  ds_read_b64_tr_b16 v[190:191], v8 offset:9216
  v_add_u32 v8, s42, v8
  s_waitcnt lgkmcnt(14)
  v_mfma_f32_16x16x32_bf16 v[100:103], v[52:55], v[68:71], v[100:103]
  ds_read_b128 v[204:207], v12 offset:1024
  v_mfma_f32_16x16x32_bf16 v[84:87], v[52:55], v[64:67], v[84:87]
  ds_read_b128 v[208:211], v12 offset:3072
  v_mfma_f32_16x16x32_bf16 v[84:87], v[20:23], v[32:35], v[84:87]
  ds_read_b128 v[176:179], v12 offset:2048
  v_mfma_f32_16x16x32_bf16 v[88:91], v[24:27], v[32:35], v[88:91]
  ds_read_b64_tr_b16 v[160:161], v9 offset:0
  s_waitcnt lgkmcnt(14)
  v_mfma_f32_16x16x32_bf16 v[88:91], v[56:59], v[64:67], v[88:91]
  ds_read_b64_tr_b16 v[162:163], v9 offset:1024
  v_mfma_f32_16x16x32_bf16 v[104:107], v[56:59], v[68:71], v[104:107]
  ds_read_b64_tr_b16 v[192:193], v9 offset:8192
  v_mfma_f32_16x16x32_bf16 v[104:107], v[24:27], v[36:39], v[104:107]
  ds_read_b64_tr_b16 v[194:195], v9 offset:9216
  v_add_u32 v9, s42, v9
  v_mfma_f32_16x16x32_bf16 v[120:123], v[24:27], v[40:43], v[120:123]
  ds_read_b64_tr_b16 v[164:165], v10 offset:0
  v_mfma_f32_16x16x32_bf16 v[120:123], v[56:59], v[72:75], v[120:123]
  ds_read_b64_tr_b16 v[166:167], v10 offset:1024
  v_mfma_f32_16x16x32_bf16 v[116:119], v[52:55], v[72:75], v[116:119]
  ds_read_b64_tr_b16 v[196:197], v10 offset:8192
  v_mfma_f32_16x16x32_bf16 v[116:119], v[20:23], v[40:43], v[116:119]
  ds_read_b64_tr_b16 v[198:199], v10 offset:9216
  v_add_u32 v10, s42, v10
  v_mfma_f32_16x16x32_bf16 v[112:115], v[16:19], v[40:43], v[112:115]
  ds_read_b128 v[180:183], v12 offset:4096
  v_mfma_f32_16x16x32_bf16 v[112:115], v[48:51], v[72:75], v[112:115]
  ds_read_b128 v[212:215], v12 offset:5120
  v_mfma_f32_16x16x32_bf16 v[128:131], v[48:51], v[76:79], v[128:131]
  ds_read_b128 v[216:219], v12 offset:7168
  s_waitcnt lgkmcnt(14)
  v_mfma_f32_16x16x32_bf16 v[128:131], v[16:19], v[44:47], v[128:131]
  ds_read_b128 v[184:187], v12 offset:6144
  v_add_u32 v12, s42, v12
  v_mfma_f32_16x16x32_bf16 v[132:135], v[20:23], v[44:47], v[132:135]
  ds_read_b64_tr_b16 v[168:169], v11 offset:0
  v_mfma_f32_16x16x32_bf16 v[132:135], v[52:55], v[76:79], v[132:135]
  ds_read_b64_tr_b16 v[170:171], v11 offset:1024
  v_mfma_f32_16x16x32_bf16 v[136:139], v[56:59], v[76:79], v[136:139]
  ds_read_b64_tr_b16 v[200:201], v11 offset:8192
  v_mfma_f32_16x16x32_bf16 v[136:139], v[24:27], v[44:47], v[136:139]
  ds_read_b64_tr_b16 v[202:203], v11 offset:9216
  v_add_u32 v11, s42, v11
  v_mfma_f32_16x16x32_bf16 v[140:143], v[28:31], v[44:47], v[140:143]
  v_mfma_f32_16x16x32_bf16 v[140:143], v[60:63], v[76:79], v[140:143]
  v_mfma_f32_16x16x32_bf16 v[124:127], v[60:63], v[72:75], v[124:127]
  v_mfma_f32_16x16x32_bf16 v[124:127], v[28:31], v[40:43], v[124:127]
  v_mfma_f32_16x16x32_bf16 v[108:111], v[28:31], v[36:39], v[108:111]
  v_mfma_f32_16x16x32_bf16 v[108:111], v[60:63], v[68:71], v[108:111]
  v_mfma_f32_16x16x32_bf16 v[92:95], v[60:63], v[64:67], v[92:95]
  v_mfma_f32_16x16x32_bf16 v[92:95], v[28:31], v[32:35], v[92:95]
  s_waitcnt lgkmcnt(14)
  v_mfma_f32_16x16x32_bf16 v[80:83], v[156:159], v[172:175], v[80:83]
  v_mfma_f32_16x16x32_bf16 v[80:83], v[188:191], v[204:207], v[80:83]
  v_mfma_f32_16x16x32_bf16 v[96:99], v[188:191], v[208:211], v[96:99]
  v_mfma_f32_16x16x32_bf16 v[96:99], v[156:159], v[176:179], v[96:99]
  v_mfma_f32_16x16x32_bf16 v[100:103], v[160:163], v[176:179], v[100:103]
  s_waitcnt lgkmcnt(12)
  v_mfma_f32_16x16x32_bf16 v[100:103], v[192:195], v[208:211], v[100:103]
  v_mfma_f32_16x16x32_bf16 v[84:87], v[192:195], v[204:207], v[84:87]
  v_mfma_f32_16x16x32_bf16 v[84:87], v[160:163], v[172:175], v[84:87]
  s_waitcnt lgkmcnt(10)
  v_mfma_f32_16x16x32_bf16 v[88:91], v[164:167], v[172:175], v[88:91]
  s_waitcnt lgkmcnt(8)
  v_mfma_f32_16x16x32_bf16 v[88:91], v[196:199], v[204:207], v[88:91]
  v_mfma_f32_16x16x32_bf16 v[104:107], v[196:199], v[208:211], v[104:107]
  v_mfma_f32_16x16x32_bf16 v[104:107], v[164:167], v[176:179], v[104:107]
  s_waitcnt lgkmcnt(7)
  v_mfma_f32_16x16x32_bf16 v[120:123], v[164:167], v[180:183], v[120:123]
  s_waitcnt lgkmcnt(6)
  v_mfma_f32_16x16x32_bf16 v[120:123], v[196:199], v[212:215], v[120:123]
  v_mfma_f32_16x16x32_bf16 v[116:119], v[192:195], v[212:215], v[116:119]
  v_mfma_f32_16x16x32_bf16 v[116:119], v[160:163], v[180:183], v[116:119]
  v_mfma_f32_16x16x32_bf16 v[112:115], v[156:159], v[180:183], v[112:115]
  v_mfma_f32_16x16x32_bf16 v[112:115], v[188:191], v[212:215], v[112:115]
  s_waitcnt lgkmcnt(5)
  v_mfma_f32_16x16x32_bf16 v[128:131], v[188:191], v[216:219], v[128:131]
  s_waitcnt lgkmcnt(4)
  v_mfma_f32_16x16x32_bf16 v[128:131], v[156:159], v[184:187], v[128:131]
  v_mfma_f32_16x16x32_bf16 v[132:135], v[160:163], v[184:187], v[132:135]
  v_mfma_f32_16x16x32_bf16 v[132:135], v[192:195], v[216:219], v[132:135]
  v_mfma_f32_16x16x32_bf16 v[136:139], v[196:199], v[216:219], v[136:139]
  v_mfma_f32_16x16x32_bf16 v[136:139], v[164:167], v[184:187], v[136:139]
  s_waitcnt lgkmcnt(2)
  v_mfma_f32_16x16x32_bf16 v[140:143], v[168:171], v[184:187], v[140:143]
  s_waitcnt lgkmcnt(0)
  v_mfma_f32_16x16x32_bf16 v[140:143], v[200:203], v[216:219], v[140:143]
  v_mfma_f32_16x16x32_bf16 v[124:127], v[200:203], v[212:215], v[124:127]
  v_mfma_f32_16x16x32_bf16 v[124:127], v[168:171], v[180:183], v[124:127]
  v_mfma_f32_16x16x32_bf16 v[108:111], v[168:171], v[176:179], v[108:111]
  v_mfma_f32_16x16x32_bf16 v[108:111], v[200:203], v[208:211], v[108:111]
  v_mfma_f32_16x16x32_bf16 v[92:95], v[200:203], v[204:207], v[92:95]
  v_mfma_f32_16x16x32_bf16 v[92:95], v[168:171], v[172:175], v[92:95]
  s_waitcnt lgkmcnt(0)
  v_mov_b32 v16, 0xc0135761
  v_mov_b32 v17, 0xbdd2d3e8
  v_pk_mul_f32 v[24:25], v[80:81], v[80:81]
  v_pk_mul_f32 v[26:27], v[82:83], v[82:83]
  v_pk_mul_f32 v[28:29], v[84:85], v[84:85]
  v_pk_mul_f32 v[30:31], v[86:87], v[86:87]
  v_pk_fma_f32 v[24:25], v[24:25], v[16:17], v[16:17] op_sel:[0,1,0] op_sel_hi:[1,1,0]
  v_pk_fma_f32 v[26:27], v[26:27], v[16:17], v[16:17] op_sel:[0,1,0] op_sel_hi:[1,1,0]
  v_pk_fma_f32 v[28:29], v[28:29], v[16:17], v[16:17] op_sel:[0,1,0] op_sel_hi:[1,1,0]
  v_pk_fma_f32 v[30:31], v[30:31], v[16:17], v[16:17] op_sel:[0,1,0] op_sel_hi:[1,1,0]
  v_pk_mul_f32 v[24:25], v[24:25], v[80:81]
  v_pk_mul_f32 v[26:27], v[26:27], v[82:83]
  v_pk_mul_f32 v[28:29], v[28:29], v[84:85]
  v_pk_mul_f32 v[30:31], v[30:31], v[86:87]
  v_exp_f32 v24, v24
  v_exp_f32 v25, v25
  v_exp_f32 v26, v26
  v_exp_f32 v27, v27
  v_exp_f32 v28, v28
  v_exp_f32 v29, v29
  v_exp_f32 v30, v30
  v_exp_f32 v31, v31
  v_pk_add_f32 v[24:25], v[24:25], 1.0 op_sel_hi:[1,0]
  v_pk_add_f32 v[26:27], v[26:27], 1.0 op_sel_hi:[1,0]
  v_pk_add_f32 v[28:29], v[28:29], 1.0 op_sel_hi:[1,0]
  v_pk_add_f32 v[30:31], v[30:31], 1.0 op_sel_hi:[1,0]
  v_rcp_f32 v24, v24
  v_rcp_f32 v25, v25
  v_rcp_f32 v26, v26
  v_rcp_f32 v27, v27
  v_rcp_f32 v28, v28
  v_rcp_f32 v29, v29
  v_rcp_f32 v30, v30
  v_rcp_f32 v31, v31
  v_pk_mul_f32 v[24:25], v[24:25], v[80:81]
  v_pk_mul_f32 v[26:27], v[26:27], v[82:83]
  v_pk_mul_f32 v[28:29], v[28:29], v[84:85]
  v_pk_mul_f32 v[30:31], v[30:31], v[86:87]
  v_cvt_pk_bf16_f32 v164, v24, v25
  v_cvt_pk_bf16_f32 v165, v26, v27
  v_cvt_pk_bf16_f32 v166, v28, v29
  v_cvt_pk_bf16_f32 v167, v30, v31
  s_nop 0
  v_permlane16_swap_b32 v164, v166
  v_permlane16_swap_b32 v165, v167
  buffer_store_dwordx4 v[164:167], v152, s[20:23], s44 offen sc0 sc1
  v_pk_mul_f32 v[40:41], v[88:89], v[88:89]
  v_pk_mul_f32 v[42:43], v[90:91], v[90:91]
  v_pk_mul_f32 v[44:45], v[92:93], v[92:93]
  v_pk_mul_f32 v[46:47], v[94:95], v[94:95]
  v_pk_fma_f32 v[40:41], v[40:41], v[16:17], v[16:17] op_sel:[0,1,0] op_sel_hi:[1,1,0]
  v_pk_fma_f32 v[42:43], v[42:43], v[16:17], v[16:17] op_sel:[0,1,0] op_sel_hi:[1,1,0]
  v_pk_fma_f32 v[44:45], v[44:45], v[16:17], v[16:17] op_sel:[0,1,0] op_sel_hi:[1,1,0]
  v_pk_fma_f32 v[46:47], v[46:47], v[16:17], v[16:17] op_sel:[0,1,0] op_sel_hi:[1,1,0]
  v_pk_mul_f32 v[40:41], v[40:41], v[88:89]
  v_pk_mul_f32 v[42:43], v[42:43], v[90:91]
  v_pk_mul_f32 v[44:45], v[44:45], v[92:93]
  v_pk_mul_f32 v[46:47], v[46:47], v[94:95]
  v_exp_f32 v40, v40
  v_exp_f32 v41, v41
  v_exp_f32 v42, v42
  v_exp_f32 v43, v43
  v_exp_f32 v44, v44
  v_exp_f32 v45, v45
  v_exp_f32 v46, v46
  v_exp_f32 v47, v47
  v_pk_add_f32 v[40:41], v[40:41], 1.0 op_sel_hi:[1,0]
  v_pk_add_f32 v[42:43], v[42:43], 1.0 op_sel_hi:[1,0]
  v_pk_add_f32 v[44:45], v[44:45], 1.0 op_sel_hi:[1,0]
  v_pk_add_f32 v[46:47], v[46:47], 1.0 op_sel_hi:[1,0]
  v_rcp_f32 v40, v40
  v_rcp_f32 v41, v41
  v_rcp_f32 v42, v42
  v_rcp_f32 v43, v43
  v_rcp_f32 v44, v44
  v_rcp_f32 v45, v45
  v_rcp_f32 v46, v46
  v_rcp_f32 v47, v47
  v_pk_mul_f32 v[40:41], v[40:41], v[88:89]
  v_pk_mul_f32 v[42:43], v[42:43], v[90:91]
  v_pk_mul_f32 v[44:45], v[44:45], v[92:93]
  v_pk_mul_f32 v[46:47], v[46:47], v[94:95]
  v_cvt_pk_bf16_f32 v168, v40, v41
  v_cvt_pk_bf16_f32 v169, v42, v43
  v_cvt_pk_bf16_f32 v170, v44, v45
  v_cvt_pk_bf16_f32 v171, v46, v47
  s_nop 0
  v_permlane16_swap_b32 v168, v170
  v_permlane16_swap_b32 v169, v171
  buffer_store_dwordx4 v[168:171], v152, s[20:23], s46 offen sc0 sc1
  v_pk_mul_f32 v[24:25], v[96:97], v[96:97]
  v_pk_mul_f32 v[26:27], v[98:99], v[98:99]
  v_pk_mul_f32 v[28:29], v[100:101], v[100:101]
  v_pk_mul_f32 v[30:31], v[102:103], v[102:103]
  v_pk_fma_f32 v[24:25], v[24:25], v[16:17], v[16:17] op_sel:[0,1,0] op_sel_hi:[1,1,0]
  v_pk_fma_f32 v[26:27], v[26:27], v[16:17], v[16:17] op_sel:[0,1,0] op_sel_hi:[1,1,0]
  v_pk_fma_f32 v[28:29], v[28:29], v[16:17], v[16:17] op_sel:[0,1,0] op_sel_hi:[1,1,0]
  v_pk_fma_f32 v[30:31], v[30:31], v[16:17], v[16:17] op_sel:[0,1,0] op_sel_hi:[1,1,0]
  v_pk_mul_f32 v[24:25], v[24:25], v[96:97]
  v_pk_mul_f32 v[26:27], v[26:27], v[98:99]
  v_pk_mul_f32 v[28:29], v[28:29], v[100:101]
  v_pk_mul_f32 v[30:31], v[30:31], v[102:103]
  v_exp_f32 v24, v24
  v_exp_f32 v25, v25
  v_exp_f32 v26, v26
  v_exp_f32 v27, v27
  v_exp_f32 v28, v28
  v_exp_f32 v29, v29
  v_exp_f32 v30, v30
  v_exp_f32 v31, v31
  v_pk_add_f32 v[24:25], v[24:25], 1.0 op_sel_hi:[1,0]
  v_pk_add_f32 v[26:27], v[26:27], 1.0 op_sel_hi:[1,0]
  v_pk_add_f32 v[28:29], v[28:29], 1.0 op_sel_hi:[1,0]
  v_pk_add_f32 v[30:31], v[30:31], 1.0 op_sel_hi:[1,0]
  v_rcp_f32 v24, v24
  v_rcp_f32 v25, v25
  v_rcp_f32 v26, v26
  v_rcp_f32 v27, v27
  v_rcp_f32 v28, v28
  v_rcp_f32 v29, v29
  v_rcp_f32 v30, v30
  v_rcp_f32 v31, v31
  v_pk_mul_f32 v[24:25], v[24:25], v[96:97]
  v_pk_mul_f32 v[26:27], v[26:27], v[98:99]
  v_pk_mul_f32 v[28:29], v[28:29], v[100:101]
  v_pk_mul_f32 v[30:31], v[30:31], v[102:103]
  v_cvt_pk_bf16_f32 v172, v24, v25
  v_cvt_pk_bf16_f32 v173, v26, v27
  v_cvt_pk_bf16_f32 v174, v28, v29
  v_cvt_pk_bf16_f32 v175, v30, v31
  s_nop 0
  v_permlane16_swap_b32 v172, v174
  v_permlane16_swap_b32 v173, v175
  buffer_store_dwordx4 v[172:175], v153, s[20:23], s44 offen sc0 sc1
  v_pk_mul_f32 v[40:41], v[104:105], v[104:105]
  v_pk_mul_f32 v[42:43], v[106:107], v[106:107]
  v_pk_mul_f32 v[44:45], v[108:109], v[108:109]
  v_pk_mul_f32 v[46:47], v[110:111], v[110:111]
  v_pk_fma_f32 v[40:41], v[40:41], v[16:17], v[16:17] op_sel:[0,1,0] op_sel_hi:[1,1,0]
  v_pk_fma_f32 v[42:43], v[42:43], v[16:17], v[16:17] op_sel:[0,1,0] op_sel_hi:[1,1,0]
  v_pk_fma_f32 v[44:45], v[44:45], v[16:17], v[16:17] op_sel:[0,1,0] op_sel_hi:[1,1,0]
  v_pk_fma_f32 v[46:47], v[46:47], v[16:17], v[16:17] op_sel:[0,1,0] op_sel_hi:[1,1,0]
  v_pk_mul_f32 v[40:41], v[40:41], v[104:105]
  v_pk_mul_f32 v[42:43], v[42:43], v[106:107]
  v_pk_mul_f32 v[44:45], v[44:45], v[108:109]
  v_pk_mul_f32 v[46:47], v[46:47], v[110:111]
  v_exp_f32 v40, v40
  v_exp_f32 v41, v41
  v_exp_f32 v42, v42
  v_exp_f32 v43, v43
  v_exp_f32 v44, v44
  v_exp_f32 v45, v45
  v_exp_f32 v46, v46
  v_exp_f32 v47, v47
  v_pk_add_f32 v[40:41], v[40:41], 1.0 op_sel_hi:[1,0]
  v_pk_add_f32 v[42:43], v[42:43], 1.0 op_sel_hi:[1,0]
  v_pk_add_f32 v[44:45], v[44:45], 1.0 op_sel_hi:[1,0]
  v_pk_add_f32 v[46:47], v[46:47], 1.0 op_sel_hi:[1,0]
  v_rcp_f32 v40, v40
  v_rcp_f32 v41, v41
  v_rcp_f32 v42, v42
  v_rcp_f32 v43, v43
  v_rcp_f32 v44, v44
  v_rcp_f32 v45, v45
  v_rcp_f32 v46, v46
  v_rcp_f32 v47, v47
  v_pk_mul_f32 v[40:41], v[40:41], v[104:105]
  v_pk_mul_f32 v[42:43], v[42:43], v[106:107]
  v_pk_mul_f32 v[44:45], v[44:45], v[108:109]
  v_pk_mul_f32 v[46:47], v[46:47], v[110:111]
  v_cvt_pk_bf16_f32 v176, v40, v41
  v_cvt_pk_bf16_f32 v177, v42, v43
  v_cvt_pk_bf16_f32 v178, v44, v45
  v_cvt_pk_bf16_f32 v179, v46, v47
  s_nop 0
  v_permlane16_swap_b32 v176, v178
  v_permlane16_swap_b32 v177, v179
  buffer_store_dwordx4 v[176:179], v153, s[20:23], s46 offen sc0 sc1
  v_pk_mul_f32 v[24:25], v[112:113], v[112:113]
  v_pk_mul_f32 v[26:27], v[114:115], v[114:115]
  v_pk_mul_f32 v[28:29], v[116:117], v[116:117]
  v_pk_mul_f32 v[30:31], v[118:119], v[118:119]
  v_pk_fma_f32 v[24:25], v[24:25], v[16:17], v[16:17] op_sel:[0,1,0] op_sel_hi:[1,1,0]
  v_pk_fma_f32 v[26:27], v[26:27], v[16:17], v[16:17] op_sel:[0,1,0] op_sel_hi:[1,1,0]
  v_pk_fma_f32 v[28:29], v[28:29], v[16:17], v[16:17] op_sel:[0,1,0] op_sel_hi:[1,1,0]
  v_pk_fma_f32 v[30:31], v[30:31], v[16:17], v[16:17] op_sel:[0,1,0] op_sel_hi:[1,1,0]
  v_pk_mul_f32 v[24:25], v[24:25], v[112:113]
  v_pk_mul_f32 v[26:27], v[26:27], v[114:115]
  v_pk_mul_f32 v[28:29], v[28:29], v[116:117]
  v_pk_mul_f32 v[30:31], v[30:31], v[118:119]
  v_exp_f32 v24, v24
  v_exp_f32 v25, v25
  v_exp_f32 v26, v26
  v_exp_f32 v27, v27
  v_exp_f32 v28, v28
  v_exp_f32 v29, v29
  v_exp_f32 v30, v30
  v_exp_f32 v31, v31
  v_pk_add_f32 v[24:25], v[24:25], 1.0 op_sel_hi:[1,0]
  v_pk_add_f32 v[26:27], v[26:27], 1.0 op_sel_hi:[1,0]
  v_pk_add_f32 v[28:29], v[28:29], 1.0 op_sel_hi:[1,0]
  v_pk_add_f32 v[30:31], v[30:31], 1.0 op_sel_hi:[1,0]
  v_rcp_f32 v24, v24
  v_rcp_f32 v25, v25
  v_rcp_f32 v26, v26
  v_rcp_f32 v27, v27
  v_rcp_f32 v28, v28
  v_rcp_f32 v29, v29
  v_rcp_f32 v30, v30
  v_rcp_f32 v31, v31
  v_pk_mul_f32 v[24:25], v[24:25], v[112:113]
  v_pk_mul_f32 v[26:27], v[26:27], v[114:115]
  v_pk_mul_f32 v[28:29], v[28:29], v[116:117]
  v_pk_mul_f32 v[30:31], v[30:31], v[118:119]
  v_cvt_pk_bf16_f32 v180, v24, v25
  v_cvt_pk_bf16_f32 v181, v26, v27
  v_cvt_pk_bf16_f32 v182, v28, v29
  v_cvt_pk_bf16_f32 v183, v30, v31
  s_nop 0
  v_permlane16_swap_b32 v180, v182
  v_permlane16_swap_b32 v181, v183
  buffer_store_dwordx4 v[180:183], v152, s[20:23], s45 offen sc0 sc1
  v_pk_mul_f32 v[40:41], v[120:121], v[120:121]
  v_pk_mul_f32 v[42:43], v[122:123], v[122:123]
  v_pk_mul_f32 v[44:45], v[124:125], v[124:125]
  v_pk_mul_f32 v[46:47], v[126:127], v[126:127]
  v_pk_fma_f32 v[40:41], v[40:41], v[16:17], v[16:17] op_sel:[0,1,0] op_sel_hi:[1,1,0]
  v_pk_fma_f32 v[42:43], v[42:43], v[16:17], v[16:17] op_sel:[0,1,0] op_sel_hi:[1,1,0]
  v_pk_fma_f32 v[44:45], v[44:45], v[16:17], v[16:17] op_sel:[0,1,0] op_sel_hi:[1,1,0]
  v_pk_fma_f32 v[46:47], v[46:47], v[16:17], v[16:17] op_sel:[0,1,0] op_sel_hi:[1,1,0]
  v_pk_mul_f32 v[40:41], v[40:41], v[120:121]
  v_pk_mul_f32 v[42:43], v[42:43], v[122:123]
  v_pk_mul_f32 v[44:45], v[44:45], v[124:125]
  v_pk_mul_f32 v[46:47], v[46:47], v[126:127]
  v_exp_f32 v40, v40
  v_exp_f32 v41, v41
  v_exp_f32 v42, v42
  v_exp_f32 v43, v43
  v_exp_f32 v44, v44
  v_exp_f32 v45, v45
  v_exp_f32 v46, v46
  v_exp_f32 v47, v47
  v_pk_add_f32 v[40:41], v[40:41], 1.0 op_sel_hi:[1,0]
  v_pk_add_f32 v[42:43], v[42:43], 1.0 op_sel_hi:[1,0]
  v_pk_add_f32 v[44:45], v[44:45], 1.0 op_sel_hi:[1,0]
  v_pk_add_f32 v[46:47], v[46:47], 1.0 op_sel_hi:[1,0]
  v_rcp_f32 v40, v40
  v_rcp_f32 v41, v41
  v_rcp_f32 v42, v42
  v_rcp_f32 v43, v43
  v_rcp_f32 v44, v44
  v_rcp_f32 v45, v45
  v_rcp_f32 v46, v46
  v_rcp_f32 v47, v47
  v_pk_mul_f32 v[40:41], v[40:41], v[120:121]
  v_pk_mul_f32 v[42:43], v[42:43], v[122:123]
  v_pk_mul_f32 v[44:45], v[44:45], v[124:125]
  v_pk_mul_f32 v[46:47], v[46:47], v[126:127]
  v_cvt_pk_bf16_f32 v184, v40, v41
  v_cvt_pk_bf16_f32 v185, v42, v43
  v_cvt_pk_bf16_f32 v186, v44, v45
  v_cvt_pk_bf16_f32 v187, v46, v47
  s_nop 0
  v_permlane16_swap_b32 v184, v186
  v_permlane16_swap_b32 v185, v187
  buffer_store_dwordx4 v[184:187], v152, s[20:23], s47 offen sc0 sc1
  v_pk_mul_f32 v[24:25], v[128:129], v[128:129]
  v_pk_mul_f32 v[26:27], v[130:131], v[130:131]
  v_pk_mul_f32 v[28:29], v[132:133], v[132:133]
  v_pk_mul_f32 v[30:31], v[134:135], v[134:135]
  v_pk_fma_f32 v[24:25], v[24:25], v[16:17], v[16:17] op_sel:[0,1,0] op_sel_hi:[1,1,0]
  v_pk_fma_f32 v[26:27], v[26:27], v[16:17], v[16:17] op_sel:[0,1,0] op_sel_hi:[1,1,0]
  v_pk_fma_f32 v[28:29], v[28:29], v[16:17], v[16:17] op_sel:[0,1,0] op_sel_hi:[1,1,0]
  v_pk_fma_f32 v[30:31], v[30:31], v[16:17], v[16:17] op_sel:[0,1,0] op_sel_hi:[1,1,0]
  v_pk_mul_f32 v[24:25], v[24:25], v[128:129]
  v_pk_mul_f32 v[26:27], v[26:27], v[130:131]
  v_pk_mul_f32 v[28:29], v[28:29], v[132:133]
  v_pk_mul_f32 v[30:31], v[30:31], v[134:135]
  v_exp_f32 v24, v24
  v_exp_f32 v25, v25
  v_exp_f32 v26, v26
  v_exp_f32 v27, v27
  v_exp_f32 v28, v28
  v_exp_f32 v29, v29
  v_exp_f32 v30, v30
  v_exp_f32 v31, v31
  v_pk_add_f32 v[24:25], v[24:25], 1.0 op_sel_hi:[1,0]
  v_pk_add_f32 v[26:27], v[26:27], 1.0 op_sel_hi:[1,0]
  v_pk_add_f32 v[28:29], v[28:29], 1.0 op_sel_hi:[1,0]
  v_pk_add_f32 v[30:31], v[30:31], 1.0 op_sel_hi:[1,0]
  v_rcp_f32 v24, v24
  v_rcp_f32 v25, v25
  v_rcp_f32 v26, v26
  v_rcp_f32 v27, v27
  v_rcp_f32 v28, v28
  v_rcp_f32 v29, v29
  v_rcp_f32 v30, v30
  v_rcp_f32 v31, v31
  v_pk_mul_f32 v[24:25], v[24:25], v[128:129]
  v_pk_mul_f32 v[26:27], v[26:27], v[130:131]
  v_pk_mul_f32 v[28:29], v[28:29], v[132:133]
  v_pk_mul_f32 v[30:31], v[30:31], v[134:135]
  v_cvt_pk_bf16_f32 v188, v24, v25
  v_cvt_pk_bf16_f32 v189, v26, v27
  v_cvt_pk_bf16_f32 v190, v28, v29
  v_cvt_pk_bf16_f32 v191, v30, v31
  s_nop 0
  v_permlane16_swap_b32 v188, v190
  v_permlane16_swap_b32 v189, v191
  buffer_store_dwordx4 v[188:191], v154, s[20:23], s45 offen sc0 sc1
  v_pk_mul_f32 v[40:41], v[136:137], v[136:137]
  v_pk_mul_f32 v[42:43], v[138:139], v[138:139]
  v_pk_mul_f32 v[44:45], v[140:141], v[140:141]
  v_pk_mul_f32 v[46:47], v[142:143], v[142:143]
  v_pk_fma_f32 v[40:41], v[40:41], v[16:17], v[16:17] op_sel:[0,1,0] op_sel_hi:[1,1,0]
  v_pk_fma_f32 v[42:43], v[42:43], v[16:17], v[16:17] op_sel:[0,1,0] op_sel_hi:[1,1,0]
  v_pk_fma_f32 v[44:45], v[44:45], v[16:17], v[16:17] op_sel:[0,1,0] op_sel_hi:[1,1,0]
  v_pk_fma_f32 v[46:47], v[46:47], v[16:17], v[16:17] op_sel:[0,1,0] op_sel_hi:[1,1,0]
  v_pk_mul_f32 v[40:41], v[40:41], v[136:137]
  v_pk_mul_f32 v[42:43], v[42:43], v[138:139]
  v_pk_mul_f32 v[44:45], v[44:45], v[140:141]
  v_pk_mul_f32 v[46:47], v[46:47], v[142:143]
  v_exp_f32 v40, v40
  v_exp_f32 v41, v41
  v_exp_f32 v42, v42
  v_exp_f32 v43, v43
  v_exp_f32 v44, v44
  v_exp_f32 v45, v45
  v_exp_f32 v46, v46
  v_exp_f32 v47, v47
  v_pk_add_f32 v[40:41], v[40:41], 1.0 op_sel_hi:[1,0]
  v_pk_add_f32 v[42:43], v[42:43], 1.0 op_sel_hi:[1,0]
  v_pk_add_f32 v[44:45], v[44:45], 1.0 op_sel_hi:[1,0]
  v_pk_add_f32 v[46:47], v[46:47], 1.0 op_sel_hi:[1,0]
  v_rcp_f32 v40, v40
  v_rcp_f32 v41, v41
  v_rcp_f32 v42, v42
  v_rcp_f32 v43, v43
  v_rcp_f32 v44, v44
  v_rcp_f32 v45, v45
  v_rcp_f32 v46, v46
  v_rcp_f32 v47, v47
  v_pk_mul_f32 v[40:41], v[40:41], v[136:137]
  v_pk_mul_f32 v[42:43], v[42:43], v[138:139]
  v_pk_mul_f32 v[44:45], v[44:45], v[140:141]
  v_pk_mul_f32 v[46:47], v[46:47], v[142:143]
  v_cvt_pk_bf16_f32 v192, v40, v41
  v_cvt_pk_bf16_f32 v193, v42, v43
  v_cvt_pk_bf16_f32 v194, v44, v45
  v_cvt_pk_bf16_f32 v195, v46, v47
  s_nop 0
  v_permlane16_swap_b32 v192, v194
  v_permlane16_swap_b32 v193, v195
  buffer_store_dwordx4 v[192:195], v154, s[20:23], s47 offen sc0 sc1
C_k3skip:
  s_nop 7
  s_nop 7
  s_lshr_b32 s32, s2, 3
  s_lshr_b32 s5, s32, 3
  s_and_b32 s6, s32, 7
  s_lshl_b32 s7, s5, 1
  s_add_u32 s7, s7, s6
  s_and_b32 s7, s7, 7
  s_and_b32 s32, s2, 7
  s_lshr_b32 s28, s32, 2
  s_lshl_b32 s28, s28, 2
  s_add_u32 s28, s28, s5
  s_and_b32 s29, s32, 3
  s_mul_i32 s29, s29, 8
  s_add_u32 s29, s29, s6
  s_mov_b32 s30, 7
  s_mov_b32 s31, -1
  s_lshl_b32 s32, s29, 6
  v_add_u32 v13, s32, v4
  v_lshlrev_b32 v13, 1, v13
  s_lshl_b32 s40, s4, 4
  s_add_u32 s32, s32, s40
  v_add_u32 v16, s32, v5
  v_lshlrev_b32 v12, 11, v16
  v_lshl_add_u32 v12, v4, 4, v12
  s_lshl_b32 s32, s28, 8
  v_add_u32 v12, s32, v12
  v_lshlrev_b32 v186, 8, v16
  v_and_b32 v17, 7, v0
  v_lshl_add_u32 v186, v17, 4, v186
  v_lshrrev_b32 v17, 3, v4
  v_lshl_add_u32 v186, v17, 19, v186
  s_lshl_b32 s32, s28, 20
  v_add_u32 v186, s32, v186
  v_mul_u32_u24 v189, 272, v4
  v_lshl_add_u32 v189, v5, 4, v189
  s_lshl_b32 s32, s4, 6
  s_add_u32 s32, s32, 1024
  v_add_u32 v189, s32, v189
  v_add_u32 v16, s40, v5
  v_mul_u32_u24 v190, 272, v16
  v_lshl_add_u32 v190, v4, 4, v190
  v_add_u32 v190, 1024, v190
  s_lshl_b32 s34, s28, 2
  s_add_u32 s34, s34, s4
  s_mul_i32 s34, s34, 458752
  s_mov_b32 s45, 8192
  s_mov_b32 s46, 16384
  s_mov_b32 s47, 24576
  v_lshrrev_b32 v16, 1, v4
  v_lshlrev_b32 v16, 4, v16
  v_lshl_add_u32 v16, v3, 8, v16
  v_and_b32 v17, 1, v4
  v_lshl_add_u32 v187, v17, 11, v16
  s_and_b32 s32, s4, 1
  s_lshl_b32 s32, s32, 1
  v_add_u32 v17, s32, v17
  v_cmp_eq_u32 vcc, 3, v17
  s_nop 1
  v_addc_co_u32 v17, vcc, 5, v17, vcc
  v_lshlrev_b32 v17, 7, v17
  v_cmp_eq_u32 vcc, 1, v3
  v_add_u32 v188, 128, v187
  s_nop 0
  v_cndmask_b32 v17, 0, v17, vcc
  v_add_u32 v188, v188, v17
  s_lshl_b32 s44, s29, 6
  s_lshl_b32 s32, s28, 2
  s_add_u32 s44, s44, s32
  s_add_u32 s44, s44, s4
  s_lshl_b32 s44, s44, 12
  s_add_u32 s51, s44, 131072
  s_add_u32 s8, s82, 25165824
  s_addc_u32 s9, s83, 0
  s_mov_b32 s10, 14680064
  s_mov_b32 s11, 0x20000
  s_add_u32 s16, s82, 8388608
  s_addc_u32 s17, s83, 0
  s_mov_b32 s18, 8388608
  s_mov_b32 s19, 0x20000
  s_mov_b32 s12, s78
  s_mov_b32 s13, s79
  s_mov_b32 s14, 4096
  s_mov_b32 s15, 0x20000
  v_lshl_add_u32 v16, v5, 3, v6
  v_lshlrev_b32 v16, 7, v16
  v_lshl_add_u32 v16, v7, 3, v16
  v_lshrrev_b32 v17, 1, v6
  v_lshl_or_b32 v17, v2, 1, v17
  v_lshl_add_u32 v16, v17, 5, v16
  v_add_u32 v16, 98304, v16
  v_xor_b32 v8, 0, v16
  v_xor_b32 v9, 32, v16
  v_xor_b32 v10, 64, v16
  v_xor_b32 v11, 96, v16
  s_lshl_b32 s48, 0x303, s7
  s_lshr_b32 s48, s48, 8
  s_mov_b32 s49, s34
  s_add_u32 s50, s34, 65536
  s_add_u32 s41, s34, 458752
  s_and_b32 s40, s4, 1
  s_lshl_b32 s32, s40, 1
  s_add_u32 s32, s32, 0
  s_cmp_eq_u32 s32, 3
  s_addc_u32 s32, s32, 5
  s_lshl_b32 s32, s32, 7
  s_mov_b32 vcc_lo, 0xff000000
  s_mov_b32 vcc_hi, 0
  v_mov_b32 v88, s32
  v_cndmask_b32 v88, 0, v88, vcc
  v_lshl_add_u32 v88, v0, 4, v88
  v_add_u32 v90, 4096, v88
  s_lshl_b32 s32, s40, 1
  s_add_u32 s32, s32, 1
  s_cmp_eq_u32 s32, 3
  s_addc_u32 s32, s32, 5
  s_lshl_b32 s32, s32, 7
  s_mov_b32 vcc_lo, 0xff000000
  s_mov_b32 vcc_hi, 0
  v_mov_b32 v89, s32
  v_cndmask_b32 v89, 0, v89, vcc
  v_lshl_add_u32 v89, v0, 4, v89
  v_add_u32 v89, 2048, v89
  v_add_u32 v91, 4096, v89
  v_lshlrev_b32 v184, 3, v0
  s_lshl_b32 s32, s4, 9
  s_add_u32 s32, s32, 90112
  v_add_u32 v185, s32, v184
  s_add_u32 s24, s84, 109051904
  s_addc_u32 s25, s85, 0
  s_mov_b32 s26, 524288
  s_mov_b32 s27, 0x20000
  v_min_u32 v15, 27, v0
  s_lshl_b32 s32, s28, 5
  v_add_u32 v15, s32, v15
  v_max_i32 v15, 0, v15
  v_lshlrev_b32 v15, 7, v15
  s_lshl_b32 s55, s3, 17
  s_add_u32 s55, s55, 65536
  s_waitcnt vmcnt(0)
  s_barrier
  buffer_load_ushort v112, v13, s[12:15], 0 offen offset:0
  buffer_load_ushort v114, v13, s[12:15], 0 offen offset:32
  buffer_load_ushort v116, v13, s[12:15], 0 offen offset:64
  buffer_load_ushort v118, v13, s[12:15], 0 offen offset:96
  s_cmp_lt_u32 s2, 224
  s_cbranch_scc1 C_nopf
  s_cmp_lg_u32 s3, 0
  s_cbranch_scc1 C_nopf
  s_mov_b32 s20, s76
  s_mov_b32 s21, s77
  s_mov_b32 s22, 14680064
  s_mov_b32 s23, 0x20000
  s_sub_u32 s32, s2, 224
  s_lshl_b32 s32, s32, 2
  s_add_u32 s32, s32, s4
  s_lshl_b32 s32, s32, 13
  v_lshlrev_b32 v17, 7, v0
  s_sleep 127
  buffer_load_dword v18, v17, s[20:23], s32 offen
  s_add_u32 s32, s32, 1048576
  buffer_load_dword v18, v17, s[20:23], s32 offen
  s_add_u32 s32, s32, 1048576
  s_waitcnt vmcnt(1)
  buffer_load_dword v18, v17, s[20:23], s32 offen
  s_add_u32 s32, s32, 1048576
  s_waitcnt vmcnt(1)
  buffer_load_dword v18, v17, s[20:23], s32 offen
  s_add_u32 s32, s32, 1048576
  s_waitcnt vmcnt(1)
  buffer_load_dword v18, v17, s[20:23], s32 offen
  s_add_u32 s32, s32, 1048576
  s_waitcnt vmcnt(1)
  buffer_load_dword v18, v17, s[20:23], s32 offen
  s_add_u32 s32, s32, 1048576
  s_waitcnt vmcnt(1)
  buffer_load_dword v18, v17, s[20:23], s32 offen
  s_add_u32 s32, s32, 1048576
  s_waitcnt vmcnt(1)
  buffer_load_dword v18, v17, s[20:23], s32 offen
  s_add_u32 s32, s32, 1048576
  s_waitcnt vmcnt(1)
  buffer_load_dword v18, v17, s[20:23], s32 offen
  s_add_u32 s32, s32, 1048576
  s_waitcnt vmcnt(1)
  buffer_load_dword v18, v17, s[20:23], s32 offen
  s_add_u32 s32, s32, 1048576
  s_waitcnt vmcnt(1)
  buffer_load_dword v18, v17, s[20:23], s32 offen
  s_add_u32 s32, s32, 1048576
  s_waitcnt vmcnt(1)
  buffer_load_dword v18, v17, s[20:23], s32 offen
  s_add_u32 s32, s32, 1048576
  s_waitcnt vmcnt(1)
  buffer_load_dword v18, v17, s[20:23], s32 offen
  s_add_u32 s32, s32, 1048576
  s_waitcnt vmcnt(1)
  buffer_load_dword v18, v17, s[20:23], s32 offen
  s_add_u32 s32, s32, 1048576
  s_waitcnt vmcnt(1)
C_nopf:
  s_mov_b32 s39, 0
  s_and_b32 s32, s4, 3
  s_cmp_lg_u32 s32, 0
  s_cbranch_scc1 poll5d
  s_sleep 8
poll5:
  buffer_load_dword v16, v15, s[24:27], s55 offen sc0 sc1
  s_waitcnt vmcnt(0)
  v_cmp_eq_u32 vcc, 0, v16
  s_add_u32 s39, s39, 1
  s_cmp_gt_u32 s39, 1000000
  s_cbranch_scc1 poll5d
  s_cbranch_vccnz poll5
poll5d:
  s_barrier
  buffer_load_dwordx4 v[96:99], v187, s[16:19], s44 offen sc1
  buffer_load_dwordx4 v[100:103], v188, s[16:19], s44 offen sc1
  buffer_load_dwordx4 v[104:107], v187, s[16:19], s51 offen sc1
  buffer_load_dwordx4 v[108:111], v188, s[16:19], s51 offen sc1
  s_cmp_eq_u32 s3, 0
  s_cselect_b32 s24, s84, s80
  s_cselect_b32 s25, s85, s81
  s_cselect_b32 s26, 100663296, 0
  s_add_u32 s24, s24, s26
  s_addc_u32 s25, s25, 0
  s_mov_b32 s26, 8388608
  s_mov_b32 s27, 0x20000
  s_lshr_b32 s26, s26, s3
  s_add_u32 s12, s84, 93323264
  s_addc_u32 s13, s85, 0
  s_mov_b32 s14, 262144
  s_mov_b32 s15, 0x20000
  s_bitcmp1_b32 s48, 0
  s_cselect_b32 s36, s50, s49
  s_add_u32 s36, s36, 0
  buffer_load_dwordx4 v[120:123], v88, s[8:11], s36 offen sc1
  buffer_load_dwordx4 v[124:127], v89, s[8:11], s36 offen sc1
  buffer_load_dwordx4 v[128:131], v90, s[8:11], s36 offen sc1
  buffer_load_dwordx4 v[132:135], v91, s[8:11], s36 offen sc1
  s_bitcmp1_b32 s48, 1
  s_cselect_b32 s36, s50, s49
  s_add_u32 s36, s36, 8192
  buffer_load_dwordx4 v[136:139], v88, s[8:11], s36 offen sc1
  buffer_load_dwordx4 v[140:143], v89, s[8:11], s36 offen sc1
  buffer_load_dwordx4 v[144:147], v90, s[8:11], s36 offen sc1
  buffer_load_dwordx4 v[148:151], v91, s[8:11], s36 offen sc1
  s_bitcmp1_b32 s48, 2
  s_cselect_b32 s36, s50, s49
  s_add_u32 s36, s36, 16384
  buffer_load_dwordx4 v[152:155], v88, s[8:11], s36 offen sc1
  buffer_load_dwordx4 v[156:159], v89, s[8:11], s36 offen sc1
  buffer_load_dwordx4 v[160:163], v90, s[8:11], s36 offen sc1
  buffer_load_dwordx4 v[164:167], v91, s[8:11], s36 offen sc1
  s_bitcmp1_b32 s48, 3
  s_cselect_b32 s36, s50, s49
  s_add_u32 s36, s36, 24576
  buffer_load_dwordx4 v[168:171], v88, s[8:11], s36 offen sc1
  buffer_load_dwordx4 v[172:175], v89, s[8:11], s36 offen sc1
  s_waitcnt vmcnt(14)
  v_lshlrev_b32 v112, 16, v112
  v_lshlrev_b32 v48, 16, v96
  v_and_b32 v49, 0xffff0000, v96
  v_lshlrev_b32 v50, 16, v97
  v_and_b32 v51, 0xffff0000, v97
  v_lshlrev_b32 v52, 16, v98
  v_and_b32 v53, 0xffff0000, v98
  v_lshlrev_b32 v54, 16, v99
  v_and_b32 v55, 0xffff0000, v99
  v_pk_add_f32 v[48:49], v[48:49], v[112:113] op_sel_hi:[1,0]
  v_pk_add_f32 v[50:51], v[50:51], v[112:113] op_sel_hi:[1,0]
  v_pk_add_f32 v[52:53], v[52:53], v[112:113] op_sel_hi:[1,0]
  v_pk_add_f32 v[54:55], v[54:55], v[112:113] op_sel_hi:[1,0]
  v_lshlrev_b32 v114, 16, v114
  v_lshlrev_b32 v56, 16, v100
  v_and_b32 v57, 0xffff0000, v100
  v_lshlrev_b32 v58, 16, v101
  v_and_b32 v59, 0xffff0000, v101
  v_lshlrev_b32 v60, 16, v102
  v_and_b32 v61, 0xffff0000, v102
  v_lshlrev_b32 v62, 16, v103
  v_and_b32 v63, 0xffff0000, v103
  v_pk_add_f32 v[56:57], v[56:57], v[114:115] op_sel_hi:[1,0]
  v_pk_add_f32 v[58:59], v[58:59], v[114:115] op_sel_hi:[1,0]
  v_pk_add_f32 v[60:61], v[60:61], v[114:115] op_sel_hi:[1,0]
  v_pk_add_f32 v[62:63], v[62:63], v[114:115] op_sel_hi:[1,0]
  v_lshlrev_b32 v116, 16, v116
  v_lshlrev_b32 v64, 16, v104
  v_and_b32 v65, 0xffff0000, v104
  v_lshlrev_b32 v66, 16, v105
  v_and_b32 v67, 0xffff0000, v105
  v_lshlrev_b32 v68, 16, v106
  v_and_b32 v69, 0xffff0000, v106
  v_lshlrev_b32 v70, 16, v107
  v_and_b32 v71, 0xffff0000, v107
  v_pk_add_f32 v[64:65], v[64:65], v[116:117] op_sel_hi:[1,0]
  v_pk_add_f32 v[66:67], v[66:67], v[116:117] op_sel_hi:[1,0]
  v_pk_add_f32 v[68:69], v[68:69], v[116:117] op_sel_hi:[1,0]
  v_pk_add_f32 v[70:71], v[70:71], v[116:117] op_sel_hi:[1,0]
  v_lshlrev_b32 v118, 16, v118
  v_lshlrev_b32 v72, 16, v108
  v_and_b32 v73, 0xffff0000, v108
  v_lshlrev_b32 v74, 16, v109
  v_and_b32 v75, 0xffff0000, v109
  v_lshlrev_b32 v76, 16, v110
  v_and_b32 v77, 0xffff0000, v110
  v_lshlrev_b32 v78, 16, v111
  v_and_b32 v79, 0xffff0000, v111
  v_pk_add_f32 v[72:73], v[72:73], v[118:119] op_sel_hi:[1,0]
  v_pk_add_f32 v[74:75], v[74:75], v[118:119] op_sel_hi:[1,0]
  v_pk_add_f32 v[76:77], v[76:77], v[118:119] op_sel_hi:[1,0]
  v_pk_add_f32 v[78:79], v[78:79], v[118:119] op_sel_hi:[1,0]
  s_mov_b32 s43, 0
  s_mov_b32 s39, 6
  s_barrier
  ds_read_b64_tr_b16 v[16:17], v8 offset:0
  ds_read_b64_tr_b16 v[18:19], v8 offset:512
  ds_read_b64_tr_b16 v[20:21], v9 offset:0
  ds_read_b64_tr_b16 v[22:23], v9 offset:512
  ds_read_b64_tr_b16 v[24:25], v10 offset:0
  ds_read_b64_tr_b16 v[26:27], v10 offset:512
  ds_read_b64_tr_b16 v[28:29], v11 offset:0
  ds_read_b64_tr_b16 v[30:31], v11 offset:512
  s_add_u32 s40, s43, 8192
  s_cmp_eq_u32 s40, 65536
  s_cselect_b32 s40, 0, s40
  s_sub_u32 s42, s40, s43
  s_mov_b32 s43, s40
cd6:
  s_waitcnt vmcnt(13) lgkmcnt(6)
  v_mfma_f32_16x16x32_bf16 v[48:51], v[120:123], v[16:19], v[48:51]
  ds_read_b64_tr_b16 v[32:33], v8 offset:4096
  s_waitcnt vmcnt(12)
  v_mfma_f32_16x16x32_bf16 v[52:55], v[124:127], v[16:19], v[52:55]
  ds_read_b64_tr_b16 v[34:35], v8 offset:4608
  v_add_u32 v8, s42, v8
  s_waitcnt lgkmcnt(6)
  v_mfma_f32_16x16x32_bf16 v[60:63], v[124:127], v[20:23], v[60:63]
  ds_read_b64_tr_b16 v[36:37], v9 offset:4096
  buffer_load_dwordx4 v[176:179], v90, s[8:11], s36 offen sc1
  v_mfma_f32_16x16x32_bf16 v[56:59], v[120:123], v[20:23], v[56:59]
  ds_read_b64_tr_b16 v[38:39], v9 offset:4608
  v_add_u32 v9, s42, v9
  s_waitcnt lgkmcnt(6)
  v_mfma_f32_16x16x32_bf16 v[64:67], v[120:123], v[24:27], v[64:67]
  ds_read_b64_tr_b16 v[40:41], v10 offset:4096
  v_mfma_f32_16x16x32_bf16 v[68:71], v[124:127], v[24:27], v[68:71]
  ds_read_b64_tr_b16 v[42:43], v10 offset:4608
  v_add_u32 v10, s42, v10
  s_waitcnt lgkmcnt(6)
  v_mfma_f32_16x16x32_bf16 v[76:79], v[124:127], v[28:31], v[76:79]
  ds_read_b64_tr_b16 v[44:45], v11 offset:4096
  buffer_load_dwordx4 v[180:183], v91, s[8:11], s36 offen sc1
  v_mfma_f32_16x16x32_bf16 v[72:75], v[120:123], v[28:31], v[72:75]
  ds_read_b64_tr_b16 v[46:47], v11 offset:4608
  v_add_u32 v11, s42, v11
  s_barrier
  s_waitcnt vmcnt(13) lgkmcnt(6)
  v_mfma_f32_16x16x32_bf16 v[48:51], v[128:131], v[32:35], v[48:51]
  ds_read_b64_tr_b16 v[16:17], v8 offset:0
  s_bitcmp1_b32 s48, 4
  s_cselect_b32 s36, s50, s49
  s_waitcnt vmcnt(12)
  v_mfma_f32_16x16x32_bf16 v[52:55], v[132:135], v[32:35], v[52:55]
  ds_read_b64_tr_b16 v[18:19], v8 offset:512
  s_add_u32 s36, s36, 32768
  s_add_u32 s40, s43, 8192
  s_waitcnt lgkmcnt(6)
  v_mfma_f32_16x16x32_bf16 v[60:63], v[132:135], v[36:39], v[60:63]
  ds_read_b64_tr_b16 v[20:21], v9 offset:0
  s_cmp_eq_u32 s40, 65536
  s_cselect_b32 s40, 0, s40
  v_mfma_f32_16x16x32_bf16 v[56:59], v[128:131], v[36:39], v[56:59]
  ds_read_b64_tr_b16 v[22:23], v9 offset:512
  s_sub_u32 s42, s40, s43
  s_mov_b32 s43, s40
  s_waitcnt lgkmcnt(6)
  v_mfma_f32_16x16x32_bf16 v[64:67], v[128:131], v[40:43], v[64:67]
  ds_read_b64_tr_b16 v[24:25], v10 offset:0
  buffer_load_dwordx4 v[120:123], v88, s[8:11], s36 offen sc1
  v_mfma_f32_16x16x32_bf16 v[68:71], v[132:135], v[40:43], v[68:71]
  ds_read_b64_tr_b16 v[26:27], v10 offset:512
  s_waitcnt lgkmcnt(6)
  v_mfma_f32_16x16x32_bf16 v[76:79], v[132:135], v[44:47], v[76:79]
  ds_read_b64_tr_b16 v[28:29], v11 offset:0
  v_mfma_f32_16x16x32_bf16 v[72:75], v[128:131], v[44:47], v[72:75]
  ds_read_b64_tr_b16 v[30:31], v11 offset:512
  buffer_load_dwordx4 v[124:127], v89, s[8:11], s36 offen sc1
  s_waitcnt vmcnt(13) lgkmcnt(6)
  v_mfma_f32_16x16x32_bf16 v[48:51], v[136:139], v[16:19], v[48:51]
  ds_read_b64_tr_b16 v[32:33], v8 offset:4096
  s_waitcnt vmcnt(12)
  v_mfma_f32_16x16x32_bf16 v[52:55], v[140:143], v[16:19], v[52:55]
  ds_read_b64_tr_b16 v[34:35], v8 offset:4608
  v_add_u32 v8, s42, v8
  s_waitcnt lgkmcnt(6)
  v_mfma_f32_16x16x32_bf16 v[60:63], v[140:143], v[20:23], v[60:63]
  ds_read_b64_tr_b16 v[36:37], v9 offset:4096
  buffer_load_dwordx4 v[128:131], v90, s[8:11], s36 offen sc1
  v_mfma_f32_16x16x32_bf16 v[56:59], v[136:139], v[20:23], v[56:59]
  ds_read_b64_tr_b16 v[38:39], v9 offset:4608
  v_add_u32 v9, s42, v9
  s_waitcnt lgkmcnt(6)
  v_mfma_f32_16x16x32_bf16 v[64:67], v[136:139], v[24:27], v[64:67]
  ds_read_b64_tr_b16 v[40:41], v10 offset:4096
  v_mfma_f32_16x16x32_bf16 v[68:71], v[140:143], v[24:27], v[68:71]
  ds_read_b64_tr_b16 v[42:43], v10 offset:4608
  v_add_u32 v10, s42, v10
  s_waitcnt lgkmcnt(6)
  v_mfma_f32_16x16x32_bf16 v[76:79], v[140:143], v[28:31], v[76:79]
  ds_read_b64_tr_b16 v[44:45], v11 offset:4096
  buffer_load_dwordx4 v[132:135], v91, s[8:11], s36 offen sc1
  v_mfma_f32_16x16x32_bf16 v[72:75], v[136:139], v[28:31], v[72:75]
  ds_read_b64_tr_b16 v[46:47], v11 offset:4608
  v_add_u32 v11, s42, v11
  s_barrier
  s_waitcnt vmcnt(13) lgkmcnt(6)
  v_mfma_f32_16x16x32_bf16 v[48:51], v[144:147], v[32:35], v[48:51]
  ds_read_b64_tr_b16 v[16:17], v8 offset:0
  s_bitcmp1_b32 s48, 5
  s_cselect_b32 s36, s50, s49
  s_waitcnt vmcnt(12)
  v_mfma_f32_16x16x32_bf16 v[52:55], v[148:151], v[32:35], v[52:55]
  ds_read_b64_tr_b16 v[18:19], v8 offset:512
  s_add_u32 s36, s36, 40960
  s_add_u32 s40, s43, 8192
  s_waitcnt lgkmcnt(6)
  v_mfma_f32_16x16x32_bf16 v[60:63], v[148:151], v[36:39], v[60:63]
  ds_read_b64_tr_b16 v[20:21], v9 offset:0
  s_cmp_eq_u32 s40, 65536
  s_cselect_b32 s40, 0, s40
  v_mfma_f32_16x16x32_bf16 v[56:59], v[144:147], v[36:39], v[56:59]
  ds_read_b64_tr_b16 v[22:23], v9 offset:512
  s_sub_u32 s42, s40, s43
  s_mov_b32 s43, s40
  s_waitcnt lgkmcnt(6)
  v_mfma_f32_16x16x32_bf16 v[64:67], v[144:147], v[40:43], v[64:67]
  ds_read_b64_tr_b16 v[24:25], v10 offset:0
  buffer_load_dwordx4 v[136:139], v88, s[8:11], s36 offen sc1
  v_mfma_f32_16x16x32_bf16 v[68:71], v[148:151], v[40:43], v[68:71]
  ds_read_b64_tr_b16 v[26:27], v10 offset:512
  s_waitcnt lgkmcnt(6)
  v_mfma_f32_16x16x32_bf16 v[76:79], v[148:151], v[44:47], v[76:79]
  ds_read_b64_tr_b16 v[28:29], v11 offset:0
  v_mfma_f32_16x16x32_bf16 v[72:75], v[144:147], v[44:47], v[72:75]
  ds_read_b64_tr_b16 v[30:31], v11 offset:512
  buffer_load_dwordx4 v[140:143], v89, s[8:11], s36 offen sc1
  s_waitcnt vmcnt(13) lgkmcnt(6)
  v_mfma_f32_16x16x32_bf16 v[48:51], v[152:155], v[16:19], v[48:51]
  ds_read_b64_tr_b16 v[32:33], v8 offset:4096
  s_waitcnt vmcnt(12)
  v_mfma_f32_16x16x32_bf16 v[52:55], v[156:159], v[16:19], v[52:55]
  ds_read_b64_tr_b16 v[34:35], v8 offset:4608
  v_add_u32 v8, s42, v8
  s_waitcnt lgkmcnt(6)
  v_mfma_f32_16x16x32_bf16 v[60:63], v[156:159], v[20:23], v[60:63]
  ds_read_b64_tr_b16 v[36:37], v9 offset:4096
  buffer_load_dwordx4 v[144:147], v90, s[8:11], s36 offen sc1
  v_mfma_f32_16x16x32_bf16 v[56:59], v[152:155], v[20:23], v[56:59]
  ds_read_b64_tr_b16 v[38:39], v9 offset:4608
  v_add_u32 v9, s42, v9
  s_waitcnt lgkmcnt(6)
  v_mfma_f32_16x16x32_bf16 v[64:67], v[152:155], v[24:27], v[64:67]
  ds_read_b64_tr_b16 v[40:41], v10 offset:4096
  v_mfma_f32_16x16x32_bf16 v[68:71], v[156:159], v[24:27], v[68:71]
  ds_read_b64_tr_b16 v[42:43], v10 offset:4608
  v_add_u32 v10, s42, v10
  s_waitcnt lgkmcnt(6)
  v_mfma_f32_16x16x32_bf16 v[76:79], v[156:159], v[28:31], v[76:79]
  ds_read_b64_tr_b16 v[44:45], v11 offset:4096
  buffer_load_dwordx4 v[148:151], v91, s[8:11], s36 offen sc1
  v_mfma_f32_16x16x32_bf16 v[72:75], v[152:155], v[28:31], v[72:75]
  ds_read_b64_tr_b16 v[46:47], v11 offset:4608
  v_add_u32 v11, s42, v11
  s_barrier
  s_waitcnt vmcnt(13) lgkmcnt(6)
  v_mfma_f32_16x16x32_bf16 v[48:51], v[160:163], v[32:35], v[48:51]
  ds_read_b64_tr_b16 v[16:17], v8 offset:0
  s_bitcmp1_b32 s48, 6
  s_cselect_b32 s36, s50, s49
  s_waitcnt vmcnt(12)
  v_mfma_f32_16x16x32_bf16 v[52:55], v[164:167], v[32:35], v[52:55]
  ds_read_b64_tr_b16 v[18:19], v8 offset:512
  s_add_u32 s36, s36, 49152
  s_add_u32 s40, s43, 8192
  s_waitcnt lgkmcnt(6)
  v_mfma_f32_16x16x32_bf16 v[60:63], v[164:167], v[36:39], v[60:63]
  ds_read_b64_tr_b16 v[20:21], v9 offset:0
  s_cmp_eq_u32 s40, 65536
  s_cselect_b32 s40, 0, s40
  v_mfma_f32_16x16x32_bf16 v[56:59], v[160:163], v[36:39], v[56:59]
  ds_read_b64_tr_b16 v[22:23], v9 offset:512
  s_sub_u32 s42, s40, s43
  s_mov_b32 s43, s40
  s_waitcnt lgkmcnt(6)
  v_mfma_f32_16x16x32_bf16 v[64:67], v[160:163], v[40:43], v[64:67]
  ds_read_b64_tr_b16 v[24:25], v10 offset:0
  buffer_load_dwordx4 v[152:155], v88, s[8:11], s36 offen sc1
  v_mfma_f32_16x16x32_bf16 v[68:71], v[164:167], v[40:43], v[68:71]
  ds_read_b64_tr_b16 v[26:27], v10 offset:512
  s_waitcnt lgkmcnt(6)
  v_mfma_f32_16x16x32_bf16 v[76:79], v[164:167], v[44:47], v[76:79]
  ds_read_b64_tr_b16 v[28:29], v11 offset:0
  v_mfma_f32_16x16x32_bf16 v[72:75], v[160:163], v[44:47], v[72:75]
  ds_read_b64_tr_b16 v[30:31], v11 offset:512
  buffer_load_dwordx4 v[156:159], v89, s[8:11], s36 offen sc1
  s_waitcnt vmcnt(13) lgkmcnt(6)
  v_mfma_f32_16x16x32_bf16 v[48:51], v[168:171], v[16:19], v[48:51]
  ds_read_b64_tr_b16 v[32:33], v8 offset:4096
  s_waitcnt vmcnt(12)
  v_mfma_f32_16x16x32_bf16 v[52:55], v[172:175], v[16:19], v[52:55]
  ds_read_b64_tr_b16 v[34:35], v8 offset:4608
  v_add_u32 v8, s42, v8
  s_waitcnt lgkmcnt(6)
  v_mfma_f32_16x16x32_bf16 v[60:63], v[172:175], v[20:23], v[60:63]
  ds_read_b64_tr_b16 v[36:37], v9 offset:4096
  buffer_load_dwordx4 v[160:163], v90, s[8:11], s36 offen sc1
  v_mfma_f32_16x16x32_bf16 v[56:59], v[168:171], v[20:23], v[56:59]
  ds_read_b64_tr_b16 v[38:39], v9 offset:4608
  v_add_u32 v9, s42, v9
  s_waitcnt lgkmcnt(6)
  v_mfma_f32_16x16x32_bf16 v[64:67], v[168:171], v[24:27], v[64:67]
  ds_read_b64_tr_b16 v[40:41], v10 offset:4096
  v_mfma_f32_16x16x32_bf16 v[68:71], v[172:175], v[24:27], v[68:71]
  ds_read_b64_tr_b16 v[42:43], v10 offset:4608
  v_add_u32 v10, s42, v10
  s_waitcnt lgkmcnt(6)
  v_mfma_f32_16x16x32_bf16 v[76:79], v[172:175], v[28:31], v[76:79]
  ds_read_b64_tr_b16 v[44:45], v11 offset:4096
  buffer_load_dwordx4 v[164:167], v91, s[8:11], s36 offen sc1
  v_mfma_f32_16x16x32_bf16 v[72:75], v[168:171], v[28:31], v[72:75]
  ds_read_b64_tr_b16 v[46:47], v11 offset:4608
  v_add_u32 v11, s42, v11
  s_barrier
  s_waitcnt vmcnt(13) lgkmcnt(6)
  v_mfma_f32_16x16x32_bf16 v[48:51], v[176:179], v[32:35], v[48:51]
  ds_read_b64_tr_b16 v[16:17], v8 offset:0
  s_bitcmp1_b32 s48, 7
  s_cselect_b32 s36, s50, s49
  s_waitcnt vmcnt(12)
  v_mfma_f32_16x16x32_bf16 v[52:55], v[180:183], v[32:35], v[52:55]
  ds_read_b64_tr_b16 v[18:19], v8 offset:512
  s_add_u32 s36, s36, 57344
  s_add_u32 s40, s43, 8192
  s_waitcnt lgkmcnt(6)
  v_mfma_f32_16x16x32_bf16 v[60:63], v[180:183], v[36:39], v[60:63]
  ds_read_b64_tr_b16 v[20:21], v9 offset:0
  s_cmp_eq_u32 s40, 65536
  s_cselect_b32 s40, 0, s40
  v_mfma_f32_16x16x32_bf16 v[56:59], v[176:179], v[36:39], v[56:59]
  ds_read_b64_tr_b16 v[22:23], v9 offset:512
  s_sub_u32 s42, s40, s43
  s_mov_b32 s43, s40
  s_waitcnt lgkmcnt(6)
  v_mfma_f32_16x16x32_bf16 v[64:67], v[176:179], v[40:43], v[64:67]
  ds_read_b64_tr_b16 v[24:25], v10 offset:0
  buffer_load_dwordx4 v[168:171], v88, s[8:11], s36 offen sc1
  v_mfma_f32_16x16x32_bf16 v[68:71], v[180:183], v[40:43], v[68:71]
  ds_read_b64_tr_b16 v[26:27], v10 offset:512
  s_waitcnt lgkmcnt(6)
  v_mfma_f32_16x16x32_bf16 v[76:79], v[180:183], v[44:47], v[76:79]
  ds_read_b64_tr_b16 v[28:29], v11 offset:0
  v_mfma_f32_16x16x32_bf16 v[72:75], v[176:179], v[44:47], v[72:75]
  ds_read_b64_tr_b16 v[30:31], v11 offset:512
  buffer_load_dwordx4 v[172:175], v89, s[8:11], s36 offen sc1
  s_waitcnt vmcnt(13) lgkmcnt(6)
  v_mfma_f32_16x16x32_bf16 v[48:51], v[120:123], v[16:19], v[48:51]
  ds_read_b64_tr_b16 v[32:33], v8 offset:4096
  s_waitcnt vmcnt(12)
  v_mfma_f32_16x16x32_bf16 v[52:55], v[124:127], v[16:19], v[52:55]
  ds_read_b64_tr_b16 v[34:35], v8 offset:4608
  v_add_u32 v8, s42, v8
  s_waitcnt lgkmcnt(6)
  v_mfma_f32_16x16x32_bf16 v[60:63], v[124:127], v[20:23], v[60:63]
  ds_read_b64_tr_b16 v[36:37], v9 offset:4096
  buffer_load_dwordx4 v[176:179], v90, s[8:11], s36 offen sc1
  v_mfma_f32_16x16x32_bf16 v[56:59], v[120:123], v[20:23], v[56:59]
  ds_read_b64_tr_b16 v[38:39], v9 offset:4608
  v_add_u32 v9, s42, v9
  s_waitcnt lgkmcnt(6)
  v_mfma_f32_16x16x32_bf16 v[64:67], v[120:123], v[24:27], v[64:67]
  ds_read_b64_tr_b16 v[40:41], v10 offset:4096
  v_mfma_f32_16x16x32_bf16 v[68:71], v[124:127], v[24:27], v[68:71]
  ds_read_b64_tr_b16 v[42:43], v10 offset:4608
  v_add_u32 v10, s42, v10
  s_waitcnt lgkmcnt(6)
  v_mfma_f32_16x16x32_bf16 v[76:79], v[124:127], v[28:31], v[76:79]
  ds_read_b64_tr_b16 v[44:45], v11 offset:4096
  buffer_load_dwordx4 v[180:183], v91, s[8:11], s36 offen sc1
  v_mfma_f32_16x16x32_bf16 v[72:75], v[120:123], v[28:31], v[72:75]
  ds_read_b64_tr_b16 v[46:47], v11 offset:4608
  v_add_u32 v11, s42, v11
  s_barrier
  s_waitcnt vmcnt(13) lgkmcnt(6)
  v_mfma_f32_16x16x32_bf16 v[48:51], v[128:131], v[32:35], v[48:51]
  ds_read_b64_tr_b16 v[16:17], v8 offset:0
  s_mov_b32 s49, s50
  s_add_u32 s50, s50, 65536
  s_waitcnt vmcnt(12)
  v_mfma_f32_16x16x32_bf16 v[52:55], v[132:135], v[32:35], v[52:55]
  ds_read_b64_tr_b16 v[18:19], v8 offset:512
  s_cmp_eq_u32 s50, s41
  s_cselect_b32 s50, s34, s50
  s_waitcnt lgkmcnt(6)
  v_mfma_f32_16x16x32_bf16 v[60:63], v[132:135], v[36:39], v[60:63]
  ds_read_b64_tr_b16 v[20:21], v9 offset:0
  s_bitcmp1_b32 s48, 0
  s_cselect_b32 s36, s50, s49
  v_mfma_f32_16x16x32_bf16 v[56:59], v[128:131], v[36:39], v[56:59]
  ds_read_b64_tr_b16 v[22:23], v9 offset:512
  s_add_u32 s36, s36, 0
  s_add_u32 s40, s43, 8192
  s_waitcnt lgkmcnt(6)
  v_mfma_f32_16x16x32_bf16 v[64:67], v[128:131], v[40:43], v[64:67]
  ds_read_b64_tr_b16 v[24:25], v10 offset:0
  s_cmp_eq_u32 s40, 65536
  s_cselect_b32 s40, 0, s40
  buffer_load_dwordx4 v[120:123], v88, s[8:11], s36 offen sc1
  v_mfma_f32_16x16x32_bf16 v[68:71], v[132:135], v[40:43], v[68:71]
  ds_read_b64_tr_b16 v[26:27], v10 offset:512
  s_sub_u32 s42, s40, s43
  s_mov_b32 s43, s40
  s_waitcnt lgkmcnt(6)
  v_mfma_f32_16x16x32_bf16 v[76:79], v[132:135], v[44:47], v[76:79]
  ds_read_b64_tr_b16 v[28:29], v11 offset:0
  v_mfma_f32_16x16x32_bf16 v[72:75], v[128:131], v[44:47], v[72:75]
  ds_read_b64_tr_b16 v[30:31], v11 offset:512
  buffer_load_dwordx4 v[124:127], v89, s[8:11], s36 offen sc1
  s_waitcnt vmcnt(13) lgkmcnt(6)
  v_mfma_f32_16x16x32_bf16 v[48:51], v[136:139], v[16:19], v[48:51]
  ds_read_b64_tr_b16 v[32:33], v8 offset:4096
  s_waitcnt vmcnt(12)
  v_mfma_f32_16x16x32_bf16 v[52:55], v[140:143], v[16:19], v[52:55]
  ds_read_b64_tr_b16 v[34:35], v8 offset:4608
  v_add_u32 v8, s42, v8
  s_waitcnt lgkmcnt(6)
  v_mfma_f32_16x16x32_bf16 v[60:63], v[140:143], v[20:23], v[60:63]
  ds_read_b64_tr_b16 v[36:37], v9 offset:4096
  buffer_load_dwordx4 v[128:131], v90, s[8:11], s36 offen sc1
  v_mfma_f32_16x16x32_bf16 v[56:59], v[136:139], v[20:23], v[56:59]
  ds_read_b64_tr_b16 v[38:39], v9 offset:4608
  v_add_u32 v9, s42, v9
  s_waitcnt lgkmcnt(6)
  v_mfma_f32_16x16x32_bf16 v[64:67], v[136:139], v[24:27], v[64:67]
  ds_read_b64_tr_b16 v[40:41], v10 offset:4096
  v_mfma_f32_16x16x32_bf16 v[68:71], v[140:143], v[24:27], v[68:71]
  ds_read_b64_tr_b16 v[42:43], v10 offset:4608
  v_add_u32 v10, s42, v10
  s_waitcnt lgkmcnt(6)
  v_mfma_f32_16x16x32_bf16 v[76:79], v[140:143], v[28:31], v[76:79]
  ds_read_b64_tr_b16 v[44:45], v11 offset:4096
  buffer_load_dwordx4 v[132:135], v91, s[8:11], s36 offen sc1
  v_mfma_f32_16x16x32_bf16 v[72:75], v[136:139], v[28:31], v[72:75]
  ds_read_b64_tr_b16 v[46:47], v11 offset:4608
  v_add_u32 v11, s42, v11
  s_barrier
  s_waitcnt vmcnt(13) lgkmcnt(6)
  v_mfma_f32_16x16x32_bf16 v[48:51], v[144:147], v[32:35], v[48:51]
  ds_read_b64_tr_b16 v[16:17], v8 offset:0
  s_bitcmp1_b32 s48, 1
  s_cselect_b32 s36, s50, s49
  s_waitcnt vmcnt(12)
  v_mfma_f32_16x16x32_bf16 v[52:55], v[148:151], v[32:35], v[52:55]
  ds_read_b64_tr_b16 v[18:19], v8 offset:512
  s_add_u32 s36, s36, 8192
  s_add_u32 s40, s43, 8192
  s_waitcnt lgkmcnt(6)
  v_mfma_f32_16x16x32_bf16 v[60:63], v[148:151], v[36:39], v[60:63]
  ds_read_b64_tr_b16 v[20:21], v9 offset:0
  s_cmp_eq_u32 s40, 65536
  s_cselect_b32 s40, 0, s40
  v_mfma_f32_16x16x32_bf16 v[56:59], v[144:147], v[36:39], v[56:59]
  ds_read_b64_tr_b16 v[22:23], v9 offset:512
  s_sub_u32 s42, s40, s43
  s_mov_b32 s43, s40
  s_waitcnt lgkmcnt(6)
  v_mfma_f32_16x16x32_bf16 v[64:67], v[144:147], v[40:43], v[64:67]
  ds_read_b64_tr_b16 v[24:25], v10 offset:0
  buffer_load_dwordx4 v[136:139], v88, s[8:11], s36 offen sc1
  v_mfma_f32_16x16x32_bf16 v[68:71], v[148:151], v[40:43], v[68:71]
  ds_read_b64_tr_b16 v[26:27], v10 offset:512
  s_waitcnt lgkmcnt(6)
  v_mfma_f32_16x16x32_bf16 v[76:79], v[148:151], v[44:47], v[76:79]
  ds_read_b64_tr_b16 v[28:29], v11 offset:0
  v_mfma_f32_16x16x32_bf16 v[72:75], v[144:147], v[44:47], v[72:75]
  ds_read_b64_tr_b16 v[30:31], v11 offset:512
  buffer_load_dwordx4 v[140:143], v89, s[8:11], s36 offen sc1
  s_waitcnt vmcnt(13) lgkmcnt(6)
  v_mfma_f32_16x16x32_bf16 v[48:51], v[152:155], v[16:19], v[48:51]
  ds_read_b64_tr_b16 v[32:33], v8 offset:4096
  s_waitcnt vmcnt(12)
  v_mfma_f32_16x16x32_bf16 v[52:55], v[156:159], v[16:19], v[52:55]
  ds_read_b64_tr_b16 v[34:35], v8 offset:4608
  v_add_u32 v8, s42, v8
  s_waitcnt lgkmcnt(6)
  v_mfma_f32_16x16x32_bf16 v[60:63], v[156:159], v[20:23], v[60:63]
  ds_read_b64_tr_b16 v[36:37], v9 offset:4096
  buffer_load_dwordx4 v[144:147], v90, s[8:11], s36 offen sc1
  v_mfma_f32_16x16x32_bf16 v[56:59], v[152:155], v[20:23], v[56:59]
  ds_read_b64_tr_b16 v[38:39], v9 offset:4608
  v_add_u32 v9, s42, v9
  s_waitcnt lgkmcnt(6)
  v_mfma_f32_16x16x32_bf16 v[64:67], v[152:155], v[24:27], v[64:67]
  ds_read_b64_tr_b16 v[40:41], v10 offset:4096
  v_mfma_f32_16x16x32_bf16 v[68:71], v[156:159], v[24:27], v[68:71]
  ds_read_b64_tr_b16 v[42:43], v10 offset:4608
  v_add_u32 v10, s42, v10
  s_waitcnt lgkmcnt(6)
  v_mfma_f32_16x16x32_bf16 v[76:79], v[156:159], v[28:31], v[76:79]
  ds_read_b64_tr_b16 v[44:45], v11 offset:4096
  buffer_load_dwordx4 v[148:151], v91, s[8:11], s36 offen sc1
  v_mfma_f32_16x16x32_bf16 v[72:75], v[152:155], v[28:31], v[72:75]
  ds_read_b64_tr_b16 v[46:47], v11 offset:4608
  v_add_u32 v11, s42, v11
  s_barrier
  s_waitcnt vmcnt(13) lgkmcnt(6)
  v_mfma_f32_16x16x32_bf16 v[48:51], v[160:163], v[32:35], v[48:51]
  ds_read_b64_tr_b16 v[16:17], v8 offset:0
  s_bitcmp1_b32 s48, 2
  s_cselect_b32 s36, s50, s49
  s_waitcnt vmcnt(12)
  v_mfma_f32_16x16x32_bf16 v[52:55], v[164:167], v[32:35], v[52:55]
  ds_read_b64_tr_b16 v[18:19], v8 offset:512
  s_add_u32 s36, s36, 16384
  s_add_u32 s40, s43, 8192
  s_waitcnt lgkmcnt(6)
  v_mfma_f32_16x16x32_bf16 v[60:63], v[164:167], v[36:39], v[60:63]
  ds_read_b64_tr_b16 v[20:21], v9 offset:0
  s_cmp_eq_u32 s40, 65536
  s_cselect_b32 s40, 0, s40
  v_mfma_f32_16x16x32_bf16 v[56:59], v[160:163], v[36:39], v[56:59]
  ds_read_b64_tr_b16 v[22:23], v9 offset:512
  s_sub_u32 s42, s40, s43
  s_mov_b32 s43, s40
  s_waitcnt lgkmcnt(6)
  v_mfma_f32_16x16x32_bf16 v[64:67], v[160:163], v[40:43], v[64:67]
  ds_read_b64_tr_b16 v[24:25], v10 offset:0
  buffer_load_dwordx4 v[152:155], v88, s[8:11], s36 offen sc1
  v_mfma_f32_16x16x32_bf16 v[68:71], v[164:167], v[40:43], v[68:71]
  ds_read_b64_tr_b16 v[26:27], v10 offset:512
  s_waitcnt lgkmcnt(6)
  v_mfma_f32_16x16x32_bf16 v[76:79], v[164:167], v[44:47], v[76:79]
  ds_read_b64_tr_b16 v[28:29], v11 offset:0
  v_mfma_f32_16x16x32_bf16 v[72:75], v[160:163], v[44:47], v[72:75]
  ds_read_b64_tr_b16 v[30:31], v11 offset:512
  buffer_load_dwordx4 v[156:159], v89, s[8:11], s36 offen sc1
  s_waitcnt vmcnt(13) lgkmcnt(6)
  v_mfma_f32_16x16x32_bf16 v[48:51], v[168:171], v[16:19], v[48:51]
  ds_read_b64_tr_b16 v[32:33], v8 offset:4096
  s_waitcnt vmcnt(12)
  v_mfma_f32_16x16x32_bf16 v[52:55], v[172:175], v[16:19], v[52:55]
  ds_read_b64_tr_b16 v[34:35], v8 offset:4608
  v_add_u32 v8, s42, v8
  s_waitcnt lgkmcnt(6)
  v_mfma_f32_16x16x32_bf16 v[60:63], v[172:175], v[20:23], v[60:63]
  ds_read_b64_tr_b16 v[36:37], v9 offset:4096
  buffer_load_dwordx4 v[160:163], v90, s[8:11], s36 offen sc1
  v_mfma_f32_16x16x32_bf16 v[56:59], v[168:171], v[20:23], v[56:59]
  ds_read_b64_tr_b16 v[38:39], v9 offset:4608
  v_add_u32 v9, s42, v9
  s_waitcnt lgkmcnt(6)
  v_mfma_f32_16x16x32_bf16 v[64:67], v[168:171], v[24:27], v[64:67]
  ds_read_b64_tr_b16 v[40:41], v10 offset:4096
  v_mfma_f32_16x16x32_bf16 v[68:71], v[172:175], v[24:27], v[68:71]
  ds_read_b64_tr_b16 v[42:43], v10 offset:4608
  v_add_u32 v10, s42, v10
  s_waitcnt lgkmcnt(6)
  v_mfma_f32_16x16x32_bf16 v[76:79], v[172:175], v[28:31], v[76:79]
  ds_read_b64_tr_b16 v[44:45], v11 offset:4096
  buffer_load_dwordx4 v[164:167], v91, s[8:11], s36 offen sc1
  v_mfma_f32_16x16x32_bf16 v[72:75], v[168:171], v[28:31], v[72:75]
  ds_read_b64_tr_b16 v[46:47], v11 offset:4608
  v_add_u32 v11, s42, v11
  s_barrier
  s_waitcnt vmcnt(13) lgkmcnt(6)
  v_mfma_f32_16x16x32_bf16 v[48:51], v[176:179], v[32:35], v[48:51]
  ds_read_b64_tr_b16 v[16:17], v8 offset:0
  s_bitcmp1_b32 s48, 3
  s_cselect_b32 s36, s50, s49
  s_waitcnt vmcnt(12)
  v_mfma_f32_16x16x32_bf16 v[52:55], v[180:183], v[32:35], v[52:55]
  ds_read_b64_tr_b16 v[18:19], v8 offset:512
  s_add_u32 s36, s36, 24576
  s_add_u32 s40, s43, 8192
  s_waitcnt lgkmcnt(6)
  v_mfma_f32_16x16x32_bf16 v[60:63], v[180:183], v[36:39], v[60:63]
  ds_read_b64_tr_b16 v[20:21], v9 offset:0
  s_cmp_eq_u32 s40, 65536
  s_cselect_b32 s40, 0, s40
  v_mfma_f32_16x16x32_bf16 v[56:59], v[176:179], v[36:39], v[56:59]
  ds_read_b64_tr_b16 v[22:23], v9 offset:512
  s_sub_u32 s42, s40, s43
  s_mov_b32 s43, s40
  s_waitcnt lgkmcnt(6)
  v_mfma_f32_16x16x32_bf16 v[64:67], v[176:179], v[40:43], v[64:67]
  ds_read_b64_tr_b16 v[24:25], v10 offset:0
  buffer_load_dwordx4 v[168:171], v88, s[8:11], s36 offen sc1
  v_mfma_f32_16x16x32_bf16 v[68:71], v[180:183], v[40:43], v[68:71]
  ds_read_b64_tr_b16 v[26:27], v10 offset:512
  s_waitcnt lgkmcnt(6)
  v_mfma_f32_16x16x32_bf16 v[76:79], v[180:183], v[44:47], v[76:79]
  ds_read_b64_tr_b16 v[28:29], v11 offset:0
  v_mfma_f32_16x16x32_bf16 v[72:75], v[176:179], v[44:47], v[72:75]
  ds_read_b64_tr_b16 v[30:31], v11 offset:512
  buffer_load_dwordx4 v[172:175], v89, s[8:11], s36 offen sc1
  s_sub_u32 s39, s39, 1
  s_cmp_lg_u32 s39, 0
  s_cbranch_scc1 cd6
  s_waitcnt vmcnt(13) lgkmcnt(6)
  v_mfma_f32_16x16x32_bf16 v[48:51], v[120:123], v[16:19], v[48:51]
  ds_read_b64_tr_b16 v[32:33], v8 offset:4096
  s_waitcnt vmcnt(12)
  v_mfma_f32_16x16x32_bf16 v[52:55], v[124:127], v[16:19], v[52:55]
  ds_read_b64_tr_b16 v[34:35], v8 offset:4608
  v_add_u32 v8, s42, v8
  s_waitcnt lgkmcnt(6)
  v_mfma_f32_16x16x32_bf16 v[60:63], v[124:127], v[20:23], v[60:63]
  ds_read_b64_tr_b16 v[36:37], v9 offset:4096
  buffer_load_dwordx4 v[176:179], v90, s[8:11], s36 offen sc1
  v_mfma_f32_16x16x32_bf16 v[56:59], v[120:123], v[20:23], v[56:59]
  ds_read_b64_tr_b16 v[38:39], v9 offset:4608
  v_add_u32 v9, s42, v9
  s_waitcnt lgkmcnt(6)
  v_mfma_f32_16x16x32_bf16 v[64:67], v[120:123], v[24:27], v[64:67]
  ds_read_b64_tr_b16 v[40:41], v10 offset:4096
  v_mfma_f32_16x16x32_bf16 v[68:71], v[124:127], v[24:27], v[68:71]
  ds_read_b64_tr_b16 v[42:43], v10 offset:4608
  v_add_u32 v10, s42, v10
  s_waitcnt lgkmcnt(6)
  v_mfma_f32_16x16x32_bf16 v[76:79], v[124:127], v[28:31], v[76:79]
  ds_read_b64_tr_b16 v[44:45], v11 offset:4096
  buffer_load_dwordx4 v[180:183], v91, s[8:11], s36 offen sc1
  v_mfma_f32_16x16x32_bf16 v[72:75], v[120:123], v[28:31], v[72:75]
  ds_read_b64_tr_b16 v[46:47], v11 offset:4608
  v_add_u32 v11, s42, v11
  s_barrier
  s_waitcnt vmcnt(13) lgkmcnt(6)
  v_mfma_f32_16x16x32_bf16 v[48:51], v[128:131], v[32:35], v[48:51]
  ds_read_b64_tr_b16 v[16:17], v8 offset:0
  s_bitcmp1_b32 s48, 4
  s_cselect_b32 s36, s50, s49
  s_waitcnt vmcnt(12)
  v_mfma_f32_16x16x32_bf16 v[52:55], v[132:135], v[32:35], v[52:55]
  ds_read_b64_tr_b16 v[18:19], v8 offset:512
  s_add_u32 s36, s36, 32768
  s_add_u32 s40, s43, 8192
  s_waitcnt lgkmcnt(6)
  v_mfma_f32_16x16x32_bf16 v[60:63], v[132:135], v[36:39], v[60:63]
  ds_read_b64_tr_b16 v[20:21], v9 offset:0
  s_cmp_eq_u32 s40, 65536
  s_cselect_b32 s40, 0, s40
  v_mfma_f32_16x16x32_bf16 v[56:59], v[128:131], v[36:39], v[56:59]
  ds_read_b64_tr_b16 v[22:23], v9 offset:512
  s_sub_u32 s42, s40, s43
  s_mov_b32 s43, s40
  s_waitcnt lgkmcnt(6)
  v_mfma_f32_16x16x32_bf16 v[64:67], v[128:131], v[40:43], v[64:67]
  ds_read_b64_tr_b16 v[24:25], v10 offset:0
  buffer_load_dwordx4 v[120:123], v88, s[8:11], s36 offen sc1
  v_mfma_f32_16x16x32_bf16 v[68:71], v[132:135], v[40:43], v[68:71]
  ds_read_b64_tr_b16 v[26:27], v10 offset:512
  s_waitcnt lgkmcnt(6)
  v_mfma_f32_16x16x32_bf16 v[76:79], v[132:135], v[44:47], v[76:79]
  ds_read_b64_tr_b16 v[28:29], v11 offset:0
  v_mfma_f32_16x16x32_bf16 v[72:75], v[128:131], v[44:47], v[72:75]
  ds_read_b64_tr_b16 v[30:31], v11 offset:512
  buffer_load_dwordx4 v[124:127], v89, s[8:11], s36 offen sc1
  s_waitcnt vmcnt(13) lgkmcnt(6)
  v_mfma_f32_16x16x32_bf16 v[48:51], v[136:139], v[16:19], v[48:51]
  ds_read_b64_tr_b16 v[32:33], v8 offset:4096
  s_waitcnt vmcnt(12)
  v_mfma_f32_16x16x32_bf16 v[52:55], v[140:143], v[16:19], v[52:55]
  ds_read_b64_tr_b16 v[34:35], v8 offset:4608
  v_add_u32 v8, s42, v8
  s_waitcnt lgkmcnt(6)
  v_mfma_f32_16x16x32_bf16 v[60:63], v[140:143], v[20:23], v[60:63]
  ds_read_b64_tr_b16 v[36:37], v9 offset:4096
  buffer_load_dwordx4 v[128:131], v90, s[8:11], s36 offen sc1
  v_mfma_f32_16x16x32_bf16 v[56:59], v[136:139], v[20:23], v[56:59]
  ds_read_b64_tr_b16 v[38:39], v9 offset:4608
  v_add_u32 v9, s42, v9
  s_waitcnt lgkmcnt(6)
  v_mfma_f32_16x16x32_bf16 v[64:67], v[136:139], v[24:27], v[64:67]
  ds_read_b64_tr_b16 v[40:41], v10 offset:4096
  v_mfma_f32_16x16x32_bf16 v[68:71], v[140:143], v[24:27], v[68:71]
  ds_read_b64_tr_b16 v[42:43], v10 offset:4608
  v_add_u32 v10, s42, v10
  s_waitcnt lgkmcnt(6)
  v_mfma_f32_16x16x32_bf16 v[76:79], v[140:143], v[28:31], v[76:79]
  ds_read_b64_tr_b16 v[44:45], v11 offset:4096
  buffer_load_dwordx4 v[132:135], v91, s[8:11], s36 offen sc1
  v_mfma_f32_16x16x32_bf16 v[72:75], v[136:139], v[28:31], v[72:75]
  ds_read_b64_tr_b16 v[46:47], v11 offset:4608
  v_add_u32 v11, s42, v11
  s_barrier
  s_waitcnt vmcnt(13) lgkmcnt(6)
  v_mfma_f32_16x16x32_bf16 v[48:51], v[144:147], v[32:35], v[48:51]
  ds_read_b64_tr_b16 v[16:17], v8 offset:0
  s_bitcmp1_b32 s48, 5
  s_cselect_b32 s36, s50, s49
  s_waitcnt vmcnt(12)
  v_mfma_f32_16x16x32_bf16 v[52:55], v[148:151], v[32:35], v[52:55]
  ds_read_b64_tr_b16 v[18:19], v8 offset:512
  s_add_u32 s36, s36, 40960
  s_add_u32 s40, s43, 8192
  s_waitcnt lgkmcnt(6)
  v_mfma_f32_16x16x32_bf16 v[60:63], v[148:151], v[36:39], v[60:63]
  ds_read_b64_tr_b16 v[20:21], v9 offset:0
  s_cmp_eq_u32 s40, 65536
  s_cselect_b32 s40, 0, s40
  v_mfma_f32_16x16x32_bf16 v[56:59], v[144:147], v[36:39], v[56:59]
  ds_read_b64_tr_b16 v[22:23], v9 offset:512
  s_sub_u32 s42, s40, s43
  s_mov_b32 s43, s40
  s_waitcnt lgkmcnt(6)
  v_mfma_f32_16x16x32_bf16 v[64:67], v[144:147], v[40:43], v[64:67]
  ds_read_b64_tr_b16 v[24:25], v10 offset:0
  buffer_load_dwordx4 v[136:139], v88, s[8:11], s36 offen sc1
  v_mfma_f32_16x16x32_bf16 v[68:71], v[148:151], v[40:43], v[68:71]
  ds_read_b64_tr_b16 v[26:27], v10 offset:512
  s_waitcnt lgkmcnt(6)
  v_mfma_f32_16x16x32_bf16 v[76:79], v[148:151], v[44:47], v[76:79]
  ds_read_b64_tr_b16 v[28:29], v11 offset:0
  v_mfma_f32_16x16x32_bf16 v[72:75], v[144:147], v[44:47], v[72:75]
  ds_read_b64_tr_b16 v[30:31], v11 offset:512
  buffer_load_dwordx4 v[140:143], v89, s[8:11], s36 offen sc1
  s_waitcnt vmcnt(13) lgkmcnt(6)
  v_mfma_f32_16x16x32_bf16 v[48:51], v[152:155], v[16:19], v[48:51]
  ds_read_b64_tr_b16 v[32:33], v8 offset:4096
  s_waitcnt vmcnt(12)
  v_mfma_f32_16x16x32_bf16 v[52:55], v[156:159], v[16:19], v[52:55]
  ds_read_b64_tr_b16 v[34:35], v8 offset:4608
  v_add_u32 v8, s42, v8
  s_waitcnt lgkmcnt(6)
  v_mfma_f32_16x16x32_bf16 v[60:63], v[156:159], v[20:23], v[60:63]
  ds_read_b64_tr_b16 v[36:37], v9 offset:4096
  buffer_load_dwordx4 v[144:147], v90, s[8:11], s36 offen sc1
  v_mfma_f32_16x16x32_bf16 v[56:59], v[152:155], v[20:23], v[56:59]
  ds_read_b64_tr_b16 v[38:39], v9 offset:4608
  v_add_u32 v9, s42, v9
  s_waitcnt lgkmcnt(6)
  v_mfma_f32_16x16x32_bf16 v[64:67], v[152:155], v[24:27], v[64:67]
  ds_read_b64_tr_b16 v[40:41], v10 offset:4096
  v_mfma_f32_16x16x32_bf16 v[68:71], v[156:159], v[24:27], v[68:71]
  ds_read_b64_tr_b16 v[42:43], v10 offset:4608
  v_add_u32 v10, s42, v10
  s_waitcnt lgkmcnt(6)
  v_mfma_f32_16x16x32_bf16 v[76:79], v[156:159], v[28:31], v[76:79]
  ds_read_b64_tr_b16 v[44:45], v11 offset:4096
  buffer_load_dwordx4 v[148:151], v91, s[8:11], s36 offen sc1
  v_mfma_f32_16x16x32_bf16 v[72:75], v[152:155], v[28:31], v[72:75]
  ds_read_b64_tr_b16 v[46:47], v11 offset:4608
  v_add_u32 v11, s42, v11
  s_barrier
  s_waitcnt vmcnt(13) lgkmcnt(6)
  v_mfma_f32_16x16x32_bf16 v[48:51], v[160:163], v[32:35], v[48:51]
  ds_read_b64_tr_b16 v[16:17], v8 offset:0
  s_bitcmp1_b32 s48, 6
  s_cselect_b32 s36, s50, s49
  s_waitcnt vmcnt(12)
  v_mfma_f32_16x16x32_bf16 v[52:55], v[164:167], v[32:35], v[52:55]
  ds_read_b64_tr_b16 v[18:19], v8 offset:512
  s_add_u32 s36, s36, 49152
  s_add_u32 s40, s43, 8192
  s_waitcnt lgkmcnt(6)
  v_mfma_f32_16x16x32_bf16 v[60:63], v[164:167], v[36:39], v[60:63]
  ds_read_b64_tr_b16 v[20:21], v9 offset:0
  s_cmp_eq_u32 s40, 65536
  s_cselect_b32 s40, 0, s40
  v_mfma_f32_16x16x32_bf16 v[56:59], v[160:163], v[36:39], v[56:59]
  ds_read_b64_tr_b16 v[22:23], v9 offset:512
  s_sub_u32 s42, s40, s43
  s_mov_b32 s43, s40
  s_waitcnt lgkmcnt(6)
  v_mfma_f32_16x16x32_bf16 v[64:67], v[160:163], v[40:43], v[64:67]
  ds_read_b64_tr_b16 v[24:25], v10 offset:0
  buffer_load_dwordx4 v[152:155], v88, s[8:11], s36 offen sc1
  v_mfma_f32_16x16x32_bf16 v[68:71], v[164:167], v[40:43], v[68:71]
  ds_read_b64_tr_b16 v[26:27], v10 offset:512
  s_waitcnt lgkmcnt(6)
  v_mfma_f32_16x16x32_bf16 v[76:79], v[164:167], v[44:47], v[76:79]
  ds_read_b64_tr_b16 v[28:29], v11 offset:0
  v_mfma_f32_16x16x32_bf16 v[72:75], v[160:163], v[44:47], v[72:75]
  ds_read_b64_tr_b16 v[30:31], v11 offset:512
  buffer_load_dwordx4 v[156:159], v89, s[8:11], s36 offen sc1
  s_waitcnt vmcnt(13) lgkmcnt(6)
  v_mfma_f32_16x16x32_bf16 v[48:51], v[168:171], v[16:19], v[48:51]
  ds_read_b64_tr_b16 v[32:33], v8 offset:4096
  s_waitcnt vmcnt(12)
  v_mfma_f32_16x16x32_bf16 v[52:55], v[172:175], v[16:19], v[52:55]
  ds_read_b64_tr_b16 v[34:35], v8 offset:4608
  v_add_u32 v8, s42, v8
  s_waitcnt lgkmcnt(6)
  v_mfma_f32_16x16x32_bf16 v[60:63], v[172:175], v[20:23], v[60:63]
  ds_read_b64_tr_b16 v[36:37], v9 offset:4096
  buffer_load_dwordx4 v[160:163], v90, s[8:11], s36 offen sc1
  v_mfma_f32_16x16x32_bf16 v[56:59], v[168:171], v[20:23], v[56:59]
  ds_read_b64_tr_b16 v[38:39], v9 offset:4608
  v_add_u32 v9, s42, v9
  s_waitcnt lgkmcnt(6)
  v_mfma_f32_16x16x32_bf16 v[64:67], v[168:171], v[24:27], v[64:67]
  ds_read_b64_tr_b16 v[40:41], v10 offset:4096
  v_mfma_f32_16x16x32_bf16 v[68:71], v[172:175], v[24:27], v[68:71]
  ds_read_b64_tr_b16 v[42:43], v10 offset:4608
  v_add_u32 v10, s42, v10
  s_waitcnt lgkmcnt(6)
  v_mfma_f32_16x16x32_bf16 v[76:79], v[172:175], v[28:31], v[76:79]
  ds_read_b64_tr_b16 v[44:45], v11 offset:4096
  buffer_load_dwordx4 v[164:167], v91, s[8:11], s36 offen sc1
  v_mfma_f32_16x16x32_bf16 v[72:75], v[168:171], v[28:31], v[72:75]
  ds_read_b64_tr_b16 v[46:47], v11 offset:4608
  v_add_u32 v11, s42, v11
  s_barrier
  s_waitcnt vmcnt(13) lgkmcnt(6)
  v_mfma_f32_16x16x32_bf16 v[48:51], v[176:179], v[32:35], v[48:51]
  ds_read_b64_tr_b16 v[16:17], v8 offset:0
  s_bitcmp1_b32 s48, 7
  s_cselect_b32 s36, s50, s49
  s_waitcnt vmcnt(12)
  v_mfma_f32_16x16x32_bf16 v[52:55], v[180:183], v[32:35], v[52:55]
  ds_read_b64_tr_b16 v[18:19], v8 offset:512
  s_add_u32 s36, s36, 57344
  s_add_u32 s40, s43, 8192
  s_waitcnt lgkmcnt(6)
  v_mfma_f32_16x16x32_bf16 v[60:63], v[180:183], v[36:39], v[60:63]
  ds_read_b64_tr_b16 v[20:21], v9 offset:0
  s_cmp_eq_u32 s40, 65536
  s_cselect_b32 s40, 0, s40
  v_mfma_f32_16x16x32_bf16 v[56:59], v[176:179], v[36:39], v[56:59]
  ds_read_b64_tr_b16 v[22:23], v9 offset:512
  s_sub_u32 s42, s40, s43
  s_mov_b32 s43, s40
  s_waitcnt lgkmcnt(6)
  v_mfma_f32_16x16x32_bf16 v[64:67], v[176:179], v[40:43], v[64:67]
  ds_read_b64_tr_b16 v[24:25], v10 offset:0
  buffer_load_dwordx4 v[168:171], v88, s[8:11], s36 offen sc1
  v_mfma_f32_16x16x32_bf16 v[68:71], v[180:183], v[40:43], v[68:71]
  ds_read_b64_tr_b16 v[26:27], v10 offset:512
  s_waitcnt lgkmcnt(6)
  v_mfma_f32_16x16x32_bf16 v[76:79], v[180:183], v[44:47], v[76:79]
  ds_read_b64_tr_b16 v[28:29], v11 offset:0
  v_mfma_f32_16x16x32_bf16 v[72:75], v[176:179], v[44:47], v[72:75]
  ds_read_b64_tr_b16 v[30:31], v11 offset:512
  buffer_load_dwordx4 v[172:175], v89, s[8:11], s36 offen sc1
  s_waitcnt vmcnt(13) lgkmcnt(6)
  v_mfma_f32_16x16x32_bf16 v[48:51], v[120:123], v[16:19], v[48:51]
  ds_read_b64_tr_b16 v[32:33], v8 offset:4096
  s_waitcnt vmcnt(12)
  v_mfma_f32_16x16x32_bf16 v[52:55], v[124:127], v[16:19], v[52:55]
  ds_read_b64_tr_b16 v[34:35], v8 offset:4608
  v_add_u32 v8, s42, v8
  s_waitcnt lgkmcnt(6)
  v_mfma_f32_16x16x32_bf16 v[60:63], v[124:127], v[20:23], v[60:63]
  ds_read_b64_tr_b16 v[36:37], v9 offset:4096
  buffer_load_dwordx4 v[176:179], v90, s[8:11], s36 offen sc1
  v_mfma_f32_16x16x32_bf16 v[56:59], v[120:123], v[20:23], v[56:59]
  ds_read_b64_tr_b16 v[38:39], v9 offset:4608
  v_add_u32 v9, s42, v9
  s_waitcnt lgkmcnt(6)
  v_mfma_f32_16x16x32_bf16 v[64:67], v[120:123], v[24:27], v[64:67]
  ds_read_b64_tr_b16 v[40:41], v10 offset:4096
  v_mfma_f32_16x16x32_bf16 v[68:71], v[124:127], v[24:27], v[68:71]
  ds_read_b64_tr_b16 v[42:43], v10 offset:4608
  v_add_u32 v10, s42, v10
  s_waitcnt lgkmcnt(6)
  v_mfma_f32_16x16x32_bf16 v[76:79], v[124:127], v[28:31], v[76:79]
  ds_read_b64_tr_b16 v[44:45], v11 offset:4096
  buffer_load_dwordx4 v[180:183], v91, s[8:11], s36 offen sc1
  v_mfma_f32_16x16x32_bf16 v[72:75], v[120:123], v[28:31], v[72:75]
  ds_read_b64_tr_b16 v[46:47], v11 offset:4608
  v_add_u32 v11, s42, v11
  s_barrier
  s_waitcnt vmcnt(13) lgkmcnt(6)
  v_mfma_f32_16x16x32_bf16 v[48:51], v[128:131], v[32:35], v[48:51]
  ds_read_b64_tr_b16 v[16:17], v8 offset:0
  s_add_u32 s40, s43, 8192
  s_cmp_eq_u32 s40, 65536
  s_waitcnt vmcnt(12)
  v_mfma_f32_16x16x32_bf16 v[52:55], v[132:135], v[32:35], v[52:55]
  ds_read_b64_tr_b16 v[18:19], v8 offset:512
  s_cselect_b32 s40, 0, s40
  s_sub_u32 s42, s40, s43
  s_waitcnt lgkmcnt(6)
  v_mfma_f32_16x16x32_bf16 v[60:63], v[132:135], v[36:39], v[60:63]
  ds_read_b64_tr_b16 v[20:21], v9 offset:0
  s_mov_b32 s43, s40
  v_mfma_f32_16x16x32_bf16 v[56:59], v[128:131], v[36:39], v[56:59]
  ds_read_b64_tr_b16 v[22:23], v9 offset:512
  s_waitcnt lgkmcnt(6)
  v_mfma_f32_16x16x32_bf16 v[64:67], v[128:131], v[40:43], v[64:67]
  ds_read_b64_tr_b16 v[24:25], v10 offset:0
  v_mfma_f32_16x16x32_bf16 v[68:71], v[132:135], v[40:43], v[68:71]
  ds_read_b64_tr_b16 v[26:27], v10 offset:512
  s_waitcnt lgkmcnt(6)
  v_mfma_f32_16x16x32_bf16 v[76:79], v[132:135], v[44:47], v[76:79]
  ds_read_b64_tr_b16 v[28:29], v11 offset:0
  v_mfma_f32_16x16x32_bf16 v[72:75], v[128:131], v[44:47], v[72:75]
  ds_read_b64_tr_b16 v[30:31], v11 offset:512
  s_waitcnt vmcnt(11) lgkmcnt(6)
  v_mfma_f32_16x16x32_bf16 v[48:51], v[136:139], v[16:19], v[48:51]
  ds_read_b64_tr_b16 v[32:33], v8 offset:4096
  s_waitcnt vmcnt(10)
  v_mfma_f32_16x16x32_bf16 v[52:55], v[140:143], v[16:19], v[52:55]
  ds_read_b64_tr_b16 v[34:35], v8 offset:4608
  v_add_u32 v8, s42, v8
  s_waitcnt lgkmcnt(6)
  v_mfma_f32_16x16x32_bf16 v[60:63], v[140:143], v[20:23], v[60:63]
  ds_read_b64_tr_b16 v[36:37], v9 offset:4096
  v_mfma_f32_16x16x32_bf16 v[56:59], v[136:139], v[20:23], v[56:59]
  ds_read_b64_tr_b16 v[38:39], v9 offset:4608
  v_add_u32 v9, s42, v9
  s_waitcnt lgkmcnt(6)
  v_mfma_f32_16x16x32_bf16 v[64:67], v[136:139], v[24:27], v[64:67]
  ds_read_b64_tr_b16 v[40:41], v10 offset:4096
  v_mfma_f32_16x16x32_bf16 v[68:71], v[140:143], v[24:27], v[68:71]
  ds_read_b64_tr_b16 v[42:43], v10 offset:4608
  v_add_u32 v10, s42, v10
  s_waitcnt lgkmcnt(6)
  v_mfma_f32_16x16x32_bf16 v[76:79], v[140:143], v[28:31], v[76:79]
  ds_read_b64_tr_b16 v[44:45], v11 offset:4096
  v_mfma_f32_16x16x32_bf16 v[72:75], v[136:139], v[28:31], v[72:75]
  ds_read_b64_tr_b16 v[46:47], v11 offset:4608
  v_add_u32 v11, s42, v11
  s_barrier
  s_waitcnt vmcnt(9) lgkmcnt(6)
  v_mfma_f32_16x16x32_bf16 v[48:51], v[144:147], v[32:35], v[48:51]
  ds_read_b64_tr_b16 v[16:17], v8 offset:0
  s_add_u32 s40, s43, 8192
  s_cmp_eq_u32 s40, 65536
  s_waitcnt vmcnt(8)
  v_mfma_f32_16x16x32_bf16 v[52:55], v[148:151], v[32:35], v[52:55]
  ds_read_b64_tr_b16 v[18:19], v8 offset:512
  s_cselect_b32 s40, 0, s40
  s_sub_u32 s42, s40, s43
  s_waitcnt lgkmcnt(6)
  v_mfma_f32_16x16x32_bf16 v[60:63], v[148:151], v[36:39], v[60:63]
  ds_read_b64_tr_b16 v[20:21], v9 offset:0
  s_mov_b32 s43, s40
  v_mfma_f32_16x16x32_bf16 v[56:59], v[144:147], v[36:39], v[56:59]
  ds_read_b64_tr_b16 v[22:23], v9 offset:512
  s_waitcnt lgkmcnt(6)
  v_mfma_f32_16x16x32_bf16 v[64:67], v[144:147], v[40:43], v[64:67]
  ds_read_b64_tr_b16 v[24:25], v10 offset:0
  v_mfma_f32_16x16x32_bf16 v[68:71], v[148:151], v[40:43], v[68:71]
  ds_read_b64_tr_b16 v[26:27], v10 offset:512
  s_waitcnt lgkmcnt(6)
  v_mfma_f32_16x16x32_bf16 v[76:79], v[148:151], v[44:47], v[76:79]
  ds_read_b64_tr_b16 v[28:29], v11 offset:0
  v_mfma_f32_16x16x32_bf16 v[72:75], v[144:147], v[44:47], v[72:75]
  ds_read_b64_tr_b16 v[30:31], v11 offset:512
  s_waitcnt vmcnt(7) lgkmcnt(6)
  v_mfma_f32_16x16x32_bf16 v[48:51], v[152:155], v[16:19], v[48:51]
  ds_read_b64_tr_b16 v[32:33], v8 offset:4096
  s_waitcnt vmcnt(6)
  v_mfma_f32_16x16x32_bf16 v[52:55], v[156:159], v[16:19], v[52:55]
  ds_read_b64_tr_b16 v[34:35], v8 offset:4608
  v_add_u32 v8, s42, v8
  s_waitcnt lgkmcnt(6)
  v_mfma_f32_16x16x32_bf16 v[60:63], v[156:159], v[20:23], v[60:63]
  ds_read_b64_tr_b16 v[36:37], v9 offset:4096
  v_mfma_f32_16x16x32_bf16 v[56:59], v[152:155], v[20:23], v[56:59]
  ds_read_b64_tr_b16 v[38:39], v9 offset:4608
  v_add_u32 v9, s42, v9
  s_waitcnt lgkmcnt(6)
  v_mfma_f32_16x16x32_bf16 v[64:67], v[152:155], v[24:27], v[64:67]
  ds_read_b64_tr_b16 v[40:41], v10 offset:4096
  v_mfma_f32_16x16x32_bf16 v[68:71], v[156:159], v[24:27], v[68:71]
  ds_read_b64_tr_b16 v[42:43], v10 offset:4608
  v_add_u32 v10, s42, v10
  s_waitcnt lgkmcnt(6)
  v_mfma_f32_16x16x32_bf16 v[76:79], v[156:159], v[28:31], v[76:79]
  ds_read_b64_tr_b16 v[44:45], v11 offset:4096
  v_mfma_f32_16x16x32_bf16 v[72:75], v[152:155], v[28:31], v[72:75]
  ds_read_b64_tr_b16 v[46:47], v11 offset:4608
  v_add_u32 v11, s42, v11
  s_barrier
  s_waitcnt vmcnt(5) lgkmcnt(6)
  v_mfma_f32_16x16x32_bf16 v[48:51], v[160:163], v[32:35], v[48:51]
  ds_read_b64_tr_b16 v[16:17], v8 offset:0
  s_add_u32 s40, s43, 8192
  s_cmp_eq_u32 s40, 65536
  s_waitcnt vmcnt(4)
  v_mfma_f32_16x16x32_bf16 v[52:55], v[164:167], v[32:35], v[52:55]
  ds_read_b64_tr_b16 v[18:19], v8 offset:512
  s_cselect_b32 s40, 0, s40
  s_sub_u32 s42, s40, s43
  s_waitcnt lgkmcnt(6)
  v_mfma_f32_16x16x32_bf16 v[60:63], v[164:167], v[36:39], v[60:63]
  ds_read_b64_tr_b16 v[20:21], v9 offset:0
  s_mov_b32 s43, s40
  v_mfma_f32_16x16x32_bf16 v[56:59], v[160:163], v[36:39], v[56:59]
  ds_read_b64_tr_b16 v[22:23], v9 offset:512
  s_waitcnt lgkmcnt(6)
  v_mfma_f32_16x16x32_bf16 v[64:67], v[160:163], v[40:43], v[64:67]
  ds_read_b64_tr_b16 v[24:25], v10 offset:0
  v_mfma_f32_16x16x32_bf16 v[68:71], v[164:167], v[40:43], v[68:71]
  ds_read_b64_tr_b16 v[26:27], v10 offset:512
  s_waitcnt lgkmcnt(6)
  v_mfma_f32_16x16x32_bf16 v[76:79], v[164:167], v[44:47], v[76:79]
  ds_read_b64_tr_b16 v[28:29], v11 offset:0
  v_mfma_f32_16x16x32_bf16 v[72:75], v[160:163], v[44:47], v[72:75]
  ds_read_b64_tr_b16 v[30:31], v11 offset:512
  s_waitcnt vmcnt(3) lgkmcnt(6)
  v_mfma_f32_16x16x32_bf16 v[48:51], v[168:171], v[16:19], v[48:51]
  ds_read_b64_tr_b16 v[32:33], v8 offset:4096
  s_waitcnt vmcnt(2)
  v_mfma_f32_16x16x32_bf16 v[52:55], v[172:175], v[16:19], v[52:55]
  ds_read_b64_tr_b16 v[34:35], v8 offset:4608
  s_waitcnt lgkmcnt(6)
  v_mfma_f32_16x16x32_bf16 v[60:63], v[172:175], v[20:23], v[60:63]
  ds_read_b64_tr_b16 v[36:37], v9 offset:4096
  v_mfma_f32_16x16x32_bf16 v[56:59], v[168:171], v[20:23], v[56:59]
  ds_read_b64_tr_b16 v[38:39], v9 offset:4608
  s_waitcnt lgkmcnt(6)
  v_mfma_f32_16x16x32_bf16 v[64:67], v[168:171], v[24:27], v[64:67]
  ds_read_b64_tr_b16 v[40:41], v10 offset:4096
  v_mfma_f32_16x16x32_bf16 v[68:71], v[172:175], v[24:27], v[68:71]
  ds_read_b64_tr_b16 v[42:43], v10 offset:4608
  s_waitcnt lgkmcnt(6)
  v_mfma_f32_16x16x32_bf16 v[76:79], v[172:175], v[28:31], v[76:79]
  ds_read_b64_tr_b16 v[44:45], v11 offset:4096
  v_mfma_f32_16x16x32_bf16 v[72:75], v[168:171], v[28:31], v[72:75]
  ds_read_b64_tr_b16 v[46:47], v11 offset:4608
  s_waitcnt vmcnt(1) lgkmcnt(6)
  v_mfma_f32_16x16x32_bf16 v[48:51], v[176:179], v[32:35], v[48:51]
  s_waitcnt vmcnt(0)
  v_mfma_f32_16x16x32_bf16 v[52:55], v[180:183], v[32:35], v[52:55]
  s_waitcnt lgkmcnt(4)
  v_mfma_f32_16x16x32_bf16 v[60:63], v[180:183], v[36:39], v[60:63]
  v_mfma_f32_16x16x32_bf16 v[56:59], v[176:179], v[36:39], v[56:59]
  s_waitcnt lgkmcnt(2)
  v_mfma_f32_16x16x32_bf16 v[64:67], v[176:179], v[40:43], v[64:67]
  v_mfma_f32_16x16x32_bf16 v[68:71], v[180:183], v[40:43], v[68:71]
  s_waitcnt lgkmcnt(0)
  v_mfma_f32_16x16x32_bf16 v[76:79], v[180:183], v[44:47], v[76:79]
  v_mfma_f32_16x16x32_bf16 v[72:75], v[176:179], v[44:47], v[72:75]
  s_waitcnt lgkmcnt(0)
  s_cmp_eq_u32 s3, 0
  s_cbranch_scc1 C_st
  v_cvt_pk_bf16_f32 v96, v48, v49
  v_cvt_pk_bf16_f32 v97, v50, v51
  v_cvt_pk_bf16_f32 v98, v52, v53
  v_cvt_pk_bf16_f32 v99, v54, v55
  ds_write_b128 v189, v[96:99] offset:0
  v_cvt_pk_bf16_f32 v100, v56, v57
  v_cvt_pk_bf16_f32 v101, v58, v59
  v_cvt_pk_bf16_f32 v102, v60, v61
  v_cvt_pk_bf16_f32 v103, v62, v63
  ds_write_b128 v189, v[100:103] offset:4352
  v_cvt_pk_bf16_f32 v104, v64, v65
  v_cvt_pk_bf16_f32 v105, v66, v67
  v_cvt_pk_bf16_f32 v106, v68, v69
  v_cvt_pk_bf16_f32 v107, v70, v71
  ds_write_b128 v189, v[104:107] offset:8704
  v_cvt_pk_bf16_f32 v108, v72, v73
  v_cvt_pk_bf16_f32 v109, v74, v75
  v_cvt_pk_bf16_f32 v110, v76, v77
  v_cvt_pk_bf16_f32 v111, v78, v79
  ds_write_b128 v189, v[108:111] offset:13056
  s_waitcnt lgkmcnt(0)
  s_barrier
  ds_read_b128 v[96:99], v190 offset:0
  ds_read_b128 v[100:103], v190 offset:1088
  ds_read_b128 v[104:107], v190 offset:2176
  ds_read_b128 v[108:111], v190 offset:3264
  s_waitcnt lgkmcnt(3)
  buffer_store_dwordx4 v[96:99], v12, s[24:27], 0 offen
  s_waitcnt lgkmcnt(2)
  buffer_store_dwordx4 v[100:103], v12, s[24:27], s45 offen
  s_waitcnt lgkmcnt(1)
  buffer_store_dwordx4 v[104:107], v12, s[24:27], s46 offen
  s_waitcnt lgkmcnt(0)
  buffer_store_dwordx4 v[108:111], v12, s[24:27], s47 offen
  s_branch C_end
C_st:
  s_nop 7
  v_pk_add_f32 v[16:17], v[48:49], v[50:51]
  v_pk_mul_f32 v[18:19], v[48:49], v[48:49]
  v_pk_fma_f32 v[18:19], v[50:51], v[50:51], v[18:19]
  v_pk_add_f32 v[16:17], v[16:17], v[52:53]
  v_pk_fma_f32 v[18:19], v[52:53], v[52:53], v[18:19]
  v_pk_add_f32 v[16:17], v[16:17], v[54:55]
  v_pk_fma_f32 v[18:19], v[54:55], v[54:55], v[18:19]
  v_add_f32 v32, v16, v17
  v_add_f32 v36, v18, v19
  v_pk_add_f32 v[20:21], v[56:57], v[58:59]
  v_pk_mul_f32 v[22:23], v[56:57], v[56:57]
  v_pk_fma_f32 v[22:23], v[58:59], v[58:59], v[22:23]
  v_pk_add_f32 v[20:21], v[20:21], v[60:61]
  v_pk_fma_f32 v[22:23], v[60:61], v[60:61], v[22:23]
  v_pk_add_f32 v[20:21], v[20:21], v[62:63]
  v_pk_fma_f32 v[22:23], v[62:63], v[62:63], v[22:23]
  v_add_f32 v33, v20, v21
  v_add_f32 v37, v22, v23
  v_pk_add_f32 v[24:25], v[64:65], v[66:67]
  v_pk_mul_f32 v[26:27], v[64:65], v[64:65]
  v_pk_fma_f32 v[26:27], v[66:67], v[66:67], v[26:27]
  v_pk_add_f32 v[24:25], v[24:25], v[68:69]
  v_pk_fma_f32 v[26:27], v[68:69], v[68:69], v[26:27]
  v_pk_add_f32 v[24:25], v[24:25], v[70:71]
  v_pk_fma_f32 v[26:27], v[70:71], v[70:71], v[26:27]
  v_add_f32 v34, v24, v25
  v_add_f32 v38, v26, v27
  v_pk_add_f32 v[28:29], v[72:73], v[74:75]
  v_pk_mul_f32 v[30:31], v[72:73], v[72:73]
  v_pk_fma_f32 v[30:31], v[74:75], v[74:75], v[30:31]
  v_pk_add_f32 v[28:29], v[28:29], v[76:77]
  v_pk_fma_f32 v[30:31], v[76:77], v[76:77], v[30:31]
  v_pk_add_f32 v[28:29], v[28:29], v[78:79]
  v_pk_fma_f32 v[30:31], v[78:79], v[78:79], v[30:31]
  v_add_f32 v35, v28, v29
  v_add_f32 v39, v30, v31
  v_permlane16_swap_b32 v32, v33
  v_permlane16_swap_b32 v34, v35
  v_permlane16_swap_b32 v36, v37
  v_permlane16_swap_b32 v38, v39
  v_add_f32 v32, v32, v33
  v_add_f32 v34, v34, v35
  v_add_f32 v36, v36, v37
  v_add_f32 v38, v38, v39
  v_permlane32_swap_b32 v32, v34
  s_nop 0
  v_permlane32_swap_b32 v36, v38
  v_add_f32 v40, v32, v34
  v_add_f32 v41, v36, v38
  ds_write_b64 v185, v[40:41]
  s_lshl_b32 s32, s28, 15
  s_lshl_b32 s40, s29, 10
  s_add_u32 s32, s32, s40
  s_add_u32 s32, s32, 512
  v_cvt_pk_bf16_f32 v96, v48, v49
  v_cvt_pk_bf16_f32 v97, v50, v51
  v_cvt_pk_bf16_f32 v98, v52, v53
  v_cvt_pk_bf16_f32 v99, v54, v55
  ds_write_b128 v189, v[96:99] offset:0
  v_cvt_pk_bf16_f32 v100, v56, v57
  v_cvt_pk_bf16_f32 v101, v58, v59
  v_cvt_pk_bf16_f32 v102, v60, v61
  v_cvt_pk_bf16_f32 v103, v62, v63
  ds_write_b128 v189, v[100:103] offset:4352
  v_cvt_pk_bf16_f32 v104, v64, v65
  v_cvt_pk_bf16_f32 v105, v66, v67
  v_cvt_pk_bf16_f32 v106, v68, v69
  v_cvt_pk_bf16_f32 v107, v70, v71
  ds_write_b128 v189, v[104:107] offset:8704
  v_cvt_pk_bf16_f32 v108, v72, v73
  v_cvt_pk_bf16_f32 v109, v74, v75
  v_cvt_pk_bf16_f32 v110, v76, v77
  v_cvt_pk_bf16_f32 v111, v78, v79
  ds_write_b128 v189, v[108:111] offset:13056
  s_waitcnt lgkmcnt(0)
  s_barrier
  s_cmp_lg_u32 s4, 0
  s_cbranch_scc1 C_nost
  ds_read_b64 v[44:45], v185 offset:512
  ds_read_b64 v[46:47], v185 offset:1024
  ds_read_b64 v[18:19], v185 offset:1536
  s_waitcnt lgkmcnt(0)
  v_pk_add_f32 v[40:41], v[40:41], v[44:45]
  v_pk_add_f32 v[46:47], v[46:47], v[18:19]
  v_pk_add_f32 v[40:41], v[40:41], v[46:47]
  buffer_store_dwordx2 v[40:41], v184, s[12:15], s32 offen sc0 sc1
C_nost:
  s_nop 1
  ds_read_b128 v[96:99], v190 offset:0
  ds_read_b128 v[100:103], v190 offset:1088
  ds_read_b128 v[104:107], v190 offset:2176
  ds_read_b128 v[108:111], v190 offset:3264
  s_waitcnt lgkmcnt(3)
  buffer_store_dwordx4 v[96:99], v186, s[24:27], 0 offen offset:0 sc0 sc1
  s_waitcnt lgkmcnt(2)
  buffer_store_dwordx4 v[100:103], v186, s[24:27], 0 offen offset:1024 sc0 sc1
  s_waitcnt lgkmcnt(1)
  buffer_store_dwordx4 v[104:107], v186, s[24:27], 0 offen offset:2048 sc0 sc1
  s_waitcnt lgkmcnt(0)
  buffer_store_dwordx4 v[108:111], v186, s[24:27], 0 offen offset:3072 sc0 sc1
  s_lshr_b32 s32, s2, 3
  s_lshr_b32 s5, s32, 3
  s_and_b32 s6, s32, 7
  s_lshl_b32 s7, s5, 1
  s_add_u32 s7, s7, s6
  s_and_b32 s7, s7, 7
  s_and_b32 s32, s2, 7
  s_lshr_b32 s28, s32, 1
  s_lshl_b32 s28, s28, 2
  s_add_u32 s28, s28, s5
  s_and_b32 s29, s32, 1
  s_mul_i32 s29, s29, 8
  s_add_u32 s29, s29, s6
  s_mov_b32 s30, 7
  s_mov_b32 s31, -1
  v_and_b32 v4, 15, v0
  v_lshrrev_b32 v5, 4, v0
  v_lshrrev_b32 v6, 2, v4
  v_and_b32 v7, 3, v0
  v_lshrrev_b32 v3, 5, v0
  v_and_b32 v2, 1, v5
  v_lshl_or_b32 v3, v2, 1, v3
  v_lshl_add_u32 v21, v5, 3, v6
  v_lshlrev_b32 v21, 7, v21
  v_lshl_add_u32 v21, v7, 3, v21
  v_lshrrev_b32 v22, 1, v6
  v_lshl_or_b32 v22, v2, 1, v22
  v_lshl_add_u32 v21, v22, 5, v21
  v_add_u32 v21, 18432, v21
  v_xor_b32 v8, 0, v21
  s_lshl_b32 s32, s4, 5
  v_xor_b32 v8, s32, v8
  v_lshrrev_b32 v21, 1, v4
  v_xor_b32 v21, v21, v5
  v_lshlrev_b32 v21, 4, v21
  v_lshlrev_b32 v22, 7, v4
  v_add_u32 v9, v21, v22
  v_xor_b32 v10, 64, v9
  v_and_b32 v21, 1, v4
  v_mul_u32_u24 v21, 28800, v21
  v_lshrrev_b32 v22, 1, v4
  v_mul_u32_u24 v22, 400, v22
  v_lshlrev_b32 v23, 3, v5
  v_add3_u32 v11, v21, v22, v23
  s_add_u32 s32, s32, 43008
  v_add_u32 v11, s32, v11
  v_lshlrev_b32 v12, 3, v4
  v_add_u32 v12, 129024, v12
  v_mov_b64 v[112:113], 0
  v_mov_b64 v[114:115], 0
  v_mov_b64 v[116:117], 0
  v_mov_b64 v[118:119], 0
  v_mov_b64 v[120:121], 0
  v_mov_b64 v[122:123], 0
  v_mov_b64 v[124:125], 0
  v_mov_b64 v[126:127], 0
  v_mov_b64 v[128:129], 0
  v_mov_b64 v[130:131], 0
  v_mov_b64 v[132:133], 0
  v_mov_b64 v[134:135], 0
  v_mov_b64 v[136:137], 0
  v_mov_b64 v[138:139], 0
  v_mov_b64 v[140:141], 0
  v_mov_b64 v[142:143], 0
  v_mov_b64 v[144:145], 0
  v_mov_b64 v[146:147], 0
  v_mov_b64 v[148:149], 0
  v_mov_b64 v[150:151], 0
  v_mov_b64 v[152:153], 0
  v_mov_b64 v[154:155], 0
  v_mov_b64 v[156:157], 0
  v_mov_b64 v[158:159], 0
  v_mov_b64 v[160:161], 0
  v_mov_b64 v[162:163], 0
  v_mov_b64 v[164:165], 0
  v_mov_b64 v[166:167], 0
  v_mov_b64 v[168:169], 0
  v_mov_b64 v[170:171], 0
  v_mov_b64 v[172:173], 0
  v_mov_b64 v[174:175], 0
  v_mov_b64 v[176:177], 0
  v_mov_b64 v[178:179], 0
  v_mov_b64 v[180:181], 0
  v_mov_b64 v[182:183], 0
  v_mov_b64 v[184:185], 0
  v_mov_b64 v[186:187], 0
  v_mov_b64 v[188:189], 0
  v_mov_b64 v[190:191], 0
  v_mov_b64 v[192:193], 0
  v_mov_b64 v[194:195], 0
  v_mov_b64 v[196:197], 0
  v_mov_b64 v[198:199], 0
  v_mov_b64 v[200:201], 0
  v_mov_b64 v[202:203], 0
  v_mov_b64 v[204:205], 0
  v_mov_b64 v[206:207], 0
  v_mov_b64 v[208:209], 0
  v_mov_b64 v[210:211], 0
  v_mov_b64 v[212:213], 0
  v_mov_b64 v[214:215], 0
  v_mov_b64 v[216:217], 0
  v_mov_b64 v[218:219], 0
  s_waitcnt vmcnt(0)
  s_barrier
  s_mov_b32 s16, s66
  s_mov_b32 s17, s67
  s_mov_b32 s18, 6291456
  s_mov_b32 s19, 0x20000
  s_lshr_b32 s32, s2, 3
  s_lshl_b32 s32, s32, 1
  s_add_u32 s32, s32, s4
  s_sub_u32 s32, s32, 1
  s_lshl_b32 s32, s32, 6
  v_add_u32 v16, s32, v0
  v_mul_u32_u24 v17, 21846, v16
  v_lshrrev_b32 v17, 16, v17
  v_mul_u32_u24 v18, 3, v17
  v_sub_u32 v18, v16, v18
  v_mul_u32_u24 v17, 6144, v17
  v_lshl_add_u32 v14, v18, 11, v17
  s_and_b32 s32, s2, 1
  s_lshl_b32 s32, s32, 10
  s_add_u32 s32, s32, 384
  s_sub_u32 s40, s4, 1
  s_cmp_lt_u32 s40, 2
  s_cselect_b32 s18, s18, 0
  buffer_load_dword v15, v14, s[16:19], s32 offen
  s_barrier
  s_mov_b32 s3, 1
  s_mov_b32 s51, 9
  s_add_u32 s82, s84, 50331648
  s_addc_u32 s83, s85, 0
  s_branch C_top1
C_end:
  s_endpgm
L_start:
  s_nop 7
  s_nop 7
  s_sub_u32 s57, s4, 4
  v_and_b32 v134, 3, v0
  v_lshlrev_b32 v134, 6, v134
  s_lshr_b32 s32, s2, 3
  s_lshr_b32 s5, s32, 3
  s_and_b32 s6, s32, 7
  s_lshl_b32 s7, s5, 1
  s_add_u32 s7, s7, s6
  s_and_b32 s7, s7, 7
  s_and_b32 s32, s2, 7
  s_lshr_b32 s28, s32, 1
  s_lshl_b32 s28, s28, 2
  s_add_u32 s28, s28, s5
  s_and_b32 s29, s32, 1
  s_mul_i32 s29, s29, 8
  s_add_u32 s29, s29, s6
  s_mov_b32 s30, 7
  s_mov_b32 s31, -1
  s_mov_b32 s41, s57
  s_mul_i32 s32, s41, 16
  s_add_u32 s32, s32, 0
  v_lshrrev_b32 v2, 3, v0
  v_add_u32 v2, s32, v2
  v_bfe_u32 v3, v2, 1, 1
  v_bfe_u32 v4, v2, 3, 1
  v_lshl_or_b32 v3, v4, 1, v3
  v_lshlrev_b32 v3, 1, v3
  v_and_b32 v4, 7, v0
  v_xor_b32 v3, v3, v4
  v_lshlrev_b32 v3, 4, v3
  s_mov_b32 s32, 6144
  v_mul_lo_u32 v2, v2, s32
  v_add_u32 v13, v2, v3
  s_mul_i32 s32, s41, 16
  s_add_u32 s32, s32, 8
  v_lshrrev_b32 v2, 3, v0
  v_add_u32 v2, s32, v2
  v_bfe_u32 v3, v2, 1, 1
  v_bfe_u32 v4, v2, 3, 1
  v_lshl_or_b32 v3, v4, 1, v3
  v_lshlrev_b32 v3, 1, v3
  v_and_b32 v4, 7, v0
  v_xor_b32 v3, v3, v4
  v_lshlrev_b32 v3, 4, v3
  s_mov_b32 s32, 6144
  v_mul_lo_u32 v2, v2, s32
  v_add_u32 v14, v2, v3
  v_subrev_u32 v14, 1024, v14
  v_add_u32 v15, 2048, v13
  v_add_u32 v16, 2048, v14
  v_add_u32 v17, 4096, v13
  v_add_u32 v18, 4096, v14
  s_lshl_b32 s46, s41, 11
  s_add_u32 s46, s46, 18432
  s_add_u32 s47, s46, 8192
  s_add_u32 s48, s46, 16384
  s_lshl_b32 s35, s29, 7
  s_lshl_b32 s40, s28, 7
  s_sub_u32 s40, s40, 16
  s_lshl_b32 s32, s41, 5
  s_add_u32 s32, s32, 16
  v_lshrrev_b32 v2, 3, v0
  v_add_u32 v2, s32, v2
  v_bfe_u32 v3, v2, 1, 3
  v_and_b32 v4, 7, v0
  v_xor_b32 v3, v3, v4
  v_lshlrev_b32 v3, 4, v3
  v_add_u32 v2, s40, v2
  v_max_i32 v2, 0, v2
  v_lshlrev_b32 v2, 11, v2
  v_add_u32 v8, v2, v3
  v_add_u32 v10, 30720, v8
  s_lshl_b32 s32, s41, 5
  s_add_u32 s32, s32, 24
  v_lshrrev_b32 v2, 3, v0
  v_add_u32 v2, s32, v2
  v_bfe_u32 v3, v2, 1, 3
  v_and_b32 v4, 7, v0
  v_xor_b32 v3, v3, v4
  v_lshlrev_b32 v3, 4, v3
  v_add_u32 v2, s40, v2
  v_max_i32 v2, 0, v2
  v_lshlrev_b32 v2, 11, v2
  v_add_u32 v9, v2, v3
  v_subrev_u32 v9, 1024, v9
  v_add_u32 v11, 30720, v9
  s_lshl_b32 s32, s41, 3
  v_lshrrev_b32 v2, 3, v0
  v_add_u32 v2, s32, v2
  v_bfe_u32 v3, v2, 1, 3
  v_and_b32 v4, 7, v0
  v_xor_b32 v3, v3, v4
  v_lshlrev_b32 v3, 4, v3
  v_add_u32 v2, s40, v2
  v_max_i32 v2, 0, v2
  v_lshlrev_b32 v2, 11, v2
  v_add_u32 v12, v2, v3
  s_lshl_b32 s44, s41, 12
  s_add_u32 s44, s44, 2048
  s_lshl_b32 s45, s41, 10
  s_mov_b32 s34, 0
  s_mov_b32 s54, 128
  s_cmp_eq_u32 s41, 0
  s_cselect_b32 s52, 0xffffff00, -1
  s_mov_b32 s53, -1
  v_mov_b32 v20, 0x3f803f80
  v_mov_b32 v21, v20
  v_mov_b32 v22, v20
  v_mov_b32 v23, v20
  v_lshlrev_b32 v24, 4, v0
  v_add_u32 v25, 86016, v24
  s_mov_b64 exec, 0xff
  ds_write_b128 v24, v[20:23]
  ds_write_b128 v24, v[20:23] offset:43008
  ds_write_b128 v25, v[20:23]
  s_mov_b64 exec, -1
  s_lshl_b32 s32, s41, 6
  v_add_u32 v26, s32, v0
  v_min_u32 v26, 143, v26
  v_add_u32 v27, s40, v26
  v_max_i32 v27, 0, v27
  v_lshrrev_b32 v2, 6, v27
  v_and_b32 v27, 63, v27
  v_lshlrev_b32 v27, 3, v27
  v_lshl_add_u32 v27, v2, 10, v27
  v_add_u32 v27, 512, v27
  v_lshlrev_b32 v26, 3, v26
  v_add_u32 v26, 129024, v26
  s_lshl_b32 s32, s2, 3
  s_lshl_b32 s40, s57, 1
  s_add_u32 s32, s32, s40
  v_lshrrev_b32 v72, 5, v0
  v_add_u32 v72, s32, v72
  v_lshlrev_b32 v46, 11, v72
  v_and_b32 v2, 31, v0
  v_lshl_add_u32 v46, v2, 4, v46
  v_lshrrev_b32 v2, 6, v72
  v_and_b32 v72, 63, v72
  v_lshlrev_b32 v72, 3, v72
  v_lshl_add_u32 v72, v2, 10, v72
  v_add_u32 v72, 42992128, v72
  s_cmp_eq_u32 s57, 0
  s_cselect_b32 s58, 0, -1
  v_mov_b32 v64, s58
  v_mov_b32 v65, s58
  v_mov_b32 v66, s58
  v_mov_b32 v67, s58
  v_lshrrev_b32 v2, 3, v0
  v_lshlrev_b32 v2, 15, v2
  v_and_b32 v3, 7, v0
  v_lshl_add_u32 v2, v3, 4, v2
  v_lshrrev_b32 v4, 4, v0
  v_and_b32 v3, 15, v0
  v_lshlrev_b32 v3, 4, v3
  v_lshl_add_u32 v3, v4, 8, v3
  s_cselect_b64 vcc, -1, 0
  s_lshl_b32 s58, s2, 7
  s_add_u32 s58, s58, 109051904
  s_lshl_b32 s59, s2, 10
  s_add_u32 s59, s59, 41943040
  s_cmp_eq_u32 s57, 0
  s_cselect_b32 s58, s58, s59
  s_add_u32 s59, s59, 50331648
  s_cmp_eq_u32 s57, 2
  s_cselect_b32 s58, s59, s58
  s_lshr_b32 s59, s2, 2
  s_mul_i32 s59, s59, 50331648
  s_and_b32 s32, s2, 3
  s_lshl_b32 s32, s32, 10
  s_add_u32 s59, s59, s32
  s_add_u32 s59, s59, 42205184
  s_cmp_lt_u32 s2, 8
  s_cselect_b32 s59, s59, 134217728
  s_cmp_eq_u32 s57, 3
  s_cselect_b32 s58, s59, s58
  v_cndmask_b32 v47, v3, v2, vcc
  s_and_b32 s59, s2, 3
  s_lshl_b32 s59, s59, 6
  v_mov_b32 v73, s59
  v_mov_b32 v74, 1
  s_lshl_b32 s56, s3, 10
  s_mul_i32 s32, s28, 16
  s_add_u32 s56, s56, s32
  s_add_u32 s56, s56, s29
  s_add_u32 s56, s56, 0
  s_lshl_b32 s56, s56, 7
  s_mov_b32 s38, 0
  s_waitcnt lgkmcnt(0)
  s_mov_b32 s8, s64
  s_mov_b32 s9, s65
  s_mov_b32 s10, 4194304
  s_mov_b32 s11, 0x20000
  s_mov_b32 s12, s66
  s_mov_b32 s13, s67
  s_mov_b32 s14, 6291456
  s_mov_b32 s15, 0x20000
  s_branch L_first
L_top:
  s_nop 7
  s_nop 7
  s_lshl_b32 s56, s3, 10
  s_mul_i32 s32, s28, 16
  s_add_u32 s56, s56, s32
  s_add_u32 s56, s56, s29
  s_add_u32 s56, s56, 0
  s_lshl_b32 s56, s56, 7
  s_mov_b32 s24, s72
  s_mov_b32 s25, s73
  s_mov_b32 s26, 14680064
  s_mov_b32 s27, 0x20000
  s_cmp_ge_u32 s57, 2
  s_cbranch_scc1 L_k1B
  s_mov_b32 s30, 7
  s_mov_b32 s31, -1
  s_mov_b32 s38, 0
  s_add_u32 s30, s30, 1
  s_and_b32 s30, s30, 7
  s_cselect_b32 s32, 0, 1
  s_add_u32 s31, s31, s32
  s_sub_u32 s32, s30, s7
  s_and_b32 s32, s32, 7
  s_cmp_lt_u32 s32, 2
  s_cselect_b32 s32, 1, 0
  s_add_u32 s32, s32, s31
  s_cmp_ge_u32 s32, 2
  s_cselect_b32 s32, 0, s32
  s_lshl_b32 s33, s32, 3
  s_add_u32 s33, s33, s30
  s_mul_i32 s36, s33, s54
  s_add_u32 s36, s36, s34
  s_add_u32 m0, s38, s45
  s_mov_b64 exec, s[52:53]
  buffer_load_dwordx4 v12, s[8:11], s36 offen offset:0 sc1 lds
  s_mov_b64 exec, -1
  s_add_u32 m0, s38, s44
  s_nop 0
  buffer_load_dwordx4 v8, s[8:11], s36 offen offset:0 sc1 lds
  buffer_load_dwordx4 v9, s[8:11], s36 offen offset:1024 sc1 lds
  buffer_load_dwordx4 v10, s[8:11], s36 offen offset:2048 sc1 lds
  buffer_load_dwordx4 v11, s[8:11], s36 offen offset:3072 sc1 lds
  s_add_u32 s38, s38, 43008
  s_cmp_eq_u32 s38, 129024
  s_cselect_b32 s38, 0, s38
  s_add_u32 s30, s30, 1
  s_and_b32 s30, s30, 7
  s_cselect_b32 s32, 0, 1
  s_add_u32 s31, s31, s32
  s_sub_u32 s32, s30, s7
  s_and_b32 s32, s32, 7
  s_cmp_lt_u32 s32, 2
  s_cselect_b32 s32, 1, 0
  s_add_u32 s32, s32, s31
  s_cmp_ge_u32 s32, 2
  s_cselect_b32 s32, 0, s32
  s_lshl_b32 s33, s32, 3
  s_add_u32 s33, s33, s30
  s_mul_i32 s36, s33, s54
  s_add_u32 s36, s36, s34
  s_add_u32 m0, s38, s45
  s_mov_b64 exec, s[52:53]
  buffer_load_dwordx4 v12, s[8:11], s36 offen offset:0 sc1 lds
  s_mov_b64 exec, -1
  s_add_u32 m0, s38, s44
  s_nop 0
  buffer_load_dwordx4 v8, s[8:11], s36 offen offset:0 sc1 lds
  buffer_load_dwordx4 v9, s[8:11], s36 offen offset:1024 sc1 lds
  buffer_load_dwordx4 v10, s[8:11], s36 offen offset:2048 sc1 lds
  buffer_load_dwordx4 v11, s[8:11], s36 offen offset:3072 sc1 lds
  s_add_u32 s38, s38, 43008
  s_cmp_eq_u32 s38, 129024
  s_cselect_b32 s38, 0, s38
  s_waitcnt vmcnt(5)
  s_barrier
  s_add_u32 s30, s30, 1
  s_and_b32 s30, s30, 7
  s_cselect_b32 s32, 0, 1
  s_add_u32 s31, s31, s32
  s_sub_u32 s32, s30, s7
  s_and_b32 s32, s32, 7
  s_cmp_lt_u32 s32, 2
  s_cselect_b32 s32, 1, 0
  s_add_u32 s32, s32, s31
  s_cmp_ge_u32 s32, 2
  s_cselect_b32 s32, 0, s32
  s_lshl_b32 s33, s32, 3
  s_add_u32 s33, s33, s30
  s_mul_i32 s36, s33, s54
  s_add_u32 s36, s36, s34
  s_mul_i32 s37, s33, 393216
  s_add_u32 s37, s37, s35
  s_add_u32 m0, s38, s45
  s_mov_b64 exec, s[52:53]
  buffer_load_dwordx4 v12, s[8:11], s36 offen offset:0 sc1 lds
  s_mov_b64 exec, -1
  s_add_u32 m0, s38, s44
  s_nop 0
  buffer_load_dwordx4 v8, s[8:11], s36 offen offset:0 sc1 lds
  buffer_load_dwordx4 v9, s[8:11], s36 offen offset:1024 sc1 lds
  buffer_load_dwordx4 v10, s[8:11], s36 offen offset:2048 sc1 lds
  buffer_load_dwordx4 v11, s[8:11], s36 offen offset:3072 sc1 lds
  s_add_u32 m0, s38, s46
  s_nop 0
  buffer_load_dwordx4 v13, s[12:15], s37 offen offset:0  lds
  buffer_load_dwordx4 v14, s[12:15], s37 offen offset:1024  lds
  s_add_u32 m0, s38, s47
  s_nop 0
  buffer_load_dwordx4 v15, s[12:15], s37 offen offset:0  lds
  buffer_load_dwordx4 v16, s[12:15], s37 offen offset:1024  lds
  s_add_u32 m0, s38, s48
  s_nop 0
  buffer_load_dwordx4 v17, s[12:15], s37 offen offset:0  lds
  buffer_load_dwordx4 v18, s[12:15], s37 offen offset:1024  lds
  s_add_u32 s38, s38, 43008
  s_cmp_eq_u32 s38, 129024
  s_cselect_b32 s38, 0, s38
L_jA:
  s_nop 1
  s_waitcnt vmcnt(11)
  s_barrier
  s_add_u32 s30, s30, 1
  s_and_b32 s30, s30, 7
  s_cselect_b32 s32, 0, 1
  s_add_u32 s31, s31, s32
  s_sub_u32 s32, s30, s7
  s_and_b32 s32, s32, 7
  s_cmp_lt_u32 s32, 2
  s_cselect_b32 s32, 1, 0
  s_add_u32 s32, s32, s31
  s_cmp_ge_u32 s32, 2
  s_cselect_b32 s32, 0, s32
  s_lshl_b32 s33, s32, 3
  s_add_u32 s33, s33, s30
  s_mul_i32 s36, s33, s54
  s_add_u32 s36, s36, s34
  s_mul_i32 s37, s33, 393216
  s_add_u32 s37, s37, s35
  s_add_u32 m0, s38, s45
  s_mov_b64 exec, s[52:53]
  buffer_load_dwordx4 v12, s[8:11], s36 offen offset:0 sc1 lds
  s_mov_b64 exec, -1
  s_add_u32 m0, s38, s44
  s_nop 0
  buffer_load_dwordx4 v8, s[8:11], s36 offen offset:0 sc1 lds
  buffer_load_dwordx4 v9, s[8:11], s36 offen offset:1024 sc1 lds
  buffer_load_dwordx4 v10, s[8:11], s36 offen offset:2048 sc1 lds
  buffer_load_dwordx4 v11, s[8:11], s36 offen offset:3072 sc1 lds
  s_add_u32 m0, s38, s46
  s_nop 0
  buffer_load_dwordx4 v13, s[12:15], s37 offen offset:0  lds
  buffer_load_dwordx4 v14, s[12:15], s37 offen offset:1024  lds
  s_add_u32 m0, s38, s47
  s_nop 0
  buffer_load_dwordx4 v15, s[12:15], s37 offen offset:0  lds
  buffer_load_dwordx4 v16, s[12:15], s37 offen offset:1024  lds
  s_add_u32 m0, s38, s48
  s_nop 0
  buffer_load_dwordx4 v17, s[12:15], s37 offen offset:0  lds
  buffer_load_dwordx4 v18, s[12:15], s37 offen offset:1024  lds
  s_add_u32 s38, s38, 43008
  s_cmp_eq_u32 s38, 129024
  s_cselect_b32 s38, 0, s38
  s_waitcnt vmcnt(11)
  s_barrier
  s_add_u32 s30, s30, 1
  s_and_b32 s30, s30, 7
  s_cselect_b32 s32, 0, 1
  s_add_u32 s31, s31, s32
  s_sub_u32 s32, s30, s7
  s_and_b32 s32, s32, 7
  s_cmp_lt_u32 s32, 2
  s_cselect_b32 s32, 1, 0
  s_add_u32 s32, s32, s31
  s_cmp_ge_u32 s32, 2
  s_cselect_b32 s32, 0, s32
  s_lshl_b32 s33, s32, 3
  s_add_u32 s33, s33, s30
  s_mul_i32 s36, s33, s54
  s_add_u32 s36, s36, s34
  s_mul_i32 s37, s33, 393216
  s_add_u32 s37, s37, s35
  s_add_u32 m0, s38, s45
  s_mov_b64 exec, s[52:53]
  buffer_load_dwordx4 v12, s[8:11], s36 offen offset:0 sc1 lds
  s_mov_b64 exec, -1
  s_add_u32 m0, s38, s44
  s_nop 0
  buffer_load_dwordx4 v8, s[8:11], s36 offen offset:0 sc1 lds
  buffer_load_dwordx4 v9, s[8:11], s36 offen offset:1024 sc1 lds
  buffer_load_dwordx4 v10, s[8:11], s36 offen offset:2048 sc1 lds
  buffer_load_dwordx4 v11, s[8:11], s36 offen offset:3072 sc1 lds
  s_add_u32 m0, s38, s46
  s_nop 0
  buffer_load_dwordx4 v13, s[12:15], s37 offen offset:0  lds
  buffer_load_dwordx4 v14, s[12:15], s37 offen offset:1024  lds
  s_add_u32 m0, s38, s47
  s_nop 0
  buffer_load_dwordx4 v15, s[12:15], s37 offen offset:0  lds
  buffer_load_dwordx4 v16, s[12:15], s37 offen offset:1024  lds
  s_add_u32 m0, s38, s48
  s_nop 0
  buffer_load_dwordx4 v17, s[12:15], s37 offen offset:0  lds
  buffer_load_dwordx4 v18, s[12:15], s37 offen offset:1024  lds
  s_add_u32 s38, s38, 43008
  s_cmp_eq_u32 s38, 129024
  s_cselect_b32 s38, 0, s38
  s_cmp_lg_u32 s3, 0
  s_cbranch_scc1 e7
  s_cmp_lg_u32 s57, 0
  s_cbranch_scc1 g8
  s_mov_b64 exec, 1
  global_atomic_add v73, v74, s[62:63] sc1
  s_mov_b64 exec, -1
g8:
e7:
  s_nop 1
  s_mov_b32 s39, 9
ll9:
  s_waitcnt vmcnt(11)
  s_barrier
  s_add_u32 s30, s30, 1
  s_and_b32 s30, s30, 7
  s_cselect_b32 s32, 0, 1
  s_add_u32 s31, s31, s32
  s_sub_u32 s32, s30, s7
  s_and_b32 s32, s32, 7
  s_cmp_lt_u32 s32, 2
  s_cselect_b32 s32, 1, 0
  s_add_u32 s32, s32, s31
  s_cmp_ge_u32 s32, 2
  s_cselect_b32 s32, 0, s32
  s_lshl_b32 s33, s32, 3
  s_add_u32 s33, s33, s30
  s_mul_i32 s36, s33, s54
  s_add_u32 s36, s36, s34
  s_mul_i32 s37, s33, 393216
  s_add_u32 s37, s37, s35
  s_add_u32 m0, s38, s45
  s_mov_b64 exec, s[52:53]
  buffer_load_dwordx4 v12, s[8:11], s36 offen offset:0 sc1 lds
  s_mov_b64 exec, -1
  s_add_u32 m0, s38, s44
  s_nop 0
  buffer_load_dwordx4 v8, s[8:11], s36 offen offset:0 sc1 lds
  buffer_load_dwordx4 v9, s[8:11], s36 offen offset:1024 sc1 lds
  buffer_load_dwordx4 v10, s[8:11], s36 offen offset:2048 sc1 lds
  buffer_load_dwordx4 v11, s[8:11], s36 offen offset:3072 sc1 lds
  s_add_u32 m0, s38, s46
  s_nop 0
  buffer_load_dwordx4 v13, s[12:15], s37 offen offset:0  lds
  buffer_load_dwordx4 v14, s[12:15], s37 offen offset:1024  lds
  s_add_u32 m0, s38, s47
  s_nop 0
  buffer_load_dwordx4 v15, s[12:15], s37 offen offset:0  lds
  buffer_load_dwordx4 v16, s[12:15], s37 offen offset:1024  lds
  s_add_u32 m0, s38, s48
  s_nop 0
  buffer_load_dwordx4 v17, s[12:15], s37 offen offset:0  lds
  buffer_load_dwordx4 v18, s[12:15], s37 offen offset:1024  lds
  s_add_u32 s38, s38, 43008
  s_cmp_eq_u32 s38, 129024
  s_cselect_b32 s38, 0, s38
  s_sub_u32 s39, s39, 1
  s_cmp_lg_u32 s39, 0
  s_cbranch_scc1 ll9
  s_waitcnt vmcnt(11)
  s_barrier
  s_add_u32 s30, s30, 1
  s_and_b32 s30, s30, 7
  s_cselect_b32 s32, 0, 1
  s_add_u32 s31, s31, s32
  s_sub_u32 s32, s30, s7
  s_and_b32 s32, s32, 7
  s_cmp_lt_u32 s32, 2
  s_cselect_b32 s32, 1, 0
  s_add_u32 s32, s32, s31
  s_cmp_ge_u32 s32, 2
  s_cselect_b32 s32, 0, s32
  s_lshl_b32 s33, s32, 3
  s_add_u32 s33, s33, s30
  s_mul_i32 s36, s33, s54
  s_add_u32 s36, s36, s34
  s_mul_i32 s37, s33, 393216
  s_add_u32 s37, s37, s35
  s_add_u32 m0, s38, s45
  s_mov_b64 exec, s[52:53]
  buffer_load_dwordx4 v12, s[8:11], s36 offen offset:0 sc1 lds
  s_mov_b64 exec, -1
  s_add_u32 m0, s38, s44
  s_nop 0
  buffer_load_dwordx4 v8, s[8:11], s36 offen offset:0 sc1 lds
  buffer_load_dwordx4 v9, s[8:11], s36 offen offset:1024 sc1 lds
  buffer_load_dwordx4 v10, s[8:11], s36 offen offset:2048 sc1 lds
  buffer_load_dwordx4 v11, s[8:11], s36 offen offset:3072 sc1 lds
  s_add_u32 m0, s38, s46
  s_nop 0
  buffer_load_dwordx4 v13, s[12:15], s37 offen offset:0  lds
  buffer_load_dwordx4 v14, s[12:15], s37 offen offset:1024  lds
  s_add_u32 m0, s38, s47
  s_nop 0
  buffer_load_dwordx4 v15, s[12:15], s37 offen offset:0  lds
  buffer_load_dwordx4 v16, s[12:15], s37 offen offset:1024  lds
  s_add_u32 m0, s38, s48
  s_nop 0
  buffer_load_dwordx4 v17, s[12:15], s37 offen offset:0  lds
  buffer_load_dwordx4 v18, s[12:15], s37 offen offset:1024  lds
  s_add_u32 s38, s38, 43008
  s_cmp_eq_u32 s38, 129024
  s_cselect_b32 s38, 0, s38
  global_load_dword v29, v134, s[62:63] sc0 sc1
  s_waitcnt vmcnt(11)
  s_barrier
  s_add_u32 s30, s30, 1
  s_and_b32 s30, s30, 7
  s_cselect_b32 s32, 0, 1
  s_add_u32 s31, s31, s32
  s_sub_u32 s32, s30, s7
  s_and_b32 s32, s32, 7
  s_cmp_lt_u32 s32, 2
  s_cselect_b32 s32, 1, 0
  s_add_u32 s32, s32, s31
  s_cmp_ge_u32 s32, 2
  s_cselect_b32 s32, 0, s32
  s_lshl_b32 s33, s32, 3
  s_add_u32 s33, s33, s30
  s_mul_i32 s36, s33, s54
  s_add_u32 s36, s36, s34
  s_mul_i32 s37, s33, 393216
  s_add_u32 s37, s37, s35
  s_add_u32 m0, s38, s45
  s_mov_b64 exec, s[52:53]
  buffer_load_dwordx4 v12, s[8:11], s36 offen offset:0 sc1 lds
  s_mov_b64 exec, -1
  s_add_u32 m0, s38, s44
  s_nop 0
  buffer_load_dwordx4 v8, s[8:11], s36 offen offset:0 sc1 lds
  buffer_load_dwordx4 v9, s[8:11], s36 offen offset:1024 sc1 lds
  buffer_load_dwordx4 v10, s[8:11], s36 offen offset:2048 sc1 lds
  buffer_load_dwordx4 v11, s[8:11], s36 offen offset:3072 sc1 lds
  s_add_u32 m0, s38, s46
  s_nop 0
  buffer_load_dwordx4 v13, s[12:15], s37 offen offset:0  lds
  buffer_load_dwordx4 v14, s[12:15], s37 offen offset:1024  lds
  s_add_u32 m0, s38, s47
  s_nop 0
  buffer_load_dwordx4 v15, s[12:15], s37 offen offset:0  lds
  buffer_load_dwordx4 v16, s[12:15], s37 offen offset:1024  lds
  s_add_u32 m0, s38, s48
  s_nop 0
  buffer_load_dwordx4 v17, s[12:15], s37 offen offset:0  lds
  buffer_load_dwordx4 v18, s[12:15], s37 offen offset:1024  lds
  s_add_u32 s38, s38, 43008
  s_cmp_eq_u32 s38, 129024
  s_cselect_b32 s38, 0, s38
  s_cmp_lg_u32 s3, 0
  s_cbranch_scc1 st10g
  s_waitcnt vmcnt(11)
  s_mov_b32 s61, 0
st10p:
  v_cmp_gt_u32 vcc, 64, v29
  s_add_u32 s61, s61, 1
  s_cmp_gt_u32 s61, 1000000
  s_cbranch_scc1 st10g
  s_cbranch_vccz st10g
  global_load_dword v29, v134, s[62:63] sc0 sc1
  s_waitcnt vmcnt(0)
  s_branch st10p
st10g:
  buffer_load_dwordx2 v[30:31], v27, s[20:23], 0 offen sc1
  s_mov_b32 s32, 32768
  buffer_load_dwordx2 v[32:33], v27, s[20:23], s32 offen sc1
  s_mov_b32 s32, 65536
  buffer_load_dwordx2 v[34:35], v27, s[20:23], s32 offen sc1
  s_mov_b32 s32, 98304
  buffer_load_dwordx2 v[36:37], v27, s[20:23], s32 offen sc1
  s_mov_b32 s32, 131072
  buffer_load_dwordx2 v[38:39], v27, s[20:23], s32 offen sc1
  s_mov_b32 s32, 163840
  buffer_load_dwordx2 v[40:41], v27, s[20:23], s32 offen sc1
  s_mov_b32 s32, 196608
  buffer_load_dwordx2 v[42:43], v27, s[20:23], s32 offen sc1
  s_mov_b32 s32, 229376
  buffer_load_dwordx2 v[44:45], v27, s[20:23], s32 offen sc1
  s_waitcnt vmcnt(19)
  s_barrier
  s_branch L_k1t
L_k1B:
  s_nop 7
  s_nop 7
  s_mov_b32 s30, 7
  s_mov_b32 s31, -1
  s_mov_b32 s38, 0
  s_add_u32 s30, s30, 1
  s_and_b32 s30, s30, 7
  s_cselect_b32 s32, 0, 1
  s_add_u32 s31, s31, s32
  s_sub_u32 s32, s30, s7
  s_and_b32 s32, s32, 7
  s_cmp_lt_u32 s32, 2
  s_cselect_b32 s32, 1, 0
  s_add_u32 s32, s32, s31
  s_cmp_ge_u32 s32, 2
  s_cselect_b32 s32, 0, s32
  s_lshl_b32 s33, s32, 3
  s_add_u32 s33, s33, s30
  s_mul_i32 s36, s33, s54
  s_add_u32 s36, s36, s34
  s_add_u32 m0, s38, s44
  s_nop 0
  buffer_load_dwordx4 v8, s[8:11], s36 offen offset:0 sc1 lds
  buffer_load_dwordx4 v9, s[8:11], s36 offen offset:1024 sc1 lds
  buffer_load_dwordx4 v10, s[8:11], s36 offen offset:2048 sc1 lds
  buffer_load_dwordx4 v11, s[8:11], s36 offen offset:3072 sc1 lds
  s_add_u32 s38, s38, 43008
  s_cmp_eq_u32 s38, 129024
  s_cselect_b32 s38, 0, s38
  s_add_u32 s30, s30, 1
  s_and_b32 s30, s30, 7
  s_cselect_b32 s32, 0, 1
  s_add_u32 s31, s31, s32
  s_sub_u32 s32, s30, s7
  s_and_b32 s32, s32, 7
  s_cmp_lt_u32 s32, 2
  s_cselect_b32 s32, 1, 0
  s_add_u32 s32, s32, s31
  s_cmp_ge_u32 s32, 2
  s_cselect_b32 s32, 0, s32
  s_lshl_b32 s33, s32, 3
  s_add_u32 s33, s33, s30
  s_mul_i32 s36, s33, s54
  s_add_u32 s36, s36, s34
  s_add_u32 m0, s38, s44
  s_nop 0
  buffer_load_dwordx4 v8, s[8:11], s36 offen offset:0 sc1 lds
  buffer_load_dwordx4 v9, s[8:11], s36 offen offset:1024 sc1 lds
  buffer_load_dwordx4 v10, s[8:11], s36 offen offset:2048 sc1 lds
  buffer_load_dwordx4 v11, s[8:11], s36 offen offset:3072 sc1 lds
  s_add_u32 s38, s38, 43008
  s_cmp_eq_u32 s38, 129024
  s_cselect_b32 s38, 0, s38
  s_waitcnt vmcnt(4)
  s_barrier
  s_add_u32 s30, s30, 1
  s_and_b32 s30, s30, 7
  s_cselect_b32 s32, 0, 1
  s_add_u32 s31, s31, s32
  s_sub_u32 s32, s30, s7
  s_and_b32 s32, s32, 7
  s_cmp_lt_u32 s32, 2
  s_cselect_b32 s32, 1, 0
  s_add_u32 s32, s32, s31
  s_cmp_ge_u32 s32, 2
  s_cselect_b32 s32, 0, s32
  s_lshl_b32 s33, s32, 3
  s_add_u32 s33, s33, s30
  s_mul_i32 s36, s33, s54
  s_add_u32 s36, s36, s34
  s_mul_i32 s37, s33, 393216
  s_add_u32 s37, s37, s35
  s_add_u32 m0, s38, s44
  s_nop 0
  buffer_load_dwordx4 v8, s[8:11], s36 offen offset:0 sc1 lds
  buffer_load_dwordx4 v9, s[8:11], s36 offen offset:1024 sc1 lds
  buffer_load_dwordx4 v10, s[8:11], s36 offen offset:2048 sc1 lds
  buffer_load_dwordx4 v11, s[8:11], s36 offen offset:3072 sc1 lds
  s_add_u32 m0, s38, s46
  s_nop 0
  buffer_load_dwordx4 v13, s[12:15], s37 offen offset:0  lds
  buffer_load_dwordx4 v14, s[12:15], s37 offen offset:1024  lds
  s_add_u32 m0, s38, s47
  s_nop 0
  buffer_load_dwordx4 v15, s[12:15], s37 offen offset:0  lds
  buffer_load_dwordx4 v16, s[12:15], s37 offen offset:1024  lds
  s_add_u32 m0, s38, s48
  s_nop 0
  buffer_load_dwordx4 v17, s[12:15], s37 offen offset:0  lds
  buffer_load_dwordx4 v18, s[12:15], s37 offen offset:1024  lds
  s_add_u32 s38, s38, 43008
  s_cmp_eq_u32 s38, 129024
  s_cselect_b32 s38, 0, s38
L_jB:
  s_nop 1
  s_waitcnt vmcnt(10)
  s_barrier
  s_add_u32 s30, s30, 1
  s_and_b32 s30, s30, 7
  s_cselect_b32 s32, 0, 1
  s_add_u32 s31, s31, s32
  s_sub_u32 s32, s30, s7
  s_and_b32 s32, s32, 7
  s_cmp_lt_u32 s32, 2
  s_cselect_b32 s32, 1, 0
  s_add_u32 s32, s32, s31
  s_cmp_ge_u32 s32, 2
  s_cselect_b32 s32, 0, s32
  s_lshl_b32 s33, s32, 3
  s_add_u32 s33, s33, s30
  s_mul_i32 s36, s33, s54
  s_add_u32 s36, s36, s34
  s_mul_i32 s37, s33, 393216
  s_add_u32 s37, s37, s35
  s_add_u32 m0, s38, s44
  s_nop 0
  buffer_load_dwordx4 v8, s[8:11], s36 offen offset:0 sc1 lds
  buffer_load_dwordx4 v9, s[8:11], s36 offen offset:1024 sc1 lds
  buffer_load_dwordx4 v10, s[8:11], s36 offen offset:2048 sc1 lds
  buffer_load_dwordx4 v11, s[8:11], s36 offen offset:3072 sc1 lds
  s_add_u32 m0, s38, s46
  s_nop 0
  buffer_load_dwordx4 v13, s[12:15], s37 offen offset:0  lds
  buffer_load_dwordx4 v14, s[12:15], s37 offen offset:1024  lds
  s_add_u32 m0, s38, s47
  s_nop 0
  buffer_load_dwordx4 v15, s[12:15], s37 offen offset:0  lds
  buffer_load_dwordx4 v16, s[12:15], s37 offen offset:1024  lds
  s_add_u32 m0, s38, s48
  s_nop 0
  buffer_load_dwordx4 v17, s[12:15], s37 offen offset:0  lds
  buffer_load_dwordx4 v18, s[12:15], s37 offen offset:1024  lds
  s_add_u32 s38, s38, 43008
  s_cmp_eq_u32 s38, 129024
  s_cselect_b32 s38, 0, s38
  s_waitcnt vmcnt(10)
  s_barrier
  s_add_u32 s30, s30, 1
  s_and_b32 s30, s30, 7
  s_cselect_b32 s32, 0, 1
  s_add_u32 s31, s31, s32
  s_sub_u32 s32, s30, s7
  s_and_b32 s32, s32, 7
  s_cmp_lt_u32 s32, 2
  s_cselect_b32 s32, 1, 0
  s_add_u32 s32, s32, s31
  s_cmp_ge_u32 s32, 2
  s_cselect_b32 s32, 0, s32
  s_lshl_b32 s33, s32, 3
  s_add_u32 s33, s33, s30
  s_mul_i32 s36, s33, s54
  s_add_u32 s36, s36, s34
  s_mul_i32 s37, s33, 393216
  s_add_u32 s37, s37, s35
  s_add_u32 m0, s38, s44
  s_nop 0
  buffer_load_dwordx4 v8, s[8:11], s36 offen offset:0 sc1 lds
  buffer_load_dwordx4 v9, s[8:11], s36 offen offset:1024 sc1 lds
  buffer_load_dwordx4 v10, s[8:11], s36 offen offset:2048 sc1 lds
  buffer_load_dwordx4 v11, s[8:11], s36 offen offset:3072 sc1 lds
  s_add_u32 m0, s38, s46
  s_nop 0
  buffer_load_dwordx4 v13, s[12:15], s37 offen offset:0  lds
  buffer_load_dwordx4 v14, s[12:15], s37 offen offset:1024  lds
  s_add_u32 m0, s38, s47
  s_nop 0
  buffer_load_dwordx4 v15, s[12:15], s37 offen offset:0  lds
  buffer_load_dwordx4 v16, s[12:15], s37 offen offset:1024  lds
  s_add_u32 m0, s38, s48
  s_nop 0
  buffer_load_dwordx4 v17, s[12:15], s37 offen offset:0  lds
  buffer_load_dwordx4 v18, s[12:15], s37 offen offset:1024  lds
  s_add_u32 s38, s38, 43008
  s_cmp_eq_u32 s38, 129024
  s_cselect_b32 s38, 0, s38
  s_cmp_lg_u32 s3, 0
  s_cbranch_scc1 e11
  s_cmp_lg_u32 s57, 0
  s_cbranch_scc1 g12
  s_mov_b64 exec, 1
  global_atomic_add v73, v74, s[62:63] sc1
  s_mov_b64 exec, -1
g12:
e11:
  s_nop 1
  s_mov_b32 s39, 9
ll13:
  s_waitcnt vmcnt(10)
  s_barrier
  s_add_u32 s30, s30, 1
  s_and_b32 s30, s30, 7
  s_cselect_b32 s32, 0, 1
  s_add_u32 s31, s31, s32
  s_sub_u32 s32, s30, s7
  s_and_b32 s32, s32, 7
  s_cmp_lt_u32 s32, 2
  s_cselect_b32 s32, 1, 0
  s_add_u32 s32, s32, s31
  s_cmp_ge_u32 s32, 2
  s_cselect_b32 s32, 0, s32
  s_lshl_b32 s33, s32, 3
  s_add_u32 s33, s33, s30
  s_mul_i32 s36, s33, s54
  s_add_u32 s36, s36, s34
  s_mul_i32 s37, s33, 393216
  s_add_u32 s37, s37, s35
  s_add_u32 m0, s38, s44
  s_nop 0
  buffer_load_dwordx4 v8, s[8:11], s36 offen offset:0 sc1 lds
  buffer_load_dwordx4 v9, s[8:11], s36 offen offset:1024 sc1 lds
  buffer_load_dwordx4 v10, s[8:11], s36 offen offset:2048 sc1 lds
  buffer_load_dwordx4 v11, s[8:11], s36 offen offset:3072 sc1 lds
  s_add_u32 m0, s38, s46
  s_nop 0
  buffer_load_dwordx4 v13, s[12:15], s37 offen offset:0  lds
  buffer_load_dwordx4 v14, s[12:15], s37 offen offset:1024  lds
  s_add_u32 m0, s38, s47
  s_nop 0
  buffer_load_dwordx4 v15, s[12:15], s37 offen offset:0  lds
  buffer_load_dwordx4 v16, s[12:15], s37 offen offset:1024  lds
  s_add_u32 m0, s38, s48
  s_nop 0
  buffer_load_dwordx4 v17, s[12:15], s37 offen offset:0  lds
  buffer_load_dwordx4 v18, s[12:15], s37 offen offset:1024  lds
  s_add_u32 s38, s38, 43008
  s_cmp_eq_u32 s38, 129024
  s_cselect_b32 s38, 0, s38
  s_sub_u32 s39, s39, 1
  s_cmp_lg_u32 s39, 0
  s_cbranch_scc1 ll13
  s_waitcnt vmcnt(10)
  s_barrier
  s_add_u32 s30, s30, 1
  s_and_b32 s30, s30, 7
  s_cselect_b32 s32, 0, 1
  s_add_u32 s31, s31, s32
  s_sub_u32 s32, s30, s7
  s_and_b32 s32, s32, 7
  s_cmp_lt_u32 s32, 2
  s_cselect_b32 s32, 1, 0
  s_add_u32 s32, s32, s31
  s_cmp_ge_u32 s32, 2
  s_cselect_b32 s32, 0, s32
  s_lshl_b32 s33, s32, 3
  s_add_u32 s33, s33, s30
  s_mul_i32 s36, s33, s54
  s_add_u32 s36, s36, s34
  s_mul_i32 s37, s33, 393216
  s_add_u32 s37, s37, s35
  s_add_u32 m0, s38, s44
  s_nop 0
  buffer_load_dwordx4 v8, s[8:11], s36 offen offset:0 sc1 lds
  buffer_load_dwordx4 v9, s[8:11], s36 offen offset:1024 sc1 lds
  buffer_load_dwordx4 v10, s[8:11], s36 offen offset:2048 sc1 lds
  buffer_load_dwordx4 v11, s[8:11], s36 offen offset:3072 sc1 lds
  s_add_u32 m0, s38, s46
  s_nop 0
  buffer_load_dwordx4 v13, s[12:15], s37 offen offset:0  lds
  buffer_load_dwordx4 v14, s[12:15], s37 offen offset:1024  lds
  s_add_u32 m0, s38, s47
  s_nop 0
  buffer_load_dwordx4 v15, s[12:15], s37 offen offset:0  lds
  buffer_load_dwordx4 v16, s[12:15], s37 offen offset:1024  lds
  s_add_u32 m0, s38, s48
  s_nop 0
  buffer_load_dwordx4 v17, s[12:15], s37 offen offset:0  lds
  buffer_load_dwordx4 v18, s[12:15], s37 offen offset:1024  lds
  s_add_u32 s38, s38, 43008
  s_cmp_eq_u32 s38, 129024
  s_cselect_b32 s38, 0, s38
  global_load_dword v29, v134, s[62:63] sc0 sc1
  s_waitcnt vmcnt(10)
  s_barrier
  s_add_u32 s30, s30, 1
  s_and_b32 s30, s30, 7
  s_cselect_b32 s32, 0, 1
  s_add_u32 s31, s31, s32
  s_sub_u32 s32, s30, s7
  s_and_b32 s32, s32, 7
  s_cmp_lt_u32 s32, 2
  s_cselect_b32 s32, 1, 0
  s_add_u32 s32, s32, s31
  s_cmp_ge_u32 s32, 2
  s_cselect_b32 s32, 0, s32
  s_lshl_b32 s33, s32, 3
  s_add_u32 s33, s33, s30
  s_mul_i32 s36, s33, s54
  s_add_u32 s36, s36, s34
  s_mul_i32 s37, s33, 393216
  s_add_u32 s37, s37, s35
  s_add_u32 m0, s38, s44
  s_nop 0
  buffer_load_dwordx4 v8, s[8:11], s36 offen offset:0 sc1 lds
  buffer_load_dwordx4 v9, s[8:11], s36 offen offset:1024 sc1 lds
  buffer_load_dwordx4 v10, s[8:11], s36 offen offset:2048 sc1 lds
  buffer_load_dwordx4 v11, s[8:11], s36 offen offset:3072 sc1 lds
  s_add_u32 m0, s38, s46
  s_nop 0
  buffer_load_dwordx4 v13, s[12:15], s37 offen offset:0  lds
  buffer_load_dwordx4 v14, s[12:15], s37 offen offset:1024  lds
  s_add_u32 m0, s38, s47
  s_nop 0
  buffer_load_dwordx4 v15, s[12:15], s37 offen offset:0  lds
  buffer_load_dwordx4 v16, s[12:15], s37 offen offset:1024  lds
  s_add_u32 m0, s38, s48
  s_nop 0
  buffer_load_dwordx4 v17, s[12:15], s37 offen offset:0  lds
  buffer_load_dwordx4 v18, s[12:15], s37 offen offset:1024  lds
  s_add_u32 s38, s38, 43008
  s_cmp_eq_u32 s38, 129024
  s_cselect_b32 s38, 0, s38
  s_cmp_lg_u32 s3, 0
  s_cbranch_scc1 st14g
  s_waitcnt vmcnt(10)
  s_mov_b32 s61, 0
st14p:
  v_cmp_gt_u32 vcc, 64, v29
  s_add_u32 s61, s61, 1
  s_cmp_gt_u32 s61, 1000000
  s_cbranch_scc1 st14g
  s_cbranch_vccz st14g
  global_load_dword v29, v134, s[62:63] sc0 sc1
  s_waitcnt vmcnt(0)
  s_branch st14p
st14g:
  buffer_load_dwordx2 v[30:31], v27, s[20:23], 0 offen sc1
  s_mov_b32 s32, 32768
  buffer_load_dwordx2 v[32:33], v27, s[20:23], s32 offen sc1
  s_mov_b32 s32, 65536
  buffer_load_dwordx2 v[34:35], v27, s[20:23], s32 offen sc1
  s_mov_b32 s32, 98304
  buffer_load_dwordx2 v[36:37], v27, s[20:23], s32 offen sc1
  s_mov_b32 s32, 131072
  buffer_load_dwordx2 v[38:39], v27, s[20:23], s32 offen sc1
  s_mov_b32 s32, 163840
  buffer_load_dwordx2 v[40:41], v27, s[20:23], s32 offen sc1
  s_mov_b32 s32, 196608
  buffer_load_dwordx2 v[42:43], v27, s[20:23], s32 offen sc1
  s_mov_b32 s32, 229376
  buffer_load_dwordx2 v[44:45], v27, s[20:23], s32 offen sc1
  s_waitcnt vmcnt(18)
  s_barrier
  s_branch L_k1t
L_first:
  s_nop 7
  s_nop 7
  s_cmp_ge_u32 s57, 2
  s_cbranch_scc1 L_firstB
  s_add_u32 s30, s30, 1
  s_and_b32 s30, s30, 7
  s_cselect_b32 s32, 0, 1
  s_add_u32 s31, s31, s32
  s_sub_u32 s32, s30, s7
  s_and_b32 s32, s32, 7
  s_cmp_lt_u32 s32, 2
  s_cselect_b32 s32, 1, 0
  s_add_u32 s32, s32, s31
  s_cmp_ge_u32 s32, 2
  s_cselect_b32 s32, 0, s32
  s_lshl_b32 s33, s32, 3
  s_add_u32 s33, s33, s30
  s_mul_i32 s36, s33, s54
  s_add_u32 s36, s36, s34
  s_mul_i32 s37, s33, 393216
  s_add_u32 s37, s37, s35
  s_add_u32 m0, s38, s45
  s_mov_b64 exec, s[52:53]
  buffer_load_dwordx4 v12, s[8:11], s36 offen offset:0 sc1 lds
  s_mov_b64 exec, -1
  s_add_u32 m0, s38, s44
  s_nop 0
  buffer_load_dwordx4 v8, s[8:11], s36 offen offset:0 sc1 lds
  buffer_load_dwordx4 v9, s[8:11], s36 offen offset:1024 sc1 lds
  buffer_load_dwordx4 v10, s[8:11], s36 offen offset:2048 sc1 lds
  buffer_load_dwordx4 v11, s[8:11], s36 offen offset:3072 sc1 lds
  s_add_u32 m0, s38, s46
  s_nop 0
  buffer_load_dwordx4 v13, s[12:15], s37 offen offset:0  lds
  buffer_load_dwordx4 v14, s[12:15], s37 offen offset:1024  lds
  s_add_u32 m0, s38, s47
  s_nop 0
  buffer_load_dwordx4 v15, s[12:15], s37 offen offset:0  lds
  buffer_load_dwordx4 v16, s[12:15], s37 offen offset:1024  lds
  s_add_u32 m0, s38, s48
  s_nop 0
  buffer_load_dwordx4 v17, s[12:15], s37 offen offset:0  lds
  buffer_load_dwordx4 v18, s[12:15], s37 offen offset:1024  lds
  s_add_u32 s38, s38, 43008
  s_cmp_eq_u32 s38, 129024
  s_cselect_b32 s38, 0, s38
  s_mov_b32 s16, s84
  s_mov_b32 s17, s85
  s_mov_b32 s18, 117440512
  s_mov_b32 s19, 0x20000
  s_add_u32 s20, s84, 42991616
  s_addc_u32 s21, s85, 0
  s_mov_b32 s22, 32768
  s_mov_b32 s23, 0x20000
  s_mov_b32 s82, s84
  s_mov_b32 s83, s85
  s_add_u32 s30, s30, 1
  s_and_b32 s30, s30, 7
  s_cselect_b32 s32, 0, 1
  s_add_u32 s31, s31, s32
  s_sub_u32 s32, s30, s7
  s_and_b32 s32, s32, 7
  s_cmp_lt_u32 s32, 2
  s_cselect_b32 s32, 1, 0
  s_add_u32 s32, s32, s31
  s_cmp_ge_u32 s32, 2
  s_cselect_b32 s32, 0, s32
  s_lshl_b32 s33, s32, 3
  s_add_u32 s33, s33, s30
  s_mul_i32 s36, s33, s54
  s_add_u32 s36, s36, s34
  s_mul_i32 s37, s33, 393216
  s_add_u32 s37, s37, s35
  s_add_u32 m0, s38, s45
  s_mov_b64 exec, s[52:53]
  buffer_load_dwordx4 v12, s[8:11], s36 offen offset:0 sc1 lds
  s_mov_b64 exec, -1
  s_add_u32 m0, s38, s44
  s_nop 0
  buffer_load_dwordx4 v8, s[8:11], s36 offen offset:0 sc1 lds
  buffer_load_dwordx4 v9, s[8:11], s36 offen offset:1024 sc1 lds
  buffer_load_dwordx4 v10, s[8:11], s36 offen offset:2048 sc1 lds
  buffer_load_dwordx4 v11, s[8:11], s36 offen offset:3072 sc1 lds
  s_add_u32 m0, s38, s46
  s_nop 0
  buffer_load_dwordx4 v13, s[12:15], s37 offen offset:0  lds
  buffer_load_dwordx4 v14, s[12:15], s37 offen offset:1024  lds
  s_add_u32 m0, s38, s47
  s_nop 0
  buffer_load_dwordx4 v15, s[12:15], s37 offen offset:0  lds
  buffer_load_dwordx4 v16, s[12:15], s37 offen offset:1024  lds
  s_add_u32 m0, s38, s48
  s_nop 0
  buffer_load_dwordx4 v17, s[12:15], s37 offen offset:0  lds
  buffer_load_dwordx4 v18, s[12:15], s37 offen offset:1024  lds
  s_add_u32 s38, s38, 43008
  s_cmp_eq_u32 s38, 129024
  s_cselect_b32 s38, 0, s38
  buffer_load_dwordx4 v[48:51], v46, s[8:11], 0 offen offset:0
  buffer_load_dwordx4 v[52:55], v46, s[8:11], 0 offen offset:512
  buffer_load_dwordx4 v[56:59], v46, s[8:11], 0 offen offset:1024
  buffer_load_dwordx4 v[60:63], v46, s[8:11], 0 offen offset:1536
  buffer_store_dwordx4 v[64:67], v47, s[16:19], s58 offen sc0 sc1
  s_barrier
  s_waitcnt vmcnt(16)
  s_barrier
  s_add_u32 s30, s30, 1
  s_and_b32 s30, s30, 7
  s_cselect_b32 s32, 0, 1
  s_add_u32 s31, s31, s32
  s_sub_u32 s32, s30, s7
  s_and_b32 s32, s32, 7
  s_cmp_lt_u32 s32, 2
  s_cselect_b32 s32, 1, 0
  s_add_u32 s32, s32, s31
  s_cmp_ge_u32 s32, 2
  s_cselect_b32 s32, 0, s32
  s_lshl_b32 s33, s32, 3
  s_add_u32 s33, s33, s30
  s_mul_i32 s36, s33, s54
  s_add_u32 s36, s36, s34
  s_mul_i32 s37, s33, 393216
  s_add_u32 s37, s37, s35
  s_add_u32 m0, s38, s45
  s_mov_b64 exec, s[52:53]
  buffer_load_dwordx4 v12, s[8:11], s36 offen offset:0 sc1 lds
  s_mov_b64 exec, -1
  s_add_u32 m0, s38, s44
  s_nop 0
  buffer_load_dwordx4 v8, s[8:11], s36 offen offset:0 sc1 lds
  buffer_load_dwordx4 v9, s[8:11], s36 offen offset:1024 sc1 lds
  buffer_load_dwordx4 v10, s[8:11], s36 offen offset:2048 sc1 lds
  buffer_load_dwordx4 v11, s[8:11], s36 offen offset:3072 sc1 lds
  s_add_u32 m0, s38, s46
  s_nop 0
  buffer_load_dwordx4 v13, s[12:15], s37 offen offset:0  lds
  buffer_load_dwordx4 v14, s[12:15], s37 offen offset:1024  lds
  s_add_u32 m0, s38, s47
  s_nop 0
  buffer_load_dwordx4 v15, s[12:15], s37 offen offset:0  lds
  buffer_load_dwordx4 v16, s[12:15], s37 offen offset:1024  lds
  s_add_u32 m0, s38, s48
  s_nop 0
  buffer_load_dwordx4 v17, s[12:15], s37 offen offset:0  lds
  buffer_load_dwordx4 v18, s[12:15], s37 offen offset:1024  lds
  s_add_u32 s38, s38, 43008
  s_cmp_eq_u32 s38, 129024
  s_cselect_b32 s38, 0, s38
  v_mov_b32 v68, 0
  v_mov_b32 v69, 0
  v_mov_b32 v70, 0x3f803f80
  s_waitcnt vmcnt(12)
  v_dot2c_f32_bf16 v68, v70, v48
  v_dot2c_f32_bf16 v69, v48, v48
  v_dot2c_f32_bf16 v68, v70, v49
  v_dot2c_f32_bf16 v69, v49, v49
  v_dot2c_f32_bf16 v68, v70, v50
  v_dot2c_f32_bf16 v69, v50, v50
  v_dot2c_f32_bf16 v68, v70, v51
  v_dot2c_f32_bf16 v69, v51, v51
  v_dot2c_f32_bf16 v68, v70, v52
  v_dot2c_f32_bf16 v69, v52, v52
  v_dot2c_f32_bf16 v68, v70, v53
  v_dot2c_f32_bf16 v69, v53, v53
  v_dot2c_f32_bf16 v68, v70, v54
  v_dot2c_f32_bf16 v69, v54, v54
  v_dot2c_f32_bf16 v68, v70, v55
  v_dot2c_f32_bf16 v69, v55, v55
  v_dot2c_f32_bf16 v68, v70, v56
  v_dot2c_f32_bf16 v69, v56, v56
  v_dot2c_f32_bf16 v68, v70, v57
  v_dot2c_f32_bf16 v69, v57, v57
  v_dot2c_f32_bf16 v68, v70, v58
  v_dot2c_f32_bf16 v69, v58, v58
  v_dot2c_f32_bf16 v68, v70, v59
  v_dot2c_f32_bf16 v69, v59, v59
  v_dot2c_f32_bf16 v68, v70, v60
  v_dot2c_f32_bf16 v69, v60, v60
  v_dot2c_f32_bf16 v68, v70, v61
  v_dot2c_f32_bf16 v69, v61, v61
  v_dot2c_f32_bf16 v68, v70, v62
  v_dot2c_f32_bf16 v69, v62, v62
  v_dot2c_f32_bf16 v68, v70, v63
  v_dot2c_f32_bf16 v69, v63, v63
  s_nop 1
  v_add_f32_dpp v68, v68, v68 quad_perm:[1,0,3,2] row_mask:0xf bank_mask:0xf
  v_add_f32_dpp v69, v69, v69 quad_perm:[1,0,3,2] row_mask:0xf bank_mask:0xf
  s_nop 0
  v_add_f32_dpp v68, v68, v68 quad_perm:[2,3,0,1] row_mask:0xf bank_mask:0xf
  v_add_f32_dpp v69, v69, v69 quad_perm:[2,3,0,1] row_mask:0xf bank_mask:0xf
  s_nop 0
  v_add_f32_dpp v68, v68, v68 row_half_mirror row_mask:0xf bank_mask:0xf
  v_add_f32_dpp v69, v69, v69 row_half_mirror row_mask:0xf bank_mask:0xf
  s_nop 0
  v_add_f32_dpp v68, v68, v68 row_mirror row_mask:0xf bank_mask:0xf
  v_add_f32_dpp v69, v69, v69 row_mirror row_mask:0xf bank_mask:0xf
  v_mov_b32 v70, v68
  v_mov_b32 v71, v69
  s_nop 0
  v_permlane16_swap_b32 v68, v70
  v_permlane16_swap_b32 v69, v71
  v_add_f32 v68, v68, v70
  v_add_f32 v69, v69, v71
  s_mov_b32 exec_lo, 1
  s_mov_b32 exec_hi, 1
  buffer_store_dwordx2 v[68:69], v72, s[16:19], 0 offen sc0 sc1
  s_mov_b64 exec, -1
  s_mov_b32 s60, 0
  s_branch L_jA
L_firstB:
  s_nop 7
  s_nop 7
  s_add_u32 s30, s30, 1
  s_and_b32 s30, s30, 7
  s_cselect_b32 s32, 0, 1
  s_add_u32 s31, s31, s32
  s_sub_u32 s32, s30, s7
  s_and_b32 s32, s32, 7
  s_cmp_lt_u32 s32, 2
  s_cselect_b32 s32, 1, 0
  s_add_u32 s32, s32, s31
  s_cmp_ge_u32 s32, 2
  s_cselect_b32 s32, 0, s32
  s_lshl_b32 s33, s32, 3
  s_add_u32 s33, s33, s30
  s_mul_i32 s36, s33, s54
  s_add_u32 s36, s36, s34
  s_mul_i32 s37, s33, 393216
  s_add_u32 s37, s37, s35
  s_add_u32 m0, s38, s44
  s_nop 0
  buffer_load_dwordx4 v8, s[8:11], s36 offen offset:0 sc1 lds
  buffer_load_dwordx4 v9, s[8:11], s36 offen offset:1024 sc1 lds
  buffer_load_dwordx4 v10, s[8:11], s36 offen offset:2048 sc1 lds
  buffer_load_dwordx4 v11, s[8:11], s36 offen offset:3072 sc1 lds
  s_add_u32 m0, s38, s46
  s_nop 0
  buffer_load_dwordx4 v13, s[12:15], s37 offen offset:0  lds
  buffer_load_dwordx4 v14, s[12:15], s37 offen offset:1024  lds
  s_add_u32 m0, s38, s47
  s_nop 0
  buffer_load_dwordx4 v15, s[12:15], s37 offen offset:0  lds
  buffer_load_dwordx4 v16, s[12:15], s37 offen offset:1024  lds
  s_add_u32 m0, s38, s48
  s_nop 0
  buffer_load_dwordx4 v17, s[12:15], s37 offen offset:0  lds
  buffer_load_dwordx4 v18, s[12:15], s37 offen offset:1024  lds
  s_add_u32 s38, s38, 43008
  s_cmp_eq_u32 s38, 129024
  s_cselect_b32 s38, 0, s38
  s_mov_b32 s16, s84
  s_mov_b32 s17, s85
  s_mov_b32 s18, 117440512
  s_mov_b32 s19, 0x20000
  s_add_u32 s20, s84, 42991616
  s_addc_u32 s21, s85, 0
  s_mov_b32 s22, 32768
  s_mov_b32 s23, 0x20000
  s_mov_b32 s82, s84
  s_mov_b32 s83, s85
  s_add_u32 s30, s30, 1
  s_and_b32 s30, s30, 7
  s_cselect_b32 s32, 0, 1
  s_add_u32 s31, s31, s32
  s_sub_u32 s32, s30, s7
  s_and_b32 s32, s32, 7
  s_cmp_lt_u32 s32, 2
  s_cselect_b32 s32, 1, 0
  s_add_u32 s32, s32, s31
  s_cmp_ge_u32 s32, 2
  s_cselect_b32 s32, 0, s32
  s_lshl_b32 s33, s32, 3
  s_add_u32 s33, s33, s30
  s_mul_i32 s36, s33, s54
  s_add_u32 s36, s36, s34
  s_mul_i32 s37, s33, 393216
  s_add_u32 s37, s37, s35
  s_add_u32 m0, s38, s44
  s_nop 0
  buffer_load_dwordx4 v8, s[8:11], s36 offen offset:0 sc1 lds
  buffer_load_dwordx4 v9, s[8:11], s36 offen offset:1024 sc1 lds
  buffer_load_dwordx4 v10, s[8:11], s36 offen offset:2048 sc1 lds
  buffer_load_dwordx4 v11, s[8:11], s36 offen offset:3072 sc1 lds
  s_add_u32 m0, s38, s46
  s_nop 0
  buffer_load_dwordx4 v13, s[12:15], s37 offen offset:0  lds
  buffer_load_dwordx4 v14, s[12:15], s37 offen offset:1024  lds
  s_add_u32 m0, s38, s47
  s_nop 0
  buffer_load_dwordx4 v15, s[12:15], s37 offen offset:0  lds
  buffer_load_dwordx4 v16, s[12:15], s37 offen offset:1024  lds
  s_add_u32 m0, s38, s48
  s_nop 0
  buffer_load_dwordx4 v17, s[12:15], s37 offen offset:0  lds
  buffer_load_dwordx4 v18, s[12:15], s37 offen offset:1024  lds
  s_add_u32 s38, s38, 43008
  s_cmp_eq_u32 s38, 129024
  s_cselect_b32 s38, 0, s38
  buffer_load_dwordx4 v[48:51], v46, s[8:11], 0 offen offset:0
  buffer_load_dwordx4 v[52:55], v46, s[8:11], 0 offen offset:512
  buffer_load_dwordx4 v[56:59], v46, s[8:11], 0 offen offset:1024
  buffer_load_dwordx4 v[60:63], v46, s[8:11], 0 offen offset:1536
  buffer_store_dwordx4 v[64:67], v47, s[16:19], s58 offen sc0 sc1
  s_barrier
  s_waitcnt vmcnt(15)
  s_barrier
  s_add_u32 s30, s30, 1
  s_and_b32 s30, s30, 7
  s_cselect_b32 s32, 0, 1
  s_add_u32 s31, s31, s32
  s_sub_u32 s32, s30, s7
  s_and_b32 s32, s32, 7
  s_cmp_lt_u32 s32, 2
  s_cselect_b32 s32, 1, 0
  s_add_u32 s32, s32, s31
  s_cmp_ge_u32 s32, 2
  s_cselect_b32 s32, 0, s32
  s_lshl_b32 s33, s32, 3
  s_add_u32 s33, s33, s30
  s_mul_i32 s36, s33, s54
  s_add_u32 s36, s36, s34
  s_mul_i32 s37, s33, 393216
  s_add_u32 s37, s37, s35
  s_add_u32 m0, s38, s44
  s_nop 0
  buffer_load_dwordx4 v8, s[8:11], s36 offen offset:0 sc1 lds
  buffer_load_dwordx4 v9, s[8:11], s36 offen offset:1024 sc1 lds
  buffer_load_dwordx4 v10, s[8:11], s36 offen offset:2048 sc1 lds
  buffer_load_dwordx4 v11, s[8:11], s36 offen offset:3072 sc1 lds
  s_add_u32 m0, s38, s46
  s_nop 0
  buffer_load_dwordx4 v13, s[12:15], s37 offen offset:0  lds
  buffer_load_dwordx4 v14, s[12:15], s37 offen offset:1024  lds
  s_add_u32 m0, s38, s47
  s_nop 0
  buffer_load_dwordx4 v15, s[12:15], s37 offen offset:0  lds
  buffer_load_dwordx4 v16, s[12:15], s37 offen offset:1024  lds
  s_add_u32 m0, s38, s48
  s_nop 0
  buffer_load_dwordx4 v17, s[12:15], s37 offen offset:0  lds
  buffer_load_dwordx4 v18, s[12:15], s37 offen offset:1024  lds
  s_add_u32 s38, s38, 43008
  s_cmp_eq_u32 s38, 129024
  s_cselect_b32 s38, 0, s38
  v_mov_b32 v68, 0
  v_mov_b32 v69, 0
  v_mov_b32 v70, 0x3f803f80
  s_waitcnt vmcnt(11)
  v_dot2c_f32_bf16 v68, v70, v48
  v_dot2c_f32_bf16 v69, v48, v48
  v_dot2c_f32_bf16 v68, v70, v49
  v_dot2c_f32_bf16 v69, v49, v49
  v_dot2c_f32_bf16 v68, v70, v50
  v_dot2c_f32_bf16 v69, v50, v50
  v_dot2c_f32_bf16 v68, v70, v51
  v_dot2c_f32_bf16 v69, v51, v51
  v_dot2c_f32_bf16 v68, v70, v52
  v_dot2c_f32_bf16 v69, v52, v52
  v_dot2c_f32_bf16 v68, v70, v53
  v_dot2c_f32_bf16 v69, v53, v53
  v_dot2c_f32_bf16 v68, v70, v54
  v_dot2c_f32_bf16 v69, v54, v54
  v_dot2c_f32_bf16 v68, v70, v55
  v_dot2c_f32_bf16 v69, v55, v55
  v_dot2c_f32_bf16 v68, v70, v56
  v_dot2c_f32_bf16 v69, v56, v56
  v_dot2c_f32_bf16 v68, v70, v57
  v_dot2c_f32_bf16 v69, v57, v57
  v_dot2c_f32_bf16 v68, v70, v58
  v_dot2c_f32_bf16 v69, v58, v58
  v_dot2c_f32_bf16 v68, v70, v59
  v_dot2c_f32_bf16 v69, v59, v59
  v_dot2c_f32_bf16 v68, v70, v60
  v_dot2c_f32_bf16 v69, v60, v60
  v_dot2c_f32_bf16 v68, v70, v61
  v_dot2c_f32_bf16 v69, v61, v61
  v_dot2c_f32_bf16 v68, v70, v62
  v_dot2c_f32_bf16 v69, v62, v62
  v_dot2c_f32_bf16 v68, v70, v63
  v_dot2c_f32_bf16 v69, v63, v63
  s_nop 1
  v_add_f32_dpp v68, v68, v68 quad_perm:[1,0,3,2] row_mask:0xf bank_mask:0xf
  v_add_f32_dpp v69, v69, v69 quad_perm:[1,0,3,2] row_mask:0xf bank_mask:0xf
  s_nop 0
  v_add_f32_dpp v68, v68, v68 quad_perm:[2,3,0,1] row_mask:0xf bank_mask:0xf
  v_add_f32_dpp v69, v69, v69 quad_perm:[2,3,0,1] row_mask:0xf bank_mask:0xf
  s_nop 0
  v_add_f32_dpp v68, v68, v68 row_half_mirror row_mask:0xf bank_mask:0xf
  v_add_f32_dpp v69, v69, v69 row_half_mirror row_mask:0xf bank_mask:0xf
  s_nop 0
  v_add_f32_dpp v68, v68, v68 row_mirror row_mask:0xf bank_mask:0xf
  v_add_f32_dpp v69, v69, v69 row_mirror row_mask:0xf bank_mask:0xf
  v_mov_b32 v70, v68
  v_mov_b32 v71, v69
  s_nop 0
  v_permlane16_swap_b32 v68, v70
  v_permlane16_swap_b32 v69, v71
  v_add_f32 v68, v68, v70
  v_add_f32 v69, v69, v71
  s_mov_b32 exec_lo, 1
  s_mov_b32 exec_hi, 1
  buffer_store_dwordx2 v[68:69], v72, s[16:19], 0 offen sc0 sc1
  s_mov_b64 exec, -1
  s_mov_b32 s60, 0
  s_branch L_jB
L_k1t:
  s_nop 7
  s_nop 7
  s_waitcnt vmcnt(0)
  v_pk_add_f32 v[30:31], v[30:31], v[32:33]
  v_pk_add_f32 v[34:35], v[34:35], v[36:37]
  v_pk_add_f32 v[38:39], v[38:39], v[40:41]
  v_pk_add_f32 v[42:43], v[42:43], v[44:45]
  v_pk_add_f32 v[30:31], v[30:31], v[34:35]
  v_pk_add_f32 v[38:39], v[38:39], v[42:43]
  v_pk_add_f32 v[30:31], v[30:31], v[38:39]
  v_mul_f32 v30, 0x3a800000, v30
  v_mul_f32 v31, 0x3a800000, v31
  v_fma_f32 v31, -v30, v30, v31
  v_max_f32 v31, 0, v31
  v_mov_b32 v32, v31
  v_cvt_pk_bf16_f32 v32, v32, v32
  v_lshlrev_b32 v32, 16, v32
  v_add_f32 v32, 0x3727c5ac, v32
  v_cvt_pk_bf16_f32 v32, v32, v32
  v_lshlrev_b32 v32, 16, v32
  v_sqrt_f32 v32, v32
  s_nop 0
  v_cvt_pk_bf16_f32 v32, v32, v32
  v_lshlrev_b32 v32, 16, v32
  v_rcp_f32 v32, v32
  v_cvt_pk_bf16_f32 v30, v30, v30
  v_lshlrev_b32 v30, 16, v30
  v_mov_b32 v31, v32
  ds_write_b64 v26, v[30:31]
  s_waitcnt lgkmcnt(0)
  s_mov_b32 s41, s57
  s_mul_i32 s32, s41, 16
  s_add_u32 s32, s32, 0
  v_lshrrev_b32 v2, 3, v0
  v_add_u32 v2, s32, v2
  v_bfe_u32 v3, v2, 1, 1
  v_bfe_u32 v4, v2, 3, 1
  v_lshl_or_b32 v3, v4, 1, v3
  v_lshlrev_b32 v3, 1, v3
  v_and_b32 v4, 7, v0
  v_xor_b32 v3, v3, v4
  v_lshlrev_b32 v3, 4, v3
  s_mov_b32 s32, 2048
  v_mul_lo_u32 v2, v2, s32
  v_add_u32 v130, v2, v3
  s_mul_i32 s32, s41, 16
  s_add_u32 s32, s32, 8
  v_lshrrev_b32 v2, 3, v0
  v_add_u32 v2, s32, v2
  v_bfe_u32 v3, v2, 1, 1
  v_bfe_u32 v4, v2, 3, 1
  v_lshl_or_b32 v3, v4, 1, v3
  v_lshlrev_b32 v3, 1, v3
  v_and_b32 v4, 7, v0
  v_xor_b32 v3, v3, v4
  v_lshlrev_b32 v3, 4, v3
  s_mov_b32 s32, 2048
  v_mul_lo_u32 v2, v2, s32
  v_add_u32 v131, v2, v3
  v_subrev_u32 v131, 1024, v131
  s_mov_b32 s12, s68
  s_mov_b32 s13, s69
  s_mov_b32 s14, 2097152
  s_mov_b32 s15, 0x20000
  s_mov_b32 s30, 7
  s_mov_b32 s31, -1
  s_lshl_b32 s52, s57, 11
  s_lshl_b32 s53, 0x303, s7
  s_lshr_b32 s53, s53, 8
  s_add_u32 s30, s30, 1
  s_and_b32 s30, s30, 7
  s_cselect_b32 s32, 0, 1
  s_add_u32 s31, s31, s32
  s_sub_u32 s32, s30, s7
  s_and_b32 s32, s32, 7
  s_cmp_lt_u32 s32, 2
  s_cselect_b32 s32, 1, 0
  s_add_u32 s32, s32, s31
  s_cmp_ge_u32 s32, 2
  s_cselect_b32 s32, 0, s32
  s_lshl_b32 s33, s32, 3
  s_add_u32 s33, s33, s30
  s_lshl_b32 s37, s33, 17
  s_add_u32 s37, s37, s35
  s_add_u32 m0, s52, 131072
  s_nop 0
  buffer_load_dwordx4 v130, s[12:15], s37 offen lds
  buffer_load_dwordx4 v131, s[12:15], s37 offen offset:1024 lds
  s_add_u32 s30, s30, 1
  s_and_b32 s30, s30, 7
  s_cselect_b32 s32, 0, 1
  s_add_u32 s31, s31, s32
  s_sub_u32 s32, s30, s7
  s_and_b32 s32, s32, 7
  s_cmp_lt_u32 s32, 2
  s_cselect_b32 s32, 1, 0
  s_add_u32 s32, s32, s31
  s_cmp_ge_u32 s32, 2
  s_cselect_b32 s32, 0, s32
  s_lshl_b32 s33, s32, 3
  s_add_u32 s33, s33, s30
  s_lshl_b32 s37, s33, 17
  s_add_u32 s37, s37, s35
  s_add_u32 m0, s52, 139264
  s_nop 0
  buffer_load_dwordx4 v130, s[12:15], s37 offen lds
  buffer_load_dwordx4 v131, s[12:15], s37 offen offset:1024 lds
  s_add_u32 s30, s30, 1
  s_and_b32 s30, s30, 7
  s_cselect_b32 s32, 0, 1
  s_add_u32 s31, s31, s32
  s_sub_u32 s32, s30, s7
  s_and_b32 s32, s32, 7
  s_cmp_lt_u32 s32, 2
  s_cselect_b32 s32, 1, 0
  s_add_u32 s32, s32, s31
  s_cmp_ge_u32 s32, 2
  s_cselect_b32 s32, 0, s32
  s_lshl_b32 s33, s32, 3
  s_add_u32 s33, s33, s30
  s_lshl_b32 s37, s33, 17
  s_add_u32 s37, s37, s35
  s_add_u32 m0, s52, 147456
  s_nop 0
  buffer_load_dwordx4 v130, s[12:15], s37 offen lds
  buffer_load_dwordx4 v131, s[12:15], s37 offen offset:1024 lds
  s_add_u32 s30, s30, 1
  s_and_b32 s30, s30, 7
  s_cselect_b32 s32, 0, 1
  s_add_u32 s31, s31, s32
  s_sub_u32 s32, s30, s7
  s_and_b32 s32, s32, 7
  s_cmp_lt_u32 s32, 2
  s_cselect_b32 s32, 1, 0
  s_add_u32 s32, s32, s31
  s_cmp_ge_u32 s32, 2
  s_cselect_b32 s32, 0, s32
  s_lshl_b32 s33, s32, 3
  s_add_u32 s33, s33, s30
  s_lshl_b32 s37, s33, 17
  s_add_u32 s37, s37, s35
  s_add_u32 m0, s52, 155648
  s_nop 0
  buffer_load_dwordx4 v130, s[12:15], s37 offen lds
  buffer_load_dwordx4 v131, s[12:15], s37 offen offset:1024 lds
  s_waitcnt vmcnt(8)
  s_barrier
  s_add_u32 s30, s30, 1
  s_and_b32 s30, s30, 7
  s_cselect_b32 s32, 0, 1
  s_add_u32 s31, s31, s32
  s_sub_u32 s32, s30, s7
  s_and_b32 s32, s32, 7
  s_cmp_lt_u32 s32, 2
  s_cselect_b32 s32, 1, 0
  s_add_u32 s32, s32, s31
  s_cmp_ge_u32 s32, 2
  s_cselect_b32 s32, 0, s32
  s_lshl_b32 s33, s32, 3
  s_add_u32 s33, s33, s30
  s_lshl_b32 s37, s33, 17
  s_add_u32 s37, s37, s35
  s_add_u32 m0, s52, 100608
  s_nop 0
  buffer_load_dwordx4 v130, s[12:15], s37 offen lds
  buffer_load_dwordx4 v131, s[12:15], s37 offen offset:1024 lds
  s_add_u32 s30, s30, 1
  s_and_b32 s30, s30, 7
  s_cselect_b32 s32, 0, 1
  s_add_u32 s31, s31, s32
  s_sub_u32 s32, s30, s7
  s_and_b32 s32, s32, 7
  s_cmp_lt_u32 s32, 2
  s_cselect_b32 s32, 1, 0
  s_add_u32 s32, s32, s31
  s_cmp_ge_u32 s32, 2
  s_cselect_b32 s32, 0, s32
  s_lshl_b32 s33, s32, 3
  s_add_u32 s33, s33, s30
  s_lshl_b32 s37, s33, 17
  s_add_u32 s37, s37, s35
  s_add_u32 m0, s52, 108800
  s_nop 0
  buffer_load_dwordx4 v130, s[12:15], s37 offen lds
  buffer_load_dwordx4 v131, s[12:15], s37 offen offset:1024 lds
  s_add_u32 s30, s30, 1
  s_and_b32 s30, s30, 7
  s_cselect_b32 s32, 0, 1
  s_add_u32 s31, s31, s32
  s_sub_u32 s32, s30, s7
  s_and_b32 s32, s32, 7
  s_cmp_lt_u32 s32, 2
  s_cselect_b32 s32, 1, 0
  s_add_u32 s32, s32, s31
  s_cmp_ge_u32 s32, 2
  s_cselect_b32 s32, 0, s32
  s_lshl_b32 s33, s32, 3
  s_add_u32 s33, s33, s30
  s_lshl_b32 s37, s33, 17
  s_add_u32 s37, s37, s35
  s_add_u32 m0, s52, 116992
  s_nop 0
  buffer_load_dwordx4 v130, s[12:15], s37 offen lds
  buffer_load_dwordx4 v131, s[12:15], s37 offen offset:1024 lds
  s_cmp_lg_u32 s3, 0
  s_cbranch_scc1 e15
  v_and_b32 v4, 15, v0
  v_lshrrev_b32 v5, 4, v0
  v_lshrrev_b32 v6, 2, v4
  v_and_b32 v7, 3, v0
  v_lshrrev_b32 v3, 5, v0
  v_and_b32 v2, 1, v5
  v_lshl_or_b32 v3, v2, 1, v3
  s_lshr_b32 s40, s4, 1
  s_and_b32 s41, s4, 1
  s_mul_i32 s32, s41, 28800
  s_add_u32 s32, s32, 43008
  s_lshl_b32 s49, s40, 4
  v_add_u32 v76, s49, v4
  v_lshlrev_b32 v77, 4, v5
  v_add_u32 v77, s32, v77
  v_mul_u32_u24 v78, 400, v76
  v_add_u32 v220, v78, v77
  v_add_u32 v223, 3200, v220
  v_add_u32 v220, 128, v220
  v_add_u32 v76, 16, v76
  v_min_u32 v76, 71, v76
  v_mul_u32_u24 v78, 400, v76
  v_add3_u32 v221, v78, v77, 64
  v_add_u32 v221, 64, v221
  v_lshl_add_u32 v76, v5, 2, v6
  v_add_u32 v76, s49, v76
  v_lshlrev_b32 v77, 4, v7
  v_add_u32 v77, s32, v77
  v_add_u32 v77, 256, v77
  v_mul_u32_u24 v78, 400, v76
  v_add_u32 v222, v78, v77
  v_add_u32 v76, 16, v76
  v_min_u32 v76, 71, v76
  v_mul_u32_u24 v78, 400, v76
  v_add_u32 v254, v78, v77
  s_lshl_b32 s50, s28, 2
  s_add_u32 s50, s50, s40
  s_lshl_b32 s50, s50, 17
  s_lshl_b32 s51, s29, 13
  s_add_u32 s50, s50, s51
  s_lshl_b32 s51, s41, 11
  s_add_u32 s50, s50, s51
  s_and_b32 s51, s40, 1
  s_lshl_b32 s32, s51, 1
  s_add_u32 s32, s32, s41
  s_cmp_eq_u32 s32, 3
  s_addc_u32 s32, s32, 5
  s_lshl_b32 s32, s32, 7
  s_mov_b32 vcc_lo, 0xff000000
  s_mov_b32 vcc_hi, 0
  v_mov_b32 v1, s32
  v_cndmask_b32 v1, 0, v1, vcc
  v_lshl_add_u32 v1, v0, 4, v1
  v_add_u32 v1, s50, v1
  v_lshlrev_b32 v76, 2, v5
  v_sub_u32 v76, v76, v4
  s_or_b32 s51, s28, s40
  s_cmp_eq_u32 s51, 0
  s_cselect_b32 s51, 0, -1
  v_add_u32 v77, -1, v76
  v_cmp_gt_u32 s[86:87], 8, v77
  v_add_u32 v77, 0, v76
  v_cmp_gt_u32 s[88:89], 8, v77
  v_add_u32 v77, 1, v76
  v_cmp_gt_u32 s[90:91], 8, v77
  v_add_u32 v77, 2, v76
  v_cmp_gt_u32 s[92:93], 8, v77
  v_add_u32 v77, 15, v76
  v_cmp_gt_u32 s[94:95], 8, v77
  v_add_u32 v77, 16, v76
  v_cmp_gt_u32 s[96:97], 8, v77
  v_add_u32 v77, 17, v76
  v_cmp_gt_u32 s[98:99], 8, v77
  v_add_u32 v77, 18, v76
  v_cmp_gt_u32 s[100:101], 8, v77
  s_and_b32 s86, s86, s51
  s_and_b32 s88, s88, s51
  s_and_b32 s90, s90, s51
  s_and_b32 s92, s92, s51
e15:
  s_nop 1
  s_waitcnt lgkmcnt(0)
  s_barrier
  s_add_u32 s30, s30, 1
  s_and_b32 s30, s30, 7
  s_cselect_b32 s32, 0, 1
  s_add_u32 s31, s31, s32
  s_sub_u32 s32, s30, s7
  s_and_b32 s32, s32, 7
  s_cmp_lt_u32 s32, 2
  s_cselect_b32 s32, 1, 0
  s_add_u32 s32, s32, s31
  s_cmp_ge_u32 s32, 2
  s_cselect_b32 s32, 0, s32
  s_lshl_b32 s33, s32, 3
  s_add_u32 s33, s33, s30
  s_lshl_b32 s37, s33, 17
  s_add_u32 s37, s37, s35
  s_add_u32 m0, s52, 0
  s_nop 0
  buffer_load_dwordx4 v130, s[12:15], s37 offen lds
  buffer_load_dwordx4 v131, s[12:15], s37 offen offset:1024 lds
  s_add_u32 s30, s30, 1
  s_and_b32 s30, s30, 7
  s_cselect_b32 s32, 0, 1
  s_add_u32 s31, s31, s32
  s_sub_u32 s32, s30, s7
  s_and_b32 s32, s32, 7
  s_cmp_lt_u32 s32, 2
  s_cselect_b32 s32, 1, 0
  s_add_u32 s32, s32, s31
  s_cmp_ge_u32 s32, 2
  s_cselect_b32 s32, 0, s32
  s_lshl_b32 s33, s32, 3
  s_add_u32 s33, s33, s30
  s_lshl_b32 s37, s33, 17
  s_add_u32 s37, s37, s35
  s_add_u32 m0, s52, 8192
  s_nop 0
  buffer_load_dwordx4 v130, s[12:15], s37 offen lds
  buffer_load_dwordx4 v131, s[12:15], s37 offen offset:1024 lds
  s_add_u32 s30, s30, 1
  s_and_b32 s30, s30, 7
  s_cselect_b32 s32, 0, 1
  s_add_u32 s31, s31, s32
  s_sub_u32 s32, s30, s7
  s_and_b32 s32, s32, 7
  s_cmp_lt_u32 s32, 2
  s_cselect_b32 s32, 1, 0
  s_add_u32 s32, s32, s31
  s_cmp_ge_u32 s32, 2
  s_cselect_b32 s32, 0, s32
  s_lshl_b32 s33, s32, 3
  s_add_u32 s33, s33, s30
  s_lshl_b32 s37, s33, 17
  s_add_u32 s37, s37, s35
  s_add_u32 m0, s52, 16384
  s_nop 0
  buffer_load_dwordx4 v130, s[12:15], s37 offen lds
  buffer_load_dwordx4 v131, s[12:15], s37 offen offset:1024 lds
  s_add_u32 s30, s30, 1
  s_and_b32 s30, s30, 7
  s_cselect_b32 s32, 0, 1
  s_add_u32 s31, s31, s32
  s_sub_u32 s32, s30, s7
  s_and_b32 s32, s32, 7
  s_cmp_lt_u32 s32, 2
  s_cselect_b32 s32, 1, 0
  s_add_u32 s32, s32, s31
  s_cmp_ge_u32 s32, 2
  s_cselect_b32 s32, 0, s32
  s_lshl_b32 s33, s32, 3
  s_add_u32 s33, s33, s30
  s_lshl_b32 s37, s33, 17
  s_add_u32 s37, s37, s35
  s_add_u32 m0, s52, 24576
  s_nop 0
  buffer_load_dwordx4 v130, s[12:15], s37 offen lds
  buffer_load_dwordx4 v131, s[12:15], s37 offen offset:1024 lds
  s_add_u32 s30, s30, 1
  s_and_b32 s30, s30, 7
  s_cselect_b32 s32, 0, 1
  s_add_u32 s31, s31, s32
  s_sub_u32 s32, s30, s7
  s_and_b32 s32, s32, 7
  s_cmp_lt_u32 s32, 2
  s_cselect_b32 s32, 1, 0
  s_add_u32 s32, s32, s31
  s_cmp_ge_u32 s32, 2
  s_cselect_b32 s32, 0, s32
  s_lshl_b32 s33, s32, 3
  s_add_u32 s33, s33, s30
  s_lshl_b32 s37, s33, 17
  s_add_u32 s37, s37, s35
  s_add_u32 m0, s52, 32768
  s_nop 0
  buffer_load_dwordx4 v130, s[12:15], s37 offen lds
  buffer_load_dwordx4 v131, s[12:15], s37 offen offset:1024 lds
  s_branch attn
L_k1done:
  s_nop 7
  s_nop 7
  s_add_u32 s24, s84, 109051904
  s_addc_u32 s25, s85, 0
  s_mov_b32 s26, 524288
  s_mov_b32 s27, 0x20000
  v_mov_b32 v136, 0
  v_mov_b32 v137, 1
  s_cmp_eq_u32 s57, 0
  s_cselect_b32 s26, s26, 0
  s_waitcnt vmcnt(0)
  s_barrier
  s_mov_b64 exec, 1
  buffer_store_dword v137, v136, s[24:27], s56 offen sc0 sc1
  s_mov_b64 exec, -1
  s_add_u32 s30, s30, 1
  s_and_b32 s30, s30, 7
  s_cselect_b32 s32, 0, 1
  s_add_u32 s31, s31, s32
  s_sub_u32 s32, s30, s7
  s_and_b32 s32, s32, 7
  s_cmp_lt_u32 s32, 2
  s_cselect_b32 s32, 1, 0
  s_add_u32 s32, s32, s31
  s_cmp_ge_u32 s32, 2
  s_cselect_b32 s32, 0, s32
  s_lshl_b32 s33, s32, 3
  s_add_u32 s33, s33, s30
  s_lshl_b32 s37, s33, 17
  s_add_u32 s37, s37, s35
  s_add_u32 m0, s52, 43008
  s_nop 0
  buffer_load_dwordx4 v130, s[12:15], s37 offen lds
  buffer_load_dwordx4 v131, s[12:15], s37 offen offset:1024 lds
  s_add_u32 s30, s30, 1
  s_and_b32 s30, s30, 7
  s_cselect_b32 s32, 0, 1
  s_add_u32 s31, s31, s32
  s_sub_u32 s32, s30, s7
  s_and_b32 s32, s32, 7
  s_cmp_lt_u32 s32, 2
  s_cselect_b32 s32, 1, 0
  s_add_u32 s32, s32, s31
  s_cmp_ge_u32 s32, 2
  s_cselect_b32 s32, 0, s32
  s_lshl_b32 s33, s32, 3
  s_add_u32 s33, s33, s30
  s_lshl_b32 s37, s33, 17
  s_add_u32 s37, s37, s35
  s_add_u32 m0, s52, 51200
  s_nop 0
  buffer_load_dwordx4 v130, s[12:15], s37 offen lds
  buffer_load_dwordx4 v131, s[12:15], s37 offen offset:1024 lds
  s_add_u32 s30, s30, 1
  s_and_b32 s30, s30, 7
  s_cselect_b32 s32, 0, 1
  s_add_u32 s31, s31, s32
  s_sub_u32 s32, s30, s7
  s_and_b32 s32, s32, 7
  s_cmp_lt_u32 s32, 2
  s_cselect_b32 s32, 1, 0
  s_add_u32 s32, s32, s31
  s_cmp_ge_u32 s32, 2
  s_cselect_b32 s32, 0, s32
  s_lshl_b32 s33, s32, 3
  s_add_u32 s33, s33, s30
  s_lshl_b32 s37, s33, 17
  s_add_u32 s37, s37, s35
  s_add_u32 m0, s52, 59392
  s_nop 0
  buffer_load_dwordx4 v130, s[12:15], s37 offen lds
  buffer_load_dwordx4 v131, s[12:15], s37 offen offset:1024 lds
  s_add_u32 s30, s30, 1
  s_and_b32 s30, s30, 7
  s_cselect_b32 s32, 0, 1
  s_add_u32 s31, s31, s32
  s_sub_u32 s32, s30, s7
  s_and_b32 s32, s32, 7
  s_cmp_lt_u32 s32, 2
  s_cselect_b32 s32, 1, 0
  s_add_u32 s32, s32, s31
  s_cmp_ge_u32 s32, 2
  s_cselect_b32 s32, 0, s32
  s_lshl_b32 s33, s32, 3
  s_add_u32 s33, s33, s30
  s_lshl_b32 s37, s33, 17
  s_add_u32 s37, s37, s35
  s_add_u32 m0, s52, 67584
  s_nop 0
  buffer_load_dwordx4 v130, s[12:15], s37 offen lds
  buffer_load_dwordx4 v131, s[12:15], s37 offen offset:1024 lds
  s_lshl_b32 s56, s3, 10
  s_mul_i32 s32, s29, 16
  s_add_u32 s56, s56, s32
  s_add_u32 s56, s56, s28
  s_add_u32 s56, s56, 256
  s_lshl_b32 s56, s56, 7
  s_barrier
  s_waitcnt vmcnt(0)
  s_barrier
  s_cmp_ge_u32 s2, 224
  s_cbranch_scc1 L_k3skip
  s_lshr_b32 s32, s2, 3
  s_mul_i32 s5, s32, 9363
  s_lshr_b32 s5, s5, 16
  s_mul_i32 s6, s5, 7
  s_sub_u32 s6, s32, s6
  s_lshl_b32 s7, s5, 1
  s_add_u32 s7, s7, s6
  s_and_b32 s7, s7, 7
  s_and_b32 s32, s2, 7
  s_lshr_b32 s28, s32, 2
  s_lshl_b32 s28, s28, 2
  s_add_u32 s28, s28, s5
  s_and_b32 s29, s32, 3
  s_mul_i32 s29, s29, 7
  s_add_u32 s29, s29, s6
  s_mov_b32 s30, 7
  s_mov_b32 s31, -1
  s_lshl_b32 s44, s57, 12
  s_add_u32 s45, s44, 16384
  v_lshrrev_b32 v2, 4, v0
  v_lshlrev_b32 v3, 1, v2
  v_and_b32 v4, 15, v0
  v_xor_b32 v3, v3, v4
  v_lshlrev_b32 v3, 4, v3
  s_lshl_b32 s32, s57, 4
  v_add_u32 v2, s32, v2
  s_mov_b32 s32, 7168
  v_mul_lo_u32 v2, v2, s32
  v_add_u32 v9, v2, v3
  v_xor_b32 v3, 128, v3
  v_add_u32 v11, v2, v3
  v_add_u32 v10, 27648, v9
  v_add_u32 v12, 82944, v11
  v_add_u32 v11, 55296, v11
  s_lshl_b32 s34, s28, 2
  s_add_u32 s34, s34, s57
  s_lshl_b32 s34, s34, 18
  s_lshl_b32 s35, s29, 8
  s_lshl_b32 s32, 0, 1
  s_add_u32 s32, s32, 0
  s_cmp_eq_u32 s32, 3
  s_addc_u32 s32, s32, 5
  s_lshl_b32 s32, s32, 7
  s_mov_b32 vcc_lo, 0xff000000
  s_mov_b32 vcc_hi, 0
  v_mov_b32 v20, s32
  v_cndmask_b32 v20, 0, v20, vcc
  v_lshl_add_u32 v20, v0, 4, v20
  s_lshl_b32 s32, 1, 1
  s_add_u32 s32, s32, 0
  s_cmp_eq_u32 s32, 3
  s_addc_u32 s32, s32, 5
  s_lshl_b32 s32, s32, 7
  s_mov_b32 vcc_lo, 0xff000000
  s_mov_b32 vcc_hi, 0
  v_mov_b32 v21, s32
  v_cndmask_b32 v21, 0, v21, vcc
  v_lshl_add_u32 v21, v0, 4, v21
  v_add_u32 v21, 1024, v21
  s_lshl_b32 s32, 0, 1
  s_add_u32 s32, s32, 1
  s_cmp_eq_u32 s32, 3
  s_addc_u32 s32, s32, 5
  s_lshl_b32 s32, s32, 7
  s_mov_b32 vcc_lo, 0xff000000
  s_mov_b32 vcc_hi, 0
  v_mov_b32 v22, s32
  v_cndmask_b32 v22, 0, v22, vcc
  v_lshl_add_u32 v22, v0, 4, v22
  v_add_u32 v22, 129024, v22
  s_lshl_b32 s32, 1, 1
  s_add_u32 s32, s32, 1
  s_cmp_eq_u32 s32, 3
  s_addc_u32 s32, s32, 5
  s_lshl_b32 s32, s32, 7
  s_mov_b32 vcc_lo, 0xff000000
  s_mov_b32 vcc_hi, 0
  v_mov_b32 v23, s32
  v_cndmask_b32 v23, 0, v23, vcc
  v_lshl_add_u32 v23, v0, 4, v23
  v_add_u32 v23, 130048, v23
  s_add_u32 s8, s82, 16777216
  s_addc_u32 s9, s83, 0
  s_mov_b32 s10, 8388608
  s_mov_b32 s11, 0x20000
  s_mov_b32 s12, s72
  s_mov_b32 s13, s73
  s_mov_b32 s14, 14680064
  s_mov_b32 s15, 0x20000
  s_add_u32 s16, s84, 109051904
  s_addc_u32 s17, s85, 0
  s_mov_b32 s18, 524288
  s_mov_b32 s19, 0x20000
  v_min_u32 v14, 31, v0
  s_lshl_b32 s32, s28, 5
  v_add_u32 v14, s32, v14
  v_max_i32 v14, 0, v14
  v_lshlrev_b32 v14, 7, v14
  s_lshl_b32 s55, s3, 17
  s_add_u32 s55, s55, 32768
  s_lshr_b32 s32, s2, 3
  s_add_u32 s32, s32, 0
  s_lshl_b32 s32, s32, 2
  s_add_u32 s32, s32, s57
  s_lshl_b32 s32, s32, 6
  v_add_u32 v2, s32, v0
  v_mul_u32_u24 v3, 74899, v2
  v_lshrrev_b32 v3, 20, v3
  v_mul_u32_u24 v4, 14, v3
  v_sub_u32 v4, v2, v4
  v_add_u32 v3, 192, v3
  v_mul_u32_u24 v3, 7168, v3
  v_lshl_add_u32 v3, v4, 7, v3
  s_and_b32 s32, s2, 3
  s_mul_i32 s32, s32, 1792
  s_lshl_b32 s40, s3, 30
  s_add_u32 s32, s32, s40
  v_add_u32 v16, s32, v3
  s_barrier
  s_barrier
  s_mov_b64 exec, 1
  buffer_store_dword v137, v136, s[24:27], s56 offen sc0 sc1
  s_mov_b64 exec, -1
  s_mov_b32 s30, 7
  s_mov_b32 s31, -1
  s_mov_b32 s38, 0
  s_add_u32 s30, s30, 1
  s_and_b32 s30, s30, 7
  s_cselect_b32 s32, 0, 1
  s_add_u32 s31, s31, s32
  s_sub_u32 s32, s30, s7
  s_and_b32 s32, s32, 7
  s_cmp_lt_u32 s32, 2
  s_cselect_b32 s32, 1, 0
  s_add_u32 s32, s32, s31
  s_cmp_ge_u32 s32, 4
  s_cselect_b32 s32, 0, s32
  s_lshl_b32 s33, s32, 3
  s_add_u32 s33, s33, s30
  s_mul_i32 s37, s33, 458752
  s_add_u32 s37, s37, s35
  s_add_u32 m0, s38, s45
  s_nop 0
  buffer_load_dwordx4 v9, s[12:15], s37 offen offset:0  lds
  buffer_load_dwordx4 v10, s[12:15], s37 offen offset:1024  lds
  buffer_load_dwordx4 v11, s[12:15], s37 offen offset:2048  lds
  buffer_load_dwordx4 v12, s[12:15], s37 offen offset:3072  lds
  s_add_u32 s38, s38, 32768
  s_cmp_eq_u32 s38, 163840
  s_cselect_b32 s38, 0, s38
  s_add_u32 s30, s30, 1
  s_and_b32 s30, s30, 7
  s_cselect_b32 s32, 0, 1
  s_add_u32 s31, s31, s32
  s_sub_u32 s32, s30, s7
  s_and_b32 s32, s32, 7
  s_cmp_lt_u32 s32, 2
  s_cselect_b32 s32, 1, 0
  s_add_u32 s32, s32, s31
  s_cmp_ge_u32 s32, 4
  s_cselect_b32 s32, 0, s32
  s_lshl_b32 s33, s32, 3
  s_add_u32 s33, s33, s30
  s_mul_i32 s37, s33, 458752
  s_add_u32 s37, s37, s35
  s_add_u32 m0, s38, s45
  s_nop 0
  buffer_load_dwordx4 v9, s[12:15], s37 offen offset:0  lds
  buffer_load_dwordx4 v10, s[12:15], s37 offen offset:1024  lds
  buffer_load_dwordx4 v11, s[12:15], s37 offen offset:2048  lds
  buffer_load_dwordx4 v12, s[12:15], s37 offen offset:3072  lds
  s_add_u32 s38, s38, 32768
  s_cmp_eq_u32 s38, 163840
  s_cselect_b32 s38, 0, s38
  s_add_u32 s30, s30, 1
  s_and_b32 s30, s30, 7
  s_cselect_b32 s32, 0, 1
  s_add_u32 s31, s31, s32
  s_sub_u32 s32, s30, s7
  s_and_b32 s32, s32, 7
  s_cmp_lt_u32 s32, 2
  s_cselect_b32 s32, 1, 0
  s_add_u32 s32, s32, s31
  s_cmp_ge_u32 s32, 4
  s_cselect_b32 s32, 0, s32
  s_lshl_b32 s33, s32, 3
  s_add_u32 s33, s33, s30
  s_mul_i32 s37, s33, 458752
  s_add_u32 s37, s37, s35
  s_add_u32 m0, s38, s45
  s_nop 0
  buffer_load_dwordx4 v9, s[12:15], s37 offen offset:0  lds
  buffer_load_dwordx4 v10, s[12:15], s37 offen offset:1024  lds
  buffer_load_dwordx4 v11, s[12:15], s37 offen offset:2048  lds
  buffer_load_dwordx4 v12, s[12:15], s37 offen offset:3072  lds
  s_add_u32 s38, s38, 32768
  s_cmp_eq_u32 s38, 163840
  s_cselect_b32 s38, 0, s38
  buffer_load_dword v135, v16, s[12:15], 0 offen
  s_lshl_b32 s56, s3, 10
  s_mul_i32 s32, s28, 32
  s_add_u32 s56, s56, s32
  s_add_u32 s56, s56, s29
  s_add_u32 s56, s56, 512
  s_lshl_b32 s56, s56, 7
  s_mov_b32 s39, 0
  s_and_b32 s32, s4, 3
  s_cmp_lg_u32 s32, 0
  s_cbranch_scc1 poll16d
  s_sleep 8
poll16:
  buffer_load_dword v15, v14, s[16:19], s55 offen sc0 sc1
  s_waitcnt vmcnt(0)
  v_cmp_eq_u32 vcc, 0, v15
  s_add_u32 s39, s39, 1
  s_cmp_gt_u32 s39, 1000000
  s_cbranch_scc1 poll16d
  s_cbranch_vccnz poll16
poll16d:
  s_barrier
  s_mov_b32 s30, 7
  s_mov_b32 s31, -1
  s_mov_b32 s38, 0
  s_add_u32 s30, s30, 1
  s_and_b32 s30, s30, 7
  s_cselect_b32 s32, 0, 1
  s_add_u32 s31, s31, s32
  s_sub_u32 s32, s30, s7
  s_and_b32 s32, s32, 7
  s_cmp_lt_u32 s32, 2
  s_cselect_b32 s32, 1, 0
  s_add_u32 s32, s32, s31
  s_cmp_ge_u32 s32, 4
  s_cselect_b32 s32, 0, s32
  s_lshl_b32 s33, s32, 3
  s_add_u32 s33, s33, s30
  s_mul_i32 s36, s33, 4096
  s_add_u32 s36, s36, s34
  s_add_u32 m0, s38, s44
  s_nop 0
  buffer_load_dwordx4 v20, s[8:11], s36 offen offset:0 sc1 lds
  buffer_load_dwordx4 v21, s[8:11], s36 offen offset:1024 sc1 lds
  buffer_load_dwordx4 v22, s[8:11], s36 offen offset:2048 sc1 lds
  buffer_load_dwordx4 v23, s[8:11], s36 offen offset:3072 sc1 lds
  s_add_u32 s38, s38, 32768
  s_cmp_eq_u32 s38, 163840
  s_cselect_b32 s38, 0, s38
  s_add_u32 s30, s30, 1
  s_and_b32 s30, s30, 7
  s_cselect_b32 s32, 0, 1
  s_add_u32 s31, s31, s32
  s_sub_u32 s32, s30, s7
  s_and_b32 s32, s32, 7
  s_cmp_lt_u32 s32, 2
  s_cselect_b32 s32, 1, 0
  s_add_u32 s32, s32, s31
  s_cmp_ge_u32 s32, 4
  s_cselect_b32 s32, 0, s32
  s_lshl_b32 s33, s32, 3
  s_add_u32 s33, s33, s30
  s_mul_i32 s36, s33, 4096
  s_add_u32 s36, s36, s34
  s_add_u32 m0, s38, s44
  s_nop 0
  buffer_load_dwordx4 v20, s[8:11], s36 offen offset:0 sc1 lds
  buffer_load_dwordx4 v21, s[8:11], s36 offen offset:1024 sc1 lds
  buffer_load_dwordx4 v22, s[8:11], s36 offen offset:2048 sc1 lds
  buffer_load_dwordx4 v23, s[8:11], s36 offen offset:3072 sc1 lds
  s_add_u32 s38, s38, 32768
  s_cmp_eq_u32 s38, 163840
  s_cselect_b32 s38, 0, s38
  s_add_u32 s30, s30, 1
  s_and_b32 s30, s30, 7
  s_cselect_b32 s32, 0, 1
  s_add_u32 s31, s31, s32
  s_sub_u32 s32, s30, s7
  s_and_b32 s32, s32, 7
  s_cmp_lt_u32 s32, 2
  s_cselect_b32 s32, 1, 0
  s_add_u32 s32, s32, s31
  s_cmp_ge_u32 s32, 4
  s_cselect_b32 s32, 0, s32
  s_lshl_b32 s33, s32, 3
  s_add_u32 s33, s33, s30
  s_mul_i32 s36, s33, 4096
  s_add_u32 s36, s36, s34
  s_add_u32 m0, s38, s44
  s_nop 0
  buffer_load_dwordx4 v20, s[8:11], s36 offen offset:0 sc1 lds
  buffer_load_dwordx4 v21, s[8:11], s36 offen offset:1024 sc1 lds
  buffer_load_dwordx4 v22, s[8:11], s36 offen offset:2048 sc1 lds
  buffer_load_dwordx4 v23, s[8:11], s36 offen offset:3072 sc1 lds
  s_add_u32 s38, s38, 32768
  s_cmp_eq_u32 s38, 163840
  s_cselect_b32 s38, 0, s38
  s_waitcnt vmcnt(8)
  s_barrier
  s_add_u32 s30, s30, 1
  s_and_b32 s30, s30, 7
  s_cselect_b32 s32, 0, 1
  s_add_u32 s31, s31, s32
  s_sub_u32 s32, s30, s7
  s_and_b32 s32, s32, 7
  s_cmp_lt_u32 s32, 2
  s_cselect_b32 s32, 1, 0
  s_add_u32 s32, s32, s31
  s_cmp_ge_u32 s32, 4
  s_cselect_b32 s32, 0, s32
  s_lshl_b32 s33, s32, 3
  s_add_u32 s33, s33, s30
  s_mul_i32 s36, s33, 4096
  s_add_u32 s36, s36, s34
  s_mul_i32 s37, s33, 458752
  s_add_u32 s37, s37, s35
  s_add_u32 m0, s38, s44
  s_nop 0
  buffer_load_dwordx4 v20, s[8:11], s36 offen offset:0 sc1 lds
  buffer_load_dwordx4 v21, s[8:11], s36 offen offset:1024 sc1 lds
  buffer_load_dwordx4 v22, s[8:11], s36 offen offset:2048 sc1 lds
  buffer_load_dwordx4 v23, s[8:11], s36 offen offset:3072 sc1 lds
  s_add_u32 m0, s38, s45
  s_nop 0
  buffer_load_dwordx4 v9, s[12:15], s37 offen offset:0  lds
  buffer_load_dwordx4 v10, s[12:15], s37 offen offset:1024  lds
  buffer_load_dwordx4 v11, s[12:15], s37 offen offset:2048  lds
  buffer_load_dwordx4 v12, s[12:15], s37 offen offset:3072  lds
  s_add_u32 s38, s38, 32768
  s_cmp_eq_u32 s38, 163840
  s_cselect_b32 s38, 0, s38
  s_waitcnt vmcnt(12)
  s_barrier
  s_add_u32 s30, s30, 1
  s_and_b32 s30, s30, 7
  s_cselect_b32 s32, 0, 1
  s_add_u32 s31, s31, s32
  s_sub_u32 s32, s30, s7
  s_and_b32 s32, s32, 7
  s_cmp_lt_u32 s32, 2
  s_cselect_b32 s32, 1, 0
  s_add_u32 s32, s32, s31
  s_cmp_ge_u32 s32, 4
  s_cselect_b32 s32, 0, s32
  s_lshl_b32 s33, s32, 3
  s_add_u32 s33, s33, s30
  s_mul_i32 s36, s33, 4096
  s_add_u32 s36, s36, s34
  s_mul_i32 s37, s33, 458752
  s_add_u32 s37, s37, s35
  s_add_u32 m0, s38, s44
  s_nop 0
  buffer_load_dwordx4 v20, s[8:11], s36 offen offset:0 sc1 lds
  buffer_load_dwordx4 v21, s[8:11], s36 offen offset:1024 sc1 lds
  buffer_load_dwordx4 v22, s[8:11], s36 offen offset:2048 sc1 lds
  buffer_load_dwordx4 v23, s[8:11], s36 offen offset:3072 sc1 lds
  s_add_u32 m0, s38, s45
  s_nop 0
  buffer_load_dwordx4 v9, s[12:15], s37 offen offset:0  lds
  buffer_load_dwordx4 v10, s[12:15], s37 offen offset:1024  lds
  buffer_load_dwordx4 v11, s[12:15], s37 offen offset:2048  lds
  buffer_load_dwordx4 v12, s[12:15], s37 offen offset:3072  lds
  s_add_u32 s38, s38, 32768
  s_cmp_eq_u32 s38, 163840
  s_cselect_b32 s38, 0, s38
  s_mov_b32 s39, 27
ll17:
  s_waitcnt vmcnt(16)
  s_barrier
  s_add_u32 s30, s30, 1
  s_and_b32 s30, s30, 7
  s_cselect_b32 s32, 0, 1
  s_add_u32 s31, s31, s32
  s_sub_u32 s32, s30, s7
  s_and_b32 s32, s32, 7
  s_cmp_lt_u32 s32, 2
  s_cselect_b32 s32, 1, 0
  s_add_u32 s32, s32, s31
  s_cmp_ge_u32 s32, 4
  s_cselect_b32 s32, 0, s32
  s_lshl_b32 s33, s32, 3
  s_add_u32 s33, s33, s30
  s_mul_i32 s36, s33, 4096
  s_add_u32 s36, s36, s34
  s_mul_i32 s37, s33, 458752
  s_add_u32 s37, s37, s35
  s_add_u32 m0, s38, s44
  s_nop 0
  buffer_load_dwordx4 v20, s[8:11], s36 offen offset:0 sc1 lds
  buffer_load_dwordx4 v21, s[8:11], s36 offen offset:1024 sc1 lds
  buffer_load_dwordx4 v22, s[8:11], s36 offen offset:2048 sc1 lds
  buffer_load_dwordx4 v23, s[8:11], s36 offen offset:3072 sc1 lds
  s_add_u32 m0, s38, s45
  s_nop 0
  buffer_load_dwordx4 v9, s[12:15], s37 offen offset:0  lds
  buffer_load_dwordx4 v10, s[12:15], s37 offen offset:1024  lds
  buffer_load_dwordx4 v11, s[12:15], s37 offen offset:2048  lds
  buffer_load_dwordx4 v12, s[12:15], s37 offen offset:3072  lds
  s_add_u32 s38, s38, 32768
  s_cmp_eq_u32 s38, 163840
  s_cselect_b32 s38, 0, s38
  s_sub_u32 s39, s39, 1
  s_cmp_lg_u32 s39, 0
  s_cbranch_scc1 ll17
  s_waitcnt vmcnt(16)
  s_barrier
  s_waitcnt vmcnt(8)
  s_barrier
  s_waitcnt vmcnt(0)
  s_barrier
  s_lshr_b32 s32, s2, 3
  s_lshr_b32 s5, s32, 3
  s_and_b32 s6, s32, 7
  s_lshl_b32 s7, s5, 1
  s_add_u32 s7, s7, s6
  s_and_b32 s7, s7, 7
  s_and_b32 s32, s2, 7
  s_lshr_b32 s28, s32, 2
  s_lshl_b32 s28, s28, 2
  s_add_u32 s28, s28, s5
  s_and_b32 s29, s32, 3
  s_mul_i32 s29, s29, 8
  s_add_u32 s29, s29, s6
  s_mov_b32 s30, 7
  s_mov_b32 s31, -1
  s_mov_b32 s41, s57
  s_lshl_b32 s45, s41, 11
  s_mul_i32 s32, s41, 16
  s_add_u32 s32, s32, 0
  v_lshrrev_b32 v2, 3, v0
  v_add_u32 v2, s32, v2
  v_bfe_u32 v3, v2, 1, 1
  v_bfe_u32 v4, v2, 3, 1
  v_lshl_or_b32 v3, v4, 1, v3
  v_lshlrev_b32 v3, 1, v3
  v_and_b32 v4, 7, v0
  v_xor_b32 v3, v3, v4
  v_lshlrev_b32 v3, 4, v3
  s_mov_b32 s32, 4096
  v_mul_lo_u32 v2, v2, s32
  v_add_u32 v9, v2, v3
  s_mul_i32 s32, s41, 16
  s_add_u32 s32, s32, 8
  v_lshrrev_b32 v2, 3, v0
  v_add_u32 v2, s32, v2
  v_bfe_u32 v3, v2, 1, 1
  v_bfe_u32 v4, v2, 3, 1
  v_lshl_or_b32 v3, v4, 1, v3
  v_lshlrev_b32 v3, 1, v3
  v_and_b32 v4, 7, v0
  v_xor_b32 v3, v3, v4
  v_lshlrev_b32 v3, 4, v3
  s_mov_b32 s32, 4096
  v_mul_lo_u32 v2, v2, s32
  v_add_u32 v10, v2, v3
  v_subrev_u32 v10, 1024, v10
  s_lshl_b32 s35, s29, 7
  s_mov_b32 s12, s76
  s_mov_b32 s13, s77
  s_mov_b32 s14, 14680064
  s_mov_b32 s15, 0x20000
  s_branch L_k4
L_k3skip:
  s_nop 7
  s_nop 7
  s_lshr_b32 s32, s2, 3
  s_lshr_b32 s5, s32, 3
  s_and_b32 s6, s32, 7
  s_lshl_b32 s7, s5, 1
  s_add_u32 s7, s7, s6
  s_and_b32 s7, s7, 7
  s_and_b32 s32, s2, 7
  s_lshr_b32 s28, s32, 2
  s_lshl_b32 s28, s28, 2
  s_add_u32 s28, s28, s5
  s_and_b32 s29, s32, 3
  s_mul_i32 s29, s29, 8
  s_add_u32 s29, s29, s6
  s_mov_b32 s30, 7
  s_mov_b32 s31, -1
  s_mov_b32 s41, s57
  s_lshl_b32 s45, s41, 11
  s_mul_i32 s32, s41, 16
  s_add_u32 s32, s32, 0
  v_lshrrev_b32 v2, 3, v0
  v_add_u32 v2, s32, v2
  v_bfe_u32 v3, v2, 1, 1
  v_bfe_u32 v4, v2, 3, 1
  v_lshl_or_b32 v3, v4, 1, v3
  v_lshlrev_b32 v3, 1, v3
  v_and_b32 v4, 7, v0
  v_xor_b32 v3, v3, v4
  v_lshlrev_b32 v3, 4, v3
  s_mov_b32 s32, 4096
  v_mul_lo_u32 v2, v2, s32
  v_add_u32 v9, v2, v3
  s_mul_i32 s32, s41, 16
  s_add_u32 s32, s32, 8
  v_lshrrev_b32 v2, 3, v0
  v_add_u32 v2, s32, v2
  v_bfe_u32 v3, v2, 1, 1
  v_bfe_u32 v4, v2, 3, 1
  v_lshl_or_b32 v3, v4, 1, v3
  v_lshlrev_b32 v3, 1, v3
  v_and_b32 v4, 7, v0
  v_xor_b32 v3, v3, v4
  v_lshlrev_b32 v3, 4, v3
  s_mov_b32 s32, 4096
  v_mul_lo_u32 v2, v2, s32
  v_add_u32 v10, v2, v3
  v_subrev_u32 v10, 1024, v10
  s_lshl_b32 s35, s29, 7
  s_mov_b32 s12, s76
  s_mov_b32 s13, s77
  s_mov_b32 s14, 14680064
  s_mov_b32 s15, 0x20000
  s_barrier
L_k4:
  s_nop 7
  s_nop 7
  s_mov_b32 s30, 7
  s_mov_b32 s31, -1
  s_mov_b32 s38, 98304
  s_add_u32 s30, s30, 1
  s_and_b32 s30, s30, 7
  s_cselect_b32 s32, 0, 1
  s_add_u32 s31, s31, s32
  s_sub_u32 s32, s30, s7
  s_and_b32 s32, s32, 7
  s_cmp_lt_u32 s32, 2
  s_cselect_b32 s32, 1, 0
  s_add_u32 s32, s32, s31
  s_cmp_ge_u32 s32, 7
  s_cselect_b32 s32, 0, s32
  s_lshl_b32 s33, s32, 3
  s_add_u32 s33, s33, s30
  s_mul_i32 s37, s33, 262144
  s_add_u32 s37, s37, s35
  s_add_u32 m0, s38, s45
  s_nop 0
  buffer_load_dwordx4 v9, s[12:15], s37 offen offset:0  lds
  buffer_load_dwordx4 v10, s[12:15], s37 offen offset:1024  lds
  s_add_u32 s38, s38, 8192
  s_cmp_eq_u32 s38, 163840
  s_cselect_b32 s38, 98304, s38
  s_add_u32 s30, s30, 1
  s_and_b32 s30, s30, 7
  s_cselect_b32 s32, 0, 1
  s_add_u32 s31, s31, s32
  s_sub_u32 s32, s30, s7
  s_and_b32 s32, s32, 7
  s_cmp_lt_u32 s32, 2
  s_cselect_b32 s32, 1, 0
  s_add_u32 s32, s32, s31
  s_cmp_ge_u32 s32, 7
  s_cselect_b32 s32, 0, s32
  s_lshl_b32 s33, s32, 3
  s_add_u32 s33, s33, s30
  s_mul_i32 s37, s33, 262144
  s_add_u32 s37, s37, s35
  s_add_u32 m0, s38, s45
  s_nop 0
  buffer_load_dwordx4 v9, s[12:15], s37 offen offset:0  lds
  buffer_load_dwordx4 v10, s[12:15], s37 offen offset:1024  lds
  s_add_u32 s38, s38, 8192
  s_cmp_eq_u32 s38, 163840
  s_cselect_b32 s38, 98304, s38
  s_add_u32 s30, s30, 1
  s_and_b32 s30, s30, 7
  s_cselect_b32 s32, 0, 1
  s_add_u32 s31, s31, s32
  s_sub_u32 s32, s30, s7
  s_and_b32 s32, s32, 7
  s_cmp_lt_u32 s32, 2
  s_cselect_b32 s32, 1, 0
  s_add_u32 s32, s32, s31
  s_cmp_ge_u32 s32, 7
  s_cselect_b32 s32, 0, s32
  s_lshl_b32 s33, s32, 3
  s_add_u32 s33, s33, s30
  s_mul_i32 s37, s33, 262144
  s_add_u32 s37, s37, s35
  s_add_u32 m0, s38, s45
  s_nop 0
  buffer_load_dwordx4 v9, s[12:15], s37 offen offset:0  lds
  buffer_load_dwordx4 v10, s[12:15], s37 offen offset:1024  lds
  s_add_u32 s38, s38, 8192
  s_cmp_eq_u32 s38, 163840
  s_cselect_b32 s38, 98304, s38
  s_add_u32 s30, s30, 1
  s_and_b32 s30, s30, 7
  s_cselect_b32 s32, 0, 1
  s_add_u32 s31, s31, s32
  s_sub_u32 s32, s30, s7
  s_and_b32 s32, s32, 7
  s_cmp_lt_u32 s32, 2
  s_cselect_b32 s32, 1, 0
  s_add_u32 s32, s32, s31
  s_cmp_ge_u32 s32, 7
  s_cselect_b32 s32, 0, s32
  s_lshl_b32 s33, s32, 3
  s_add_u32 s33, s33, s30
  s_mul_i32 s37, s33, 262144
  s_add_u32 s37, s37, s35
  s_add_u32 m0, s38, s45
  s_nop 0
  buffer_load_dwordx4 v9, s[12:15], s37 offen offset:0  lds
  buffer_load_dwordx4 v10, s[12:15], s37 offen offset:1024  lds
  s_add_u32 s38, s38, 8192
  s_cmp_eq_u32 s38, 163840
  s_cselect_b32 s38, 98304, s38
  s_add_u32 s30, s30, 1
  s_and_b32 s30, s30, 7
  s_cselect_b32 s32, 0, 1
  s_add_u32 s31, s31, s32
  s_sub_u32 s32, s30, s7
  s_and_b32 s32, s32, 7
  s_cmp_lt_u32 s32, 2
  s_cselect_b32 s32, 1, 0
  s_add_u32 s32, s32, s31
  s_cmp_ge_u32 s32, 7
  s_cselect_b32 s32, 0, s32
  s_lshl_b32 s33, s32, 3
  s_add_u32 s33, s33, s30
  s_mul_i32 s37, s33, 262144
  s_add_u32 s37, s37, s35
  s_add_u32 m0, s38, s45
  s_nop 0
  buffer_load_dwordx4 v9, s[12:15], s37 offen offset:0  lds
  buffer_load_dwordx4 v10, s[12:15], s37 offen offset:1024  lds
  s_add_u32 s38, s38, 8192
  s_cmp_eq_u32 s38, 163840
  s_cselect_b32 s38, 98304, s38
  s_add_u32 s30, s30, 1
  s_and_b32 s30, s30, 7
  s_cselect_b32 s32, 0, 1
  s_add_u32 s31, s31, s32
  s_sub_u32 s32, s30, s7
  s_and_b32 s32, s32, 7
  s_cmp_lt_u32 s32, 2
  s_cselect_b32 s32, 1, 0
  s_add_u32 s32, s32, s31
  s_cmp_ge_u32 s32, 7
  s_cselect_b32 s32, 0, s32
  s_lshl_b32 s33, s32, 3
  s_add_u32 s33, s33, s30
  s_mul_i32 s37, s33, 262144
  s_add_u32 s37, s37, s35
  s_add_u32 m0, s38, s45
  s_nop 0
  buffer_load_dwordx4 v9, s[12:15], s37 offen offset:0  lds
  buffer_load_dwordx4 v10, s[12:15], s37 offen offset:1024  lds
  s_add_u32 s38, s38, 8192
  s_cmp_eq_u32 s38, 163840
  s_cselect_b32 s38, 98304, s38
  s_barrier
  s_mov_b64 exec, 1
  buffer_store_dword v137, v136, s[24:27], s56 offen sc0 sc1
  s_mov_b64 exec, -1
  s_lshl_b32 s56, s3, 10
  s_mul_i32 s32, s29, 8
  s_add_u32 s56, s56, s32
  s_add_u32 s56, s56, s28
  s_add_u32 s56, s56, 768
  s_lshl_b32 s56, s56, 7
  s_barrier
  s_mov_b32 s39, 50
ll18:
  s_waitcnt vmcnt(10)
  s_barrier
  s_add_u32 s30, s30, 1
  s_and_b32 s30, s30, 7
  s_cselect_b32 s32, 0, 1
  s_add_u32 s31, s31, s32
  s_sub_u32 s32, s30, s7
  s_and_b32 s32, s32, 7
  s_cmp_lt_u32 s32, 2
  s_cselect_b32 s32, 1, 0
  s_add_u32 s32, s32, s31
  s_cmp_ge_u32 s32, 7
  s_cselect_b32 s32, 0, s32
  s_lshl_b32 s33, s32, 3
  s_add_u32 s33, s33, s30
  s_mul_i32 s37, s33, 262144
  s_add_u32 s37, s37, s35
  s_add_u32 m0, s38, s45
  s_nop 0
  buffer_load_dwordx4 v9, s[12:15], s37 offen offset:0  lds
  buffer_load_dwordx4 v10, s[12:15], s37 offen offset:1024  lds
  s_add_u32 s38, s38, 8192
  s_cmp_eq_u32 s38, 163840
  s_cselect_b32 s38, 98304, s38
  s_sub_u32 s39, s39, 1
  s_cmp_lg_u32 s39, 0
  s_cbranch_scc1 ll18
  s_waitcnt vmcnt(10)
  s_barrier
  s_waitcnt vmcnt(8)
  s_barrier
  s_waitcnt vmcnt(6)
  s_barrier
  s_waitcnt vmcnt(4)
  s_barrier
  s_waitcnt vmcnt(2)
  s_barrier
  s_waitcnt vmcnt(0)
  s_barrier
  s_cmp_lg_u32 s3, 0
  s_cbranch_scc1 L_end
  s_lshr_b32 s32, s2, 3
  s_lshr_b32 s5, s32, 3
  s_and_b32 s6, s32, 7
  s_lshl_b32 s7, s5, 1
  s_add_u32 s7, s7, s6
  s_and_b32 s7, s7, 7
  s_and_b32 s32, s2, 7
  s_lshr_b32 s28, s32, 1
  s_lshl_b32 s28, s28, 2
  s_add_u32 s28, s28, s5
  s_and_b32 s29, s32, 1
  s_mul_i32 s29, s29, 8
  s_add_u32 s29, s29, s6
  s_mov_b32 s30, 7
  s_mov_b32 s31, -1
  s_mov_b32 s41, s57
  s_mul_i32 s32, s41, 16
  s_add_u32 s32, s32, 0
  v_lshrrev_b32 v2, 3, v0
  v_add_u32 v2, s32, v2
  v_bfe_u32 v3, v2, 1, 1
  v_bfe_u32 v4, v2, 3, 1
  v_lshl_or_b32 v3, v4, 1, v3
  v_lshlrev_b32 v3, 1, v3
  v_and_b32 v4, 7, v0
  v_xor_b32 v3, v3, v4
  v_lshlrev_b32 v3, 4, v3
  s_mov_b32 s32, 6144
  v_mul_lo_u32 v2, v2, s32
  v_add_u32 v13, v2, v3
  s_mul_i32 s32, s41, 16
  s_add_u32 s32, s32, 8
  v_lshrrev_b32 v2, 3, v0
  v_add_u32 v2, s32, v2
  v_bfe_u32 v3, v2, 1, 1
  v_bfe_u32 v4, v2, 3, 1
  v_lshl_or_b32 v3, v4, 1, v3
  v_lshlrev_b32 v3, 1, v3
  v_and_b32 v4, 7, v0
  v_xor_b32 v3, v3, v4
  v_lshlrev_b32 v3, 4, v3
  s_mov_b32 s32, 6144
  v_mul_lo_u32 v2, v2, s32
  v_add_u32 v14, v2, v3
  v_subrev_u32 v14, 1024, v14
  v_add_u32 v15, 2048, v13
  v_add_u32 v16, 2048, v14
  v_add_u32 v17, 4096, v13
  v_add_u32 v18, 4096, v14
  s_lshl_b32 s46, s41, 11
  s_add_u32 s46, s46, 18432
  s_add_u32 s47, s46, 8192
  s_add_u32 s48, s46, 16384
  s_lshl_b32 s35, s29, 7
  s_mov_b32 s12, s66
  s_mov_b32 s13, s67
  s_mov_b32 s14, 6291456
  s_mov_b32 s15, 0x20000
  s_mov_b32 s30, 7
  s_mov_b32 s31, -1
  s_mov_b32 s38, 0
  s_add_u32 s30, s30, 1
  s_and_b32 s30, s30, 7
  s_cselect_b32 s32, 0, 1
  s_add_u32 s31, s31, s32
  s_sub_u32 s32, s30, s7
  s_and_b32 s32, s32, 7
  s_cmp_lt_u32 s32, 2
  s_cselect_b32 s32, 1, 0
  s_add_u32 s32, s32, s31
  s_cmp_ge_u32 s32, 2
  s_cselect_b32 s32, 0, s32
  s_lshl_b32 s33, s32, 3
  s_add_u32 s33, s33, s30
  s_mul_i32 s37, s33, 393216
  s_add_u32 s37, s37, s35
  s_add_u32 m0, s38, s46
  s_nop 0
  buffer_load_dwordx4 v13, s[12:15], s37 offen offset:0  lds
  buffer_load_dwordx4 v14, s[12:15], s37 offen offset:1024  lds
  s_add_u32 m0, s38, s47
  s_nop 0
  buffer_load_dwordx4 v15, s[12:15], s37 offen offset:0  lds
  buffer_load_dwordx4 v16, s[12:15], s37 offen offset:1024  lds
  s_add_u32 m0, s38, s48
  s_nop 0
  buffer_load_dwordx4 v17, s[12:15], s37 offen offset:0  lds
  buffer_load_dwordx4 v18, s[12:15], s37 offen offset:1024  lds
  s_add_u32 s38, s38, 43008
  s_cmp_eq_u32 s38, 129024
  s_cselect_b32 s38, 0, s38
  s_add_u32 s30, s30, 1
  s_and_b32 s30, s30, 7
  s_cselect_b32 s32, 0, 1
  s_add_u32 s31, s31, s32
  s_sub_u32 s32, s30, s7
  s_and_b32 s32, s32, 7
  s_cmp_lt_u32 s32, 2
  s_cselect_b32 s32, 1, 0
  s_add_u32 s32, s32, s31
  s_cmp_ge_u32 s32, 2
  s_cselect_b32 s32, 0, s32
  s_lshl_b32 s33, s32, 3
  s_add_u32 s33, s33, s30
  s_mul_i32 s37, s33, 393216
  s_add_u32 s37, s37, s35
  s_add_u32 m0, s38, s46
  s_nop 0
  buffer_load_dwordx4 v13, s[12:15], s37 offen offset:0  lds
  buffer_load_dwordx4 v14, s[12:15], s37 offen offset:1024  lds
  s_add_u32 m0, s38, s47
  s_nop 0
  buffer_load_dwordx4 v15, s[12:15], s37 offen offset:0  lds
  buffer_load_dwordx4 v16, s[12:15], s37 offen offset:1024  lds
  s_add_u32 m0, s38, s48
  s_nop 0
  buffer_load_dwordx4 v17, s[12:15], s37 offen offset:0  lds
  buffer_load_dwordx4 v18, s[12:15], s37 offen offset:1024  lds
  s_add_u32 s38, s38, 43008
  s_cmp_eq_u32 s38, 129024
  s_cselect_b32 s38, 0, s38
  s_lshl_b32 s40, s28, 7
  s_sub_u32 s40, s40, 16
  s_lshl_b32 s32, s41, 5
  s_add_u32 s32, s32, 16
  v_lshrrev_b32 v2, 3, v0
  v_add_u32 v2, s32, v2
  v_bfe_u32 v3, v2, 1, 3
  v_and_b32 v4, 7, v0
  v_xor_b32 v3, v3, v4
  v_lshlrev_b32 v3, 4, v3
  v_add_u32 v2, s40, v2
  v_max_i32 v2, 0, v2
  v_lshlrev_b32 v2, 8, v2
  v_add_u32 v8, v2, v3
  v_add_u32 v10, 2048, v8
  s_lshl_b32 s32, s41, 5
  s_add_u32 s32, s32, 24
  v_lshrrev_b32 v2, 3, v0
  v_add_u32 v2, s32, v2
  v_bfe_u32 v3, v2, 1, 3
  v_and_b32 v4, 7, v0
  v_xor_b32 v3, v3, v4
  v_lshlrev_b32 v3, 4, v3
  v_add_u32 v2, s40, v2
  v_max_i32 v2, 0, v2
  v_lshlrev_b32 v2, 8, v2
  v_add_u32 v9, v2, v3
  v_subrev_u32 v9, 1024, v9
  v_add_u32 v11, 2048, v9
  s_lshl_b32 s32, s41, 3
  v_lshrrev_b32 v2, 3, v0
  v_add_u32 v2, s32, v2
  v_bfe_u32 v3, v2, 1, 3
  v_and_b32 v4, 7, v0
  v_xor_b32 v3, v3, v4
  v_lshlrev_b32 v3, 4, v3
  v_add_u32 v2, s40, v2
  v_max_i32 v2, 0, v2
  v_lshlrev_b32 v2, 8, v2
  v_add_u32 v12, v2, v3
  s_lshl_b32 s44, s41, 12
  s_add_u32 s44, s44, 2048
  s_lshl_b32 s45, s41, 10
  s_mov_b32 s34, 0
  s_mov_b32 s54, 524288
  s_cmp_eq_u32 s41, 0
  s_cselect_b32 s52, 0xffffff00, -1
  s_mov_b32 s53, -1
  v_mov_b32 v20, 0x3f803f80
  v_mov_b32 v21, v20
  v_mov_b32 v22, v20
  v_mov_b32 v23, v20
  v_lshlrev_b32 v24, 4, v0
  v_add_u32 v25, 86016, v24
  s_mov_b64 exec, 0xff
  ds_write_b128 v24, v[20:23]
  ds_write_b128 v24, v[20:23] offset:43008
  ds_write_b128 v25, v[20:23]
  s_mov_b64 exec, -1
  s_lshl_b32 s32, s41, 6
  v_add_u32 v26, s32, v0
  v_min_u32 v26, 143, v26
  v_add_u32 v27, s40, v26
  v_max_i32 v27, 0, v27
  v_lshrrev_b32 v2, 6, v27
  v_and_b32 v27, 63, v27
  v_lshlrev_b32 v27, 3, v27
  v_lshl_add_u32 v27, v2, 10, v27
  v_add_u32 v27, 512, v27
  v_lshlrev_b32 v26, 3, v26
  v_add_u32 v26, 129024, v26
  s_add_u32 s8, s84, 100663296
  s_addc_u32 s9, s85, 0
  s_mov_b32 s10, 8388608
  s_mov_b32 s11, 0x20000
  s_add_u32 s20, s84, 93323264
  s_addc_u32 s21, s85, 0
  s_mov_b32 s22, 262144
  s_mov_b32 s23, 0x20000
  s_waitcnt lgkmcnt(0)
  s_add_u32 s16, s84, 109051904
  s_addc_u32 s17, s85, 0
  s_mov_b32 s18, 524288
  s_mov_b32 s19, 0x20000
  v_min_u32 v28, 23, v0
  s_lshl_b32 s32, s28, 4
  s_sub_u32 s32, s32, 8
  v_add_u32 v28, s32, v28
  v_max_i32 v28, 0, v28
  v_lshlrev_b32 v28, 7, v28
  s_lshl_b32 s55, s3, 17
  s_add_u32 s55, s55, 98304
  s_barrier
  s_barrier
  s_mov_b64 exec, 1
  buffer_store_dword v137, v136, s[24:27], s56 offen sc0 sc1
  s_mov_b64 exec, -1
  s_mov_b32 s39, 0
  s_and_b32 s32, s4, 3
  s_cmp_lg_u32 s32, 0
  s_cbranch_scc1 poll19d
  s_sleep 8
poll19:
  buffer_load_dword v29, v28, s[16:19], s55 offen sc0 sc1
  s_waitcnt vmcnt(0)
  v_cmp_eq_u32 vcc, 0, v29
  s_add_u32 s39, s39, 1
  s_cmp_gt_u32 s39, 1000000
  s_cbranch_scc1 poll19d
  s_cbranch_vccnz poll19
poll19d:
  s_barrier
  s_mov_b32 s3, 1
  s_add_u32 s82, s84, 50331648
  s_addc_u32 s83, s85, 0
  s_branch L_top
L_end:
mega_end:
  s_endpgm
.section .rodata,"a"
.p2align 6
.amdhsa_kernel interleave_layers__sliding_local_dilated__mixer_token_mlp__prompt_kernel
  .amdhsa_next_free_vgpr 256
  .amdhsa_next_free_sgpr 102
  .amdhsa_accum_offset 256
  .amdhsa_group_segment_fixed_size 0
  .amdhsa_kernarg_size 88
  .amdhsa_user_sgpr_count 2
  .amdhsa_user_sgpr_kernarg_segment_ptr 1
  .amdhsa_system_sgpr_workgroup_id_x 1
.end_amdhsa_kernel
```

```asm
; @launch grid=(256,1,1) block=(512,1,1) lds=163840
.amdgcn_target "amdgcn-amd-amdhsa--gfx950"
.text
.globl interleave_layers__sliding_local_dilated__mixer_token_mlp__prompt_kernel
.type interleave_layers__sliding_local_dilated__mixer_token_mlp__prompt_kernel,@function
.p2align 8
interleave_layers__sliding_local_dilated__mixer_token_mlp__prompt_kernel:
  s_cmp_ge_u32 s2, 256
  s_cbranch_scc1 mega_end
  s_load_dwordx16 s[64:79], s[0:1], 0
  s_load_dwordx2 s[80:81], s[0:1], 64
  s_load_dwordx2 s[84:85], s[0:1], 80
  s_load_dwordx2 s[62:63], s[0:1], 72
  v_lshrrev_b32 v1, 6, v0
  v_and_b32 v0, 63, v0
  v_readfirstlane_b32 s4, v1
  s_mov_b32 s3, 0
  v_mov_b32 v130, 0
  v_mov_b32 v131, 0
  v_mov_b32 v134, 0
  s_cmp_ge_u32 s4, 4
  s_cbranch_scc1 L_start
  s_lshr_b32 s32, s2, 3
  s_lshr_b32 s5, s32, 3
  s_and_b32 s6, s32, 7
  s_lshl_b32 s7, s5, 1
  s_add_u32 s7, s7, s6
  s_and_b32 s7, s7, 7
  s_and_b32 s32, s2, 7
  s_lshr_b32 s28, s32, 1
  s_lshl_b32 s28, s28, 2
  s_add_u32 s28, s28, s5
  s_and_b32 s29, s32, 1
  s_mul_i32 s29, s29, 8
  s_add_u32 s29, s29, s6
  s_mov_b32 s30, 7
  s_mov_b32 s31, -1
  v_and_b32 v4, 15, v0
  v_lshrrev_b32 v5, 4, v0
  v_lshrrev_b32 v6, 2, v4
  v_and_b32 v7, 3, v0
  v_lshrrev_b32 v3, 5, v0
  v_and_b32 v2, 1, v5
  v_lshl_or_b32 v3, v2, 1, v3
  v_lshl_add_u32 v21, v5, 3, v6
  v_lshlrev_b32 v21, 7, v21
  v_lshl_add_u32 v21, v7, 3, v21
  v_lshrrev_b32 v22, 1, v6
  v_lshl_or_b32 v22, v2, 1, v22
  v_lshl_add_u32 v21, v22, 5, v21
  v_add_u32 v21, 18432, v21
  v_xor_b32 v8, 0, v21
  s_lshl_b32 s32, s4, 5
  v_xor_b32 v8, s32, v8
  v_lshrrev_b32 v21, 1, v4
  v_xor_b32 v21, v21, v5
  v_lshlrev_b32 v21, 4, v21
  v_lshlrev_b32 v22, 7, v4
  v_add_u32 v9, v21, v22
  v_xor_b32 v10, 64, v9
  v_and_b32 v21, 1, v4
  v_mul_u32_u24 v21, 28800, v21
  v_lshrrev_b32 v22, 1, v4
  v_mul_u32_u24 v22, 400, v22
  v_lshlrev_b32 v23, 3, v5
  v_add3_u32 v11, v21, v22, v23
  s_add_u32 s32, s32, 43008
  v_add_u32 v11, s32, v11
  v_lshlrev_b32 v12, 3, v4
  v_add_u32 v12, 129024, v12
  v_mov_b64 v[112:113], 0
  v_mov_b64 v[114:115], 0
  v_mov_b64 v[116:117], 0
  v_mov_b64 v[118:119], 0
  v_mov_b64 v[120:121], 0
  v_mov_b64 v[122:123], 0
  v_mov_b64 v[124:125], 0
  v_mov_b64 v[126:127], 0
  v_mov_b64 v[128:129], 0
  v_mov_b64 v[130:131], 0
  v_mov_b64 v[132:133], 0
  v_mov_b64 v[134:135], 0
  v_mov_b64 v[136:137], 0
  v_mov_b64 v[138:139], 0
  v_mov_b64 v[140:141], 0
  v_mov_b64 v[142:143], 0
  v_mov_b64 v[144:145], 0
  v_mov_b64 v[146:147], 0
  v_mov_b64 v[148:149], 0
  v_mov_b64 v[150:151], 0
  v_mov_b64 v[152:153], 0
  v_mov_b64 v[154:155], 0
  v_mov_b64 v[156:157], 0
  v_mov_b64 v[158:159], 0
  v_mov_b64 v[160:161], 0
  v_mov_b64 v[162:163], 0
  v_mov_b64 v[164:165], 0
  v_mov_b64 v[166:167], 0
  v_mov_b64 v[168:169], 0
  v_mov_b64 v[170:171], 0
  v_mov_b64 v[172:173], 0
  v_mov_b64 v[174:175], 0
  v_mov_b64 v[176:177], 0
  v_mov_b64 v[178:179], 0
  v_mov_b64 v[180:181], 0
  v_mov_b64 v[182:183], 0
  v_mov_b64 v[184:185], 0
  v_mov_b64 v[186:187], 0
  v_mov_b64 v[188:189], 0
  v_mov_b64 v[190:191], 0
  v_mov_b64 v[192:193], 0
  v_mov_b64 v[194:195], 0
  v_mov_b64 v[196:197], 0
  v_mov_b64 v[198:199], 0
  v_mov_b64 v[200:201], 0
  v_mov_b64 v[202:203], 0
  v_mov_b64 v[204:205], 0
  v_mov_b64 v[206:207], 0
  v_mov_b64 v[208:209], 0
  v_mov_b64 v[210:211], 0
  v_mov_b64 v[212:213], 0
  v_mov_b64 v[214:215], 0
  v_mov_b64 v[216:217], 0
  v_mov_b64 v[218:219], 0
  s_lshr_b32 s40, s4, 1
  s_and_b32 s41, s4, 1
  s_mul_i32 s32, s41, 28800
  s_add_u32 s32, s32, 43008
  s_lshl_b32 s49, s40, 4
  v_add_u32 v76, s49, v4
  v_lshlrev_b32 v77, 4, v5
  v_add_u32 v77, s32, v77
  v_mul_u32_u24 v78, 400, v76
  v_add_u32 v220, v78, v77
  v_add_u32 v223, 3200, v220
  v_add_u32 v220, 128, v220
  v_add_u32 v76, 16, v76
  v_min_u32 v76, 71, v76
  v_mul_u32_u24 v78, 400, v76
  v_add3_u32 v221, v78, v77, 64
  v_add_u32 v221, 64, v221
  v_lshl_add_u32 v76, v5, 2, v6
  v_add_u32 v76, s49, v76
  v_lshlrev_b32 v77, 4, v7
  v_add_u32 v77, s32, v77
  v_add_u32 v77, 256, v77
  v_mul_u32_u24 v78, 400, v76
  v_add_u32 v222, v78, v77
  v_add_u32 v76, 16, v76
  v_min_u32 v76, 71, v76
  v_mul_u32_u24 v78, 400, v76
  v_add_u32 v254, v78, v77
  s_lshl_b32 s50, s28, 2
  s_add_u32 s50, s50, s40
  s_lshl_b32 s50, s50, 17
  s_lshl_b32 s51, s29, 13
  s_add_u32 s50, s50, s51
  s_lshl_b32 s51, s41, 11
  s_add_u32 s50, s50, s51
  s_and_b32 s51, s40, 1
  s_lshl_b32 s32, s51, 1
  s_add_u32 s32, s32, s41
  s_cmp_eq_u32 s32, 3
  s_addc_u32 s32, s32, 5
  s_lshl_b32 s32, s32, 7
  s_mov_b32 vcc_lo, 0xff000000
  s_mov_b32 vcc_hi, 0
  v_mov_b32 v1, s32
  v_cndmask_b32 v1, 0, v1, vcc
  v_lshl_add_u32 v1, v0, 4, v1
  v_add_u32 v1, s50, v1
  v_lshlrev_b32 v76, 2, v5
  v_sub_u32 v76, v76, v4
  s_or_b32 s51, s28, s40
  s_cmp_eq_u32 s51, 0
  s_cselect_b32 s51, 0, -1
  v_add_u32 v77, -1, v76
  v_cmp_gt_u32 s[86:87], 8, v77
  v_add_u32 v77, 0, v76
  v_cmp_gt_u32 s[88:89], 8, v77
  v_add_u32 v77, 1, v76
  v_cmp_gt_u32 s[90:91], 8, v77
  v_add_u32 v77, 2, v76
  v_cmp_gt_u32 s[92:93], 8, v77
  v_add_u32 v77, 15, v76
  v_cmp_gt_u32 s[94:95], 8, v77
  v_add_u32 v77, 16, v76
  v_cmp_gt_u32 s[96:97], 8, v77
  v_add_u32 v77, 17, v76
  v_cmp_gt_u32 s[98:99], 8, v77
  v_add_u32 v77, 18, v76
  v_cmp_gt_u32 s[100:101], 8, v77
  s_and_b32 s86, s86, s51
  s_and_b32 s88, s88, s51
  s_and_b32 s90, s90, s51
  s_and_b32 s92, s92, s51
  s_waitcnt lgkmcnt(0)
  s_mov_b32 s82, s84
  s_mov_b32 s83, s85
  s_mov_b32 s12, s84
  s_mov_b32 s13, s85
  s_mov_b32 s14, 0
  s_mov_b32 s15, 0x20000
  s_mov_b32 s20, s66
  s_mov_b32 s21, s67
  s_mov_b32 s22, 6291456
  s_mov_b32 s23, 0x20000
  s_cmp_eq_u32 s4, 3
  s_cselect_b32 s20, s68, s20
  s_cselect_b32 s21, s69, s21
  s_cselect_b32 s22, 2097152, s22
  s_cselect_b32 s47, 0, s4
  s_lshl_b32 s47, s47, 8
  s_add_u32 s47, s47, s2
  s_lshl_b32 s47, s47, 13
  v_lshlrev_b32 v13, 7, v0
  s_mov_b32 s51, s4
  s_barrier
  s_cmp_lg_u32 s51, 0
  s_cbranch_scc1 C_wm0
  buffer_load_dword v15, v13, s[20:23], s47 offen
C_wm0:
  s_mov_b32 s16, s66
  s_mov_b32 s17, s67
  s_mov_b32 s18, 6291456
  s_mov_b32 s19, 0x20000
  s_lshr_b32 s32, s2, 3
  s_lshl_b32 s32, s32, 1
  s_add_u32 s32, s32, s4
  s_sub_u32 s32, s32, 1
  s_lshl_b32 s32, s32, 6
  v_add_u32 v16, s32, v0
  v_mul_u32_u24 v17, 21846, v16
  v_lshrrev_b32 v17, 16, v17
  v_mul_u32_u24 v18, 3, v17
  v_sub_u32 v18, v16, v18
  v_mul_u32_u24 v17, 6144, v17
  v_lshl_add_u32 v14, v18, 11, v17
  s_and_b32 s32, s2, 1
  s_lshl_b32 s32, s32, 10
  s_add_u32 s32, s32, 384
  s_sub_u32 s40, s4, 1
  s_cmp_lt_u32 s40, 2
  s_cselect_b32 s18, s18, 0
  buffer_load_dword v15, v14, s[16:19], s32 offen
C_top:
  s_nop 7
  s_nop 7
  s_mov_b32 s43, 0
  s_mov_b32 s39, 12
  s_barrier
  ds_read_b64_tr_b16 v[16:17], v8 offset:0
  ds_read_b64_tr_b16 v[18:19], v8 offset:512
  ds_read_b128 v[28:31], v9 offset:0
  ds_read_b64_tr_b16 v[20:21], v8 offset:8192
  ds_read_b64_tr_b16 v[22:23], v8 offset:8704
  ds_read_b64_tr_b16 v[24:25], v8 offset:16384
  ds_read_b64_tr_b16 v[26:27], v8 offset:16896
  ds_read_b128 v[32:35], v9 offset:2048
  ds_read_b128 v[36:39], v9 offset:4096
  ds_read_b128 v[40:43], v9 offset:6144
  ds_read_b128 v[44:47], v9 offset:8192
  ds_read_b128 v[48:51], v9 offset:10240
  ds_read_b128 v[52:55], v9 offset:12288
  ds_read_b128 v[56:59], v9 offset:14336
  ds_read_b128 v[60:63], v9 offset:16384
  s_add_u32 s40, s43, 43008
  s_cmp_eq_u32 s40, 129024
  s_cselect_b32 s40, 0, s40
  s_sub_u32 s42, s40, s43
  s_mov_b32 s43, s40
  s_waitcnt lgkmcnt(12)
  v_mfma_f32_16x16x32_bf16 v[112:115], v[16:19], v[28:31], v[112:115]
  ds_read_b64_tr_b16 v[64:65], v8 offset:4096
  s_waitcnt lgkmcnt(11)
  v_mfma_f32_16x16x32_bf16 v[148:151], v[20:23], v[28:31], v[148:151]
  ds_read_b64_tr_b16 v[66:67], v8 offset:4608
  s_waitcnt lgkmcnt(10)
  v_mfma_f32_16x16x32_bf16 v[184:187], v[24:27], v[28:31], v[184:187]
  ds_read_b128 v[76:79], v10 offset:0
  s_waitcnt lgkmcnt(10)
  v_mfma_f32_16x16x32_bf16 v[188:191], v[24:27], v[32:35], v[188:191]
  ds_read_b64_tr_b16 v[68:69], v8 offset:12288
  v_mfma_f32_16x16x32_bf16 v[152:155], v[20:23], v[32:35], v[152:155]
  ds_read_b64_tr_b16 v[70:71], v8 offset:12800
  v_mfma_f32_16x16x32_bf16 v[116:119], v[16:19], v[32:35], v[116:119]
  ds_read_b64_tr_b16 v[72:73], v8 offset:20480
  s_waitcnt lgkmcnt(12)
  v_mfma_f32_16x16x32_bf16 v[120:123], v[16:19], v[36:39], v[120:123]
  ds_read_b64_tr_b16 v[74:75], v8 offset:20992
  v_add_u32 v8, s42, v8
  v_mfma_f32_16x16x32_bf16 v[156:159], v[20:23], v[36:39], v[156:159]
  ds_read_b128 v[80:83], v10 offset:2048
  v_mfma_f32_16x16x32_bf16 v[192:195], v[24:27], v[36:39], v[192:195]
  ds_read_b128 v[84:87], v10 offset:4096
  s_waitcnt lgkmcnt(14)
  v_mfma_f32_16x16x32_bf16 v[196:199], v[24:27], v[40:43], v[196:199]
  ds_read_b128 v[88:91], v10 offset:6144
  v_mfma_f32_16x16x32_bf16 v[160:163], v[20:23], v[40:43], v[160:163]
  ds_read_b128 v[92:95], v10 offset:8192
  v_mfma_f32_16x16x32_bf16 v[124:127], v[16:19], v[40:43], v[124:127]
  ds_read_b128 v[96:99], v10 offset:10240
  s_waitcnt lgkmcnt(14)
  v_mfma_f32_16x16x32_bf16 v[128:131], v[16:19], v[44:47], v[128:131]
  ds_read_b128 v[100:103], v10 offset:12288
  v_mfma_f32_16x16x32_bf16 v[164:167], v[20:23], v[44:47], v[164:167]
  ds_read_b128 v[104:107], v10 offset:14336
  v_mfma_f32_16x16x32_bf16 v[200:203], v[24:27], v[44:47], v[200:203]
  ds_read_b128 v[108:111], v10 offset:16384
  v_add_u32 v9, s42, v9
  v_add_u32 v10, s42, v10
  v_mfma_f32_16x16x32_bf16 v[204:207], v[24:27], v[48:51], v[204:207]
  v_mfma_f32_16x16x32_bf16 v[168:171], v[20:23], v[48:51], v[168:171]
  v_mfma_f32_16x16x32_bf16 v[132:135], v[16:19], v[48:51], v[132:135]
  v_mfma_f32_16x16x32_bf16 v[136:139], v[16:19], v[52:55], v[136:139]
  v_mfma_f32_16x16x32_bf16 v[172:175], v[20:23], v[52:55], v[172:175]
  v_mfma_f32_16x16x32_bf16 v[208:211], v[24:27], v[52:55], v[208:211]
  s_waitcnt lgkmcnt(14)
  v_mfma_f32_16x16x32_bf16 v[212:215], v[24:27], v[56:59], v[212:215]
  v_mfma_f32_16x16x32_bf16 v[176:179], v[20:23], v[56:59], v[176:179]
  v_mfma_f32_16x16x32_bf16 v[140:143], v[16:19], v[56:59], v[140:143]
  v_mfma_f32_16x16x32_bf16 v[144:147], v[16:19], v[60:63], v[144:147]
  v_mfma_f32_16x16x32_bf16 v[180:183], v[20:23], v[60:63], v[180:183]
  v_mfma_f32_16x16x32_bf16 v[216:219], v[24:27], v[60:63], v[216:219]
  s_waitcnt lgkmcnt(0)
  s_barrier
  s_cmp_lg_u32 s51, 1
  s_cbranch_scc1 C_wm1
  buffer_load_dword v15, v13, s[20:23], s47 offen
C_wm1:
  v_mfma_f32_16x16x32_bf16 v[112:115], v[64:67], v[76:79], v[112:115]
  ds_read_b64_tr_b16 v[16:17], v8 offset:0
  s_add_u32 s40, s43, 43008
  v_mfma_f32_16x16x32_bf16 v[148:151], v[68:71], v[76:79], v[148:151]
  ds_read_b64_tr_b16 v[18:19], v8 offset:512
  s_cmp_eq_u32 s40, 129024
  v_mfma_f32_16x16x32_bf16 v[184:187], v[72:75], v[76:79], v[184:187]
  ds_read_b128 v[28:31], v9 offset:0
  s_cselect_b32 s40, 0, s40
  v_mfma_f32_16x16x32_bf16 v[188:191], v[72:75], v[80:83], v[188:191]
  ds_read_b64_tr_b16 v[20:21], v8 offset:8192
  s_sub_u32 s42, s40, s43
  v_mfma_f32_16x16x32_bf16 v[152:155], v[68:71], v[80:83], v[152:155]
  ds_read_b64_tr_b16 v[22:23], v8 offset:8704
  s_mov_b32 s43, s40
  v_mfma_f32_16x16x32_bf16 v[116:119], v[64:67], v[80:83], v[116:119]
  ds_read_b64_tr_b16 v[24:25], v8 offset:16384
  v_mfma_f32_16x16x32_bf16 v[120:123], v[64:67], v[84:87], v[120:123]
  ds_read_b64_tr_b16 v[26:27], v8 offset:16896
  v_mfma_f32_16x16x32_bf16 v[156:159], v[68:71], v[84:87], v[156:159]
  ds_read_b128 v[32:35], v9 offset:2048
  v_mfma_f32_16x16x32_bf16 v[192:195], v[72:75], v[84:87], v[192:195]
  ds_read_b128 v[36:39], v9 offset:4096
  v_mfma_f32_16x16x32_bf16 v[196:199], v[72:75], v[88:91], v[196:199]
  ds_read_b128 v[40:43], v9 offset:6144
  v_mfma_f32_16x16x32_bf16 v[160:163], v[68:71], v[88:91], v[160:163]
  ds_read_b128 v[44:47], v9 offset:8192
  v_mfma_f32_16x16x32_bf16 v[124:127], v[64:67], v[88:91], v[124:127]
  ds_read_b128 v[48:51], v9 offset:10240
  v_mfma_f32_16x16x32_bf16 v[128:131], v[64:67], v[92:95], v[128:131]
  ds_read_b128 v[52:55], v9 offset:12288
  v_mfma_f32_16x16x32_bf16 v[164:167], v[68:71], v[92:95], v[164:167]
  ds_read_b128 v[56:59], v9 offset:14336
  v_mfma_f32_16x16x32_bf16 v[200:203], v[72:75], v[92:95], v[200:203]
  ds_read_b128 v[60:63], v9 offset:16384
  v_mfma_f32_16x16x32_bf16 v[204:207], v[72:75], v[96:99], v[204:207]
  v_mfma_f32_16x16x32_bf16 v[168:171], v[68:71], v[96:99], v[168:171]
  v_mfma_f32_16x16x32_bf16 v[132:135], v[64:67], v[96:99], v[132:135]
  v_mfma_f32_16x16x32_bf16 v[136:139], v[64:67], v[100:103], v[136:139]
  v_mfma_f32_16x16x32_bf16 v[172:175], v[68:71], v[100:103], v[172:175]
  v_mfma_f32_16x16x32_bf16 v[208:211], v[72:75], v[100:103], v[208:211]
  v_mfma_f32_16x16x32_bf16 v[212:215], v[72:75], v[104:107], v[212:215]
  v_mfma_f32_16x16x32_bf16 v[176:179], v[68:71], v[104:107], v[176:179]
  v_mfma_f32_16x16x32_bf16 v[140:143], v[64:67], v[104:107], v[140:143]
  v_mfma_f32_16x16x32_bf16 v[144:147], v[64:67], v[108:111], v[144:147]
  v_mfma_f32_16x16x32_bf16 v[180:183], v[68:71], v[108:111], v[180:183]
  v_mfma_f32_16x16x32_bf16 v[216:219], v[72:75], v[108:111], v[216:219]
  s_waitcnt lgkmcnt(12)
  v_mfma_f32_16x16x32_bf16 v[112:115], v[16:19], v[28:31], v[112:115]
  ds_read_b64_tr_b16 v[64:65], v8 offset:4096
  s_waitcnt lgkmcnt(11)
  v_mfma_f32_16x16x32_bf16 v[148:151], v[20:23], v[28:31], v[148:151]
  ds_read_b64_tr_b16 v[66:67], v8 offset:4608
  s_waitcnt lgkmcnt(10)
  v_mfma_f32_16x16x32_bf16 v[184:187], v[24:27], v[28:31], v[184:187]
  ds_read_b128 v[76:79], v10 offset:0
  s_waitcnt lgkmcnt(10)
  v_mfma_f32_16x16x32_bf16 v[188:191], v[24:27], v[32:35], v[188:191]
  ds_read_b64_tr_b16 v[68:69], v8 offset:12288
  v_mfma_f32_16x16x32_bf16 v[152:155], v[20:23], v[32:35], v[152:155]
  ds_read_b64_tr_b16 v[70:71], v8 offset:12800
  v_mfma_f32_16x16x32_bf16 v[116:119], v[16:19], v[32:35], v[116:119]
  ds_read_b64_tr_b16 v[72:73], v8 offset:20480
  s_waitcnt lgkmcnt(12)
  v_mfma_f32_16x16x32_bf16 v[120:123], v[16:19], v[36:39], v[120:123]
  ds_read_b64_tr_b16 v[74:75], v8 offset:20992
  v_add_u32 v8, s42, v8
  v_mfma_f32_16x16x32_bf16 v[156:159], v[20:23], v[36:39], v[156:159]
  ds_read_b128 v[80:83], v10 offset:2048
  v_mfma_f32_16x16x32_bf16 v[192:195], v[24:27], v[36:39], v[192:195]
  ds_read_b128 v[84:87], v10 offset:4096
  s_waitcnt lgkmcnt(14)
  v_mfma_f32_16x16x32_bf16 v[196:199], v[24:27], v[40:43], v[196:199]
  ds_read_b128 v[88:91], v10 offset:6144
  v_mfma_f32_16x16x32_bf16 v[160:163], v[20:23], v[40:43], v[160:163]
  ds_read_b128 v[92:95], v10 offset:8192
  v_mfma_f32_16x16x32_bf16 v[124:127], v[16:19], v[40:43], v[124:127]
  ds_read_b128 v[96:99], v10 offset:10240
  s_waitcnt lgkmcnt(14)
  v_mfma_f32_16x16x32_bf16 v[128:131], v[16:19], v[44:47], v[128:131]
  ds_read_b128 v[100:103], v10 offset:12288
  v_mfma_f32_16x16x32_bf16 v[164:167], v[20:23], v[44:47], v[164:167]
  ds_read_b128 v[104:107], v10 offset:14336
  v_mfma_f32_16x16x32_bf16 v[200:203], v[24:27], v[44:47], v[200:203]
  ds_read_b128 v[108:111], v10 offset:16384
  v_add_u32 v9, s42, v9
  v_add_u32 v10, s42, v10
  v_mfma_f32_16x16x32_bf16 v[204:207], v[24:27], v[48:51], v[204:207]
  v_mfma_f32_16x16x32_bf16 v[168:171], v[20:23], v[48:51], v[168:171]
  v_mfma_f32_16x16x32_bf16 v[132:135], v[16:19], v[48:51], v[132:135]
  v_mfma_f32_16x16x32_bf16 v[136:139], v[16:19], v[52:55], v[136:139]
  v_mfma_f32_16x16x32_bf16 v[172:175], v[20:23], v[52:55], v[172:175]
  v_mfma_f32_16x16x32_bf16 v[208:211], v[24:27], v[52:55], v[208:211]
  s_waitcnt lgkmcnt(14)
  v_mfma_f32_16x16x32_bf16 v[212:215], v[24:27], v[56:59], v[212:215]
  v_mfma_f32_16x16x32_bf16 v[176:179], v[20:23], v[56:59], v[176:179]
  v_mfma_f32_16x16x32_bf16 v[140:143], v[16:19], v[56:59], v[140:143]
  v_mfma_f32_16x16x32_bf16 v[144:147], v[16:19], v[60:63], v[144:147]
  v_mfma_f32_16x16x32_bf16 v[180:183], v[20:23], v[60:63], v[180:183]
  v_mfma_f32_16x16x32_bf16 v[216:219], v[24:27], v[60:63], v[216:219]
  s_waitcnt lgkmcnt(0)
  s_barrier
  s_cmp_lg_u32 s51, 2
  s_cbranch_scc1 C_wm2
  buffer_load_dword v15, v13, s[20:23], s47 offen
C_wm2:
  v_mfma_f32_16x16x32_bf16 v[112:115], v[64:67], v[76:79], v[112:115]
  ds_read_b64_tr_b16 v[16:17], v8 offset:0
  s_add_u32 s40, s43, 43008
  v_mfma_f32_16x16x32_bf16 v[148:151], v[68:71], v[76:79], v[148:151]
  ds_read_b64_tr_b16 v[18:19], v8 offset:512
  s_cmp_eq_u32 s40, 129024
  v_mfma_f32_16x16x32_bf16 v[184:187], v[72:75], v[76:79], v[184:187]
  ds_read_b128 v[28:31], v9 offset:0
  s_cselect_b32 s40, 0, s40
  v_mfma_f32_16x16x32_bf16 v[188:191], v[72:75], v[80:83], v[188:191]
  ds_read_b64_tr_b16 v[20:21], v8 offset:8192
  s_sub_u32 s42, s40, s43
  v_mfma_f32_16x16x32_bf16 v[152:155], v[68:71], v[80:83], v[152:155]
  ds_read_b64_tr_b16 v[22:23], v8 offset:8704
  s_mov_b32 s43, s40
  v_mfma_f32_16x16x32_bf16 v[116:119], v[64:67], v[80:83], v[116:119]
  ds_read_b64_tr_b16 v[24:25], v8 offset:16384
  v_mfma_f32_16x16x32_bf16 v[120:123], v[64:67], v[84:87], v[120:123]
  ds_read_b64_tr_b16 v[26:27], v8 offset:16896
  v_mfma_f32_16x16x32_bf16 v[156:159], v[68:71], v[84:87], v[156:159]
  ds_read_b128 v[32:35], v9 offset:2048
  v_mfma_f32_16x16x32_bf16 v[192:195], v[72:75], v[84:87], v[192:195]
  ds_read_b128 v[36:39], v9 offset:4096
  v_mfma_f32_16x16x32_bf16 v[196:199], v[72:75], v[88:91], v[196:199]
  ds_read_b128 v[40:43], v9 offset:6144
  v_mfma_f32_16x16x32_bf16 v[160:163], v[68:71], v[88:91], v[160:163]
  ds_read_b128 v[44:47], v9 offset:8192
  v_mfma_f32_16x16x32_bf16 v[124:127], v[64:67], v[88:91], v[124:127]
  ds_read_b128 v[48:51], v9 offset:10240
  v_mfma_f32_16x16x32_bf16 v[128:131], v[64:67], v[92:95], v[128:131]
  ds_read_b128 v[52:55], v9 offset:12288
  v_mfma_f32_16x16x32_bf16 v[164:167], v[68:71], v[92:95], v[164:167]
  ds_read_b128 v[56:59], v9 offset:14336
  v_mfma_f32_16x16x32_bf16 v[200:203], v[72:75], v[92:95], v[200:203]
  ds_read_b128 v[60:63], v9 offset:16384
  v_mfma_f32_16x16x32_bf16 v[204:207], v[72:75], v[96:99], v[204:207]
  v_mfma_f32_16x16x32_bf16 v[168:171], v[68:71], v[96:99], v[168:171]
  v_mfma_f32_16x16x32_bf16 v[132:135], v[64:67], v[96:99], v[132:135]
  v_mfma_f32_16x16x32_bf16 v[136:139], v[64:67], v[100:103], v[136:139]
  v_mfma_f32_16x16x32_bf16 v[172:175], v[68:71], v[100:103], v[172:175]
  v_mfma_f32_16x16x32_bf16 v[208:211], v[72:75], v[100:103], v[208:211]
  v_mfma_f32_16x16x32_bf16 v[212:215], v[72:75], v[104:107], v[212:215]
  v_mfma_f32_16x16x32_bf16 v[176:179], v[68:71], v[104:107], v[176:179]
  v_mfma_f32_16x16x32_bf16 v[140:143], v[64:67], v[104:107], v[140:143]
  v_mfma_f32_16x16x32_bf16 v[144:147], v[64:67], v[108:111], v[144:147]
  v_mfma_f32_16x16x32_bf16 v[180:183], v[68:71], v[108:111], v[180:183]
  v_mfma_f32_16x16x32_bf16 v[216:219], v[72:75], v[108:111], v[216:219]
  s_waitcnt lgkmcnt(12)
  v_mfma_f32_16x16x32_bf16 v[112:115], v[16:19], v[28:31], v[112:115]
  ds_read_b64_tr_b16 v[64:65], v8 offset:4096
  s_waitcnt lgkmcnt(11)
  v_mfma_f32_16x16x32_bf16 v[148:151], v[20:23], v[28:31], v[148:151]
  ds_read_b64_tr_b16 v[66:67], v8 offset:4608
  s_waitcnt lgkmcnt(10)
  v_mfma_f32_16x16x32_bf16 v[184:187], v[24:27], v[28:31], v[184:187]
  ds_read_b128 v[76:79], v10 offset:0
  s_waitcnt lgkmcnt(10)
  v_mfma_f32_16x16x32_bf16 v[188:191], v[24:27], v[32:35], v[188:191]
  ds_read_b64_tr_b16 v[68:69], v8 offset:12288
  v_mfma_f32_16x16x32_bf16 v[152:155], v[20:23], v[32:35], v[152:155]
  ds_read_b64_tr_b16 v[70:71], v8 offset:12800
  v_mfma_f32_16x16x32_bf16 v[116:119], v[16:19], v[32:35], v[116:119]
  ds_read_b64_tr_b16 v[72:73], v8 offset:20480
  s_waitcnt lgkmcnt(12)
  v_mfma_f32_16x16x32_bf16 v[120:123], v[16:19], v[36:39], v[120:123]
  ds_read_b64_tr_b16 v[74:75], v8 offset:20992
  v_add_u32 v8, s42, v8
  v_mfma_f32_16x16x32_bf16 v[156:159], v[20:23], v[36:39], v[156:159]
  ds_read_b128 v[80:83], v10 offset:2048
  v_mfma_f32_16x16x32_bf16 v[192:195], v[24:27], v[36:39], v[192:195]
  ds_read_b128 v[84:87], v10 offset:4096
  s_waitcnt lgkmcnt(14)
  v_mfma_f32_16x16x32_bf16 v[196:199], v[24:27], v[40:43], v[196:199]
  ds_read_b128 v[88:91], v10 offset:6144
  v_mfma_f32_16x16x32_bf16 v[160:163], v[20:23], v[40:43], v[160:163]
  ds_read_b128 v[92:95], v10 offset:8192
  v_mfma_f32_16x16x32_bf16 v[124:127], v[16:19], v[40:43], v[124:127]
  ds_read_b128 v[96:99], v10 offset:10240
  s_waitcnt lgkmcnt(14)
  v_mfma_f32_16x16x32_bf16 v[128:131], v[16:19], v[44:47], v[128:131]
  ds_read_b128 v[100:103], v10 offset:12288
  v_mfma_f32_16x16x32_bf16 v[164:167], v[20:23], v[44:47], v[164:167]
  ds_read_b128 v[104:107], v10 offset:14336
  v_mfma_f32_16x16x32_bf16 v[200:203], v[24:27], v[44:47], v[200:203]
  ds_read_b128 v[108:111], v10 offset:16384
  v_add_u32 v9, s42, v9
  v_add_u32 v10, s42, v10
  v_mfma_f32_16x16x32_bf16 v[204:207], v[24:27], v[48:51], v[204:207]
  v_mfma_f32_16x16x32_bf16 v[168:171], v[20:23], v[48:51], v[168:171]
  v_mfma_f32_16x16x32_bf16 v[132:135], v[16:19], v[48:51], v[132:135]
  v_mfma_f32_16x16x32_bf16 v[136:139], v[16:19], v[52:55], v[136:139]
  v_mfma_f32_16x16x32_bf16 v[172:175], v[20:23], v[52:55], v[172:175]
  v_mfma_f32_16x16x32_bf16 v[208:211], v[24:27], v[52:55], v[208:211]
  s_waitcnt lgkmcnt(14)
  v_mfma_f32_16x16x32_bf16 v[212:215], v[24:27], v[56:59], v[212:215]
  v_mfma_f32_16x16x32_bf16 v[176:179], v[20:23], v[56:59], v[176:179]
  v_mfma_f32_16x16x32_bf16 v[140:143], v[16:19], v[56:59], v[140:143]
  v_mfma_f32_16x16x32_bf16 v[144:147], v[16:19], v[60:63], v[144:147]
  v_mfma_f32_16x16x32_bf16 v[180:183], v[20:23], v[60:63], v[180:183]
  v_mfma_f32_16x16x32_bf16 v[216:219], v[24:27], v[60:63], v[216:219]
  s_waitcnt lgkmcnt(0)
  s_barrier
  s_cmp_lg_u32 s51, 3
  s_cbranch_scc1 C_wm3
  buffer_load_dword v15, v13, s[20:23], s47 offen
C_wm3:
  v_mfma_f32_16x16x32_bf16 v[112:115], v[64:67], v[76:79], v[112:115]
  ds_read_b64_tr_b16 v[16:17], v8 offset:0
  s_add_u32 s40, s43, 43008
  v_mfma_f32_16x16x32_bf16 v[148:151], v[68:71], v[76:79], v[148:151]
  ds_read_b64_tr_b16 v[18:19], v8 offset:512
  s_cmp_eq_u32 s40, 129024
  v_mfma_f32_16x16x32_bf16 v[184:187], v[72:75], v[76:79], v[184:187]
  ds_read_b128 v[28:31], v9 offset:0
  s_cselect_b32 s40, 0, s40
  v_mfma_f32_16x16x32_bf16 v[188:191], v[72:75], v[80:83], v[188:191]
  ds_read_b64_tr_b16 v[20:21], v8 offset:8192
  s_sub_u32 s42, s40, s43
  v_mfma_f32_16x16x32_bf16 v[152:155], v[68:71], v[80:83], v[152:155]
  ds_read_b64_tr_b16 v[22:23], v8 offset:8704
  s_mov_b32 s43, s40
  v_mfma_f32_16x16x32_bf16 v[116:119], v[64:67], v[80:83], v[116:119]
  ds_read_b64_tr_b16 v[24:25], v8 offset:16384
  v_mfma_f32_16x16x32_bf16 v[120:123], v[64:67], v[84:87], v[120:123]
  ds_read_b64_tr_b16 v[26:27], v8 offset:16896
  v_mfma_f32_16x16x32_bf16 v[156:159], v[68:71], v[84:87], v[156:159]
  ds_read_b128 v[32:35], v9 offset:2048
  v_mfma_f32_16x16x32_bf16 v[192:195], v[72:75], v[84:87], v[192:195]
  ds_read_b128 v[36:39], v9 offset:4096
  v_mfma_f32_16x16x32_bf16 v[196:199], v[72:75], v[88:91], v[196:199]
  ds_read_b128 v[40:43], v9 offset:6144
  v_mfma_f32_16x16x32_bf16 v[160:163], v[68:71], v[88:91], v[160:163]
  ds_read_b128 v[44:47], v9 offset:8192
  v_mfma_f32_16x16x32_bf16 v[124:127], v[64:67], v[88:91], v[124:127]
  ds_read_b128 v[48:51], v9 offset:10240
  v_mfma_f32_16x16x32_bf16 v[128:131], v[64:67], v[92:95], v[128:131]
  ds_read_b128 v[52:55], v9 offset:12288
  v_mfma_f32_16x16x32_bf16 v[164:167], v[68:71], v[92:95], v[164:167]
  ds_read_b128 v[56:59], v9 offset:14336
  v_mfma_f32_16x16x32_bf16 v[200:203], v[72:75], v[92:95], v[200:203]
  ds_read_b128 v[60:63], v9 offset:16384
  v_mfma_f32_16x16x32_bf16 v[204:207], v[72:75], v[96:99], v[204:207]
  v_mfma_f32_16x16x32_bf16 v[168:171], v[68:71], v[96:99], v[168:171]
  v_mfma_f32_16x16x32_bf16 v[132:135], v[64:67], v[96:99], v[132:135]
  v_mfma_f32_16x16x32_bf16 v[136:139], v[64:67], v[100:103], v[136:139]
  v_mfma_f32_16x16x32_bf16 v[172:175], v[68:71], v[100:103], v[172:175]
  v_mfma_f32_16x16x32_bf16 v[208:211], v[72:75], v[100:103], v[208:211]
  v_mfma_f32_16x16x32_bf16 v[212:215], v[72:75], v[104:107], v[212:215]
  v_mfma_f32_16x16x32_bf16 v[176:179], v[68:71], v[104:107], v[176:179]
  v_mfma_f32_16x16x32_bf16 v[140:143], v[64:67], v[104:107], v[140:143]
  v_mfma_f32_16x16x32_bf16 v[144:147], v[64:67], v[108:111], v[144:147]
  v_mfma_f32_16x16x32_bf16 v[180:183], v[68:71], v[108:111], v[180:183]
  v_mfma_f32_16x16x32_bf16 v[216:219], v[72:75], v[108:111], v[216:219]
cl1:
  s_waitcnt lgkmcnt(12)
  v_mfma_f32_16x16x32_bf16 v[112:115], v[16:19], v[28:31], v[112:115]
  ds_read_b64_tr_b16 v[64:65], v8 offset:4096
  s_waitcnt lgkmcnt(11)
  v_mfma_f32_16x16x32_bf16 v[148:151], v[20:23], v[28:31], v[148:151]
  ds_read_b64_tr_b16 v[66:67], v8 offset:4608
  s_waitcnt lgkmcnt(10)
  v_mfma_f32_16x16x32_bf16 v[184:187], v[24:27], v[28:31], v[184:187]
  ds_read_b128 v[76:79], v10 offset:0
  s_waitcnt lgkmcnt(10)
  v_mfma_f32_16x16x32_bf16 v[188:191], v[24:27], v[32:35], v[188:191]
  ds_read_b64_tr_b16 v[68:69], v8 offset:12288
  v_mfma_f32_16x16x32_bf16 v[152:155], v[20:23], v[32:35], v[152:155]
  ds_read_b64_tr_b16 v[70:71], v8 offset:12800
  v_mfma_f32_16x16x32_bf16 v[116:119], v[16:19], v[32:35], v[116:119]
  ds_read_b64_tr_b16 v[72:73], v8 offset:20480
  s_waitcnt lgkmcnt(12)
  v_mfma_f32_16x16x32_bf16 v[120:123], v[16:19], v[36:39], v[120:123]
  ds_read_b64_tr_b16 v[74:75], v8 offset:20992
  v_add_u32 v8, s42, v8
  v_mfma_f32_16x16x32_bf16 v[156:159], v[20:23], v[36:39], v[156:159]
  ds_read_b128 v[80:83], v10 offset:2048
  v_mfma_f32_16x16x32_bf16 v[192:195], v[24:27], v[36:39], v[192:195]
  ds_read_b128 v[84:87], v10 offset:4096
  s_waitcnt lgkmcnt(14)
  v_mfma_f32_16x16x32_bf16 v[196:199], v[24:27], v[40:43], v[196:199]
  ds_read_b128 v[88:91], v10 offset:6144
  v_mfma_f32_16x16x32_bf16 v[160:163], v[20:23], v[40:43], v[160:163]
  ds_read_b128 v[92:95], v10 offset:8192
  v_mfma_f32_16x16x32_bf16 v[124:127], v[16:19], v[40:43], v[124:127]
  ds_read_b128 v[96:99], v10 offset:10240
  s_waitcnt lgkmcnt(14)
  v_mfma_f32_16x16x32_bf16 v[128:131], v[16:19], v[44:47], v[128:131]
  ds_read_b128 v[100:103], v10 offset:12288
  v_mfma_f32_16x16x32_bf16 v[164:167], v[20:23], v[44:47], v[164:167]
  ds_read_b128 v[104:107], v10 offset:14336
  v_mfma_f32_16x16x32_bf16 v[200:203], v[24:27], v[44:47], v[200:203]
  ds_read_b128 v[108:111], v10 offset:16384
  v_add_u32 v9, s42, v9
  v_add_u32 v10, s42, v10
  v_mfma_f32_16x16x32_bf16 v[204:207], v[24:27], v[48:51], v[204:207]
  v_mfma_f32_16x16x32_bf16 v[168:171], v[20:23], v[48:51], v[168:171]
  v_mfma_f32_16x16x32_bf16 v[132:135], v[16:19], v[48:51], v[132:135]
  v_mfma_f32_16x16x32_bf16 v[136:139], v[16:19], v[52:55], v[136:139]
  v_mfma_f32_16x16x32_bf16 v[172:175], v[20:23], v[52:55], v[172:175]
  v_mfma_f32_16x16x32_bf16 v[208:211], v[24:27], v[52:55], v[208:211]
  s_waitcnt lgkmcnt(14)
  v_mfma_f32_16x16x32_bf16 v[212:215], v[24:27], v[56:59], v[212:215]
  v_mfma_f32_16x16x32_bf16 v[176:179], v[20:23], v[56:59], v[176:179]
  v_mfma_f32_16x16x32_bf16 v[140:143], v[16:19], v[56:59], v[140:143]
  v_mfma_f32_16x16x32_bf16 v[144:147], v[16:19], v[60:63], v[144:147]
  v_mfma_f32_16x16x32_bf16 v[180:183], v[20:23], v[60:63], v[180:183]
  v_mfma_f32_16x16x32_bf16 v[216:219], v[24:27], v[60:63], v[216:219]
  s_waitcnt lgkmcnt(0)
  s_barrier
  v_mfma_f32_16x16x32_bf16 v[112:115], v[64:67], v[76:79], v[112:115]
  ds_read_b64_tr_b16 v[16:17], v8 offset:0
  s_add_u32 s40, s43, 43008
  v_mfma_f32_16x16x32_bf16 v[148:151], v[68:71], v[76:79], v[148:151]
  ds_read_b64_tr_b16 v[18:19], v8 offset:512
  s_cmp_eq_u32 s40, 129024
  v_mfma_f32_16x16x32_bf16 v[184:187], v[72:75], v[76:79], v[184:187]
  ds_read_b128 v[28:31], v9 offset:0
  s_cselect_b32 s40, 0, s40
  v_mfma_f32_16x16x32_bf16 v[188:191], v[72:75], v[80:83], v[188:191]
  ds_read_b64_tr_b16 v[20:21], v8 offset:8192
  s_sub_u32 s42, s40, s43
  v_mfma_f32_16x16x32_bf16 v[152:155], v[68:71], v[80:83], v[152:155]
  ds_read_b64_tr_b16 v[22:23], v8 offset:8704
  s_mov_b32 s43, s40
  v_mfma_f32_16x16x32_bf16 v[116:119], v[64:67], v[80:83], v[116:119]
  ds_read_b64_tr_b16 v[24:25], v8 offset:16384
  v_mfma_f32_16x16x32_bf16 v[120:123], v[64:67], v[84:87], v[120:123]
  ds_read_b64_tr_b16 v[26:27], v8 offset:16896
  v_mfma_f32_16x16x32_bf16 v[156:159], v[68:71], v[84:87], v[156:159]
  ds_read_b128 v[32:35], v9 offset:2048
  v_mfma_f32_16x16x32_bf16 v[192:195], v[72:75], v[84:87], v[192:195]
  ds_read_b128 v[36:39], v9 offset:4096
  v_mfma_f32_16x16x32_bf16 v[196:199], v[72:75], v[88:91], v[196:199]
  ds_read_b128 v[40:43], v9 offset:6144
  v_mfma_f32_16x16x32_bf16 v[160:163], v[68:71], v[88:91], v[160:163]
  ds_read_b128 v[44:47], v9 offset:8192
  v_mfma_f32_16x16x32_bf16 v[124:127], v[64:67], v[88:91], v[124:127]
  ds_read_b128 v[48:51], v9 offset:10240
  v_mfma_f32_16x16x32_bf16 v[128:131], v[64:67], v[92:95], v[128:131]
  ds_read_b128 v[52:55], v9 offset:12288
  v_mfma_f32_16x16x32_bf16 v[164:167], v[68:71], v[92:95], v[164:167]
  ds_read_b128 v[56:59], v9 offset:14336
  v_mfma_f32_16x16x32_bf16 v[200:203], v[72:75], v[92:95], v[200:203]
  ds_read_b128 v[60:63], v9 offset:16384
  v_mfma_f32_16x16x32_bf16 v[204:207], v[72:75], v[96:99], v[204:207]
  v_mfma_f32_16x16x32_bf16 v[168:171], v[68:71], v[96:99], v[168:171]
  v_mfma_f32_16x16x32_bf16 v[132:135], v[64:67], v[96:99], v[132:135]
  v_mfma_f32_16x16x32_bf16 v[136:139], v[64:67], v[100:103], v[136:139]
  v_mfma_f32_16x16x32_bf16 v[172:175], v[68:71], v[100:103], v[172:175]
  v_mfma_f32_16x16x32_bf16 v[208:211], v[72:75], v[100:103], v[208:211]
  v_mfma_f32_16x16x32_bf16 v[212:215], v[72:75], v[104:107], v[212:215]
  v_mfma_f32_16x16x32_bf16 v[176:179], v[68:71], v[104:107], v[176:179]
  v_mfma_f32_16x16x32_bf16 v[140:143], v[64:67], v[104:107], v[140:143]
  v_mfma_f32_16x16x32_bf16 v[144:147], v[64:67], v[108:111], v[144:147]
  v_mfma_f32_16x16x32_bf16 v[180:183], v[68:71], v[108:111], v[180:183]
  v_mfma_f32_16x16x32_bf16 v[216:219], v[72:75], v[108:111], v[216:219]
  s_sub_u32 s39, s39, 1
  s_cmp_lg_u32 s39, 0
  s_cbranch_scc1 cl1
  s_waitcnt lgkmcnt(12)
  v_mfma_f32_16x16x32_bf16 v[112:115], v[16:19], v[28:31], v[112:115]
  ds_read_b64_tr_b16 v[64:65], v8 offset:4096
  s_waitcnt lgkmcnt(11)
  v_mfma_f32_16x16x32_bf16 v[148:151], v[20:23], v[28:31], v[148:151]
  ds_read_b64_tr_b16 v[66:67], v8 offset:4608
  s_waitcnt lgkmcnt(10)
  v_mfma_f32_16x16x32_bf16 v[184:187], v[24:27], v[28:31], v[184:187]
  ds_read_b128 v[76:79], v10 offset:0
  s_waitcnt lgkmcnt(10)
  v_mfma_f32_16x16x32_bf16 v[188:191], v[24:27], v[32:35], v[188:191]
  ds_read_b64_tr_b16 v[68:69], v8 offset:12288
  v_mfma_f32_16x16x32_bf16 v[152:155], v[20:23], v[32:35], v[152:155]
  ds_read_b64_tr_b16 v[70:71], v8 offset:12800
  v_mfma_f32_16x16x32_bf16 v[116:119], v[16:19], v[32:35], v[116:119]
  ds_read_b64_tr_b16 v[72:73], v8 offset:20480
  s_waitcnt lgkmcnt(12)
  v_mfma_f32_16x16x32_bf16 v[120:123], v[16:19], v[36:39], v[120:123]
  ds_read_b64_tr_b16 v[74:75], v8 offset:20992
  v_mfma_f32_16x16x32_bf16 v[156:159], v[20:23], v[36:39], v[156:159]
  ds_read_b128 v[80:83], v10 offset:2048
  v_mfma_f32_16x16x32_bf16 v[192:195], v[24:27], v[36:39], v[192:195]
  ds_read_b128 v[84:87], v10 offset:4096
  s_waitcnt lgkmcnt(14)
  v_mfma_f32_16x16x32_bf16 v[196:199], v[24:27], v[40:43], v[196:199]
  ds_read_b128 v[88:91], v10 offset:6144
  v_mfma_f32_16x16x32_bf16 v[160:163], v[20:23], v[40:43], v[160:163]
  ds_read_b128 v[92:95], v10 offset:8192
  v_mfma_f32_16x16x32_bf16 v[124:127], v[16:19], v[40:43], v[124:127]
  ds_read_b128 v[96:99], v10 offset:10240
  s_waitcnt lgkmcnt(14)
  v_mfma_f32_16x16x32_bf16 v[128:131], v[16:19], v[44:47], v[128:131]
  ds_read_b128 v[100:103], v10 offset:12288
  v_mfma_f32_16x16x32_bf16 v[164:167], v[20:23], v[44:47], v[164:167]
  ds_read_b128 v[104:107], v10 offset:14336
  v_mfma_f32_16x16x32_bf16 v[200:203], v[24:27], v[44:47], v[200:203]
  ds_read_b128 v[108:111], v10 offset:16384
  v_mfma_f32_16x16x32_bf16 v[204:207], v[24:27], v[48:51], v[204:207]
  ds_read_b64 v[224:225], v12 offset:0
  v_mfma_f32_16x16x32_bf16 v[168:171], v[20:23], v[48:51], v[168:171]
  ds_read_b64 v[226:227], v12 offset:128
  v_mfma_f32_16x16x32_bf16 v[132:135], v[16:19], v[48:51], v[132:135]
  ds_read_b64 v[228:229], v12 offset:256
  v_mfma_f32_16x16x32_bf16 v[136:139], v[16:19], v[52:55], v[136:139]
  ds_read_b64 v[230:231], v12 offset:384
  v_mfma_f32_16x16x32_bf16 v[172:175], v[20:23], v[52:55], v[172:175]
  ds_read_b64 v[232:233], v12 offset:512
  v_mfma_f32_16x16x32_bf16 v[208:211], v[24:27], v[52:55], v[208:211]
  ds_read_b64 v[234:235], v12 offset:640
  s_waitcnt lgkmcnt(14)
  v_mfma_f32_16x16x32_bf16 v[212:215], v[24:27], v[56:59], v[212:215]
  ds_read_b64 v[236:237], v12 offset:768
  v_mfma_f32_16x16x32_bf16 v[176:179], v[20:23], v[56:59], v[176:179]
  ds_read_b64 v[238:239], v12 offset:896
  v_mfma_f32_16x16x32_bf16 v[140:143], v[16:19], v[56:59], v[140:143]
  ds_read_b64 v[240:241], v12 offset:1024
  v_mfma_f32_16x16x32_bf16 v[144:147], v[16:19], v[60:63], v[144:147]
  v_mfma_f32_16x16x32_bf16 v[180:183], v[20:23], v[60:63], v[180:183]
  v_mfma_f32_16x16x32_bf16 v[216:219], v[24:27], v[60:63], v[216:219]
  s_waitcnt lgkmcnt(0)
  v_mfma_f32_16x16x32_bf16 v[112:115], v[64:67], v[76:79], v[112:115]
  v_mfma_f32_16x16x32_bf16 v[148:151], v[68:71], v[76:79], v[148:151]
  v_mfma_f32_16x16x32_bf16 v[184:187], v[72:75], v[76:79], v[184:187]
  v_mfma_f32_16x16x32_bf16 v[188:191], v[72:75], v[80:83], v[188:191]
  s_nop 4
  v_mov_b32_dpp v242, v112 row_newbcast:0 row_mask:0xf bank_mask:0xf
  v_mov_b32_dpp v243, v113 row_newbcast:0 row_mask:0xf bank_mask:0xf
  v_mov_b32_dpp v244, v114 row_newbcast:0 row_mask:0xf bank_mask:0xf
  v_mov_b32_dpp v245, v115 row_newbcast:0 row_mask:0xf bank_mask:0xf
  v_mov_b32_dpp v246, v148 row_newbcast:0 row_mask:0xf bank_mask:0xf
  v_mov_b32_dpp v247, v149 row_newbcast:0 row_mask:0xf bank_mask:0xf
  v_mov_b32_dpp v248, v150 row_newbcast:0 row_mask:0xf bank_mask:0xf
  v_mfma_f32_16x16x32_bf16 v[152:155], v[68:71], v[80:83], v[152:155]
  v_mov_b32_dpp v249, v151 row_newbcast:0 row_mask:0xf bank_mask:0xf
  v_mov_b32_dpp v250, v184 row_newbcast:0 row_mask:0xf bank_mask:0xf
  v_mov_b32_dpp v251, v185 row_newbcast:0 row_mask:0xf bank_mask:0xf
  v_mov_b32_dpp v252, v186 row_newbcast:0 row_mask:0xf bank_mask:0xf
  v_mov_b32_dpp v253, v187 row_newbcast:0 row_mask:0xf bank_mask:0xf
  v_pk_fma_f32 v[148:149], v[246:247], v[224:225], v[148:149] op_sel_hi:[1,0,1] neg_lo:[0,1,0] neg_hi:[0,1,0]
  v_pk_fma_f32 v[150:151], v[248:249], v[224:225], v[150:151] op_sel_hi:[1,0,1] neg_lo:[0,1,0] neg_hi:[0,1,0]
  v_mfma_f32_16x16x32_bf16 v[116:119], v[64:67], v[80:83], v[116:119]
  v_pk_fma_f32 v[184:185], v[250:251], v[224:225], v[184:185] op_sel_hi:[1,0,1] neg_lo:[0,1,0] neg_hi:[0,1,0]
  v_pk_fma_f32 v[186:187], v[252:253], v[224:225], v[186:187] op_sel_hi:[1,0,1] neg_lo:[0,1,0] neg_hi:[0,1,0]
  v_pk_mul_f32 v[148:149], v[148:149], v[224:225] op_sel:[0,1] op_sel_hi:[1,1]
  v_pk_mul_f32 v[150:151], v[150:151], v[224:225] op_sel:[0,1] op_sel_hi:[1,1]
  v_pk_mul_f32 v[184:185], v[184:185], v[224:225] op_sel:[0,1] op_sel_hi:[1,1]
  v_pk_mul_f32 v[186:187], v[186:187], v[224:225] op_sel:[0,1] op_sel_hi:[1,1]
  v_cvt_pk_bf16_f32 v16, v148, v149
  v_mfma_f32_16x16x32_bf16 v[120:123], v[64:67], v[84:87], v[120:123]
  v_cvt_pk_bf16_f32 v17, v150, v151
  ds_write_b64 v11, v[16:17] offset:128
  v_cvt_pk_bf16_f32 v18, v184, v185
  v_cvt_pk_bf16_f32 v19, v186, v187
  ds_write_b64 v11, v[18:19] offset:256
  v_pk_fma_f32 v[116:117], v[242:243], v[226:227], v[116:117] op_sel_hi:[1,0,1] neg_lo:[0,1,0] neg_hi:[0,1,0]
  v_pk_fma_f32 v[118:119], v[244:245], v[226:227], v[118:119] op_sel_hi:[1,0,1] neg_lo:[0,1,0] neg_hi:[0,1,0]
  v_mfma_f32_16x16x32_bf16 v[156:159], v[68:71], v[84:87], v[156:159]
  v_pk_fma_f32 v[152:153], v[246:247], v[226:227], v[152:153] op_sel_hi:[1,0,1] neg_lo:[0,1,0] neg_hi:[0,1,0]
  v_pk_fma_f32 v[154:155], v[248:249], v[226:227], v[154:155] op_sel_hi:[1,0,1] neg_lo:[0,1,0] neg_hi:[0,1,0]
  v_pk_fma_f32 v[188:189], v[250:251], v[226:227], v[188:189] op_sel_hi:[1,0,1] neg_lo:[0,1,0] neg_hi:[0,1,0]
  v_pk_fma_f32 v[190:191], v[252:253], v[226:227], v[190:191] op_sel_hi:[1,0,1] neg_lo:[0,1,0] neg_hi:[0,1,0]
  v_pk_mul_f32 v[116:117], v[116:117], v[226:227] op_sel:[0,1] op_sel_hi:[1,1]
  v_pk_mul_f32 v[118:119], v[118:119], v[226:227] op_sel:[0,1] op_sel_hi:[1,1]
  v_pk_mul_f32 v[152:153], v[152:153], v[226:227] op_sel:[0,1] op_sel_hi:[1,1]
  v_mfma_f32_16x16x32_bf16 v[192:195], v[72:75], v[84:87], v[192:195]
  v_pk_mul_f32 v[154:155], v[154:155], v[226:227] op_sel:[0,1] op_sel_hi:[1,1]
  v_pk_mul_f32 v[188:189], v[188:189], v[226:227] op_sel:[0,1] op_sel_hi:[1,1]
  v_pk_mul_f32 v[190:191], v[190:191], v[226:227] op_sel:[0,1] op_sel_hi:[1,1]
  v_cvt_pk_bf16_f32 v22, v116, v117
  v_cvt_pk_bf16_f32 v23, v118, v119
  ds_write_b64 v11, v[22:23] offset:3200
  v_cvt_pk_bf16_f32 v24, v152, v153
  v_mfma_f32_16x16x32_bf16 v[196:199], v[72:75], v[88:91], v[196:199]
  v_cvt_pk_bf16_f32 v25, v154, v155
  ds_write_b64 v11, v[24:25] offset:3328
  v_cvt_pk_bf16_f32 v26, v188, v189
  v_cvt_pk_bf16_f32 v27, v190, v191
  ds_write_b64 v11, v[26:27] offset:3456
  v_pk_fma_f32 v[120:121], v[242:243], v[228:229], v[120:121] op_sel_hi:[1,0,1] neg_lo:[0,1,0] neg_hi:[0,1,0]
  v_pk_fma_f32 v[122:123], v[244:245], v[228:229], v[122:123] op_sel_hi:[1,0,1] neg_lo:[0,1,0] neg_hi:[0,1,0]
  v_mfma_f32_16x16x32_bf16 v[160:163], v[68:71], v[88:91], v[160:163]
  v_pk_fma_f32 v[156:157], v[246:247], v[228:229], v[156:157] op_sel_hi:[1,0,1] neg_lo:[0,1,0] neg_hi:[0,1,0]
  v_pk_fma_f32 v[158:159], v[248:249], v[228:229], v[158:159] op_sel_hi:[1,0,1] neg_lo:[0,1,0] neg_hi:[0,1,0]
  v_pk_fma_f32 v[192:193], v[250:251], v[228:229], v[192:193] op_sel_hi:[1,0,1] neg_lo:[0,1,0] neg_hi:[0,1,0]
  v_pk_fma_f32 v[194:195], v[252:253], v[228:229], v[194:195] op_sel_hi:[1,0,1] neg_lo:[0,1,0] neg_hi:[0,1,0]
  v_pk_mul_f32 v[120:121], v[120:121], v[228:229] op_sel:[0,1] op_sel_hi:[1,1]
  v_pk_mul_f32 v[122:123], v[122:123], v[228:229] op_sel:[0,1] op_sel_hi:[1,1]
  v_pk_mul_f32 v[156:157], v[156:157], v[228:229] op_sel:[0,1] op_sel_hi:[1,1]
  v_mfma_f32_16x16x32_bf16 v[124:127], v[64:67], v[88:91], v[124:127]
  v_pk_mul_f32 v[158:159], v[158:159], v[228:229] op_sel:[0,1] op_sel_hi:[1,1]
  v_pk_mul_f32 v[192:193], v[192:193], v[228:229] op_sel:[0,1] op_sel_hi:[1,1]
  v_pk_mul_f32 v[194:195], v[194:195], v[228:229] op_sel:[0,1] op_sel_hi:[1,1]
  v_cvt_pk_bf16_f32 v28, v120, v121
  v_cvt_pk_bf16_f32 v29, v122, v123
  ds_write_b64 v11, v[28:29] offset:6400
  v_cvt_pk_bf16_f32 v30, v156, v157
  v_mfma_f32_16x16x32_bf16 v[128:131], v[64:67], v[92:95], v[128:131]
  v_cvt_pk_bf16_f32 v31, v158, v159
  ds_write_b64 v11, v[30:31] offset:6528
  v_cvt_pk_bf16_f32 v32, v192, v193
  v_cvt_pk_bf16_f32 v33, v194, v195
  ds_write_b64 v11, v[32:33] offset:6656
  v_pk_fma_f32 v[124:125], v[242:243], v[230:231], v[124:125] op_sel_hi:[1,0,1] neg_lo:[0,1,0] neg_hi:[0,1,0]
  v_pk_fma_f32 v[126:127], v[244:245], v[230:231], v[126:127] op_sel_hi:[1,0,1] neg_lo:[0,1,0] neg_hi:[0,1,0]
  v_mfma_f32_16x16x32_bf16 v[164:167], v[68:71], v[92:95], v[164:167]
  v_pk_fma_f32 v[160:161], v[246:247], v[230:231], v[160:161] op_sel_hi:[1,0,1] neg_lo:[0,1,0] neg_hi:[0,1,0]
  v_pk_fma_f32 v[162:163], v[248:249], v[230:231], v[162:163] op_sel_hi:[1,0,1] neg_lo:[0,1,0] neg_hi:[0,1,0]
  v_pk_fma_f32 v[196:197], v[250:251], v[230:231], v[196:197] op_sel_hi:[1,0,1] neg_lo:[0,1,0] neg_hi:[0,1,0]
  v_pk_fma_f32 v[198:199], v[252:253], v[230:231], v[198:199] op_sel_hi:[1,0,1] neg_lo:[0,1,0] neg_hi:[0,1,0]
  v_pk_mul_f32 v[124:125], v[124:125], v[230:231] op_sel:[0,1] op_sel_hi:[1,1]
  v_pk_mul_f32 v[126:127], v[126:127], v[230:231] op_sel:[0,1] op_sel_hi:[1,1]
  v_pk_mul_f32 v[160:161], v[160:161], v[230:231] op_sel:[0,1] op_sel_hi:[1,1]
  v_mfma_f32_16x16x32_bf16 v[200:203], v[72:75], v[92:95], v[200:203]
  v_pk_mul_f32 v[162:163], v[162:163], v[230:231] op_sel:[0,1] op_sel_hi:[1,1]
  v_pk_mul_f32 v[196:197], v[196:197], v[230:231] op_sel:[0,1] op_sel_hi:[1,1]
  v_pk_mul_f32 v[198:199], v[198:199], v[230:231] op_sel:[0,1] op_sel_hi:[1,1]
  v_cvt_pk_bf16_f32 v34, v124, v125
  v_cvt_pk_bf16_f32 v35, v126, v127
  ds_write_b64 v11, v[34:35] offset:9600
  v_cvt_pk_bf16_f32 v36, v160, v161
  v_mfma_f32_16x16x32_bf16 v[204:207], v[72:75], v[96:99], v[204:207]
  v_cvt_pk_bf16_f32 v37, v162, v163
  ds_write_b64 v11, v[36:37] offset:9728
  v_cvt_pk_bf16_f32 v38, v196, v197
  v_cvt_pk_bf16_f32 v39, v198, v199
  ds_write_b64 v11, v[38:39] offset:9856
  v_pk_fma_f32 v[128:129], v[242:243], v[232:233], v[128:129] op_sel_hi:[1,0,1] neg_lo:[0,1,0] neg_hi:[0,1,0]
  v_pk_fma_f32 v[130:131], v[244:245], v[232:233], v[130:131] op_sel_hi:[1,0,1] neg_lo:[0,1,0] neg_hi:[0,1,0]
  v_mfma_f32_16x16x32_bf16 v[168:171], v[68:71], v[96:99], v[168:171]
  v_pk_fma_f32 v[164:165], v[246:247], v[232:233], v[164:165] op_sel_hi:[1,0,1] neg_lo:[0,1,0] neg_hi:[0,1,0]
  v_pk_fma_f32 v[166:167], v[248:249], v[232:233], v[166:167] op_sel_hi:[1,0,1] neg_lo:[0,1,0] neg_hi:[0,1,0]
  v_pk_fma_f32 v[200:201], v[250:251], v[232:233], v[200:201] op_sel_hi:[1,0,1] neg_lo:[0,1,0] neg_hi:[0,1,0]
  v_pk_fma_f32 v[202:203], v[252:253], v[232:233], v[202:203] op_sel_hi:[1,0,1] neg_lo:[0,1,0] neg_hi:[0,1,0]
  v_pk_mul_f32 v[128:129], v[128:129], v[232:233] op_sel:[0,1] op_sel_hi:[1,1]
  v_pk_mul_f32 v[130:131], v[130:131], v[232:233] op_sel:[0,1] op_sel_hi:[1,1]
  v_pk_mul_f32 v[164:165], v[164:165], v[232:233] op_sel:[0,1] op_sel_hi:[1,1]
  v_mfma_f32_16x16x32_bf16 v[132:135], v[64:67], v[96:99], v[132:135]
  v_pk_mul_f32 v[166:167], v[166:167], v[232:233] op_sel:[0,1] op_sel_hi:[1,1]
  v_pk_mul_f32 v[200:201], v[200:201], v[232:233] op_sel:[0,1] op_sel_hi:[1,1]
  v_pk_mul_f32 v[202:203], v[202:203], v[232:233] op_sel:[0,1] op_sel_hi:[1,1]
  v_cvt_pk_bf16_f32 v40, v128, v129
  v_cvt_pk_bf16_f32 v41, v130, v131
  ds_write_b64 v11, v[40:41] offset:12800
  v_cvt_pk_bf16_f32 v42, v164, v165
  v_mfma_f32_16x16x32_bf16 v[136:139], v[64:67], v[100:103], v[136:139]
  v_cvt_pk_bf16_f32 v43, v166, v167
  ds_write_b64 v11, v[42:43] offset:12928
  v_cvt_pk_bf16_f32 v44, v200, v201
  v_cvt_pk_bf16_f32 v45, v202, v203
  ds_write_b64 v11, v[44:45] offset:13056
  v_pk_fma_f32 v[132:133], v[242:243], v[234:235], v[132:133] op_sel_hi:[1,0,1] neg_lo:[0,1,0] neg_hi:[0,1,0]
  v_pk_fma_f32 v[134:135], v[244:245], v[234:235], v[134:135] op_sel_hi:[1,0,1] neg_lo:[0,1,0] neg_hi:[0,1,0]
  v_mfma_f32_16x16x32_bf16 v[172:175], v[68:71], v[100:103], v[172:175]
  v_pk_fma_f32 v[168:169], v[246:247], v[234:235], v[168:169] op_sel_hi:[1,0,1] neg_lo:[0,1,0] neg_hi:[0,1,0]
  v_pk_fma_f32 v[170:171], v[248:249], v[234:235], v[170:171] op_sel_hi:[1,0,1] neg_lo:[0,1,0] neg_hi:[0,1,0]
  v_pk_fma_f32 v[204:205], v[250:251], v[234:235], v[204:205] op_sel_hi:[1,0,1] neg_lo:[0,1,0] neg_hi:[0,1,0]
  v_pk_fma_f32 v[206:207], v[252:253], v[234:235], v[206:207] op_sel_hi:[1,0,1] neg_lo:[0,1,0] neg_hi:[0,1,0]
  v_pk_mul_f32 v[132:133], v[132:133], v[234:235] op_sel:[0,1] op_sel_hi:[1,1]
  v_pk_mul_f32 v[134:135], v[134:135], v[234:235] op_sel:[0,1] op_sel_hi:[1,1]
  v_pk_mul_f32 v[168:169], v[168:169], v[234:235] op_sel:[0,1] op_sel_hi:[1,1]
  v_mfma_f32_16x16x32_bf16 v[208:211], v[72:75], v[100:103], v[208:211]
  v_pk_mul_f32 v[170:171], v[170:171], v[234:235] op_sel:[0,1] op_sel_hi:[1,1]
  v_pk_mul_f32 v[204:205], v[204:205], v[234:235] op_sel:[0,1] op_sel_hi:[1,1]
  v_pk_mul_f32 v[206:207], v[206:207], v[234:235] op_sel:[0,1] op_sel_hi:[1,1]
  v_cvt_pk_bf16_f32 v46, v132, v133
  v_cvt_pk_bf16_f32 v47, v134, v135
  ds_write_b64 v11, v[46:47] offset:16000
  v_cvt_pk_bf16_f32 v48, v168, v169
  v_mfma_f32_16x16x32_bf16 v[212:215], v[72:75], v[104:107], v[212:215]
  v_cvt_pk_bf16_f32 v49, v170, v171
  ds_write_b64 v11, v[48:49] offset:16128
  v_cvt_pk_bf16_f32 v50, v204, v205
  v_cvt_pk_bf16_f32 v51, v206, v207
  ds_write_b64 v11, v[50:51] offset:16256
  v_pk_fma_f32 v[136:137], v[242:243], v[236:237], v[136:137] op_sel_hi:[1,0,1] neg_lo:[0,1,0] neg_hi:[0,1,0]
  v_pk_fma_f32 v[138:139], v[244:245], v[236:237], v[138:139] op_sel_hi:[1,0,1] neg_lo:[0,1,0] neg_hi:[0,1,0]
  v_mfma_f32_16x16x32_bf16 v[176:179], v[68:71], v[104:107], v[176:179]
  v_pk_fma_f32 v[172:173], v[246:247], v[236:237], v[172:173] op_sel_hi:[1,0,1] neg_lo:[0,1,0] neg_hi:[0,1,0]
  v_pk_fma_f32 v[174:175], v[248:249], v[236:237], v[174:175] op_sel_hi:[1,0,1] neg_lo:[0,1,0] neg_hi:[0,1,0]
  v_pk_fma_f32 v[208:209], v[250:251], v[236:237], v[208:209] op_sel_hi:[1,0,1] neg_lo:[0,1,0] neg_hi:[0,1,0]
  v_pk_fma_f32 v[210:211], v[252:253], v[236:237], v[210:211] op_sel_hi:[1,0,1] neg_lo:[0,1,0] neg_hi:[0,1,0]
  v_pk_mul_f32 v[136:137], v[136:137], v[236:237] op_sel:[0,1] op_sel_hi:[1,1]
  v_pk_mul_f32 v[138:139], v[138:139], v[236:237] op_sel:[0,1] op_sel_hi:[1,1]
  v_pk_mul_f32 v[172:173], v[172:173], v[236:237] op_sel:[0,1] op_sel_hi:[1,1]
  v_mfma_f32_16x16x32_bf16 v[140:143], v[64:67], v[104:107], v[140:143]
  v_pk_mul_f32 v[174:175], v[174:175], v[236:237] op_sel:[0,1] op_sel_hi:[1,1]
  v_pk_mul_f32 v[208:209], v[208:209], v[236:237] op_sel:[0,1] op_sel_hi:[1,1]
  v_pk_mul_f32 v[210:211], v[210:211], v[236:237] op_sel:[0,1] op_sel_hi:[1,1]
  v_cvt_pk_bf16_f32 v52, v136, v137
  v_cvt_pk_bf16_f32 v53, v138, v139
  ds_write_b64 v11, v[52:53] offset:19200
  v_cvt_pk_bf16_f32 v54, v172, v173
  v_mfma_f32_16x16x32_bf16 v[144:147], v[64:67], v[108:111], v[144:147]
  v_cvt_pk_bf16_f32 v55, v174, v175
  ds_write_b64 v11, v[54:55] offset:19328
  v_cvt_pk_bf16_f32 v56, v208, v209
  v_cvt_pk_bf16_f32 v57, v210, v211
  ds_write_b64 v11, v[56:57] offset:19456
  v_pk_fma_f32 v[140:141], v[242:243], v[238:239], v[140:141] op_sel_hi:[1,0,1] neg_lo:[0,1,0] neg_hi:[0,1,0]
  v_pk_fma_f32 v[142:143], v[244:245], v[238:239], v[142:143] op_sel_hi:[1,0,1] neg_lo:[0,1,0] neg_hi:[0,1,0]
  v_mfma_f32_16x16x32_bf16 v[180:183], v[68:71], v[108:111], v[180:183]
  v_pk_fma_f32 v[176:177], v[246:247], v[238:239], v[176:177] op_sel_hi:[1,0,1] neg_lo:[0,1,0] neg_hi:[0,1,0]
  v_pk_fma_f32 v[178:179], v[248:249], v[238:239], v[178:179] op_sel_hi:[1,0,1] neg_lo:[0,1,0] neg_hi:[0,1,0]
  v_pk_fma_f32 v[212:213], v[250:251], v[238:239], v[212:213] op_sel_hi:[1,0,1] neg_lo:[0,1,0] neg_hi:[0,1,0]
  v_pk_fma_f32 v[214:215], v[252:253], v[238:239], v[214:215] op_sel_hi:[1,0,1] neg_lo:[0,1,0] neg_hi:[0,1,0]
  v_pk_mul_f32 v[140:141], v[140:141], v[238:239] op_sel:[0,1] op_sel_hi:[1,1]
  v_pk_mul_f32 v[142:143], v[142:143], v[238:239] op_sel:[0,1] op_sel_hi:[1,1]
  v_pk_mul_f32 v[176:177], v[176:177], v[238:239] op_sel:[0,1] op_sel_hi:[1,1]
  v_mfma_f32_16x16x32_bf16 v[216:219], v[72:75], v[108:111], v[216:219]
  v_pk_mul_f32 v[178:179], v[178:179], v[238:239] op_sel:[0,1] op_sel_hi:[1,1]
  v_pk_mul_f32 v[212:213], v[212:213], v[238:239] op_sel:[0,1] op_sel_hi:[1,1]
  v_pk_mul_f32 v[214:215], v[214:215], v[238:239] op_sel:[0,1] op_sel_hi:[1,1]
  v_cvt_pk_bf16_f32 v58, v140, v141
  v_cvt_pk_bf16_f32 v59, v142, v143
  ds_write_b64 v11, v[58:59] offset:22400
  v_cvt_pk_bf16_f32 v60, v176, v177
  s_barrier
  v_cvt_pk_bf16_f32 v61, v178, v179
  ds_write_b64 v11, v[60:61] offset:22528
  v_cvt_pk_bf16_f32 v62, v212, v213
  v_cvt_pk_bf16_f32 v63, v214, v215
  ds_write_b64 v11, v[62:63] offset:22656
  v_pk_fma_f32 v[144:145], v[242:243], v[240:241], v[144:145] op_sel_hi:[1,0,1] neg_lo:[0,1,0] neg_hi:[0,1,0]
  v_pk_fma_f32 v[146:147], v[244:245], v[240:241], v[146:147] op_sel_hi:[1,0,1] neg_lo:[0,1,0] neg_hi:[0,1,0]
  v_pk_fma_f32 v[180:181], v[246:247], v[240:241], v[180:181] op_sel_hi:[1,0,1] neg_lo:[0,1,0] neg_hi:[0,1,0]
  v_pk_fma_f32 v[182:183], v[248:249], v[240:241], v[182:183] op_sel_hi:[1,0,1] neg_lo:[0,1,0] neg_hi:[0,1,0]
  v_pk_fma_f32 v[216:217], v[250:251], v[240:241], v[216:217] op_sel_hi:[1,0,1] neg_lo:[0,1,0] neg_hi:[0,1,0]
  v_pk_fma_f32 v[218:219], v[252:253], v[240:241], v[218:219] op_sel_hi:[1,0,1] neg_lo:[0,1,0] neg_hi:[0,1,0]
  v_pk_mul_f32 v[144:145], v[144:145], v[240:241] op_sel:[0,1] op_sel_hi:[1,1]
  v_pk_mul_f32 v[146:147], v[146:147], v[240:241] op_sel:[0,1] op_sel_hi:[1,1]
  v_pk_mul_f32 v[180:181], v[180:181], v[240:241] op_sel:[0,1] op_sel_hi:[1,1]
  v_pk_mul_f32 v[182:183], v[182:183], v[240:241] op_sel:[0,1] op_sel_hi:[1,1]
  v_pk_mul_f32 v[216:217], v[216:217], v[240:241] op_sel:[0,1] op_sel_hi:[1,1]
  v_pk_mul_f32 v[218:219], v[218:219], v[240:241] op_sel:[0,1] op_sel_hi:[1,1]
  v_cvt_pk_bf16_f32 v16, v144, v145
  v_cvt_pk_bf16_f32 v17, v146, v147
  ds_write_b64 v11, v[16:17] offset:25600
  v_cvt_pk_bf16_f32 v18, v180, v181
  v_cvt_pk_bf16_f32 v19, v182, v183
  ds_write_b64 v11, v[18:19] offset:25728
  v_cvt_pk_bf16_f32 v20, v216, v217
  v_cvt_pk_bf16_f32 v21, v218, v219
  ds_write_b64 v11, v[20:21] offset:25856
  s_branch attn
C_top1:
  s_nop 7
  s_nop 7
  s_mov_b32 s43, 0
  s_mov_b32 s39, 15
  s_barrier
  ds_read_b64_tr_b16 v[16:17], v8 offset:0
  ds_read_b64_tr_b16 v[18:19], v8 offset:512
  ds_read_b128 v[28:31], v9 offset:0
  ds_read_b64_tr_b16 v[20:21], v8 offset:8192
  ds_read_b64_tr_b16 v[22:23], v8 offset:8704
  ds_read_b64_tr_b16 v[24:25], v8 offset:16384
  ds_read_b64_tr_b16 v[26:27], v8 offset:16896
  ds_read_b128 v[32:35], v9 offset:2048
  ds_read_b128 v[36:39], v9 offset:4096
  ds_read_b128 v[40:43], v9 offset:6144
  ds_read_b128 v[44:47], v9 offset:8192
  ds_read_b128 v[48:51], v9 offset:10240
  ds_read_b128 v[52:55], v9 offset:12288
  ds_read_b128 v[56:59], v9 offset:14336
  ds_read_b128 v[60:63], v9 offset:16384
  s_add_u32 s40, s43, 43008
  s_cmp_eq_u32 s40, 129024
  s_cselect_b32 s40, 0, s40
  s_sub_u32 s42, s40, s43
  s_mov_b32 s43, s40
cl2:
  s_waitcnt lgkmcnt(10)
  v_mfma_f32_16x16x32_bf16 v[148:151], v[20:23], v[28:31], v[148:151]
  ds_read_b64_tr_b16 v[64:65], v8 offset:4096
  s_waitcnt lgkmcnt(9)
  v_mfma_f32_16x16x32_bf16 v[184:187], v[24:27], v[28:31], v[184:187]
  ds_read_b64_tr_b16 v[66:67], v8 offset:4608
  s_waitcnt lgkmcnt(9)
  v_mfma_f32_16x16x32_bf16 v[188:191], v[24:27], v[32:35], v[188:191]
  ds_read_b128 v[76:79], v10 offset:0
  v_mfma_f32_16x16x32_bf16 v[152:155], v[20:23], v[32:35], v[152:155]
  ds_read_b64_tr_b16 v[68:69], v8 offset:12288
  v_mfma_f32_16x16x32_bf16 v[116:119], v[16:19], v[32:35], v[116:119]
  ds_read_b64_tr_b16 v[70:71], v8 offset:12800
  s_waitcnt lgkmcnt(11)
  v_mfma_f32_16x16x32_bf16 v[120:123], v[16:19], v[36:39], v[120:123]
  ds_read_b64_tr_b16 v[72:73], v8 offset:20480
  v_mfma_f32_16x16x32_bf16 v[156:159], v[20:23], v[36:39], v[156:159]
  ds_read_b64_tr_b16 v[74:75], v8 offset:20992
  v_add_u32 v8, s42, v8
  v_mfma_f32_16x16x32_bf16 v[192:195], v[24:27], v[36:39], v[192:195]
  ds_read_b128 v[80:83], v10 offset:2048
  s_waitcnt lgkmcnt(13)
  v_mfma_f32_16x16x32_bf16 v[196:199], v[24:27], v[40:43], v[196:199]
  ds_read_b128 v[84:87], v10 offset:4096
  v_mfma_f32_16x16x32_bf16 v[160:163], v[20:23], v[40:43], v[160:163]
  ds_read_b128 v[88:91], v10 offset:6144
  v_mfma_f32_16x16x32_bf16 v[124:127], v[16:19], v[40:43], v[124:127]
  ds_read_b128 v[92:95], v10 offset:8192
  s_waitcnt lgkmcnt(14)
  v_mfma_f32_16x16x32_bf16 v[128:131], v[16:19], v[44:47], v[128:131]
  ds_read_b128 v[96:99], v10 offset:10240
  v_mfma_f32_16x16x32_bf16 v[164:167], v[20:23], v[44:47], v[164:167]
  ds_read_b128 v[100:103], v10 offset:12288
  v_mfma_f32_16x16x32_bf16 v[200:203], v[24:27], v[44:47], v[200:203]
  ds_read_b128 v[104:107], v10 offset:14336
  v_mfma_f32_16x16x32_bf16 v[204:207], v[24:27], v[48:51], v[204:207]
  ds_read_b128 v[108:111], v10 offset:16384
  v_add_u32 v9, s42, v9
  v_add_u32 v10, s42, v10
  v_mfma_f32_16x16x32_bf16 v[168:171], v[20:23], v[48:51], v[168:171]
  v_mfma_f32_16x16x32_bf16 v[132:135], v[16:19], v[48:51], v[132:135]
  s_waitcnt lgkmcnt(14)
  v_mfma_f32_16x16x32_bf16 v[136:139], v[16:19], v[52:55], v[136:139]
  v_mfma_f32_16x16x32_bf16 v[172:175], v[20:23], v[52:55], v[172:175]
  v_mfma_f32_16x16x32_bf16 v[208:211], v[24:27], v[52:55], v[208:211]
  v_mfma_f32_16x16x32_bf16 v[212:215], v[24:27], v[56:59], v[212:215]
  v_mfma_f32_16x16x32_bf16 v[176:179], v[20:23], v[56:59], v[176:179]
  v_mfma_f32_16x16x32_bf16 v[140:143], v[16:19], v[56:59], v[140:143]
  v_mfma_f32_16x16x32_bf16 v[144:147], v[16:19], v[60:63], v[144:147]
  v_mfma_f32_16x16x32_bf16 v[180:183], v[20:23], v[60:63], v[180:183]
  v_mfma_f32_16x16x32_bf16 v[216:219], v[24:27], v[60:63], v[216:219]
  s_waitcnt lgkmcnt(0)
  s_barrier
  v_mfma_f32_16x16x32_bf16 v[148:151], v[68:71], v[76:79], v[148:151]
  ds_read_b64_tr_b16 v[16:17], v8 offset:0
  s_add_u32 s40, s43, 43008
  v_mfma_f32_16x16x32_bf16 v[184:187], v[72:75], v[76:79], v[184:187]
  ds_read_b64_tr_b16 v[18:19], v8 offset:512
  s_cmp_eq_u32 s40, 129024
  v_mfma_f32_16x16x32_bf16 v[188:191], v[72:75], v[80:83], v[188:191]
  ds_read_b128 v[28:31], v9 offset:0
  s_cselect_b32 s40, 0, s40
  v_mfma_f32_16x16x32_bf16 v[152:155], v[68:71], v[80:83], v[152:155]
  ds_read_b64_tr_b16 v[20:21], v8 offset:8192
  s_sub_u32 s42, s40, s43
  v_mfma_f32_16x16x32_bf16 v[116:119], v[64:67], v[80:83], v[116:119]
  ds_read_b64_tr_b16 v[22:23], v8 offset:8704
  s_mov_b32 s43, s40
  v_mfma_f32_16x16x32_bf16 v[120:123], v[64:67], v[84:87], v[120:123]
  ds_read_b64_tr_b16 v[24:25], v8 offset:16384
  v_mfma_f32_16x16x32_bf16 v[156:159], v[68:71], v[84:87], v[156:159]
  ds_read_b64_tr_b16 v[26:27], v8 offset:16896
  v_mfma_f32_16x16x32_bf16 v[192:195], v[72:75], v[84:87], v[192:195]
  ds_read_b128 v[32:35], v9 offset:2048
  v_mfma_f32_16x16x32_bf16 v[196:199], v[72:75], v[88:91], v[196:199]
  ds_read_b128 v[36:39], v9 offset:4096
  v_mfma_f32_16x16x32_bf16 v[160:163], v[68:71], v[88:91], v[160:163]
  ds_read_b128 v[40:43], v9 offset:6144
  v_mfma_f32_16x16x32_bf16 v[124:127], v[64:67], v[88:91], v[124:127]
  ds_read_b128 v[44:47], v9 offset:8192
  v_mfma_f32_16x16x32_bf16 v[128:131], v[64:67], v[92:95], v[128:131]
  ds_read_b128 v[48:51], v9 offset:10240
  v_mfma_f32_16x16x32_bf16 v[164:167], v[68:71], v[92:95], v[164:167]
  ds_read_b128 v[52:55], v9 offset:12288
  v_mfma_f32_16x16x32_bf16 v[200:203], v[72:75], v[92:95], v[200:203]
  ds_read_b128 v[56:59], v9 offset:14336
  v_mfma_f32_16x16x32_bf16 v[204:207], v[72:75], v[96:99], v[204:207]
  ds_read_b128 v[60:63], v9 offset:16384
  v_mfma_f32_16x16x32_bf16 v[168:171], v[68:71], v[96:99], v[168:171]
  v_mfma_f32_16x16x32_bf16 v[132:135], v[64:67], v[96:99], v[132:135]
  v_mfma_f32_16x16x32_bf16 v[136:139], v[64:67], v[100:103], v[136:139]
  v_mfma_f32_16x16x32_bf16 v[172:175], v[68:71], v[100:103], v[172:175]
  v_mfma_f32_16x16x32_bf16 v[208:211], v[72:75], v[100:103], v[208:211]
  v_mfma_f32_16x16x32_bf16 v[212:215], v[72:75], v[104:107], v[212:215]
  v_mfma_f32_16x16x32_bf16 v[176:179], v[68:71], v[104:107], v[176:179]
  v_mfma_f32_16x16x32_bf16 v[140:143], v[64:67], v[104:107], v[140:143]
  v_mfma_f32_16x16x32_bf16 v[144:147], v[64:67], v[108:111], v[144:147]
  v_mfma_f32_16x16x32_bf16 v[180:183], v[68:71], v[108:111], v[180:183]
  v_mfma_f32_16x16x32_bf16 v[216:219], v[72:75], v[108:111], v[216:219]
  s_sub_u32 s39, s39, 1
  s_cmp_lg_u32 s39, 0
  s_cbranch_scc1 cl2
  s_waitcnt lgkmcnt(10)
  v_mfma_f32_16x16x32_bf16 v[148:151], v[20:23], v[28:31], v[148:151]
  ds_read_b64_tr_b16 v[64:65], v8 offset:4096
  s_waitcnt lgkmcnt(9)
  v_mfma_f32_16x16x32_bf16 v[184:187], v[24:27], v[28:31], v[184:187]
  ds_read_b64_tr_b16 v[66:67], v8 offset:4608
  s_waitcnt lgkmcnt(9)
  v_mfma_f32_16x16x32_bf16 v[188:191], v[24:27], v[32:35], v[188:191]
  ds_read_b128 v[76:79], v10 offset:0
  v_mfma_f32_16x16x32_bf16 v[152:155], v[20:23], v[32:35], v[152:155]
  ds_read_b64_tr_b16 v[68:69], v8 offset:12288
  v_mfma_f32_16x16x32_bf16 v[116:119], v[16:19], v[32:35], v[116:119]
  ds_read_b64_tr_b16 v[70:71], v8 offset:12800
  s_waitcnt lgkmcnt(11)
  v_mfma_f32_16x16x32_bf16 v[120:123], v[16:19], v[36:39], v[120:123]
  ds_read_b64_tr_b16 v[72:73], v8 offset:20480
  v_mfma_f32_16x16x32_bf16 v[156:159], v[20:23], v[36:39], v[156:159]
  ds_read_b64_tr_b16 v[74:75], v8 offset:20992
  v_mfma_f32_16x16x32_bf16 v[192:195], v[24:27], v[36:39], v[192:195]
  ds_read_b128 v[80:83], v10 offset:2048
  s_waitcnt lgkmcnt(13)
  v_mfma_f32_16x16x32_bf16 v[196:199], v[24:27], v[40:43], v[196:199]
  ds_read_b128 v[84:87], v10 offset:4096
  v_mfma_f32_16x16x32_bf16 v[160:163], v[20:23], v[40:43], v[160:163]
  ds_read_b128 v[88:91], v10 offset:6144
  v_mfma_f32_16x16x32_bf16 v[124:127], v[16:19], v[40:43], v[124:127]
  ds_read_b128 v[92:95], v10 offset:8192
  s_waitcnt lgkmcnt(14)
  v_mfma_f32_16x16x32_bf16 v[128:131], v[16:19], v[44:47], v[128:131]
  ds_read_b128 v[96:99], v10 offset:10240
  v_mfma_f32_16x16x32_bf16 v[164:167], v[20:23], v[44:47], v[164:167]
  ds_read_b128 v[100:103], v10 offset:12288
  v_mfma_f32_16x16x32_bf16 v[200:203], v[24:27], v[44:47], v[200:203]
  ds_read_b128 v[104:107], v10 offset:14336
  v_mfma_f32_16x16x32_bf16 v[204:207], v[24:27], v[48:51], v[204:207]
  ds_read_b128 v[108:111], v10 offset:16384
  v_mfma_f32_16x16x32_bf16 v[168:171], v[20:23], v[48:51], v[168:171]
  ds_read_b64 v[224:225], v12 offset:0
  v_mfma_f32_16x16x32_bf16 v[132:135], v[16:19], v[48:51], v[132:135]
  ds_read_b64 v[226:227], v12 offset:128
  s_waitcnt lgkmcnt(14)
  v_mfma_f32_16x16x32_bf16 v[136:139], v[16:19], v[52:55], v[136:139]
  ds_read_b64 v[228:229], v12 offset:256
  v_mfma_f32_16x16x32_bf16 v[172:175], v[20:23], v[52:55], v[172:175]
  ds_read_b64 v[230:231], v12 offset:384
  v_mfma_f32_16x16x32_bf16 v[208:211], v[24:27], v[52:55], v[208:211]
  ds_read_b64 v[232:233], v12 offset:512
  v_mfma_f32_16x16x32_bf16 v[212:215], v[24:27], v[56:59], v[212:215]
  ds_read_b64 v[234:235], v12 offset:640
  v_mfma_f32_16x16x32_bf16 v[176:179], v[20:23], v[56:59], v[176:179]
  ds_read_b64 v[236:237], v12 offset:768
  v_mfma_f32_16x16x32_bf16 v[140:143], v[16:19], v[56:59], v[140:143]
  ds_read_b64 v[238:239], v12 offset:896
  v_mfma_f32_16x16x32_bf16 v[144:147], v[16:19], v[60:63], v[144:147]
  ds_read_b64 v[240:241], v12 offset:1024
  v_mfma_f32_16x16x32_bf16 v[180:183], v[20:23], v[60:63], v[180:183]
  v_mfma_f32_16x16x32_bf16 v[216:219], v[24:27], v[60:63], v[216:219]
  s_waitcnt lgkmcnt(0)
  v_mfma_f32_16x16x32_bf16 v[148:151], v[68:71], v[76:79], v[148:151]
  v_mfma_f32_16x16x32_bf16 v[184:187], v[72:75], v[76:79], v[184:187]
  v_mfma_f32_16x16x32_bf16 v[188:191], v[72:75], v[80:83], v[188:191]
  s_nop 5
  v_mov_b32_dpp v246, v148 row_newbcast:0 row_mask:0xf bank_mask:0xf
  v_mov_b32_dpp v247, v149 row_newbcast:0 row_mask:0xf bank_mask:0xf
  v_mov_b32_dpp v248, v150 row_newbcast:0 row_mask:0xf bank_mask:0xf
  v_mov_b32_dpp v249, v151 row_newbcast:0 row_mask:0xf bank_mask:0xf
  v_mov_b32_dpp v250, v184 row_newbcast:0 row_mask:0xf bank_mask:0xf
  v_mov_b32_dpp v251, v185 row_newbcast:0 row_mask:0xf bank_mask:0xf
  v_mov_b32_dpp v252, v186 row_newbcast:0 row_mask:0xf bank_mask:0xf
  v_mfma_f32_16x16x32_bf16 v[152:155], v[68:71], v[80:83], v[152:155]
  v_mov_b32_dpp v253, v187 row_newbcast:0 row_mask:0xf bank_mask:0xf
  v_pk_fma_f32 v[148:149], v[246:247], v[224:225], v[148:149] op_sel_hi:[1,0,1] neg_lo:[0,1,0] neg_hi:[0,1,0]
  v_pk_fma_f32 v[150:151], v[248:249], v[224:225], v[150:151] op_sel_hi:[1,0,1] neg_lo:[0,1,0] neg_hi:[0,1,0]
  v_pk_fma_f32 v[184:185], v[250:251], v[224:225], v[184:185] op_sel_hi:[1,0,1] neg_lo:[0,1,0] neg_hi:[0,1,0]
  v_pk_fma_f32 v[186:187], v[252:253], v[224:225], v[186:187] op_sel_hi:[1,0,1] neg_lo:[0,1,0] neg_hi:[0,1,0]
  v_pk_mul_f32 v[148:149], v[148:149], v[224:225] op_sel:[0,1] op_sel_hi:[1,1]
  v_pk_mul_f32 v[150:151], v[150:151], v[224:225] op_sel:[0,1] op_sel_hi:[1,1]
  v_mfma_f32_16x16x32_bf16 v[116:119], v[64:67], v[80:83], v[116:119]
  v_pk_mul_f32 v[184:185], v[184:185], v[224:225] op_sel:[0,1] op_sel_hi:[1,1]
  v_pk_mul_f32 v[186:187], v[186:187], v[224:225] op_sel:[0,1] op_sel_hi:[1,1]
  v_cvt_pk_bf16_f32 v16, v148, v149
  v_cvt_pk_bf16_f32 v17, v150, v151
  ds_write_b64 v11, v[16:17] offset:128
  v_cvt_pk_bf16_f32 v18, v184, v185
  v_cvt_pk_bf16_f32 v19, v186, v187
  v_mfma_f32_16x16x32_bf16 v[120:123], v[64:67], v[84:87], v[120:123]
  ds_write_b64 v11, v[18:19] offset:256
  v_pk_fma_f32 v[116:117], v[242:243], v[226:227], v[116:117] op_sel_hi:[1,0,1] neg_lo:[0,1,0] neg_hi:[0,1,0]
  v_pk_fma_f32 v[118:119], v[244:245], v[226:227], v[118:119] op_sel_hi:[1,0,1] neg_lo:[0,1,0] neg_hi:[0,1,0]
  v_pk_fma_f32 v[152:153], v[246:247], v[226:227], v[152:153] op_sel_hi:[1,0,1] neg_lo:[0,1,0] neg_hi:[0,1,0]
  v_pk_fma_f32 v[154:155], v[248:249], v[226:227], v[154:155] op_sel_hi:[1,0,1] neg_lo:[0,1,0] neg_hi:[0,1,0]
  v_pk_fma_f32 v[188:189], v[250:251], v[226:227], v[188:189] op_sel_hi:[1,0,1] neg_lo:[0,1,0] neg_hi:[0,1,0]
  v_pk_fma_f32 v[190:191], v[252:253], v[226:227], v[190:191] op_sel_hi:[1,0,1] neg_lo:[0,1,0] neg_hi:[0,1,0]
  v_mfma_f32_16x16x32_bf16 v[156:159], v[68:71], v[84:87], v[156:159]
  v_pk_mul_f32 v[116:117], v[116:117], v[226:227] op_sel:[0,1] op_sel_hi:[1,1]
  v_pk_mul_f32 v[118:119], v[118:119], v[226:227] op_sel:[0,1] op_sel_hi:[1,1]
  v_pk_mul_f32 v[152:153], v[152:153], v[226:227] op_sel:[0,1] op_sel_hi:[1,1]
  v_pk_mul_f32 v[154:155], v[154:155], v[226:227] op_sel:[0,1] op_sel_hi:[1,1]
  v_pk_mul_f32 v[188:189], v[188:189], v[226:227] op_sel:[0,1] op_sel_hi:[1,1]
  v_pk_mul_f32 v[190:191], v[190:191], v[226:227] op_sel:[0,1] op_sel_hi:[1,1]
  v_cvt_pk_bf16_f32 v22, v116, v117
  v_mfma_f32_16x16x32_bf16 v[192:195], v[72:75], v[84:87], v[192:195]
  v_cvt_pk_bf16_f32 v23, v118, v119
  ds_write_b64 v11, v[22:23] offset:3200
  v_cvt_pk_bf16_f32 v24, v152, v153
  v_cvt_pk_bf16_f32 v25, v154, v155
  ds_write_b64 v11, v[24:25] offset:3328
  v_cvt_pk_bf16_f32 v26, v188, v189
  v_cvt_pk_bf16_f32 v27, v190, v191
  v_mfma_f32_16x16x32_bf16 v[196:199], v[72:75], v[88:91], v[196:199]
  ds_write_b64 v11, v[26:27] offset:3456
  v_pk_fma_f32 v[120:121], v[242:243], v[228:229], v[120:121] op_sel_hi:[1,0,1] neg_lo:[0,1,0] neg_hi:[0,1,0]
  v_pk_fma_f32 v[122:123], v[244:245], v[228:229], v[122:123] op_sel_hi:[1,0,1] neg_lo:[0,1,0] neg_hi:[0,1,0]
  v_pk_fma_f32 v[156:157], v[246:247], v[228:229], v[156:157] op_sel_hi:[1,0,1] neg_lo:[0,1,0] neg_hi:[0,1,0]
  v_pk_fma_f32 v[158:159], v[248:249], v[228:229], v[158:159] op_sel_hi:[1,0,1] neg_lo:[0,1,0] neg_hi:[0,1,0]
  v_pk_fma_f32 v[192:193], v[250:251], v[228:229], v[192:193] op_sel_hi:[1,0,1] neg_lo:[0,1,0] neg_hi:[0,1,0]
  v_pk_fma_f32 v[194:195], v[252:253], v[228:229], v[194:195] op_sel_hi:[1,0,1] neg_lo:[0,1,0] neg_hi:[0,1,0]
  v_mfma_f32_16x16x32_bf16 v[160:163], v[68:71], v[88:91], v[160:163]
  v_pk_mul_f32 v[120:121], v[120:121], v[228:229] op_sel:[0,1] op_sel_hi:[1,1]
  v_pk_mul_f32 v[122:123], v[122:123], v[228:229] op_sel:[0,1] op_sel_hi:[1,1]
  v_pk_mul_f32 v[156:157], v[156:157], v[228:229] op_sel:[0,1] op_sel_hi:[1,1]
  v_pk_mul_f32 v[158:159], v[158:159], v[228:229] op_sel:[0,1] op_sel_hi:[1,1]
  v_pk_mul_f32 v[192:193], v[192:193], v[228:229] op_sel:[0,1] op_sel_hi:[1,1]
  v_pk_mul_f32 v[194:195], v[194:195], v[228:229] op_sel:[0,1] op_sel_hi:[1,1]
  v_cvt_pk_bf16_f32 v28, v120, v121
  v_mfma_f32_16x16x32_bf16 v[124:127], v[64:67], v[88:91], v[124:127]
  v_cvt_pk_bf16_f32 v29, v122, v123
  ds_write_b64 v11, v[28:29] offset:6400
  v_cvt_pk_bf16_f32 v30, v156, v157
  v_cvt_pk_bf16_f32 v31, v158, v159
  ds_write_b64 v11, v[30:31] offset:6528
  v_cvt_pk_bf16_f32 v32, v192, v193
  v_cvt_pk_bf16_f32 v33, v194, v195
  v_mfma_f32_16x16x32_bf16 v[128:131], v[64:67], v[92:95], v[128:131]
  ds_write_b64 v11, v[32:33] offset:6656
  v_pk_fma_f32 v[124:125], v[242:243], v[230:231], v[124:125] op_sel_hi:[1,0,1] neg_lo:[0,1,0] neg_hi:[0,1,0]
  v_pk_fma_f32 v[126:127], v[244:245], v[230:231], v[126:127] op_sel_hi:[1,0,1] neg_lo:[0,1,0] neg_hi:[0,1,0]
  v_pk_fma_f32 v[160:161], v[246:247], v[230:231], v[160:161] op_sel_hi:[1,0,1] neg_lo:[0,1,0] neg_hi:[0,1,0]
  v_pk_fma_f32 v[162:163], v[248:249], v[230:231], v[162:163] op_sel_hi:[1,0,1] neg_lo:[0,1,0] neg_hi:[0,1,0]
  v_pk_fma_f32 v[196:197], v[250:251], v[230:231], v[196:197] op_sel_hi:[1,0,1] neg_lo:[0,1,0] neg_hi:[0,1,0]
  v_pk_fma_f32 v[198:199], v[252:253], v[230:231], v[198:199] op_sel_hi:[1,0,1] neg_lo:[0,1,0] neg_hi:[0,1,0]
  v_mfma_f32_16x16x32_bf16 v[164:167], v[68:71], v[92:95], v[164:167]
  v_pk_mul_f32 v[124:125], v[124:125], v[230:231] op_sel:[0,1] op_sel_hi:[1,1]
  v_pk_mul_f32 v[126:127], v[126:127], v[230:231] op_sel:[0,1] op_sel_hi:[1,1]
  v_pk_mul_f32 v[160:161], v[160:161], v[230:231] op_sel:[0,1] op_sel_hi:[1,1]
  v_pk_mul_f32 v[162:163], v[162:163], v[230:231] op_sel:[0,1] op_sel_hi:[1,1]
  v_pk_mul_f32 v[196:197], v[196:197], v[230:231] op_sel:[0,1] op_sel_hi:[1,1]
  v_pk_mul_f32 v[198:199], v[198:199], v[230:231] op_sel:[0,1] op_sel_hi:[1,1]
  v_cvt_pk_bf16_f32 v34, v124, v125
  v_mfma_f32_16x16x32_bf16 v[200:203], v[72:75], v[92:95], v[200:203]
  v_cvt_pk_bf16_f32 v35, v126, v127
  ds_write_b64 v11, v[34:35] offset:9600
  v_cvt_pk_bf16_f32 v36, v160, v161
  v_cvt_pk_bf16_f32 v37, v162, v163
  ds_write_b64 v11, v[36:37] offset:9728
  v_cvt_pk_bf16_f32 v38, v196, v197
  v_cvt_pk_bf16_f32 v39, v198, v199
  v_mfma_f32_16x16x32_bf16 v[204:207], v[72:75], v[96:99], v[204:207]
  ds_write_b64 v11, v[38:39] offset:9856
  v_pk_fma_f32 v[128:129], v[242:243], v[232:233], v[128:129] op_sel_hi:[1,0,1] neg_lo:[0,1,0] neg_hi:[0,1,0]
  v_pk_fma_f32 v[130:131], v[244:245], v[232:233], v[130:131] op_sel_hi:[1,0,1] neg_lo:[0,1,0] neg_hi:[0,1,0]
  v_pk_fma_f32 v[164:165], v[246:247], v[232:233], v[164:165] op_sel_hi:[1,0,1] neg_lo:[0,1,0] neg_hi:[0,1,0]
  v_pk_fma_f32 v[166:167], v[248:249], v[232:233], v[166:167] op_sel_hi:[1,0,1] neg_lo:[0,1,0] neg_hi:[0,1,0]
  v_pk_fma_f32 v[200:201], v[250:251], v[232:233], v[200:201] op_sel_hi:[1,0,1] neg_lo:[0,1,0] neg_hi:[0,1,0]
  v_pk_fma_f32 v[202:203], v[252:253], v[232:233], v[202:203] op_sel_hi:[1,0,1] neg_lo:[0,1,0] neg_hi:[0,1,0]
  v_mfma_f32_16x16x32_bf16 v[168:171], v[68:71], v[96:99], v[168:171]
  v_pk_mul_f32 v[128:129], v[128:129], v[232:233] op_sel:[0,1] op_sel_hi:[1,1]
  v_pk_mul_f32 v[130:131], v[130:131], v[232:233] op_sel:[0,1] op_sel_hi:[1,1]
  v_pk_mul_f32 v[164:165], v[164:165], v[232:233] op_sel:[0,1] op_sel_hi:[1,1]
  v_pk_mul_f32 v[166:167], v[166:167], v[232:233] op_sel:[0,1] op_sel_hi:[1,1]
  v_pk_mul_f32 v[200:201], v[200:201], v[232:233] op_sel:[0,1] op_sel_hi:[1,1]
  v_pk_mul_f32 v[202:203], v[202:203], v[232:233] op_sel:[0,1] op_sel_hi:[1,1]
  v_cvt_pk_bf16_f32 v40, v128, v129
  v_mfma_f32_16x16x32_bf16 v[132:135], v[64:67], v[96:99], v[132:135]
  v_cvt_pk_bf16_f32 v41, v130, v131
  ds_write_b64 v11, v[40:41] offset:12800
  v_cvt_pk_bf16_f32 v42, v164, v165
  v_cvt_pk_bf16_f32 v43, v166, v167
  ds_write_b64 v11, v[42:43] offset:12928
  v_cvt_pk_bf16_f32 v44, v200, v201
  v_cvt_pk_bf16_f32 v45, v202, v203
  v_mfma_f32_16x16x32_bf16 v[136:139], v[64:67], v[100:103], v[136:139]
  ds_write_b64 v11, v[44:45] offset:13056
  v_pk_fma_f32 v[132:133], v[242:243], v[234:235], v[132:133] op_sel_hi:[1,0,1] neg_lo:[0,1,0] neg_hi:[0,1,0]
  v_pk_fma_f32 v[134:135], v[244:245], v[234:235], v[134:135] op_sel_hi:[1,0,1] neg_lo:[0,1,0] neg_hi:[0,1,0]
  v_pk_fma_f32 v[168:169], v[246:247], v[234:235], v[168:169] op_sel_hi:[1,0,1] neg_lo:[0,1,0] neg_hi:[0,1,0]
  v_pk_fma_f32 v[170:171], v[248:249], v[234:235], v[170:171] op_sel_hi:[1,0,1] neg_lo:[0,1,0] neg_hi:[0,1,0]
  v_pk_fma_f32 v[204:205], v[250:251], v[234:235], v[204:205] op_sel_hi:[1,0,1] neg_lo:[0,1,0] neg_hi:[0,1,0]
  v_pk_fma_f32 v[206:207], v[252:253], v[234:235], v[206:207] op_sel_hi:[1,0,1] neg_lo:[0,1,0] neg_hi:[0,1,0]
  v_mfma_f32_16x16x32_bf16 v[172:175], v[68:71], v[100:103], v[172:175]
  v_pk_mul_f32 v[132:133], v[132:133], v[234:235] op_sel:[0,1] op_sel_hi:[1,1]
  v_pk_mul_f32 v[134:135], v[134:135], v[234:235] op_sel:[0,1] op_sel_hi:[1,1]
  v_pk_mul_f32 v[168:169], v[168:169], v[234:235] op_sel:[0,1] op_sel_hi:[1,1]
  v_pk_mul_f32 v[170:171], v[170:171], v[234:235] op_sel:[0,1] op_sel_hi:[1,1]
  v_pk_mul_f32 v[204:205], v[204:205], v[234:235] op_sel:[0,1] op_sel_hi:[1,1]
  v_pk_mul_f32 v[206:207], v[206:207], v[234:235] op_sel:[0,1] op_sel_hi:[1,1]
  v_cvt_pk_bf16_f32 v46, v132, v133
  v_mfma_f32_16x16x32_bf16 v[208:211], v[72:75], v[100:103], v[208:211]
  v_cvt_pk_bf16_f32 v47, v134, v135
  ds_write_b64 v11, v[46:47] offset:16000
  v_cvt_pk_bf16_f32 v48, v168, v169
  v_cvt_pk_bf16_f32 v49, v170, v171
  ds_write_b64 v11, v[48:49] offset:16128
  v_cvt_pk_bf16_f32 v50, v204, v205
  v_cvt_pk_bf16_f32 v51, v206, v207
  v_mfma_f32_16x16x32_bf16 v[212:215], v[72:75], v[104:107], v[212:215]
  ds_write_b64 v11, v[50:51] offset:16256
  v_pk_fma_f32 v[136:137], v[242:243], v[236:237], v[136:137] op_sel_hi:[1,0,1] neg_lo:[0,1,0] neg_hi:[0,1,0]
  v_pk_fma_f32 v[138:139], v[244:245], v[236:237], v[138:139] op_sel_hi:[1,0,1] neg_lo:[0,1,0] neg_hi:[0,1,0]
  v_pk_fma_f32 v[172:173], v[246:247], v[236:237], v[172:173] op_sel_hi:[1,0,1] neg_lo:[0,1,0] neg_hi:[0,1,0]
  v_pk_fma_f32 v[174:175], v[248:249], v[236:237], v[174:175] op_sel_hi:[1,0,1] neg_lo:[0,1,0] neg_hi:[0,1,0]
  v_pk_fma_f32 v[208:209], v[250:251], v[236:237], v[208:209] op_sel_hi:[1,0,1] neg_lo:[0,1,0] neg_hi:[0,1,0]
  v_pk_fma_f32 v[210:211], v[252:253], v[236:237], v[210:211] op_sel_hi:[1,0,1] neg_lo:[0,1,0] neg_hi:[0,1,0]
  v_mfma_f32_16x16x32_bf16 v[176:179], v[68:71], v[104:107], v[176:179]
  v_pk_mul_f32 v[136:137], v[136:137], v[236:237] op_sel:[0,1] op_sel_hi:[1,1]
  v_pk_mul_f32 v[138:139], v[138:139], v[236:237] op_sel:[0,1] op_sel_hi:[1,1]
  v_pk_mul_f32 v[172:173], v[172:173], v[236:237] op_sel:[0,1] op_sel_hi:[1,1]
  v_pk_mul_f32 v[174:175], v[174:175], v[236:237] op_sel:[0,1] op_sel_hi:[1,1]
  v_pk_mul_f32 v[208:209], v[208:209], v[236:237] op_sel:[0,1] op_sel_hi:[1,1]
  v_pk_mul_f32 v[210:211], v[210:211], v[236:237] op_sel:[0,1] op_sel_hi:[1,1]
  v_cvt_pk_bf16_f32 v52, v136, v137
  v_mfma_f32_16x16x32_bf16 v[140:143], v[64:67], v[104:107], v[140:143]
  v_cvt_pk_bf16_f32 v53, v138, v139
  ds_write_b64 v11, v[52:53] offset:19200
  v_cvt_pk_bf16_f32 v54, v172, v173
  v_cvt_pk_bf16_f32 v55, v174, v175
  ds_write_b64 v11, v[54:55] offset:19328
  v_cvt_pk_bf16_f32 v56, v208, v209
  v_cvt_pk_bf16_f32 v57, v210, v211
  v_mfma_f32_16x16x32_bf16 v[144:147], v[64:67], v[108:111], v[144:147]
  ds_write_b64 v11, v[56:57] offset:19456
  v_pk_fma_f32 v[140:141], v[242:243], v[238:239], v[140:141] op_sel_hi:[1,0,1] neg_lo:[0,1,0] neg_hi:[0,1,0]
  v_pk_fma_f32 v[142:143], v[244:245], v[238:239], v[142:143] op_sel_hi:[1,0,1] neg_lo:[0,1,0] neg_hi:[0,1,0]
  v_pk_fma_f32 v[176:177], v[246:247], v[238:239], v[176:177] op_sel_hi:[1,0,1] neg_lo:[0,1,0] neg_hi:[0,1,0]
  v_pk_fma_f32 v[178:179], v[248:249], v[238:239], v[178:179] op_sel_hi:[1,0,1] neg_lo:[0,1,0] neg_hi:[0,1,0]
  v_pk_fma_f32 v[212:213], v[250:251], v[238:239], v[212:213] op_sel_hi:[1,0,1] neg_lo:[0,1,0] neg_hi:[0,1,0]
  v_pk_fma_f32 v[214:215], v[252:253], v[238:239], v[214:215] op_sel_hi:[1,0,1] neg_lo:[0,1,0] neg_hi:[0,1,0]
  v_mfma_f32_16x16x32_bf16 v[180:183], v[68:71], v[108:111], v[180:183]
  v_pk_mul_f32 v[140:141], v[140:141], v[238:239] op_sel:[0,1] op_sel_hi:[1,1]
  v_pk_mul_f32 v[142:143], v[142:143], v[238:239] op_sel:[0,1] op_sel_hi:[1,1]
  v_pk_mul_f32 v[176:177], v[176:177], v[238:239] op_sel:[0,1] op_sel_hi:[1,1]
  v_pk_mul_f32 v[178:179], v[178:179], v[238:239] op_sel:[0,1] op_sel_hi:[1,1]
  v_pk_mul_f32 v[212:213], v[212:213], v[238:239] op_sel:[0,1] op_sel_hi:[1,1]
  v_pk_mul_f32 v[214:215], v[214:215], v[238:239] op_sel:[0,1] op_sel_hi:[1,1]
  v_cvt_pk_bf16_f32 v58, v140, v141
  v_mfma_f32_16x16x32_bf16 v[216:219], v[72:75], v[108:111], v[216:219]
  v_cvt_pk_bf16_f32 v59, v142, v143
  ds_write_b64 v11, v[58:59] offset:22400
  v_cvt_pk_bf16_f32 v60, v176, v177
  v_cvt_pk_bf16_f32 v61, v178, v179
  ds_write_b64 v11, v[60:61] offset:22528
  v_cvt_pk_bf16_f32 v62, v212, v213
  v_cvt_pk_bf16_f32 v63, v214, v215
  s_barrier
  ds_write_b64 v11, v[62:63] offset:22656
  v_pk_fma_f32 v[144:145], v[242:243], v[240:241], v[144:145] op_sel_hi:[1,0,1] neg_lo:[0,1,0] neg_hi:[0,1,0]
  v_pk_fma_f32 v[146:147], v[244:245], v[240:241], v[146:147] op_sel_hi:[1,0,1] neg_lo:[0,1,0] neg_hi:[0,1,0]
  v_pk_fma_f32 v[180:181], v[246:247], v[240:241], v[180:181] op_sel_hi:[1,0,1] neg_lo:[0,1,0] neg_hi:[0,1,0]
  v_pk_fma_f32 v[182:183], v[248:249], v[240:241], v[182:183] op_sel_hi:[1,0,1] neg_lo:[0,1,0] neg_hi:[0,1,0]
  v_pk_fma_f32 v[216:217], v[250:251], v[240:241], v[216:217] op_sel_hi:[1,0,1] neg_lo:[0,1,0] neg_hi:[0,1,0]
  v_pk_fma_f32 v[218:219], v[252:253], v[240:241], v[218:219] op_sel_hi:[1,0,1] neg_lo:[0,1,0] neg_hi:[0,1,0]
  v_pk_mul_f32 v[144:145], v[144:145], v[240:241] op_sel:[0,1] op_sel_hi:[1,1]
  v_pk_mul_f32 v[146:147], v[146:147], v[240:241] op_sel:[0,1] op_sel_hi:[1,1]
  v_pk_mul_f32 v[180:181], v[180:181], v[240:241] op_sel:[0,1] op_sel_hi:[1,1]
  v_pk_mul_f32 v[182:183], v[182:183], v[240:241] op_sel:[0,1] op_sel_hi:[1,1]
  v_pk_mul_f32 v[216:217], v[216:217], v[240:241] op_sel:[0,1] op_sel_hi:[1,1]
  v_pk_mul_f32 v[218:219], v[218:219], v[240:241] op_sel:[0,1] op_sel_hi:[1,1]
  v_cvt_pk_bf16_f32 v16, v144, v145
  v_cvt_pk_bf16_f32 v17, v146, v147
  ds_write_b64 v11, v[16:17] offset:25600
  v_cvt_pk_bf16_f32 v18, v180, v181
  v_cvt_pk_bf16_f32 v19, v182, v183
  ds_write_b64 v11, v[18:19] offset:25728
  v_cvt_pk_bf16_f32 v20, v216, v217
  v_cvt_pk_bf16_f32 v21, v218, v219
  ds_write_b64 v11, v[20:21] offset:25856
attn:
  s_nop 7
  s_nop 7
  v_mov_b32 v18, 0x3e8293ee
  v_mov_b32 v19, 0xff800000
  s_mov_b32 s20, s82
  s_mov_b32 s21, s83
  s_mov_b32 s22, 8388608
  s_mov_b32 s23, 0x20000
  s_mov_b32 s49, 4096
  s_waitcnt lgkmcnt(0)
  s_barrier
  ds_read_b128 v[32:35], v223 offset:0
  ds_read_b128 v[36:39], v220 offset:0
  ds_read_b128 v[40:43], v221 offset:0
  ds_read_b128 v[80:83], v223 offset:64
  ds_read_b128 v[84:87], v220 offset:64
  ds_read_b128 v[88:91], v221 offset:64
  ds_read_b64_tr_b16 v[44:45], v222 offset:0
  ds_read_b64_tr_b16 v[46:47], v254 offset:0
  ds_read_b64_tr_b16 v[48:49], v222 offset:8
  ds_read_b64_tr_b16 v[50:51], v254 offset:8
  ds_read_b64_tr_b16 v[92:93], v222 offset:64
  ds_read_b64_tr_b16 v[94:95], v254 offset:64
  ds_read_b64_tr_b16 v[96:97], v222 offset:72
  ds_read_b64_tr_b16 v[98:99], v254 offset:72
  s_waitcnt lgkmcnt(11)
  v_mfma_f32_16x16x32_bf16 v[52:55], v[36:39], v[32:35], 0
  v_mfma_f32_16x16x32_bf16 v[56:59], v[40:43], v[32:35], 0
  s_waitcnt lgkmcnt(8)
  v_mfma_f32_16x16x32_bf16 v[100:103], v[84:87], v[80:83], 0
  v_mfma_f32_16x16x32_bf16 v[104:107], v[88:91], v[80:83], 0
  s_nop 3
  v_cndmask_b32 v52, v19, v52, s[86:87]
  s_nop 1
  v_cndmask_b32 v100, v19, v100, s[86:87]
  v_cndmask_b32 v53, v19, v53, s[88:89]
  v_cndmask_b32 v101, v19, v101, s[88:89]
  v_cndmask_b32 v54, v19, v54, s[90:91]
  v_cndmask_b32 v102, v19, v102, s[90:91]
  v_cndmask_b32 v55, v19, v55, s[92:93]
  v_cndmask_b32 v103, v19, v103, s[92:93]
  v_cndmask_b32 v56, v19, v56, s[94:95]
  v_cndmask_b32 v104, v19, v104, s[94:95]
  v_cndmask_b32 v57, v19, v57, s[96:97]
  v_cndmask_b32 v105, v19, v105, s[96:97]
  v_cndmask_b32 v58, v19, v58, s[98:99]
  v_cndmask_b32 v106, v19, v106, s[98:99]
  v_cndmask_b32 v59, v19, v59, s[100:101]
  v_cndmask_b32 v107, v19, v107, s[100:101]
  v_max3_f32 v60, v52, v53, v54
  v_max3_f32 v108, v100, v101, v102
  v_max3_f32 v61, v55, v56, v57
  v_max3_f32 v109, v103, v104, v105
  v_max3_f32 v60, v60, v58, v59
  v_max3_f32 v108, v108, v106, v107
  v_max_f32 v60, v60, v61
  v_max_f32 v108, v108, v109
  v_mov_b32 v61, v60
  v_mov_b32 v109, v108
  s_nop 0
  v_permlane16_swap_b32 v60, v61
  v_permlane16_swap_b32 v108, v109
  v_max_f32 v60, v60, v61
  v_max_f32 v108, v108, v109
  v_mov_b32 v61, v60
  v_mov_b32 v109, v108
  s_nop 0
  v_permlane32_swap_b32 v60, v61
  v_permlane32_swap_b32 v108, v109
  v_max_f32 v60, v60, v61
  v_max_f32 v108, v108, v109
  v_mul_f32 v60, v18, v60
  v_mul_f32 v108, v18, v108
  v_fma_f32 v52, v52, v18, -v60
  v_fma_f32 v100, v100, v18, -v108
  v_fma_f32 v53, v53, v18, -v60
  v_fma_f32 v101, v101, v18, -v108
  v_fma_f32 v54, v54, v18, -v60
  v_fma_f32 v102, v102, v18, -v108
  v_fma_f32 v55, v55, v18, -v60
  v_fma_f32 v103, v103, v18, -v108
  v_fma_f32 v56, v56, v18, -v60
  v_fma_f32 v104, v104, v18, -v108
  v_fma_f32 v57, v57, v18, -v60
  v_fma_f32 v105, v105, v18, -v108
  v_fma_f32 v58, v58, v18, -v60
  v_fma_f32 v106, v106, v18, -v108
  v_fma_f32 v59, v59, v18, -v60
  v_fma_f32 v107, v107, v18, -v108
  v_exp_f32 v52, v52
  v_exp_f32 v100, v100
  v_exp_f32 v53, v53
  v_exp_f32 v101, v101
  v_exp_f32 v54, v54
  v_exp_f32 v102, v102
  v_exp_f32 v55, v55
  v_exp_f32 v103, v103
  v_exp_f32 v56, v56
  v_exp_f32 v104, v104
  v_exp_f32 v57, v57
  v_exp_f32 v105, v105
  v_exp_f32 v58, v58
  v_exp_f32 v106, v106
  v_exp_f32 v59, v59
  v_exp_f32 v107, v107
  v_pk_add_f32 v[60:61], v[52:53], v[54:55]
  v_pk_add_f32 v[108:109], v[100:101], v[102:103]
  v_pk_add_f32 v[62:63], v[56:57], v[58:59]
  v_pk_add_f32 v[110:111], v[104:105], v[106:107]
  v_pk_add_f32 v[60:61], v[60:61], v[62:63]
  v_pk_add_f32 v[108:109], v[108:109], v[110:111]
  v_add_f32 v60, v60, v61
  v_add_f32 v108, v108, v109
  v_mov_b32 v61, v60
  v_mov_b32 v109, v108
  s_nop 0
  v_permlane16_swap_b32 v60, v61
  v_permlane16_swap_b32 v108, v109
  v_add_f32 v60, v60, v61
  v_add_f32 v108, v108, v109
  v_mov_b32 v61, v60
  v_mov_b32 v109, v108
  s_nop 0
  v_permlane32_swap_b32 v60, v61
  v_permlane32_swap_b32 v108, v109
  v_add_f32 v60, v60, v61
  v_add_f32 v108, v108, v109
  v_rcp_f32 v60, v60
  v_rcp_f32 v108, v108
  v_pk_mul_f32 v[52:53], v[52:53], v[60:61] op_sel_hi:[1,0]
  v_pk_mul_f32 v[100:101], v[100:101], v[108:109] op_sel_hi:[1,0]
  v_pk_mul_f32 v[54:55], v[54:55], v[60:61] op_sel_hi:[1,0]
  v_pk_mul_f32 v[102:103], v[102:103], v[108:109] op_sel_hi:[1,0]
  v_pk_mul_f32 v[56:57], v[56:57], v[60:61] op_sel_hi:[1,0]
  v_pk_mul_f32 v[104:105], v[104:105], v[108:109] op_sel_hi:[1,0]
  v_pk_mul_f32 v[58:59], v[58:59], v[60:61] op_sel_hi:[1,0]
  v_pk_mul_f32 v[106:107], v[106:107], v[108:109] op_sel_hi:[1,0]
  v_cvt_pk_bf16_f32 v64, v52, v53
  v_cvt_pk_bf16_f32 v112, v100, v101
  v_cvt_pk_bf16_f32 v65, v54, v55
  v_cvt_pk_bf16_f32 v113, v102, v103
  v_cvt_pk_bf16_f32 v66, v56, v57
  v_cvt_pk_bf16_f32 v114, v104, v105
  v_cvt_pk_bf16_f32 v67, v58, v59
  v_cvt_pk_bf16_f32 v115, v106, v107
  s_waitcnt lgkmcnt(0)
  v_mfma_f32_16x16x32_bf16 v[68:71], v[44:47], v[64:67], 0
  v_mfma_f32_16x16x32_bf16 v[116:119], v[92:95], v[112:115], 0
  v_mfma_f32_16x16x32_bf16 v[72:75], v[48:51], v[64:67], 0
  v_mfma_f32_16x16x32_bf16 v[120:123], v[96:99], v[112:115], 0
  s_nop 4
  v_cvt_pk_bf16_f32 v32, v68, v69
  v_cvt_pk_bf16_f32 v80, v116, v117
  v_cvt_pk_bf16_f32 v33, v70, v71
  v_cvt_pk_bf16_f32 v81, v118, v119
  v_cvt_pk_bf16_f32 v34, v72, v73
  v_cvt_pk_bf16_f32 v82, v120, v121
  v_cvt_pk_bf16_f32 v35, v74, v75
  v_cvt_pk_bf16_f32 v83, v122, v123
  buffer_store_dwordx4 v[32:35], v1, s[20:23], 0 offen sc0 sc1
  buffer_store_dwordx4 v[80:83], v1, s[20:23], s49 offen sc0 sc1
  s_cmp_ge_u32 s4, 4
  s_cbranch_scc1 L_k1done
  s_lshl_b32 s32, s28, 2
  s_add_u32 s32, s32, s4
  s_lshl_b32 s34, s32, 17
  s_lshl_b32 s40, s32, 5
  s_lshl_b32 s52, s32, 8
  v_lshlrev_b32 v13, 1, v4
  v_add_u32 v13, s40, v13
  v_lshlrev_b32 v12, 11, v13
  v_lshl_add_u32 v12, v3, 4, v12
  s_lshl_b32 s32, s29, 7
  v_add_u32 v12, s32, v12
  v_lshlrev_b32 v14, 4, v0
  v_lshlrev_b32 v87, 8, v13
  v_lshl_add_u32 v87, v3, 4, v87
  s_lshl_b32 s32, s29, 19
  v_add_u32 v87, s32, v87
  s_mov_b32 s8, s82
  s_mov_b32 s9, s83
  s_mov_b32 s10, 8388608
  s_mov_b32 s11, 0x20000
  s_cmp_eq_u32 s3, 0
  s_cselect_b32 s16, s64, s84
  s_cselect_b32 s17, s65, s85
  s_cselect_b32 s18, 0, 100663296
  s_add_u32 s16, s16, s18
  s_addc_u32 s17, s17, 0
  s_mov_b32 s18, 4194304
  s_mov_b32 s19, 0x20000
  s_lshl_b32 s18, s18, s3
  s_cmp_eq_u32 s3, 0
  s_cselect_b32 s12, s84, s84
  s_cselect_b32 s13, s85, s85
  s_cselect_b32 s14, 0, 50331648
  s_add_u32 s12, s12, s14
  s_addc_u32 s13, s13, 0
  s_mov_b32 s14, 0
  s_mov_b32 s15, 0x20000
  s_add_u32 s12, s12, 41943040
  s_addc_u32 s13, s13, 0
  s_mov_b32 s14, 524288
  v_lshl_add_u32 v16, v5, 3, v6
  v_lshlrev_b32 v16, 7, v16
  v_lshl_add_u32 v16, v7, 3, v16
  v_lshrrev_b32 v17, 1, v6
  v_lshl_or_b32 v17, v2, 1, v17
  v_lshl_add_u32 v16, v17, 5, v16
  v_add_u32 v16, 131072, v16
  v_xor_b32 v8, 0, v16
  v_xor_b32 v9, 32, v16
  v_xor_b32 v10, 64, v16
  v_xor_b32 v11, 96, v16
  v_lshl_add_u32 v16, v4, 1, v2
  v_lshlrev_b32 v16, 3, v16
  v_add_u32 v16, s52, v16
  s_mul_i32 s32, s29, 16384
  v_add_u32 v112, s32, v16
  v_lshrrev_b32 v17, 5, v0
  v_mul_u32_u24 v17, 131072, v17
  v_add_u32 v113, v16, v17
  s_lshl_b32 s32, s4, 12
  v_lshlrev_b32 v16, 8, v4
  v_lshl_add_u32 v16, v5, 3, v16
  v_add_u32 v16, s32, v16
  v_and_b32 v17, 1, v4
  v_bfe_u32 v18, v4, 2, 1
  v_lshl_or_b32 v17, v18, 1, v17
  v_lshl_add_u32 v114, v17, 5, v16
  s_lshl_b32 s44, s29, 8
  s_lshl_b32 s40, s28, 2
  s_add_u32 s44, s44, s40
  s_add_u32 s44, s44, s4
  s_lshl_b32 s44, s44, 11
  v_lshl_add_u32 v16, v5, 3, v6
  v_lshlrev_b32 v16, 7, v16
  v_lshl_add_u32 v16, v7, 3, v16
  v_lshrrev_b32 v17, 1, v6
  v_lshl_or_b32 v17, v2, 1, v17
  v_lshl_add_u32 v16, v17, 5, v16
  v_xor_b32 v115, 0, v16
  v_add_u32 v115, s32, v115
  s_add_u32 s45, s44, 131072
  s_add_u32 s46, s44, 262144
  s_add_u32 s47, s44, 393216
  v_add_u32 v80, 16384, v113
  v_add_u32 v81, 32768, v113
  v_add_u32 v82, 49152, v113
  v_add_u32 v83, 65536, v113
  v_add_u32 v84, 81920, v113
  v_add_u32 v85, 98304, v113
  v_add_u32 v86, 114688, v113
  s_lshl_b32 s48, 0x303, s7
  s_lshr_b32 s48, s48, 8
  s_mov_b32 s49, s34
  s_add_u32 s50, s34, 65536
  s_add_u32 s41, s34, 131072
  s_and_b32 s40, s4, 1
  s_lshl_b32 s32, s40, 1
  s_add_u32 s32, s32, 0
  s_cmp_eq_u32 s32, 3
  s_addc_u32 s32, s32, 5
  s_lshl_b32 s32, s32, 7
  s_mov_b32 vcc_lo, 0xff000000
  s_mov_b32 vcc_hi, 0
  v_mov_b32 v88, s32
  v_cndmask_b32 v88, 0, v88, vcc
  v_lshl_add_u32 v88, v0, 4, v88
  v_add_u32 v90, 4096, v88
  s_lshl_b32 s32, s40, 1
  s_add_u32 s32, s32, 1
  s_cmp_eq_u32 s32, 3
  s_addc_u32 s32, s32, 5
  s_lshl_b32 s32, s32, 7
  s_mov_b32 vcc_lo, 0xff000000
  s_mov_b32 vcc_hi, 0
  v_mov_b32 v89, s32
  v_cndmask_b32 v89, 0, v89, vcc
  v_lshl_add_u32 v89, v0, 4, v89
  v_add_u32 v89, 2048, v89
  v_add_u32 v91, 4096, v89
  s_lshl_b32 s32, s40, 1
  s_add_u32 s32, s32, 0
  s_cmp_eq_u32 s32, 3
  s_addc_u32 s32, s32, 5
  s_lshl_b32 s32, s32, 7
  s_mov_b32 vcc_lo, 0xff000000
  s_mov_b32 vcc_hi, 0
  v_mov_b32 v92, s32
  v_cndmask_b32 v92, 0, v92, vcc
  v_lshl_add_u32 v92, v0, 4, v92
  s_lshl_b32 s32, s40, 1
  s_add_u32 s32, s32, 1
  s_cmp_eq_u32 s32, 3
  s_addc_u32 s32, s32, 5
  s_lshl_b32 s32, s32, 7
  s_mov_b32 vcc_lo, 0xff000000
  s_mov_b32 vcc_hi, 0
  v_mov_b32 v93, s32
  v_cndmask_b32 v93, 0, v93, vcc
  v_lshl_add_u32 v93, v0, 4, v93
  s_lshl_b32 s32, 0, 1
  s_add_u32 s32, s32, 0
  s_cmp_eq_u32 s32, 3
  s_addc_u32 s32, s32, 5
  s_lshl_b32 s32, s32, 7
  s_mov_b32 vcc_lo, 0xff000000
  s_mov_b32 vcc_hi, 0
  v_mov_b32 v192, s32
  v_cndmask_b32 v192, 0, v192, vcc
  v_lshl_add_u32 v192, v0, 4, v192
  s_lshl_b32 s32, 0, 1
  s_add_u32 s32, s32, 1
  s_cmp_eq_u32 s32, 3
  s_addc_u32 s32, s32, 5
  s_lshl_b32 s32, s32, 7
  s_mov_b32 vcc_lo, 0xff000000
  s_mov_b32 vcc_hi, 0
  v_mov_b32 v193, s32
  v_cndmask_b32 v193, 0, v193, vcc
  v_lshl_add_u32 v193, v0, 4, v193
  v_add_u32 v193, 2048, v193
  s_lshl_b32 s32, 1, 1
  s_add_u32 s32, s32, 0
  s_cmp_eq_u32 s32, 3
  s_addc_u32 s32, s32, 5
  s_lshl_b32 s32, s32, 7
  s_mov_b32 vcc_lo, 0xff000000
  s_mov_b32 vcc_hi, 0
  v_mov_b32 v194, s32
  v_cndmask_b32 v194, 0, v194, vcc
  v_lshl_add_u32 v194, v0, 4, v194
  v_add_u32 v194, 4096, v194
  s_lshl_b32 s32, 1, 1
  s_add_u32 s32, s32, 1
  s_cmp_eq_u32 s32, 3
  s_addc_u32 s32, s32, 5
  s_lshl_b32 s32, s32, 7
  s_mov_b32 vcc_lo, 0xff000000
  s_mov_b32 vcc_hi, 0
  v_mov_b32 v195, s32
  v_cndmask_b32 v195, 0, v195, vcc
  v_lshl_add_u32 v195, v0, 4, v195
  v_add_u32 v195, 6144, v195
  s_lshl_b32 s53, s29, 13
  s_add_u32 s53, s53, s34
  s_add_u32 s24, s84, 109051904
  s_addc_u32 s25, s85, 0
  s_mov_b32 s26, 524288
  s_mov_b32 s27, 0x20000
  v_min_u32 v119, 15, v0
  s_lshl_b32 s32, s28, 4
  v_add_u32 v119, s32, v119
  v_max_i32 v119, 0, v119
  v_lshlrev_b32 v119, 7, v119
  s_lshl_b32 s55, s3, 17
  s_add_u32 s55, s55, 0
  s_waitcnt vmcnt(0)
  s_barrier
  s_cmp_lg_u32 s3, 0
  s_cbranch_scc1 C_r1
  buffer_load_dwordx4 v[96:99], v12, s[16:19], 0 offen offset:0
  buffer_load_dwordx4 v[100:103], v12, s[16:19], 0 offen offset:64
  buffer_load_dwordx4 v[104:107], v12, s[16:19], 0 offen offset:2048
  buffer_load_dwordx4 v[108:111], v12, s[16:19], 0 offen offset:2112
  s_branch C_r2
C_r1:
  buffer_load_dwordx4 v[96:99], v87, s[16:19], 0 offen offset:0 sc1
  buffer_load_dwordx4 v[100:103], v87, s[16:19], 0 offen offset:64 sc1
  buffer_load_dwordx4 v[104:107], v87, s[16:19], 0 offen offset:256 sc1
  buffer_load_dwordx4 v[108:111], v87, s[16:19], 0 offen offset:320 sc1
C_r2:
  s_mov_b32 s39, 0
  s_and_b32 s32, s4, 3
  s_cmp_lg_u32 s32, 0
  s_cbranch_scc1 poll3d
  s_sleep 8
poll3:
  buffer_load_dword v16, v119, s[24:27], s55 offen sc0 sc1
  s_waitcnt vmcnt(0)
  v_cmp_eq_u32 vcc, 0, v16
  s_add_u32 s39, s39, 1
  s_cmp_gt_u32 s39, 1000000
  s_cbranch_scc1 poll3d
  s_cbranch_vccnz poll3
poll3d:
  s_barrier
  s_bitcmp1_b32 s48, 0
  s_cselect_b32 s36, s50, s49
  s_add_u32 s36, s36, 0
  buffer_load_dwordx4 v[120:123], v88, s[8:11], s36 offen sc1
  buffer_load_dwordx4 v[124:127], v89, s[8:11], s36 offen sc1
  buffer_load_dwordx4 v[128:131], v90, s[8:11], s36 offen sc1
  buffer_load_dwordx4 v[132:135], v91, s[8:11], s36 offen sc1
  s_bitcmp1_b32 s48, 1
  s_cselect_b32 s36, s50, s49
  s_add_u32 s36, s36, 8192
  buffer_load_dwordx4 v[136:139], v88, s[8:11], s36 offen sc1
  buffer_load_dwordx4 v[140:143], v89, s[8:11], s36 offen sc1
  buffer_load_dwordx4 v[144:147], v90, s[8:11], s36 offen sc1
  buffer_load_dwordx4 v[148:151], v91, s[8:11], s36 offen sc1
  s_bitcmp1_b32 s48, 2
  s_cselect_b32 s36, s50, s49
  s_add_u32 s36, s36, 16384
  buffer_load_dwordx4 v[152:155], v88, s[8:11], s36 offen sc1
  buffer_load_dwordx4 v[156:159], v89, s[8:11], s36 offen sc1
  buffer_load_dwordx4 v[160:163], v90, s[8:11], s36 offen sc1
  buffer_load_dwordx4 v[164:167], v91, s[8:11], s36 offen sc1
  s_bitcmp1_b32 s48, 3
  s_cselect_b32 s36, s50, s49
  s_add_u32 s36, s36, 24576
  buffer_load_dwordx4 v[168:171], v88, s[8:11], s36 offen sc1
  buffer_load_dwordx4 v[172:175], v89, s[8:11], s36 offen sc1
  s_waitcnt vmcnt(14)
  v_permlane16_swap_b32 v96, v98
  v_permlane16_swap_b32 v97, v99
  v_permlane16_swap_b32 v100, v102
  v_permlane16_swap_b32 v101, v103
  v_permlane16_swap_b32 v104, v106
  v_permlane16_swap_b32 v105, v107
  v_permlane16_swap_b32 v108, v110
  v_permlane16_swap_b32 v109, v111
  v_lshlrev_b32 v48, 16, v96
  v_and_b32 v49, 0xffff0000, v96
  v_lshlrev_b32 v50, 16, v97
  v_and_b32 v51, 0xffff0000, v97
  v_lshlrev_b32 v52, 16, v98
  v_and_b32 v53, 0xffff0000, v98
  v_lshlrev_b32 v54, 16, v99
  v_and_b32 v55, 0xffff0000, v99
  v_lshlrev_b32 v56, 16, v100
  v_and_b32 v57, 0xffff0000, v100
  v_lshlrev_b32 v58, 16, v101
  v_and_b32 v59, 0xffff0000, v101
  v_lshlrev_b32 v60, 16, v102
  v_and_b32 v61, 0xffff0000, v102
  v_lshlrev_b32 v62, 16, v103
  v_and_b32 v63, 0xffff0000, v103
  v_lshlrev_b32 v64, 16, v104
  v_and_b32 v65, 0xffff0000, v104
  v_lshlrev_b32 v66, 16, v105
  v_and_b32 v67, 0xffff0000, v105
  v_lshlrev_b32 v68, 16, v106
  v_and_b32 v69, 0xffff0000, v106
  v_lshlrev_b32 v70, 16, v107
  v_and_b32 v71, 0xffff0000, v107
  v_lshlrev_b32 v72, 16, v108
  v_and_b32 v73, 0xffff0000, v108
  v_lshlrev_b32 v74, 16, v109
  v_and_b32 v75, 0xffff0000, v109
  v_lshlrev_b32 v76, 16, v110
  v_and_b32 v77, 0xffff0000, v110
  v_lshlrev_b32 v78, 16, v111
  v_and_b32 v79, 0xffff0000, v111
  s_mov_b32 s43, 0
  s_mov_b32 s39, 1
  s_barrier
  ds_read_b64_tr_b16 v[16:17], v8 offset:0
  ds_read_b64_tr_b16 v[18:19], v8 offset:512
  ds_read_b64_tr_b16 v[20:21], v9 offset:0
  ds_read_b64_tr_b16 v[22:23], v9 offset:512
  ds_read_b64_tr_b16 v[24:25], v10 offset:0
  ds_read_b64_tr_b16 v[26:27], v10 offset:512
  ds_read_b64_tr_b16 v[28:29], v11 offset:0
  ds_read_b64_tr_b16 v[30:31], v11 offset:512
  s_waitcnt vmcnt(13) lgkmcnt(6)
  v_mfma_f32_16x16x32_bf16 v[48:51], v[16:19], v[120:123], v[48:51]
  ds_read_b64_tr_b16 v[32:33], v8 offset:4096
  s_waitcnt vmcnt(12)
  v_mfma_f32_16x16x32_bf16 v[64:67], v[16:19], v[124:127], v[64:67]
  ds_read_b64_tr_b16 v[34:35], v8 offset:4608
  v_add_u32 v8, 8192, v8
  s_waitcnt lgkmcnt(6)
  v_mfma_f32_16x16x32_bf16 v[68:71], v[20:23], v[124:127], v[68:71]
  ds_read_b64_tr_b16 v[36:37], v9 offset:4096
  buffer_load_dwordx4 v[176:179], v90, s[8:11], s36 offen sc1
  v_mfma_f32_16x16x32_bf16 v[52:55], v[20:23], v[120:123], v[52:55]
  ds_read_b64_tr_b16 v[38:39], v9 offset:4608
  v_add_u32 v9, 8192, v9
  s_waitcnt lgkmcnt(6)
  v_mfma_f32_16x16x32_bf16 v[56:59], v[24:27], v[120:123], v[56:59]
  ds_read_b64_tr_b16 v[40:41], v10 offset:4096
  v_mfma_f32_16x16x32_bf16 v[72:75], v[24:27], v[124:127], v[72:75]
  ds_read_b64_tr_b16 v[42:43], v10 offset:4608
  v_add_u32 v10, 8192, v10
  s_waitcnt lgkmcnt(6)
  v_mfma_f32_16x16x32_bf16 v[76:79], v[28:31], v[124:127], v[76:79]
  ds_read_b64_tr_b16 v[44:45], v11 offset:4096
  buffer_load_dwordx4 v[180:183], v91, s[8:11], s36 offen sc1
  v_mfma_f32_16x16x32_bf16 v[60:63], v[28:31], v[120:123], v[60:63]
  ds_read_b64_tr_b16 v[46:47], v11 offset:4608
  v_add_u32 v11, 8192, v11
  s_waitcnt vmcnt(13) lgkmcnt(6)
  v_mfma_f32_16x16x32_bf16 v[48:51], v[32:35], v[128:131], v[48:51]
  ds_read_b64_tr_b16 v[16:17], v8 offset:0
  s_bitcmp1_b32 s48, 4
  s_cselect_b32 s36, s50, s49
  s_waitcnt vmcnt(12)
  v_mfma_f32_16x16x32_bf16 v[64:67], v[32:35], v[132:135], v[64:67]
  ds_read_b64_tr_b16 v[18:19], v8 offset:512
  s_add_u32 s36, s36, 32768
  s_waitcnt lgkmcnt(6)
  v_mfma_f32_16x16x32_bf16 v[68:71], v[36:39], v[132:135], v[68:71]
  ds_read_b64_tr_b16 v[20:21], v9 offset:0
  v_mfma_f32_16x16x32_bf16 v[52:55], v[36:39], v[128:131], v[52:55]
  ds_read_b64_tr_b16 v[22:23], v9 offset:512
  s_waitcnt lgkmcnt(6)
  v_mfma_f32_16x16x32_bf16 v[56:59], v[40:43], v[128:131], v[56:59]
  ds_read_b64_tr_b16 v[24:25], v10 offset:0
  buffer_load_dwordx4 v[120:123], v88, s[8:11], s36 offen sc1
  v_mfma_f32_16x16x32_bf16 v[72:75], v[40:43], v[132:135], v[72:75]
  ds_read_b64_tr_b16 v[26:27], v10 offset:512
  s_waitcnt lgkmcnt(6)
  v_mfma_f32_16x16x32_bf16 v[76:79], v[44:47], v[132:135], v[76:79]
  ds_read_b64_tr_b16 v[28:29], v11 offset:0
  v_mfma_f32_16x16x32_bf16 v[60:63], v[44:47], v[128:131], v[60:63]
  ds_read_b64_tr_b16 v[30:31], v11 offset:512
  buffer_load_dwordx4 v[124:127], v89, s[8:11], s36 offen sc1
  s_waitcnt vmcnt(13) lgkmcnt(6)
  v_mfma_f32_16x16x32_bf16 v[48:51], v[16:19], v[136:139], v[48:51]
  ds_read_b64_tr_b16 v[32:33], v8 offset:4096
  s_waitcnt vmcnt(12)
  v_mfma_f32_16x16x32_bf16 v[64:67], v[16:19], v[140:143], v[64:67]
  ds_read_b64_tr_b16 v[34:35], v8 offset:4608
  v_add_u32 v8, 8192, v8
  s_waitcnt lgkmcnt(6)
  v_mfma_f32_16x16x32_bf16 v[68:71], v[20:23], v[140:143], v[68:71]
  ds_read_b64_tr_b16 v[36:37], v9 offset:4096
  buffer_load_dwordx4 v[128:131], v90, s[8:11], s36 offen sc1
  v_mfma_f32_16x16x32_bf16 v[52:55], v[20:23], v[136:139], v[52:55]
  ds_read_b64_tr_b16 v[38:39], v9 offset:4608
  v_add_u32 v9, 8192, v9
  s_waitcnt lgkmcnt(6)
  v_mfma_f32_16x16x32_bf16 v[56:59], v[24:27], v[136:139], v[56:59]
  ds_read_b64_tr_b16 v[40:41], v10 offset:4096
  v_mfma_f32_16x16x32_bf16 v[72:75], v[24:27], v[140:143], v[72:75]
  ds_read_b64_tr_b16 v[42:43], v10 offset:4608
  v_add_u32 v10, 8192, v10
  s_waitcnt lgkmcnt(6)
  v_mfma_f32_16x16x32_bf16 v[76:79], v[28:31], v[140:143], v[76:79]
  ds_read_b64_tr_b16 v[44:45], v11 offset:4096
  buffer_load_dwordx4 v[132:135], v91, s[8:11], s36 offen sc1
  v_mfma_f32_16x16x32_bf16 v[60:63], v[28:31], v[136:139], v[60:63]
  ds_read_b64_tr_b16 v[46:47], v11 offset:4608
  v_add_u32 v11, 8192, v11
  s_waitcnt vmcnt(13) lgkmcnt(6)
  v_mfma_f32_16x16x32_bf16 v[48:51], v[32:35], v[144:147], v[48:51]
  ds_read_b64_tr_b16 v[16:17], v8 offset:0
  s_bitcmp1_b32 s48, 5
  s_cselect_b32 s36, s50, s49
  s_waitcnt vmcnt(12)
  v_mfma_f32_16x16x32_bf16 v[64:67], v[32:35], v[148:151], v[64:67]
  ds_read_b64_tr_b16 v[18:19], v8 offset:512
  s_add_u32 s36, s36, 40960
  s_waitcnt lgkmcnt(6)
  v_mfma_f32_16x16x32_bf16 v[68:71], v[36:39], v[148:151], v[68:71]
  ds_read_b64_tr_b16 v[20:21], v9 offset:0
  v_mfma_f32_16x16x32_bf16 v[52:55], v[36:39], v[144:147], v[52:55]
  ds_read_b64_tr_b16 v[22:23], v9 offset:512
  s_waitcnt lgkmcnt(6)
  v_mfma_f32_16x16x32_bf16 v[56:59], v[40:43], v[144:147], v[56:59]
  ds_read_b64_tr_b16 v[24:25], v10 offset:0
  buffer_load_dwordx4 v[136:139], v88, s[8:11], s36 offen sc1
  v_mfma_f32_16x16x32_bf16 v[72:75], v[40:43], v[148:151], v[72:75]
  ds_read_b64_tr_b16 v[26:27], v10 offset:512
  s_waitcnt lgkmcnt(6)
  v_mfma_f32_16x16x32_bf16 v[76:79], v[44:47], v[148:151], v[76:79]
  ds_read_b64_tr_b16 v[28:29], v11 offset:0
  v_mfma_f32_16x16x32_bf16 v[60:63], v[44:47], v[144:147], v[60:63]
  ds_read_b64_tr_b16 v[30:31], v11 offset:512
  buffer_load_dwordx4 v[140:143], v89, s[8:11], s36 offen sc1
  s_waitcnt vmcnt(13) lgkmcnt(6)
  v_mfma_f32_16x16x32_bf16 v[48:51], v[16:19], v[152:155], v[48:51]
  ds_read_b64_tr_b16 v[32:33], v8 offset:4096
  s_waitcnt vmcnt(12)
  v_mfma_f32_16x16x32_bf16 v[64:67], v[16:19], v[156:159], v[64:67]
  ds_read_b64_tr_b16 v[34:35], v8 offset:4608
  v_add_u32 v8, 8192, v8
  s_waitcnt lgkmcnt(6)
  v_mfma_f32_16x16x32_bf16 v[68:71], v[20:23], v[156:159], v[68:71]
  ds_read_b64_tr_b16 v[36:37], v9 offset:4096
  buffer_load_dwordx4 v[144:147], v90, s[8:11], s36 offen sc1
  v_mfma_f32_16x16x32_bf16 v[52:55], v[20:23], v[152:155], v[52:55]
  ds_read_b64_tr_b16 v[38:39], v9 offset:4608
  v_add_u32 v9, 8192, v9
  s_waitcnt lgkmcnt(6)
  v_mfma_f32_16x16x32_bf16 v[56:59], v[24:27], v[152:155], v[56:59]
  ds_read_b64_tr_b16 v[40:41], v10 offset:4096
  v_mfma_f32_16x16x32_bf16 v[72:75], v[24:27], v[156:159], v[72:75]
  ds_read_b64_tr_b16 v[42:43], v10 offset:4608
  v_add_u32 v10, 8192, v10
  s_waitcnt lgkmcnt(6)
  v_mfma_f32_16x16x32_bf16 v[76:79], v[28:31], v[156:159], v[76:79]
  ds_read_b64_tr_b16 v[44:45], v11 offset:4096
  buffer_load_dwordx4 v[148:151], v91, s[8:11], s36 offen sc1
  v_mfma_f32_16x16x32_bf16 v[60:63], v[28:31], v[152:155], v[60:63]
  ds_read_b64_tr_b16 v[46:47], v11 offset:4608
  v_add_u32 v11, 8192, v11
  s_waitcnt vmcnt(13) lgkmcnt(6)
  v_mfma_f32_16x16x32_bf16 v[48:51], v[32:35], v[160:163], v[48:51]
  ds_read_b64_tr_b16 v[16:17], v8 offset:0
  s_bitcmp1_b32 s48, 6
  s_cselect_b32 s36, s50, s49
  s_waitcnt vmcnt(12)
  v_mfma_f32_16x16x32_bf16 v[64:67], v[32:35], v[164:167], v[64:67]
  ds_read_b64_tr_b16 v[18:19], v8 offset:512
  s_add_u32 s36, s36, 49152
  s_waitcnt lgkmcnt(6)
  v_mfma_f32_16x16x32_bf16 v[68:71], v[36:39], v[164:167], v[68:71]
  ds_read_b64_tr_b16 v[20:21], v9 offset:0
  v_mfma_f32_16x16x32_bf16 v[52:55], v[36:39], v[160:163], v[52:55]
  ds_read_b64_tr_b16 v[22:23], v9 offset:512
  s_waitcnt lgkmcnt(6)
  v_mfma_f32_16x16x32_bf16 v[56:59], v[40:43], v[160:163], v[56:59]
  ds_read_b64_tr_b16 v[24:25], v10 offset:0
  buffer_load_dwordx4 v[152:155], v88, s[8:11], s36 offen sc1
  v_mfma_f32_16x16x32_bf16 v[72:75], v[40:43], v[164:167], v[72:75]
  ds_read_b64_tr_b16 v[26:27], v10 offset:512
  s_waitcnt lgkmcnt(6)
  v_mfma_f32_16x16x32_bf16 v[76:79], v[44:47], v[164:167], v[76:79]
  ds_read_b64_tr_b16 v[28:29], v11 offset:0
  v_mfma_f32_16x16x32_bf16 v[60:63], v[44:47], v[160:163], v[60:63]
  ds_read_b64_tr_b16 v[30:31], v11 offset:512
  buffer_load_dwordx4 v[156:159], v89, s[8:11], s36 offen sc1
  s_waitcnt vmcnt(13) lgkmcnt(6)
  v_mfma_f32_16x16x32_bf16 v[48:51], v[16:19], v[168:171], v[48:51]
  ds_read_b64_tr_b16 v[32:33], v8 offset:4096
  s_waitcnt vmcnt(12)
  v_mfma_f32_16x16x32_bf16 v[64:67], v[16:19], v[172:175], v[64:67]
  ds_read_b64_tr_b16 v[34:35], v8 offset:4608
  v_add_u32 v8, 4294912256, v8
  s_waitcnt lgkmcnt(6)
  v_mfma_f32_16x16x32_bf16 v[68:71], v[20:23], v[172:175], v[68:71]
  ds_read_b64_tr_b16 v[36:37], v9 offset:4096
  buffer_load_dwordx4 v[160:163], v90, s[8:11], s36 offen sc1
  v_mfma_f32_16x16x32_bf16 v[52:55], v[20:23], v[168:171], v[52:55]
  ds_read_b64_tr_b16 v[38:39], v9 offset:4608
  v_add_u32 v9, 4294912256, v9
  s_waitcnt lgkmcnt(6)
  v_mfma_f32_16x16x32_bf16 v[56:59], v[24:27], v[168:171], v[56:59]
  ds_read_b64_tr_b16 v[40:41], v10 offset:4096
  v_mfma_f32_16x16x32_bf16 v[72:75], v[24:27], v[172:175], v[72:75]
  ds_read_b64_tr_b16 v[42:43], v10 offset:4608
  v_add_u32 v10, 4294912256, v10
  s_waitcnt lgkmcnt(6)
  v_mfma_f32_16x16x32_bf16 v[76:79], v[28:31], v[172:175], v[76:79]
  ds_read_b64_tr_b16 v[44:45], v11 offset:4096
  buffer_load_dwordx4 v[164:167], v91, s[8:11], s36 offen sc1
  v_mfma_f32_16x16x32_bf16 v[60:63], v[28:31], v[168:171], v[60:63]
  ds_read_b64_tr_b16 v[46:47], v11 offset:4608
  v_add_u32 v11, 4294912256, v11
  s_waitcnt vmcnt(13) lgkmcnt(6)
  v_mfma_f32_16x16x32_bf16 v[48:51], v[32:35], v[176:179], v[48:51]
  ds_read_b64_tr_b16 v[16:17], v8 offset:0
  s_bitcmp1_b32 s48, 7
  s_cselect_b32 s36, s50, s49
  s_waitcnt vmcnt(12)
  v_mfma_f32_16x16x32_bf16 v[64:67], v[32:35], v[180:183], v[64:67]
  ds_read_b64_tr_b16 v[18:19], v8 offset:512
  s_add_u32 s36, s36, 57344
  s_waitcnt lgkmcnt(6)
  v_mfma_f32_16x16x32_bf16 v[68:71], v[36:39], v[180:183], v[68:71]
  ds_read_b64_tr_b16 v[20:21], v9 offset:0
  v_mfma_f32_16x16x32_bf16 v[52:55], v[36:39], v[176:179], v[52:55]
  ds_read_b64_tr_b16 v[22:23], v9 offset:512
  s_waitcnt lgkmcnt(6)
  v_mfma_f32_16x16x32_bf16 v[56:59], v[40:43], v[176:179], v[56:59]
  ds_read_b64_tr_b16 v[24:25], v10 offset:0
  buffer_load_dwordx4 v[168:171], v88, s[8:11], s36 offen sc1
  v_mfma_f32_16x16x32_bf16 v[72:75], v[40:43], v[180:183], v[72:75]
  ds_read_b64_tr_b16 v[26:27], v10 offset:512
  s_waitcnt lgkmcnt(6)
  v_mfma_f32_16x16x32_bf16 v[76:79], v[44:47], v[180:183], v[76:79]
  ds_read_b64_tr_b16 v[28:29], v11 offset:0
  v_mfma_f32_16x16x32_bf16 v[60:63], v[44:47], v[176:179], v[60:63]
  ds_read_b64_tr_b16 v[30:31], v11 offset:512
  buffer_load_dwordx4 v[172:175], v89, s[8:11], s36 offen sc1
  s_waitcnt vmcnt(13) lgkmcnt(6)
  v_mfma_f32_16x16x32_bf16 v[48:51], v[16:19], v[120:123], v[48:51]
  ds_read_b64_tr_b16 v[32:33], v8 offset:4096
  s_waitcnt vmcnt(12)
  v_mfma_f32_16x16x32_bf16 v[64:67], v[16:19], v[124:127], v[64:67]
  ds_read_b64_tr_b16 v[34:35], v8 offset:4608
  v_add_u32 v8, 8192, v8
  s_waitcnt lgkmcnt(6)
  v_mfma_f32_16x16x32_bf16 v[68:71], v[20:23], v[124:127], v[68:71]
  ds_read_b64_tr_b16 v[36:37], v9 offset:4096
  buffer_load_dwordx4 v[176:179], v90, s[8:11], s36 offen sc1
  v_mfma_f32_16x16x32_bf16 v[52:55], v[20:23], v[120:123], v[52:55]
  ds_read_b64_tr_b16 v[38:39], v9 offset:4608
  v_add_u32 v9, 8192, v9
  s_waitcnt lgkmcnt(6)
  v_mfma_f32_16x16x32_bf16 v[56:59], v[24:27], v[120:123], v[56:59]
  ds_read_b64_tr_b16 v[40:41], v10 offset:4096
  v_mfma_f32_16x16x32_bf16 v[72:75], v[24:27], v[124:127], v[72:75]
  ds_read_b64_tr_b16 v[42:43], v10 offset:4608
  v_add_u32 v10, 8192, v10
  s_waitcnt lgkmcnt(6)
  v_mfma_f32_16x16x32_bf16 v[76:79], v[28:31], v[124:127], v[76:79]
  ds_read_b64_tr_b16 v[44:45], v11 offset:4096
  buffer_load_dwordx4 v[180:183], v91, s[8:11], s36 offen sc1
  v_mfma_f32_16x16x32_bf16 v[60:63], v[28:31], v[120:123], v[60:63]
  ds_read_b64_tr_b16 v[46:47], v11 offset:4608
  v_add_u32 v11, 8192, v11
  s_waitcnt vmcnt(13) lgkmcnt(6)
  v_mfma_f32_16x16x32_bf16 v[48:51], v[32:35], v[128:131], v[48:51]
  ds_read_b64_tr_b16 v[16:17], v8 offset:0
  s_mov_b32 s49, s50
  s_add_u32 s50, s50, 65536
  s_waitcnt vmcnt(12)
  v_mfma_f32_16x16x32_bf16 v[64:67], v[32:35], v[132:135], v[64:67]
  ds_read_b64_tr_b16 v[18:19], v8 offset:512
  s_cmp_eq_u32 s50, s41
  s_cselect_b32 s50, s34, s50
  s_waitcnt lgkmcnt(6)
  v_mfma_f32_16x16x32_bf16 v[68:71], v[36:39], v[132:135], v[68:71]
  ds_read_b64_tr_b16 v[20:21], v9 offset:0
  s_bitcmp1_b32 s48, 0
  s_cselect_b32 s36, s50, s49
  v_mfma_f32_16x16x32_bf16 v[52:55], v[36:39], v[128:131], v[52:55]
  ds_read_b64_tr_b16 v[22:23], v9 offset:512
  s_add_u32 s36, s36, 0
  s_waitcnt lgkmcnt(6)
  v_mfma_f32_16x16x32_bf16 v[56:59], v[40:43], v[128:131], v[56:59]
  ds_read_b64_tr_b16 v[24:25], v10 offset:0
  buffer_load_dwordx4 v[120:123], v88, s[8:11], s36 offen sc1
  v_mfma_f32_16x16x32_bf16 v[72:75], v[40:43], v[132:135], v[72:75]
  ds_read_b64_tr_b16 v[26:27], v10 offset:512
  s_waitcnt lgkmcnt(6)
  v_mfma_f32_16x16x32_bf16 v[76:79], v[44:47], v[132:135], v[76:79]
  ds_read_b64_tr_b16 v[28:29], v11 offset:0
  v_mfma_f32_16x16x32_bf16 v[60:63], v[44:47], v[128:131], v[60:63]
  ds_read_b64_tr_b16 v[30:31], v11 offset:512
  buffer_load_dwordx4 v[124:127], v89, s[8:11], s36 offen sc1
  s_waitcnt vmcnt(13) lgkmcnt(6)
  v_mfma_f32_16x16x32_bf16 v[48:51], v[16:19], v[136:139], v[48:51]
  ds_read_b64_tr_b16 v[32:33], v8 offset:4096
  s_waitcnt vmcnt(12)
  v_mfma_f32_16x16x32_bf16 v[64:67], v[16:19], v[140:143], v[64:67]
  ds_read_b64_tr_b16 v[34:35], v8 offset:4608
  v_add_u32 v8, 8192, v8
  s_waitcnt lgkmcnt(6)
  v_mfma_f32_16x16x32_bf16 v[68:71], v[20:23], v[140:143], v[68:71]
  ds_read_b64_tr_b16 v[36:37], v9 offset:4096
  buffer_load_dwordx4 v[128:131], v90, s[8:11], s36 offen sc1
  v_mfma_f32_16x16x32_bf16 v[52:55], v[20:23], v[136:139], v[52:55]
  ds_read_b64_tr_b16 v[38:39], v9 offset:4608
  v_add_u32 v9, 8192, v9
  s_waitcnt lgkmcnt(6)
  v_mfma_f32_16x16x32_bf16 v[56:59], v[24:27], v[136:139], v[56:59]
  ds_read_b64_tr_b16 v[40:41], v10 offset:4096
  v_mfma_f32_16x16x32_bf16 v[72:75], v[24:27], v[140:143], v[72:75]
  ds_read_b64_tr_b16 v[42:43], v10 offset:4608
  v_add_u32 v10, 8192, v10
  s_waitcnt lgkmcnt(6)
  v_mfma_f32_16x16x32_bf16 v[76:79], v[28:31], v[140:143], v[76:79]
  ds_read_b64_tr_b16 v[44:45], v11 offset:4096
  buffer_load_dwordx4 v[132:135], v91, s[8:11], s36 offen sc1
  v_mfma_f32_16x16x32_bf16 v[60:63], v[28:31], v[136:139], v[60:63]
  ds_read_b64_tr_b16 v[46:47], v11 offset:4608
  v_add_u32 v11, 8192, v11
  s_waitcnt vmcnt(13) lgkmcnt(6)
  v_mfma_f32_16x16x32_bf16 v[48:51], v[32:35], v[144:147], v[48:51]
  ds_read_b64_tr_b16 v[16:17], v8 offset:0
  s_bitcmp1_b32 s48, 1
  s_cselect_b32 s36, s50, s49
  s_waitcnt vmcnt(12)
  v_mfma_f32_16x16x32_bf16 v[64:67], v[32:35], v[148:151], v[64:67]
  ds_read_b64_tr_b16 v[18:19], v8 offset:512
  s_add_u32 s36, s36, 8192
  s_waitcnt lgkmcnt(6)
  v_mfma_f32_16x16x32_bf16 v[68:71], v[36:39], v[148:151], v[68:71]
  ds_read_b64_tr_b16 v[20:21], v9 offset:0
  v_mfma_f32_16x16x32_bf16 v[52:55], v[36:39], v[144:147], v[52:55]
  ds_read_b64_tr_b16 v[22:23], v9 offset:512
  s_waitcnt lgkmcnt(6)
  v_mfma_f32_16x16x32_bf16 v[56:59], v[40:43], v[144:147], v[56:59]
  ds_read_b64_tr_b16 v[24:25], v10 offset:0
  buffer_load_dwordx4 v[136:139], v88, s[8:11], s36 offen sc1
  v_mfma_f32_16x16x32_bf16 v[72:75], v[40:43], v[148:151], v[72:75]
  ds_read_b64_tr_b16 v[26:27], v10 offset:512
  s_waitcnt lgkmcnt(6)
  v_mfma_f32_16x16x32_bf16 v[76:79], v[44:47], v[148:151], v[76:79]
  ds_read_b64_tr_b16 v[28:29], v11 offset:0
  v_mfma_f32_16x16x32_bf16 v[60:63], v[44:47], v[144:147], v[60:63]
  ds_read_b64_tr_b16 v[30:31], v11 offset:512
  buffer_load_dwordx4 v[140:143], v89, s[8:11], s36 offen sc1
  s_waitcnt vmcnt(13) lgkmcnt(6)
  v_mfma_f32_16x16x32_bf16 v[48:51], v[16:19], v[152:155], v[48:51]
  ds_read_b64_tr_b16 v[32:33], v8 offset:4096
  s_waitcnt vmcnt(12)
  v_mfma_f32_16x16x32_bf16 v[64:67], v[16:19], v[156:159], v[64:67]
  ds_read_b64_tr_b16 v[34:35], v8 offset:4608
  v_add_u32 v8, 4294850304, v8
  s_waitcnt lgkmcnt(6)
  v_mfma_f32_16x16x32_bf16 v[68:71], v[20:23], v[156:159], v[68:71]
  ds_read_b64_tr_b16 v[36:37], v9 offset:4096
  buffer_load_dwordx4 v[144:147], v90, s[8:11], s36 offen sc1
  v_mfma_f32_16x16x32_bf16 v[52:55], v[20:23], v[152:155], v[52:55]
  ds_read_b64_tr_b16 v[38:39], v9 offset:4608
  v_add_u32 v9, 4294850304, v9
  s_waitcnt lgkmcnt(6)
  v_mfma_f32_16x16x32_bf16 v[56:59], v[24:27], v[152:155], v[56:59]
  ds_read_b64_tr_b16 v[40:41], v10 offset:4096
  v_mfma_f32_16x16x32_bf16 v[72:75], v[24:27], v[156:159], v[72:75]
  ds_read_b64_tr_b16 v[42:43], v10 offset:4608
  v_add_u32 v10, 4294850304, v10
  s_waitcnt lgkmcnt(6)
  v_mfma_f32_16x16x32_bf16 v[76:79], v[28:31], v[156:159], v[76:79]
  ds_read_b64_tr_b16 v[44:45], v11 offset:4096
  buffer_load_dwordx4 v[148:151], v91, s[8:11], s36 offen sc1
  v_mfma_f32_16x16x32_bf16 v[60:63], v[28:31], v[152:155], v[60:63]
  ds_read_b64_tr_b16 v[46:47], v11 offset:4608
  v_add_u32 v11, 4294850304, v11
  s_waitcnt vmcnt(13) lgkmcnt(6)
  v_mfma_f32_16x16x32_bf16 v[48:51], v[32:35], v[160:163], v[48:51]
  ds_read_b64_tr_b16 v[16:17], v8 offset:0
  s_bitcmp1_b32 s48, 2
  s_cselect_b32 s36, s50, s49
  s_waitcnt vmcnt(12)
  v_mfma_f32_16x16x32_bf16 v[64:67], v[32:35], v[164:167], v[64:67]
  ds_read_b64_tr_b16 v[18:19], v8 offset:512
  s_add_u32 s36, s36, 16384
  s_waitcnt lgkmcnt(6)
  v_mfma_f32_16x16x32_bf16 v[68:71], v[36:39], v[164:167], v[68:71]
  ds_read_b64_tr_b16 v[20:21], v9 offset:0
  v_mfma_f32_16x16x32_bf16 v[52:55], v[36:39], v[160:163], v[52:55]
  ds_read_b64_tr_b16 v[22:23], v9 offset:512
  s_waitcnt lgkmcnt(6)
  v_mfma_f32_16x16x32_bf16 v[56:59], v[40:43], v[160:163], v[56:59]
  ds_read_b64_tr_b16 v[24:25], v10 offset:0
  buffer_load_dwordx4 v[152:155], v88, s[8:11], s36 offen sc1
  v_mfma_f32_16x16x32_bf16 v[72:75], v[40:43], v[164:167], v[72:75]
  ds_read_b64_tr_b16 v[26:27], v10 offset:512
  s_waitcnt lgkmcnt(6)
  v_mfma_f32_16x16x32_bf16 v[76:79], v[44:47], v[164:167], v[76:79]
  ds_read_b64_tr_b16 v[28:29], v11 offset:0
  v_mfma_f32_16x16x32_bf16 v[60:63], v[44:47], v[160:163], v[60:63]
  ds_read_b64_tr_b16 v[30:31], v11 offset:512
  buffer_load_dwordx4 v[156:159], v89, s[8:11], s36 offen sc1
  s_waitcnt vmcnt(13) lgkmcnt(6)
  v_mfma_f32_16x16x32_bf16 v[48:51], v[16:19], v[168:171], v[48:51]
  ds_read_b64_tr_b16 v[32:33], v8 offset:4096
  s_waitcnt vmcnt(12)
  v_mfma_f32_16x16x32_bf16 v[64:67], v[16:19], v[172:175], v[64:67]
  ds_read_b64_tr_b16 v[34:35], v8 offset:4608
  v_add_u32 v8, 8192, v8
  s_waitcnt lgkmcnt(6)
  v_mfma_f32_16x16x32_bf16 v[68:71], v[20:23], v[172:175], v[68:71]
  ds_read_b64_tr_b16 v[36:37], v9 offset:4096
  buffer_load_dwordx4 v[160:163], v90, s[8:11], s36 offen sc1
  v_mfma_f32_16x16x32_bf16 v[52:55], v[20:23], v[168:171], v[52:55]
  ds_read_b64_tr_b16 v[38:39], v9 offset:4608
  v_add_u32 v9, 8192, v9
  s_waitcnt lgkmcnt(6)
  v_mfma_f32_16x16x32_bf16 v[56:59], v[24:27], v[168:171], v[56:59]
  ds_read_b64_tr_b16 v[40:41], v10 offset:4096
  v_mfma_f32_16x16x32_bf16 v[72:75], v[24:27], v[172:175], v[72:75]
  ds_read_b64_tr_b16 v[42:43], v10 offset:4608
  v_add_u32 v10, 8192, v10
  s_waitcnt lgkmcnt(6)
  v_mfma_f32_16x16x32_bf16 v[76:79], v[28:31], v[172:175], v[76:79]
  ds_read_b64_tr_b16 v[44:45], v11 offset:4096
  buffer_load_dwordx4 v[164:167], v91, s[8:11], s36 offen sc1
  v_mfma_f32_16x16x32_bf16 v[60:63], v[28:31], v[168:171], v[60:63]
  ds_read_b64_tr_b16 v[46:47], v11 offset:4608
  v_add_u32 v11, 8192, v11
  s_waitcnt vmcnt(13) lgkmcnt(6)
  v_mfma_f32_16x16x32_bf16 v[48:51], v[32:35], v[176:179], v[48:51]
  ds_read_b64_tr_b16 v[16:17], v8 offset:0
  s_bitcmp1_b32 s48, 3
  s_cselect_b32 s36, s50, s49
  s_waitcnt vmcnt(12)
  v_mfma_f32_16x16x32_bf16 v[64:67], v[32:35], v[180:183], v[64:67]
  ds_read_b64_tr_b16 v[18:19], v8 offset:512
  s_add_u32 s36, s36, 24576
  s_waitcnt lgkmcnt(6)
  v_mfma_f32_16x16x32_bf16 v[68:71], v[36:39], v[180:183], v[68:71]
  ds_read_b64_tr_b16 v[20:21], v9 offset:0
  v_mfma_f32_16x16x32_bf16 v[52:55], v[36:39], v[176:179], v[52:55]
  ds_read_b64_tr_b16 v[22:23], v9 offset:512
  s_waitcnt lgkmcnt(6)
  v_mfma_f32_16x16x32_bf16 v[56:59], v[40:43], v[176:179], v[56:59]
  ds_read_b64_tr_b16 v[24:25], v10 offset:0
  buffer_load_dwordx4 v[168:171], v88, s[8:11], s36 offen sc1
  v_mfma_f32_16x16x32_bf16 v[72:75], v[40:43], v[180:183], v[72:75]
  ds_read_b64_tr_b16 v[26:27], v10 offset:512
  s_waitcnt lgkmcnt(6)
  v_mfma_f32_16x16x32_bf16 v[76:79], v[44:47], v[180:183], v[76:79]
  ds_read_b64_tr_b16 v[28:29], v11 offset:0
  v_mfma_f32_16x16x32_bf16 v[60:63], v[44:47], v[176:179], v[60:63]
  ds_read_b64_tr_b16 v[30:31], v11 offset:512
  buffer_load_dwordx4 v[172:175], v89, s[8:11], s36 offen sc1
  s_waitcnt vmcnt(13) lgkmcnt(6)
  v_mfma_f32_16x16x32_bf16 v[48:51], v[16:19], v[120:123], v[48:51]
  ds_read_b64_tr_b16 v[32:33], v8 offset:4096
  s_waitcnt vmcnt(12)
  v_mfma_f32_16x16x32_bf16 v[64:67], v[16:19], v[124:127], v[64:67]
  ds_read_b64_tr_b16 v[34:35], v8 offset:4608
  v_add_u32 v8, 8192, v8
  s_waitcnt lgkmcnt(6)
  v_mfma_f32_16x16x32_bf16 v[68:71], v[20:23], v[124:127], v[68:71]
  ds_read_b64_tr_b16 v[36:37], v9 offset:4096
  buffer_load_dwordx4 v[176:179], v90, s[8:11], s36 offen sc1
  v_mfma_f32_16x16x32_bf16 v[52:55], v[20:23], v[120:123], v[52:55]
  ds_read_b64_tr_b16 v[38:39], v9 offset:4608
  v_add_u32 v9, 8192, v9
  s_waitcnt lgkmcnt(6)
  v_mfma_f32_16x16x32_bf16 v[56:59], v[24:27], v[120:123], v[56:59]
  ds_read_b64_tr_b16 v[40:41], v10 offset:4096
  v_mfma_f32_16x16x32_bf16 v[72:75], v[24:27], v[124:127], v[72:75]
  ds_read_b64_tr_b16 v[42:43], v10 offset:4608
  v_add_u32 v10, 8192, v10
  s_waitcnt lgkmcnt(6)
  v_mfma_f32_16x16x32_bf16 v[76:79], v[28:31], v[124:127], v[76:79]
  ds_read_b64_tr_b16 v[44:45], v11 offset:4096
  buffer_load_dwordx4 v[180:183], v91, s[8:11], s36 offen sc1
  v_mfma_f32_16x16x32_bf16 v[60:63], v[28:31], v[120:123], v[60:63]
  ds_read_b64_tr_b16 v[46:47], v11 offset:4608
  v_add_u32 v11, 8192, v11
  s_waitcnt vmcnt(13) lgkmcnt(6)
  v_mfma_f32_16x16x32_bf16 v[48:51], v[32:35], v[128:131], v[48:51]
  ds_read_b64_tr_b16 v[16:17], v8 offset:0
  s_bitcmp1_b32 s48, 4
  s_cselect_b32 s36, s50, s49
  s_waitcnt vmcnt(12)
  v_mfma_f32_16x16x32_bf16 v[64:67], v[32:35], v[132:135], v[64:67]
  ds_read_b64_tr_b16 v[18:19], v8 offset:512
  s_add_u32 s36, s36, 32768
  s_waitcnt lgkmcnt(6)
  v_mfma_f32_16x16x32_bf16 v[68:71], v[36:39], v[132:135], v[68:71]
  ds_read_b64_tr_b16 v[20:21], v9 offset:0
  v_mfma_f32_16x16x32_bf16 v[52:55], v[36:39], v[128:131], v[52:55]
  ds_read_b64_tr_b16 v[22:23], v9 offset:512
  s_waitcnt lgkmcnt(6)
  v_mfma_f32_16x16x32_bf16 v[56:59], v[40:43], v[128:131], v[56:59]
  ds_read_b64_tr_b16 v[24:25], v10 offset:0
  buffer_load_dwordx4 v[120:123], v88, s[8:11], s36 offen sc1
  v_mfma_f32_16x16x32_bf16 v[72:75], v[40:43], v[132:135], v[72:75]
  ds_read_b64_tr_b16 v[26:27], v10 offset:512
  s_waitcnt lgkmcnt(6)
  v_mfma_f32_16x16x32_bf16 v[76:79], v[44:47], v[132:135], v[76:79]
  ds_read_b64_tr_b16 v[28:29], v11 offset:0
  v_mfma_f32_16x16x32_bf16 v[60:63], v[44:47], v[128:131], v[60:63]
  ds_read_b64_tr_b16 v[30:31], v11 offset:512
  buffer_load_dwordx4 v[124:127], v89, s[8:11], s36 offen sc1
  s_waitcnt vmcnt(13) lgkmcnt(6)
  v_mfma_f32_16x16x32_bf16 v[48:51], v[16:19], v[136:139], v[48:51]
  ds_read_b64_tr_b16 v[32:33], v8 offset:4096
  s_waitcnt vmcnt(12)
  v_mfma_f32_16x16x32_bf16 v[64:67], v[16:19], v[140:143], v[64:67]
  ds_read_b64_tr_b16 v[34:35], v8 offset:4608
  v_add_u32 v8, 8192, v8
  s_waitcnt lgkmcnt(6)
  v_mfma_f32_16x16x32_bf16 v[68:71], v[20:23], v[140:143], v[68:71]
  ds_read_b64_tr_b16 v[36:37], v9 offset:4096
  buffer_load_dwordx4 v[128:131], v90, s[8:11], s36 offen sc1
  v_mfma_f32_16x16x32_bf16 v[52:55], v[20:23], v[136:139], v[52:55]
  ds_read_b64_tr_b16 v[38:39], v9 offset:4608
  v_add_u32 v9, 8192, v9
  s_waitcnt lgkmcnt(6)
  v_mfma_f32_16x16x32_bf16 v[56:59], v[24:27], v[136:139], v[56:59]
  ds_read_b64_tr_b16 v[40:41], v10 offset:4096
  v_mfma_f32_16x16x32_bf16 v[72:75], v[24:27], v[140:143], v[72:75]
  ds_read_b64_tr_b16 v[42:43], v10 offset:4608
  v_add_u32 v10, 8192, v10
  s_waitcnt lgkmcnt(6)
  v_mfma_f32_16x16x32_bf16 v[76:79], v[28:31], v[140:143], v[76:79]
  ds_read_b64_tr_b16 v[44:45], v11 offset:4096
  buffer_load_dwordx4 v[132:135], v91, s[8:11], s36 offen sc1
  v_mfma_f32_16x16x32_bf16 v[60:63], v[28:31], v[136:139], v[60:63]
  ds_read_b64_tr_b16 v[46:47], v11 offset:4608
  v_add_u32 v11, 8192, v11
  s_waitcnt vmcnt(13) lgkmcnt(6)
  v_mfma_f32_16x16x32_bf16 v[48:51], v[32:35], v[144:147], v[48:51]
  ds_read_b64_tr_b16 v[16:17], v8 offset:0
  s_bitcmp1_b32 s48, 5
  s_cselect_b32 s36, s50, s49
  s_waitcnt vmcnt(12)
  v_mfma_f32_16x16x32_bf16 v[64:67], v[32:35], v[148:151], v[64:67]
  ds_read_b64_tr_b16 v[18:19], v8 offset:512
  s_add_u32 s36, s36, 40960
  s_waitcnt lgkmcnt(6)
  v_mfma_f32_16x16x32_bf16 v[68:71], v[36:39], v[148:151], v[68:71]
  ds_read_b64_tr_b16 v[20:21], v9 offset:0
  v_mfma_f32_16x16x32_bf16 v[52:55], v[36:39], v[144:147], v[52:55]
  ds_read_b64_tr_b16 v[22:23], v9 offset:512
  s_waitcnt lgkmcnt(6)
  v_mfma_f32_16x16x32_bf16 v[56:59], v[40:43], v[144:147], v[56:59]
  ds_read_b64_tr_b16 v[24:25], v10 offset:0
  buffer_load_dwordx4 v[136:139], v88, s[8:11], s36 offen sc1
  v_mfma_f32_16x16x32_bf16 v[72:75], v[40:43], v[148:151], v[72:75]
  ds_read_b64_tr_b16 v[26:27], v10 offset:512
  s_waitcnt lgkmcnt(6)
  v_mfma_f32_16x16x32_bf16 v[76:79], v[44:47], v[148:151], v[76:79]
  ds_read_b64_tr_b16 v[28:29], v11 offset:0
  v_mfma_f32_16x16x32_bf16 v[60:63], v[44:47], v[144:147], v[60:63]
  ds_read_b64_tr_b16 v[30:31], v11 offset:512
  buffer_load_dwordx4 v[140:143], v89, s[8:11], s36 offen sc1
  s_waitcnt vmcnt(13) lgkmcnt(6)
  v_mfma_f32_16x16x32_bf16 v[48:51], v[16:19], v[152:155], v[48:51]
  ds_read_b64_tr_b16 v[32:33], v8 offset:4096
  s_waitcnt vmcnt(12)
  v_mfma_f32_16x16x32_bf16 v[64:67], v[16:19], v[156:159], v[64:67]
  ds_read_b64_tr_b16 v[34:35], v8 offset:4608
  v_add_u32 v8, 8192, v8
  s_waitcnt lgkmcnt(6)
  v_mfma_f32_16x16x32_bf16 v[68:71], v[20:23], v[156:159], v[68:71]
  ds_read_b64_tr_b16 v[36:37], v9 offset:4096
  buffer_load_dwordx4 v[144:147], v90, s[8:11], s36 offen sc1
  v_mfma_f32_16x16x32_bf16 v[52:55], v[20:23], v[152:155], v[52:55]
  ds_read_b64_tr_b16 v[38:39], v9 offset:4608
  v_add_u32 v9, 8192, v9
  s_waitcnt lgkmcnt(6)
  v_mfma_f32_16x16x32_bf16 v[56:59], v[24:27], v[152:155], v[56:59]
  ds_read_b64_tr_b16 v[40:41], v10 offset:4096
  v_mfma_f32_16x16x32_bf16 v[72:75], v[24:27], v[156:159], v[72:75]
  ds_read_b64_tr_b16 v[42:43], v10 offset:4608
  v_add_u32 v10, 8192, v10
  s_waitcnt lgkmcnt(6)
  v_mfma_f32_16x16x32_bf16 v[76:79], v[28:31], v[156:159], v[76:79]
  ds_read_b64_tr_b16 v[44:45], v11 offset:4096
  buffer_load_dwordx4 v[148:151], v91, s[8:11], s36 offen sc1
  v_mfma_f32_16x16x32_bf16 v[60:63], v[28:31], v[152:155], v[60:63]
  ds_read_b64_tr_b16 v[46:47], v11 offset:4608
  v_add_u32 v11, 8192, v11
  s_waitcnt vmcnt(13) lgkmcnt(6)
  v_mfma_f32_16x16x32_bf16 v[48:51], v[32:35], v[160:163], v[48:51]
  ds_read_b64_tr_b16 v[16:17], v8 offset:0
  s_bitcmp1_b32 s48, 6
  s_cselect_b32 s36, s50, s49
  s_waitcnt vmcnt(12)
  v_mfma_f32_16x16x32_bf16 v[64:67], v[32:35], v[164:167], v[64:67]
  ds_read_b64_tr_b16 v[18:19], v8 offset:512
  s_add_u32 s36, s36, 49152
  s_waitcnt lgkmcnt(6)
  v_mfma_f32_16x16x32_bf16 v[68:71], v[36:39], v[164:167], v[68:71]
  ds_read_b64_tr_b16 v[20:21], v9 offset:0
  v_mfma_f32_16x16x32_bf16 v[52:55], v[36:39], v[160:163], v[52:55]
  ds_read_b64_tr_b16 v[22:23], v9 offset:512
  s_waitcnt lgkmcnt(6)
  v_mfma_f32_16x16x32_bf16 v[56:59], v[40:43], v[160:163], v[56:59]
  ds_read_b64_tr_b16 v[24:25], v10 offset:0
  buffer_load_dwordx4 v[152:155], v88, s[8:11], s36 offen sc1
  v_mfma_f32_16x16x32_bf16 v[72:75], v[40:43], v[164:167], v[72:75]
  ds_read_b64_tr_b16 v[26:27], v10 offset:512
  s_waitcnt lgkmcnt(6)
  v_mfma_f32_16x16x32_bf16 v[76:79], v[44:47], v[164:167], v[76:79]
  ds_read_b64_tr_b16 v[28:29], v11 offset:0
  v_mfma_f32_16x16x32_bf16 v[60:63], v[44:47], v[160:163], v[60:63]
  ds_read_b64_tr_b16 v[30:31], v11 offset:512
  buffer_load_dwordx4 v[156:159], v89, s[8:11], s36 offen sc1
  s_waitcnt vmcnt(13) lgkmcnt(6)
  v_mfma_f32_16x16x32_bf16 v[48:51], v[16:19], v[168:171], v[48:51]
  ds_read_b64_tr_b16 v[32:33], v8 offset:4096
  s_waitcnt vmcnt(12)
  v_mfma_f32_16x16x32_bf16 v[64:67], v[16:19], v[172:175], v[64:67]
  ds_read_b64_tr_b16 v[34:35], v8 offset:4608
  v_add_u32 v8, 10240, v8
  s_waitcnt lgkmcnt(6)
  v_mfma_f32_16x16x32_bf16 v[68:71], v[20:23], v[172:175], v[68:71]
  ds_read_b64_tr_b16 v[36:37], v9 offset:4096
  buffer_load_dwordx4 v[160:163], v90, s[8:11], s36 offen sc1
  v_mfma_f32_16x16x32_bf16 v[52:55], v[20:23], v[168:171], v[52:55]
  ds_read_b64_tr_b16 v[38:39], v9 offset:4608
  v_add_u32 v9, 10240, v9
  s_waitcnt lgkmcnt(6)
  v_mfma_f32_16x16x32_bf16 v[56:59], v[24:27], v[168:171], v[56:59]
  ds_read_b64_tr_b16 v[40:41], v10 offset:4096
  v_mfma_f32_16x16x32_bf16 v[72:75], v[24:27], v[172:175], v[72:75]
  ds_read_b64_tr_b16 v[42:43], v10 offset:4608
  v_add_u32 v10, 10240, v10
  s_waitcnt lgkmcnt(6)
  v_mfma_f32_16x16x32_bf16 v[76:79], v[28:31], v[172:175], v[76:79]
  ds_read_b64_tr_b16 v[44:45], v11 offset:4096
  buffer_load_dwordx4 v[164:167], v91, s[8:11], s36 offen sc1
  v_mfma_f32_16x16x32_bf16 v[60:63], v[28:31], v[168:171], v[60:63]
  ds_read_b64_tr_b16 v[46:47], v11 offset:4608
  v_add_u32 v11, 10240, v11
  s_waitcnt vmcnt(13) lgkmcnt(6)
  v_mfma_f32_16x16x32_bf16 v[48:51], v[32:35], v[176:179], v[48:51]
  ds_read_b64_tr_b16 v[16:17], v8 offset:0
  s_bitcmp1_b32 s48, 7
  s_cselect_b32 s36, s50, s49
  s_waitcnt vmcnt(12)
  v_mfma_f32_16x16x32_bf16 v[64:67], v[32:35], v[180:183], v[64:67]
  ds_read_b64_tr_b16 v[18:19], v8 offset:512
  s_add_u32 s36, s36, 57344
  s_waitcnt lgkmcnt(6)
  v_mfma_f32_16x16x32_bf16 v[68:71], v[36:39], v[180:183], v[68:71]
  ds_read_b64_tr_b16 v[20:21], v9 offset:0
  v_mfma_f32_16x16x32_bf16 v[52:55], v[36:39], v[176:179], v[52:55]
  ds_read_b64_tr_b16 v[22:23], v9 offset:512
  s_waitcnt lgkmcnt(6)
  v_mfma_f32_16x16x32_bf16 v[56:59], v[40:43], v[176:179], v[56:59]
  ds_read_b64_tr_b16 v[24:25], v10 offset:0
  buffer_load_dwordx4 v[168:171], v88, s[8:11], s36 offen sc1
  v_mfma_f32_16x16x32_bf16 v[72:75], v[40:43], v[180:183], v[72:75]
  ds_read_b64_tr_b16 v[26:27], v10 offset:512
  s_waitcnt lgkmcnt(6)
  v_mfma_f32_16x16x32_bf16 v[76:79], v[44:47], v[180:183], v[76:79]
  ds_read_b64_tr_b16 v[28:29], v11 offset:0
  v_mfma_f32_16x16x32_bf16 v[60:63], v[44:47], v[176:179], v[60:63]
  ds_read_b64_tr_b16 v[30:31], v11 offset:512
  buffer_load_dwordx4 v[172:175], v89, s[8:11], s36 offen sc1
  s_waitcnt vmcnt(13) lgkmcnt(6)
  v_mfma_f32_16x16x32_bf16 v[48:51], v[16:19], v[120:123], v[48:51]
  ds_read_b64_tr_b16 v[32:33], v8 offset:4096
  s_waitcnt vmcnt(12)
  v_mfma_f32_16x16x32_bf16 v[64:67], v[16:19], v[124:127], v[64:67]
  ds_read_b64_tr_b16 v[34:35], v8 offset:4608
  v_add_u32 v8, 8192, v8
  s_waitcnt lgkmcnt(6)
  v_mfma_f32_16x16x32_bf16 v[68:71], v[20:23], v[124:127], v[68:71]
  ds_read_b64_tr_b16 v[36:37], v9 offset:4096
  buffer_load_dwordx4 v[176:179], v90, s[8:11], s36 offen sc1
  v_mfma_f32_16x16x32_bf16 v[52:55], v[20:23], v[120:123], v[52:55]
  ds_read_b64_tr_b16 v[38:39], v9 offset:4608
  v_add_u32 v9, 8192, v9
  s_waitcnt lgkmcnt(6)
  v_mfma_f32_16x16x32_bf16 v[56:59], v[24:27], v[120:123], v[56:59]
  ds_read_b64_tr_b16 v[40:41], v10 offset:4096
  v_mfma_f32_16x16x32_bf16 v[72:75], v[24:27], v[124:127], v[72:75]
  ds_read_b64_tr_b16 v[42:43], v10 offset:4608
  v_add_u32 v10, 8192, v10
  s_waitcnt lgkmcnt(6)
  v_mfma_f32_16x16x32_bf16 v[76:79], v[28:31], v[124:127], v[76:79]
  ds_read_b64_tr_b16 v[44:45], v11 offset:4096
  buffer_load_dwordx4 v[180:183], v91, s[8:11], s36 offen sc1
  v_mfma_f32_16x16x32_bf16 v[60:63], v[28:31], v[120:123], v[60:63]
  ds_read_b64_tr_b16 v[46:47], v11 offset:4608
  v_add_u32 v11, 8192, v11
  s_waitcnt vmcnt(13) lgkmcnt(6)
  v_mfma_f32_16x16x32_bf16 v[48:51], v[32:35], v[128:131], v[48:51]
  ds_read_b64_tr_b16 v[16:17], v8 offset:0
  s_waitcnt vmcnt(12)
  v_mfma_f32_16x16x32_bf16 v[64:67], v[32:35], v[132:135], v[64:67]
  ds_read_b64_tr_b16 v[18:19], v8 offset:512
  s_waitcnt lgkmcnt(6)
  v_mfma_f32_16x16x32_bf16 v[68:71], v[36:39], v[132:135], v[68:71]
  ds_read_b64_tr_b16 v[20:21], v9 offset:0
  v_mfma_f32_16x16x32_bf16 v[52:55], v[36:39], v[128:131], v[52:55]
  ds_read_b64_tr_b16 v[22:23], v9 offset:512
  s_waitcnt lgkmcnt(6)
  v_mfma_f32_16x16x32_bf16 v[56:59], v[40:43], v[128:131], v[56:59]
  ds_read_b64_tr_b16 v[24:25], v10 offset:0
  v_mfma_f32_16x16x32_bf16 v[72:75], v[40:43], v[132:135], v[72:75]
  ds_read_b64_tr_b16 v[26:27], v10 offset:512
  s_waitcnt lgkmcnt(6)
  v_mfma_f32_16x16x32_bf16 v[76:79], v[44:47], v[132:135], v[76:79]
  ds_read_b64_tr_b16 v[28:29], v11 offset:0
  v_mfma_f32_16x16x32_bf16 v[60:63], v[44:47], v[128:131], v[60:63]
  ds_read_b64_tr_b16 v[30:31], v11 offset:512
  s_waitcnt vmcnt(11) lgkmcnt(6)
  v_mfma_f32_16x16x32_bf16 v[48:51], v[16:19], v[136:139], v[48:51]
  ds_read_b64_tr_b16 v[32:33], v8 offset:4096
  s_waitcnt vmcnt(10)
  v_mfma_f32_16x16x32_bf16 v[64:67], v[16:19], v[140:143], v[64:67]
  ds_read_b64_tr_b16 v[34:35], v8 offset:4608
  v_add_u32 v8, 8192, v8
  s_waitcnt lgkmcnt(6)
  v_mfma_f32_16x16x32_bf16 v[68:71], v[20:23], v[140:143], v[68:71]
  ds_read_b64_tr_b16 v[36:37], v9 offset:4096
  v_mfma_f32_16x16x32_bf16 v[52:55], v[20:23], v[136:139], v[52:55]
  ds_read_b64_tr_b16 v[38:39], v9 offset:4608
  v_add_u32 v9, 8192, v9
  s_waitcnt lgkmcnt(6)
  v_mfma_f32_16x16x32_bf16 v[56:59], v[24:27], v[136:139], v[56:59]
  ds_read_b64_tr_b16 v[40:41], v10 offset:4096
  v_mfma_f32_16x16x32_bf16 v[72:75], v[24:27], v[140:143], v[72:75]
  ds_read_b64_tr_b16 v[42:43], v10 offset:4608
  v_add_u32 v10, 8192, v10
  s_waitcnt lgkmcnt(6)
  v_mfma_f32_16x16x32_bf16 v[76:79], v[28:31], v[140:143], v[76:79]
  ds_read_b64_tr_b16 v[44:45], v11 offset:4096
  v_mfma_f32_16x16x32_bf16 v[60:63], v[28:31], v[136:139], v[60:63]
  ds_read_b64_tr_b16 v[46:47], v11 offset:4608
  v_add_u32 v11, 8192, v11
  s_waitcnt vmcnt(9) lgkmcnt(6)
  v_mfma_f32_16x16x32_bf16 v[48:51], v[32:35], v[144:147], v[48:51]
  ds_read_b64_tr_b16 v[16:17], v8 offset:0
  s_waitcnt vmcnt(8)
  v_mfma_f32_16x16x32_bf16 v[64:67], v[32:35], v[148:151], v[64:67]
  ds_read_b64_tr_b16 v[18:19], v8 offset:512
  s_waitcnt lgkmcnt(6)
  v_mfma_f32_16x16x32_bf16 v[68:71], v[36:39], v[148:151], v[68:71]
  ds_read_b64_tr_b16 v[20:21], v9 offset:0
  v_mfma_f32_16x16x32_bf16 v[52:55], v[36:39], v[144:147], v[52:55]
  ds_read_b64_tr_b16 v[22:23], v9 offset:512
  s_waitcnt lgkmcnt(6)
  v_mfma_f32_16x16x32_bf16 v[56:59], v[40:43], v[144:147], v[56:59]
  ds_read_b64_tr_b16 v[24:25], v10 offset:0
  v_mfma_f32_16x16x32_bf16 v[72:75], v[40:43], v[148:151], v[72:75]
  ds_read_b64_tr_b16 v[26:27], v10 offset:512
  s_waitcnt lgkmcnt(6)
  v_mfma_f32_16x16x32_bf16 v[76:79], v[44:47], v[148:151], v[76:79]
  ds_read_b64_tr_b16 v[28:29], v11 offset:0
  v_mfma_f32_16x16x32_bf16 v[60:63], v[44:47], v[144:147], v[60:63]
  ds_read_b64_tr_b16 v[30:31], v11 offset:512
  s_waitcnt vmcnt(7) lgkmcnt(6)
  v_mfma_f32_16x16x32_bf16 v[48:51], v[16:19], v[152:155], v[48:51]
  ds_read_b64_tr_b16 v[32:33], v8 offset:4096
  s_waitcnt vmcnt(6)
  v_mfma_f32_16x16x32_bf16 v[64:67], v[16:19], v[156:159], v[64:67]
  ds_read_b64_tr_b16 v[34:35], v8 offset:4608
  v_add_u32 v8, 8192, v8
  s_waitcnt lgkmcnt(6)
  v_mfma_f32_16x16x32_bf16 v[68:71], v[20:23], v[156:159], v[68:71]
  ds_read_b64_tr_b16 v[36:37], v9 offset:4096
  v_mfma_f32_16x16x32_bf16 v[52:55], v[20:23], v[152:155], v[52:55]
  ds_read_b64_tr_b16 v[38:39], v9 offset:4608
  v_add_u32 v9, 8192, v9
  s_waitcnt lgkmcnt(6)
  v_mfma_f32_16x16x32_bf16 v[56:59], v[24:27], v[152:155], v[56:59]
  ds_read_b64_tr_b16 v[40:41], v10 offset:4096
  v_mfma_f32_16x16x32_bf16 v[72:75], v[24:27], v[156:159], v[72:75]
  ds_read_b64_tr_b16 v[42:43], v10 offset:4608
  v_add_u32 v10, 8192, v10
  s_waitcnt lgkmcnt(6)
  v_mfma_f32_16x16x32_bf16 v[76:79], v[28:31], v[156:159], v[76:79]
  ds_read_b64_tr_b16 v[44:45], v11 offset:4096
  v_mfma_f32_16x16x32_bf16 v[60:63], v[28:31], v[152:155], v[60:63]
  ds_read_b64_tr_b16 v[46:47], v11 offset:4608
  v_add_u32 v11, 8192, v11
  s_waitcnt vmcnt(5) lgkmcnt(6)
  v_mfma_f32_16x16x32_bf16 v[48:51], v[32:35], v[160:163], v[48:51]
  ds_read_b64_tr_b16 v[16:17], v8 offset:0
  s_waitcnt vmcnt(4)
  v_mfma_f32_16x16x32_bf16 v[64:67], v[32:35], v[164:167], v[64:67]
  ds_read_b64_tr_b16 v[18:19], v8 offset:512
  s_waitcnt lgkmcnt(6)
  v_mfma_f32_16x16x32_bf16 v[68:71], v[36:39], v[164:167], v[68:71]
  ds_read_b64_tr_b16 v[20:21], v9 offset:0
  v_mfma_f32_16x16x32_bf16 v[52:55], v[36:39], v[160:163], v[52:55]
  ds_read_b64_tr_b16 v[22:23], v9 offset:512
  s_waitcnt lgkmcnt(6)
  v_mfma_f32_16x16x32_bf16 v[56:59], v[40:43], v[160:163], v[56:59]
  ds_read_b64_tr_b16 v[24:25], v10 offset:0
  v_mfma_f32_16x16x32_bf16 v[72:75], v[40:43], v[164:167], v[72:75]
  ds_read_b64_tr_b16 v[26:27], v10 offset:512
  s_waitcnt lgkmcnt(6)
  v_mfma_f32_16x16x32_bf16 v[76:79], v[44:47], v[164:167], v[76:79]
  ds_read_b64_tr_b16 v[28:29], v11 offset:0
  v_mfma_f32_16x16x32_bf16 v[60:63], v[44:47], v[160:163], v[60:63]
  ds_read_b64_tr_b16 v[30:31], v11 offset:512
  s_waitcnt vmcnt(3) lgkmcnt(6)
  v_mfma_f32_16x16x32_bf16 v[48:51], v[16:19], v[168:171], v[48:51]
  ds_read_b64_tr_b16 v[32:33], v8 offset:4096
  s_waitcnt vmcnt(2)
  v_mfma_f32_16x16x32_bf16 v[64:67], v[16:19], v[172:175], v[64:67]
  ds_read_b64_tr_b16 v[34:35], v8 offset:4608
  s_waitcnt lgkmcnt(6)
  v_mfma_f32_16x16x32_bf16 v[68:71], v[20:23], v[172:175], v[68:71]
  ds_read_b64_tr_b16 v[36:37], v9 offset:4096
  v_mfma_f32_16x16x32_bf16 v[52:55], v[20:23], v[168:171], v[52:55]
  ds_read_b64_tr_b16 v[38:39], v9 offset:4608
  s_waitcnt lgkmcnt(6)
  v_mfma_f32_16x16x32_bf16 v[56:59], v[24:27], v[168:171], v[56:59]
  ds_read_b64_tr_b16 v[40:41], v10 offset:4096
  v_mfma_f32_16x16x32_bf16 v[72:75], v[24:27], v[172:175], v[72:75]
  ds_read_b64_tr_b16 v[42:43], v10 offset:4608
  s_waitcnt lgkmcnt(6)
  v_mfma_f32_16x16x32_bf16 v[76:79], v[28:31], v[172:175], v[76:79]
  ds_read_b64_tr_b16 v[44:45], v11 offset:4096
  v_mfma_f32_16x16x32_bf16 v[60:63], v[28:31], v[168:171], v[60:63]
  ds_read_b64_tr_b16 v[46:47], v11 offset:4608
  s_waitcnt vmcnt(1) lgkmcnt(6)
  v_mfma_f32_16x16x32_bf16 v[48:51], v[32:35], v[176:179], v[48:51]
  s_waitcnt vmcnt(0)
  v_mfma_f32_16x16x32_bf16 v[64:67], v[32:35], v[180:183], v[64:67]
  s_waitcnt lgkmcnt(4)
  v_mfma_f32_16x16x32_bf16 v[68:71], v[36:39], v[180:183], v[68:71]
  v_mfma_f32_16x16x32_bf16 v[52:55], v[36:39], v[176:179], v[52:55]
  s_waitcnt lgkmcnt(2)
  v_mfma_f32_16x16x32_bf16 v[56:59], v[40:43], v[176:179], v[56:59]
  v_mfma_f32_16x16x32_bf16 v[72:75], v[40:43], v[180:183], v[72:75]
  s_waitcnt lgkmcnt(0)
  v_mfma_f32_16x16x32_bf16 v[76:79], v[44:47], v[180:183], v[76:79]
  v_mfma_f32_16x16x32_bf16 v[60:63], v[44:47], v[176:179], v[60:63]
  s_waitcnt lgkmcnt(0)
  s_barrier
  s_add_u32 s20, s82, 8388608
  s_addc_u32 s21, s83, 0
  s_mov_b32 s22, 8388608
  s_mov_b32 s23, 0x20000
  s_add_u32 s24, s82, 16777216
  s_addc_u32 s25, s83, 0
  s_mov_b32 s26, 8388608
  s_mov_b32 s27, 0x20000
  v_pk_add_f32 v[16:17], v[48:49], v[50:51]
  v_pk_mul_f32 v[18:19], v[48:49], v[48:49]
  v_pk_fma_f32 v[18:19], v[50:51], v[50:51], v[18:19]
  v_pk_add_f32 v[16:17], v[16:17], v[52:53]
  v_pk_fma_f32 v[18:19], v[52:53], v[52:53], v[18:19]
  v_pk_add_f32 v[16:17], v[16:17], v[54:55]
  v_pk_fma_f32 v[18:19], v[54:55], v[54:55], v[18:19]
  v_pk_add_f32 v[16:17], v[16:17], v[56:57]
  v_pk_fma_f32 v[18:19], v[56:57], v[56:57], v[18:19]
  v_pk_add_f32 v[16:17], v[16:17], v[58:59]
  v_pk_fma_f32 v[18:19], v[58:59], v[58:59], v[18:19]
  v_pk_add_f32 v[16:17], v[16:17], v[60:61]
  v_pk_fma_f32 v[18:19], v[60:61], v[60:61], v[18:19]
  v_pk_add_f32 v[16:17], v[16:17], v[62:63]
  v_pk_fma_f32 v[18:19], v[62:63], v[62:63], v[18:19]
  v_add_f32 v24, v16, v17
  v_add_f32 v26, v18, v19
  v_pk_add_f32 v[20:21], v[64:65], v[66:67]
  v_pk_mul_f32 v[22:23], v[64:65], v[64:65]
  v_pk_fma_f32 v[22:23], v[66:67], v[66:67], v[22:23]
  v_pk_add_f32 v[20:21], v[20:21], v[68:69]
  v_pk_fma_f32 v[22:23], v[68:69], v[68:69], v[22:23]
  v_pk_add_f32 v[20:21], v[20:21], v[70:71]
  v_pk_fma_f32 v[22:23], v[70:71], v[70:71], v[22:23]
  v_pk_add_f32 v[20:21], v[20:21], v[72:73]
  v_pk_fma_f32 v[22:23], v[72:73], v[72:73], v[22:23]
  v_pk_add_f32 v[20:21], v[20:21], v[74:75]
  v_pk_fma_f32 v[22:23], v[74:75], v[74:75], v[22:23]
  v_pk_add_f32 v[20:21], v[20:21], v[76:77]
  v_pk_fma_f32 v[22:23], v[76:77], v[76:77], v[22:23]
  v_pk_add_f32 v[20:21], v[20:21], v[78:79]
  v_pk_fma_f32 v[22:23], v[78:79], v[78:79], v[22:23]
  v_add_f32 v25, v20, v21
  v_add_f32 v27, v22, v23
  s_nop 0
  v_permlane16_swap_b32 v24, v25
  v_permlane16_swap_b32 v26, v27
  v_add_f32 v28, v24, v25
  v_add_f32 v29, v26, v27
  v_mov_b32 v30, v28
  v_mov_b32 v31, v29
  s_nop 0
  v_permlane32_swap_b32 v28, v30
  v_permlane32_swap_b32 v29, v31
  v_add_f32 v28, v28, v30
  v_add_f32 v29, v29, v31
  v_and_b32 v29, 0x7fffffff, v29
  s_mov_b32 exec_hi, 0
  buffer_store_dwordx2 v[28:29], v112, s[12:15], 0 offen sc0 sc1
  s_mov_b64 exec, -1
  v_cvt_pk_bf16_f32 v96, v48, v49
  v_cvt_pk_bf16_f32 v97, v50, v51
  v_cvt_pk_bf16_f32 v98, v52, v53
  v_cvt_pk_bf16_f32 v99, v54, v55
  v_cvt_pk_bf16_f32 v100, v56, v57
  v_cvt_pk_bf16_f32 v101, v58, v59
  v_cvt_pk_bf16_f32 v102, v60, v61
  v_cvt_pk_bf16_f32 v103, v62, v63
  v_cvt_pk_bf16_f32 v104, v64, v65
  v_cvt_pk_bf16_f32 v105, v66, v67
  v_cvt_pk_bf16_f32 v106, v68, v69
  v_cvt_pk_bf16_f32 v107, v70, v71
  v_cvt_pk_bf16_f32 v108, v72, v73
  v_cvt_pk_bf16_f32 v109, v74, v75
  v_cvt_pk_bf16_f32 v110, v76, v77
  v_cvt_pk_bf16_f32 v111, v78, v79
  v_permlane16_swap_b32 v96, v98
  v_permlane16_swap_b32 v97, v99
  v_permlane16_swap_b32 v100, v102
  v_permlane16_swap_b32 v101, v103
  v_permlane16_swap_b32 v104, v106
  v_permlane16_swap_b32 v105, v107
  v_permlane16_swap_b32 v108, v110
  v_permlane16_swap_b32 v109, v111
  v_xor_b32 v116, 32, v115
  v_xor_b32 v121, 32, v114
  v_xor_b32 v117, 64, v115
  v_xor_b32 v122, 64, v114
  v_xor_b32 v118, 96, v115
  v_xor_b32 v123, 96, v114
  v_mov_b32 v120, v114
  s_mov_b32 s39, 0
k2_poll:
  buffer_load_dwordx2 v[32:33], v113, s[12:15], 0 offen sc0 sc1
  buffer_load_dwordx2 v[34:35], v80, s[12:15], 0 offen sc0 sc1
  buffer_load_dwordx2 v[36:37], v81, s[12:15], 0 offen sc0 sc1
  buffer_load_dwordx2 v[38:39], v82, s[12:15], 0 offen sc0 sc1
  buffer_load_dwordx2 v[40:41], v83, s[12:15], 0 offen sc0 sc1
  buffer_load_dwordx2 v[42:43], v84, s[12:15], 0 offen sc0 sc1
  buffer_load_dwordx2 v[44:45], v85, s[12:15], 0 offen sc0 sc1
  buffer_load_dwordx2 v[46:47], v86, s[12:15], 0 offen sc0 sc1
  s_waitcnt vmcnt(0)
  v_min3_i32 v16, v33, v35, v37
  v_min3_i32 v17, v39, v41, v43
  v_min3_i32 v16, v16, v45, v47
  v_min_i32 v16, v16, v17
  v_cmp_gt_i32 vcc, 0, v16
  s_add_u32 s39, s39, 1
  s_cmp_gt_u32 s39, 1000000
  s_cbranch_scc1 k2_pdone
  s_cbranch_vccnz k2_poll
k2_pdone:
  buffer_store_dwordx4 v[96:99], v192, s[20:23], s53 offen sc0 sc1
  buffer_store_dwordx4 v[100:103], v194, s[20:23], s53 offen sc0 sc1
  buffer_store_dwordx4 v[104:107], v193, s[20:23], s53 offen sc0 sc1
  buffer_store_dwordx4 v[108:111], v195, s[20:23], s53 offen sc0 sc1
  v_pk_add_f32 v[32:33], v[32:33], v[34:35]
  v_pk_add_f32 v[36:37], v[36:37], v[38:39]
  v_pk_add_f32 v[40:41], v[40:41], v[42:43]
  v_pk_add_f32 v[44:45], v[44:45], v[46:47]
  v_pk_add_f32 v[32:33], v[32:33], v[36:37]
  v_pk_add_f32 v[40:41], v[40:41], v[44:45]
  v_pk_add_f32 v[32:33], v[32:33], v[40:41]
  v_mov_b32 v34, v32
  v_mov_b32 v35, v33
  s_nop 0
  v_permlane32_swap_b32 v32, v34
  v_permlane32_swap_b32 v33, v35
  v_add_f32 v32, v32, v34
  v_add_f32 v33, v33, v35
  v_mul_f32 v32, 0x3a800000, v32
  v_mul_f32 v33, 0x3a800000, v33
  v_fma_f32 v33, -v32, v32, v33
  v_max_f32 v33, 0, v33
  v_mov_b32 v36, v33
  v_cvt_pk_bf16_f32 v36, v36, v36
  v_lshlrev_b32 v36, 16, v36
  v_add_f32 v36, 0x3727c5ac, v36
  v_cvt_pk_bf16_f32 v36, v36, v36
  v_lshlrev_b32 v36, 16, v36
  v_sqrt_f32 v36, v36
  s_nop 0
  v_cvt_pk_bf16_f32 v36, v36, v36
  v_lshlrev_b32 v36, 16, v36
  v_rcp_f32 v36, v36
  s_nop 0
  v_mul_f32 v33, v33, v36
  v_mul_f32 v33, v33, v36
  v_cvt_pk_bf16_f32 v33, v33, v33
  v_lshlrev_b32 v33, 16, v33
  v_add_f32 v33, 0x3727c5ac, v33
  v_cvt_pk_bf16_f32 v33, v33, v33
  v_lshlrev_b32 v33, 16, v33
  v_sqrt_f32 v33, v33
  s_nop 0
  v_cvt_pk_bf16_f32 v33, v33, v33
  v_lshlrev_b32 v33, 16, v33
  v_rcp_f32 v33, v33
  s_nop 0
  v_mul_f32 v33, v33, v36
  v_mov_b32 v34, v32
  v_mov_b32 v35, v33
  s_nop 0
  v_permlane16_swap_b32 v32, v34
  v_permlane16_swap_b32 v33, v35
  v_pk_add_f32 v[48:49], v[48:49], v[32:33] op_sel_hi:[1,0] neg_lo:[0,1] neg_hi:[0,1]
  v_pk_add_f32 v[50:51], v[50:51], v[32:33] op_sel_hi:[1,0] neg_lo:[0,1] neg_hi:[0,1]
  v_pk_add_f32 v[52:53], v[52:53], v[32:33] op_sel_hi:[1,0] neg_lo:[0,1] neg_hi:[0,1]
  v_pk_add_f32 v[54:55], v[54:55], v[32:33] op_sel_hi:[1,0] neg_lo:[0,1] neg_hi:[0,1]
  v_pk_add_f32 v[56:57], v[56:57], v[32:33] op_sel_hi:[1,0] neg_lo:[0,1] neg_hi:[0,1]
  v_pk_add_f32 v[58:59], v[58:59], v[32:33] op_sel_hi:[1,0] neg_lo:[0,1] neg_hi:[0,1]
  v_pk_add_f32 v[60:61], v[60:61], v[32:33] op_sel_hi:[1,0] neg_lo:[0,1] neg_hi:[0,1]
  v_pk_add_f32 v[62:63], v[62:63], v[32:33] op_sel_hi:[1,0] neg_lo:[0,1] neg_hi:[0,1]
  v_pk_mul_f32 v[48:49], v[48:49], v[32:33] op_sel:[0,1] op_sel_hi:[1,1]
  v_pk_mul_f32 v[50:51], v[50:51], v[32:33] op_sel:[0,1] op_sel_hi:[1,1]
  v_pk_mul_f32 v[52:53], v[52:53], v[32:33] op_sel:[0,1] op_sel_hi:[1,1]
  v_pk_mul_f32 v[54:55], v[54:55], v[32:33] op_sel:[0,1] op_sel_hi:[1,1]
  v_pk_mul_f32 v[56:57], v[56:57], v[32:33] op_sel:[0,1] op_sel_hi:[1,1]
  v_pk_mul_f32 v[58:59], v[58:59], v[32:33] op_sel:[0,1] op_sel_hi:[1,1]
  v_pk_mul_f32 v[60:61], v[60:61], v[32:33] op_sel:[0,1] op_sel_hi:[1,1]
  v_pk_mul_f32 v[62:63], v[62:63], v[32:33] op_sel:[0,1] op_sel_hi:[1,1]
  v_cvt_pk_bf16_f32 v160, v48, v49
  v_cvt_pk_bf16_f32 v161, v50, v51
  ds_write_b64 v120, v[160:161] offset:0
  v_cvt_pk_bf16_f32 v162, v52, v53
  v_cvt_pk_bf16_f32 v163, v54, v55
  ds_write_b64 v121, v[162:163] offset:0
  v_cvt_pk_bf16_f32 v164, v56, v57
  v_cvt_pk_bf16_f32 v165, v58, v59
  ds_write_b64 v122, v[164:165] offset:0
  v_cvt_pk_bf16_f32 v166, v60, v61
  v_cvt_pk_bf16_f32 v167, v62, v63
  ds_write_b64 v123, v[166:167] offset:0
  v_pk_add_f32 v[64:65], v[64:65], v[34:35] op_sel_hi:[1,0] neg_lo:[0,1] neg_hi:[0,1]
  v_pk_add_f32 v[66:67], v[66:67], v[34:35] op_sel_hi:[1,0] neg_lo:[0,1] neg_hi:[0,1]
  v_pk_add_f32 v[68:69], v[68:69], v[34:35] op_sel_hi:[1,0] neg_lo:[0,1] neg_hi:[0,1]
  v_pk_add_f32 v[70:71], v[70:71], v[34:35] op_sel_hi:[1,0] neg_lo:[0,1] neg_hi:[0,1]
  v_pk_add_f32 v[72:73], v[72:73], v[34:35] op_sel_hi:[1,0] neg_lo:[0,1] neg_hi:[0,1]
  v_pk_add_f32 v[74:75], v[74:75], v[34:35] op_sel_hi:[1,0] neg_lo:[0,1] neg_hi:[0,1]
  v_pk_add_f32 v[76:77], v[76:77], v[34:35] op_sel_hi:[1,0] neg_lo:[0,1] neg_hi:[0,1]
  v_pk_add_f32 v[78:79], v[78:79], v[34:35] op_sel_hi:[1,0] neg_lo:[0,1] neg_hi:[0,1]
  v_pk_mul_f32 v[64:65], v[64:65], v[34:35] op_sel:[0,1] op_sel_hi:[1,1]
  v_pk_mul_f32 v[66:67], v[66:67], v[34:35] op_sel:[0,1] op_sel_hi:[1,1]
  v_pk_mul_f32 v[68:69], v[68:69], v[34:35] op_sel:[0,1] op_sel_hi:[1,1]
  v_pk_mul_f32 v[70:71], v[70:71], v[34:35] op_sel:[0,1] op_sel_hi:[1,1]
  v_pk_mul_f32 v[72:73], v[72:73], v[34:35] op_sel:[0,1] op_sel_hi:[1,1]
  v_pk_mul_f32 v[74:75], v[74:75], v[34:35] op_sel:[0,1] op_sel_hi:[1,1]
  v_pk_mul_f32 v[76:77], v[76:77], v[34:35] op_sel:[0,1] op_sel_hi:[1,1]
  v_pk_mul_f32 v[78:79], v[78:79], v[34:35] op_sel:[0,1] op_sel_hi:[1,1]
  v_cvt_pk_bf16_f32 v168, v64, v65
  v_cvt_pk_bf16_f32 v169, v66, v67
  ds_write_b64 v120, v[168:169] offset:128
  v_cvt_pk_bf16_f32 v170, v68, v69
  v_cvt_pk_bf16_f32 v171, v70, v71
  ds_write_b64 v121, v[170:171] offset:128
  v_cvt_pk_bf16_f32 v172, v72, v73
  v_cvt_pk_bf16_f32 v173, v74, v75
  ds_write_b64 v122, v[172:173] offset:128
  v_cvt_pk_bf16_f32 v174, v76, v77
  v_cvt_pk_bf16_f32 v175, v78, v79
  ds_write_b64 v123, v[174:175] offset:128
  s_waitcnt lgkmcnt(0)
  ds_read_b64_tr_b16 v[176:177], v115
  ds_read_b64_tr_b16 v[178:179], v115 offset:512
  ds_read_b64_tr_b16 v[180:181], v116
  ds_read_b64_tr_b16 v[182:183], v116 offset:512
  ds_read_b64_tr_b16 v[184:185], v117
  ds_read_b64_tr_b16 v[186:187], v117 offset:512
  ds_read_b64_tr_b16 v[188:189], v118
  ds_read_b64_tr_b16 v[190:191], v118 offset:512
  s_waitcnt lgkmcnt(6)
  buffer_store_dwordx4 v[176:179], v92, s[24:27], s44 offen sc0 sc1
  s_waitcnt lgkmcnt(4)
  buffer_store_dwordx4 v[180:183], v93, s[24:27], s45 offen sc0 sc1
  s_waitcnt lgkmcnt(2)
  buffer_store_dwordx4 v[184:187], v92, s[24:27], s46 offen sc0 sc1
  s_waitcnt lgkmcnt(0)
  buffer_store_dwordx4 v[188:191], v93, s[24:27], s47 offen sc0 sc1
  s_cmp_ge_u32 s2, 224
  s_cbranch_scc1 C_k3skip
  s_lshr_b32 s32, s2, 3
  s_mul_i32 s5, s32, 9363
  s_lshr_b32 s5, s5, 16
  s_mul_i32 s6, s5, 7
  s_sub_u32 s6, s32, s6
  s_lshl_b32 s7, s5, 1
  s_add_u32 s7, s7, s6
  s_and_b32 s7, s7, 7
  s_and_b32 s32, s2, 7
  s_lshr_b32 s28, s32, 2
  s_lshl_b32 s28, s28, 2
  s_add_u32 s28, s28, s5
  s_and_b32 s29, s32, 3
  s_mul_i32 s29, s29, 7
  s_add_u32 s29, s29, s6
  s_mov_b32 s30, 7
  s_mov_b32 s31, -1
  s_and_b32 s46, s4, 1
  s_lshr_b32 s41, s4, 1
  s_lshl_b32 s32, s29, 8
  s_lshl_b32 s44, s46, 7
  s_add_u32 s32, s32, s44
  v_lshlrev_b32 v16, 3, v5
  v_add_u32 v16, s32, v16
  s_mov_b32 s16, s74
  s_mov_b32 s17, s75
  s_mov_b32 s18, 7168
  s_mov_b32 s19, 0x20000
  v_mov_b32 v155, v16
  s_add_u32 s20, s82, 25165824
  s_addc_u32 s21, s83, 0
  s_mov_b32 s22, 14680064
  s_mov_b32 s23, 0x20000
  v_lshl_add_u32 v17, v5, 3, v6
  v_lshlrev_b32 v17, 8, v17
  v_lshl_add_u32 v17, v7, 3, v17
  v_lshl_or_b32 v18, v2, 2, v6
  v_lshl_add_u32 v17, v18, 5, v17
  s_lshl_b32 s32, s46, 7
  s_add_u32 s32, s32, 16384
  v_xor_b32 v18, s32, v17
  s_lshl_b32 s32, s41, 13
  v_add_u32 v12, s32, v14
  v_xor_b32 v8, 0, v18
  v_xor_b32 v9, 32, v18
  v_xor_b32 v10, 64, v18
  v_xor_b32 v11, 96, v18
  v_bfe_u32 v19, v4, 2, 1
  v_lshlrev_b32 v17, 11, v19
  v_lshl_add_u32 v17, v3, 8, v17
  v_lshrrev_b32 v18, 3, v4
  v_lshl_add_u32 v17, v18, 6, v17
  v_lshl_add_u32 v152, v7, 4, v17
  v_add_u32 v153, 128, v152
  v_cmp_eq_u32 vcc, 1, v3
  v_lshlrev_b32 v17, 7, v19
  v_add_u32 v18, 640, v17
  v_lshlrev_b32 v17, 8, v19
  v_add_u32 v17, 896, v17
  v_cndmask_b32 v18, 0, v18, vcc
  v_cndmask_b32 v17, 0, v17, vcc
  v_add_u32 v154, v153, v17
  v_add_u32 v153, v153, v18
  s_lshl_b32 s32, s28, 1
  s_add_u32 s32, s32, s41
  s_mul_i32 s32, s32, 224
  s_lshl_b32 s44, s29, 2
  s_add_u32 s32, s32, s44
  s_lshl_b32 s44, s46, 1
  s_add_u32 s32, s32, s44
  s_lshl_b32 s44, s32, 12
  s_add_u32 s45, s44, 458752
  s_add_u32 s46, s44, 4096
  s_add_u32 s47, s45, 4096
  s_waitcnt vmcnt(0)
  s_barrier
  buffer_load_dwordx2 v[144:145], v155, s[16:19], 0 offen offset:0
  buffer_load_dwordx2 v[146:147], v155, s[16:19], 0 offen offset:32
  buffer_load_dwordx2 v[148:149], v155, s[16:19], 0 offen offset:64
  buffer_load_dwordx2 v[150:151], v155, s[16:19], 0 offen offset:96
  s_waitcnt vmcnt(0)
  v_lshlrev_b32 v80, 16, v144
  v_and_b32 v81, 0xffff0000, v144
  v_lshlrev_b32 v82, 16, v145
  v_and_b32 v83, 0xffff0000, v145
  v_mov_b64 v[96:97], v[80:81]
  v_mov_b64 v[98:99], v[82:83]
  v_mov_b64 v[112:113], v[80:81]
  v_mov_b64 v[114:115], v[82:83]
  v_mov_b64 v[128:129], v[80:81]
  v_mov_b64 v[130:131], v[82:83]
  v_lshlrev_b32 v84, 16, v146
  v_and_b32 v85, 0xffff0000, v146
  v_lshlrev_b32 v86, 16, v147
  v_and_b32 v87, 0xffff0000, v147
  v_mov_b64 v[100:101], v[84:85]
  v_mov_b64 v[102:103], v[86:87]
  v_mov_b64 v[116:117], v[84:85]
  v_mov_b64 v[118:119], v[86:87]
  v_mov_b64 v[132:133], v[84:85]
  v_mov_b64 v[134:135], v[86:87]
  v_lshlrev_b32 v88, 16, v148
  v_and_b32 v89, 0xffff0000, v148
  v_lshlrev_b32 v90, 16, v149
  v_and_b32 v91, 0xffff0000, v149
  v_mov_b64 v[104:105], v[88:89]
  v_mov_b64 v[106:107], v[90:91]
  v_mov_b64 v[120:121], v[88:89]
  v_mov_b64 v[122:123], v[90:91]
  v_mov_b64 v[136:137], v[88:89]
  v_mov_b64 v[138:139], v[90:91]
  v_lshlrev_b32 v92, 16, v150
  v_and_b32 v93, 0xffff0000, v150
  v_lshlrev_b32 v94, 16, v151
  v_and_b32 v95, 0xffff0000, v151
  v_mov_b64 v[108:109], v[92:93]
  v_mov_b64 v[110:111], v[94:95]
  v_mov_b64 v[124:125], v[92:93]
  v_mov_b64 v[126:127], v[94:95]
  v_mov_b64 v[140:141], v[92:93]
  v_mov_b64 v[142:143], v[94:95]
  s_barrier
  s_mov_b32 s43, 0
  s_mov_b32 s39, 15
  s_add_u32 s40, s43, 32768
  s_cmp_eq_u32 s40, 163840
  s_cselect_b32 s40, 0, s40
  s_sub_u32 s42, s40, s43
  s_mov_b32 s43, s40
  s_barrier
  ds_read_b64_tr_b16 v[16:17], v8 offset:0
  ds_read_b64_tr_b16 v[18:19], v8 offset:1024
  ds_read_b128 v[32:35], v12 offset:0
  ds_read_b64_tr_b16 v[48:49], v8 offset:8192
  ds_read_b64_tr_b16 v[50:51], v8 offset:9216
  ds_read_b128 v[64:67], v12 offset:1024
  ds_read_b128 v[68:71], v12 offset:3072
  ds_read_b128 v[36:39], v12 offset:2048
  ds_read_b64_tr_b16 v[20:21], v9 offset:0
  ds_read_b64_tr_b16 v[22:23], v9 offset:1024
  ds_read_b64_tr_b16 v[52:53], v9 offset:8192
  ds_read_b64_tr_b16 v[54:55], v9 offset:9216
  ds_read_b64_tr_b16 v[24:25], v10 offset:0
  ds_read_b64_tr_b16 v[26:27], v10 offset:1024
  ds_read_b64_tr_b16 v[56:57], v10 offset:8192
  ds_read_b64_tr_b16 v[58:59], v10 offset:9216
  ds_read_b128 v[40:43], v12 offset:4096
  ds_read_b128 v[72:75], v12 offset:5120
  ds_read_b128 v[76:79], v12 offset:7168
  ds_read_b128 v[44:47], v12 offset:6144
  ds_read_b64_tr_b16 v[28:29], v11 offset:0
  ds_read_b64_tr_b16 v[30:31], v11 offset:1024
  ds_read_b64_tr_b16 v[60:61], v11 offset:8192
  ds_read_b64_tr_b16 v[62:63], v11 offset:9216
  v_add_u32 v8, s42, v8
  v_add_u32 v9, s42, v9
  v_add_u32 v10, s42, v10
  v_add_u32 v11, s42, v11
  v_add_u32 v12, s42, v12
cf4:
  s_barrier
  s_waitcnt lgkmcnt(14)
  v_mfma_f32_16x16x32_bf16 v[80:83], v[16:19], v[32:35], v[80:83]
  ds_read_b64_tr_b16 v[156:157], v8 offset:0
  s_add_u32 s40, s43, 32768
  s_cmp_eq_u32 s40, 163840
  v_mfma_f32_16x16x32_bf16 v[80:83], v[48:51], v[64:67], v[80:83]
  ds_read_b64_tr_b16 v[158:159], v8 offset:1024
  s_cselect_b32 s40, 0, s40
  s_sub_u32 s42, s40, s43
  v_mfma_f32_16x16x32_bf16 v[96:99], v[48:51], v[68:71], v[96:99]
  ds_read_b128 v[172:175], v12 offset:0
  s_mov_b32 s43, s40
  v_mfma_f32_16x16x32_bf16 v[96:99], v[16:19], v[36:39], v[96:99]
  ds_read_b64_tr_b16 v[188:189], v8 offset:8192
  v_mfma_f32_16x16x32_bf16 v[100:103], v[20:23], v[36:39], v[100:103]
  ds_read_b64_tr_b16 v[190:191], v8 offset:9216
  v_add_u32 v8, s42, v8
  s_waitcnt lgkmcnt(14)
  v_mfma_f32_16x16x32_bf16 v[100:103], v[52:55], v[68:71], v[100:103]
  ds_read_b128 v[204:207], v12 offset:1024
  v_mfma_f32_16x16x32_bf16 v[84:87], v[52:55], v[64:67], v[84:87]
  ds_read_b128 v[208:211], v12 offset:3072
  v_mfma_f32_16x16x32_bf16 v[84:87], v[20:23], v[32:35], v[84:87]
  ds_read_b128 v[176:179], v12 offset:2048
  v_mfma_f32_16x16x32_bf16 v[88:91], v[24:27], v[32:35], v[88:91]
  ds_read_b64_tr_b16 v[160:161], v9 offset:0
  s_waitcnt lgkmcnt(14)
  v_mfma_f32_16x16x32_bf16 v[88:91], v[56:59], v[64:67], v[88:91]
  ds_read_b64_tr_b16 v[162:163], v9 offset:1024
  v_mfma_f32_16x16x32_bf16 v[104:107], v[56:59], v[68:71], v[104:107]
  ds_read_b64_tr_b16 v[192:193], v9 offset:8192
  v_mfma_f32_16x16x32_bf16 v[104:107], v[24:27], v[36:39], v[104:107]
  ds_read_b64_tr_b16 v[194:195], v9 offset:9216
  v_add_u32 v9, s42, v9
  v_mfma_f32_16x16x32_bf16 v[120:123], v[24:27], v[40:43], v[120:123]
  ds_read_b64_tr_b16 v[164:165], v10 offset:0
  v_mfma_f32_16x16x32_bf16 v[120:123], v[56:59], v[72:75], v[120:123]
  ds_read_b64_tr_b16 v[166:167], v10 offset:1024
  v_mfma_f32_16x16x32_bf16 v[116:119], v[52:55], v[72:75], v[116:119]
  ds_read_b64_tr_b16 v[196:197], v10 offset:8192
  v_mfma_f32_16x16x32_bf16 v[116:119], v[20:23], v[40:43], v[116:119]
  ds_read_b64_tr_b16 v[198:199], v10 offset:9216
  v_add_u32 v10, s42, v10
  v_mfma_f32_16x16x32_bf16 v[112:115], v[16:19], v[40:43], v[112:115]
  ds_read_b128 v[180:183], v12 offset:4096
  v_mfma_f32_16x16x32_bf16 v[112:115], v[48:51], v[72:75], v[112:115]
  ds_read_b128 v[212:215], v12 offset:5120
  v_mfma_f32_16x16x32_bf16 v[128:131], v[48:51], v[76:79], v[128:131]
  ds_read_b128 v[216:219], v12 offset:7168
  s_waitcnt lgkmcnt(14)
  v_mfma_f32_16x16x32_bf16 v[128:131], v[16:19], v[44:47], v[128:131]
  ds_read_b128 v[184:187], v12 offset:6144
  v_add_u32 v12, s42, v12
  v_mfma_f32_16x16x32_bf16 v[132:135], v[20:23], v[44:47], v[132:135]
  ds_read_b64_tr_b16 v[168:169], v11 offset:0
  v_mfma_f32_16x16x32_bf16 v[132:135], v[52:55], v[76:79], v[132:135]
  ds_read_b64_tr_b16 v[170:171], v11 offset:1024
  v_mfma_f32_16x16x32_bf16 v[136:139], v[56:59], v[76:79], v[136:139]
  ds_read_b64_tr_b16 v[200:201], v11 offset:8192
  v_mfma_f32_16x16x32_bf16 v[136:139], v[24:27], v[44:47], v[136:139]
  ds_read_b64_tr_b16 v[202:203], v11 offset:9216
  v_add_u32 v11, s42, v11
  v_mfma_f32_16x16x32_bf16 v[140:143], v[28:31], v[44:47], v[140:143]
  v_mfma_f32_16x16x32_bf16 v[140:143], v[60:63], v[76:79], v[140:143]
  v_mfma_f32_16x16x32_bf16 v[124:127], v[60:63], v[72:75], v[124:127]
  v_mfma_f32_16x16x32_bf16 v[124:127], v[28:31], v[40:43], v[124:127]
  v_mfma_f32_16x16x32_bf16 v[108:111], v[28:31], v[36:39], v[108:111]
  v_mfma_f32_16x16x32_bf16 v[108:111], v[60:63], v[68:71], v[108:111]
  v_mfma_f32_16x16x32_bf16 v[92:95], v[60:63], v[64:67], v[92:95]
  v_mfma_f32_16x16x32_bf16 v[92:95], v[28:31], v[32:35], v[92:95]
  s_barrier
  s_waitcnt lgkmcnt(14)
  v_mfma_f32_16x16x32_bf16 v[80:83], v[156:159], v[172:175], v[80:83]
  ds_read_b64_tr_b16 v[16:17], v8 offset:0
  s_add_u32 s40, s43, 32768
  s_cmp_eq_u32 s40, 163840
  v_mfma_f32_16x16x32_bf16 v[80:83], v[188:191], v[204:207], v[80:83]
  ds_read_b64_tr_b16 v[18:19], v8 offset:1024
  s_cselect_b32 s40, 0, s40
  s_sub_u32 s42, s40, s43
  v_mfma_f32_16x16x32_bf16 v[96:99], v[188:191], v[208:211], v[96:99]
  ds_read_b128 v[32:35], v12 offset:0
  s_mov_b32 s43, s40
  v_mfma_f32_16x16x32_bf16 v[96:99], v[156:159], v[176:179], v[96:99]
  ds_read_b64_tr_b16 v[48:49], v8 offset:8192
  v_mfma_f32_16x16x32_bf16 v[100:103], v[160:163], v[176:179], v[100:103]
  ds_read_b64_tr_b16 v[50:51], v8 offset:9216
  v_add_u32 v8, s42, v8
  s_waitcnt lgkmcnt(14)
  v_mfma_f32_16x16x32_bf16 v[100:103], v[192:195], v[208:211], v[100:103]
  ds_read_b128 v[64:67], v12 offset:1024
  v_mfma_f32_16x16x32_bf16 v[84:87], v[192:195], v[204:207], v[84:87]
  ds_read_b128 v[68:71], v12 offset:3072
  v_mfma_f32_16x16x32_bf16 v[84:87], v[160:163], v[172:175], v[84:87]
  ds_read_b128 v[36:39], v12 offset:2048
  v_mfma_f32_16x16x32_bf16 v[88:91], v[164:167], v[172:175], v[88:91]
  ds_read_b64_tr_b16 v[20:21], v9 offset:0
  s_waitcnt lgkmcnt(14)
  v_mfma_f32_16x16x32_bf16 v[88:91], v[196:199], v[204:207], v[88:91]
  ds_read_b64_tr_b16 v[22:23], v9 offset:1024
  v_mfma_f32_16x16x32_bf16 v[104:107], v[196:199], v[208:211], v[104:107]
  ds_read_b64_tr_b16 v[52:53], v9 offset:8192
  v_mfma_f32_16x16x32_bf16 v[104:107], v[164:167], v[176:179], v[104:107]
  ds_read_b64_tr_b16 v[54:55], v9 offset:9216
  v_add_u32 v9, s42, v9
  v_mfma_f32_16x16x32_bf16 v[120:123], v[164:167], v[180:183], v[120:123]
  ds_read_b64_tr_b16 v[24:25], v10 offset:0
  v_mfma_f32_16x16x32_bf16 v[120:123], v[196:199], v[212:215], v[120:123]
  ds_read_b64_tr_b16 v[26:27], v10 offset:1024
  v_mfma_f32_16x16x32_bf16 v[116:119], v[192:195], v[212:215], v[116:119]
  ds_read_b64_tr_b16 v[56:57], v10 offset:8192
  v_mfma_f32_16x16x32_bf16 v[116:119], v[160:163], v[180:183], v[116:119]
  ds_read_b64_tr_b16 v[58:59], v10 offset:9216
  v_add_u32 v10, s42, v10
  v_mfma_f32_16x16x32_bf16 v[112:115], v[156:159], v[180:183], v[112:115]
  ds_read_b128 v[40:43], v12 offset:4096
  v_mfma_f32_16x16x32_bf16 v[112:115], v[188:191], v[212:215], v[112:115]
  ds_read_b128 v[72:75], v12 offset:5120
  v_mfma_f32_16x16x32_bf16 v[128:131], v[188:191], v[216:219], v[128:131]
  ds_read_b128 v[76:79], v12 offset:7168
  s_waitcnt lgkmcnt(14)
  v_mfma_f32_16x16x32_bf16 v[128:131], v[156:159], v[184:187], v[128:131]
  ds_read_b128 v[44:47], v12 offset:6144
  v_add_u32 v12, s42, v12
  v_mfma_f32_16x16x32_bf16 v[132:135], v[160:163], v[184:187], v[132:135]
  ds_read_b64_tr_b16 v[28:29], v11 offset:0
  v_mfma_f32_16x16x32_bf16 v[132:135], v[192:195], v[216:219], v[132:135]
  ds_read_b64_tr_b16 v[30:31], v11 offset:1024
  v_mfma_f32_16x16x32_bf16 v[136:139], v[196:199], v[216:219], v[136:139]
  ds_read_b64_tr_b16 v[60:61], v11 offset:8192
  v_mfma_f32_16x16x32_bf16 v[136:139], v[164:167], v[184:187], v[136:139]
  ds_read_b64_tr_b16 v[62:63], v11 offset:9216
  v_add_u32 v11, s42, v11
  v_mfma_f32_16x16x32_bf16 v[140:143], v[168:171], v[184:187], v[140:143]
  v_mfma_f32_16x16x32_bf16 v[140:143], v[200:203], v[216:219], v[140:143]
  v_mfma_f32_16x16x32_bf16 v[124:127], v[200:203], v[212:215], v[124:127]
  v_mfma_f32_16x16x32_bf16 v[124:127], v[168:171], v[180:183], v[124:127]
  v_mfma_f32_16x16x32_bf16 v[108:111], v[168:171], v[176:179], v[108:111]
  v_mfma_f32_16x16x32_bf16 v[108:111], v[200:203], v[208:211], v[108:111]
  v_mfma_f32_16x16x32_bf16 v[92:95], v[200:203], v[204:207], v[92:95]
  v_mfma_f32_16x16x32_bf16 v[92:95], v[168:171], v[172:175], v[92:95]
  s_sub_u32 s39, s39, 1
  s_cmp_lg_u32 s39, 0
  s_cbranch_scc1 cf4
  s_barrier
  s_waitcnt lgkmcnt(14)
  v_mfma_f32_16x16x32_bf16 v[80:83], v[16:19], v[32:35], v[80:83]
  ds_read_b64_tr_b16 v[156:157], v8 offset:0
  s_add_u32 s40, s43, 32768
  s_cmp_eq_u32 s40, 163840
  v_mfma_f32_16x16x32_bf16 v[80:83], v[48:51], v[64:67], v[80:83]
  ds_read_b64_tr_b16 v[158:159], v8 offset:1024
  s_cselect_b32 s40, 0, s40
  s_sub_u32 s42, s40, s43
  v_mfma_f32_16x16x32_bf16 v[96:99], v[48:51], v[68:71], v[96:99]
  ds_read_b128 v[172:175], v12 offset:0
  s_mov_b32 s43, s40
  v_mfma_f32_16x16x32_bf16 v[96:99], v[16:19], v[36:39], v[96:99]
  ds_read_b64_tr_b16 v[188:189], v8 offset:8192
  v_mfma_f32_16x16x32_bf16 v[100:103], v[20:23], v[36:39], v[100:103]
  ds_read_b64_tr_b16 v[190:191], v8 offset:9216
  v_add_u32 v8, s42, v8
  s_waitcnt lgkmcnt(14)
  v_mfma_f32_16x16x32_bf16 v[100:103], v[52:55], v[68:71], v[100:103]
  ds_read_b128 v[204:207], v12 offset:1024
  v_mfma_f32_16x16x32_bf16 v[84:87], v[52:55], v[64:67], v[84:87]
  ds_read_b128 v[208:211], v12 offset:3072
  v_mfma_f32_16x16x32_bf16 v[84:87], v[20:23], v[32:35], v[84:87]
  ds_read_b128 v[176:179], v12 offset:2048
  v_mfma_f32_16x16x32_bf16 v[88:91], v[24:27], v[32:35], v[88:91]
  ds_read_b64_tr_b16 v[160:161], v9 offset:0
  s_waitcnt lgkmcnt(14)
  v_mfma_f32_16x16x32_bf16 v[88:91], v[56:59], v[64:67], v[88:91]
  ds_read_b64_tr_b16 v[162:163], v9 offset:1024
  v_mfma_f32_16x16x32_bf16 v[104:107], v[56:59], v[68:71], v[104:107]
  ds_read_b64_tr_b16 v[192:193], v9 offset:8192
  v_mfma_f32_16x16x32_bf16 v[104:107], v[24:27], v[36:39], v[104:107]
  ds_read_b64_tr_b16 v[194:195], v9 offset:9216
  v_add_u32 v9, s42, v9
  v_mfma_f32_16x16x32_bf16 v[120:123], v[24:27], v[40:43], v[120:123]
  ds_read_b64_tr_b16 v[164:165], v10 offset:0
  v_mfma_f32_16x16x32_bf16 v[120:123], v[56:59], v[72:75], v[120:123]
  ds_read_b64_tr_b16 v[166:167], v10 offset:1024
  v_mfma_f32_16x16x32_bf16 v[116:119], v[52:55], v[72:75], v[116:119]
  ds_read_b64_tr_b16 v[196:197], v10 offset:8192
  v_mfma_f32_16x16x32_bf16 v[116:119], v[20:23], v[40:43], v[116:119]
  ds_read_b64_tr_b16 v[198:199], v10 offset:9216
  v_add_u32 v10, s42, v10
  v_mfma_f32_16x16x32_bf16 v[112:115], v[16:19], v[40:43], v[112:115]
  ds_read_b128 v[180:183], v12 offset:4096
  v_mfma_f32_16x16x32_bf16 v[112:115], v[48:51], v[72:75], v[112:115]
  ds_read_b128 v[212:215], v12 offset:5120
  v_mfma_f32_16x16x32_bf16 v[128:131], v[48:51], v[76:79], v[128:131]
  ds_read_b128 v[216:219], v12 offset:7168
  s_waitcnt lgkmcnt(14)
  v_mfma_f32_16x16x32_bf16 v[128:131], v[16:19], v[44:47], v[128:131]
  ds_read_b128 v[184:187], v12 offset:6144
  v_add_u32 v12, s42, v12
  v_mfma_f32_16x16x32_bf16 v[132:135], v[20:23], v[44:47], v[132:135]
  ds_read_b64_tr_b16 v[168:169], v11 offset:0
  v_mfma_f32_16x16x32_bf16 v[132:135], v[52:55], v[76:79], v[132:135]
  ds_read_b64_tr_b16 v[170:171], v11 offset:1024
  v_mfma_f32_16x16x32_bf16 v[136:139], v[56:59], v[76:79], v[136:139]
  ds_read_b64_tr_b16 v[200:201], v11 offset:8192
  v_mfma_f32_16x16x32_bf16 v[136:139], v[24:27], v[44:47], v[136:139]
  ds_read_b64_tr_b16 v[202:203], v11 offset:9216
  v_add_u32 v11, s42, v11
  v_mfma_f32_16x16x32_bf16 v[140:143], v[28:31], v[44:47], v[140:143]
  v_mfma_f32_16x16x32_bf16 v[140:143], v[60:63], v[76:79], v[140:143]
  v_mfma_f32_16x16x32_bf16 v[124:127], v[60:63], v[72:75], v[124:127]
  v_mfma_f32_16x16x32_bf16 v[124:127], v[28:31], v[40:43], v[124:127]
  v_mfma_f32_16x16x32_bf16 v[108:111], v[28:31], v[36:39], v[108:111]
  v_mfma_f32_16x16x32_bf16 v[108:111], v[60:63], v[68:71], v[108:111]
  v_mfma_f32_16x16x32_bf16 v[92:95], v[60:63], v[64:67], v[92:95]
  v_mfma_f32_16x16x32_bf16 v[92:95], v[28:31], v[32:35], v[92:95]
  s_waitcnt lgkmcnt(14)
  v_mfma_f32_16x16x32_bf16 v[80:83], v[156:159], v[172:175], v[80:83]
  v_mfma_f32_16x16x32_bf16 v[80:83], v[188:191], v[204:207], v[80:83]
  v_mfma_f32_16x16x32_bf16 v[96:99], v[188:191], v[208:211], v[96:99]
  v_mfma_f32_16x16x32_bf16 v[96:99], v[156:159], v[176:179], v[96:99]
  v_mfma_f32_16x16x32_bf16 v[100:103], v[160:163], v[176:179], v[100:103]
  s_waitcnt lgkmcnt(12)
  v_mfma_f32_16x16x32_bf16 v[100:103], v[192:195], v[208:211], v[100:103]
  v_mfma_f32_16x16x32_bf16 v[84:87], v[192:195], v[204:207], v[84:87]
  v_mfma_f32_16x16x32_bf16 v[84:87], v[160:163], v[172:175], v[84:87]
  s_waitcnt lgkmcnt(10)
  v_mfma_f32_16x16x32_bf16 v[88:91], v[164:167], v[172:175], v[88:91]
  s_waitcnt lgkmcnt(8)
  v_mfma_f32_16x16x32_bf16 v[88:91], v[196:199], v[204:207], v[88:91]
  v_mfma_f32_16x16x32_bf16 v[104:107], v[196:199], v[208:211], v[104:107]
  v_mfma_f32_16x16x32_bf16 v[104:107], v[164:167], v[176:179], v[104:107]
  s_waitcnt lgkmcnt(7)
  v_mfma_f32_16x16x32_bf16 v[120:123], v[164:167], v[180:183], v[120:123]
  s_waitcnt lgkmcnt(6)
  v_mfma_f32_16x16x32_bf16 v[120:123], v[196:199], v[212:215], v[120:123]
  v_mfma_f32_16x16x32_bf16 v[116:119], v[192:195], v[212:215], v[116:119]
  v_mfma_f32_16x16x32_bf16 v[116:119], v[160:163], v[180:183], v[116:119]
  v_mfma_f32_16x16x32_bf16 v[112:115], v[156:159], v[180:183], v[112:115]
  v_mfma_f32_16x16x32_bf16 v[112:115], v[188:191], v[212:215], v[112:115]
  s_waitcnt lgkmcnt(5)
  v_mfma_f32_16x16x32_bf16 v[128:131], v[188:191], v[216:219], v[128:131]
  s_waitcnt lgkmcnt(4)
  v_mfma_f32_16x16x32_bf16 v[128:131], v[156:159], v[184:187], v[128:131]
  v_mfma_f32_16x16x32_bf16 v[132:135], v[160:163], v[184:187], v[132:135]
  v_mfma_f32_16x16x32_bf16 v[132:135], v[192:195], v[216:219], v[132:135]
  v_mfma_f32_16x16x32_bf16 v[136:139], v[196:199], v[216:219], v[136:139]
  v_mfma_f32_16x16x32_bf16 v[136:139], v[164:167], v[184:187], v[136:139]
  s_waitcnt lgkmcnt(2)
  v_mfma_f32_16x16x32_bf16 v[140:143], v[168:171], v[184:187], v[140:143]
  s_waitcnt lgkmcnt(0)
  v_mfma_f32_16x16x32_bf16 v[140:143], v[200:203], v[216:219], v[140:143]
  v_mfma_f32_16x16x32_bf16 v[124:127], v[200:203], v[212:215], v[124:127]
  v_mfma_f32_16x16x32_bf16 v[124:127], v[168:171], v[180:183], v[124:127]
  v_mfma_f32_16x16x32_bf16 v[108:111], v[168:171], v[176:179], v[108:111]
  v_mfma_f32_16x16x32_bf16 v[108:111], v[200:203], v[208:211], v[108:111]
  v_mfma_f32_16x16x32_bf16 v[92:95], v[200:203], v[204:207], v[92:95]
  v_mfma_f32_16x16x32_bf16 v[92:95], v[168:171], v[172:175], v[92:95]
  s_waitcnt lgkmcnt(0)
  v_mov_b32 v16, 0xc0135761
  v_mov_b32 v17, 0xbdd2d3e8
  v_pk_mul_f32 v[24:25], v[80:81], v[80:81]
  v_pk_mul_f32 v[26:27], v[82:83], v[82:83]
  v_pk_mul_f32 v[28:29], v[84:85], v[84:85]
  v_pk_mul_f32 v[30:31], v[86:87], v[86:87]
  v_pk_fma_f32 v[24:25], v[24:25], v[16:17], v[16:17] op_sel:[0,1,0] op_sel_hi:[1,1,0]
  v_pk_fma_f32 v[26:27], v[26:27], v[16:17], v[16:17] op_sel:[0,1,0] op_sel_hi:[1,1,0]
  v_pk_fma_f32 v[28:29], v[28:29], v[16:17], v[16:17] op_sel:[0,1,0] op_sel_hi:[1,1,0]
  v_pk_fma_f32 v[30:31], v[30:31], v[16:17], v[16:17] op_sel:[0,1,0] op_sel_hi:[1,1,0]
  v_pk_mul_f32 v[24:25], v[24:25], v[80:81]
  v_pk_mul_f32 v[26:27], v[26:27], v[82:83]
  v_pk_mul_f32 v[28:29], v[28:29], v[84:85]
  v_pk_mul_f32 v[30:31], v[30:31], v[86:87]
  v_exp_f32 v24, v24
  v_exp_f32 v25, v25
  v_exp_f32 v26, v26
  v_exp_f32 v27, v27
  v_exp_f32 v28, v28
  v_exp_f32 v29, v29
  v_exp_f32 v30, v30
  v_exp_f32 v31, v31
  v_pk_add_f32 v[24:25], v[24:25], 1.0 op_sel_hi:[1,0]
  v_pk_add_f32 v[26:27], v[26:27], 1.0 op_sel_hi:[1,0]
  v_pk_add_f32 v[28:29], v[28:29], 1.0 op_sel_hi:[1,0]
  v_pk_add_f32 v[30:31], v[30:31], 1.0 op_sel_hi:[1,0]
  v_rcp_f32 v24, v24
  v_rcp_f32 v25, v25
  v_rcp_f32 v26, v26
  v_rcp_f32 v27, v27
  v_rcp_f32 v28, v28
  v_rcp_f32 v29, v29
  v_rcp_f32 v30, v30
  v_rcp_f32 v31, v31
  v_pk_mul_f32 v[24:25], v[24:25], v[80:81]
  v_pk_mul_f32 v[26:27], v[26:27], v[82:83]
  v_pk_mul_f32 v[28:29], v[28:29], v[84:85]
  v_pk_mul_f32 v[30:31], v[30:31], v[86:87]
  v_cvt_pk_bf16_f32 v164, v24, v25
  v_cvt_pk_bf16_f32 v165, v26, v27
  v_cvt_pk_bf16_f32 v166, v28, v29
  v_cvt_pk_bf16_f32 v167, v30, v31
  s_nop 0
  v_permlane16_swap_b32 v164, v166
  v_permlane16_swap_b32 v165, v167
  buffer_store_dwordx4 v[164:167], v152, s[20:23], s44 offen sc0 sc1
  v_pk_mul_f32 v[40:41], v[88:89], v[88:89]
  v_pk_mul_f32 v[42:43], v[90:91], v[90:91]
  v_pk_mul_f32 v[44:45], v[92:93], v[92:93]
  v_pk_mul_f32 v[46:47], v[94:95], v[94:95]
  v_pk_fma_f32 v[40:41], v[40:41], v[16:17], v[16:17] op_sel:[0,1,0] op_sel_hi:[1,1,0]
  v_pk_fma_f32 v[42:43], v[42:43], v[16:17], v[16:17] op_sel:[0,1,0] op_sel_hi:[1,1,0]
  v_pk_fma_f32 v[44:45], v[44:45], v[16:17], v[16:17] op_sel:[0,1,0] op_sel_hi:[1,1,0]
  v_pk_fma_f32 v[46:47], v[46:47], v[16:17], v[16:17] op_sel:[0,1,0] op_sel_hi:[1,1,0]
  v_pk_mul_f32 v[40:41], v[40:41], v[88:89]
  v_pk_mul_f32 v[42:43], v[42:43], v[90:91]
  v_pk_mul_f32 v[44:45], v[44:45], v[92:93]
  v_pk_mul_f32 v[46:47], v[46:47], v[94:95]
  v_exp_f32 v40, v40
  v_exp_f32 v41, v41
  v_exp_f32 v42, v42
  v_exp_f32 v43, v43
  v_exp_f32 v44, v44
  v_exp_f32 v45, v45
  v_exp_f32 v46, v46
  v_exp_f32 v47, v47
  v_pk_add_f32 v[40:41], v[40:41], 1.0 op_sel_hi:[1,0]
  v_pk_add_f32 v[42:43], v[42:43], 1.0 op_sel_hi:[1,0]
  v_pk_add_f32 v[44:45], v[44:45], 1.0 op_sel_hi:[1,0]
  v_pk_add_f32 v[46:47], v[46:47], 1.0 op_sel_hi:[1,0]
  v_rcp_f32 v40, v40
  v_rcp_f32 v41, v41
  v_rcp_f32 v42, v42
  v_rcp_f32 v43, v43
  v_rcp_f32 v44, v44
  v_rcp_f32 v45, v45
  v_rcp_f32 v46, v46
  v_rcp_f32 v47, v47
  v_pk_mul_f32 v[40:41], v[40:41], v[88:89]
  v_pk_mul_f32 v[42:43], v[42:43], v[90:91]
  v_pk_mul_f32 v[44:45], v[44:45], v[92:93]
  v_pk_mul_f32 v[46:47], v[46:47], v[94:95]
  v_cvt_pk_bf16_f32 v168, v40, v41
  v_cvt_pk_bf16_f32 v169, v42, v43
  v_cvt_pk_bf16_f32 v170, v44, v45
  v_cvt_pk_bf16_f32 v171, v46, v47
  s_nop 0
  v_permlane16_swap_b32 v168, v170
  v_permlane16_swap_b32 v169, v171
  buffer_store_dwordx4 v[168:171], v152, s[20:23], s46 offen sc0 sc1
  v_pk_mul_f32 v[24:25], v[96:97], v[96:97]
  v_pk_mul_f32 v[26:27], v[98:99], v[98:99]
  v_pk_mul_f32 v[28:29], v[100:101], v[100:101]
  v_pk_mul_f32 v[30:31], v[102:103], v[102:103]
  v_pk_fma_f32 v[24:25], v[24:25], v[16:17], v[16:17] op_sel:[0,1,0] op_sel_hi:[1,1,0]
  v_pk_fma_f32 v[26:27], v[26:27], v[16:17], v[16:17] op_sel:[0,1,0] op_sel_hi:[1,1,0]
  v_pk_fma_f32 v[28:29], v[28:29], v[16:17], v[16:17] op_sel:[0,1,0] op_sel_hi:[1,1,0]
  v_pk_fma_f32 v[30:31], v[30:31], v[16:17], v[16:17] op_sel:[0,1,0] op_sel_hi:[1,1,0]
  v_pk_mul_f32 v[24:25], v[24:25], v[96:97]
  v_pk_mul_f32 v[26:27], v[26:27], v[98:99]
  v_pk_mul_f32 v[28:29], v[28:29], v[100:101]
  v_pk_mul_f32 v[30:31], v[30:31], v[102:103]
  v_exp_f32 v24, v24
  v_exp_f32 v25, v25
  v_exp_f32 v26, v26
  v_exp_f32 v27, v27
  v_exp_f32 v28, v28
  v_exp_f32 v29, v29
  v_exp_f32 v30, v30
  v_exp_f32 v31, v31
  v_pk_add_f32 v[24:25], v[24:25], 1.0 op_sel_hi:[1,0]
  v_pk_add_f32 v[26:27], v[26:27], 1.0 op_sel_hi:[1,0]
  v_pk_add_f32 v[28:29], v[28:29], 1.0 op_sel_hi:[1,0]
  v_pk_add_f32 v[30:31], v[30:31], 1.0 op_sel_hi:[1,0]
  v_rcp_f32 v24, v24
  v_rcp_f32 v25, v25
  v_rcp_f32 v26, v26
  v_rcp_f32 v27, v27
  v_rcp_f32 v28, v28
  v_rcp_f32 v29, v29
  v_rcp_f32 v30, v30
  v_rcp_f32 v31, v31
  v_pk_mul_f32 v[24:25], v[24:25], v[96:97]
  v_pk_mul_f32 v[26:27], v[26:27], v[98:99]
  v_pk_mul_f32 v[28:29], v[28:29], v[100:101]
  v_pk_mul_f32 v[30:31], v[30:31], v[102:103]
  v_cvt_pk_bf16_f32 v172, v24, v25
  v_cvt_pk_bf16_f32 v173, v26, v27
  v_cvt_pk_bf16_f32 v174, v28, v29
  v_cvt_pk_bf16_f32 v175, v30, v31
  s_nop 0
  v_permlane16_swap_b32 v172, v174
  v_permlane16_swap_b32 v173, v175
  buffer_store_dwordx4 v[172:175], v153, s[20:23], s44 offen sc0 sc1
  v_pk_mul_f32 v[40:41], v[104:105], v[104:105]
  v_pk_mul_f32 v[42:43], v[106:107], v[106:107]
  v_pk_mul_f32 v[44:45], v[108:109], v[108:109]
  v_pk_mul_f32 v[46:47], v[110:111], v[110:111]
  v_pk_fma_f32 v[40:41], v[40:41], v[16:17], v[16:17] op_sel:[0,1,0] op_sel_hi:[1,1,0]
  v_pk_fma_f32 v[42:43], v[42:43], v[16:17], v[16:17] op_sel:[0,1,0] op_sel_hi:[1,1,0]
  v_pk_fma_f32 v[44:45], v[44:45], v[16:17], v[16:17] op_sel:[0,1,0] op_sel_hi:[1,1,0]
  v_pk_fma_f32 v[46:47], v[46:47], v[16:17], v[16:17] op_sel:[0,1,0] op_sel_hi:[1,1,0]
  v_pk_mul_f32 v[40:41], v[40:41], v[104:105]
  v_pk_mul_f32 v[42:43], v[42:43], v[106:107]
  v_pk_mul_f32 v[44:45], v[44:45], v[108:109]
  v_pk_mul_f32 v[46:47], v[46:47], v[110:111]
  v_exp_f32 v40, v40
  v_exp_f32 v41, v41
  v_exp_f32 v42, v42
  v_exp_f32 v43, v43
  v_exp_f32 v44, v44
  v_exp_f32 v45, v45
  v_exp_f32 v46, v46
  v_exp_f32 v47, v47
  v_pk_add_f32 v[40:41], v[40:41], 1.0 op_sel_hi:[1,0]
  v_pk_add_f32 v[42:43], v[42:43], 1.0 op_sel_hi:[1,0]
  v_pk_add_f32 v[44:45], v[44:45], 1.0 op_sel_hi:[1,0]
  v_pk_add_f32 v[46:47], v[46:47], 1.0 op_sel_hi:[1,0]
  v_rcp_f32 v40, v40
  v_rcp_f32 v41, v41
  v_rcp_f32 v42, v42
  v_rcp_f32 v43, v43
  v_rcp_f32 v44, v44
  v_rcp_f32 v45, v45
  v_rcp_f32 v46, v46
  v_rcp_f32 v47, v47
  v_pk_mul_f32 v[40:41], v[40:41], v[104:105]
  v_pk_mul_f32 v[42:43], v[42:43], v[106:107]
  v_pk_mul_f32 v[44:45], v[44:45], v[108:109]
  v_pk_mul_f32 v[46:47], v[46:47], v[110:111]
  v_cvt_pk_bf16_f32 v176, v40, v41
  v_cvt_pk_bf16_f32 v177, v42, v43
  v_cvt_pk_bf16_f32 v178, v44, v45
  v_cvt_pk_bf16_f32 v179, v46, v47
  s_nop 0
  v_permlane16_swap_b32 v176, v178
  v_permlane16_swap_b32 v177, v179
  buffer_store_dwordx4 v[176:179], v153, s[20:23], s46 offen sc0 sc1
  v_pk_mul_f32 v[24:25], v[112:113], v[112:113]
  v_pk_mul_f32 v[26:27], v[114:115], v[114:115]
  v_pk_mul_f32 v[28:29], v[116:117], v[116:117]
  v_pk_mul_f32 v[30:31], v[118:119], v[118:119]
  v_pk_fma_f32 v[24:25], v[24:25], v[16:17], v[16:17] op_sel:[0,1,0] op_sel_hi:[1,1,0]
  v_pk_fma_f32 v[26:27], v[26:27], v[16:17], v[16:17] op_sel:[0,1,0] op_sel_hi:[1,1,0]
  v_pk_fma_f32 v[28:29], v[28:29], v[16:17], v[16:17] op_sel:[0,1,0] op_sel_hi:[1,1,0]
  v_pk_fma_f32 v[30:31], v[30:31], v[16:17], v[16:17] op_sel:[0,1,0] op_sel_hi:[1,1,0]
  v_pk_mul_f32 v[24:25], v[24:25], v[112:113]
  v_pk_mul_f32 v[26:27], v[26:27], v[114:115]
  v_pk_mul_f32 v[28:29], v[28:29], v[116:117]
  v_pk_mul_f32 v[30:31], v[30:31], v[118:119]
  v_exp_f32 v24, v24
  v_exp_f32 v25, v25
  v_exp_f32 v26, v26
  v_exp_f32 v27, v27
  v_exp_f32 v28, v28
  v_exp_f32 v29, v29
  v_exp_f32 v30, v30
  v_exp_f32 v31, v31
  v_pk_add_f32 v[24:25], v[24:25], 1.0 op_sel_hi:[1,0]
  v_pk_add_f32 v[26:27], v[26:27], 1.0 op_sel_hi:[1,0]
  v_pk_add_f32 v[28:29], v[28:29], 1.0 op_sel_hi:[1,0]
  v_pk_add_f32 v[30:31], v[30:31], 1.0 op_sel_hi:[1,0]
  v_rcp_f32 v24, v24
  v_rcp_f32 v25, v25
  v_rcp_f32 v26, v26
  v_rcp_f32 v27, v27
  v_rcp_f32 v28, v28
  v_rcp_f32 v29, v29
  v_rcp_f32 v30, v30
  v_rcp_f32 v31, v31
  v_pk_mul_f32 v[24:25], v[24:25], v[112:113]
  v_pk_mul_f32 v[26:27], v[26:27], v[114:115]
  v_pk_mul_f32 v[28:29], v[28:29], v[116:117]
  v_pk_mul_f32 v[30:31], v[30:31], v[118:119]
  v_cvt_pk_bf16_f32 v180, v24, v25
  v_cvt_pk_bf16_f32 v181, v26, v27
  v_cvt_pk_bf16_f32 v182, v28, v29
  v_cvt_pk_bf16_f32 v183, v30, v31
  s_nop 0
  v_permlane16_swap_b32 v180, v182
  v_permlane16_swap_b32 v181, v183
  buffer_store_dwordx4 v[180:183], v152, s[20:23], s45 offen sc0 sc1
  v_pk_mul_f32 v[40:41], v[120:121], v[120:121]
  v_pk_mul_f32 v[42:43], v[122:123], v[122:123]
  v_pk_mul_f32 v[44:45], v[124:125], v[124:125]
  v_pk_mul_f32 v[46:47], v[126:127], v[126:127]
  v_pk_fma_f32 v[40:41], v[40:41], v[16:17], v[16:17] op_sel:[0,1,0] op_sel_hi:[1,1,0]
  v_pk_fma_f32 v[42:43], v[42:43], v[16:17], v[16:17] op_sel:[0,1,0] op_sel_hi:[1,1,0]
  v_pk_fma_f32 v[44:45], v[44:45], v[16:17], v[16:17] op_sel:[0,1,0] op_sel_hi:[1,1,0]
  v_pk_fma_f32 v[46:47], v[46:47], v[16:17], v[16:17] op_sel:[0,1,0] op_sel_hi:[1,1,0]
  v_pk_mul_f32 v[40:41], v[40:41], v[120:121]
  v_pk_mul_f32 v[42:43], v[42:43], v[122:123]
  v_pk_mul_f32 v[44:45], v[44:45], v[124:125]
  v_pk_mul_f32 v[46:47], v[46:47], v[126:127]
  v_exp_f32 v40, v40
  v_exp_f32 v41, v41
  v_exp_f32 v42, v42
  v_exp_f32 v43, v43
  v_exp_f32 v44, v44
  v_exp_f32 v45, v45
  v_exp_f32 v46, v46
  v_exp_f32 v47, v47
  v_pk_add_f32 v[40:41], v[40:41], 1.0 op_sel_hi:[1,0]
  v_pk_add_f32 v[42:43], v[42:43], 1.0 op_sel_hi:[1,0]
  v_pk_add_f32 v[44:45], v[44:45], 1.0 op_sel_hi:[1,0]
  v_pk_add_f32 v[46:47], v[46:47], 1.0 op_sel_hi:[1,0]
  v_rcp_f32 v40, v40
  v_rcp_f32 v41, v41
  v_rcp_f32 v42, v42
  v_rcp_f32 v43, v43
  v_rcp_f32 v44, v44
  v_rcp_f32 v45, v45
  v_rcp_f32 v46, v46
  v_rcp_f32 v47, v47
  v_pk_mul_f32 v[40:41], v[40:41], v[120:121]
  v_pk_mul_f32 v[42:43], v[42:43], v[122:123]
  v_pk_mul_f32 v[44:45], v[44:45], v[124:125]
  v_pk_mul_f32 v[46:47], v[46:47], v[126:127]
  v_cvt_pk_bf16_f32 v184, v40, v41
  v_cvt_pk_bf16_f32 v185, v42, v43
  v_cvt_pk_bf16_f32 v186, v44, v45
  v_cvt_pk_bf16_f32 v187, v46, v47
  s_nop 0
  v_permlane16_swap_b32 v184, v186
  v_permlane16_swap_b32 v185, v187
  buffer_store_dwordx4 v[184:187], v152, s[20:23], s47 offen sc0 sc1
  v_pk_mul_f32 v[24:25], v[128:129], v[128:129]
  v_pk_mul_f32 v[26:27], v[130:131], v[130:131]
  v_pk_mul_f32 v[28:29], v[132:133], v[132:133]
  v_pk_mul_f32 v[30:31], v[134:135], v[134:135]
  v_pk_fma_f32 v[24:25], v[24:25], v[16:17], v[16:17] op_sel:[0,1,0] op_sel_hi:[1,1,0]
  v_pk_fma_f32 v[26:27], v[26:27], v[16:17], v[16:17] op_sel:[0,1,0] op_sel_hi:[1,1,0]
  v_pk_fma_f32 v[28:29], v[28:29], v[16:17], v[16:17] op_sel:[0,1,0] op_sel_hi:[1,1,0]
  v_pk_fma_f32 v[30:31], v[30:31], v[16:17], v[16:17] op_sel:[0,1,0] op_sel_hi:[1,1,0]
  v_pk_mul_f32 v[24:25], v[24:25], v[128:129]
  v_pk_mul_f32 v[26:27], v[26:27], v[130:131]
  v_pk_mul_f32 v[28:29], v[28:29], v[132:133]
  v_pk_mul_f32 v[30:31], v[30:31], v[134:135]
  v_exp_f32 v24, v24
  v_exp_f32 v25, v25
  v_exp_f32 v26, v26
  v_exp_f32 v27, v27
  v_exp_f32 v28, v28
  v_exp_f32 v29, v29
  v_exp_f32 v30, v30
  v_exp_f32 v31, v31
  v_pk_add_f32 v[24:25], v[24:25], 1.0 op_sel_hi:[1,0]
  v_pk_add_f32 v[26:27], v[26:27], 1.0 op_sel_hi:[1,0]
  v_pk_add_f32 v[28:29], v[28:29], 1.0 op_sel_hi:[1,0]
  v_pk_add_f32 v[30:31], v[30:31], 1.0 op_sel_hi:[1,0]
  v_rcp_f32 v24, v24
  v_rcp_f32 v25, v25
  v_rcp_f32 v26, v26
  v_rcp_f32 v27, v27
  v_rcp_f32 v28, v28
  v_rcp_f32 v29, v29
  v_rcp_f32 v30, v30
  v_rcp_f32 v31, v31
  v_pk_mul_f32 v[24:25], v[24:25], v[128:129]
  v_pk_mul_f32 v[26:27], v[26:27], v[130:131]
  v_pk_mul_f32 v[28:29], v[28:29], v[132:133]
  v_pk_mul_f32 v[30:31], v[30:31], v[134:135]
  v_cvt_pk_bf16_f32 v188, v24, v25
  v_cvt_pk_bf16_f32 v189, v26, v27
  v_cvt_pk_bf16_f32 v190, v28, v29
  v_cvt_pk_bf16_f32 v191, v30, v31
  s_nop 0
  v_permlane16_swap_b32 v188, v190
  v_permlane16_swap_b32 v189, v191
  buffer_store_dwordx4 v[188:191], v154, s[20:23], s45 offen sc0 sc1
  v_pk_mul_f32 v[40:41], v[136:137], v[136:137]
  v_pk_mul_f32 v[42:43], v[138:139], v[138:139]
  v_pk_mul_f32 v[44:45], v[140:141], v[140:141]
  v_pk_mul_f32 v[46:47], v[142:143], v[142:143]
  v_pk_fma_f32 v[40:41], v[40:41], v[16:17], v[16:17] op_sel:[0,1,0] op_sel_hi:[1,1,0]
  v_pk_fma_f32 v[42:43], v[42:43], v[16:17], v[16:17] op_sel:[0,1,0] op_sel_hi:[1,1,0]
  v_pk_fma_f32 v[44:45], v[44:45], v[16:17], v[16:17] op_sel:[0,1,0] op_sel_hi:[1,1,0]
  v_pk_fma_f32 v[46:47], v[46:47], v[16:17], v[16:17] op_sel:[0,1,0] op_sel_hi:[1,1,0]
  v_pk_mul_f32 v[40:41], v[40:41], v[136:137]
  v_pk_mul_f32 v[42:43], v[42:43], v[138:139]
  v_pk_mul_f32 v[44:45], v[44:45], v[140:141]
  v_pk_mul_f32 v[46:47], v[46:47], v[142:143]
  v_exp_f32 v40, v40
  v_exp_f32 v41, v41
  v_exp_f32 v42, v42
  v_exp_f32 v43, v43
  v_exp_f32 v44, v44
  v_exp_f32 v45, v45
  v_exp_f32 v46, v46
  v_exp_f32 v47, v47
  v_pk_add_f32 v[40:41], v[40:41], 1.0 op_sel_hi:[1,0]
  v_pk_add_f32 v[42:43], v[42:43], 1.0 op_sel_hi:[1,0]
  v_pk_add_f32 v[44:45], v[44:45], 1.0 op_sel_hi:[1,0]
  v_pk_add_f32 v[46:47], v[46:47], 1.0 op_sel_hi:[1,0]
  v_rcp_f32 v40, v40
  v_rcp_f32 v41, v41
  v_rcp_f32 v42, v42
  v_rcp_f32 v43, v43
  v_rcp_f32 v44, v44
  v_rcp_f32 v45, v45
  v_rcp_f32 v46, v46
  v_rcp_f32 v47, v47
  v_pk_mul_f32 v[40:41], v[40:41], v[136:137]
  v_pk_mul_f32 v[42:43], v[42:43], v[138:139]
  v_pk_mul_f32 v[44:45], v[44:45], v[140:141]
  v_pk_mul_f32 v[46:47], v[46:47], v[142:143]
  v_cvt_pk_bf16_f32 v192, v40, v41
  v_cvt_pk_bf16_f32 v193, v42, v43
  v_cvt_pk_bf16_f32 v194, v44, v45
  v_cvt_pk_bf16_f32 v195, v46, v47
  s_nop 0
  v_permlane16_swap_b32 v192, v194
  v_permlane16_swap_b32 v193, v195
  buffer_store_dwordx4 v[192:195], v154, s[20:23], s47 offen sc0 sc1
C_k3skip:
  s_nop 7
  s_nop 7
  s_lshr_b32 s32, s2, 3
  s_lshr_b32 s5, s32, 3
  s_and_b32 s6, s32, 7
  s_lshl_b32 s7, s5, 1
  s_add_u32 s7, s7, s6
  s_and_b32 s7, s7, 7
  s_and_b32 s32, s2, 7
  s_lshr_b32 s28, s32, 2
  s_lshl_b32 s28, s28, 2
  s_add_u32 s28, s28, s5
  s_and_b32 s29, s32, 3
  s_mul_i32 s29, s29, 8
  s_add_u32 s29, s29, s6
  s_mov_b32 s30, 7
  s_mov_b32 s31, -1
  s_lshl_b32 s32, s29, 6
  v_add_u32 v13, s32, v4
  v_lshlrev_b32 v13, 1, v13
  s_lshl_b32 s40, s4, 4
  s_add_u32 s32, s32, s40
  v_add_u32 v16, s32, v5
  v_lshlrev_b32 v12, 11, v16
  v_lshl_add_u32 v12, v4, 4, v12
  s_lshl_b32 s32, s28, 8
  v_add_u32 v12, s32, v12
  v_lshlrev_b32 v186, 8, v16
  v_and_b32 v17, 7, v0
  v_lshl_add_u32 v186, v17, 4, v186
  v_lshrrev_b32 v17, 3, v4
  v_lshl_add_u32 v186, v17, 19, v186
  s_lshl_b32 s32, s28, 20
  v_add_u32 v186, s32, v186
  v_mul_u32_u24 v189, 272, v4
  v_lshl_add_u32 v189, v5, 4, v189
  s_lshl_b32 s32, s4, 6
  s_add_u32 s32, s32, 1024
  v_add_u32 v189, s32, v189
  v_add_u32 v16, s40, v5
  v_mul_u32_u24 v190, 272, v16
  v_lshl_add_u32 v190, v4, 4, v190
  v_add_u32 v190, 1024, v190
  s_lshl_b32 s34, s28, 2
  s_add_u32 s34, s34, s4
  s_mul_i32 s34, s34, 458752
  s_mov_b32 s45, 8192
  s_mov_b32 s46, 16384
  s_mov_b32 s47, 24576
  v_lshrrev_b32 v16, 1, v4
  v_lshlrev_b32 v16, 4, v16
  v_lshl_add_u32 v16, v3, 8, v16
  v_and_b32 v17, 1, v4
  v_lshl_add_u32 v187, v17, 11, v16
  s_and_b32 s32, s4, 1
  s_lshl_b32 s32, s32, 1
  v_add_u32 v17, s32, v17
  v_cmp_eq_u32 vcc, 3, v17
  s_nop 1
  v_addc_co_u32 v17, vcc, 5, v17, vcc
  v_lshlrev_b32 v17, 7, v17
  v_cmp_eq_u32 vcc, 1, v3
  v_add_u32 v188, 128, v187
  s_nop 0
  v_cndmask_b32 v17, 0, v17, vcc
  v_add_u32 v188, v188, v17
  s_lshl_b32 s44, s29, 6
  s_lshl_b32 s32, s28, 2
  s_add_u32 s44, s44, s32
  s_add_u32 s44, s44, s4
  s_lshl_b32 s44, s44, 12
  s_add_u32 s51, s44, 131072
  s_add_u32 s8, s82, 25165824
  s_addc_u32 s9, s83, 0
  s_mov_b32 s10, 14680064
  s_mov_b32 s11, 0x20000
  s_add_u32 s16, s82, 8388608
  s_addc_u32 s17, s83, 0
  s_mov_b32 s18, 8388608
  s_mov_b32 s19, 0x20000
  s_mov_b32 s12, s78
  s_mov_b32 s13, s79
  s_mov_b32 s14, 4096
  s_mov_b32 s15, 0x20000
  v_lshl_add_u32 v16, v5, 3, v6
  v_lshlrev_b32 v16, 7, v16
  v_lshl_add_u32 v16, v7, 3, v16
  v_lshrrev_b32 v17, 1, v6
  v_lshl_or_b32 v17, v2, 1, v17
  v_lshl_add_u32 v16, v17, 5, v16
  v_add_u32 v16, 98304, v16
  v_xor_b32 v8, 0, v16
  v_xor_b32 v9, 32, v16
  v_xor_b32 v10, 64, v16
  v_xor_b32 v11, 96, v16
  s_lshl_b32 s48, 0x303, s7
  s_lshr_b32 s48, s48, 8
  s_mov_b32 s49, s34
  s_add_u32 s50, s34, 65536
  s_add_u32 s41, s34, 458752
  s_and_b32 s40, s4, 1
  s_lshl_b32 s32, s40, 1
  s_add_u32 s32, s32, 0
  s_cmp_eq_u32 s32, 3
  s_addc_u32 s32, s32, 5
  s_lshl_b32 s32, s32, 7
  s_mov_b32 vcc_lo, 0xff000000
  s_mov_b32 vcc_hi, 0
  v_mov_b32 v88, s32
  v_cndmask_b32 v88, 0, v88, vcc
  v_lshl_add_u32 v88, v0, 4, v88
  v_add_u32 v90, 4096, v88
  s_lshl_b32 s32, s40, 1
  s_add_u32 s32, s32, 1
  s_cmp_eq_u32 s32, 3
  s_addc_u32 s32, s32, 5
  s_lshl_b32 s32, s32, 7
  s_mov_b32 vcc_lo, 0xff000000
  s_mov_b32 vcc_hi, 0
  v_mov_b32 v89, s32
  v_cndmask_b32 v89, 0, v89, vcc
  v_lshl_add_u32 v89, v0, 4, v89
  v_add_u32 v89, 2048, v89
  v_add_u32 v91, 4096, v89
  v_lshlrev_b32 v184, 3, v0
  s_lshl_b32 s32, s4, 9
  s_add_u32 s32, s32, 90112
  v_add_u32 v185, s32, v184
  s_add_u32 s24, s84, 109051904
  s_addc_u32 s25, s85, 0
  s_mov_b32 s26, 524288
  s_mov_b32 s27, 0x20000
  v_min_u32 v15, 27, v0
  s_lshl_b32 s32, s28, 5
  v_add_u32 v15, s32, v15
  v_max_i32 v15, 0, v15
  v_lshlrev_b32 v15, 7, v15
  s_lshl_b32 s55, s3, 17
  s_add_u32 s55, s55, 65536
  s_waitcnt vmcnt(0)
  s_barrier
  buffer_load_ushort v112, v13, s[12:15], 0 offen offset:0
  buffer_load_ushort v114, v13, s[12:15], 0 offen offset:32
  buffer_load_ushort v116, v13, s[12:15], 0 offen offset:64
  buffer_load_ushort v118, v13, s[12:15], 0 offen offset:96
  s_cmp_lt_u32 s2, 224
  s_cbranch_scc1 C_nopf
  s_mov_b32 s20, s72
  s_mov_b32 s21, s73
  s_mov_b32 s22, 14680064
  s_mov_b32 s23, 0x20000
  s_and_b32 s32, s2, 3
  s_mul_i32 s32, s32, 14
  s_sub_u32 s40, 3, s32
  s_and_b32 s40, s40, 7
  v_and_b32 v17, 1, v0
  v_lshlrev_b32 v17, 3, v17
  v_add_u32 v17, s40, v17
  v_cmp_gt_u32 vcc, 14, v17
  v_add_u32 v17, s32, v17
  v_lshlrev_b32 v17, 7, v17
  s_sub_u32 s32, s2, 224
  s_lshr_b32 s32, s32, 3
  s_lshl_b32 s32, s32, 2
  s_add_u32 s32, s32, s4
  s_lshl_b32 s32, s32, 5
  v_lshrrev_b32 v18, 1, v0
  v_add_u32 v18, s32, v18
  v_mul_u32_u24 v18, 7168, v18
  v_add_u32 v17, v17, v18
  v_mov_b32 v18, 0x40000000
  v_cndmask_b32 v17, v18, v17, vcc
  s_mov_b32 s32, 0
  buffer_load_dword v18, v17, s[20:23], s32 offen
  s_add_u32 s32, s32, 3670016
  buffer_load_dword v18, v17, s[20:23], s32 offen
  s_add_u32 s32, s32, 3670016
  buffer_load_dword v18, v17, s[20:23], s32 offen
  s_add_u32 s32, s32, 3670016
  buffer_load_dword v18, v17, s[20:23], s32 offen
  s_add_u32 s32, s32, 3670016
  s_cmp_lg_u32 s3, 0
  s_cbranch_scc1 C_nopf
  s_mov_b32 s20, s76
  s_mov_b32 s21, s77
  s_mov_b32 s22, 14680064
  s_mov_b32 s23, 0x20000
  s_sub_u32 s32, s2, 224
  s_lshl_b32 s32, s32, 2
  s_add_u32 s32, s32, s4
  s_lshl_b32 s32, s32, 13
  v_lshlrev_b32 v17, 7, v0
  s_sleep 127
  buffer_load_dword v18, v17, s[20:23], s32 offen
  s_add_u32 s32, s32, 1048576
  buffer_load_dword v18, v17, s[20:23], s32 offen
  s_add_u32 s32, s32, 1048576
  s_waitcnt vmcnt(1)
  buffer_load_dword v18, v17, s[20:23], s32 offen
  s_add_u32 s32, s32, 1048576
  s_waitcnt vmcnt(1)
  buffer_load_dword v18, v17, s[20:23], s32 offen
  s_add_u32 s32, s32, 1048576
  s_waitcnt vmcnt(1)
  buffer_load_dword v18, v17, s[20:23], s32 offen
  s_add_u32 s32, s32, 1048576
  s_waitcnt vmcnt(1)
  buffer_load_dword v18, v17, s[20:23], s32 offen
  s_add_u32 s32, s32, 1048576
  s_waitcnt vmcnt(1)
  buffer_load_dword v18, v17, s[20:23], s32 offen
  s_add_u32 s32, s32, 1048576
  s_waitcnt vmcnt(1)
  buffer_load_dword v18, v17, s[20:23], s32 offen
  s_add_u32 s32, s32, 1048576
  s_waitcnt vmcnt(1)
  buffer_load_dword v18, v17, s[20:23], s32 offen
  s_add_u32 s32, s32, 1048576
  s_waitcnt vmcnt(1)
  buffer_load_dword v18, v17, s[20:23], s32 offen
  s_add_u32 s32, s32, 1048576
  s_waitcnt vmcnt(1)
  buffer_load_dword v18, v17, s[20:23], s32 offen
  s_add_u32 s32, s32, 1048576
  s_waitcnt vmcnt(1)
  buffer_load_dword v18, v17, s[20:23], s32 offen
  s_add_u32 s32, s32, 1048576
  s_waitcnt vmcnt(1)
  buffer_load_dword v18, v17, s[20:23], s32 offen
  s_add_u32 s32, s32, 1048576
  s_waitcnt vmcnt(1)
  buffer_load_dword v18, v17, s[20:23], s32 offen
  s_add_u32 s32, s32, 1048576
  s_waitcnt vmcnt(1)
C_nopf:
  s_mov_b32 s39, 0
  s_and_b32 s32, s4, 3
  s_cmp_lg_u32 s32, 0
  s_cbranch_scc1 poll5d
  s_sleep 8
poll5:
  buffer_load_dword v16, v15, s[24:27], s55 offen sc0 sc1
  s_waitcnt vmcnt(0)
  v_cmp_eq_u32 vcc, 0, v16
  s_add_u32 s39, s39, 1
  s_cmp_gt_u32 s39, 1000000
  s_cbranch_scc1 poll5d
  s_cbranch_vccnz poll5
poll5d:
  s_barrier
  buffer_load_dwordx4 v[96:99], v187, s[16:19], s44 offen sc1
  buffer_load_dwordx4 v[100:103], v188, s[16:19], s44 offen sc1
  buffer_load_dwordx4 v[104:107], v187, s[16:19], s51 offen sc1
  buffer_load_dwordx4 v[108:111], v188, s[16:19], s51 offen sc1
  s_cmp_eq_u32 s3, 0
  s_cselect_b32 s24, s84, s80
  s_cselect_b32 s25, s85, s81
  s_cselect_b32 s26, 100663296, 0
  s_add_u32 s24, s24, s26
  s_addc_u32 s25, s25, 0
  s_mov_b32 s26, 8388608
  s_mov_b32 s27, 0x20000
  s_lshr_b32 s26, s26, s3
  s_add_u32 s12, s84, 93323264
  s_addc_u32 s13, s85, 0
  s_mov_b32 s14, 262144
  s_mov_b32 s15, 0x20000
  s_bitcmp1_b32 s48, 0
  s_cselect_b32 s36, s50, s49
  s_add_u32 s36, s36, 0
  buffer_load_dwordx4 v[120:123], v88, s[8:11], s36 offen sc1
  buffer_load_dwordx4 v[124:127], v89, s[8:11], s36 offen sc1
  buffer_load_dwordx4 v[128:131], v90, s[8:11], s36 offen sc1
  buffer_load_dwordx4 v[132:135], v91, s[8:11], s36 offen sc1
  s_bitcmp1_b32 s48, 1
  s_cselect_b32 s36, s50, s49
  s_add_u32 s36, s36, 8192
  buffer_load_dwordx4 v[136:139], v88, s[8:11], s36 offen sc1
  buffer_load_dwordx4 v[140:143], v89, s[8:11], s36 offen sc1
  buffer_load_dwordx4 v[144:147], v90, s[8:11], s36 offen sc1
  buffer_load_dwordx4 v[148:151], v91, s[8:11], s36 offen sc1
  s_bitcmp1_b32 s48, 2
  s_cselect_b32 s36, s50, s49
  s_add_u32 s36, s36, 16384
  buffer_load_dwordx4 v[152:155], v88, s[8:11], s36 offen sc1
  buffer_load_dwordx4 v[156:159], v89, s[8:11], s36 offen sc1
  buffer_load_dwordx4 v[160:163], v90, s[8:11], s36 offen sc1
  buffer_load_dwordx4 v[164:167], v91, s[8:11], s36 offen sc1
  s_bitcmp1_b32 s48, 3
  s_cselect_b32 s36, s50, s49
  s_add_u32 s36, s36, 24576
  buffer_load_dwordx4 v[168:171], v88, s[8:11], s36 offen sc1
  buffer_load_dwordx4 v[172:175], v89, s[8:11], s36 offen sc1
  s_waitcnt vmcnt(14)
  v_lshlrev_b32 v112, 16, v112
  v_lshlrev_b32 v48, 16, v96
  v_and_b32 v49, 0xffff0000, v96
  v_lshlrev_b32 v50, 16, v97
  v_and_b32 v51, 0xffff0000, v97
  v_lshlrev_b32 v52, 16, v98
  v_and_b32 v53, 0xffff0000, v98
  v_lshlrev_b32 v54, 16, v99
  v_and_b32 v55, 0xffff0000, v99
  v_pk_add_f32 v[48:49], v[48:49], v[112:113] op_sel_hi:[1,0]
  v_pk_add_f32 v[50:51], v[50:51], v[112:113] op_sel_hi:[1,0]
  v_pk_add_f32 v[52:53], v[52:53], v[112:113] op_sel_hi:[1,0]
  v_pk_add_f32 v[54:55], v[54:55], v[112:113] op_sel_hi:[1,0]
  v_lshlrev_b32 v114, 16, v114
  v_lshlrev_b32 v56, 16, v100
  v_and_b32 v57, 0xffff0000, v100
  v_lshlrev_b32 v58, 16, v101
  v_and_b32 v59, 0xffff0000, v101
  v_lshlrev_b32 v60, 16, v102
  v_and_b32 v61, 0xffff0000, v102
  v_lshlrev_b32 v62, 16, v103
  v_and_b32 v63, 0xffff0000, v103
  v_pk_add_f32 v[56:57], v[56:57], v[114:115] op_sel_hi:[1,0]
  v_pk_add_f32 v[58:59], v[58:59], v[114:115] op_sel_hi:[1,0]
  v_pk_add_f32 v[60:61], v[60:61], v[114:115] op_sel_hi:[1,0]
  v_pk_add_f32 v[62:63], v[62:63], v[114:115] op_sel_hi:[1,0]
  v_lshlrev_b32 v116, 16, v116
  v_lshlrev_b32 v64, 16, v104
  v_and_b32 v65, 0xffff0000, v104
  v_lshlrev_b32 v66, 16, v105
  v_and_b32 v67, 0xffff0000, v105
  v_lshlrev_b32 v68, 16, v106
  v_and_b32 v69, 0xffff0000, v106
  v_lshlrev_b32 v70, 16, v107
  v_and_b32 v71, 0xffff0000, v107
  v_pk_add_f32 v[64:65], v[64:65], v[116:117] op_sel_hi:[1,0]
  v_pk_add_f32 v[66:67], v[66:67], v[116:117] op_sel_hi:[1,0]
  v_pk_add_f32 v[68:69], v[68:69], v[116:117] op_sel_hi:[1,0]
  v_pk_add_f32 v[70:71], v[70:71], v[116:117] op_sel_hi:[1,0]
  v_lshlrev_b32 v118, 16, v118
  v_lshlrev_b32 v72, 16, v108
  v_and_b32 v73, 0xffff0000, v108
  v_lshlrev_b32 v74, 16, v109
  v_and_b32 v75, 0xffff0000, v109
  v_lshlrev_b32 v76, 16, v110
  v_and_b32 v77, 0xffff0000, v110
  v_lshlrev_b32 v78, 16, v111
  v_and_b32 v79, 0xffff0000, v111
  v_pk_add_f32 v[72:73], v[72:73], v[118:119] op_sel_hi:[1,0]
  v_pk_add_f32 v[74:75], v[74:75], v[118:119] op_sel_hi:[1,0]
  v_pk_add_f32 v[76:77], v[76:77], v[118:119] op_sel_hi:[1,0]
  v_pk_add_f32 v[78:79], v[78:79], v[118:119] op_sel_hi:[1,0]
  s_mov_b32 s43, 0
  s_mov_b32 s39, 6
  s_barrier
  ds_read_b64_tr_b16 v[16:17], v8 offset:0
  ds_read_b64_tr_b16 v[18:19], v8 offset:512
  ds_read_b64_tr_b16 v[20:21], v9 offset:0
  ds_read_b64_tr_b16 v[22:23], v9 offset:512
  ds_read_b64_tr_b16 v[24:25], v10 offset:0
  ds_read_b64_tr_b16 v[26:27], v10 offset:512
  ds_read_b64_tr_b16 v[28:29], v11 offset:0
  ds_read_b64_tr_b16 v[30:31], v11 offset:512
  s_add_u32 s40, s43, 8192
  s_cmp_eq_u32 s40, 65536
  s_cselect_b32 s40, 0, s40
  s_sub_u32 s42, s40, s43
  s_mov_b32 s43, s40
cd6:
  s_waitcnt vmcnt(13) lgkmcnt(6)
  v_mfma_f32_16x16x32_bf16 v[48:51], v[120:123], v[16:19], v[48:51]
  ds_read_b64_tr_b16 v[32:33], v8 offset:4096
  s_waitcnt vmcnt(12)
  v_mfma_f32_16x16x32_bf16 v[52:55], v[124:127], v[16:19], v[52:55]
  ds_read_b64_tr_b16 v[34:35], v8 offset:4608
  v_add_u32 v8, s42, v8
  s_waitcnt lgkmcnt(6)
  v_mfma_f32_16x16x32_bf16 v[60:63], v[124:127], v[20:23], v[60:63]
  ds_read_b64_tr_b16 v[36:37], v9 offset:4096
  buffer_load_dwordx4 v[176:179], v90, s[8:11], s36 offen sc1
  v_mfma_f32_16x16x32_bf16 v[56:59], v[120:123], v[20:23], v[56:59]
  ds_read_b64_tr_b16 v[38:39], v9 offset:4608
  v_add_u32 v9, s42, v9
  s_waitcnt lgkmcnt(6)
  v_mfma_f32_16x16x32_bf16 v[64:67], v[120:123], v[24:27], v[64:67]
  ds_read_b64_tr_b16 v[40:41], v10 offset:4096
  v_mfma_f32_16x16x32_bf16 v[68:71], v[124:127], v[24:27], v[68:71]
  ds_read_b64_tr_b16 v[42:43], v10 offset:4608
  v_add_u32 v10, s42, v10
  s_waitcnt lgkmcnt(6)
  v_mfma_f32_16x16x32_bf16 v[76:79], v[124:127], v[28:31], v[76:79]
  ds_read_b64_tr_b16 v[44:45], v11 offset:4096
  buffer_load_dwordx4 v[180:183], v91, s[8:11], s36 offen sc1
  v_mfma_f32_16x16x32_bf16 v[72:75], v[120:123], v[28:31], v[72:75]
  ds_read_b64_tr_b16 v[46:47], v11 offset:4608
  v_add_u32 v11, s42, v11
  s_barrier
  s_waitcnt vmcnt(13) lgkmcnt(6)
  v_mfma_f32_16x16x32_bf16 v[48:51], v[128:131], v[32:35], v[48:51]
  ds_read_b64_tr_b16 v[16:17], v8 offset:0
  s_bitcmp1_b32 s48, 4
  s_cselect_b32 s36, s50, s49
  s_waitcnt vmcnt(12)
  v_mfma_f32_16x16x32_bf16 v[52:55], v[132:135], v[32:35], v[52:55]
  ds_read_b64_tr_b16 v[18:19], v8 offset:512
  s_add_u32 s36, s36, 32768
  s_add_u32 s40, s43, 8192
  s_waitcnt lgkmcnt(6)
  v_mfma_f32_16x16x32_bf16 v[60:63], v[132:135], v[36:39], v[60:63]
  ds_read_b64_tr_b16 v[20:21], v9 offset:0
  s_cmp_eq_u32 s40, 65536
  s_cselect_b32 s40, 0, s40
  v_mfma_f32_16x16x32_bf16 v[56:59], v[128:131], v[36:39], v[56:59]
  ds_read_b64_tr_b16 v[22:23], v9 offset:512
  s_sub_u32 s42, s40, s43
  s_mov_b32 s43, s40
  s_waitcnt lgkmcnt(6)
  v_mfma_f32_16x16x32_bf16 v[64:67], v[128:131], v[40:43], v[64:67]
  ds_read_b64_tr_b16 v[24:25], v10 offset:0
  buffer_load_dwordx4 v[120:123], v88, s[8:11], s36 offen sc1
  v_mfma_f32_16x16x32_bf16 v[68:71], v[132:135], v[40:43], v[68:71]
  ds_read_b64_tr_b16 v[26:27], v10 offset:512
  s_waitcnt lgkmcnt(6)
  v_mfma_f32_16x16x32_bf16 v[76:79], v[132:135], v[44:47], v[76:79]
  ds_read_b64_tr_b16 v[28:29], v11 offset:0
  v_mfma_f32_16x16x32_bf16 v[72:75], v[128:131], v[44:47], v[72:75]
  ds_read_b64_tr_b16 v[30:31], v11 offset:512
  buffer_load_dwordx4 v[124:127], v89, s[8:11], s36 offen sc1
  s_waitcnt vmcnt(13) lgkmcnt(6)
  v_mfma_f32_16x16x32_bf16 v[48:51], v[136:139], v[16:19], v[48:51]
  ds_read_b64_tr_b16 v[32:33], v8 offset:4096
  s_waitcnt vmcnt(12)
  v_mfma_f32_16x16x32_bf16 v[52:55], v[140:143], v[16:19], v[52:55]
  ds_read_b64_tr_b16 v[34:35], v8 offset:4608
  v_add_u32 v8, s42, v8
  s_waitcnt lgkmcnt(6)
  v_mfma_f32_16x16x32_bf16 v[60:63], v[140:143], v[20:23], v[60:63]
  ds_read_b64_tr_b16 v[36:37], v9 offset:4096
  buffer_load_dwordx4 v[128:131], v90, s[8:11], s36 offen sc1
  v_mfma_f32_16x16x32_bf16 v[56:59], v[136:139], v[20:23], v[56:59]
  ds_read_b64_tr_b16 v[38:39], v9 offset:4608
  v_add_u32 v9, s42, v9
  s_waitcnt lgkmcnt(6)
  v_mfma_f32_16x16x32_bf16 v[64:67], v[136:139], v[24:27], v[64:67]
  ds_read_b64_tr_b16 v[40:41], v10 offset:4096
  v_mfma_f32_16x16x32_bf16 v[68:71], v[140:143], v[24:27], v[68:71]
  ds_read_b64_tr_b16 v[42:43], v10 offset:4608
  v_add_u32 v10, s42, v10
  s_waitcnt lgkmcnt(6)
  v_mfma_f32_16x16x32_bf16 v[76:79], v[140:143], v[28:31], v[76:79]
  ds_read_b64_tr_b16 v[44:45], v11 offset:4096
  buffer_load_dwordx4 v[132:135], v91, s[8:11], s36 offen sc1
  v_mfma_f32_16x16x32_bf16 v[72:75], v[136:139], v[28:31], v[72:75]
  ds_read_b64_tr_b16 v[46:47], v11 offset:4608
  v_add_u32 v11, s42, v11
  s_barrier
  s_waitcnt vmcnt(13) lgkmcnt(6)
  v_mfma_f32_16x16x32_bf16 v[48:51], v[144:147], v[32:35], v[48:51]
  ds_read_b64_tr_b16 v[16:17], v8 offset:0
  s_bitcmp1_b32 s48, 5
  s_cselect_b32 s36, s50, s49
  s_waitcnt vmcnt(12)
  v_mfma_f32_16x16x32_bf16 v[52:55], v[148:151], v[32:35], v[52:55]
  ds_read_b64_tr_b16 v[18:19], v8 offset:512
  s_add_u32 s36, s36, 40960
  s_add_u32 s40, s43, 8192
  s_waitcnt lgkmcnt(6)
  v_mfma_f32_16x16x32_bf16 v[60:63], v[148:151], v[36:39], v[60:63]
  ds_read_b64_tr_b16 v[20:21], v9 offset:0
  s_cmp_eq_u32 s40, 65536
  s_cselect_b32 s40, 0, s40
  v_mfma_f32_16x16x32_bf16 v[56:59], v[144:147], v[36:39], v[56:59]
  ds_read_b64_tr_b16 v[22:23], v9 offset:512
  s_sub_u32 s42, s40, s43
  s_mov_b32 s43, s40
  s_waitcnt lgkmcnt(6)
  v_mfma_f32_16x16x32_bf16 v[64:67], v[144:147], v[40:43], v[64:67]
  ds_read_b64_tr_b16 v[24:25], v10 offset:0
  buffer_load_dwordx4 v[136:139], v88, s[8:11], s36 offen sc1
  v_mfma_f32_16x16x32_bf16 v[68:71], v[148:151], v[40:43], v[68:71]
  ds_read_b64_tr_b16 v[26:27], v10 offset:512
  s_waitcnt lgkmcnt(6)
  v_mfma_f32_16x16x32_bf16 v[76:79], v[148:151], v[44:47], v[76:79]
  ds_read_b64_tr_b16 v[28:29], v11 offset:0
  v_mfma_f32_16x16x32_bf16 v[72:75], v[144:147], v[44:47], v[72:75]
  ds_read_b64_tr_b16 v[30:31], v11 offset:512
  buffer_load_dwordx4 v[140:143], v89, s[8:11], s36 offen sc1
  s_waitcnt vmcnt(13) lgkmcnt(6)
  v_mfma_f32_16x16x32_bf16 v[48:51], v[152:155], v[16:19], v[48:51]
  ds_read_b64_tr_b16 v[32:33], v8 offset:4096
  s_waitcnt vmcnt(12)
  v_mfma_f32_16x16x32_bf16 v[52:55], v[156:159], v[16:19], v[52:55]
  ds_read_b64_tr_b16 v[34:35], v8 offset:4608
  v_add_u32 v8, s42, v8
  s_waitcnt lgkmcnt(6)
  v_mfma_f32_16x16x32_bf16 v[60:63], v[156:159], v[20:23], v[60:63]
  ds_read_b64_tr_b16 v[36:37], v9 offset:4096
  buffer_load_dwordx4 v[144:147], v90, s[8:11], s36 offen sc1
  v_mfma_f32_16x16x32_bf16 v[56:59], v[152:155], v[20:23], v[56:59]
  ds_read_b64_tr_b16 v[38:39], v9 offset:4608
  v_add_u32 v9, s42, v9
  s_waitcnt lgkmcnt(6)
  v_mfma_f32_16x16x32_bf16 v[64:67], v[152:155], v[24:27], v[64:67]
  ds_read_b64_tr_b16 v[40:41], v10 offset:4096
  v_mfma_f32_16x16x32_bf16 v[68:71], v[156:159], v[24:27], v[68:71]
  ds_read_b64_tr_b16 v[42:43], v10 offset:4608
  v_add_u32 v10, s42, v10
  s_waitcnt lgkmcnt(6)
  v_mfma_f32_16x16x32_bf16 v[76:79], v[156:159], v[28:31], v[76:79]
  ds_read_b64_tr_b16 v[44:45], v11 offset:4096
  buffer_load_dwordx4 v[148:151], v91, s[8:11], s36 offen sc1
  v_mfma_f32_16x16x32_bf16 v[72:75], v[152:155], v[28:31], v[72:75]
  ds_read_b64_tr_b16 v[46:47], v11 offset:4608
  v_add_u32 v11, s42, v11
  s_barrier
  s_waitcnt vmcnt(13) lgkmcnt(6)
  v_mfma_f32_16x16x32_bf16 v[48:51], v[160:163], v[32:35], v[48:51]
  ds_read_b64_tr_b16 v[16:17], v8 offset:0
  s_bitcmp1_b32 s48, 6
  s_cselect_b32 s36, s50, s49
  s_waitcnt vmcnt(12)
  v_mfma_f32_16x16x32_bf16 v[52:55], v[164:167], v[32:35], v[52:55]
  ds_read_b64_tr_b16 v[18:19], v8 offset:512
  s_add_u32 s36, s36, 49152
  s_add_u32 s40, s43, 8192
  s_waitcnt lgkmcnt(6)
  v_mfma_f32_16x16x32_bf16 v[60:63], v[164:167], v[36:39], v[60:63]
  ds_read_b64_tr_b16 v[20:21], v9 offset:0
  s_cmp_eq_u32 s40, 65536
  s_cselect_b32 s40, 0, s40
  v_mfma_f32_16x16x32_bf16 v[56:59], v[160:163], v[36:39], v[56:59]
  ds_read_b64_tr_b16 v[22:23], v9 offset:512
  s_sub_u32 s42, s40, s43
  s_mov_b32 s43, s40
  s_waitcnt lgkmcnt(6)
  v_mfma_f32_16x16x32_bf16 v[64:67], v[160:163], v[40:43], v[64:67]
  ds_read_b64_tr_b16 v[24:25], v10 offset:0
  buffer_load_dwordx4 v[152:155], v88, s[8:11], s36 offen sc1
  v_mfma_f32_16x16x32_bf16 v[68:71], v[164:167], v[40:43], v[68:71]
  ds_read_b64_tr_b16 v[26:27], v10 offset:512
  s_waitcnt lgkmcnt(6)
  v_mfma_f32_16x16x32_bf16 v[76:79], v[164:167], v[44:47], v[76:79]
  ds_read_b64_tr_b16 v[28:29], v11 offset:0
  v_mfma_f32_16x16x32_bf16 v[72:75], v[160:163], v[44:47], v[72:75]
  ds_read_b64_tr_b16 v[30:31], v11 offset:512
  buffer_load_dwordx4 v[156:159], v89, s[8:11], s36 offen sc1
  s_waitcnt vmcnt(13) lgkmcnt(6)
  v_mfma_f32_16x16x32_bf16 v[48:51], v[168:171], v[16:19], v[48:51]
  ds_read_b64_tr_b16 v[32:33], v8 offset:4096
  s_waitcnt vmcnt(12)
  v_mfma_f32_16x16x32_bf16 v[52:55], v[172:175], v[16:19], v[52:55]
  ds_read_b64_tr_b16 v[34:35], v8 offset:4608
  v_add_u32 v8, s42, v8
  s_waitcnt lgkmcnt(6)
  v_mfma_f32_16x16x32_bf16 v[60:63], v[172:175], v[20:23], v[60:63]
  ds_read_b64_tr_b16 v[36:37], v9 offset:4096
  buffer_load_dwordx4 v[160:163], v90, s[8:11], s36 offen sc1
  v_mfma_f32_16x16x32_bf16 v[56:59], v[168:171], v[20:23], v[56:59]
  ds_read_b64_tr_b16 v[38:39], v9 offset:4608
  v_add_u32 v9, s42, v9
  s_waitcnt lgkmcnt(6)
  v_mfma_f32_16x16x32_bf16 v[64:67], v[168:171], v[24:27], v[64:67]
  ds_read_b64_tr_b16 v[40:41], v10 offset:4096
  v_mfma_f32_16x16x32_bf16 v[68:71], v[172:175], v[24:27], v[68:71]
  ds_read_b64_tr_b16 v[42:43], v10 offset:4608
  v_add_u32 v10, s42, v10
  s_waitcnt lgkmcnt(6)
  v_mfma_f32_16x16x32_bf16 v[76:79], v[172:175], v[28:31], v[76:79]
  ds_read_b64_tr_b16 v[44:45], v11 offset:4096
  buffer_load_dwordx4 v[164:167], v91, s[8:11], s36 offen sc1
  v_mfma_f32_16x16x32_bf16 v[72:75], v[168:171], v[28:31], v[72:75]
  ds_read_b64_tr_b16 v[46:47], v11 offset:4608
  v_add_u32 v11, s42, v11
  s_barrier
  s_waitcnt vmcnt(13) lgkmcnt(6)
  v_mfma_f32_16x16x32_bf16 v[48:51], v[176:179], v[32:35], v[48:51]
  ds_read_b64_tr_b16 v[16:17], v8 offset:0
  s_bitcmp1_b32 s48, 7
  s_cselect_b32 s36, s50, s49
  s_waitcnt vmcnt(12)
  v_mfma_f32_16x16x32_bf16 v[52:55], v[180:183], v[32:35], v[52:55]
  ds_read_b64_tr_b16 v[18:19], v8 offset:512
  s_add_u32 s36, s36, 57344
  s_add_u32 s40, s43, 8192
  s_waitcnt lgkmcnt(6)
  v_mfma_f32_16x16x32_bf16 v[60:63], v[180:183], v[36:39], v[60:63]
  ds_read_b64_tr_b16 v[20:21], v9 offset:0
  s_cmp_eq_u32 s40, 65536
  s_cselect_b32 s40, 0, s40
  v_mfma_f32_16x16x32_bf16 v[56:59], v[176:179], v[36:39], v[56:59]
  ds_read_b64_tr_b16 v[22:23], v9 offset:512
  s_sub_u32 s42, s40, s43
  s_mov_b32 s43, s40
  s_waitcnt lgkmcnt(6)
  v_mfma_f32_16x16x32_bf16 v[64:67], v[176:179], v[40:43], v[64:67]
  ds_read_b64_tr_b16 v[24:25], v10 offset:0
  buffer_load_dwordx4 v[168:171], v88, s[8:11], s36 offen sc1
  v_mfma_f32_16x16x32_bf16 v[68:71], v[180:183], v[40:43], v[68:71]
  ds_read_b64_tr_b16 v[26:27], v10 offset:512
  s_waitcnt lgkmcnt(6)
  v_mfma_f32_16x16x32_bf16 v[76:79], v[180:183], v[44:47], v[76:79]
  ds_read_b64_tr_b16 v[28:29], v11 offset:0
  v_mfma_f32_16x16x32_bf16 v[72:75], v[176:179], v[44:47], v[72:75]
  ds_read_b64_tr_b16 v[30:31], v11 offset:512
  buffer_load_dwordx4 v[172:175], v89, s[8:11], s36 offen sc1
  s_waitcnt vmcnt(13) lgkmcnt(6)
  v_mfma_f32_16x16x32_bf16 v[48:51], v[120:123], v[16:19], v[48:51]
  ds_read_b64_tr_b16 v[32:33], v8 offset:4096
  s_waitcnt vmcnt(12)
  v_mfma_f32_16x16x32_bf16 v[52:55], v[124:127], v[16:19], v[52:55]
  ds_read_b64_tr_b16 v[34:35], v8 offset:4608
  v_add_u32 v8, s42, v8
  s_waitcnt lgkmcnt(6)
  v_mfma_f32_16x16x32_bf16 v[60:63], v[124:127], v[20:23], v[60:63]
  ds_read_b64_tr_b16 v[36:37], v9 offset:4096
  buffer_load_dwordx4 v[176:179], v90, s[8:11], s36 offen sc1
  v_mfma_f32_16x16x32_bf16 v[56:59], v[120:123], v[20:23], v[56:59]
  ds_read_b64_tr_b16 v[38:39], v9 offset:4608
  v_add_u32 v9, s42, v9
  s_waitcnt lgkmcnt(6)
  v_mfma_f32_16x16x32_bf16 v[64:67], v[120:123], v[24:27], v[64:67]
  ds_read_b64_tr_b16 v[40:41], v10 offset:4096
  v_mfma_f32_16x16x32_bf16 v[68:71], v[124:127], v[24:27], v[68:71]
  ds_read_b64_tr_b16 v[42:43], v10 offset:4608
  v_add_u32 v10, s42, v10
  s_waitcnt lgkmcnt(6)
  v_mfma_f32_16x16x32_bf16 v[76:79], v[124:127], v[28:31], v[76:79]
  ds_read_b64_tr_b16 v[44:45], v11 offset:4096
  buffer_load_dwordx4 v[180:183], v91, s[8:11], s36 offen sc1
  v_mfma_f32_16x16x32_bf16 v[72:75], v[120:123], v[28:31], v[72:75]
  ds_read_b64_tr_b16 v[46:47], v11 offset:4608
  v_add_u32 v11, s42, v11
  s_barrier
  s_waitcnt vmcnt(13) lgkmcnt(6)
  v_mfma_f32_16x16x32_bf16 v[48:51], v[128:131], v[32:35], v[48:51]
  ds_read_b64_tr_b16 v[16:17], v8 offset:0
  s_mov_b32 s49, s50
  s_add_u32 s50, s50, 65536
  s_waitcnt vmcnt(12)
  v_mfma_f32_16x16x32_bf16 v[52:55], v[132:135], v[32:35], v[52:55]
  ds_read_b64_tr_b16 v[18:19], v8 offset:512
  s_cmp_eq_u32 s50, s41
  s_cselect_b32 s50, s34, s50
  s_waitcnt lgkmcnt(6)
  v_mfma_f32_16x16x32_bf16 v[60:63], v[132:135], v[36:39], v[60:63]
  ds_read_b64_tr_b16 v[20:21], v9 offset:0
  s_bitcmp1_b32 s48, 0
  s_cselect_b32 s36, s50, s49
  v_mfma_f32_16x16x32_bf16 v[56:59], v[128:131], v[36:39], v[56:59]
  ds_read_b64_tr_b16 v[22:23], v9 offset:512
  s_add_u32 s36, s36, 0
  s_add_u32 s40, s43, 8192
  s_waitcnt lgkmcnt(6)
  v_mfma_f32_16x16x32_bf16 v[64:67], v[128:131], v[40:43], v[64:67]
  ds_read_b64_tr_b16 v[24:25], v10 offset:0
  s_cmp_eq_u32 s40, 65536
  s_cselect_b32 s40, 0, s40
  buffer_load_dwordx4 v[120:123], v88, s[8:11], s36 offen sc1
  v_mfma_f32_16x16x32_bf16 v[68:71], v[132:135], v[40:43], v[68:71]
  ds_read_b64_tr_b16 v[26:27], v10 offset:512
  s_sub_u32 s42, s40, s43
  s_mov_b32 s43, s40
  s_waitcnt lgkmcnt(6)
  v_mfma_f32_16x16x32_bf16 v[76:79], v[132:135], v[44:47], v[76:79]
  ds_read_b64_tr_b16 v[28:29], v11 offset:0
  v_mfma_f32_16x16x32_bf16 v[72:75], v[128:131], v[44:47], v[72:75]
  ds_read_b64_tr_b16 v[30:31], v11 offset:512
  buffer_load_dwordx4 v[124:127], v89, s[8:11], s36 offen sc1
  s_waitcnt vmcnt(13) lgkmcnt(6)
  v_mfma_f32_16x16x32_bf16 v[48:51], v[136:139], v[16:19], v[48:51]
  ds_read_b64_tr_b16 v[32:33], v8 offset:4096
  s_waitcnt vmcnt(12)
  v_mfma_f32_16x16x32_bf16 v[52:55], v[140:143], v[16:19], v[52:55]
  ds_read_b64_tr_b16 v[34:35], v8 offset:4608
  v_add_u32 v8, s42, v8
  s_waitcnt lgkmcnt(6)
  v_mfma_f32_16x16x32_bf16 v[60:63], v[140:143], v[20:23], v[60:63]
  ds_read_b64_tr_b16 v[36:37], v9 offset:4096
  buffer_load_dwordx4 v[128:131], v90, s[8:11], s36 offen sc1
  v_mfma_f32_16x16x32_bf16 v[56:59], v[136:139], v[20:23], v[56:59]
  ds_read_b64_tr_b16 v[38:39], v9 offset:4608
  v_add_u32 v9, s42, v9
  s_waitcnt lgkmcnt(6)
  v_mfma_f32_16x16x32_bf16 v[64:67], v[136:139], v[24:27], v[64:67]
  ds_read_b64_tr_b16 v[40:41], v10 offset:4096
  v_mfma_f32_16x16x32_bf16 v[68:71], v[140:143], v[24:27], v[68:71]
  ds_read_b64_tr_b16 v[42:43], v10 offset:4608
  v_add_u32 v10, s42, v10
  s_waitcnt lgkmcnt(6)
  v_mfma_f32_16x16x32_bf16 v[76:79], v[140:143], v[28:31], v[76:79]
  ds_read_b64_tr_b16 v[44:45], v11 offset:4096
  buffer_load_dwordx4 v[132:135], v91, s[8:11], s36 offen sc1
  v_mfma_f32_16x16x32_bf16 v[72:75], v[136:139], v[28:31], v[72:75]
  ds_read_b64_tr_b16 v[46:47], v11 offset:4608
  v_add_u32 v11, s42, v11
  s_barrier
  s_waitcnt vmcnt(13) lgkmcnt(6)
  v_mfma_f32_16x16x32_bf16 v[48:51], v[144:147], v[32:35], v[48:51]
  ds_read_b64_tr_b16 v[16:17], v8 offset:0
  s_bitcmp1_b32 s48, 1
  s_cselect_b32 s36, s50, s49
  s_waitcnt vmcnt(12)
  v_mfma_f32_16x16x32_bf16 v[52:55], v[148:151], v[32:35], v[52:55]
  ds_read_b64_tr_b16 v[18:19], v8 offset:512
  s_add_u32 s36, s36, 8192
  s_add_u32 s40, s43, 8192
  s_waitcnt lgkmcnt(6)
  v_mfma_f32_16x16x32_bf16 v[60:63], v[148:151], v[36:39], v[60:63]
  ds_read_b64_tr_b16 v[20:21], v9 offset:0
  s_cmp_eq_u32 s40, 65536
  s_cselect_b32 s40, 0, s40
  v_mfma_f32_16x16x32_bf16 v[56:59], v[144:147], v[36:39], v[56:59]
  ds_read_b64_tr_b16 v[22:23], v9 offset:512
  s_sub_u32 s42, s40, s43
  s_mov_b32 s43, s40
  s_waitcnt lgkmcnt(6)
  v_mfma_f32_16x16x32_bf16 v[64:67], v[144:147], v[40:43], v[64:67]
  ds_read_b64_tr_b16 v[24:25], v10 offset:0
  buffer_load_dwordx4 v[136:139], v88, s[8:11], s36 offen sc1
  v_mfma_f32_16x16x32_bf16 v[68:71], v[148:151], v[40:43], v[68:71]
  ds_read_b64_tr_b16 v[26:27], v10 offset:512
  s_waitcnt lgkmcnt(6)
  v_mfma_f32_16x16x32_bf16 v[76:79], v[148:151], v[44:47], v[76:79]
  ds_read_b64_tr_b16 v[28:29], v11 offset:0
  v_mfma_f32_16x16x32_bf16 v[72:75], v[144:147], v[44:47], v[72:75]
  ds_read_b64_tr_b16 v[30:31], v11 offset:512
  buffer_load_dwordx4 v[140:143], v89, s[8:11], s36 offen sc1
  s_waitcnt vmcnt(13) lgkmcnt(6)
  v_mfma_f32_16x16x32_bf16 v[48:51], v[152:155], v[16:19], v[48:51]
  ds_read_b64_tr_b16 v[32:33], v8 offset:4096
  s_waitcnt vmcnt(12)
  v_mfma_f32_16x16x32_bf16 v[52:55], v[156:159], v[16:19], v[52:55]
  ds_read_b64_tr_b16 v[34:35], v8 offset:4608
  v_add_u32 v8, s42, v8
  s_waitcnt lgkmcnt(6)
  v_mfma_f32_16x16x32_bf16 v[60:63], v[156:159], v[20:23], v[60:63]
  ds_read_b64_tr_b16 v[36:37], v9 offset:4096
  buffer_load_dwordx4 v[144:147], v90, s[8:11], s36 offen sc1
  v_mfma_f32_16x16x32_bf16 v[56:59], v[152:155], v[20:23], v[56:59]
  ds_read_b64_tr_b16 v[38:39], v9 offset:4608
  v_add_u32 v9, s42, v9
  s_waitcnt lgkmcnt(6)
  v_mfma_f32_16x16x32_bf16 v[64:67], v[152:155], v[24:27], v[64:67]
  ds_read_b64_tr_b16 v[40:41], v10 offset:4096
  v_mfma_f32_16x16x32_bf16 v[68:71], v[156:159], v[24:27], v[68:71]
  ds_read_b64_tr_b16 v[42:43], v10 offset:4608
  v_add_u32 v10, s42, v10
  s_waitcnt lgkmcnt(6)
  v_mfma_f32_16x16x32_bf16 v[76:79], v[156:159], v[28:31], v[76:79]
  ds_read_b64_tr_b16 v[44:45], v11 offset:4096
  buffer_load_dwordx4 v[148:151], v91, s[8:11], s36 offen sc1
  v_mfma_f32_16x16x32_bf16 v[72:75], v[152:155], v[28:31], v[72:75]
  ds_read_b64_tr_b16 v[46:47], v11 offset:4608
  v_add_u32 v11, s42, v11
  s_barrier
  s_waitcnt vmcnt(13) lgkmcnt(6)
  v_mfma_f32_16x16x32_bf16 v[48:51], v[160:163], v[32:35], v[48:51]
  ds_read_b64_tr_b16 v[16:17], v8 offset:0
  s_bitcmp1_b32 s48, 2
  s_cselect_b32 s36, s50, s49
  s_waitcnt vmcnt(12)
  v_mfma_f32_16x16x32_bf16 v[52:55], v[164:167], v[32:35], v[52:55]
  ds_read_b64_tr_b16 v[18:19], v8 offset:512
  s_add_u32 s36, s36, 16384
  s_add_u32 s40, s43, 8192
  s_waitcnt lgkmcnt(6)
  v_mfma_f32_16x16x32_bf16 v[60:63], v[164:167], v[36:39], v[60:63]
  ds_read_b64_tr_b16 v[20:21], v9 offset:0
  s_cmp_eq_u32 s40, 65536
  s_cselect_b32 s40, 0, s40
  v_mfma_f32_16x16x32_bf16 v[56:59], v[160:163], v[36:39], v[56:59]
  ds_read_b64_tr_b16 v[22:23], v9 offset:512
  s_sub_u32 s42, s40, s43
  s_mov_b32 s43, s40
  s_waitcnt lgkmcnt(6)
  v_mfma_f32_16x16x32_bf16 v[64:67], v[160:163], v[40:43], v[64:67]
  ds_read_b64_tr_b16 v[24:25], v10 offset:0
  buffer_load_dwordx4 v[152:155], v88, s[8:11], s36 offen sc1
  v_mfma_f32_16x16x32_bf16 v[68:71], v[164:167], v[40:43], v[68:71]
  ds_read_b64_tr_b16 v[26:27], v10 offset:512
  s_waitcnt lgkmcnt(6)
  v_mfma_f32_16x16x32_bf16 v[76:79], v[164:167], v[44:47], v[76:79]
  ds_read_b64_tr_b16 v[28:29], v11 offset:0
  v_mfma_f32_16x16x32_bf16 v[72:75], v[160:163], v[44:47], v[72:75]
  ds_read_b64_tr_b16 v[30:31], v11 offset:512
  buffer_load_dwordx4 v[156:159], v89, s[8:11], s36 offen sc1
  s_waitcnt vmcnt(13) lgkmcnt(6)
  v_mfma_f32_16x16x32_bf16 v[48:51], v[168:171], v[16:19], v[48:51]
  ds_read_b64_tr_b16 v[32:33], v8 offset:4096
  s_waitcnt vmcnt(12)
  v_mfma_f32_16x16x32_bf16 v[52:55], v[172:175], v[16:19], v[52:55]
  ds_read_b64_tr_b16 v[34:35], v8 offset:4608
  v_add_u32 v8, s42, v8
  s_waitcnt lgkmcnt(6)
  v_mfma_f32_16x16x32_bf16 v[60:63], v[172:175], v[20:23], v[60:63]
  ds_read_b64_tr_b16 v[36:37], v9 offset:4096
  buffer_load_dwordx4 v[160:163], v90, s[8:11], s36 offen sc1
  v_mfma_f32_16x16x32_bf16 v[56:59], v[168:171], v[20:23], v[56:59]
  ds_read_b64_tr_b16 v[38:39], v9 offset:4608
  v_add_u32 v9, s42, v9
  s_waitcnt lgkmcnt(6)
  v_mfma_f32_16x16x32_bf16 v[64:67], v[168:171], v[24:27], v[64:67]
  ds_read_b64_tr_b16 v[40:41], v10 offset:4096
  v_mfma_f32_16x16x32_bf16 v[68:71], v[172:175], v[24:27], v[68:71]
  ds_read_b64_tr_b16 v[42:43], v10 offset:4608
  v_add_u32 v10, s42, v10
  s_waitcnt lgkmcnt(6)
  v_mfma_f32_16x16x32_bf16 v[76:79], v[172:175], v[28:31], v[76:79]
  ds_read_b64_tr_b16 v[44:45], v11 offset:4096
  buffer_load_dwordx4 v[164:167], v91, s[8:11], s36 offen sc1
  v_mfma_f32_16x16x32_bf16 v[72:75], v[168:171], v[28:31], v[72:75]
  ds_read_b64_tr_b16 v[46:47], v11 offset:4608
  v_add_u32 v11, s42, v11
  s_barrier
  s_waitcnt vmcnt(13) lgkmcnt(6)
  v_mfma_f32_16x16x32_bf16 v[48:51], v[176:179], v[32:35], v[48:51]
  ds_read_b64_tr_b16 v[16:17], v8 offset:0
  s_bitcmp1_b32 s48, 3
  s_cselect_b32 s36, s50, s49
  s_waitcnt vmcnt(12)
  v_mfma_f32_16x16x32_bf16 v[52:55], v[180:183], v[32:35], v[52:55]
  ds_read_b64_tr_b16 v[18:19], v8 offset:512
  s_add_u32 s36, s36, 24576
  s_add_u32 s40, s43, 8192
  s_waitcnt lgkmcnt(6)
  v_mfma_f32_16x16x32_bf16 v[60:63], v[180:183], v[36:39], v[60:63]
  ds_read_b64_tr_b16 v[20:21], v9 offset:0
  s_cmp_eq_u32 s40, 65536
  s_cselect_b32 s40, 0, s40
  v_mfma_f32_16x16x32_bf16 v[56:59], v[176:179], v[36:39], v[56:59]
  ds_read_b64_tr_b16 v[22:23], v9 offset:512
  s_sub_u32 s42, s40, s43
  s_mov_b32 s43, s40
  s_waitcnt lgkmcnt(6)
  v_mfma_f32_16x16x32_bf16 v[64:67], v[176:179], v[40:43], v[64:67]
  ds_read_b64_tr_b16 v[24:25], v10 offset:0
  buffer_load_dwordx4 v[168:171], v88, s[8:11], s36 offen sc1
  v_mfma_f32_16x16x32_bf16 v[68:71], v[180:183], v[40:43], v[68:71]
  ds_read_b64_tr_b16 v[26:27], v10 offset:512
  s_waitcnt lgkmcnt(6)
  v_mfma_f32_16x16x32_bf16 v[76:79], v[180:183], v[44:47], v[76:79]
  ds_read_b64_tr_b16 v[28:29], v11 offset:0
  v_mfma_f32_16x16x32_bf16 v[72:75], v[176:179], v[44:47], v[72:75]
  ds_read_b64_tr_b16 v[30:31], v11 offset:512
  buffer_load_dwordx4 v[172:175], v89, s[8:11], s36 offen sc1
  s_sub_u32 s39, s39, 1
  s_cmp_lg_u32 s39, 0
  s_cbranch_scc1 cd6
  s_waitcnt vmcnt(13) lgkmcnt(6)
  v_mfma_f32_16x16x32_bf16 v[48:51], v[120:123], v[16:19], v[48:51]
  ds_read_b64_tr_b16 v[32:33], v8 offset:4096
  s_waitcnt vmcnt(12)
  v_mfma_f32_16x16x32_bf16 v[52:55], v[124:127], v[16:19], v[52:55]
  ds_read_b64_tr_b16 v[34:35], v8 offset:4608
  v_add_u32 v8, s42, v8
  s_waitcnt lgkmcnt(6)
  v_mfma_f32_16x16x32_bf16 v[60:63], v[124:127], v[20:23], v[60:63]
  ds_read_b64_tr_b16 v[36:37], v9 offset:4096
  buffer_load_dwordx4 v[176:179], v90, s[8:11], s36 offen sc1
  v_mfma_f32_16x16x32_bf16 v[56:59], v[120:123], v[20:23], v[56:59]
  ds_read_b64_tr_b16 v[38:39], v9 offset:4608
  v_add_u32 v9, s42, v9
  s_waitcnt lgkmcnt(6)
  v_mfma_f32_16x16x32_bf16 v[64:67], v[120:123], v[24:27], v[64:67]
  ds_read_b64_tr_b16 v[40:41], v10 offset:4096
  v_mfma_f32_16x16x32_bf16 v[68:71], v[124:127], v[24:27], v[68:71]
  ds_read_b64_tr_b16 v[42:43], v10 offset:4608
  v_add_u32 v10, s42, v10
  s_waitcnt lgkmcnt(6)
  v_mfma_f32_16x16x32_bf16 v[76:79], v[124:127], v[28:31], v[76:79]
  ds_read_b64_tr_b16 v[44:45], v11 offset:4096
  buffer_load_dwordx4 v[180:183], v91, s[8:11], s36 offen sc1
  v_mfma_f32_16x16x32_bf16 v[72:75], v[120:123], v[28:31], v[72:75]
  ds_read_b64_tr_b16 v[46:47], v11 offset:4608
  v_add_u32 v11, s42, v11
  s_barrier
  s_waitcnt vmcnt(13) lgkmcnt(6)
  v_mfma_f32_16x16x32_bf16 v[48:51], v[128:131], v[32:35], v[48:51]
  ds_read_b64_tr_b16 v[16:17], v8 offset:0
  s_bitcmp1_b32 s48, 4
  s_cselect_b32 s36, s50, s49
  s_waitcnt vmcnt(12)
  v_mfma_f32_16x16x32_bf16 v[52:55], v[132:135], v[32:35], v[52:55]
  ds_read_b64_tr_b16 v[18:19], v8 offset:512
  s_add_u32 s36, s36, 32768
  s_add_u32 s40, s43, 8192
  s_waitcnt lgkmcnt(6)
  v_mfma_f32_16x16x32_bf16 v[60:63], v[132:135], v[36:39], v[60:63]
  ds_read_b64_tr_b16 v[20:21], v9 offset:0
  s_cmp_eq_u32 s40, 65536
  s_cselect_b32 s40, 0, s40
  v_mfma_f32_16x16x32_bf16 v[56:59], v[128:131], v[36:39], v[56:59]
  ds_read_b64_tr_b16 v[22:23], v9 offset:512
  s_sub_u32 s42, s40, s43
  s_mov_b32 s43, s40
  s_waitcnt lgkmcnt(6)
  v_mfma_f32_16x16x32_bf16 v[64:67], v[128:131], v[40:43], v[64:67]
  ds_read_b64_tr_b16 v[24:25], v10 offset:0
  buffer_load_dwordx4 v[120:123], v88, s[8:11], s36 offen sc1
  v_mfma_f32_16x16x32_bf16 v[68:71], v[132:135], v[40:43], v[68:71]
  ds_read_b64_tr_b16 v[26:27], v10 offset:512
  s_waitcnt lgkmcnt(6)
  v_mfma_f32_16x16x32_bf16 v[76:79], v[132:135], v[44:47], v[76:79]
  ds_read_b64_tr_b16 v[28:29], v11 offset:0
  v_mfma_f32_16x16x32_bf16 v[72:75], v[128:131], v[44:47], v[72:75]
  ds_read_b64_tr_b16 v[30:31], v11 offset:512
  buffer_load_dwordx4 v[124:127], v89, s[8:11], s36 offen sc1
  s_waitcnt vmcnt(13) lgkmcnt(6)
  v_mfma_f32_16x16x32_bf16 v[48:51], v[136:139], v[16:19], v[48:51]
  ds_read_b64_tr_b16 v[32:33], v8 offset:4096
  s_waitcnt vmcnt(12)
  v_mfma_f32_16x16x32_bf16 v[52:55], v[140:143], v[16:19], v[52:55]
  ds_read_b64_tr_b16 v[34:35], v8 offset:4608
  v_add_u32 v8, s42, v8
  s_waitcnt lgkmcnt(6)
  v_mfma_f32_16x16x32_bf16 v[60:63], v[140:143], v[20:23], v[60:63]
  ds_read_b64_tr_b16 v[36:37], v9 offset:4096
  buffer_load_dwordx4 v[128:131], v90, s[8:11], s36 offen sc1
  v_mfma_f32_16x16x32_bf16 v[56:59], v[136:139], v[20:23], v[56:59]
  ds_read_b64_tr_b16 v[38:39], v9 offset:4608
  v_add_u32 v9, s42, v9
  s_waitcnt lgkmcnt(6)
  v_mfma_f32_16x16x32_bf16 v[64:67], v[136:139], v[24:27], v[64:67]
  ds_read_b64_tr_b16 v[40:41], v10 offset:4096
  v_mfma_f32_16x16x32_bf16 v[68:71], v[140:143], v[24:27], v[68:71]
  ds_read_b64_tr_b16 v[42:43], v10 offset:4608
  v_add_u32 v10, s42, v10
  s_waitcnt lgkmcnt(6)
  v_mfma_f32_16x16x32_bf16 v[76:79], v[140:143], v[28:31], v[76:79]
  ds_read_b64_tr_b16 v[44:45], v11 offset:4096
  buffer_load_dwordx4 v[132:135], v91, s[8:11], s36 offen sc1
  v_mfma_f32_16x16x32_bf16 v[72:75], v[136:139], v[28:31], v[72:75]
  ds_read_b64_tr_b16 v[46:47], v11 offset:4608
  v_add_u32 v11, s42, v11
  s_barrier
  s_waitcnt vmcnt(13) lgkmcnt(6)
  v_mfma_f32_16x16x32_bf16 v[48:51], v[144:147], v[32:35], v[48:51]
  ds_read_b64_tr_b16 v[16:17], v8 offset:0
  s_bitcmp1_b32 s48, 5
  s_cselect_b32 s36, s50, s49
  s_waitcnt vmcnt(12)
  v_mfma_f32_16x16x32_bf16 v[52:55], v[148:151], v[32:35], v[52:55]
  ds_read_b64_tr_b16 v[18:19], v8 offset:512
  s_add_u32 s36, s36, 40960
  s_add_u32 s40, s43, 8192
  s_waitcnt lgkmcnt(6)
  v_mfma_f32_16x16x32_bf16 v[60:63], v[148:151], v[36:39], v[60:63]
  ds_read_b64_tr_b16 v[20:21], v9 offset:0
  s_cmp_eq_u32 s40, 65536
  s_cselect_b32 s40, 0, s40
  v_mfma_f32_16x16x32_bf16 v[56:59], v[144:147], v[36:39], v[56:59]
  ds_read_b64_tr_b16 v[22:23], v9 offset:512
  s_sub_u32 s42, s40, s43
  s_mov_b32 s43, s40
  s_waitcnt lgkmcnt(6)
  v_mfma_f32_16x16x32_bf16 v[64:67], v[144:147], v[40:43], v[64:67]
  ds_read_b64_tr_b16 v[24:25], v10 offset:0
  buffer_load_dwordx4 v[136:139], v88, s[8:11], s36 offen sc1
  v_mfma_f32_16x16x32_bf16 v[68:71], v[148:151], v[40:43], v[68:71]
  ds_read_b64_tr_b16 v[26:27], v10 offset:512
  s_waitcnt lgkmcnt(6)
  v_mfma_f32_16x16x32_bf16 v[76:79], v[148:151], v[44:47], v[76:79]
  ds_read_b64_tr_b16 v[28:29], v11 offset:0
  v_mfma_f32_16x16x32_bf16 v[72:75], v[144:147], v[44:47], v[72:75]
  ds_read_b64_tr_b16 v[30:31], v11 offset:512
  buffer_load_dwordx4 v[140:143], v89, s[8:11], s36 offen sc1
  s_waitcnt vmcnt(13) lgkmcnt(6)
  v_mfma_f32_16x16x32_bf16 v[48:51], v[152:155], v[16:19], v[48:51]
  ds_read_b64_tr_b16 v[32:33], v8 offset:4096
  s_waitcnt vmcnt(12)
  v_mfma_f32_16x16x32_bf16 v[52:55], v[156:159], v[16:19], v[52:55]
  ds_read_b64_tr_b16 v[34:35], v8 offset:4608
  v_add_u32 v8, s42, v8
  s_waitcnt lgkmcnt(6)
  v_mfma_f32_16x16x32_bf16 v[60:63], v[156:159], v[20:23], v[60:63]
  ds_read_b64_tr_b16 v[36:37], v9 offset:4096
  buffer_load_dwordx4 v[144:147], v90, s[8:11], s36 offen sc1
  v_mfma_f32_16x16x32_bf16 v[56:59], v[152:155], v[20:23], v[56:59]
  ds_read_b64_tr_b16 v[38:39], v9 offset:4608
  v_add_u32 v9, s42, v9
  s_waitcnt lgkmcnt(6)
  v_mfma_f32_16x16x32_bf16 v[64:67], v[152:155], v[24:27], v[64:67]
  ds_read_b64_tr_b16 v[40:41], v10 offset:4096
  v_mfma_f32_16x16x32_bf16 v[68:71], v[156:159], v[24:27], v[68:71]
  ds_read_b64_tr_b16 v[42:43], v10 offset:4608
  v_add_u32 v10, s42, v10
  s_waitcnt lgkmcnt(6)
  v_mfma_f32_16x16x32_bf16 v[76:79], v[156:159], v[28:31], v[76:79]
  ds_read_b64_tr_b16 v[44:45], v11 offset:4096
  buffer_load_dwordx4 v[148:151], v91, s[8:11], s36 offen sc1
  v_mfma_f32_16x16x32_bf16 v[72:75], v[152:155], v[28:31], v[72:75]
  ds_read_b64_tr_b16 v[46:47], v11 offset:4608
  v_add_u32 v11, s42, v11
  s_barrier
  s_waitcnt vmcnt(13) lgkmcnt(6)
  v_mfma_f32_16x16x32_bf16 v[48:51], v[160:163], v[32:35], v[48:51]
  ds_read_b64_tr_b16 v[16:17], v8 offset:0
  s_bitcmp1_b32 s48, 6
  s_cselect_b32 s36, s50, s49
  s_waitcnt vmcnt(12)
  v_mfma_f32_16x16x32_bf16 v[52:55], v[164:167], v[32:35], v[52:55]
  ds_read_b64_tr_b16 v[18:19], v8 offset:512
  s_add_u32 s36, s36, 49152
  s_add_u32 s40, s43, 8192
  s_waitcnt lgkmcnt(6)
  v_mfma_f32_16x16x32_bf16 v[60:63], v[164:167], v[36:39], v[60:63]
  ds_read_b64_tr_b16 v[20:21], v9 offset:0
  s_cmp_eq_u32 s40, 65536
  s_cselect_b32 s40, 0, s40
  v_mfma_f32_16x16x32_bf16 v[56:59], v[160:163], v[36:39], v[56:59]
  ds_read_b64_tr_b16 v[22:23], v9 offset:512
  s_sub_u32 s42, s40, s43
  s_mov_b32 s43, s40
  s_waitcnt lgkmcnt(6)
  v_mfma_f32_16x16x32_bf16 v[64:67], v[160:163], v[40:43], v[64:67]
  ds_read_b64_tr_b16 v[24:25], v10 offset:0
  buffer_load_dwordx4 v[152:155], v88, s[8:11], s36 offen sc1
  v_mfma_f32_16x16x32_bf16 v[68:71], v[164:167], v[40:43], v[68:71]
  ds_read_b64_tr_b16 v[26:27], v10 offset:512
  s_waitcnt lgkmcnt(6)
  v_mfma_f32_16x16x32_bf16 v[76:79], v[164:167], v[44:47], v[76:79]
  ds_read_b64_tr_b16 v[28:29], v11 offset:0
  v_mfma_f32_16x16x32_bf16 v[72:75], v[160:163], v[44:47], v[72:75]
  ds_read_b64_tr_b16 v[30:31], v11 offset:512
  buffer_load_dwordx4 v[156:159], v89, s[8:11], s36 offen sc1
  s_waitcnt vmcnt(13) lgkmcnt(6)
  v_mfma_f32_16x16x32_bf16 v[48:51], v[168:171], v[16:19], v[48:51]
  ds_read_b64_tr_b16 v[32:33], v8 offset:4096
  s_waitcnt vmcnt(12)
  v_mfma_f32_16x16x32_bf16 v[52:55], v[172:175], v[16:19], v[52:55]
  ds_read_b64_tr_b16 v[34:35], v8 offset:4608
  v_add_u32 v8, s42, v8
  s_waitcnt lgkmcnt(6)
  v_mfma_f32_16x16x32_bf16 v[60:63], v[172:175], v[20:23], v[60:63]
  ds_read_b64_tr_b16 v[36:37], v9 offset:4096
  buffer_load_dwordx4 v[160:163], v90, s[8:11], s36 offen sc1
  v_mfma_f32_16x16x32_bf16 v[56:59], v[168:171], v[20:23], v[56:59]
  ds_read_b64_tr_b16 v[38:39], v9 offset:4608
  v_add_u32 v9, s42, v9
  s_waitcnt lgkmcnt(6)
  v_mfma_f32_16x16x32_bf16 v[64:67], v[168:171], v[24:27], v[64:67]
  ds_read_b64_tr_b16 v[40:41], v10 offset:4096
  v_mfma_f32_16x16x32_bf16 v[68:71], v[172:175], v[24:27], v[68:71]
  ds_read_b64_tr_b16 v[42:43], v10 offset:4608
  v_add_u32 v10, s42, v10
  s_waitcnt lgkmcnt(6)
  v_mfma_f32_16x16x32_bf16 v[76:79], v[172:175], v[28:31], v[76:79]
  ds_read_b64_tr_b16 v[44:45], v11 offset:4096
  buffer_load_dwordx4 v[164:167], v91, s[8:11], s36 offen sc1
  v_mfma_f32_16x16x32_bf16 v[72:75], v[168:171], v[28:31], v[72:75]
  ds_read_b64_tr_b16 v[46:47], v11 offset:4608
  v_add_u32 v11, s42, v11
  s_barrier
  s_waitcnt vmcnt(13) lgkmcnt(6)
  v_mfma_f32_16x16x32_bf16 v[48:51], v[176:179], v[32:35], v[48:51]
  ds_read_b64_tr_b16 v[16:17], v8 offset:0
  s_bitcmp1_b32 s48, 7
  s_cselect_b32 s36, s50, s49
  s_waitcnt vmcnt(12)
  v_mfma_f32_16x16x32_bf16 v[52:55], v[180:183], v[32:35], v[52:55]
  ds_read_b64_tr_b16 v[18:19], v8 offset:512
  s_add_u32 s36, s36, 57344
  s_add_u32 s40, s43, 8192
  s_waitcnt lgkmcnt(6)
  v_mfma_f32_16x16x32_bf16 v[60:63], v[180:183], v[36:39], v[60:63]
  ds_read_b64_tr_b16 v[20:21], v9 offset:0
  s_cmp_eq_u32 s40, 65536
  s_cselect_b32 s40, 0, s40
  v_mfma_f32_16x16x32_bf16 v[56:59], v[176:179], v[36:39], v[56:59]
  ds_read_b64_tr_b16 v[22:23], v9 offset:512
  s_sub_u32 s42, s40, s43
  s_mov_b32 s43, s40
  s_waitcnt lgkmcnt(6)
  v_mfma_f32_16x16x32_bf16 v[64:67], v[176:179], v[40:43], v[64:67]
  ds_read_b64_tr_b16 v[24:25], v10 offset:0
  buffer_load_dwordx4 v[168:171], v88, s[8:11], s36 offen sc1
  v_mfma_f32_16x16x32_bf16 v[68:71], v[180:183], v[40:43], v[68:71]
  ds_read_b64_tr_b16 v[26:27], v10 offset:512
  s_waitcnt lgkmcnt(6)
  v_mfma_f32_16x16x32_bf16 v[76:79], v[180:183], v[44:47], v[76:79]
  ds_read_b64_tr_b16 v[28:29], v11 offset:0
  v_mfma_f32_16x16x32_bf16 v[72:75], v[176:179], v[44:47], v[72:75]
  ds_read_b64_tr_b16 v[30:31], v11 offset:512
  buffer_load_dwordx4 v[172:175], v89, s[8:11], s36 offen sc1
  s_waitcnt vmcnt(13) lgkmcnt(6)
  v_mfma_f32_16x16x32_bf16 v[48:51], v[120:123], v[16:19], v[48:51]
  ds_read_b64_tr_b16 v[32:33], v8 offset:4096
  s_waitcnt vmcnt(12)
  v_mfma_f32_16x16x32_bf16 v[52:55], v[124:127], v[16:19], v[52:55]
  ds_read_b64_tr_b16 v[34:35], v8 offset:4608
  v_add_u32 v8, s42, v8
  s_waitcnt lgkmcnt(6)
  v_mfma_f32_16x16x32_bf16 v[60:63], v[124:127], v[20:23], v[60:63]
  ds_read_b64_tr_b16 v[36:37], v9 offset:4096
  buffer_load_dwordx4 v[176:179], v90, s[8:11], s36 offen sc1
  v_mfma_f32_16x16x32_bf16 v[56:59], v[120:123], v[20:23], v[56:59]
  ds_read_b64_tr_b16 v[38:39], v9 offset:4608
  v_add_u32 v9, s42, v9
  s_waitcnt lgkmcnt(6)
  v_mfma_f32_16x16x32_bf16 v[64:67], v[120:123], v[24:27], v[64:67]
  ds_read_b64_tr_b16 v[40:41], v10 offset:4096
  v_mfma_f32_16x16x32_bf16 v[68:71], v[124:127], v[24:27], v[68:71]
  ds_read_b64_tr_b16 v[42:43], v10 offset:4608
  v_add_u32 v10, s42, v10
  s_waitcnt lgkmcnt(6)
  v_mfma_f32_16x16x32_bf16 v[76:79], v[124:127], v[28:31], v[76:79]
  ds_read_b64_tr_b16 v[44:45], v11 offset:4096
  buffer_load_dwordx4 v[180:183], v91, s[8:11], s36 offen sc1
  v_mfma_f32_16x16x32_bf16 v[72:75], v[120:123], v[28:31], v[72:75]
  ds_read_b64_tr_b16 v[46:47], v11 offset:4608
  v_add_u32 v11, s42, v11
  s_barrier
  s_waitcnt vmcnt(13) lgkmcnt(6)
  v_mfma_f32_16x16x32_bf16 v[48:51], v[128:131], v[32:35], v[48:51]
  ds_read_b64_tr_b16 v[16:17], v8 offset:0
  s_add_u32 s40, s43, 8192
  s_cmp_eq_u32 s40, 65536
  s_waitcnt vmcnt(12)
  v_mfma_f32_16x16x32_bf16 v[52:55], v[132:135], v[32:35], v[52:55]
  ds_read_b64_tr_b16 v[18:19], v8 offset:512
  s_cselect_b32 s40, 0, s40
  s_sub_u32 s42, s40, s43
  s_waitcnt lgkmcnt(6)
  v_mfma_f32_16x16x32_bf16 v[60:63], v[132:135], v[36:39], v[60:63]
  ds_read_b64_tr_b16 v[20:21], v9 offset:0
  s_mov_b32 s43, s40
  v_mfma_f32_16x16x32_bf16 v[56:59], v[128:131], v[36:39], v[56:59]
  ds_read_b64_tr_b16 v[22:23], v9 offset:512
  s_waitcnt lgkmcnt(6)
  v_mfma_f32_16x16x32_bf16 v[64:67], v[128:131], v[40:43], v[64:67]
  ds_read_b64_tr_b16 v[24:25], v10 offset:0
  v_mfma_f32_16x16x32_bf16 v[68:71], v[132:135], v[40:43], v[68:71]
  ds_read_b64_tr_b16 v[26:27], v10 offset:512
  s_waitcnt lgkmcnt(6)
  v_mfma_f32_16x16x32_bf16 v[76:79], v[132:135], v[44:47], v[76:79]
  ds_read_b64_tr_b16 v[28:29], v11 offset:0
  v_mfma_f32_16x16x32_bf16 v[72:75], v[128:131], v[44:47], v[72:75]
  ds_read_b64_tr_b16 v[30:31], v11 offset:512
  s_waitcnt vmcnt(11) lgkmcnt(6)
  v_mfma_f32_16x16x32_bf16 v[48:51], v[136:139], v[16:19], v[48:51]
  ds_read_b64_tr_b16 v[32:33], v8 offset:4096
  s_waitcnt vmcnt(10)
  v_mfma_f32_16x16x32_bf16 v[52:55], v[140:143], v[16:19], v[52:55]
  ds_read_b64_tr_b16 v[34:35], v8 offset:4608
  v_add_u32 v8, s42, v8
  s_waitcnt lgkmcnt(6)
  v_mfma_f32_16x16x32_bf16 v[60:63], v[140:143], v[20:23], v[60:63]
  ds_read_b64_tr_b16 v[36:37], v9 offset:4096
  v_mfma_f32_16x16x32_bf16 v[56:59], v[136:139], v[20:23], v[56:59]
  ds_read_b64_tr_b16 v[38:39], v9 offset:4608
  v_add_u32 v9, s42, v9
  s_waitcnt lgkmcnt(6)
  v_mfma_f32_16x16x32_bf16 v[64:67], v[136:139], v[24:27], v[64:67]
  ds_read_b64_tr_b16 v[40:41], v10 offset:4096
  v_mfma_f32_16x16x32_bf16 v[68:71], v[140:143], v[24:27], v[68:71]
  ds_read_b64_tr_b16 v[42:43], v10 offset:4608
  v_add_u32 v10, s42, v10
  s_waitcnt lgkmcnt(6)
  v_mfma_f32_16x16x32_bf16 v[76:79], v[140:143], v[28:31], v[76:79]
  ds_read_b64_tr_b16 v[44:45], v11 offset:4096
  v_mfma_f32_16x16x32_bf16 v[72:75], v[136:139], v[28:31], v[72:75]
  ds_read_b64_tr_b16 v[46:47], v11 offset:4608
  v_add_u32 v11, s42, v11
  s_barrier
  s_waitcnt vmcnt(9) lgkmcnt(6)
  v_mfma_f32_16x16x32_bf16 v[48:51], v[144:147], v[32:35], v[48:51]
  ds_read_b64_tr_b16 v[16:17], v8 offset:0
  s_add_u32 s40, s43, 8192
  s_cmp_eq_u32 s40, 65536
  s_waitcnt vmcnt(8)
  v_mfma_f32_16x16x32_bf16 v[52:55], v[148:151], v[32:35], v[52:55]
  ds_read_b64_tr_b16 v[18:19], v8 offset:512
  s_cselect_b32 s40, 0, s40
  s_sub_u32 s42, s40, s43
  s_waitcnt lgkmcnt(6)
  v_mfma_f32_16x16x32_bf16 v[60:63], v[148:151], v[36:39], v[60:63]
  ds_read_b64_tr_b16 v[20:21], v9 offset:0
  s_mov_b32 s43, s40
  v_mfma_f32_16x16x32_bf16 v[56:59], v[144:147], v[36:39], v[56:59]
  ds_read_b64_tr_b16 v[22:23], v9 offset:512
  s_waitcnt lgkmcnt(6)
  v_mfma_f32_16x16x32_bf16 v[64:67], v[144:147], v[40:43], v[64:67]
  ds_read_b64_tr_b16 v[24:25], v10 offset:0
  v_mfma_f32_16x16x32_bf16 v[68:71], v[148:151], v[40:43], v[68:71]
  ds_read_b64_tr_b16 v[26:27], v10 offset:512
  s_waitcnt lgkmcnt(6)
  v_mfma_f32_16x16x32_bf16 v[76:79], v[148:151], v[44:47], v[76:79]
  ds_read_b64_tr_b16 v[28:29], v11 offset:0
  v_mfma_f32_16x16x32_bf16 v[72:75], v[144:147], v[44:47], v[72:75]
  ds_read_b64_tr_b16 v[30:31], v11 offset:512
  s_waitcnt vmcnt(7) lgkmcnt(6)
  v_mfma_f32_16x16x32_bf16 v[48:51], v[152:155], v[16:19], v[48:51]
  ds_read_b64_tr_b16 v[32:33], v8 offset:4096
  s_waitcnt vmcnt(6)
  v_mfma_f32_16x16x32_bf16 v[52:55], v[156:159], v[16:19], v[52:55]
  ds_read_b64_tr_b16 v[34:35], v8 offset:4608
  v_add_u32 v8, s42, v8
  s_waitcnt lgkmcnt(6)
  v_mfma_f32_16x16x32_bf16 v[60:63], v[156:159], v[20:23], v[60:63]
  ds_read_b64_tr_b16 v[36:37], v9 offset:4096
  v_mfma_f32_16x16x32_bf16 v[56:59], v[152:155], v[20:23], v[56:59]
  ds_read_b64_tr_b16 v[38:39], v9 offset:4608
  v_add_u32 v9, s42, v9
  s_waitcnt lgkmcnt(6)
  v_mfma_f32_16x16x32_bf16 v[64:67], v[152:155], v[24:27], v[64:67]
  ds_read_b64_tr_b16 v[40:41], v10 offset:4096
  v_mfma_f32_16x16x32_bf16 v[68:71], v[156:159], v[24:27], v[68:71]
  ds_read_b64_tr_b16 v[42:43], v10 offset:4608
  v_add_u32 v10, s42, v10
  s_waitcnt lgkmcnt(6)
  v_mfma_f32_16x16x32_bf16 v[76:79], v[156:159], v[28:31], v[76:79]
  ds_read_b64_tr_b16 v[44:45], v11 offset:4096
  v_mfma_f32_16x16x32_bf16 v[72:75], v[152:155], v[28:31], v[72:75]
  ds_read_b64_tr_b16 v[46:47], v11 offset:4608
  v_add_u32 v11, s42, v11
  s_barrier
  s_waitcnt vmcnt(5) lgkmcnt(6)
  v_mfma_f32_16x16x32_bf16 v[48:51], v[160:163], v[32:35], v[48:51]
  ds_read_b64_tr_b16 v[16:17], v8 offset:0
  s_add_u32 s40, s43, 8192
  s_cmp_eq_u32 s40, 65536
  s_waitcnt vmcnt(4)
  v_mfma_f32_16x16x32_bf16 v[52:55], v[164:167], v[32:35], v[52:55]
  ds_read_b64_tr_b16 v[18:19], v8 offset:512
  s_cselect_b32 s40, 0, s40
  s_sub_u32 s42, s40, s43
  s_waitcnt lgkmcnt(6)
  v_mfma_f32_16x16x32_bf16 v[60:63], v[164:167], v[36:39], v[60:63]
  ds_read_b64_tr_b16 v[20:21], v9 offset:0
  s_mov_b32 s43, s40
  v_mfma_f32_16x16x32_bf16 v[56:59], v[160:163], v[36:39], v[56:59]
  ds_read_b64_tr_b16 v[22:23], v9 offset:512
  s_waitcnt lgkmcnt(6)
  v_mfma_f32_16x16x32_bf16 v[64:67], v[160:163], v[40:43], v[64:67]
  ds_read_b64_tr_b16 v[24:25], v10 offset:0
  v_mfma_f32_16x16x32_bf16 v[68:71], v[164:167], v[40:43], v[68:71]
  ds_read_b64_tr_b16 v[26:27], v10 offset:512
  s_waitcnt lgkmcnt(6)
  v_mfma_f32_16x16x32_bf16 v[76:79], v[164:167], v[44:47], v[76:79]
  ds_read_b64_tr_b16 v[28:29], v11 offset:0
  v_mfma_f32_16x16x32_bf16 v[72:75], v[160:163], v[44:47], v[72:75]
  ds_read_b64_tr_b16 v[30:31], v11 offset:512
  s_waitcnt vmcnt(3) lgkmcnt(6)
  v_mfma_f32_16x16x32_bf16 v[48:51], v[168:171], v[16:19], v[48:51]
  ds_read_b64_tr_b16 v[32:33], v8 offset:4096
  s_waitcnt vmcnt(2)
  v_mfma_f32_16x16x32_bf16 v[52:55], v[172:175], v[16:19], v[52:55]
  ds_read_b64_tr_b16 v[34:35], v8 offset:4608
  s_waitcnt lgkmcnt(6)
  v_mfma_f32_16x16x32_bf16 v[60:63], v[172:175], v[20:23], v[60:63]
  ds_read_b64_tr_b16 v[36:37], v9 offset:4096
  v_mfma_f32_16x16x32_bf16 v[56:59], v[168:171], v[20:23], v[56:59]
  ds_read_b64_tr_b16 v[38:39], v9 offset:4608
  s_waitcnt lgkmcnt(6)
  v_mfma_f32_16x16x32_bf16 v[64:67], v[168:171], v[24:27], v[64:67]
  ds_read_b64_tr_b16 v[40:41], v10 offset:4096
  v_mfma_f32_16x16x32_bf16 v[68:71], v[172:175], v[24:27], v[68:71]
  ds_read_b64_tr_b16 v[42:43], v10 offset:4608
  s_waitcnt lgkmcnt(6)
  v_mfma_f32_16x16x32_bf16 v[76:79], v[172:175], v[28:31], v[76:79]
  ds_read_b64_tr_b16 v[44:45], v11 offset:4096
  v_mfma_f32_16x16x32_bf16 v[72:75], v[168:171], v[28:31], v[72:75]
  ds_read_b64_tr_b16 v[46:47], v11 offset:4608
  s_waitcnt vmcnt(1) lgkmcnt(6)
  v_mfma_f32_16x16x32_bf16 v[48:51], v[176:179], v[32:35], v[48:51]
  s_waitcnt vmcnt(0)
  v_mfma_f32_16x16x32_bf16 v[52:55], v[180:183], v[32:35], v[52:55]
  s_waitcnt lgkmcnt(4)
  v_mfma_f32_16x16x32_bf16 v[60:63], v[180:183], v[36:39], v[60:63]
  v_mfma_f32_16x16x32_bf16 v[56:59], v[176:179], v[36:39], v[56:59]
  s_waitcnt lgkmcnt(2)
  v_mfma_f32_16x16x32_bf16 v[64:67], v[176:179], v[40:43], v[64:67]
  v_mfma_f32_16x16x32_bf16 v[68:71], v[180:183], v[40:43], v[68:71]
  s_waitcnt lgkmcnt(0)
  v_mfma_f32_16x16x32_bf16 v[76:79], v[180:183], v[44:47], v[76:79]
  v_mfma_f32_16x16x32_bf16 v[72:75], v[176:179], v[44:47], v[72:75]
  s_waitcnt lgkmcnt(0)
  s_cmp_eq_u32 s3, 0
  s_cbranch_scc1 C_st
  v_cvt_pk_bf16_f32 v96, v48, v49
  v_cvt_pk_bf16_f32 v97, v50, v51
  v_cvt_pk_bf16_f32 v98, v52, v53
  v_cvt_pk_bf16_f32 v99, v54, v55
  ds_write_b128 v189, v[96:99] offset:0
  v_cvt_pk_bf16_f32 v100, v56, v57
  v_cvt_pk_bf16_f32 v101, v58, v59
  v_cvt_pk_bf16_f32 v102, v60, v61
  v_cvt_pk_bf16_f32 v103, v62, v63
  ds_write_b128 v189, v[100:103] offset:4352
  v_cvt_pk_bf16_f32 v104, v64, v65
  v_cvt_pk_bf16_f32 v105, v66, v67
  v_cvt_pk_bf16_f32 v106, v68, v69
  v_cvt_pk_bf16_f32 v107, v70, v71
  ds_write_b128 v189, v[104:107] offset:8704
  v_cvt_pk_bf16_f32 v108, v72, v73
  v_cvt_pk_bf16_f32 v109, v74, v75
  v_cvt_pk_bf16_f32 v110, v76, v77
  v_cvt_pk_bf16_f32 v111, v78, v79
  ds_write_b128 v189, v[108:111] offset:13056
  s_waitcnt lgkmcnt(0)
  s_barrier
  ds_read_b128 v[96:99], v190 offset:0
  ds_read_b128 v[100:103], v190 offset:1088
  ds_read_b128 v[104:107], v190 offset:2176
  ds_read_b128 v[108:111], v190 offset:3264
  s_waitcnt lgkmcnt(3)
  buffer_store_dwordx4 v[96:99], v12, s[24:27], 0 offen
  s_waitcnt lgkmcnt(2)
  buffer_store_dwordx4 v[100:103], v12, s[24:27], s45 offen
  s_waitcnt lgkmcnt(1)
  buffer_store_dwordx4 v[104:107], v12, s[24:27], s46 offen
  s_waitcnt lgkmcnt(0)
  buffer_store_dwordx4 v[108:111], v12, s[24:27], s47 offen
  s_branch C_end
C_st:
  s_nop 7
  v_pk_add_f32 v[16:17], v[48:49], v[50:51]
  v_pk_mul_f32 v[18:19], v[48:49], v[48:49]
  v_pk_fma_f32 v[18:19], v[50:51], v[50:51], v[18:19]
  v_pk_add_f32 v[16:17], v[16:17], v[52:53]
  v_pk_fma_f32 v[18:19], v[52:53], v[52:53], v[18:19]
  v_pk_add_f32 v[16:17], v[16:17], v[54:55]
  v_pk_fma_f32 v[18:19], v[54:55], v[54:55], v[18:19]
  v_add_f32 v32, v16, v17
  v_add_f32 v36, v18, v19
  v_pk_add_f32 v[20:21], v[56:57], v[58:59]
  v_pk_mul_f32 v[22:23], v[56:57], v[56:57]
  v_pk_fma_f32 v[22:23], v[58:59], v[58:59], v[22:23]
  v_pk_add_f32 v[20:21], v[20:21], v[60:61]
  v_pk_fma_f32 v[22:23], v[60:61], v[60:61], v[22:23]
  v_pk_add_f32 v[20:21], v[20:21], v[62:63]
  v_pk_fma_f32 v[22:23], v[62:63], v[62:63], v[22:23]
  v_add_f32 v33, v20, v21
  v_add_f32 v37, v22, v23
  v_pk_add_f32 v[24:25], v[64:65], v[66:67]
  v_pk_mul_f32 v[26:27], v[64:65], v[64:65]
  v_pk_fma_f32 v[26:27], v[66:67], v[66:67], v[26:27]
  v_pk_add_f32 v[24:25], v[24:25], v[68:69]
  v_pk_fma_f32 v[26:27], v[68:69], v[68:69], v[26:27]
  v_pk_add_f32 v[24:25], v[24:25], v[70:71]
  v_pk_fma_f32 v[26:27], v[70:71], v[70:71], v[26:27]
  v_add_f32 v34, v24, v25
  v_add_f32 v38, v26, v27
  v_pk_add_f32 v[28:29], v[72:73], v[74:75]
  v_pk_mul_f32 v[30:31], v[72:73], v[72:73]
  v_pk_fma_f32 v[30:31], v[74:75], v[74:75], v[30:31]
  v_pk_add_f32 v[28:29], v[28:29], v[76:77]
  v_pk_fma_f32 v[30:31], v[76:77], v[76:77], v[30:31]
  v_pk_add_f32 v[28:29], v[28:29], v[78:79]
  v_pk_fma_f32 v[30:31], v[78:79], v[78:79], v[30:31]
  v_add_f32 v35, v28, v29
  v_add_f32 v39, v30, v31
  v_permlane16_swap_b32 v32, v33
  v_permlane16_swap_b32 v34, v35
  v_permlane16_swap_b32 v36, v37
  v_permlane16_swap_b32 v38, v39
  v_add_f32 v32, v32, v33
  v_add_f32 v34, v34, v35
  v_add_f32 v36, v36, v37
  v_add_f32 v38, v38, v39
  v_permlane32_swap_b32 v32, v34
  s_nop 0
  v_permlane32_swap_b32 v36, v38
  v_add_f32 v40, v32, v34
  v_add_f32 v41, v36, v38
  ds_write_b64 v185, v[40:41]
  s_lshl_b32 s32, s28, 15
  s_lshl_b32 s40, s29, 10
  s_add_u32 s32, s32, s40
  s_add_u32 s32, s32, 512
  v_cvt_pk_bf16_f32 v96, v48, v49
  v_cvt_pk_bf16_f32 v97, v50, v51
  v_cvt_pk_bf16_f32 v98, v52, v53
  v_cvt_pk_bf16_f32 v99, v54, v55
  ds_write_b128 v189, v[96:99] offset:0
  v_cvt_pk_bf16_f32 v100, v56, v57
  v_cvt_pk_bf16_f32 v101, v58, v59
  v_cvt_pk_bf16_f32 v102, v60, v61
  v_cvt_pk_bf16_f32 v103, v62, v63
  ds_write_b128 v189, v[100:103] offset:4352
  v_cvt_pk_bf16_f32 v104, v64, v65
  v_cvt_pk_bf16_f32 v105, v66, v67
  v_cvt_pk_bf16_f32 v106, v68, v69
  v_cvt_pk_bf16_f32 v107, v70, v71
  ds_write_b128 v189, v[104:107] offset:8704
  v_cvt_pk_bf16_f32 v108, v72, v73
  v_cvt_pk_bf16_f32 v109, v74, v75
  v_cvt_pk_bf16_f32 v110, v76, v77
  v_cvt_pk_bf16_f32 v111, v78, v79
  ds_write_b128 v189, v[108:111] offset:13056
  s_waitcnt lgkmcnt(0)
  s_barrier
  s_cmp_lg_u32 s4, 0
  s_cbranch_scc1 C_nost
  ds_read_b64 v[44:45], v185 offset:512
  ds_read_b64 v[46:47], v185 offset:1024
  ds_read_b64 v[18:19], v185 offset:1536
  s_waitcnt lgkmcnt(0)
  v_pk_add_f32 v[40:41], v[40:41], v[44:45]
  v_pk_add_f32 v[46:47], v[46:47], v[18:19]
  v_pk_add_f32 v[40:41], v[40:41], v[46:47]
  buffer_store_dwordx2 v[40:41], v184, s[12:15], s32 offen sc0 sc1
C_nost:
  s_nop 1
  ds_read_b128 v[96:99], v190 offset:0
  ds_read_b128 v[100:103], v190 offset:1088
  ds_read_b128 v[104:107], v190 offset:2176
  ds_read_b128 v[108:111], v190 offset:3264
  s_waitcnt lgkmcnt(3)
  buffer_store_dwordx4 v[96:99], v186, s[24:27], 0 offen offset:0 sc0 sc1
  s_waitcnt lgkmcnt(2)
  buffer_store_dwordx4 v[100:103], v186, s[24:27], 0 offen offset:1024 sc0 sc1
  s_waitcnt lgkmcnt(1)
  buffer_store_dwordx4 v[104:107], v186, s[24:27], 0 offen offset:2048 sc0 sc1
  s_waitcnt lgkmcnt(0)
  buffer_store_dwordx4 v[108:111], v186, s[24:27], 0 offen offset:3072 sc0 sc1
  s_lshr_b32 s32, s2, 3
  s_lshr_b32 s5, s32, 3
  s_and_b32 s6, s32, 7
  s_lshl_b32 s7, s5, 1
  s_add_u32 s7, s7, s6
  s_and_b32 s7, s7, 7
  s_and_b32 s32, s2, 7
  s_lshr_b32 s28, s32, 1
  s_lshl_b32 s28, s28, 2
  s_add_u32 s28, s28, s5
  s_and_b32 s29, s32, 1
  s_mul_i32 s29, s29, 8
  s_add_u32 s29, s29, s6
  s_mov_b32 s30, 7
  s_mov_b32 s31, -1
  v_and_b32 v4, 15, v0
  v_lshrrev_b32 v5, 4, v0
  v_lshrrev_b32 v6, 2, v4
  v_and_b32 v7, 3, v0
  v_lshrrev_b32 v3, 5, v0
  v_and_b32 v2, 1, v5
  v_lshl_or_b32 v3, v2, 1, v3
  v_lshl_add_u32 v21, v5, 3, v6
  v_lshlrev_b32 v21, 7, v21
  v_lshl_add_u32 v21, v7, 3, v21
  v_lshrrev_b32 v22, 1, v6
  v_lshl_or_b32 v22, v2, 1, v22
  v_lshl_add_u32 v21, v22, 5, v21
  v_add_u32 v21, 18432, v21
  v_xor_b32 v8, 0, v21
  s_lshl_b32 s32, s4, 5
  v_xor_b32 v8, s32, v8
  v_lshrrev_b32 v21, 1, v4
  v_xor_b32 v21, v21, v5
  v_lshlrev_b32 v21, 4, v21
  v_lshlrev_b32 v22, 7, v4
  v_add_u32 v9, v21, v22
  v_xor_b32 v10, 64, v9
  v_and_b32 v21, 1, v4
  v_mul_u32_u24 v21, 28800, v21
  v_lshrrev_b32 v22, 1, v4
  v_mul_u32_u24 v22, 400, v22
  v_lshlrev_b32 v23, 3, v5
  v_add3_u32 v11, v21, v22, v23
  s_add_u32 s32, s32, 43008
  v_add_u32 v11, s32, v11
  v_lshlrev_b32 v12, 3, v4
  v_add_u32 v12, 129024, v12
  v_mov_b64 v[112:113], 0
  v_mov_b64 v[114:115], 0
  v_mov_b64 v[116:117], 0
  v_mov_b64 v[118:119], 0
  v_mov_b64 v[120:121], 0
  v_mov_b64 v[122:123], 0
  v_mov_b64 v[124:125], 0
  v_mov_b64 v[126:127], 0
  v_mov_b64 v[128:129], 0
  v_mov_b64 v[130:131], 0
  v_mov_b64 v[132:133], 0
  v_mov_b64 v[134:135], 0
  v_mov_b64 v[136:137], 0
  v_mov_b64 v[138:139], 0
  v_mov_b64 v[140:141], 0
  v_mov_b64 v[142:143], 0
  v_mov_b64 v[144:145], 0
  v_mov_b64 v[146:147], 0
  v_mov_b64 v[148:149], 0
  v_mov_b64 v[150:151], 0
  v_mov_b64 v[152:153], 0
  v_mov_b64 v[154:155], 0
  v_mov_b64 v[156:157], 0
  v_mov_b64 v[158:159], 0
  v_mov_b64 v[160:161], 0
  v_mov_b64 v[162:163], 0
  v_mov_b64 v[164:165], 0
  v_mov_b64 v[166:167], 0
  v_mov_b64 v[168:169], 0
  v_mov_b64 v[170:171], 0
  v_mov_b64 v[172:173], 0
  v_mov_b64 v[174:175], 0
  v_mov_b64 v[176:177], 0
  v_mov_b64 v[178:179], 0
  v_mov_b64 v[180:181], 0
  v_mov_b64 v[182:183], 0
  v_mov_b64 v[184:185], 0
  v_mov_b64 v[186:187], 0
  v_mov_b64 v[188:189], 0
  v_mov_b64 v[190:191], 0
  v_mov_b64 v[192:193], 0
  v_mov_b64 v[194:195], 0
  v_mov_b64 v[196:197], 0
  v_mov_b64 v[198:199], 0
  v_mov_b64 v[200:201], 0
  v_mov_b64 v[202:203], 0
  v_mov_b64 v[204:205], 0
  v_mov_b64 v[206:207], 0
  v_mov_b64 v[208:209], 0
  v_mov_b64 v[210:211], 0
  v_mov_b64 v[212:213], 0
  v_mov_b64 v[214:215], 0
  v_mov_b64 v[216:217], 0
  v_mov_b64 v[218:219], 0
  s_waitcnt vmcnt(0)
  s_barrier
  s_mov_b32 s16, s66
  s_mov_b32 s17, s67
  s_mov_b32 s18, 6291456
  s_mov_b32 s19, 0x20000
  s_lshr_b32 s32, s2, 3
  s_lshl_b32 s32, s32, 1
  s_add_u32 s32, s32, s4
  s_sub_u32 s32, s32, 1
  s_lshl_b32 s32, s32, 6
  v_add_u32 v16, s32, v0
  v_mul_u32_u24 v17, 21846, v16
  v_lshrrev_b32 v17, 16, v17
  v_mul_u32_u24 v18, 3, v17
  v_sub_u32 v18, v16, v18
  v_mul_u32_u24 v17, 6144, v17
  v_lshl_add_u32 v14, v18, 11, v17
  s_and_b32 s32, s2, 1
  s_lshl_b32 s32, s32, 10
  s_add_u32 s32, s32, 384
  s_sub_u32 s40, s4, 1
  s_cmp_lt_u32 s40, 2
  s_cselect_b32 s18, s18, 0
  buffer_load_dword v15, v14, s[16:19], s32 offen
  s_barrier
  s_mov_b32 s3, 1
  s_mov_b32 s51, 9
  s_add_u32 s82, s84, 50331648
  s_addc_u32 s83, s85, 0
  s_branch C_top1
C_end:
  s_endpgm
L_start:
  s_nop 7
  s_nop 7
  s_sub_u32 s57, s4, 4
  v_and_b32 v134, 3, v0
  v_lshlrev_b32 v134, 6, v134
  s_lshr_b32 s32, s2, 3
  s_lshr_b32 s5, s32, 3
  s_and_b32 s6, s32, 7
  s_lshl_b32 s7, s5, 1
  s_add_u32 s7, s7, s6
  s_and_b32 s7, s7, 7
  s_and_b32 s32, s2, 7
  s_lshr_b32 s28, s32, 1
  s_lshl_b32 s28, s28, 2
  s_add_u32 s28, s28, s5
  s_and_b32 s29, s32, 1
  s_mul_i32 s29, s29, 8
  s_add_u32 s29, s29, s6
  s_mov_b32 s30, 7
  s_mov_b32 s31, -1
  s_mov_b32 s41, s57
  s_mul_i32 s32, s41, 16
  s_add_u32 s32, s32, 0
  v_lshrrev_b32 v2, 3, v0
  v_add_u32 v2, s32, v2
  v_bfe_u32 v3, v2, 1, 1
  v_bfe_u32 v4, v2, 3, 1
  v_lshl_or_b32 v3, v4, 1, v3
  v_lshlrev_b32 v3, 1, v3
  v_and_b32 v4, 7, v0
  v_xor_b32 v3, v3, v4
  v_lshlrev_b32 v3, 4, v3
  s_mov_b32 s32, 6144
  v_mul_lo_u32 v2, v2, s32
  v_add_u32 v13, v2, v3
  s_mul_i32 s32, s41, 16
  s_add_u32 s32, s32, 8
  v_lshrrev_b32 v2, 3, v0
  v_add_u32 v2, s32, v2
  v_bfe_u32 v3, v2, 1, 1
  v_bfe_u32 v4, v2, 3, 1
  v_lshl_or_b32 v3, v4, 1, v3
  v_lshlrev_b32 v3, 1, v3
  v_and_b32 v4, 7, v0
  v_xor_b32 v3, v3, v4
  v_lshlrev_b32 v3, 4, v3
  s_mov_b32 s32, 6144
  v_mul_lo_u32 v2, v2, s32
  v_add_u32 v14, v2, v3
  v_subrev_u32 v14, 1024, v14
  v_add_u32 v15, 2048, v13
  v_add_u32 v16, 2048, v14
  v_add_u32 v17, 4096, v13
  v_add_u32 v18, 4096, v14
  s_lshl_b32 s46, s41, 11
  s_add_u32 s46, s46, 18432
  s_add_u32 s47, s46, 8192
  s_add_u32 s48, s46, 16384
  s_lshl_b32 s35, s29, 7
  s_lshl_b32 s40, s28, 7
  s_sub_u32 s40, s40, 16
  s_lshl_b32 s32, s41, 5
  s_add_u32 s32, s32, 16
  v_lshrrev_b32 v2, 3, v0
  v_add_u32 v2, s32, v2
  v_bfe_u32 v3, v2, 1, 3
  v_and_b32 v4, 7, v0
  v_xor_b32 v3, v3, v4
  v_lshlrev_b32 v3, 4, v3
  v_add_u32 v2, s40, v2
  v_max_i32 v2, 0, v2
  v_lshlrev_b32 v2, 11, v2
  v_add_u32 v8, v2, v3
  v_add_u32 v10, 30720, v8
  s_lshl_b32 s32, s41, 5
  s_add_u32 s32, s32, 24
  v_lshrrev_b32 v2, 3, v0
  v_add_u32 v2, s32, v2
  v_bfe_u32 v3, v2, 1, 3
  v_and_b32 v4, 7, v0
  v_xor_b32 v3, v3, v4
  v_lshlrev_b32 v3, 4, v3
  v_add_u32 v2, s40, v2
  v_max_i32 v2, 0, v2
  v_lshlrev_b32 v2, 11, v2
  v_add_u32 v9, v2, v3
  v_subrev_u32 v9, 1024, v9
  v_add_u32 v11, 30720, v9
  s_lshl_b32 s32, s41, 3
  v_lshrrev_b32 v2, 3, v0
  v_add_u32 v2, s32, v2
  v_bfe_u32 v3, v2, 1, 3
  v_and_b32 v4, 7, v0
  v_xor_b32 v3, v3, v4
  v_lshlrev_b32 v3, 4, v3
  v_add_u32 v2, s40, v2
  v_max_i32 v2, 0, v2
  v_lshlrev_b32 v2, 11, v2
  v_add_u32 v12, v2, v3
  s_lshl_b32 s44, s41, 12
  s_add_u32 s44, s44, 2048
  s_lshl_b32 s45, s41, 10
  s_mov_b32 s34, 0
  s_mov_b32 s54, 128
  s_cmp_eq_u32 s41, 0
  s_cselect_b32 s52, 0xffffff00, -1
  s_mov_b32 s53, -1
  v_mov_b32 v20, 0x3f803f80
  v_mov_b32 v21, v20
  v_mov_b32 v22, v20
  v_mov_b32 v23, v20
  v_lshlrev_b32 v24, 4, v0
  v_add_u32 v25, 86016, v24
  s_mov_b64 exec, 0xff
  ds_write_b128 v24, v[20:23]
  ds_write_b128 v24, v[20:23] offset:43008
  ds_write_b128 v25, v[20:23]
  s_mov_b64 exec, -1
  s_lshl_b32 s32, s41, 6
  v_add_u32 v26, s32, v0
  v_min_u32 v26, 143, v26
  v_add_u32 v27, s40, v26
  v_max_i32 v27, 0, v27
  v_lshrrev_b32 v2, 6, v27
  v_and_b32 v27, 63, v27
  v_lshlrev_b32 v27, 3, v27
  v_lshl_add_u32 v27, v2, 10, v27
  v_add_u32 v27, 512, v27
  v_lshlrev_b32 v26, 3, v26
  v_add_u32 v26, 129024, v26
  s_lshl_b32 s32, s2, 3
  s_lshl_b32 s40, s57, 1
  s_add_u32 s32, s32, s40
  v_lshrrev_b32 v72, 5, v0
  v_add_u32 v72, s32, v72
  v_lshlrev_b32 v46, 11, v72
  v_and_b32 v2, 31, v0
  v_lshl_add_u32 v46, v2, 4, v46
  v_lshrrev_b32 v2, 6, v72
  v_and_b32 v72, 63, v72
  v_lshlrev_b32 v72, 3, v72
  v_lshl_add_u32 v72, v2, 10, v72
  v_add_u32 v72, 42992128, v72
  s_cmp_eq_u32 s57, 0
  s_cselect_b32 s58, 0, -1
  v_mov_b32 v64, s58
  v_mov_b32 v65, s58
  v_mov_b32 v66, s58
  v_mov_b32 v67, s58
  v_lshrrev_b32 v2, 3, v0
  v_lshlrev_b32 v2, 15, v2
  v_and_b32 v3, 7, v0
  v_lshl_add_u32 v2, v3, 4, v2
  v_lshrrev_b32 v4, 4, v0
  v_and_b32 v3, 15, v0
  v_lshlrev_b32 v3, 4, v3
  v_lshl_add_u32 v3, v4, 8, v3
  s_cselect_b64 vcc, -1, 0
  s_lshl_b32 s58, s2, 7
  s_add_u32 s58, s58, 109051904
  s_lshl_b32 s59, s2, 10
  s_add_u32 s59, s59, 41943040
  s_cmp_eq_u32 s57, 0
  s_cselect_b32 s58, s58, s59
  s_add_u32 s59, s59, 50331648
  s_cmp_eq_u32 s57, 2
  s_cselect_b32 s58, s59, s58
  s_lshr_b32 s59, s2, 2
  s_mul_i32 s59, s59, 50331648
  s_and_b32 s32, s2, 3
  s_lshl_b32 s32, s32, 10
  s_add_u32 s59, s59, s32
  s_add_u32 s59, s59, 42205184
  s_cmp_lt_u32 s2, 8
  s_cselect_b32 s59, s59, 134217728
  s_cmp_eq_u32 s57, 3
  s_cselect_b32 s58, s59, s58
  v_cndmask_b32 v47, v3, v2, vcc
  s_and_b32 s59, s2, 3
  s_lshl_b32 s59, s59, 6
  v_mov_b32 v73, s59
  v_mov_b32 v74, 1
  s_lshl_b32 s56, s3, 10
  s_mul_i32 s32, s28, 16
  s_add_u32 s56, s56, s32
  s_add_u32 s56, s56, s29
  s_add_u32 s56, s56, 0
  s_lshl_b32 s56, s56, 7
  s_mov_b32 s38, 0
  s_waitcnt lgkmcnt(0)
  s_mov_b32 s8, s64
  s_mov_b32 s9, s65
  s_mov_b32 s10, 4194304
  s_mov_b32 s11, 0x20000
  s_mov_b32 s12, s66
  s_mov_b32 s13, s67
  s_mov_b32 s14, 6291456
  s_mov_b32 s15, 0x20000
  s_branch L_first
L_top:
  s_nop 7
  s_nop 7
  s_lshl_b32 s56, s3, 10
  s_mul_i32 s32, s28, 16
  s_add_u32 s56, s56, s32
  s_add_u32 s56, s56, s29
  s_add_u32 s56, s56, 0
  s_lshl_b32 s56, s56, 7
  s_mov_b32 s24, s72
  s_mov_b32 s25, s73
  s_mov_b32 s26, 14680064
  s_mov_b32 s27, 0x20000
  s_cmp_ge_u32 s57, 2
  s_cbranch_scc1 L_k1B
  s_mov_b32 s30, 7
  s_mov_b32 s31, -1
  s_mov_b32 s38, 0
  s_add_u32 s30, s30, 1
  s_and_b32 s30, s30, 7
  s_cselect_b32 s32, 0, 1
  s_add_u32 s31, s31, s32
  s_sub_u32 s32, s30, s7
  s_and_b32 s32, s32, 7
  s_cmp_lt_u32 s32, 2
  s_cselect_b32 s32, 1, 0
  s_add_u32 s32, s32, s31
  s_cmp_ge_u32 s32, 2
  s_cselect_b32 s32, 0, s32
  s_lshl_b32 s33, s32, 3
  s_add_u32 s33, s33, s30
  s_mul_i32 s36, s33, s54
  s_add_u32 s36, s36, s34
  s_add_u32 m0, s38, s45
  s_mov_b64 exec, s[52:53]
  buffer_load_dwordx4 v12, s[8:11], s36 offen offset:0 sc1 lds
  s_mov_b64 exec, -1
  s_add_u32 m0, s38, s44
  s_nop 0
  buffer_load_dwordx4 v8, s[8:11], s36 offen offset:0 sc1 lds
  buffer_load_dwordx4 v9, s[8:11], s36 offen offset:1024 sc1 lds
  buffer_load_dwordx4 v10, s[8:11], s36 offen offset:2048 sc1 lds
  buffer_load_dwordx4 v11, s[8:11], s36 offen offset:3072 sc1 lds
  s_add_u32 s38, s38, 43008
  s_cmp_eq_u32 s38, 129024
  s_cselect_b32 s38, 0, s38
  s_add_u32 s30, s30, 1
  s_and_b32 s30, s30, 7
  s_cselect_b32 s32, 0, 1
  s_add_u32 s31, s31, s32
  s_sub_u32 s32, s30, s7
  s_and_b32 s32, s32, 7
  s_cmp_lt_u32 s32, 2
  s_cselect_b32 s32, 1, 0
  s_add_u32 s32, s32, s31
  s_cmp_ge_u32 s32, 2
  s_cselect_b32 s32, 0, s32
  s_lshl_b32 s33, s32, 3
  s_add_u32 s33, s33, s30
  s_mul_i32 s36, s33, s54
  s_add_u32 s36, s36, s34
  s_add_u32 m0, s38, s45
  s_mov_b64 exec, s[52:53]
  buffer_load_dwordx4 v12, s[8:11], s36 offen offset:0 sc1 lds
  s_mov_b64 exec, -1
  s_add_u32 m0, s38, s44
  s_nop 0
  buffer_load_dwordx4 v8, s[8:11], s36 offen offset:0 sc1 lds
  buffer_load_dwordx4 v9, s[8:11], s36 offen offset:1024 sc1 lds
  buffer_load_dwordx4 v10, s[8:11], s36 offen offset:2048 sc1 lds
  buffer_load_dwordx4 v11, s[8:11], s36 offen offset:3072 sc1 lds
  s_add_u32 s38, s38, 43008
  s_cmp_eq_u32 s38, 129024
  s_cselect_b32 s38, 0, s38
  s_waitcnt vmcnt(5)
  s_barrier
  s_add_u32 s30, s30, 1
  s_and_b32 s30, s30, 7
  s_cselect_b32 s32, 0, 1
  s_add_u32 s31, s31, s32
  s_sub_u32 s32, s30, s7
  s_and_b32 s32, s32, 7
  s_cmp_lt_u32 s32, 2
  s_cselect_b32 s32, 1, 0
  s_add_u32 s32, s32, s31
  s_cmp_ge_u32 s32, 2
  s_cselect_b32 s32, 0, s32
  s_lshl_b32 s33, s32, 3
  s_add_u32 s33, s33, s30
  s_mul_i32 s36, s33, s54
  s_add_u32 s36, s36, s34
  s_mul_i32 s37, s33, 393216
  s_add_u32 s37, s37, s35
  s_add_u32 m0, s38, s45
  s_mov_b64 exec, s[52:53]
  buffer_load_dwordx4 v12, s[8:11], s36 offen offset:0 sc1 lds
  s_mov_b64 exec, -1
  s_add_u32 m0, s38, s44
  s_nop 0
  buffer_load_dwordx4 v8, s[8:11], s36 offen offset:0 sc1 lds
  buffer_load_dwordx4 v9, s[8:11], s36 offen offset:1024 sc1 lds
  buffer_load_dwordx4 v10, s[8:11], s36 offen offset:2048 sc1 lds
  buffer_load_dwordx4 v11, s[8:11], s36 offen offset:3072 sc1 lds
  s_add_u32 m0, s38, s46
  s_nop 0
  buffer_load_dwordx4 v13, s[12:15], s37 offen offset:0  lds
  buffer_load_dwordx4 v14, s[12:15], s37 offen offset:1024  lds
  s_add_u32 m0, s38, s47
  s_nop 0
  buffer_load_dwordx4 v15, s[12:15], s37 offen offset:0  lds
  buffer_load_dwordx4 v16, s[12:15], s37 offen offset:1024  lds
  s_add_u32 m0, s38, s48
  s_nop 0
  buffer_load_dwordx4 v17, s[12:15], s37 offen offset:0  lds
  buffer_load_dwordx4 v18, s[12:15], s37 offen offset:1024  lds
  s_add_u32 s38, s38, 43008
  s_cmp_eq_u32 s38, 129024
  s_cselect_b32 s38, 0, s38
L_jA:
  s_nop 1
  s_waitcnt vmcnt(11)
  s_barrier
  s_add_u32 s30, s30, 1
  s_and_b32 s30, s30, 7
  s_cselect_b32 s32, 0, 1
  s_add_u32 s31, s31, s32
  s_sub_u32 s32, s30, s7
  s_and_b32 s32, s32, 7
  s_cmp_lt_u32 s32, 2
  s_cselect_b32 s32, 1, 0
  s_add_u32 s32, s32, s31
  s_cmp_ge_u32 s32, 2
  s_cselect_b32 s32, 0, s32
  s_lshl_b32 s33, s32, 3
  s_add_u32 s33, s33, s30
  s_mul_i32 s36, s33, s54
  s_add_u32 s36, s36, s34
  s_mul_i32 s37, s33, 393216
  s_add_u32 s37, s37, s35
  s_add_u32 m0, s38, s45
  s_mov_b64 exec, s[52:53]
  buffer_load_dwordx4 v12, s[8:11], s36 offen offset:0 sc1 lds
  s_mov_b64 exec, -1
  s_add_u32 m0, s38, s44
  s_nop 0
  buffer_load_dwordx4 v8, s[8:11], s36 offen offset:0 sc1 lds
  buffer_load_dwordx4 v9, s[8:11], s36 offen offset:1024 sc1 lds
  buffer_load_dwordx4 v10, s[8:11], s36 offen offset:2048 sc1 lds
  buffer_load_dwordx4 v11, s[8:11], s36 offen offset:3072 sc1 lds
  s_add_u32 m0, s38, s46
  s_nop 0
  buffer_load_dwordx4 v13, s[12:15], s37 offen offset:0  lds
  buffer_load_dwordx4 v14, s[12:15], s37 offen offset:1024  lds
  s_add_u32 m0, s38, s47
  s_nop 0
  buffer_load_dwordx4 v15, s[12:15], s37 offen offset:0  lds
  buffer_load_dwordx4 v16, s[12:15], s37 offen offset:1024  lds
  s_add_u32 m0, s38, s48
  s_nop 0
  buffer_load_dwordx4 v17, s[12:15], s37 offen offset:0  lds
  buffer_load_dwordx4 v18, s[12:15], s37 offen offset:1024  lds
  s_add_u32 s38, s38, 43008
  s_cmp_eq_u32 s38, 129024
  s_cselect_b32 s38, 0, s38
  s_waitcnt vmcnt(11)
  s_barrier
  s_add_u32 s30, s30, 1
  s_and_b32 s30, s30, 7
  s_cselect_b32 s32, 0, 1
  s_add_u32 s31, s31, s32
  s_sub_u32 s32, s30, s7
  s_and_b32 s32, s32, 7
  s_cmp_lt_u32 s32, 2
  s_cselect_b32 s32, 1, 0
  s_add_u32 s32, s32, s31
  s_cmp_ge_u32 s32, 2
  s_cselect_b32 s32, 0, s32
  s_lshl_b32 s33, s32, 3
  s_add_u32 s33, s33, s30
  s_mul_i32 s36, s33, s54
  s_add_u32 s36, s36, s34
  s_mul_i32 s37, s33, 393216
  s_add_u32 s37, s37, s35
  s_add_u32 m0, s38, s45
  s_mov_b64 exec, s[52:53]
  buffer_load_dwordx4 v12, s[8:11], s36 offen offset:0 sc1 lds
  s_mov_b64 exec, -1
  s_add_u32 m0, s38, s44
  s_nop 0
  buffer_load_dwordx4 v8, s[8:11], s36 offen offset:0 sc1 lds
  buffer_load_dwordx4 v9, s[8:11], s36 offen offset:1024 sc1 lds
  buffer_load_dwordx4 v10, s[8:11], s36 offen offset:2048 sc1 lds
  buffer_load_dwordx4 v11, s[8:11], s36 offen offset:3072 sc1 lds
  s_add_u32 m0, s38, s46
  s_nop 0
  buffer_load_dwordx4 v13, s[12:15], s37 offen offset:0  lds
  buffer_load_dwordx4 v14, s[12:15], s37 offen offset:1024  lds
  s_add_u32 m0, s38, s47
  s_nop 0
  buffer_load_dwordx4 v15, s[12:15], s37 offen offset:0  lds
  buffer_load_dwordx4 v16, s[12:15], s37 offen offset:1024  lds
  s_add_u32 m0, s38, s48
  s_nop 0
  buffer_load_dwordx4 v17, s[12:15], s37 offen offset:0  lds
  buffer_load_dwordx4 v18, s[12:15], s37 offen offset:1024  lds
  s_add_u32 s38, s38, 43008
  s_cmp_eq_u32 s38, 129024
  s_cselect_b32 s38, 0, s38
  s_cmp_lg_u32 s3, 0
  s_cbranch_scc1 e7
  s_cmp_lg_u32 s57, 0
  s_cbranch_scc1 g8
  s_mov_b64 exec, 1
  global_atomic_add v73, v74, s[62:63] sc1
  s_mov_b64 exec, -1
g8:
e7:
  s_nop 1
  s_mov_b32 s39, 9
ll9:
  s_waitcnt vmcnt(11)
  s_barrier
  s_add_u32 s30, s30, 1
  s_and_b32 s30, s30, 7
  s_cselect_b32 s32, 0, 1
  s_add_u32 s31, s31, s32
  s_sub_u32 s32, s30, s7
  s_and_b32 s32, s32, 7
  s_cmp_lt_u32 s32, 2
  s_cselect_b32 s32, 1, 0
  s_add_u32 s32, s32, s31
  s_cmp_ge_u32 s32, 2
  s_cselect_b32 s32, 0, s32
  s_lshl_b32 s33, s32, 3
  s_add_u32 s33, s33, s30
  s_mul_i32 s36, s33, s54
  s_add_u32 s36, s36, s34
  s_mul_i32 s37, s33, 393216
  s_add_u32 s37, s37, s35
  s_add_u32 m0, s38, s45
  s_mov_b64 exec, s[52:53]
  buffer_load_dwordx4 v12, s[8:11], s36 offen offset:0 sc1 lds
  s_mov_b64 exec, -1
  s_add_u32 m0, s38, s44
  s_nop 0
  buffer_load_dwordx4 v8, s[8:11], s36 offen offset:0 sc1 lds
  buffer_load_dwordx4 v9, s[8:11], s36 offen offset:1024 sc1 lds
  buffer_load_dwordx4 v10, s[8:11], s36 offen offset:2048 sc1 lds
  buffer_load_dwordx4 v11, s[8:11], s36 offen offset:3072 sc1 lds
  s_add_u32 m0, s38, s46
  s_nop 0
  buffer_load_dwordx4 v13, s[12:15], s37 offen offset:0  lds
  buffer_load_dwordx4 v14, s[12:15], s37 offen offset:1024  lds
  s_add_u32 m0, s38, s47
  s_nop 0
  buffer_load_dwordx4 v15, s[12:15], s37 offen offset:0  lds
  buffer_load_dwordx4 v16, s[12:15], s37 offen offset:1024  lds
  s_add_u32 m0, s38, s48
  s_nop 0
  buffer_load_dwordx4 v17, s[12:15], s37 offen offset:0  lds
  buffer_load_dwordx4 v18, s[12:15], s37 offen offset:1024  lds
  s_add_u32 s38, s38, 43008
  s_cmp_eq_u32 s38, 129024
  s_cselect_b32 s38, 0, s38
  s_sub_u32 s39, s39, 1
  s_cmp_lg_u32 s39, 0
  s_cbranch_scc1 ll9
  s_waitcnt vmcnt(11)
  s_barrier
  s_add_u32 s30, s30, 1
  s_and_b32 s30, s30, 7
  s_cselect_b32 s32, 0, 1
  s_add_u32 s31, s31, s32
  s_sub_u32 s32, s30, s7
  s_and_b32 s32, s32, 7
  s_cmp_lt_u32 s32, 2
  s_cselect_b32 s32, 1, 0
  s_add_u32 s32, s32, s31
  s_cmp_ge_u32 s32, 2
  s_cselect_b32 s32, 0, s32
  s_lshl_b32 s33, s32, 3
  s_add_u32 s33, s33, s30
  s_mul_i32 s36, s33, s54
  s_add_u32 s36, s36, s34
  s_mul_i32 s37, s33, 393216
  s_add_u32 s37, s37, s35
  s_add_u32 m0, s38, s45
  s_mov_b64 exec, s[52:53]
  buffer_load_dwordx4 v12, s[8:11], s36 offen offset:0 sc1 lds
  s_mov_b64 exec, -1
  s_add_u32 m0, s38, s44
  s_nop 0
  buffer_load_dwordx4 v8, s[8:11], s36 offen offset:0 sc1 lds
  buffer_load_dwordx4 v9, s[8:11], s36 offen offset:1024 sc1 lds
  buffer_load_dwordx4 v10, s[8:11], s36 offen offset:2048 sc1 lds
  buffer_load_dwordx4 v11, s[8:11], s36 offen offset:3072 sc1 lds
  s_add_u32 m0, s38, s46
  s_nop 0
  buffer_load_dwordx4 v13, s[12:15], s37 offen offset:0  lds
  buffer_load_dwordx4 v14, s[12:15], s37 offen offset:1024  lds
  s_add_u32 m0, s38, s47
  s_nop 0
  buffer_load_dwordx4 v15, s[12:15], s37 offen offset:0  lds
  buffer_load_dwordx4 v16, s[12:15], s37 offen offset:1024  lds
  s_add_u32 m0, s38, s48
  s_nop 0
  buffer_load_dwordx4 v17, s[12:15], s37 offen offset:0  lds
  buffer_load_dwordx4 v18, s[12:15], s37 offen offset:1024  lds
  s_add_u32 s38, s38, 43008
  s_cmp_eq_u32 s38, 129024
  s_cselect_b32 s38, 0, s38
  global_load_dword v29, v134, s[62:63] sc0 sc1
  s_waitcnt vmcnt(11)
  s_barrier
  s_add_u32 s30, s30, 1
  s_and_b32 s30, s30, 7
  s_cselect_b32 s32, 0, 1
  s_add_u32 s31, s31, s32
  s_sub_u32 s32, s30, s7
  s_and_b32 s32, s32, 7
  s_cmp_lt_u32 s32, 2
  s_cselect_b32 s32, 1, 0
  s_add_u32 s32, s32, s31
  s_cmp_ge_u32 s32, 2
  s_cselect_b32 s32, 0, s32
  s_lshl_b32 s33, s32, 3
  s_add_u32 s33, s33, s30
  s_mul_i32 s36, s33, s54
  s_add_u32 s36, s36, s34
  s_mul_i32 s37, s33, 393216
  s_add_u32 s37, s37, s35
  s_add_u32 m0, s38, s45
  s_mov_b64 exec, s[52:53]
  buffer_load_dwordx4 v12, s[8:11], s36 offen offset:0 sc1 lds
  s_mov_b64 exec, -1
  s_add_u32 m0, s38, s44
  s_nop 0
  buffer_load_dwordx4 v8, s[8:11], s36 offen offset:0 sc1 lds
  buffer_load_dwordx4 v9, s[8:11], s36 offen offset:1024 sc1 lds
  buffer_load_dwordx4 v10, s[8:11], s36 offen offset:2048 sc1 lds
  buffer_load_dwordx4 v11, s[8:11], s36 offen offset:3072 sc1 lds
  s_add_u32 m0, s38, s46
  s_nop 0
  buffer_load_dwordx4 v13, s[12:15], s37 offen offset:0  lds
  buffer_load_dwordx4 v14, s[12:15], s37 offen offset:1024  lds
  s_add_u32 m0, s38, s47
  s_nop 0
  buffer_load_dwordx4 v15, s[12:15], s37 offen offset:0  lds
  buffer_load_dwordx4 v16, s[12:15], s37 offen offset:1024  lds
  s_add_u32 m0, s38, s48
  s_nop 0
  buffer_load_dwordx4 v17, s[12:15], s37 offen offset:0  lds
  buffer_load_dwordx4 v18, s[12:15], s37 offen offset:1024  lds
  s_add_u32 s38, s38, 43008
  s_cmp_eq_u32 s38, 129024
  s_cselect_b32 s38, 0, s38
  s_cmp_lg_u32 s3, 0
  s_cbranch_scc1 st10g
  s_waitcnt vmcnt(11)
  s_mov_b32 s61, 0
st10p:
  v_cmp_gt_u32 vcc, 64, v29
  s_add_u32 s61, s61, 1
  s_cmp_gt_u32 s61, 1000000
  s_cbranch_scc1 st10g
  s_cbranch_vccz st10g
  global_load_dword v29, v134, s[62:63] sc0 sc1
  s_waitcnt vmcnt(0)
  s_branch st10p
st10g:
  buffer_load_dwordx2 v[30:31], v27, s[20:23], 0 offen sc1
  s_mov_b32 s32, 32768
  buffer_load_dwordx2 v[32:33], v27, s[20:23], s32 offen sc1
  s_mov_b32 s32, 65536
  buffer_load_dwordx2 v[34:35], v27, s[20:23], s32 offen sc1
  s_mov_b32 s32, 98304
  buffer_load_dwordx2 v[36:37], v27, s[20:23], s32 offen sc1
  s_mov_b32 s32, 131072
  buffer_load_dwordx2 v[38:39], v27, s[20:23], s32 offen sc1
  s_mov_b32 s32, 163840
  buffer_load_dwordx2 v[40:41], v27, s[20:23], s32 offen sc1
  s_mov_b32 s32, 196608
  buffer_load_dwordx2 v[42:43], v27, s[20:23], s32 offen sc1
  s_mov_b32 s32, 229376
  buffer_load_dwordx2 v[44:45], v27, s[20:23], s32 offen sc1
  s_waitcnt vmcnt(19)
  s_barrier
  s_branch L_k1t
L_k1B:
  s_nop 7
  s_nop 7
  s_mov_b32 s30, 7
  s_mov_b32 s31, -1
  s_mov_b32 s38, 0
  s_add_u32 s30, s30, 1
  s_and_b32 s30, s30, 7
  s_cselect_b32 s32, 0, 1
  s_add_u32 s31, s31, s32
  s_sub_u32 s32, s30, s7
  s_and_b32 s32, s32, 7
  s_cmp_lt_u32 s32, 2
  s_cselect_b32 s32, 1, 0
  s_add_u32 s32, s32, s31
  s_cmp_ge_u32 s32, 2
  s_cselect_b32 s32, 0, s32
  s_lshl_b32 s33, s32, 3
  s_add_u32 s33, s33, s30
  s_mul_i32 s36, s33, s54
  s_add_u32 s36, s36, s34
  s_add_u32 m0, s38, s44
  s_nop 0
  buffer_load_dwordx4 v8, s[8:11], s36 offen offset:0 sc1 lds
  buffer_load_dwordx4 v9, s[8:11], s36 offen offset:1024 sc1 lds
  buffer_load_dwordx4 v10, s[8:11], s36 offen offset:2048 sc1 lds
  buffer_load_dwordx4 v11, s[8:11], s36 offen offset:3072 sc1 lds
  s_add_u32 s38, s38, 43008
  s_cmp_eq_u32 s38, 129024
  s_cselect_b32 s38, 0, s38
  s_add_u32 s30, s30, 1
  s_and_b32 s30, s30, 7
  s_cselect_b32 s32, 0, 1
  s_add_u32 s31, s31, s32
  s_sub_u32 s32, s30, s7
  s_and_b32 s32, s32, 7
  s_cmp_lt_u32 s32, 2
  s_cselect_b32 s32, 1, 0
  s_add_u32 s32, s32, s31
  s_cmp_ge_u32 s32, 2
  s_cselect_b32 s32, 0, s32
  s_lshl_b32 s33, s32, 3
  s_add_u32 s33, s33, s30
  s_mul_i32 s36, s33, s54
  s_add_u32 s36, s36, s34
  s_add_u32 m0, s38, s44
  s_nop 0
  buffer_load_dwordx4 v8, s[8:11], s36 offen offset:0 sc1 lds
  buffer_load_dwordx4 v9, s[8:11], s36 offen offset:1024 sc1 lds
  buffer_load_dwordx4 v10, s[8:11], s36 offen offset:2048 sc1 lds
  buffer_load_dwordx4 v11, s[8:11], s36 offen offset:3072 sc1 lds
  s_add_u32 s38, s38, 43008
  s_cmp_eq_u32 s38, 129024
  s_cselect_b32 s38, 0, s38
  s_waitcnt vmcnt(4)
  s_barrier
  s_add_u32 s30, s30, 1
  s_and_b32 s30, s30, 7
  s_cselect_b32 s32, 0, 1
  s_add_u32 s31, s31, s32
  s_sub_u32 s32, s30, s7
  s_and_b32 s32, s32, 7
  s_cmp_lt_u32 s32, 2
  s_cselect_b32 s32, 1, 0
  s_add_u32 s32, s32, s31
  s_cmp_ge_u32 s32, 2
  s_cselect_b32 s32, 0, s32
  s_lshl_b32 s33, s32, 3
  s_add_u32 s33, s33, s30
  s_mul_i32 s36, s33, s54
  s_add_u32 s36, s36, s34
  s_mul_i32 s37, s33, 393216
  s_add_u32 s37, s37, s35
  s_add_u32 m0, s38, s44
  s_nop 0
  buffer_load_dwordx4 v8, s[8:11], s36 offen offset:0 sc1 lds
  buffer_load_dwordx4 v9, s[8:11], s36 offen offset:1024 sc1 lds
  buffer_load_dwordx4 v10, s[8:11], s36 offen offset:2048 sc1 lds
  buffer_load_dwordx4 v11, s[8:11], s36 offen offset:3072 sc1 lds
  s_add_u32 m0, s38, s46
  s_nop 0
  buffer_load_dwordx4 v13, s[12:15], s37 offen offset:0  lds
  buffer_load_dwordx4 v14, s[12:15], s37 offen offset:1024  lds
  s_add_u32 m0, s38, s47
  s_nop 0
  buffer_load_dwordx4 v15, s[12:15], s37 offen offset:0  lds
  buffer_load_dwordx4 v16, s[12:15], s37 offen offset:1024  lds
  s_add_u32 m0, s38, s48
  s_nop 0
  buffer_load_dwordx4 v17, s[12:15], s37 offen offset:0  lds
  buffer_load_dwordx4 v18, s[12:15], s37 offen offset:1024  lds
  s_add_u32 s38, s38, 43008
  s_cmp_eq_u32 s38, 129024
  s_cselect_b32 s38, 0, s38
L_jB:
  s_nop 1
  s_waitcnt vmcnt(10)
  s_barrier
  s_add_u32 s30, s30, 1
  s_and_b32 s30, s30, 7
  s_cselect_b32 s32, 0, 1
  s_add_u32 s31, s31, s32
  s_sub_u32 s32, s30, s7
  s_and_b32 s32, s32, 7
  s_cmp_lt_u32 s32, 2
  s_cselect_b32 s32, 1, 0
  s_add_u32 s32, s32, s31
  s_cmp_ge_u32 s32, 2
  s_cselect_b32 s32, 0, s32
  s_lshl_b32 s33, s32, 3
  s_add_u32 s33, s33, s30
  s_mul_i32 s36, s33, s54
  s_add_u32 s36, s36, s34
  s_mul_i32 s37, s33, 393216
  s_add_u32 s37, s37, s35
  s_add_u32 m0, s38, s44
  s_nop 0
  buffer_load_dwordx4 v8, s[8:11], s36 offen offset:0 sc1 lds
  buffer_load_dwordx4 v9, s[8:11], s36 offen offset:1024 sc1 lds
  buffer_load_dwordx4 v10, s[8:11], s36 offen offset:2048 sc1 lds
  buffer_load_dwordx4 v11, s[8:11], s36 offen offset:3072 sc1 lds
  s_add_u32 m0, s38, s46
  s_nop 0
  buffer_load_dwordx4 v13, s[12:15], s37 offen offset:0  lds
  buffer_load_dwordx4 v14, s[12:15], s37 offen offset:1024  lds
  s_add_u32 m0, s38, s47
  s_nop 0
  buffer_load_dwordx4 v15, s[12:15], s37 offen offset:0  lds
  buffer_load_dwordx4 v16, s[12:15], s37 offen offset:1024  lds
  s_add_u32 m0, s38, s48
  s_nop 0
  buffer_load_dwordx4 v17, s[12:15], s37 offen offset:0  lds
  buffer_load_dwordx4 v18, s[12:15], s37 offen offset:1024  lds
  s_add_u32 s38, s38, 43008
  s_cmp_eq_u32 s38, 129024
  s_cselect_b32 s38, 0, s38
  s_waitcnt vmcnt(10)
  s_barrier
  s_add_u32 s30, s30, 1
  s_and_b32 s30, s30, 7
  s_cselect_b32 s32, 0, 1
  s_add_u32 s31, s31, s32
  s_sub_u32 s32, s30, s7
  s_and_b32 s32, s32, 7
  s_cmp_lt_u32 s32, 2
  s_cselect_b32 s32, 1, 0
  s_add_u32 s32, s32, s31
  s_cmp_ge_u32 s32, 2
  s_cselect_b32 s32, 0, s32
  s_lshl_b32 s33, s32, 3
  s_add_u32 s33, s33, s30
  s_mul_i32 s36, s33, s54
  s_add_u32 s36, s36, s34
  s_mul_i32 s37, s33, 393216
  s_add_u32 s37, s37, s35
  s_add_u32 m0, s38, s44
  s_nop 0
  buffer_load_dwordx4 v8, s[8:11], s36 offen offset:0 sc1 lds
  buffer_load_dwordx4 v9, s[8:11], s36 offen offset:1024 sc1 lds
  buffer_load_dwordx4 v10, s[8:11], s36 offen offset:2048 sc1 lds
  buffer_load_dwordx4 v11, s[8:11], s36 offen offset:3072 sc1 lds
  s_add_u32 m0, s38, s46
  s_nop 0
  buffer_load_dwordx4 v13, s[12:15], s37 offen offset:0  lds
  buffer_load_dwordx4 v14, s[12:15], s37 offen offset:1024  lds
  s_add_u32 m0, s38, s47
  s_nop 0
  buffer_load_dwordx4 v15, s[12:15], s37 offen offset:0  lds
  buffer_load_dwordx4 v16, s[12:15], s37 offen offset:1024  lds
  s_add_u32 m0, s38, s48
  s_nop 0
  buffer_load_dwordx4 v17, s[12:15], s37 offen offset:0  lds
  buffer_load_dwordx4 v18, s[12:15], s37 offen offset:1024  lds
  s_add_u32 s38, s38, 43008
  s_cmp_eq_u32 s38, 129024
  s_cselect_b32 s38, 0, s38
  s_cmp_lg_u32 s3, 0
  s_cbranch_scc1 e11
  s_cmp_lg_u32 s57, 0
  s_cbranch_scc1 g12
  s_mov_b64 exec, 1
  global_atomic_add v73, v74, s[62:63] sc1
  s_mov_b64 exec, -1
g12:
e11:
  s_nop 1
  s_mov_b32 s39, 9
ll13:
  s_waitcnt vmcnt(10)
  s_barrier
  s_add_u32 s30, s30, 1
  s_and_b32 s30, s30, 7
  s_cselect_b32 s32, 0, 1
  s_add_u32 s31, s31, s32
  s_sub_u32 s32, s30, s7
  s_and_b32 s32, s32, 7
  s_cmp_lt_u32 s32, 2
  s_cselect_b32 s32, 1, 0
  s_add_u32 s32, s32, s31
  s_cmp_ge_u32 s32, 2
  s_cselect_b32 s32, 0, s32
  s_lshl_b32 s33, s32, 3
  s_add_u32 s33, s33, s30
  s_mul_i32 s36, s33, s54
  s_add_u32 s36, s36, s34
  s_mul_i32 s37, s33, 393216
  s_add_u32 s37, s37, s35
  s_add_u32 m0, s38, s44
  s_nop 0
  buffer_load_dwordx4 v8, s[8:11], s36 offen offset:0 sc1 lds
  buffer_load_dwordx4 v9, s[8:11], s36 offen offset:1024 sc1 lds
  buffer_load_dwordx4 v10, s[8:11], s36 offen offset:2048 sc1 lds
  buffer_load_dwordx4 v11, s[8:11], s36 offen offset:3072 sc1 lds
  s_add_u32 m0, s38, s46
  s_nop 0
  buffer_load_dwordx4 v13, s[12:15], s37 offen offset:0  lds
  buffer_load_dwordx4 v14, s[12:15], s37 offen offset:1024  lds
  s_add_u32 m0, s38, s47
  s_nop 0
  buffer_load_dwordx4 v15, s[12:15], s37 offen offset:0  lds
  buffer_load_dwordx4 v16, s[12:15], s37 offen offset:1024  lds
  s_add_u32 m0, s38, s48
  s_nop 0
  buffer_load_dwordx4 v17, s[12:15], s37 offen offset:0  lds
  buffer_load_dwordx4 v18, s[12:15], s37 offen offset:1024  lds
  s_add_u32 s38, s38, 43008
  s_cmp_eq_u32 s38, 129024
  s_cselect_b32 s38, 0, s38
  s_sub_u32 s39, s39, 1
  s_cmp_lg_u32 s39, 0
  s_cbranch_scc1 ll13
  s_waitcnt vmcnt(10)
  s_barrier
  s_add_u32 s30, s30, 1
  s_and_b32 s30, s30, 7
  s_cselect_b32 s32, 0, 1
  s_add_u32 s31, s31, s32
  s_sub_u32 s32, s30, s7
  s_and_b32 s32, s32, 7
  s_cmp_lt_u32 s32, 2
  s_cselect_b32 s32, 1, 0
  s_add_u32 s32, s32, s31
  s_cmp_ge_u32 s32, 2
  s_cselect_b32 s32, 0, s32
  s_lshl_b32 s33, s32, 3
  s_add_u32 s33, s33, s30
  s_mul_i32 s36, s33, s54
  s_add_u32 s36, s36, s34
  s_mul_i32 s37, s33, 393216
  s_add_u32 s37, s37, s35
  s_add_u32 m0, s38, s44
  s_nop 0
  buffer_load_dwordx4 v8, s[8:11], s36 offen offset:0 sc1 lds
  buffer_load_dwordx4 v9, s[8:11], s36 offen offset:1024 sc1 lds
  buffer_load_dwordx4 v10, s[8:11], s36 offen offset:2048 sc1 lds
  buffer_load_dwordx4 v11, s[8:11], s36 offen offset:3072 sc1 lds
  s_add_u32 m0, s38, s46
  s_nop 0
  buffer_load_dwordx4 v13, s[12:15], s37 offen offset:0  lds
  buffer_load_dwordx4 v14, s[12:15], s37 offen offset:1024  lds
  s_add_u32 m0, s38, s47
  s_nop 0
  buffer_load_dwordx4 v15, s[12:15], s37 offen offset:0  lds
  buffer_load_dwordx4 v16, s[12:15], s37 offen offset:1024  lds
  s_add_u32 m0, s38, s48
  s_nop 0
  buffer_load_dwordx4 v17, s[12:15], s37 offen offset:0  lds
  buffer_load_dwordx4 v18, s[12:15], s37 offen offset:1024  lds
  s_add_u32 s38, s38, 43008
  s_cmp_eq_u32 s38, 129024
  s_cselect_b32 s38, 0, s38
  global_load_dword v29, v134, s[62:63] sc0 sc1
  s_waitcnt vmcnt(10)
  s_barrier
  s_add_u32 s30, s30, 1
  s_and_b32 s30, s30, 7
  s_cselect_b32 s32, 0, 1
  s_add_u32 s31, s31, s32
  s_sub_u32 s32, s30, s7
  s_and_b32 s32, s32, 7
  s_cmp_lt_u32 s32, 2
  s_cselect_b32 s32, 1, 0
  s_add_u32 s32, s32, s31
  s_cmp_ge_u32 s32, 2
  s_cselect_b32 s32, 0, s32
  s_lshl_b32 s33, s32, 3
  s_add_u32 s33, s33, s30
  s_mul_i32 s36, s33, s54
  s_add_u32 s36, s36, s34
  s_mul_i32 s37, s33, 393216
  s_add_u32 s37, s37, s35
  s_add_u32 m0, s38, s44
  s_nop 0
  buffer_load_dwordx4 v8, s[8:11], s36 offen offset:0 sc1 lds
  buffer_load_dwordx4 v9, s[8:11], s36 offen offset:1024 sc1 lds
  buffer_load_dwordx4 v10, s[8:11], s36 offen offset:2048 sc1 lds
  buffer_load_dwordx4 v11, s[8:11], s36 offen offset:3072 sc1 lds
  s_add_u32 m0, s38, s46
  s_nop 0
  buffer_load_dwordx4 v13, s[12:15], s37 offen offset:0  lds
  buffer_load_dwordx4 v14, s[12:15], s37 offen offset:1024  lds
  s_add_u32 m0, s38, s47
  s_nop 0
  buffer_load_dwordx4 v15, s[12:15], s37 offen offset:0  lds
  buffer_load_dwordx4 v16, s[12:15], s37 offen offset:1024  lds
  s_add_u32 m0, s38, s48
  s_nop 0
  buffer_load_dwordx4 v17, s[12:15], s37 offen offset:0  lds
  buffer_load_dwordx4 v18, s[12:15], s37 offen offset:1024  lds
  s_add_u32 s38, s38, 43008
  s_cmp_eq_u32 s38, 129024
  s_cselect_b32 s38, 0, s38
  s_cmp_lg_u32 s3, 0
  s_cbranch_scc1 st14g
  s_waitcnt vmcnt(10)
  s_mov_b32 s61, 0
st14p:
  v_cmp_gt_u32 vcc, 64, v29
  s_add_u32 s61, s61, 1
  s_cmp_gt_u32 s61, 1000000
  s_cbranch_scc1 st14g
  s_cbranch_vccz st14g
  global_load_dword v29, v134, s[62:63] sc0 sc1
  s_waitcnt vmcnt(0)
  s_branch st14p
st14g:
  buffer_load_dwordx2 v[30:31], v27, s[20:23], 0 offen sc1
  s_mov_b32 s32, 32768
  buffer_load_dwordx2 v[32:33], v27, s[20:23], s32 offen sc1
  s_mov_b32 s32, 65536
  buffer_load_dwordx2 v[34:35], v27, s[20:23], s32 offen sc1
  s_mov_b32 s32, 98304
  buffer_load_dwordx2 v[36:37], v27, s[20:23], s32 offen sc1
  s_mov_b32 s32, 131072
  buffer_load_dwordx2 v[38:39], v27, s[20:23], s32 offen sc1
  s_mov_b32 s32, 163840
  buffer_load_dwordx2 v[40:41], v27, s[20:23], s32 offen sc1
  s_mov_b32 s32, 196608
  buffer_load_dwordx2 v[42:43], v27, s[20:23], s32 offen sc1
  s_mov_b32 s32, 229376
  buffer_load_dwordx2 v[44:45], v27, s[20:23], s32 offen sc1
  s_waitcnt vmcnt(18)
  s_barrier
  s_branch L_k1t
L_first:
  s_nop 7
  s_nop 7
  s_cmp_ge_u32 s57, 2
  s_cbranch_scc1 L_firstB
  s_add_u32 s30, s30, 1
  s_and_b32 s30, s30, 7
  s_cselect_b32 s32, 0, 1
  s_add_u32 s31, s31, s32
  s_sub_u32 s32, s30, s7
  s_and_b32 s32, s32, 7
  s_cmp_lt_u32 s32, 2
  s_cselect_b32 s32, 1, 0
  s_add_u32 s32, s32, s31
  s_cmp_ge_u32 s32, 2
  s_cselect_b32 s32, 0, s32
  s_lshl_b32 s33, s32, 3
  s_add_u32 s33, s33, s30
  s_mul_i32 s36, s33, s54
  s_add_u32 s36, s36, s34
  s_mul_i32 s37, s33, 393216
  s_add_u32 s37, s37, s35
  s_add_u32 m0, s38, s45
  s_mov_b64 exec, s[52:53]
  buffer_load_dwordx4 v12, s[8:11], s36 offen offset:0 sc1 lds
  s_mov_b64 exec, -1
  s_add_u32 m0, s38, s44
  s_nop 0
  buffer_load_dwordx4 v8, s[8:11], s36 offen offset:0 sc1 lds
  buffer_load_dwordx4 v9, s[8:11], s36 offen offset:1024 sc1 lds
  buffer_load_dwordx4 v10, s[8:11], s36 offen offset:2048 sc1 lds
  buffer_load_dwordx4 v11, s[8:11], s36 offen offset:3072 sc1 lds
  s_add_u32 m0, s38, s46
  s_nop 0
  buffer_load_dwordx4 v13, s[12:15], s37 offen offset:0  lds
  buffer_load_dwordx4 v14, s[12:15], s37 offen offset:1024  lds
  s_add_u32 m0, s38, s47
  s_nop 0
  buffer_load_dwordx4 v15, s[12:15], s37 offen offset:0  lds
  buffer_load_dwordx4 v16, s[12:15], s37 offen offset:1024  lds
  s_add_u32 m0, s38, s48
  s_nop 0
  buffer_load_dwordx4 v17, s[12:15], s37 offen offset:0  lds
  buffer_load_dwordx4 v18, s[12:15], s37 offen offset:1024  lds
  s_add_u32 s38, s38, 43008
  s_cmp_eq_u32 s38, 129024
  s_cselect_b32 s38, 0, s38
  s_mov_b32 s16, s84
  s_mov_b32 s17, s85
  s_mov_b32 s18, 117440512
  s_mov_b32 s19, 0x20000
  s_add_u32 s20, s84, 42991616
  s_addc_u32 s21, s85, 0
  s_mov_b32 s22, 32768
  s_mov_b32 s23, 0x20000
  s_mov_b32 s82, s84
  s_mov_b32 s83, s85
  s_add_u32 s30, s30, 1
  s_and_b32 s30, s30, 7
  s_cselect_b32 s32, 0, 1
  s_add_u32 s31, s31, s32
  s_sub_u32 s32, s30, s7
  s_and_b32 s32, s32, 7
  s_cmp_lt_u32 s32, 2
  s_cselect_b32 s32, 1, 0
  s_add_u32 s32, s32, s31
  s_cmp_ge_u32 s32, 2
  s_cselect_b32 s32, 0, s32
  s_lshl_b32 s33, s32, 3
  s_add_u32 s33, s33, s30
  s_mul_i32 s36, s33, s54
  s_add_u32 s36, s36, s34
  s_mul_i32 s37, s33, 393216
  s_add_u32 s37, s37, s35
  s_add_u32 m0, s38, s45
  s_mov_b64 exec, s[52:53]
  buffer_load_dwordx4 v12, s[8:11], s36 offen offset:0 sc1 lds
  s_mov_b64 exec, -1
  s_add_u32 m0, s38, s44
  s_nop 0
  buffer_load_dwordx4 v8, s[8:11], s36 offen offset:0 sc1 lds
  buffer_load_dwordx4 v9, s[8:11], s36 offen offset:1024 sc1 lds
  buffer_load_dwordx4 v10, s[8:11], s36 offen offset:2048 sc1 lds
  buffer_load_dwordx4 v11, s[8:11], s36 offen offset:3072 sc1 lds
  s_add_u32 m0, s38, s46
  s_nop 0
  buffer_load_dwordx4 v13, s[12:15], s37 offen offset:0  lds
  buffer_load_dwordx4 v14, s[12:15], s37 offen offset:1024  lds
  s_add_u32 m0, s38, s47
  s_nop 0
  buffer_load_dwordx4 v15, s[12:15], s37 offen offset:0  lds
  buffer_load_dwordx4 v16, s[12:15], s37 offen offset:1024  lds
  s_add_u32 m0, s38, s48
  s_nop 0
  buffer_load_dwordx4 v17, s[12:15], s37 offen offset:0  lds
  buffer_load_dwordx4 v18, s[12:15], s37 offen offset:1024  lds
  s_add_u32 s38, s38, 43008
  s_cmp_eq_u32 s38, 129024
  s_cselect_b32 s38, 0, s38
  buffer_load_dwordx4 v[48:51], v46, s[8:11], 0 offen offset:0
  buffer_load_dwordx4 v[52:55], v46, s[8:11], 0 offen offset:512
  buffer_load_dwordx4 v[56:59], v46, s[8:11], 0 offen offset:1024
  buffer_load_dwordx4 v[60:63], v46, s[8:11], 0 offen offset:1536
  buffer_store_dwordx4 v[64:67], v47, s[16:19], s58 offen sc0 sc1
  s_barrier
  s_waitcnt vmcnt(16)
  s_barrier
  s_add_u32 s30, s30, 1
  s_and_b32 s30, s30, 7
  s_cselect_b32 s32, 0, 1
  s_add_u32 s31, s31, s32
  s_sub_u32 s32, s30, s7
  s_and_b32 s32, s32, 7
  s_cmp_lt_u32 s32, 2
  s_cselect_b32 s32, 1, 0
  s_add_u32 s32, s32, s31
  s_cmp_ge_u32 s32, 2
  s_cselect_b32 s32, 0, s32
  s_lshl_b32 s33, s32, 3
  s_add_u32 s33, s33, s30
  s_mul_i32 s36, s33, s54
  s_add_u32 s36, s36, s34
  s_mul_i32 s37, s33, 393216
  s_add_u32 s37, s37, s35
  s_add_u32 m0, s38, s45
  s_mov_b64 exec, s[52:53]
  buffer_load_dwordx4 v12, s[8:11], s36 offen offset:0 sc1 lds
  s_mov_b64 exec, -1
  s_add_u32 m0, s38, s44
  s_nop 0
  buffer_load_dwordx4 v8, s[8:11], s36 offen offset:0 sc1 lds
  buffer_load_dwordx4 v9, s[8:11], s36 offen offset:1024 sc1 lds
  buffer_load_dwordx4 v10, s[8:11], s36 offen offset:2048 sc1 lds
  buffer_load_dwordx4 v11, s[8:11], s36 offen offset:3072 sc1 lds
  s_add_u32 m0, s38, s46
  s_nop 0
  buffer_load_dwordx4 v13, s[12:15], s37 offen offset:0  lds
  buffer_load_dwordx4 v14, s[12:15], s37 offen offset:1024  lds
  s_add_u32 m0, s38, s47
  s_nop 0
  buffer_load_dwordx4 v15, s[12:15], s37 offen offset:0  lds
  buffer_load_dwordx4 v16, s[12:15], s37 offen offset:1024  lds
  s_add_u32 m0, s38, s48
  s_nop 0
  buffer_load_dwordx4 v17, s[12:15], s37 offen offset:0  lds
  buffer_load_dwordx4 v18, s[12:15], s37 offen offset:1024  lds
  s_add_u32 s38, s38, 43008
  s_cmp_eq_u32 s38, 129024
  s_cselect_b32 s38, 0, s38
  v_mov_b32 v68, 0
  v_mov_b32 v69, 0
  v_mov_b32 v70, 0x3f803f80
  s_waitcnt vmcnt(12)
  v_dot2c_f32_bf16 v68, v70, v48
  v_dot2c_f32_bf16 v69, v48, v48
  v_dot2c_f32_bf16 v68, v70, v49
  v_dot2c_f32_bf16 v69, v49, v49
  v_dot2c_f32_bf16 v68, v70, v50
  v_dot2c_f32_bf16 v69, v50, v50
  v_dot2c_f32_bf16 v68, v70, v51
  v_dot2c_f32_bf16 v69, v51, v51
  v_dot2c_f32_bf16 v68, v70, v52
  v_dot2c_f32_bf16 v69, v52, v52
  v_dot2c_f32_bf16 v68, v70, v53
  v_dot2c_f32_bf16 v69, v53, v53
  v_dot2c_f32_bf16 v68, v70, v54
  v_dot2c_f32_bf16 v69, v54, v54
  v_dot2c_f32_bf16 v68, v70, v55
  v_dot2c_f32_bf16 v69, v55, v55
  v_dot2c_f32_bf16 v68, v70, v56
  v_dot2c_f32_bf16 v69, v56, v56
  v_dot2c_f32_bf16 v68, v70, v57
  v_dot2c_f32_bf16 v69, v57, v57
  v_dot2c_f32_bf16 v68, v70, v58
  v_dot2c_f32_bf16 v69, v58, v58
  v_dot2c_f32_bf16 v68, v70, v59
  v_dot2c_f32_bf16 v69, v59, v59
  v_dot2c_f32_bf16 v68, v70, v60
  v_dot2c_f32_bf16 v69, v60, v60
  v_dot2c_f32_bf16 v68, v70, v61
  v_dot2c_f32_bf16 v69, v61, v61
  v_dot2c_f32_bf16 v68, v70, v62
  v_dot2c_f32_bf16 v69, v62, v62
  v_dot2c_f32_bf16 v68, v70, v63
  v_dot2c_f32_bf16 v69, v63, v63
  s_nop 1
  v_add_f32_dpp v68, v68, v68 quad_perm:[1,0,3,2] row_mask:0xf bank_mask:0xf
  v_add_f32_dpp v69, v69, v69 quad_perm:[1,0,3,2] row_mask:0xf bank_mask:0xf
  s_nop 0
  v_add_f32_dpp v68, v68, v68 quad_perm:[2,3,0,1] row_mask:0xf bank_mask:0xf
  v_add_f32_dpp v69, v69, v69 quad_perm:[2,3,0,1] row_mask:0xf bank_mask:0xf
  s_nop 0
  v_add_f32_dpp v68, v68, v68 row_half_mirror row_mask:0xf bank_mask:0xf
  v_add_f32_dpp v69, v69, v69 row_half_mirror row_mask:0xf bank_mask:0xf
  s_nop 0
  v_add_f32_dpp v68, v68, v68 row_mirror row_mask:0xf bank_mask:0xf
  v_add_f32_dpp v69, v69, v69 row_mirror row_mask:0xf bank_mask:0xf
  v_mov_b32 v70, v68
  v_mov_b32 v71, v69
  s_nop 0
  v_permlane16_swap_b32 v68, v70
  v_permlane16_swap_b32 v69, v71
  v_add_f32 v68, v68, v70
  v_add_f32 v69, v69, v71
  s_mov_b32 exec_lo, 1
  s_mov_b32 exec_hi, 1
  buffer_store_dwordx2 v[68:69], v72, s[16:19], 0 offen sc0 sc1
  s_mov_b64 exec, -1
  s_mov_b32 s60, 0
  s_branch L_jA
L_firstB:
  s_nop 7
  s_nop 7
  s_add_u32 s30, s30, 1
  s_and_b32 s30, s30, 7
  s_cselect_b32 s32, 0, 1
  s_add_u32 s31, s31, s32
  s_sub_u32 s32, s30, s7
  s_and_b32 s32, s32, 7
  s_cmp_lt_u32 s32, 2
  s_cselect_b32 s32, 1, 0
  s_add_u32 s32, s32, s31
  s_cmp_ge_u32 s32, 2
  s_cselect_b32 s32, 0, s32
  s_lshl_b32 s33, s32, 3
  s_add_u32 s33, s33, s30
  s_mul_i32 s36, s33, s54
  s_add_u32 s36, s36, s34
  s_mul_i32 s37, s33, 393216
  s_add_u32 s37, s37, s35
  s_add_u32 m0, s38, s44
  s_nop 0
  buffer_load_dwordx4 v8, s[8:11], s36 offen offset:0 sc1 lds
  buffer_load_dwordx4 v9, s[8:11], s36 offen offset:1024 sc1 lds
  buffer_load_dwordx4 v10, s[8:11], s36 offen offset:2048 sc1 lds
  buffer_load_dwordx4 v11, s[8:11], s36 offen offset:3072 sc1 lds
  s_add_u32 m0, s38, s46
  s_nop 0
  buffer_load_dwordx4 v13, s[12:15], s37 offen offset:0  lds
  buffer_load_dwordx4 v14, s[12:15], s37 offen offset:1024  lds
  s_add_u32 m0, s38, s47
  s_nop 0
  buffer_load_dwordx4 v15, s[12:15], s37 offen offset:0  lds
  buffer_load_dwordx4 v16, s[12:15], s37 offen offset:1024  lds
  s_add_u32 m0, s38, s48
  s_nop 0
  buffer_load_dwordx4 v17, s[12:15], s37 offen offset:0  lds
  buffer_load_dwordx4 v18, s[12:15], s37 offen offset:1024  lds
  s_add_u32 s38, s38, 43008
  s_cmp_eq_u32 s38, 129024
  s_cselect_b32 s38, 0, s38
  s_mov_b32 s16, s84
  s_mov_b32 s17, s85
  s_mov_b32 s18, 117440512
  s_mov_b32 s19, 0x20000
  s_add_u32 s20, s84, 42991616
  s_addc_u32 s21, s85, 0
  s_mov_b32 s22, 32768
  s_mov_b32 s23, 0x20000
  s_mov_b32 s82, s84
  s_mov_b32 s83, s85
  s_add_u32 s30, s30, 1
  s_and_b32 s30, s30, 7
  s_cselect_b32 s32, 0, 1
  s_add_u32 s31, s31, s32
  s_sub_u32 s32, s30, s7
  s_and_b32 s32, s32, 7
  s_cmp_lt_u32 s32, 2
  s_cselect_b32 s32, 1, 0
  s_add_u32 s32, s32, s31
  s_cmp_ge_u32 s32, 2
  s_cselect_b32 s32, 0, s32
  s_lshl_b32 s33, s32, 3
  s_add_u32 s33, s33, s30
  s_mul_i32 s36, s33, s54
  s_add_u32 s36, s36, s34
  s_mul_i32 s37, s33, 393216
  s_add_u32 s37, s37, s35
  s_add_u32 m0, s38, s44
  s_nop 0
  buffer_load_dwordx4 v8, s[8:11], s36 offen offset:0 sc1 lds
  buffer_load_dwordx4 v9, s[8:11], s36 offen offset:1024 sc1 lds
  buffer_load_dwordx4 v10, s[8:11], s36 offen offset:2048 sc1 lds
  buffer_load_dwordx4 v11, s[8:11], s36 offen offset:3072 sc1 lds
  s_add_u32 m0, s38, s46
  s_nop 0
  buffer_load_dwordx4 v13, s[12:15], s37 offen offset:0  lds
  buffer_load_dwordx4 v14, s[12:15], s37 offen offset:1024  lds
  s_add_u32 m0, s38, s47
  s_nop 0
  buffer_load_dwordx4 v15, s[12:15], s37 offen offset:0  lds
  buffer_load_dwordx4 v16, s[12:15], s37 offen offset:1024  lds
  s_add_u32 m0, s38, s48
  s_nop 0
  buffer_load_dwordx4 v17, s[12:15], s37 offen offset:0  lds
  buffer_load_dwordx4 v18, s[12:15], s37 offen offset:1024  lds
  s_add_u32 s38, s38, 43008
  s_cmp_eq_u32 s38, 129024
  s_cselect_b32 s38, 0, s38
  buffer_load_dwordx4 v[48:51], v46, s[8:11], 0 offen offset:0
  buffer_load_dwordx4 v[52:55], v46, s[8:11], 0 offen offset:512
  buffer_load_dwordx4 v[56:59], v46, s[8:11], 0 offen offset:1024
  buffer_load_dwordx4 v[60:63], v46, s[8:11], 0 offen offset:1536
  buffer_store_dwordx4 v[64:67], v47, s[16:19], s58 offen sc0 sc1
  s_barrier
  s_waitcnt vmcnt(15)
  s_barrier
  s_add_u32 s30, s30, 1
  s_and_b32 s30, s30, 7
  s_cselect_b32 s32, 0, 1
  s_add_u32 s31, s31, s32
  s_sub_u32 s32, s30, s7
  s_and_b32 s32, s32, 7
  s_cmp_lt_u32 s32, 2
  s_cselect_b32 s32, 1, 0
  s_add_u32 s32, s32, s31
  s_cmp_ge_u32 s32, 2
  s_cselect_b32 s32, 0, s32
  s_lshl_b32 s33, s32, 3
  s_add_u32 s33, s33, s30
  s_mul_i32 s36, s33, s54
  s_add_u32 s36, s36, s34
  s_mul_i32 s37, s33, 393216
  s_add_u32 s37, s37, s35
  s_add_u32 m0, s38, s44
  s_nop 0
  buffer_load_dwordx4 v8, s[8:11], s36 offen offset:0 sc1 lds
  buffer_load_dwordx4 v9, s[8:11], s36 offen offset:1024 sc1 lds
  buffer_load_dwordx4 v10, s[8:11], s36 offen offset:2048 sc1 lds
  buffer_load_dwordx4 v11, s[8:11], s36 offen offset:3072 sc1 lds
  s_add_u32 m0, s38, s46
  s_nop 0
  buffer_load_dwordx4 v13, s[12:15], s37 offen offset:0  lds
  buffer_load_dwordx4 v14, s[12:15], s37 offen offset:1024  lds
  s_add_u32 m0, s38, s47
  s_nop 0
  buffer_load_dwordx4 v15, s[12:15], s37 offen offset:0  lds
  buffer_load_dwordx4 v16, s[12:15], s37 offen offset:1024  lds
  s_add_u32 m0, s38, s48
  s_nop 0
  buffer_load_dwordx4 v17, s[12:15], s37 offen offset:0  lds
  buffer_load_dwordx4 v18, s[12:15], s37 offen offset:1024  lds
  s_add_u32 s38, s38, 43008
  s_cmp_eq_u32 s38, 129024
  s_cselect_b32 s38, 0, s38
  v_mov_b32 v68, 0
  v_mov_b32 v69, 0
  v_mov_b32 v70, 0x3f803f80
  s_waitcnt vmcnt(11)
  v_dot2c_f32_bf16 v68, v70, v48
  v_dot2c_f32_bf16 v69, v48, v48
  v_dot2c_f32_bf16 v68, v70, v49
  v_dot2c_f32_bf16 v69, v49, v49
  v_dot2c_f32_bf16 v68, v70, v50
  v_dot2c_f32_bf16 v69, v50, v50
  v_dot2c_f32_bf16 v68, v70, v51
  v_dot2c_f32_bf16 v69, v51, v51
  v_dot2c_f32_bf16 v68, v70, v52
  v_dot2c_f32_bf16 v69, v52, v52
  v_dot2c_f32_bf16 v68, v70, v53
  v_dot2c_f32_bf16 v69, v53, v53
  v_dot2c_f32_bf16 v68, v70, v54
  v_dot2c_f32_bf16 v69, v54, v54
  v_dot2c_f32_bf16 v68, v70, v55
  v_dot2c_f32_bf16 v69, v55, v55
  v_dot2c_f32_bf16 v68, v70, v56
  v_dot2c_f32_bf16 v69, v56, v56
  v_dot2c_f32_bf16 v68, v70, v57
  v_dot2c_f32_bf16 v69, v57, v57
  v_dot2c_f32_bf16 v68, v70, v58
  v_dot2c_f32_bf16 v69, v58, v58
  v_dot2c_f32_bf16 v68, v70, v59
  v_dot2c_f32_bf16 v69, v59, v59
  v_dot2c_f32_bf16 v68, v70, v60
  v_dot2c_f32_bf16 v69, v60, v60
  v_dot2c_f32_bf16 v68, v70, v61
  v_dot2c_f32_bf16 v69, v61, v61
  v_dot2c_f32_bf16 v68, v70, v62
  v_dot2c_f32_bf16 v69, v62, v62
  v_dot2c_f32_bf16 v68, v70, v63
  v_dot2c_f32_bf16 v69, v63, v63
  s_nop 1
  v_add_f32_dpp v68, v68, v68 quad_perm:[1,0,3,2] row_mask:0xf bank_mask:0xf
  v_add_f32_dpp v69, v69, v69 quad_perm:[1,0,3,2] row_mask:0xf bank_mask:0xf
  s_nop 0
  v_add_f32_dpp v68, v68, v68 quad_perm:[2,3,0,1] row_mask:0xf bank_mask:0xf
  v_add_f32_dpp v69, v69, v69 quad_perm:[2,3,0,1] row_mask:0xf bank_mask:0xf
  s_nop 0
  v_add_f32_dpp v68, v68, v68 row_half_mirror row_mask:0xf bank_mask:0xf
  v_add_f32_dpp v69, v69, v69 row_half_mirror row_mask:0xf bank_mask:0xf
  s_nop 0
  v_add_f32_dpp v68, v68, v68 row_mirror row_mask:0xf bank_mask:0xf
  v_add_f32_dpp v69, v69, v69 row_mirror row_mask:0xf bank_mask:0xf
  v_mov_b32 v70, v68
  v_mov_b32 v71, v69
  s_nop 0
  v_permlane16_swap_b32 v68, v70
  v_permlane16_swap_b32 v69, v71
  v_add_f32 v68, v68, v70
  v_add_f32 v69, v69, v71
  s_mov_b32 exec_lo, 1
  s_mov_b32 exec_hi, 1
  buffer_store_dwordx2 v[68:69], v72, s[16:19], 0 offen sc0 sc1
  s_mov_b64 exec, -1
  s_mov_b32 s60, 0
  s_branch L_jB
L_k1t:
  s_nop 7
  s_nop 7
  s_waitcnt vmcnt(0)
  v_pk_add_f32 v[30:31], v[30:31], v[32:33]
  v_pk_add_f32 v[34:35], v[34:35], v[36:37]
  v_pk_add_f32 v[38:39], v[38:39], v[40:41]
  v_pk_add_f32 v[42:43], v[42:43], v[44:45]
  v_pk_add_f32 v[30:31], v[30:31], v[34:35]
  v_pk_add_f32 v[38:39], v[38:39], v[42:43]
  v_pk_add_f32 v[30:31], v[30:31], v[38:39]
  v_mul_f32 v30, 0x3a800000, v30
  v_mul_f32 v31, 0x3a800000, v31
  v_fma_f32 v31, -v30, v30, v31
  v_max_f32 v31, 0, v31
  v_mov_b32 v32, v31
  v_cvt_pk_bf16_f32 v32, v32, v32
  v_lshlrev_b32 v32, 16, v32
  v_add_f32 v32, 0x3727c5ac, v32
  v_cvt_pk_bf16_f32 v32, v32, v32
  v_lshlrev_b32 v32, 16, v32
  v_sqrt_f32 v32, v32
  s_nop 0
  v_cvt_pk_bf16_f32 v32, v32, v32
  v_lshlrev_b32 v32, 16, v32
  v_rcp_f32 v32, v32
  v_cvt_pk_bf16_f32 v30, v30, v30
  v_lshlrev_b32 v30, 16, v30
  v_mov_b32 v31, v32
  ds_write_b64 v26, v[30:31]
  s_waitcnt lgkmcnt(0)
  s_mov_b32 s41, s57
  s_mul_i32 s32, s41, 16
  s_add_u32 s32, s32, 0
  v_lshrrev_b32 v2, 3, v0
  v_add_u32 v2, s32, v2
  v_bfe_u32 v3, v2, 1, 1
  v_bfe_u32 v4, v2, 3, 1
  v_lshl_or_b32 v3, v4, 1, v3
  v_lshlrev_b32 v3, 1, v3
  v_and_b32 v4, 7, v0
  v_xor_b32 v3, v3, v4
  v_lshlrev_b32 v3, 4, v3
  s_mov_b32 s32, 2048
  v_mul_lo_u32 v2, v2, s32
  v_add_u32 v130, v2, v3
  s_mul_i32 s32, s41, 16
  s_add_u32 s32, s32, 8
  v_lshrrev_b32 v2, 3, v0
  v_add_u32 v2, s32, v2
  v_bfe_u32 v3, v2, 1, 1
  v_bfe_u32 v4, v2, 3, 1
  v_lshl_or_b32 v3, v4, 1, v3
  v_lshlrev_b32 v3, 1, v3
  v_and_b32 v4, 7, v0
  v_xor_b32 v3, v3, v4
  v_lshlrev_b32 v3, 4, v3
  s_mov_b32 s32, 2048
  v_mul_lo_u32 v2, v2, s32
  v_add_u32 v131, v2, v3
  v_subrev_u32 v131, 1024, v131
  s_mov_b32 s12, s68
  s_mov_b32 s13, s69
  s_mov_b32 s14, 2097152
  s_mov_b32 s15, 0x20000
  s_mov_b32 s30, 7
  s_mov_b32 s31, -1
  s_lshl_b32 s52, s57, 11
  s_lshl_b32 s53, 0x303, s7
  s_lshr_b32 s53, s53, 8
  s_add_u32 s30, s30, 1
  s_and_b32 s30, s30, 7
  s_cselect_b32 s32, 0, 1
  s_add_u32 s31, s31, s32
  s_sub_u32 s32, s30, s7
  s_and_b32 s32, s32, 7
  s_cmp_lt_u32 s32, 2
  s_cselect_b32 s32, 1, 0
  s_add_u32 s32, s32, s31
  s_cmp_ge_u32 s32, 2
  s_cselect_b32 s32, 0, s32
  s_lshl_b32 s33, s32, 3
  s_add_u32 s33, s33, s30
  s_lshl_b32 s37, s33, 17
  s_add_u32 s37, s37, s35
  s_add_u32 m0, s52, 131072
  s_nop 0
  buffer_load_dwordx4 v130, s[12:15], s37 offen lds
  buffer_load_dwordx4 v131, s[12:15], s37 offen offset:1024 lds
  s_add_u32 s30, s30, 1
  s_and_b32 s30, s30, 7
  s_cselect_b32 s32, 0, 1
  s_add_u32 s31, s31, s32
  s_sub_u32 s32, s30, s7
  s_and_b32 s32, s32, 7
  s_cmp_lt_u32 s32, 2
  s_cselect_b32 s32, 1, 0
  s_add_u32 s32, s32, s31
  s_cmp_ge_u32 s32, 2
  s_cselect_b32 s32, 0, s32
  s_lshl_b32 s33, s32, 3
  s_add_u32 s33, s33, s30
  s_lshl_b32 s37, s33, 17
  s_add_u32 s37, s37, s35
  s_add_u32 m0, s52, 139264
  s_nop 0
  buffer_load_dwordx4 v130, s[12:15], s37 offen lds
  buffer_load_dwordx4 v131, s[12:15], s37 offen offset:1024 lds
  s_add_u32 s30, s30, 1
  s_and_b32 s30, s30, 7
  s_cselect_b32 s32, 0, 1
  s_add_u32 s31, s31, s32
  s_sub_u32 s32, s30, s7
  s_and_b32 s32, s32, 7
  s_cmp_lt_u32 s32, 2
  s_cselect_b32 s32, 1, 0
  s_add_u32 s32, s32, s31
  s_cmp_ge_u32 s32, 2
  s_cselect_b32 s32, 0, s32
  s_lshl_b32 s33, s32, 3
  s_add_u32 s33, s33, s30
  s_lshl_b32 s37, s33, 17
  s_add_u32 s37, s37, s35
  s_add_u32 m0, s52, 147456
  s_nop 0
  buffer_load_dwordx4 v130, s[12:15], s37 offen lds
  buffer_load_dwordx4 v131, s[12:15], s37 offen offset:1024 lds
  s_add_u32 s30, s30, 1
  s_and_b32 s30, s30, 7
  s_cselect_b32 s32, 0, 1
  s_add_u32 s31, s31, s32
  s_sub_u32 s32, s30, s7
  s_and_b32 s32, s32, 7
  s_cmp_lt_u32 s32, 2
  s_cselect_b32 s32, 1, 0
  s_add_u32 s32, s32, s31
  s_cmp_ge_u32 s32, 2
  s_cselect_b32 s32, 0, s32
  s_lshl_b32 s33, s32, 3
  s_add_u32 s33, s33, s30
  s_lshl_b32 s37, s33, 17
  s_add_u32 s37, s37, s35
  s_add_u32 m0, s52, 155648
  s_nop 0
  buffer_load_dwordx4 v130, s[12:15], s37 offen lds
  buffer_load_dwordx4 v131, s[12:15], s37 offen offset:1024 lds
  s_waitcnt vmcnt(8)
  s_barrier
  s_add_u32 s30, s30, 1
  s_and_b32 s30, s30, 7
  s_cselect_b32 s32, 0, 1
  s_add_u32 s31, s31, s32
  s_sub_u32 s32, s30, s7
  s_and_b32 s32, s32, 7
  s_cmp_lt_u32 s32, 2
  s_cselect_b32 s32, 1, 0
  s_add_u32 s32, s32, s31
  s_cmp_ge_u32 s32, 2
  s_cselect_b32 s32, 0, s32
  s_lshl_b32 s33, s32, 3
  s_add_u32 s33, s33, s30
  s_lshl_b32 s37, s33, 17
  s_add_u32 s37, s37, s35
  s_add_u32 m0, s52, 100608
  s_nop 0
  buffer_load_dwordx4 v130, s[12:15], s37 offen lds
  buffer_load_dwordx4 v131, s[12:15], s37 offen offset:1024 lds
  s_add_u32 s30, s30, 1
  s_and_b32 s30, s30, 7
  s_cselect_b32 s32, 0, 1
  s_add_u32 s31, s31, s32
  s_sub_u32 s32, s30, s7
  s_and_b32 s32, s32, 7
  s_cmp_lt_u32 s32, 2
  s_cselect_b32 s32, 1, 0
  s_add_u32 s32, s32, s31
  s_cmp_ge_u32 s32, 2
  s_cselect_b32 s32, 0, s32
  s_lshl_b32 s33, s32, 3
  s_add_u32 s33, s33, s30
  s_lshl_b32 s37, s33, 17
  s_add_u32 s37, s37, s35
  s_add_u32 m0, s52, 108800
  s_nop 0
  buffer_load_dwordx4 v130, s[12:15], s37 offen lds
  buffer_load_dwordx4 v131, s[12:15], s37 offen offset:1024 lds
  s_add_u32 s30, s30, 1
  s_and_b32 s30, s30, 7
  s_cselect_b32 s32, 0, 1
  s_add_u32 s31, s31, s32
  s_sub_u32 s32, s30, s7
  s_and_b32 s32, s32, 7
  s_cmp_lt_u32 s32, 2
  s_cselect_b32 s32, 1, 0
  s_add_u32 s32, s32, s31
  s_cmp_ge_u32 s32, 2
  s_cselect_b32 s32, 0, s32
  s_lshl_b32 s33, s32, 3
  s_add_u32 s33, s33, s30
  s_lshl_b32 s37, s33, 17
  s_add_u32 s37, s37, s35
  s_add_u32 m0, s52, 116992
  s_nop 0
  buffer_load_dwordx4 v130, s[12:15], s37 offen lds
  buffer_load_dwordx4 v131, s[12:15], s37 offen offset:1024 lds
  s_cmp_lg_u32 s3, 0
  s_cbranch_scc1 e15
  v_and_b32 v4, 15, v0
  v_lshrrev_b32 v5, 4, v0
  v_lshrrev_b32 v6, 2, v4
  v_and_b32 v7, 3, v0
  v_lshrrev_b32 v3, 5, v0
  v_and_b32 v2, 1, v5
  v_lshl_or_b32 v3, v2, 1, v3
  s_lshr_b32 s40, s4, 1
  s_and_b32 s41, s4, 1
  s_mul_i32 s32, s41, 28800
  s_add_u32 s32, s32, 43008
  s_lshl_b32 s49, s40, 4
  v_add_u32 v76, s49, v4
  v_lshlrev_b32 v77, 4, v5
  v_add_u32 v77, s32, v77
  v_mul_u32_u24 v78, 400, v76
  v_add_u32 v220, v78, v77
  v_add_u32 v223, 3200, v220
  v_add_u32 v220, 128, v220
  v_add_u32 v76, 16, v76
  v_min_u32 v76, 71, v76
  v_mul_u32_u24 v78, 400, v76
  v_add3_u32 v221, v78, v77, 64
  v_add_u32 v221, 64, v221
  v_lshl_add_u32 v76, v5, 2, v6
  v_add_u32 v76, s49, v76
  v_lshlrev_b32 v77, 4, v7
  v_add_u32 v77, s32, v77
  v_add_u32 v77, 256, v77
  v_mul_u32_u24 v78, 400, v76
  v_add_u32 v222, v78, v77
  v_add_u32 v76, 16, v76
  v_min_u32 v76, 71, v76
  v_mul_u32_u24 v78, 400, v76
  v_add_u32 v254, v78, v77
  s_lshl_b32 s50, s28, 2
  s_add_u32 s50, s50, s40
  s_lshl_b32 s50, s50, 17
  s_lshl_b32 s51, s29, 13
  s_add_u32 s50, s50, s51
  s_lshl_b32 s51, s41, 11
  s_add_u32 s50, s50, s51
  s_and_b32 s51, s40, 1
  s_lshl_b32 s32, s51, 1
  s_add_u32 s32, s32, s41
  s_cmp_eq_u32 s32, 3
  s_addc_u32 s32, s32, 5
  s_lshl_b32 s32, s32, 7
  s_mov_b32 vcc_lo, 0xff000000
  s_mov_b32 vcc_hi, 0
  v_mov_b32 v1, s32
  v_cndmask_b32 v1, 0, v1, vcc
  v_lshl_add_u32 v1, v0, 4, v1
  v_add_u32 v1, s50, v1
  v_lshlrev_b32 v76, 2, v5
  v_sub_u32 v76, v76, v4
  s_or_b32 s51, s28, s40
  s_cmp_eq_u32 s51, 0
  s_cselect_b32 s51, 0, -1
  v_add_u32 v77, -1, v76
  v_cmp_gt_u32 s[86:87], 8, v77
  v_add_u32 v77, 0, v76
  v_cmp_gt_u32 s[88:89], 8, v77
  v_add_u32 v77, 1, v76
  v_cmp_gt_u32 s[90:91], 8, v77
  v_add_u32 v77, 2, v76
  v_cmp_gt_u32 s[92:93], 8, v77
  v_add_u32 v77, 15, v76
  v_cmp_gt_u32 s[94:95], 8, v77
  v_add_u32 v77, 16, v76
  v_cmp_gt_u32 s[96:97], 8, v77
  v_add_u32 v77, 17, v76
  v_cmp_gt_u32 s[98:99], 8, v77
  v_add_u32 v77, 18, v76
  v_cmp_gt_u32 s[100:101], 8, v77
  s_and_b32 s86, s86, s51
  s_and_b32 s88, s88, s51
  s_and_b32 s90, s90, s51
  s_and_b32 s92, s92, s51
e15:
  s_nop 1
  s_waitcnt lgkmcnt(0)
  s_barrier
  s_add_u32 s30, s30, 1
  s_and_b32 s30, s30, 7
  s_cselect_b32 s32, 0, 1
  s_add_u32 s31, s31, s32
  s_sub_u32 s32, s30, s7
  s_and_b32 s32, s32, 7
  s_cmp_lt_u32 s32, 2
  s_cselect_b32 s32, 1, 0
  s_add_u32 s32, s32, s31
  s_cmp_ge_u32 s32, 2
  s_cselect_b32 s32, 0, s32
  s_lshl_b32 s33, s32, 3
  s_add_u32 s33, s33, s30
  s_lshl_b32 s37, s33, 17
  s_add_u32 s37, s37, s35
  s_add_u32 m0, s52, 0
  s_nop 0
  buffer_load_dwordx4 v130, s[12:15], s37 offen lds
  buffer_load_dwordx4 v131, s[12:15], s37 offen offset:1024 lds
  s_add_u32 s30, s30, 1
  s_and_b32 s30, s30, 7
  s_cselect_b32 s32, 0, 1
  s_add_u32 s31, s31, s32
  s_sub_u32 s32, s30, s7
  s_and_b32 s32, s32, 7
  s_cmp_lt_u32 s32, 2
  s_cselect_b32 s32, 1, 0
  s_add_u32 s32, s32, s31
  s_cmp_ge_u32 s32, 2
  s_cselect_b32 s32, 0, s32
  s_lshl_b32 s33, s32, 3
  s_add_u32 s33, s33, s30
  s_lshl_b32 s37, s33, 17
  s_add_u32 s37, s37, s35
  s_add_u32 m0, s52, 8192
  s_nop 0
  buffer_load_dwordx4 v130, s[12:15], s37 offen lds
  buffer_load_dwordx4 v131, s[12:15], s37 offen offset:1024 lds
  s_add_u32 s30, s30, 1
  s_and_b32 s30, s30, 7
  s_cselect_b32 s32, 0, 1
  s_add_u32 s31, s31, s32
  s_sub_u32 s32, s30, s7
  s_and_b32 s32, s32, 7
  s_cmp_lt_u32 s32, 2
  s_cselect_b32 s32, 1, 0
  s_add_u32 s32, s32, s31
  s_cmp_ge_u32 s32, 2
  s_cselect_b32 s32, 0, s32
  s_lshl_b32 s33, s32, 3
  s_add_u32 s33, s33, s30
  s_lshl_b32 s37, s33, 17
  s_add_u32 s37, s37, s35
  s_add_u32 m0, s52, 16384
  s_nop 0
  buffer_load_dwordx4 v130, s[12:15], s37 offen lds
  buffer_load_dwordx4 v131, s[12:15], s37 offen offset:1024 lds
  s_add_u32 s30, s30, 1
  s_and_b32 s30, s30, 7
  s_cselect_b32 s32, 0, 1
  s_add_u32 s31, s31, s32
  s_sub_u32 s32, s30, s7
  s_and_b32 s32, s32, 7
  s_cmp_lt_u32 s32, 2
  s_cselect_b32 s32, 1, 0
  s_add_u32 s32, s32, s31
  s_cmp_ge_u32 s32, 2
  s_cselect_b32 s32, 0, s32
  s_lshl_b32 s33, s32, 3
  s_add_u32 s33, s33, s30
  s_lshl_b32 s37, s33, 17
  s_add_u32 s37, s37, s35
  s_add_u32 m0, s52, 24576
  s_nop 0
  buffer_load_dwordx4 v130, s[12:15], s37 offen lds
  buffer_load_dwordx4 v131, s[12:15], s37 offen offset:1024 lds
  s_add_u32 s30, s30, 1
  s_and_b32 s30, s30, 7
  s_cselect_b32 s32, 0, 1
  s_add_u32 s31, s31, s32
  s_sub_u32 s32, s30, s7
  s_and_b32 s32, s32, 7
  s_cmp_lt_u32 s32, 2
  s_cselect_b32 s32, 1, 0
  s_add_u32 s32, s32, s31
  s_cmp_ge_u32 s32, 2
  s_cselect_b32 s32, 0, s32
  s_lshl_b32 s33, s32, 3
  s_add_u32 s33, s33, s30
  s_lshl_b32 s37, s33, 17
  s_add_u32 s37, s37, s35
  s_add_u32 m0, s52, 32768
  s_nop 0
  buffer_load_dwordx4 v130, s[12:15], s37 offen lds
  buffer_load_dwordx4 v131, s[12:15], s37 offen offset:1024 lds
  s_branch attn
L_k1done:
  s_nop 7
  s_nop 7
  s_add_u32 s24, s84, 109051904
  s_addc_u32 s25, s85, 0
  s_mov_b32 s26, 524288
  s_mov_b32 s27, 0x20000
  v_mov_b32 v136, 0
  v_mov_b32 v137, 1
  s_cmp_eq_u32 s57, 0
  s_cselect_b32 s26, s26, 0
  s_waitcnt vmcnt(0)
  s_barrier
  s_mov_b64 exec, 1
  buffer_store_dword v137, v136, s[24:27], s56 offen sc0 sc1
  s_mov_b64 exec, -1
  s_add_u32 s30, s30, 1
  s_and_b32 s30, s30, 7
  s_cselect_b32 s32, 0, 1
  s_add_u32 s31, s31, s32
  s_sub_u32 s32, s30, s7
  s_and_b32 s32, s32, 7
  s_cmp_lt_u32 s32, 2
  s_cselect_b32 s32, 1, 0
  s_add_u32 s32, s32, s31
  s_cmp_ge_u32 s32, 2
  s_cselect_b32 s32, 0, s32
  s_lshl_b32 s33, s32, 3
  s_add_u32 s33, s33, s30
  s_lshl_b32 s37, s33, 17
  s_add_u32 s37, s37, s35
  s_add_u32 m0, s52, 43008
  s_nop 0
  buffer_load_dwordx4 v130, s[12:15], s37 offen lds
  buffer_load_dwordx4 v131, s[12:15], s37 offen offset:1024 lds
  s_add_u32 s30, s30, 1
  s_and_b32 s30, s30, 7
  s_cselect_b32 s32, 0, 1
  s_add_u32 s31, s31, s32
  s_sub_u32 s32, s30, s7
  s_and_b32 s32, s32, 7
  s_cmp_lt_u32 s32, 2
  s_cselect_b32 s32, 1, 0
  s_add_u32 s32, s32, s31
  s_cmp_ge_u32 s32, 2
  s_cselect_b32 s32, 0, s32
  s_lshl_b32 s33, s32, 3
  s_add_u32 s33, s33, s30
  s_lshl_b32 s37, s33, 17
  s_add_u32 s37, s37, s35
  s_add_u32 m0, s52, 51200
  s_nop 0
  buffer_load_dwordx4 v130, s[12:15], s37 offen lds
  buffer_load_dwordx4 v131, s[12:15], s37 offen offset:1024 lds
  s_add_u32 s30, s30, 1
  s_and_b32 s30, s30, 7
  s_cselect_b32 s32, 0, 1
  s_add_u32 s31, s31, s32
  s_sub_u32 s32, s30, s7
  s_and_b32 s32, s32, 7
  s_cmp_lt_u32 s32, 2
  s_cselect_b32 s32, 1, 0
  s_add_u32 s32, s32, s31
  s_cmp_ge_u32 s32, 2
  s_cselect_b32 s32, 0, s32
  s_lshl_b32 s33, s32, 3
  s_add_u32 s33, s33, s30
  s_lshl_b32 s37, s33, 17
  s_add_u32 s37, s37, s35
  s_add_u32 m0, s52, 59392
  s_nop 0
  buffer_load_dwordx4 v130, s[12:15], s37 offen lds
  buffer_load_dwordx4 v131, s[12:15], s37 offen offset:1024 lds
  s_add_u32 s30, s30, 1
  s_and_b32 s30, s30, 7
  s_cselect_b32 s32, 0, 1
  s_add_u32 s31, s31, s32
  s_sub_u32 s32, s30, s7
  s_and_b32 s32, s32, 7
  s_cmp_lt_u32 s32, 2
  s_cselect_b32 s32, 1, 0
  s_add_u32 s32, s32, s31
  s_cmp_ge_u32 s32, 2
  s_cselect_b32 s32, 0, s32
  s_lshl_b32 s33, s32, 3
  s_add_u32 s33, s33, s30
  s_lshl_b32 s37, s33, 17
  s_add_u32 s37, s37, s35
  s_add_u32 m0, s52, 67584
  s_nop 0
  buffer_load_dwordx4 v130, s[12:15], s37 offen lds
  buffer_load_dwordx4 v131, s[12:15], s37 offen offset:1024 lds
  s_lshl_b32 s56, s3, 10
  s_mul_i32 s32, s29, 16
  s_add_u32 s56, s56, s32
  s_add_u32 s56, s56, s28
  s_add_u32 s56, s56, 256
  s_lshl_b32 s56, s56, 7
  s_barrier
  s_waitcnt vmcnt(0)
  s_barrier
  s_cmp_ge_u32 s2, 224
  s_cbranch_scc1 L_k3skip
  s_lshr_b32 s32, s2, 3
  s_mul_i32 s5, s32, 9363
  s_lshr_b32 s5, s5, 16
  s_mul_i32 s6, s5, 7
  s_sub_u32 s6, s32, s6
  s_lshl_b32 s7, s5, 1
  s_add_u32 s7, s7, s6
  s_and_b32 s7, s7, 7
  s_and_b32 s32, s2, 7
  s_lshr_b32 s28, s32, 2
  s_lshl_b32 s28, s28, 2
  s_add_u32 s28, s28, s5
  s_and_b32 s29, s32, 3
  s_mul_i32 s29, s29, 7
  s_add_u32 s29, s29, s6
  s_mov_b32 s30, 7
  s_mov_b32 s31, -1
  s_lshl_b32 s44, s57, 12
  s_add_u32 s45, s44, 16384
  v_lshrrev_b32 v2, 4, v0
  v_lshlrev_b32 v3, 1, v2
  v_and_b32 v4, 15, v0
  v_xor_b32 v3, v3, v4
  v_lshlrev_b32 v3, 4, v3
  s_lshl_b32 s32, s57, 4
  v_add_u32 v2, s32, v2
  s_mov_b32 s32, 7168
  v_mul_lo_u32 v2, v2, s32
  v_add_u32 v9, v2, v3
  v_xor_b32 v3, 128, v3
  v_add_u32 v11, v2, v3
  v_add_u32 v10, 27648, v9
  v_add_u32 v12, 82944, v11
  v_add_u32 v11, 55296, v11
  s_lshl_b32 s34, s28, 2
  s_add_u32 s34, s34, s57
  s_lshl_b32 s34, s34, 18
  s_lshl_b32 s35, s29, 8
  s_lshl_b32 s32, 0, 1
  s_add_u32 s32, s32, 0
  s_cmp_eq_u32 s32, 3
  s_addc_u32 s32, s32, 5
  s_lshl_b32 s32, s32, 7
  s_mov_b32 vcc_lo, 0xff000000
  s_mov_b32 vcc_hi, 0
  v_mov_b32 v20, s32
  v_cndmask_b32 v20, 0, v20, vcc
  v_lshl_add_u32 v20, v0, 4, v20
  s_lshl_b32 s32, 1, 1
  s_add_u32 s32, s32, 0
  s_cmp_eq_u32 s32, 3
  s_addc_u32 s32, s32, 5
  s_lshl_b32 s32, s32, 7
  s_mov_b32 vcc_lo, 0xff000000
  s_mov_b32 vcc_hi, 0
  v_mov_b32 v21, s32
  v_cndmask_b32 v21, 0, v21, vcc
  v_lshl_add_u32 v21, v0, 4, v21
  v_add_u32 v21, 1024, v21
  s_lshl_b32 s32, 0, 1
  s_add_u32 s32, s32, 1
  s_cmp_eq_u32 s32, 3
  s_addc_u32 s32, s32, 5
  s_lshl_b32 s32, s32, 7
  s_mov_b32 vcc_lo, 0xff000000
  s_mov_b32 vcc_hi, 0
  v_mov_b32 v22, s32
  v_cndmask_b32 v22, 0, v22, vcc
  v_lshl_add_u32 v22, v0, 4, v22
  v_add_u32 v22, 129024, v22
  s_lshl_b32 s32, 1, 1
  s_add_u32 s32, s32, 1
  s_cmp_eq_u32 s32, 3
  s_addc_u32 s32, s32, 5
  s_lshl_b32 s32, s32, 7
  s_mov_b32 vcc_lo, 0xff000000
  s_mov_b32 vcc_hi, 0
  v_mov_b32 v23, s32
  v_cndmask_b32 v23, 0, v23, vcc
  v_lshl_add_u32 v23, v0, 4, v23
  v_add_u32 v23, 130048, v23
  s_add_u32 s8, s82, 16777216
  s_addc_u32 s9, s83, 0
  s_mov_b32 s10, 8388608
  s_mov_b32 s11, 0x20000
  s_mov_b32 s12, s72
  s_mov_b32 s13, s73
  s_mov_b32 s14, 14680064
  s_mov_b32 s15, 0x20000
  s_add_u32 s16, s84, 109051904
  s_addc_u32 s17, s85, 0
  s_mov_b32 s18, 524288
  s_mov_b32 s19, 0x20000
  v_min_u32 v14, 31, v0
  s_lshl_b32 s32, s28, 5
  v_add_u32 v14, s32, v14
  v_max_i32 v14, 0, v14
  v_lshlrev_b32 v14, 7, v14
  s_lshl_b32 s55, s3, 17
  s_add_u32 s55, s55, 32768
  s_lshr_b32 s32, s2, 3
  s_add_u32 s32, s32, 0
  s_lshl_b32 s32, s32, 2
  s_add_u32 s32, s32, s57
  s_lshl_b32 s32, s32, 6
  v_add_u32 v2, s32, v0
  v_mul_u32_u24 v3, 74899, v2
  v_lshrrev_b32 v3, 20, v3
  v_mul_u32_u24 v4, 14, v3
  v_sub_u32 v4, v2, v4
  v_add_u32 v3, 192, v3
  v_mul_u32_u24 v3, 7168, v3
  v_lshl_add_u32 v3, v4, 7, v3
  s_and_b32 s32, s2, 3
  s_mul_i32 s32, s32, 1792
  s_lshl_b32 s40, s3, 30
  s_add_u32 s32, s32, s40
  v_add_u32 v16, s32, v3
  s_barrier
  s_barrier
  s_mov_b64 exec, 1
  buffer_store_dword v137, v136, s[24:27], s56 offen sc0 sc1
  s_mov_b64 exec, -1
  s_mov_b32 s30, 7
  s_mov_b32 s31, -1
  s_mov_b32 s38, 0
  s_add_u32 s30, s30, 1
  s_and_b32 s30, s30, 7
  s_cselect_b32 s32, 0, 1
  s_add_u32 s31, s31, s32
  s_sub_u32 s32, s30, s7
  s_and_b32 s32, s32, 7
  s_cmp_lt_u32 s32, 2
  s_cselect_b32 s32, 1, 0
  s_add_u32 s32, s32, s31
  s_cmp_ge_u32 s32, 4
  s_cselect_b32 s32, 0, s32
  s_lshl_b32 s33, s32, 3
  s_add_u32 s33, s33, s30
  s_mul_i32 s37, s33, 458752
  s_add_u32 s37, s37, s35
  s_add_u32 m0, s38, s45
  s_nop 0
  buffer_load_dwordx4 v9, s[12:15], s37 offen offset:0  lds
  buffer_load_dwordx4 v10, s[12:15], s37 offen offset:1024  lds
  buffer_load_dwordx4 v11, s[12:15], s37 offen offset:2048  lds
  buffer_load_dwordx4 v12, s[12:15], s37 offen offset:3072  lds
  s_add_u32 s38, s38, 32768
  s_cmp_eq_u32 s38, 163840
  s_cselect_b32 s38, 0, s38
  s_add_u32 s30, s30, 1
  s_and_b32 s30, s30, 7
  s_cselect_b32 s32, 0, 1
  s_add_u32 s31, s31, s32
  s_sub_u32 s32, s30, s7
  s_and_b32 s32, s32, 7
  s_cmp_lt_u32 s32, 2
  s_cselect_b32 s32, 1, 0
  s_add_u32 s32, s32, s31
  s_cmp_ge_u32 s32, 4
  s_cselect_b32 s32, 0, s32
  s_lshl_b32 s33, s32, 3
  s_add_u32 s33, s33, s30
  s_mul_i32 s37, s33, 458752
  s_add_u32 s37, s37, s35
  s_add_u32 m0, s38, s45
  s_nop 0
  buffer_load_dwordx4 v9, s[12:15], s37 offen offset:0  lds
  buffer_load_dwordx4 v10, s[12:15], s37 offen offset:1024  lds
  buffer_load_dwordx4 v11, s[12:15], s37 offen offset:2048  lds
  buffer_load_dwordx4 v12, s[12:15], s37 offen offset:3072  lds
  s_add_u32 s38, s38, 32768
  s_cmp_eq_u32 s38, 163840
  s_cselect_b32 s38, 0, s38
  s_add_u32 s30, s30, 1
  s_and_b32 s30, s30, 7
  s_cselect_b32 s32, 0, 1
  s_add_u32 s31, s31, s32
  s_sub_u32 s32, s30, s7
  s_and_b32 s32, s32, 7
  s_cmp_lt_u32 s32, 2
  s_cselect_b32 s32, 1, 0
  s_add_u32 s32, s32, s31
  s_cmp_ge_u32 s32, 4
  s_cselect_b32 s32, 0, s32
  s_lshl_b32 s33, s32, 3
  s_add_u32 s33, s33, s30
  s_mul_i32 s37, s33, 458752
  s_add_u32 s37, s37, s35
  s_add_u32 m0, s38, s45
  s_nop 0
  buffer_load_dwordx4 v9, s[12:15], s37 offen offset:0  lds
  buffer_load_dwordx4 v10, s[12:15], s37 offen offset:1024  lds
  buffer_load_dwordx4 v11, s[12:15], s37 offen offset:2048  lds
  buffer_load_dwordx4 v12, s[12:15], s37 offen offset:3072  lds
  s_add_u32 s38, s38, 32768
  s_cmp_eq_u32 s38, 163840
  s_cselect_b32 s38, 0, s38
  buffer_load_dword v135, v16, s[12:15], 0 offen
  s_lshl_b32 s56, s3, 10
  s_mul_i32 s32, s28, 32
  s_add_u32 s56, s56, s32
  s_add_u32 s56, s56, s29
  s_add_u32 s56, s56, 512
  s_lshl_b32 s56, s56, 7
  s_mov_b32 s39, 0
  s_and_b32 s32, s4, 3
  s_cmp_lg_u32 s32, 0
  s_cbranch_scc1 poll16d
  s_sleep 8
poll16:
  buffer_load_dword v15, v14, s[16:19], s55 offen sc0 sc1
  s_waitcnt vmcnt(0)
  v_cmp_eq_u32 vcc, 0, v15
  s_add_u32 s39, s39, 1
  s_cmp_gt_u32 s39, 1000000
  s_cbranch_scc1 poll16d
  s_cbranch_vccnz poll16
poll16d:
  s_barrier
  s_mov_b32 s30, 7
  s_mov_b32 s31, -1
  s_mov_b32 s38, 0
  s_add_u32 s30, s30, 1
  s_and_b32 s30, s30, 7
  s_cselect_b32 s32, 0, 1
  s_add_u32 s31, s31, s32
  s_sub_u32 s32, s30, s7
  s_and_b32 s32, s32, 7
  s_cmp_lt_u32 s32, 2
  s_cselect_b32 s32, 1, 0
  s_add_u32 s32, s32, s31
  s_cmp_ge_u32 s32, 4
  s_cselect_b32 s32, 0, s32
  s_lshl_b32 s33, s32, 3
  s_add_u32 s33, s33, s30
  s_mul_i32 s36, s33, 4096
  s_add_u32 s36, s36, s34
  s_add_u32 m0, s38, s44
  s_nop 0
  buffer_load_dwordx4 v20, s[8:11], s36 offen offset:0 sc1 lds
  buffer_load_dwordx4 v21, s[8:11], s36 offen offset:1024 sc1 lds
  buffer_load_dwordx4 v22, s[8:11], s36 offen offset:2048 sc1 lds
  buffer_load_dwordx4 v23, s[8:11], s36 offen offset:3072 sc1 lds
  s_add_u32 s38, s38, 32768
  s_cmp_eq_u32 s38, 163840
  s_cselect_b32 s38, 0, s38
  s_add_u32 s30, s30, 1
  s_and_b32 s30, s30, 7
  s_cselect_b32 s32, 0, 1
  s_add_u32 s31, s31, s32
  s_sub_u32 s32, s30, s7
  s_and_b32 s32, s32, 7
  s_cmp_lt_u32 s32, 2
  s_cselect_b32 s32, 1, 0
  s_add_u32 s32, s32, s31
  s_cmp_ge_u32 s32, 4
  s_cselect_b32 s32, 0, s32
  s_lshl_b32 s33, s32, 3
  s_add_u32 s33, s33, s30
  s_mul_i32 s36, s33, 4096
  s_add_u32 s36, s36, s34
  s_add_u32 m0, s38, s44
  s_nop 0
  buffer_load_dwordx4 v20, s[8:11], s36 offen offset:0 sc1 lds
  buffer_load_dwordx4 v21, s[8:11], s36 offen offset:1024 sc1 lds
  buffer_load_dwordx4 v22, s[8:11], s36 offen offset:2048 sc1 lds
  buffer_load_dwordx4 v23, s[8:11], s36 offen offset:3072 sc1 lds
  s_add_u32 s38, s38, 32768
  s_cmp_eq_u32 s38, 163840
  s_cselect_b32 s38, 0, s38
  s_add_u32 s30, s30, 1
  s_and_b32 s30, s30, 7
  s_cselect_b32 s32, 0, 1
  s_add_u32 s31, s31, s32
  s_sub_u32 s32, s30, s7
  s_and_b32 s32, s32, 7
  s_cmp_lt_u32 s32, 2
  s_cselect_b32 s32, 1, 0
  s_add_u32 s32, s32, s31
  s_cmp_ge_u32 s32, 4
  s_cselect_b32 s32, 0, s32
  s_lshl_b32 s33, s32, 3
  s_add_u32 s33, s33, s30
  s_mul_i32 s36, s33, 4096
  s_add_u32 s36, s36, s34
  s_add_u32 m0, s38, s44
  s_nop 0
  buffer_load_dwordx4 v20, s[8:11], s36 offen offset:0 sc1 lds
  buffer_load_dwordx4 v21, s[8:11], s36 offen offset:1024 sc1 lds
  buffer_load_dwordx4 v22, s[8:11], s36 offen offset:2048 sc1 lds
  buffer_load_dwordx4 v23, s[8:11], s36 offen offset:3072 sc1 lds
  s_add_u32 s38, s38, 32768
  s_cmp_eq_u32 s38, 163840
  s_cselect_b32 s38, 0, s38
  s_waitcnt vmcnt(8)
  s_barrier
  s_add_u32 s30, s30, 1
  s_and_b32 s30, s30, 7
  s_cselect_b32 s32, 0, 1
  s_add_u32 s31, s31, s32
  s_sub_u32 s32, s30, s7
  s_and_b32 s32, s32, 7
  s_cmp_lt_u32 s32, 2
  s_cselect_b32 s32, 1, 0
  s_add_u32 s32, s32, s31
  s_cmp_ge_u32 s32, 4
  s_cselect_b32 s32, 0, s32
  s_lshl_b32 s33, s32, 3
  s_add_u32 s33, s33, s30
  s_mul_i32 s36, s33, 4096
  s_add_u32 s36, s36, s34
  s_mul_i32 s37, s33, 458752
  s_add_u32 s37, s37, s35
  s_add_u32 m0, s38, s44
  s_nop 0
  buffer_load_dwordx4 v20, s[8:11], s36 offen offset:0 sc1 lds
  buffer_load_dwordx4 v21, s[8:11], s36 offen offset:1024 sc1 lds
  buffer_load_dwordx4 v22, s[8:11], s36 offen offset:2048 sc1 lds
  buffer_load_dwordx4 v23, s[8:11], s36 offen offset:3072 sc1 lds
  s_add_u32 m0, s38, s45
  s_nop 0
  buffer_load_dwordx4 v9, s[12:15], s37 offen offset:0  lds
  buffer_load_dwordx4 v10, s[12:15], s37 offen offset:1024  lds
  buffer_load_dwordx4 v11, s[12:15], s37 offen offset:2048  lds
  buffer_load_dwordx4 v12, s[12:15], s37 offen offset:3072  lds
  s_add_u32 s38, s38, 32768
  s_cmp_eq_u32 s38, 163840
  s_cselect_b32 s38, 0, s38
  s_waitcnt vmcnt(12)
  s_barrier
  s_add_u32 s30, s30, 1
  s_and_b32 s30, s30, 7
  s_cselect_b32 s32, 0, 1
  s_add_u32 s31, s31, s32
  s_sub_u32 s32, s30, s7
  s_and_b32 s32, s32, 7
  s_cmp_lt_u32 s32, 2
  s_cselect_b32 s32, 1, 0
  s_add_u32 s32, s32, s31
  s_cmp_ge_u32 s32, 4
  s_cselect_b32 s32, 0, s32
  s_lshl_b32 s33, s32, 3
  s_add_u32 s33, s33, s30
  s_mul_i32 s36, s33, 4096
  s_add_u32 s36, s36, s34
  s_mul_i32 s37, s33, 458752
  s_add_u32 s37, s37, s35
  s_add_u32 m0, s38, s44
  s_nop 0
  buffer_load_dwordx4 v20, s[8:11], s36 offen offset:0 sc1 lds
  buffer_load_dwordx4 v21, s[8:11], s36 offen offset:1024 sc1 lds
  buffer_load_dwordx4 v22, s[8:11], s36 offen offset:2048 sc1 lds
  buffer_load_dwordx4 v23, s[8:11], s36 offen offset:3072 sc1 lds
  s_add_u32 m0, s38, s45
  s_nop 0
  buffer_load_dwordx4 v9, s[12:15], s37 offen offset:0  lds
  buffer_load_dwordx4 v10, s[12:15], s37 offen offset:1024  lds
  buffer_load_dwordx4 v11, s[12:15], s37 offen offset:2048  lds
  buffer_load_dwordx4 v12, s[12:15], s37 offen offset:3072  lds
  s_add_u32 s38, s38, 32768
  s_cmp_eq_u32 s38, 163840
  s_cselect_b32 s38, 0, s38
  s_mov_b32 s39, 27
ll17:
  s_waitcnt vmcnt(16)
  s_barrier
  s_add_u32 s30, s30, 1
  s_and_b32 s30, s30, 7
  s_cselect_b32 s32, 0, 1
  s_add_u32 s31, s31, s32
  s_sub_u32 s32, s30, s7
  s_and_b32 s32, s32, 7
  s_cmp_lt_u32 s32, 2
  s_cselect_b32 s32, 1, 0
  s_add_u32 s32, s32, s31
  s_cmp_ge_u32 s32, 4
  s_cselect_b32 s32, 0, s32
  s_lshl_b32 s33, s32, 3
  s_add_u32 s33, s33, s30
  s_mul_i32 s36, s33, 4096
  s_add_u32 s36, s36, s34
  s_mul_i32 s37, s33, 458752
  s_add_u32 s37, s37, s35
  s_add_u32 m0, s38, s44
  s_nop 0
  buffer_load_dwordx4 v20, s[8:11], s36 offen offset:0 sc1 lds
  buffer_load_dwordx4 v21, s[8:11], s36 offen offset:1024 sc1 lds
  buffer_load_dwordx4 v22, s[8:11], s36 offen offset:2048 sc1 lds
  buffer_load_dwordx4 v23, s[8:11], s36 offen offset:3072 sc1 lds
  s_add_u32 m0, s38, s45
  s_nop 0
  buffer_load_dwordx4 v9, s[12:15], s37 offen offset:0  lds
  buffer_load_dwordx4 v10, s[12:15], s37 offen offset:1024  lds
  buffer_load_dwordx4 v11, s[12:15], s37 offen offset:2048  lds
  buffer_load_dwordx4 v12, s[12:15], s37 offen offset:3072  lds
  s_add_u32 s38, s38, 32768
  s_cmp_eq_u32 s38, 163840
  s_cselect_b32 s38, 0, s38
  s_sub_u32 s39, s39, 1
  s_cmp_lg_u32 s39, 0
  s_cbranch_scc1 ll17
  s_waitcnt vmcnt(16)
  s_barrier
  s_waitcnt vmcnt(8)
  s_barrier
  s_waitcnt vmcnt(0)
  s_barrier
  s_lshr_b32 s32, s2, 3
  s_lshr_b32 s5, s32, 3
  s_and_b32 s6, s32, 7
  s_lshl_b32 s7, s5, 1
  s_add_u32 s7, s7, s6
  s_and_b32 s7, s7, 7
  s_and_b32 s32, s2, 7
  s_lshr_b32 s28, s32, 2
  s_lshl_b32 s28, s28, 2
  s_add_u32 s28, s28, s5
  s_and_b32 s29, s32, 3
  s_mul_i32 s29, s29, 8
  s_add_u32 s29, s29, s6
  s_mov_b32 s30, 7
  s_mov_b32 s31, -1
  s_mov_b32 s41, s57
  s_lshl_b32 s45, s41, 11
  s_mul_i32 s32, s41, 16
  s_add_u32 s32, s32, 0
  v_lshrrev_b32 v2, 3, v0
  v_add_u32 v2, s32, v2
  v_bfe_u32 v3, v2, 1, 1
  v_bfe_u32 v4, v2, 3, 1
  v_lshl_or_b32 v3, v4, 1, v3
  v_lshlrev_b32 v3, 1, v3
  v_and_b32 v4, 7, v0
  v_xor_b32 v3, v3, v4
  v_lshlrev_b32 v3, 4, v3
  s_mov_b32 s32, 4096
  v_mul_lo_u32 v2, v2, s32
  v_add_u32 v9, v2, v3
  s_mul_i32 s32, s41, 16
  s_add_u32 s32, s32, 8
  v_lshrrev_b32 v2, 3, v0
  v_add_u32 v2, s32, v2
  v_bfe_u32 v3, v2, 1, 1
  v_bfe_u32 v4, v2, 3, 1
  v_lshl_or_b32 v3, v4, 1, v3
  v_lshlrev_b32 v3, 1, v3
  v_and_b32 v4, 7, v0
  v_xor_b32 v3, v3, v4
  v_lshlrev_b32 v3, 4, v3
  s_mov_b32 s32, 4096
  v_mul_lo_u32 v2, v2, s32
  v_add_u32 v10, v2, v3
  v_subrev_u32 v10, 1024, v10
  s_lshl_b32 s35, s29, 7
  s_mov_b32 s12, s76
  s_mov_b32 s13, s77
  s_mov_b32 s14, 14680064
  s_mov_b32 s15, 0x20000
  s_branch L_k4
L_k3skip:
  s_nop 7
  s_nop 7
  s_lshr_b32 s32, s2, 3
  s_lshr_b32 s5, s32, 3
  s_and_b32 s6, s32, 7
  s_lshl_b32 s7, s5, 1
  s_add_u32 s7, s7, s6
  s_and_b32 s7, s7, 7
  s_and_b32 s32, s2, 7
  s_lshr_b32 s28, s32, 2
  s_lshl_b32 s28, s28, 2
  s_add_u32 s28, s28, s5
  s_and_b32 s29, s32, 3
  s_mul_i32 s29, s29, 8
  s_add_u32 s29, s29, s6
  s_mov_b32 s30, 7
  s_mov_b32 s31, -1
  s_mov_b32 s41, s57
  s_lshl_b32 s45, s41, 11
  s_mul_i32 s32, s41, 16
  s_add_u32 s32, s32, 0
  v_lshrrev_b32 v2, 3, v0
  v_add_u32 v2, s32, v2
  v_bfe_u32 v3, v2, 1, 1
  v_bfe_u32 v4, v2, 3, 1
  v_lshl_or_b32 v3, v4, 1, v3
  v_lshlrev_b32 v3, 1, v3
  v_and_b32 v4, 7, v0
  v_xor_b32 v3, v3, v4
  v_lshlrev_b32 v3, 4, v3
  s_mov_b32 s32, 4096
  v_mul_lo_u32 v2, v2, s32
  v_add_u32 v9, v2, v3
  s_mul_i32 s32, s41, 16
  s_add_u32 s32, s32, 8
  v_lshrrev_b32 v2, 3, v0
  v_add_u32 v2, s32, v2
  v_bfe_u32 v3, v2, 1, 1
  v_bfe_u32 v4, v2, 3, 1
  v_lshl_or_b32 v3, v4, 1, v3
  v_lshlrev_b32 v3, 1, v3
  v_and_b32 v4, 7, v0
  v_xor_b32 v3, v3, v4
  v_lshlrev_b32 v3, 4, v3
  s_mov_b32 s32, 4096
  v_mul_lo_u32 v2, v2, s32
  v_add_u32 v10, v2, v3
  v_subrev_u32 v10, 1024, v10
  s_lshl_b32 s35, s29, 7
  s_mov_b32 s12, s76
  s_mov_b32 s13, s77
  s_mov_b32 s14, 14680064
  s_mov_b32 s15, 0x20000
  s_barrier
L_k4:
  s_nop 7
  s_nop 7
  s_mov_b32 s30, 7
  s_mov_b32 s31, -1
  s_mov_b32 s38, 98304
  s_add_u32 s30, s30, 1
  s_and_b32 s30, s30, 7
  s_cselect_b32 s32, 0, 1
  s_add_u32 s31, s31, s32
  s_sub_u32 s32, s30, s7
  s_and_b32 s32, s32, 7
  s_cmp_lt_u32 s32, 2
  s_cselect_b32 s32, 1, 0
  s_add_u32 s32, s32, s31
  s_cmp_ge_u32 s32, 7
  s_cselect_b32 s32, 0, s32
  s_lshl_b32 s33, s32, 3
  s_add_u32 s33, s33, s30
  s_mul_i32 s37, s33, 262144
  s_add_u32 s37, s37, s35
  s_add_u32 m0, s38, s45
  s_nop 0
  buffer_load_dwordx4 v9, s[12:15], s37 offen offset:0  lds
  buffer_load_dwordx4 v10, s[12:15], s37 offen offset:1024  lds
  s_add_u32 s38, s38, 8192
  s_cmp_eq_u32 s38, 163840
  s_cselect_b32 s38, 98304, s38
  s_add_u32 s30, s30, 1
  s_and_b32 s30, s30, 7
  s_cselect_b32 s32, 0, 1
  s_add_u32 s31, s31, s32
  s_sub_u32 s32, s30, s7
  s_and_b32 s32, s32, 7
  s_cmp_lt_u32 s32, 2
  s_cselect_b32 s32, 1, 0
  s_add_u32 s32, s32, s31
  s_cmp_ge_u32 s32, 7
  s_cselect_b32 s32, 0, s32
  s_lshl_b32 s33, s32, 3
  s_add_u32 s33, s33, s30
  s_mul_i32 s37, s33, 262144
  s_add_u32 s37, s37, s35
  s_add_u32 m0, s38, s45
  s_nop 0
  buffer_load_dwordx4 v9, s[12:15], s37 offen offset:0  lds
  buffer_load_dwordx4 v10, s[12:15], s37 offen offset:1024  lds
  s_add_u32 s38, s38, 8192
  s_cmp_eq_u32 s38, 163840
  s_cselect_b32 s38, 98304, s38
  s_add_u32 s30, s30, 1
  s_and_b32 s30, s30, 7
  s_cselect_b32 s32, 0, 1
  s_add_u32 s31, s31, s32
  s_sub_u32 s32, s30, s7
  s_and_b32 s32, s32, 7
  s_cmp_lt_u32 s32, 2
  s_cselect_b32 s32, 1, 0
  s_add_u32 s32, s32, s31
  s_cmp_ge_u32 s32, 7
  s_cselect_b32 s32, 0, s32
  s_lshl_b32 s33, s32, 3
  s_add_u32 s33, s33, s30
  s_mul_i32 s37, s33, 262144
  s_add_u32 s37, s37, s35
  s_add_u32 m0, s38, s45
  s_nop 0
  buffer_load_dwordx4 v9, s[12:15], s37 offen offset:0  lds
  buffer_load_dwordx4 v10, s[12:15], s37 offen offset:1024  lds
  s_add_u32 s38, s38, 8192
  s_cmp_eq_u32 s38, 163840
  s_cselect_b32 s38, 98304, s38
  s_add_u32 s30, s30, 1
  s_and_b32 s30, s30, 7
  s_cselect_b32 s32, 0, 1
  s_add_u32 s31, s31, s32
  s_sub_u32 s32, s30, s7
  s_and_b32 s32, s32, 7
  s_cmp_lt_u32 s32, 2
  s_cselect_b32 s32, 1, 0
  s_add_u32 s32, s32, s31
  s_cmp_ge_u32 s32, 7
  s_cselect_b32 s32, 0, s32
  s_lshl_b32 s33, s32, 3
  s_add_u32 s33, s33, s30
  s_mul_i32 s37, s33, 262144
  s_add_u32 s37, s37, s35
  s_add_u32 m0, s38, s45
  s_nop 0
  buffer_load_dwordx4 v9, s[12:15], s37 offen offset:0  lds
  buffer_load_dwordx4 v10, s[12:15], s37 offen offset:1024  lds
  s_add_u32 s38, s38, 8192
  s_cmp_eq_u32 s38, 163840
  s_cselect_b32 s38, 98304, s38
  s_add_u32 s30, s30, 1
  s_and_b32 s30, s30, 7
  s_cselect_b32 s32, 0, 1
  s_add_u32 s31, s31, s32
  s_sub_u32 s32, s30, s7
  s_and_b32 s32, s32, 7
  s_cmp_lt_u32 s32, 2
  s_cselect_b32 s32, 1, 0
  s_add_u32 s32, s32, s31
  s_cmp_ge_u32 s32, 7
  s_cselect_b32 s32, 0, s32
  s_lshl_b32 s33, s32, 3
  s_add_u32 s33, s33, s30
  s_mul_i32 s37, s33, 262144
  s_add_u32 s37, s37, s35
  s_add_u32 m0, s38, s45
  s_nop 0
  buffer_load_dwordx4 v9, s[12:15], s37 offen offset:0  lds
  buffer_load_dwordx4 v10, s[12:15], s37 offen offset:1024  lds
  s_add_u32 s38, s38, 8192
  s_cmp_eq_u32 s38, 163840
  s_cselect_b32 s38, 98304, s38
  s_add_u32 s30, s30, 1
  s_and_b32 s30, s30, 7
  s_cselect_b32 s32, 0, 1
  s_add_u32 s31, s31, s32
  s_sub_u32 s32, s30, s7
  s_and_b32 s32, s32, 7
  s_cmp_lt_u32 s32, 2
  s_cselect_b32 s32, 1, 0
  s_add_u32 s32, s32, s31
  s_cmp_ge_u32 s32, 7
  s_cselect_b32 s32, 0, s32
  s_lshl_b32 s33, s32, 3
  s_add_u32 s33, s33, s30
  s_mul_i32 s37, s33, 262144
  s_add_u32 s37, s37, s35
  s_add_u32 m0, s38, s45
  s_nop 0
  buffer_load_dwordx4 v9, s[12:15], s37 offen offset:0  lds
  buffer_load_dwordx4 v10, s[12:15], s37 offen offset:1024  lds
  s_add_u32 s38, s38, 8192
  s_cmp_eq_u32 s38, 163840
  s_cselect_b32 s38, 98304, s38
  s_barrier
  s_mov_b64 exec, 1
  buffer_store_dword v137, v136, s[24:27], s56 offen sc0 sc1
  s_mov_b64 exec, -1
  s_lshl_b32 s56, s3, 10
  s_mul_i32 s32, s29, 8
  s_add_u32 s56, s56, s32
  s_add_u32 s56, s56, s28
  s_add_u32 s56, s56, 768
  s_lshl_b32 s56, s56, 7
  s_barrier
  s_mov_b32 s39, 50
ll18:
  s_waitcnt vmcnt(10)
  s_barrier
  s_add_u32 s30, s30, 1
  s_and_b32 s30, s30, 7
  s_cselect_b32 s32, 0, 1
  s_add_u32 s31, s31, s32
  s_sub_u32 s32, s30, s7
  s_and_b32 s32, s32, 7
  s_cmp_lt_u32 s32, 2
  s_cselect_b32 s32, 1, 0
  s_add_u32 s32, s32, s31
  s_cmp_ge_u32 s32, 7
  s_cselect_b32 s32, 0, s32
  s_lshl_b32 s33, s32, 3
  s_add_u32 s33, s33, s30
  s_mul_i32 s37, s33, 262144
  s_add_u32 s37, s37, s35
  s_add_u32 m0, s38, s45
  s_nop 0
  buffer_load_dwordx4 v9, s[12:15], s37 offen offset:0  lds
  buffer_load_dwordx4 v10, s[12:15], s37 offen offset:1024  lds
  s_add_u32 s38, s38, 8192
  s_cmp_eq_u32 s38, 163840
  s_cselect_b32 s38, 98304, s38
  s_sub_u32 s39, s39, 1
  s_cmp_lg_u32 s39, 0
  s_cbranch_scc1 ll18
  s_waitcnt vmcnt(10)
  s_barrier
  s_waitcnt vmcnt(8)
  s_barrier
  s_waitcnt vmcnt(6)
  s_barrier
  s_waitcnt vmcnt(4)
  s_barrier
  s_waitcnt vmcnt(2)
  s_barrier
  s_waitcnt vmcnt(0)
  s_barrier
  s_cmp_lg_u32 s3, 0
  s_cbranch_scc1 L_end
  s_lshr_b32 s32, s2, 3
  s_lshr_b32 s5, s32, 3
  s_and_b32 s6, s32, 7
  s_lshl_b32 s7, s5, 1
  s_add_u32 s7, s7, s6
  s_and_b32 s7, s7, 7
  s_and_b32 s32, s2, 7
  s_lshr_b32 s28, s32, 1
  s_lshl_b32 s28, s28, 2
  s_add_u32 s28, s28, s5
  s_and_b32 s29, s32, 1
  s_mul_i32 s29, s29, 8
  s_add_u32 s29, s29, s6
  s_mov_b32 s30, 7
  s_mov_b32 s31, -1
  s_mov_b32 s41, s57
  s_mul_i32 s32, s41, 16
  s_add_u32 s32, s32, 0
  v_lshrrev_b32 v2, 3, v0
  v_add_u32 v2, s32, v2
  v_bfe_u32 v3, v2, 1, 1
  v_bfe_u32 v4, v2, 3, 1
  v_lshl_or_b32 v3, v4, 1, v3
  v_lshlrev_b32 v3, 1, v3
  v_and_b32 v4, 7, v0
  v_xor_b32 v3, v3, v4
  v_lshlrev_b32 v3, 4, v3
  s_mov_b32 s32, 6144
  v_mul_lo_u32 v2, v2, s32
  v_add_u32 v13, v2, v3
  s_mul_i32 s32, s41, 16
  s_add_u32 s32, s32, 8
  v_lshrrev_b32 v2, 3, v0
  v_add_u32 v2, s32, v2
  v_bfe_u32 v3, v2, 1, 1
  v_bfe_u32 v4, v2, 3, 1
  v_lshl_or_b32 v3, v4, 1, v3
  v_lshlrev_b32 v3, 1, v3
  v_and_b32 v4, 7, v0
  v_xor_b32 v3, v3, v4
  v_lshlrev_b32 v3, 4, v3
  s_mov_b32 s32, 6144
  v_mul_lo_u32 v2, v2, s32
  v_add_u32 v14, v2, v3
  v_subrev_u32 v14, 1024, v14
  v_add_u32 v15, 2048, v13
  v_add_u32 v16, 2048, v14
  v_add_u32 v17, 4096, v13
  v_add_u32 v18, 4096, v14
  s_lshl_b32 s46, s41, 11
  s_add_u32 s46, s46, 18432
  s_add_u32 s47, s46, 8192
  s_add_u32 s48, s46, 16384
  s_lshl_b32 s35, s29, 7
  s_mov_b32 s12, s66
  s_mov_b32 s13, s67
  s_mov_b32 s14, 6291456
  s_mov_b32 s15, 0x20000
  s_mov_b32 s30, 7
  s_mov_b32 s31, -1
  s_mov_b32 s38, 0
  s_add_u32 s30, s30, 1
  s_and_b32 s30, s30, 7
  s_cselect_b32 s32, 0, 1
  s_add_u32 s31, s31, s32
  s_sub_u32 s32, s30, s7
  s_and_b32 s32, s32, 7
  s_cmp_lt_u32 s32, 2
  s_cselect_b32 s32, 1, 0
  s_add_u32 s32, s32, s31
  s_cmp_ge_u32 s32, 2
  s_cselect_b32 s32, 0, s32
  s_lshl_b32 s33, s32, 3
  s_add_u32 s33, s33, s30
  s_mul_i32 s37, s33, 393216
  s_add_u32 s37, s37, s35
  s_add_u32 m0, s38, s46
  s_nop 0
  buffer_load_dwordx4 v13, s[12:15], s37 offen offset:0  lds
  buffer_load_dwordx4 v14, s[12:15], s37 offen offset:1024  lds
  s_add_u32 m0, s38, s47
  s_nop 0
  buffer_load_dwordx4 v15, s[12:15], s37 offen offset:0  lds
  buffer_load_dwordx4 v16, s[12:15], s37 offen offset:1024  lds
  s_add_u32 m0, s38, s48
  s_nop 0
  buffer_load_dwordx4 v17, s[12:15], s37 offen offset:0  lds
  buffer_load_dwordx4 v18, s[12:15], s37 offen offset:1024  lds
  s_add_u32 s38, s38, 43008
  s_cmp_eq_u32 s38, 129024
  s_cselect_b32 s38, 0, s38
  s_add_u32 s30, s30, 1
  s_and_b32 s30, s30, 7
  s_cselect_b32 s32, 0, 1
  s_add_u32 s31, s31, s32
  s_sub_u32 s32, s30, s7
  s_and_b32 s32, s32, 7
  s_cmp_lt_u32 s32, 2
  s_cselect_b32 s32, 1, 0
  s_add_u32 s32, s32, s31
  s_cmp_ge_u32 s32, 2
  s_cselect_b32 s32, 0, s32
  s_lshl_b32 s33, s32, 3
  s_add_u32 s33, s33, s30
  s_mul_i32 s37, s33, 393216
  s_add_u32 s37, s37, s35
  s_add_u32 m0, s38, s46
  s_nop 0
  buffer_load_dwordx4 v13, s[12:15], s37 offen offset:0  lds
  buffer_load_dwordx4 v14, s[12:15], s37 offen offset:1024  lds
  s_add_u32 m0, s38, s47
  s_nop 0
  buffer_load_dwordx4 v15, s[12:15], s37 offen offset:0  lds
  buffer_load_dwordx4 v16, s[12:15], s37 offen offset:1024  lds
  s_add_u32 m0, s38, s48
  s_nop 0
  buffer_load_dwordx4 v17, s[12:15], s37 offen offset:0  lds
  buffer_load_dwordx4 v18, s[12:15], s37 offen offset:1024  lds
  s_add_u32 s38, s38, 43008
  s_cmp_eq_u32 s38, 129024
  s_cselect_b32 s38, 0, s38
  s_lshl_b32 s40, s28, 7
  s_sub_u32 s40, s40, 16
  s_lshl_b32 s32, s41, 5
  s_add_u32 s32, s32, 16
  v_lshrrev_b32 v2, 3, v0
  v_add_u32 v2, s32, v2
  v_bfe_u32 v3, v2, 1, 3
  v_and_b32 v4, 7, v0
  v_xor_b32 v3, v3, v4
  v_lshlrev_b32 v3, 4, v3
  v_add_u32 v2, s40, v2
  v_max_i32 v2, 0, v2
  v_lshlrev_b32 v2, 8, v2
  v_add_u32 v8, v2, v3
  v_add_u32 v10, 2048, v8
  s_lshl_b32 s32, s41, 5
  s_add_u32 s32, s32, 24
  v_lshrrev_b32 v2, 3, v0
  v_add_u32 v2, s32, v2
  v_bfe_u32 v3, v2, 1, 3
  v_and_b32 v4, 7, v0
  v_xor_b32 v3, v3, v4
  v_lshlrev_b32 v3, 4, v3
  v_add_u32 v2, s40, v2
  v_max_i32 v2, 0, v2
  v_lshlrev_b32 v2, 8, v2
  v_add_u32 v9, v2, v3
  v_subrev_u32 v9, 1024, v9
  v_add_u32 v11, 2048, v9
  s_lshl_b32 s32, s41, 3
  v_lshrrev_b32 v2, 3, v0
  v_add_u32 v2, s32, v2
  v_bfe_u32 v3, v2, 1, 3
  v_and_b32 v4, 7, v0
  v_xor_b32 v3, v3, v4
  v_lshlrev_b32 v3, 4, v3
  v_add_u32 v2, s40, v2
  v_max_i32 v2, 0, v2
  v_lshlrev_b32 v2, 8, v2
  v_add_u32 v12, v2, v3
  s_lshl_b32 s44, s41, 12
  s_add_u32 s44, s44, 2048
  s_lshl_b32 s45, s41, 10
  s_mov_b32 s34, 0
  s_mov_b32 s54, 524288
  s_cmp_eq_u32 s41, 0
  s_cselect_b32 s52, 0xffffff00, -1
  s_mov_b32 s53, -1
  v_mov_b32 v20, 0x3f803f80
  v_mov_b32 v21, v20
  v_mov_b32 v22, v20
  v_mov_b32 v23, v20
  v_lshlrev_b32 v24, 4, v0
  v_add_u32 v25, 86016, v24
  s_mov_b64 exec, 0xff
  ds_write_b128 v24, v[20:23]
  ds_write_b128 v24, v[20:23] offset:43008
  ds_write_b128 v25, v[20:23]
  s_mov_b64 exec, -1
  s_lshl_b32 s32, s41, 6
  v_add_u32 v26, s32, v0
  v_min_u32 v26, 143, v26
  v_add_u32 v27, s40, v26
  v_max_i32 v27, 0, v27
  v_lshrrev_b32 v2, 6, v27
  v_and_b32 v27, 63, v27
  v_lshlrev_b32 v27, 3, v27
  v_lshl_add_u32 v27, v2, 10, v27
  v_add_u32 v27, 512, v27
  v_lshlrev_b32 v26, 3, v26
  v_add_u32 v26, 129024, v26
  s_add_u32 s8, s84, 100663296
  s_addc_u32 s9, s85, 0
  s_mov_b32 s10, 8388608
  s_mov_b32 s11, 0x20000
  s_add_u32 s20, s84, 93323264
  s_addc_u32 s21, s85, 0
  s_mov_b32 s22, 262144
  s_mov_b32 s23, 0x20000
  s_waitcnt lgkmcnt(0)
  s_add_u32 s16, s84, 109051904
  s_addc_u32 s17, s85, 0
  s_mov_b32 s18, 524288
  s_mov_b32 s19, 0x20000
  v_min_u32 v28, 23, v0
  s_lshl_b32 s32, s28, 4
  s_sub_u32 s32, s32, 8
  v_add_u32 v28, s32, v28
  v_max_i32 v28, 0, v28
  v_lshlrev_b32 v28, 7, v28
  s_lshl_b32 s55, s3, 17
  s_add_u32 s55, s55, 98304
  s_barrier
  s_barrier
  s_mov_b64 exec, 1
  buffer_store_dword v137, v136, s[24:27], s56 offen sc0 sc1
  s_mov_b64 exec, -1
  s_mov_b32 s39, 0
  s_and_b32 s32, s4, 3
  s_cmp_lg_u32 s32, 0
  s_cbranch_scc1 poll19d
  s_sleep 8
poll19:
  buffer_load_dword v29, v28, s[16:19], s55 offen sc0 sc1
  s_waitcnt vmcnt(0)
  v_cmp_eq_u32 vcc, 0, v29
  s_add_u32 s39, s39, 1
  s_cmp_gt_u32 s39, 1000000
  s_cbranch_scc1 poll19d
  s_cbranch_vccnz poll19
poll19d:
  s_barrier
  s_mov_b32 s3, 1
  s_add_u32 s82, s84, 50331648
  s_addc_u32 s83, s85, 0
  s_branch L_top
L_end:
mega_end:
  s_endpgm
.section .rodata,"a"
.p2align 6
.amdhsa_kernel interleave_layers__sliding_local_dilated__mixer_token_mlp__prompt_kernel
  .amdhsa_next_free_vgpr 256
  .amdhsa_next_free_sgpr 102
  .amdhsa_accum_offset 256
  .amdhsa_group_segment_fixed_size 0
  .amdhsa_kernarg_size 88
  .amdhsa_user_sgpr_count 2
  .amdhsa_user_sgpr_kernarg_segment_ptr 1
  .amdhsa_system_sgpr_workgroup_id_x 1
.end_amdhsa_kernel
```

```asm
; @launch grid=(256,1,1) block=(512,1,1) lds=163840
.amdgcn_target "amdgcn-amd-amdhsa--gfx950"
.text
.globl interleave_layers__sliding_local_dilated__mixer_token_mlp__prompt_kernel
.type interleave_layers__sliding_local_dilated__mixer_token_mlp__prompt_kernel,@function
.p2align 8
interleave_layers__sliding_local_dilated__mixer_token_mlp__prompt_kernel:
  s_cmp_ge_u32 s2, 256
  s_cbranch_scc1 mega_end
  s_load_dwordx16 s[64:79], s[0:1], 0
  s_load_dwordx2 s[80:81], s[0:1], 64
  s_load_dwordx2 s[84:85], s[0:1], 80
  s_load_dwordx2 s[62:63], s[0:1], 72
  v_lshrrev_b32 v1, 6, v0
  v_and_b32 v0, 63, v0
  v_readfirstlane_b32 s4, v1
  s_mov_b32 s3, 0
  v_mov_b32 v130, 0
  v_mov_b32 v131, 0
  v_mov_b32 v134, 0
  s_cmp_ge_u32 s4, 4
  s_cbranch_scc1 L_start
  s_lshr_b32 s32, s2, 3
  s_lshr_b32 s5, s32, 3
  s_and_b32 s6, s32, 7
  s_lshl_b32 s7, s5, 1
  s_add_u32 s7, s7, s6
  s_and_b32 s7, s7, 7
  s_and_b32 s32, s2, 7
  s_lshr_b32 s28, s32, 1
  s_lshl_b32 s28, s28, 2
  s_add_u32 s28, s28, s5
  s_and_b32 s29, s32, 1
  s_mul_i32 s29, s29, 8
  s_add_u32 s29, s29, s6
  s_mov_b32 s30, 7
  s_mov_b32 s31, -1
  v_and_b32 v4, 15, v0
  v_lshrrev_b32 v5, 4, v0
  v_lshrrev_b32 v6, 2, v4
  v_and_b32 v7, 3, v0
  v_lshrrev_b32 v3, 5, v0
  v_and_b32 v2, 1, v5
  v_lshl_or_b32 v3, v2, 1, v3
  v_lshl_add_u32 v21, v5, 3, v6
  v_lshlrev_b32 v21, 7, v21
  v_lshl_add_u32 v21, v7, 3, v21
  v_lshrrev_b32 v22, 1, v6
  v_lshl_or_b32 v22, v2, 1, v22
  v_lshl_add_u32 v21, v22, 5, v21
  v_add_u32 v21, 18432, v21
  v_xor_b32 v8, 0, v21
  s_lshl_b32 s32, s4, 5
  v_xor_b32 v8, s32, v8
  v_lshrrev_b32 v21, 1, v4
  v_xor_b32 v21, v21, v5
  v_lshlrev_b32 v21, 4, v21
  v_lshlrev_b32 v22, 7, v4
  v_add_u32 v9, v21, v22
  v_xor_b32 v10, 64, v9
  v_and_b32 v21, 1, v4
  v_mul_u32_u24 v21, 28800, v21
  v_lshrrev_b32 v22, 1, v4
  v_mul_u32_u24 v22, 400, v22
  v_lshlrev_b32 v23, 3, v5
  v_add3_u32 v11, v21, v22, v23
  s_add_u32 s32, s32, 43008
  v_add_u32 v11, s32, v11
  v_lshlrev_b32 v12, 3, v4
  v_add_u32 v12, 129024, v12
  v_mov_b64 v[112:113], 0
  v_mov_b64 v[114:115], 0
  v_mov_b64 v[116:117], 0
  v_mov_b64 v[118:119], 0
  v_mov_b64 v[120:121], 0
  v_mov_b64 v[122:123], 0
  v_mov_b64 v[124:125], 0
  v_mov_b64 v[126:127], 0
  v_mov_b64 v[128:129], 0
  v_mov_b64 v[130:131], 0
  v_mov_b64 v[132:133], 0
  v_mov_b64 v[134:135], 0
  v_mov_b64 v[136:137], 0
  v_mov_b64 v[138:139], 0
  v_mov_b64 v[140:141], 0
  v_mov_b64 v[142:143], 0
  v_mov_b64 v[144:145], 0
  v_mov_b64 v[146:147], 0
  v_mov_b64 v[148:149], 0
  v_mov_b64 v[150:151], 0
  v_mov_b64 v[152:153], 0
  v_mov_b64 v[154:155], 0
  v_mov_b64 v[156:157], 0
  v_mov_b64 v[158:159], 0
  v_mov_b64 v[160:161], 0
  v_mov_b64 v[162:163], 0
  v_mov_b64 v[164:165], 0
  v_mov_b64 v[166:167], 0
  v_mov_b64 v[168:169], 0
  v_mov_b64 v[170:171], 0
  v_mov_b64 v[172:173], 0
  v_mov_b64 v[174:175], 0
  v_mov_b64 v[176:177], 0
  v_mov_b64 v[178:179], 0
  v_mov_b64 v[180:181], 0
  v_mov_b64 v[182:183], 0
  v_mov_b64 v[184:185], 0
  v_mov_b64 v[186:187], 0
  v_mov_b64 v[188:189], 0
  v_mov_b64 v[190:191], 0
  v_mov_b64 v[192:193], 0
  v_mov_b64 v[194:195], 0
  v_mov_b64 v[196:197], 0
  v_mov_b64 v[198:199], 0
  v_mov_b64 v[200:201], 0
  v_mov_b64 v[202:203], 0
  v_mov_b64 v[204:205], 0
  v_mov_b64 v[206:207], 0
  v_mov_b64 v[208:209], 0
  v_mov_b64 v[210:211], 0
  v_mov_b64 v[212:213], 0
  v_mov_b64 v[214:215], 0
  v_mov_b64 v[216:217], 0
  v_mov_b64 v[218:219], 0
  s_lshr_b32 s40, s4, 1
  s_and_b32 s41, s4, 1
  s_mul_i32 s32, s41, 28800
  s_add_u32 s32, s32, 43008
  s_lshl_b32 s49, s40, 4
  v_add_u32 v76, s49, v4
  v_lshlrev_b32 v77, 4, v5
  v_add_u32 v77, s32, v77
  v_mul_u32_u24 v78, 400, v76
  v_add_u32 v220, v78, v77
  v_add_u32 v223, 3200, v220
  v_add_u32 v220, 128, v220
  v_add_u32 v76, 16, v76
  v_min_u32 v76, 71, v76
  v_mul_u32_u24 v78, 400, v76
  v_add3_u32 v221, v78, v77, 64
  v_add_u32 v221, 64, v221
  v_lshl_add_u32 v76, v5, 2, v6
  v_add_u32 v76, s49, v76
  v_lshlrev_b32 v77, 4, v7
  v_add_u32 v77, s32, v77
  v_add_u32 v77, 256, v77
  v_mul_u32_u24 v78, 400, v76
  v_add_u32 v222, v78, v77
  v_add_u32 v76, 16, v76
  v_min_u32 v76, 71, v76
  v_mul_u32_u24 v78, 400, v76
  v_add_u32 v254, v78, v77
  s_lshl_b32 s50, s28, 2
  s_add_u32 s50, s50, s40
  s_lshl_b32 s50, s50, 17
  s_lshl_b32 s51, s29, 13
  s_add_u32 s50, s50, s51
  s_lshl_b32 s51, s41, 11
  s_add_u32 s50, s50, s51
  s_and_b32 s51, s40, 1
  s_lshl_b32 s32, s51, 1
  s_add_u32 s32, s32, s41
  s_cmp_eq_u32 s32, 3
  s_addc_u32 s32, s32, 5
  s_lshl_b32 s32, s32, 7
  s_mov_b32 vcc_lo, 0xff000000
  s_mov_b32 vcc_hi, 0
  v_mov_b32 v1, s32
  v_cndmask_b32 v1, 0, v1, vcc
  v_lshl_add_u32 v1, v0, 4, v1
  v_add_u32 v1, s50, v1
  v_lshlrev_b32 v76, 2, v5
  v_sub_u32 v76, v76, v4
  s_or_b32 s51, s28, s40
  s_cmp_eq_u32 s51, 0
  s_cselect_b32 s51, 0, -1
  v_add_u32 v77, -1, v76
  v_cmp_gt_u32 s[86:87], 8, v77
  v_add_u32 v77, 0, v76
  v_cmp_gt_u32 s[88:89], 8, v77
  v_add_u32 v77, 1, v76
  v_cmp_gt_u32 s[90:91], 8, v77
  v_add_u32 v77, 2, v76
  v_cmp_gt_u32 s[92:93], 8, v77
  v_add_u32 v77, 15, v76
  v_cmp_gt_u32 s[94:95], 8, v77
  v_add_u32 v77, 16, v76
  v_cmp_gt_u32 s[96:97], 8, v77
  v_add_u32 v77, 17, v76
  v_cmp_gt_u32 s[98:99], 8, v77
  v_add_u32 v77, 18, v76
  v_cmp_gt_u32 s[100:101], 8, v77
  s_and_b32 s86, s86, s51
  s_and_b32 s88, s88, s51
  s_and_b32 s90, s90, s51
  s_and_b32 s92, s92, s51
  s_waitcnt lgkmcnt(0)
  s_mov_b32 s82, s84
  s_mov_b32 s83, s85
  s_mov_b32 s12, s84
  s_mov_b32 s13, s85
  s_mov_b32 s14, 0
  s_mov_b32 s15, 0x20000
  s_mov_b32 s20, s66
  s_mov_b32 s21, s67
  s_mov_b32 s22, 6291456
  s_mov_b32 s23, 0x20000
  s_cmp_eq_u32 s4, 3
  s_cselect_b32 s20, s68, s20
  s_cselect_b32 s21, s69, s21
  s_cselect_b32 s22, 2097152, s22
  s_cselect_b32 s47, 0, s4
  s_lshl_b32 s47, s47, 8
  s_add_u32 s47, s47, s2
  s_lshl_b32 s47, s47, 13
  v_lshlrev_b32 v13, 7, v0
  s_mov_b32 s51, s4
  s_barrier
  s_cmp_lg_u32 s51, 0
  s_cbranch_scc1 C_wm0
  buffer_load_dword v15, v13, s[20:23], s47 offen
C_wm0:
  s_mov_b32 s16, s66
  s_mov_b32 s17, s67
  s_mov_b32 s18, 6291456
  s_mov_b32 s19, 0x20000
  s_lshr_b32 s32, s2, 3
  s_lshl_b32 s32, s32, 1
  s_add_u32 s32, s32, s4
  s_sub_u32 s32, s32, 1
  s_lshl_b32 s32, s32, 6
  v_add_u32 v16, s32, v0
  v_mul_u32_u24 v17, 21846, v16
  v_lshrrev_b32 v17, 16, v17
  v_mul_u32_u24 v18, 3, v17
  v_sub_u32 v18, v16, v18
  v_mul_u32_u24 v17, 6144, v17
  v_lshl_add_u32 v14, v18, 11, v17
  s_and_b32 s32, s2, 1
  s_lshl_b32 s32, s32, 10
  s_add_u32 s32, s32, 384
  s_sub_u32 s40, s4, 1
  s_cmp_lt_u32 s40, 2
  s_cselect_b32 s18, s18, 0
  buffer_load_dword v15, v14, s[16:19], s32 offen
C_top:
  s_nop 7
  s_nop 7
  s_mov_b32 s43, 0
  s_mov_b32 s39, 12
  s_barrier
  ds_read_b64_tr_b16 v[16:17], v8 offset:0
  ds_read_b64_tr_b16 v[18:19], v8 offset:512
  ds_read_b128 v[28:31], v9 offset:0
  ds_read_b64_tr_b16 v[20:21], v8 offset:8192
  ds_read_b64_tr_b16 v[22:23], v8 offset:8704
  ds_read_b64_tr_b16 v[24:25], v8 offset:16384
  ds_read_b64_tr_b16 v[26:27], v8 offset:16896
  ds_read_b128 v[32:35], v9 offset:2048
  ds_read_b128 v[36:39], v9 offset:4096
  ds_read_b128 v[40:43], v9 offset:6144
  ds_read_b128 v[44:47], v9 offset:8192
  ds_read_b128 v[48:51], v9 offset:10240
  ds_read_b128 v[52:55], v9 offset:12288
  ds_read_b128 v[56:59], v9 offset:14336
  ds_read_b128 v[60:63], v9 offset:16384
  s_add_u32 s40, s43, 43008
  s_cmp_eq_u32 s40, 129024
  s_cselect_b32 s40, 0, s40
  s_sub_u32 s42, s40, s43
  s_mov_b32 s43, s40
  s_waitcnt lgkmcnt(12)
  v_mfma_f32_16x16x32_bf16 v[112:115], v[16:19], v[28:31], v[112:115]
  ds_read_b64_tr_b16 v[64:65], v8 offset:4096
  s_waitcnt lgkmcnt(11)
  v_mfma_f32_16x16x32_bf16 v[148:151], v[20:23], v[28:31], v[148:151]
  ds_read_b64_tr_b16 v[66:67], v8 offset:4608
  s_waitcnt lgkmcnt(10)
  v_mfma_f32_16x16x32_bf16 v[184:187], v[24:27], v[28:31], v[184:187]
  ds_read_b128 v[76:79], v10 offset:0
  s_waitcnt lgkmcnt(10)
  v_mfma_f32_16x16x32_bf16 v[188:191], v[24:27], v[32:35], v[188:191]
  ds_read_b64_tr_b16 v[68:69], v8 offset:12288
  v_mfma_f32_16x16x32_bf16 v[152:155], v[20:23], v[32:35], v[152:155]
  ds_read_b64_tr_b16 v[70:71], v8 offset:12800
  v_mfma_f32_16x16x32_bf16 v[116:119], v[16:19], v[32:35], v[116:119]
  ds_read_b64_tr_b16 v[72:73], v8 offset:20480
  s_waitcnt lgkmcnt(12)
  v_mfma_f32_16x16x32_bf16 v[120:123], v[16:19], v[36:39], v[120:123]
  ds_read_b64_tr_b16 v[74:75], v8 offset:20992
  v_add_u32 v8, s42, v8
  v_mfma_f32_16x16x32_bf16 v[156:159], v[20:23], v[36:39], v[156:159]
  ds_read_b128 v[80:83], v10 offset:2048
  v_mfma_f32_16x16x32_bf16 v[192:195], v[24:27], v[36:39], v[192:195]
  ds_read_b128 v[84:87], v10 offset:4096
  s_waitcnt lgkmcnt(14)
  v_mfma_f32_16x16x32_bf16 v[196:199], v[24:27], v[40:43], v[196:199]
  ds_read_b128 v[88:91], v10 offset:6144
  v_mfma_f32_16x16x32_bf16 v[160:163], v[20:23], v[40:43], v[160:163]
  ds_read_b128 v[92:95], v10 offset:8192
  v_mfma_f32_16x16x32_bf16 v[124:127], v[16:19], v[40:43], v[124:127]
  ds_read_b128 v[96:99], v10 offset:10240
  s_waitcnt lgkmcnt(14)
  v_mfma_f32_16x16x32_bf16 v[128:131], v[16:19], v[44:47], v[128:131]
  ds_read_b128 v[100:103], v10 offset:12288
  v_mfma_f32_16x16x32_bf16 v[164:167], v[20:23], v[44:47], v[164:167]
  ds_read_b128 v[104:107], v10 offset:14336
  v_mfma_f32_16x16x32_bf16 v[200:203], v[24:27], v[44:47], v[200:203]
  ds_read_b128 v[108:111], v10 offset:16384
  v_add_u32 v9, s42, v9
  v_add_u32 v10, s42, v10
  v_mfma_f32_16x16x32_bf16 v[204:207], v[24:27], v[48:51], v[204:207]
  v_mfma_f32_16x16x32_bf16 v[168:171], v[20:23], v[48:51], v[168:171]
  v_mfma_f32_16x16x32_bf16 v[132:135], v[16:19], v[48:51], v[132:135]
  v_mfma_f32_16x16x32_bf16 v[136:139], v[16:19], v[52:55], v[136:139]
  v_mfma_f32_16x16x32_bf16 v[172:175], v[20:23], v[52:55], v[172:175]
  v_mfma_f32_16x16x32_bf16 v[208:211], v[24:27], v[52:55], v[208:211]
  s_waitcnt lgkmcnt(14)
  v_mfma_f32_16x16x32_bf16 v[212:215], v[24:27], v[56:59], v[212:215]
  v_mfma_f32_16x16x32_bf16 v[176:179], v[20:23], v[56:59], v[176:179]
  v_mfma_f32_16x16x32_bf16 v[140:143], v[16:19], v[56:59], v[140:143]
  v_mfma_f32_16x16x32_bf16 v[144:147], v[16:19], v[60:63], v[144:147]
  v_mfma_f32_16x16x32_bf16 v[180:183], v[20:23], v[60:63], v[180:183]
  v_mfma_f32_16x16x32_bf16 v[216:219], v[24:27], v[60:63], v[216:219]
  s_waitcnt lgkmcnt(0)
  s_barrier
  s_cmp_lg_u32 s51, 1
  s_cbranch_scc1 C_wm1
  buffer_load_dword v15, v13, s[20:23], s47 offen
C_wm1:
  v_mfma_f32_16x16x32_bf16 v[112:115], v[64:67], v[76:79], v[112:115]
  ds_read_b64_tr_b16 v[16:17], v8 offset:0
  s_add_u32 s40, s43, 43008
  v_mfma_f32_16x16x32_bf16 v[148:151], v[68:71], v[76:79], v[148:151]
  ds_read_b64_tr_b16 v[18:19], v8 offset:512
  s_cmp_eq_u32 s40, 129024
  v_mfma_f32_16x16x32_bf16 v[184:187], v[72:75], v[76:79], v[184:187]
  ds_read_b128 v[28:31], v9 offset:0
  s_cselect_b32 s40, 0, s40
  v_mfma_f32_16x16x32_bf16 v[188:191], v[72:75], v[80:83], v[188:191]
  ds_read_b64_tr_b16 v[20:21], v8 offset:8192
  s_sub_u32 s42, s40, s43
  v_mfma_f32_16x16x32_bf16 v[152:155], v[68:71], v[80:83], v[152:155]
  ds_read_b64_tr_b16 v[22:23], v8 offset:8704
  s_mov_b32 s43, s40
  v_mfma_f32_16x16x32_bf16 v[116:119], v[64:67], v[80:83], v[116:119]
  ds_read_b64_tr_b16 v[24:25], v8 offset:16384
  v_mfma_f32_16x16x32_bf16 v[120:123], v[64:67], v[84:87], v[120:123]
  ds_read_b64_tr_b16 v[26:27], v8 offset:16896
  v_mfma_f32_16x16x32_bf16 v[156:159], v[68:71], v[84:87], v[156:159]
  ds_read_b128 v[32:35], v9 offset:2048
  v_mfma_f32_16x16x32_bf16 v[192:195], v[72:75], v[84:87], v[192:195]
  ds_read_b128 v[36:39], v9 offset:4096
  v_mfma_f32_16x16x32_bf16 v[196:199], v[72:75], v[88:91], v[196:199]
  ds_read_b128 v[40:43], v9 offset:6144
  v_mfma_f32_16x16x32_bf16 v[160:163], v[68:71], v[88:91], v[160:163]
  ds_read_b128 v[44:47], v9 offset:8192
  v_mfma_f32_16x16x32_bf16 v[124:127], v[64:67], v[88:91], v[124:127]
  ds_read_b128 v[48:51], v9 offset:10240
  v_mfma_f32_16x16x32_bf16 v[128:131], v[64:67], v[92:95], v[128:131]
  ds_read_b128 v[52:55], v9 offset:12288
  v_mfma_f32_16x16x32_bf16 v[164:167], v[68:71], v[92:95], v[164:167]
  ds_read_b128 v[56:59], v9 offset:14336
  v_mfma_f32_16x16x32_bf16 v[200:203], v[72:75], v[92:95], v[200:203]
  ds_read_b128 v[60:63], v9 offset:16384
  v_mfma_f32_16x16x32_bf16 v[204:207], v[72:75], v[96:99], v[204:207]
  v_mfma_f32_16x16x32_bf16 v[168:171], v[68:71], v[96:99], v[168:171]
  v_mfma_f32_16x16x32_bf16 v[132:135], v[64:67], v[96:99], v[132:135]
  v_mfma_f32_16x16x32_bf16 v[136:139], v[64:67], v[100:103], v[136:139]
  v_mfma_f32_16x16x32_bf16 v[172:175], v[68:71], v[100:103], v[172:175]
  v_mfma_f32_16x16x32_bf16 v[208:211], v[72:75], v[100:103], v[208:211]
  v_mfma_f32_16x16x32_bf16 v[212:215], v[72:75], v[104:107], v[212:215]
  v_mfma_f32_16x16x32_bf16 v[176:179], v[68:71], v[104:107], v[176:179]
  v_mfma_f32_16x16x32_bf16 v[140:143], v[64:67], v[104:107], v[140:143]
  v_mfma_f32_16x16x32_bf16 v[144:147], v[64:67], v[108:111], v[144:147]
  v_mfma_f32_16x16x32_bf16 v[180:183], v[68:71], v[108:111], v[180:183]
  v_mfma_f32_16x16x32_bf16 v[216:219], v[72:75], v[108:111], v[216:219]
  s_waitcnt lgkmcnt(12)
  v_mfma_f32_16x16x32_bf16 v[112:115], v[16:19], v[28:31], v[112:115]
  ds_read_b64_tr_b16 v[64:65], v8 offset:4096
  s_waitcnt lgkmcnt(11)
  v_mfma_f32_16x16x32_bf16 v[148:151], v[20:23], v[28:31], v[148:151]
  ds_read_b64_tr_b16 v[66:67], v8 offset:4608
  s_waitcnt lgkmcnt(10)
  v_mfma_f32_16x16x32_bf16 v[184:187], v[24:27], v[28:31], v[184:187]
  ds_read_b128 v[76:79], v10 offset:0
  s_waitcnt lgkmcnt(10)
  v_mfma_f32_16x16x32_bf16 v[188:191], v[24:27], v[32:35], v[188:191]
  ds_read_b64_tr_b16 v[68:69], v8 offset:12288
  v_mfma_f32_16x16x32_bf16 v[152:155], v[20:23], v[32:35], v[152:155]
  ds_read_b64_tr_b16 v[70:71], v8 offset:12800
  v_mfma_f32_16x16x32_bf16 v[116:119], v[16:19], v[32:35], v[116:119]
  ds_read_b64_tr_b16 v[72:73], v8 offset:20480
  s_waitcnt lgkmcnt(12)
  v_mfma_f32_16x16x32_bf16 v[120:123], v[16:19], v[36:39], v[120:123]
  ds_read_b64_tr_b16 v[74:75], v8 offset:20992
  v_add_u32 v8, s42, v8
  v_mfma_f32_16x16x32_bf16 v[156:159], v[20:23], v[36:39], v[156:159]
  ds_read_b128 v[80:83], v10 offset:2048
  v_mfma_f32_16x16x32_bf16 v[192:195], v[24:27], v[36:39], v[192:195]
  ds_read_b128 v[84:87], v10 offset:4096
  s_waitcnt lgkmcnt(14)
  v_mfma_f32_16x16x32_bf16 v[196:199], v[24:27], v[40:43], v[196:199]
  ds_read_b128 v[88:91], v10 offset:6144
  v_mfma_f32_16x16x32_bf16 v[160:163], v[20:23], v[40:43], v[160:163]
  ds_read_b128 v[92:95], v10 offset:8192
  v_mfma_f32_16x16x32_bf16 v[124:127], v[16:19], v[40:43], v[124:127]
  ds_read_b128 v[96:99], v10 offset:10240
  s_waitcnt lgkmcnt(14)
  v_mfma_f32_16x16x32_bf16 v[128:131], v[16:19], v[44:47], v[128:131]
  ds_read_b128 v[100:103], v10 offset:12288
  v_mfma_f32_16x16x32_bf16 v[164:167], v[20:23], v[44:47], v[164:167]
  ds_read_b128 v[104:107], v10 offset:14336
  v_mfma_f32_16x16x32_bf16 v[200:203], v[24:27], v[44:47], v[200:203]
  ds_read_b128 v[108:111], v10 offset:16384
  v_add_u32 v9, s42, v9
  v_add_u32 v10, s42, v10
  v_mfma_f32_16x16x32_bf16 v[204:207], v[24:27], v[48:51], v[204:207]
  v_mfma_f32_16x16x32_bf16 v[168:171], v[20:23], v[48:51], v[168:171]
  v_mfma_f32_16x16x32_bf16 v[132:135], v[16:19], v[48:51], v[132:135]
  v_mfma_f32_16x16x32_bf16 v[136:139], v[16:19], v[52:55], v[136:139]
  v_mfma_f32_16x16x32_bf16 v[172:175], v[20:23], v[52:55], v[172:175]
  v_mfma_f32_16x16x32_bf16 v[208:211], v[24:27], v[52:55], v[208:211]
  s_waitcnt lgkmcnt(14)
  v_mfma_f32_16x16x32_bf16 v[212:215], v[24:27], v[56:59], v[212:215]
  v_mfma_f32_16x16x32_bf16 v[176:179], v[20:23], v[56:59], v[176:179]
  v_mfma_f32_16x16x32_bf16 v[140:143], v[16:19], v[56:59], v[140:143]
  v_mfma_f32_16x16x32_bf16 v[144:147], v[16:19], v[60:63], v[144:147]
  v_mfma_f32_16x16x32_bf16 v[180:183], v[20:23], v[60:63], v[180:183]
  v_mfma_f32_16x16x32_bf16 v[216:219], v[24:27], v[60:63], v[216:219]
  s_waitcnt lgkmcnt(0)
  s_barrier
  s_cmp_lg_u32 s51, 2
  s_cbranch_scc1 C_wm2
  buffer_load_dword v15, v13, s[20:23], s47 offen
C_wm2:
  v_mfma_f32_16x16x32_bf16 v[112:115], v[64:67], v[76:79], v[112:115]
  ds_read_b64_tr_b16 v[16:17], v8 offset:0
  s_add_u32 s40, s43, 43008
  v_mfma_f32_16x16x32_bf16 v[148:151], v[68:71], v[76:79], v[148:151]
  ds_read_b64_tr_b16 v[18:19], v8 offset:512
  s_cmp_eq_u32 s40, 129024
  v_mfma_f32_16x16x32_bf16 v[184:187], v[72:75], v[76:79], v[184:187]
  ds_read_b128 v[28:31], v9 offset:0
  s_cselect_b32 s40, 0, s40
  v_mfma_f32_16x16x32_bf16 v[188:191], v[72:75], v[80:83], v[188:191]
  ds_read_b64_tr_b16 v[20:21], v8 offset:8192
  s_sub_u32 s42, s40, s43
  v_mfma_f32_16x16x32_bf16 v[152:155], v[68:71], v[80:83], v[152:155]
  ds_read_b64_tr_b16 v[22:23], v8 offset:8704
  s_mov_b32 s43, s40
  v_mfma_f32_16x16x32_bf16 v[116:119], v[64:67], v[80:83], v[116:119]
  ds_read_b64_tr_b16 v[24:25], v8 offset:16384
  v_mfma_f32_16x16x32_bf16 v[120:123], v[64:67], v[84:87], v[120:123]
  ds_read_b64_tr_b16 v[26:27], v8 offset:16896
  v_mfma_f32_16x16x32_bf16 v[156:159], v[68:71], v[84:87], v[156:159]
  ds_read_b128 v[32:35], v9 offset:2048
  v_mfma_f32_16x16x32_bf16 v[192:195], v[72:75], v[84:87], v[192:195]
  ds_read_b128 v[36:39], v9 offset:4096
  v_mfma_f32_16x16x32_bf16 v[196:199], v[72:75], v[88:91], v[196:199]
  ds_read_b128 v[40:43], v9 offset:6144
  v_mfma_f32_16x16x32_bf16 v[160:163], v[68:71], v[88:91], v[160:163]
  ds_read_b128 v[44:47], v9 offset:8192
  v_mfma_f32_16x16x32_bf16 v[124:127], v[64:67], v[88:91], v[124:127]
  ds_read_b128 v[48:51], v9 offset:10240
  v_mfma_f32_16x16x32_bf16 v[128:131], v[64:67], v[92:95], v[128:131]
  ds_read_b128 v[52:55], v9 offset:12288
  v_mfma_f32_16x16x32_bf16 v[164:167], v[68:71], v[92:95], v[164:167]
  ds_read_b128 v[56:59], v9 offset:14336
  v_mfma_f32_16x16x32_bf16 v[200:203], v[72:75], v[92:95], v[200:203]
  ds_read_b128 v[60:63], v9 offset:16384
  v_mfma_f32_16x16x32_bf16 v[204:207], v[72:75], v[96:99], v[204:207]
  v_mfma_f32_16x16x32_bf16 v[168:171], v[68:71], v[96:99], v[168:171]
  v_mfma_f32_16x16x32_bf16 v[132:135], v[64:67], v[96:99], v[132:135]
  v_mfma_f32_16x16x32_bf16 v[136:139], v[64:67], v[100:103], v[136:139]
  v_mfma_f32_16x16x32_bf16 v[172:175], v[68:71], v[100:103], v[172:175]
  v_mfma_f32_16x16x32_bf16 v[208:211], v[72:75], v[100:103], v[208:211]
  v_mfma_f32_16x16x32_bf16 v[212:215], v[72:75], v[104:107], v[212:215]
  v_mfma_f32_16x16x32_bf16 v[176:179], v[68:71], v[104:107], v[176:179]
  v_mfma_f32_16x16x32_bf16 v[140:143], v[64:67], v[104:107], v[140:143]
  v_mfma_f32_16x16x32_bf16 v[144:147], v[64:67], v[108:111], v[144:147]
  v_mfma_f32_16x16x32_bf16 v[180:183], v[68:71], v[108:111], v[180:183]
  v_mfma_f32_16x16x32_bf16 v[216:219], v[72:75], v[108:111], v[216:219]
  s_waitcnt lgkmcnt(12)
  v_mfma_f32_16x16x32_bf16 v[112:115], v[16:19], v[28:31], v[112:115]
  ds_read_b64_tr_b16 v[64:65], v8 offset:4096
  s_waitcnt lgkmcnt(11)
  v_mfma_f32_16x16x32_bf16 v[148:151], v[20:23], v[28:31], v[148:151]
  ds_read_b64_tr_b16 v[66:67], v8 offset:4608
  s_waitcnt lgkmcnt(10)
  v_mfma_f32_16x16x32_bf16 v[184:187], v[24:27], v[28:31], v[184:187]
  ds_read_b128 v[76:79], v10 offset:0
  s_waitcnt lgkmcnt(10)
  v_mfma_f32_16x16x32_bf16 v[188:191], v[24:27], v[32:35], v[188:191]
  ds_read_b64_tr_b16 v[68:69], v8 offset:12288
  v_mfma_f32_16x16x32_bf16 v[152:155], v[20:23], v[32:35], v[152:155]
  ds_read_b64_tr_b16 v[70:71], v8 offset:12800
  v_mfma_f32_16x16x32_bf16 v[116:119], v[16:19], v[32:35], v[116:119]
  ds_read_b64_tr_b16 v[72:73], v8 offset:20480
  s_waitcnt lgkmcnt(12)
  v_mfma_f32_16x16x32_bf16 v[120:123], v[16:19], v[36:39], v[120:123]
  ds_read_b64_tr_b16 v[74:75], v8 offset:20992
  v_add_u32 v8, s42, v8
  v_mfma_f32_16x16x32_bf16 v[156:159], v[20:23], v[36:39], v[156:159]
  ds_read_b128 v[80:83], v10 offset:2048
  v_mfma_f32_16x16x32_bf16 v[192:195], v[24:27], v[36:39], v[192:195]
  ds_read_b128 v[84:87], v10 offset:4096
  s_waitcnt lgkmcnt(14)
  v_mfma_f32_16x16x32_bf16 v[196:199], v[24:27], v[40:43], v[196:199]
  ds_read_b128 v[88:91], v10 offset:6144
  v_mfma_f32_16x16x32_bf16 v[160:163], v[20:23], v[40:43], v[160:163]
  ds_read_b128 v[92:95], v10 offset:8192
  v_mfma_f32_16x16x32_bf16 v[124:127], v[16:19], v[40:43], v[124:127]
  ds_read_b128 v[96:99], v10 offset:10240
  s_waitcnt lgkmcnt(14)
  v_mfma_f32_16x16x32_bf16 v[128:131], v[16:19], v[44:47], v[128:131]
  ds_read_b128 v[100:103], v10 offset:12288
  v_mfma_f32_16x16x32_bf16 v[164:167], v[20:23], v[44:47], v[164:167]
  ds_read_b128 v[104:107], v10 offset:14336
  v_mfma_f32_16x16x32_bf16 v[200:203], v[24:27], v[44:47], v[200:203]
  ds_read_b128 v[108:111], v10 offset:16384
  v_add_u32 v9, s42, v9
  v_add_u32 v10, s42, v10
  v_mfma_f32_16x16x32_bf16 v[204:207], v[24:27], v[48:51], v[204:207]
  v_mfma_f32_16x16x32_bf16 v[168:171], v[20:23], v[48:51], v[168:171]
  v_mfma_f32_16x16x32_bf16 v[132:135], v[16:19], v[48:51], v[132:135]
  v_mfma_f32_16x16x32_bf16 v[136:139], v[16:19], v[52:55], v[136:139]
  v_mfma_f32_16x16x32_bf16 v[172:175], v[20:23], v[52:55], v[172:175]
  v_mfma_f32_16x16x32_bf16 v[208:211], v[24:27], v[52:55], v[208:211]
  s_waitcnt lgkmcnt(14)
  v_mfma_f32_16x16x32_bf16 v[212:215], v[24:27], v[56:59], v[212:215]
  v_mfma_f32_16x16x32_bf16 v[176:179], v[20:23], v[56:59], v[176:179]
  v_mfma_f32_16x16x32_bf16 v[140:143], v[16:19], v[56:59], v[140:143]
  v_mfma_f32_16x16x32_bf16 v[144:147], v[16:19], v[60:63], v[144:147]
  v_mfma_f32_16x16x32_bf16 v[180:183], v[20:23], v[60:63], v[180:183]
  v_mfma_f32_16x16x32_bf16 v[216:219], v[24:27], v[60:63], v[216:219]
  s_waitcnt lgkmcnt(0)
  s_barrier
  s_cmp_lg_u32 s51, 3
  s_cbranch_scc1 C_wm3
  buffer_load_dword v15, v13, s[20:23], s47 offen
C_wm3:
  v_mfma_f32_16x16x32_bf16 v[112:115], v[64:67], v[76:79], v[112:115]
  ds_read_b64_tr_b16 v[16:17], v8 offset:0
  s_add_u32 s40, s43, 43008
  v_mfma_f32_16x16x32_bf16 v[148:151], v[68:71], v[76:79], v[148:151]
  ds_read_b64_tr_b16 v[18:19], v8 offset:512
  s_cmp_eq_u32 s40, 129024
  v_mfma_f32_16x16x32_bf16 v[184:187], v[72:75], v[76:79], v[184:187]
  ds_read_b128 v[28:31], v9 offset:0
  s_cselect_b32 s40, 0, s40
  v_mfma_f32_16x16x32_bf16 v[188:191], v[72:75], v[80:83], v[188:191]
  ds_read_b64_tr_b16 v[20:21], v8 offset:8192
  s_sub_u32 s42, s40, s43
  v_mfma_f32_16x16x32_bf16 v[152:155], v[68:71], v[80:83], v[152:155]
  ds_read_b64_tr_b16 v[22:23], v8 offset:8704
  s_mov_b32 s43, s40
  v_mfma_f32_16x16x32_bf16 v[116:119], v[64:67], v[80:83], v[116:119]
  ds_read_b64_tr_b16 v[24:25], v8 offset:16384
  v_mfma_f32_16x16x32_bf16 v[120:123], v[64:67], v[84:87], v[120:123]
  ds_read_b64_tr_b16 v[26:27], v8 offset:16896
  v_mfma_f32_16x16x32_bf16 v[156:159], v[68:71], v[84:87], v[156:159]
  ds_read_b128 v[32:35], v9 offset:2048
  v_mfma_f32_16x16x32_bf16 v[192:195], v[72:75], v[84:87], v[192:195]
  ds_read_b128 v[36:39], v9 offset:4096
  v_mfma_f32_16x16x32_bf16 v[196:199], v[72:75], v[88:91], v[196:199]
  ds_read_b128 v[40:43], v9 offset:6144
  v_mfma_f32_16x16x32_bf16 v[160:163], v[68:71], v[88:91], v[160:163]
  ds_read_b128 v[44:47], v9 offset:8192
  v_mfma_f32_16x16x32_bf16 v[124:127], v[64:67], v[88:91], v[124:127]
  ds_read_b128 v[48:51], v9 offset:10240
  v_mfma_f32_16x16x32_bf16 v[128:131], v[64:67], v[92:95], v[128:131]
  ds_read_b128 v[52:55], v9 offset:12288
  v_mfma_f32_16x16x32_bf16 v[164:167], v[68:71], v[92:95], v[164:167]
  ds_read_b128 v[56:59], v9 offset:14336
  v_mfma_f32_16x16x32_bf16 v[200:203], v[72:75], v[92:95], v[200:203]
  ds_read_b128 v[60:63], v9 offset:16384
  v_mfma_f32_16x16x32_bf16 v[204:207], v[72:75], v[96:99], v[204:207]
  v_mfma_f32_16x16x32_bf16 v[168:171], v[68:71], v[96:99], v[168:171]
  v_mfma_f32_16x16x32_bf16 v[132:135], v[64:67], v[96:99], v[132:135]
  v_mfma_f32_16x16x32_bf16 v[136:139], v[64:67], v[100:103], v[136:139]
  v_mfma_f32_16x16x32_bf16 v[172:175], v[68:71], v[100:103], v[172:175]
  v_mfma_f32_16x16x32_bf16 v[208:211], v[72:75], v[100:103], v[208:211]
  v_mfma_f32_16x16x32_bf16 v[212:215], v[72:75], v[104:107], v[212:215]
  v_mfma_f32_16x16x32_bf16 v[176:179], v[68:71], v[104:107], v[176:179]
  v_mfma_f32_16x16x32_bf16 v[140:143], v[64:67], v[104:107], v[140:143]
  v_mfma_f32_16x16x32_bf16 v[144:147], v[64:67], v[108:111], v[144:147]
  v_mfma_f32_16x16x32_bf16 v[180:183], v[68:71], v[108:111], v[180:183]
  v_mfma_f32_16x16x32_bf16 v[216:219], v[72:75], v[108:111], v[216:219]
cl1:
  s_waitcnt lgkmcnt(12)
  v_mfma_f32_16x16x32_bf16 v[112:115], v[16:19], v[28:31], v[112:115]
  ds_read_b64_tr_b16 v[64:65], v8 offset:4096
  s_waitcnt lgkmcnt(11)
  v_mfma_f32_16x16x32_bf16 v[148:151], v[20:23], v[28:31], v[148:151]
  ds_read_b64_tr_b16 v[66:67], v8 offset:4608
  s_waitcnt lgkmcnt(10)
  v_mfma_f32_16x16x32_bf16 v[184:187], v[24:27], v[28:31], v[184:187]
  ds_read_b128 v[76:79], v10 offset:0
  s_waitcnt lgkmcnt(10)
  v_mfma_f32_16x16x32_bf16 v[188:191], v[24:27], v[32:35], v[188:191]
  ds_read_b64_tr_b16 v[68:69], v8 offset:12288
  v_mfma_f32_16x16x32_bf16 v[152:155], v[20:23], v[32:35], v[152:155]
  ds_read_b64_tr_b16 v[70:71], v8 offset:12800
  v_mfma_f32_16x16x32_bf16 v[116:119], v[16:19], v[32:35], v[116:119]
  ds_read_b64_tr_b16 v[72:73], v8 offset:20480
  s_waitcnt lgkmcnt(12)
  v_mfma_f32_16x16x32_bf16 v[120:123], v[16:19], v[36:39], v[120:123]
  ds_read_b64_tr_b16 v[74:75], v8 offset:20992
  v_add_u32 v8, s42, v8
  v_mfma_f32_16x16x32_bf16 v[156:159], v[20:23], v[36:39], v[156:159]
  ds_read_b128 v[80:83], v10 offset:2048
  v_mfma_f32_16x16x32_bf16 v[192:195], v[24:27], v[36:39], v[192:195]
  ds_read_b128 v[84:87], v10 offset:4096
  s_waitcnt lgkmcnt(14)
  v_mfma_f32_16x16x32_bf16 v[196:199], v[24:27], v[40:43], v[196:199]
  ds_read_b128 v[88:91], v10 offset:6144
  v_mfma_f32_16x16x32_bf16 v[160:163], v[20:23], v[40:43], v[160:163]
  ds_read_b128 v[92:95], v10 offset:8192
  v_mfma_f32_16x16x32_bf16 v[124:127], v[16:19], v[40:43], v[124:127]
  ds_read_b128 v[96:99], v10 offset:10240
  s_waitcnt lgkmcnt(14)
  v_mfma_f32_16x16x32_bf16 v[128:131], v[16:19], v[44:47], v[128:131]
  ds_read_b128 v[100:103], v10 offset:12288
  v_mfma_f32_16x16x32_bf16 v[164:167], v[20:23], v[44:47], v[164:167]
  ds_read_b128 v[104:107], v10 offset:14336
  v_mfma_f32_16x16x32_bf16 v[200:203], v[24:27], v[44:47], v[200:203]
  ds_read_b128 v[108:111], v10 offset:16384
  v_add_u32 v9, s42, v9
  v_add_u32 v10, s42, v10
  v_mfma_f32_16x16x32_bf16 v[204:207], v[24:27], v[48:51], v[204:207]
  v_mfma_f32_16x16x32_bf16 v[168:171], v[20:23], v[48:51], v[168:171]
  v_mfma_f32_16x16x32_bf16 v[132:135], v[16:19], v[48:51], v[132:135]
  v_mfma_f32_16x16x32_bf16 v[136:139], v[16:19], v[52:55], v[136:139]
  v_mfma_f32_16x16x32_bf16 v[172:175], v[20:23], v[52:55], v[172:175]
  v_mfma_f32_16x16x32_bf16 v[208:211], v[24:27], v[52:55], v[208:211]
  s_waitcnt lgkmcnt(14)
  v_mfma_f32_16x16x32_bf16 v[212:215], v[24:27], v[56:59], v[212:215]
  v_mfma_f32_16x16x32_bf16 v[176:179], v[20:23], v[56:59], v[176:179]
  v_mfma_f32_16x16x32_bf16 v[140:143], v[16:19], v[56:59], v[140:143]
  v_mfma_f32_16x16x32_bf16 v[144:147], v[16:19], v[60:63], v[144:147]
  v_mfma_f32_16x16x32_bf16 v[180:183], v[20:23], v[60:63], v[180:183]
  v_mfma_f32_16x16x32_bf16 v[216:219], v[24:27], v[60:63], v[216:219]
  s_waitcnt lgkmcnt(0)
  s_barrier
  v_mfma_f32_16x16x32_bf16 v[112:115], v[64:67], v[76:79], v[112:115]
  ds_read_b64_tr_b16 v[16:17], v8 offset:0
  s_add_u32 s40, s43, 43008
  v_mfma_f32_16x16x32_bf16 v[148:151], v[68:71], v[76:79], v[148:151]
  ds_read_b64_tr_b16 v[18:19], v8 offset:512
  s_cmp_eq_u32 s40, 129024
  v_mfma_f32_16x16x32_bf16 v[184:187], v[72:75], v[76:79], v[184:187]
  ds_read_b128 v[28:31], v9 offset:0
  s_cselect_b32 s40, 0, s40
  v_mfma_f32_16x16x32_bf16 v[188:191], v[72:75], v[80:83], v[188:191]
  ds_read_b64_tr_b16 v[20:21], v8 offset:8192
  s_sub_u32 s42, s40, s43
  v_mfma_f32_16x16x32_bf16 v[152:155], v[68:71], v[80:83], v[152:155]
  ds_read_b64_tr_b16 v[22:23], v8 offset:8704
  s_mov_b32 s43, s40
  v_mfma_f32_16x16x32_bf16 v[116:119], v[64:67], v[80:83], v[116:119]
  ds_read_b64_tr_b16 v[24:25], v8 offset:16384
  v_mfma_f32_16x16x32_bf16 v[120:123], v[64:67], v[84:87], v[120:123]
  ds_read_b64_tr_b16 v[26:27], v8 offset:16896
  v_mfma_f32_16x16x32_bf16 v[156:159], v[68:71], v[84:87], v[156:159]
  ds_read_b128 v[32:35], v9 offset:2048
  v_mfma_f32_16x16x32_bf16 v[192:195], v[72:75], v[84:87], v[192:195]
  ds_read_b128 v[36:39], v9 offset:4096
  v_mfma_f32_16x16x32_bf16 v[196:199], v[72:75], v[88:91], v[196:199]
  ds_read_b128 v[40:43], v9 offset:6144
  v_mfma_f32_16x16x32_bf16 v[160:163], v[68:71], v[88:91], v[160:163]
  ds_read_b128 v[44:47], v9 offset:8192
  v_mfma_f32_16x16x32_bf16 v[124:127], v[64:67], v[88:91], v[124:127]
  ds_read_b128 v[48:51], v9 offset:10240
  v_mfma_f32_16x16x32_bf16 v[128:131], v[64:67], v[92:95], v[128:131]
  ds_read_b128 v[52:55], v9 offset:12288
  v_mfma_f32_16x16x32_bf16 v[164:167], v[68:71], v[92:95], v[164:167]
  ds_read_b128 v[56:59], v9 offset:14336
  v_mfma_f32_16x16x32_bf16 v[200:203], v[72:75], v[92:95], v[200:203]
  ds_read_b128 v[60:63], v9 offset:16384
  v_mfma_f32_16x16x32_bf16 v[204:207], v[72:75], v[96:99], v[204:207]
  v_mfma_f32_16x16x32_bf16 v[168:171], v[68:71], v[96:99], v[168:171]
  v_mfma_f32_16x16x32_bf16 v[132:135], v[64:67], v[96:99], v[132:135]
  v_mfma_f32_16x16x32_bf16 v[136:139], v[64:67], v[100:103], v[136:139]
  v_mfma_f32_16x16x32_bf16 v[172:175], v[68:71], v[100:103], v[172:175]
  v_mfma_f32_16x16x32_bf16 v[208:211], v[72:75], v[100:103], v[208:211]
  v_mfma_f32_16x16x32_bf16 v[212:215], v[72:75], v[104:107], v[212:215]
  v_mfma_f32_16x16x32_bf16 v[176:179], v[68:71], v[104:107], v[176:179]
  v_mfma_f32_16x16x32_bf16 v[140:143], v[64:67], v[104:107], v[140:143]
  v_mfma_f32_16x16x32_bf16 v[144:147], v[64:67], v[108:111], v[144:147]
  v_mfma_f32_16x16x32_bf16 v[180:183], v[68:71], v[108:111], v[180:183]
  v_mfma_f32_16x16x32_bf16 v[216:219], v[72:75], v[108:111], v[216:219]
  s_sub_u32 s39, s39, 1
  s_cmp_lg_u32 s39, 0
  s_cbranch_scc1 cl1
  s_waitcnt lgkmcnt(12)
  v_mfma_f32_16x16x32_bf16 v[112:115], v[16:19], v[28:31], v[112:115]
  ds_read_b64_tr_b16 v[64:65], v8 offset:4096
  s_waitcnt lgkmcnt(11)
  v_mfma_f32_16x16x32_bf16 v[148:151], v[20:23], v[28:31], v[148:151]
  ds_read_b64_tr_b16 v[66:67], v8 offset:4608
  s_waitcnt lgkmcnt(10)
  v_mfma_f32_16x16x32_bf16 v[184:187], v[24:27], v[28:31], v[184:187]
  ds_read_b128 v[76:79], v10 offset:0
  s_waitcnt lgkmcnt(10)
  v_mfma_f32_16x16x32_bf16 v[188:191], v[24:27], v[32:35], v[188:191]
  ds_read_b64_tr_b16 v[68:69], v8 offset:12288
  v_mfma_f32_16x16x32_bf16 v[152:155], v[20:23], v[32:35], v[152:155]
  ds_read_b64_tr_b16 v[70:71], v8 offset:12800
  v_mfma_f32_16x16x32_bf16 v[116:119], v[16:19], v[32:35], v[116:119]
  ds_read_b64_tr_b16 v[72:73], v8 offset:20480
  s_waitcnt lgkmcnt(12)
  v_mfma_f32_16x16x32_bf16 v[120:123], v[16:19], v[36:39], v[120:123]
  ds_read_b64_tr_b16 v[74:75], v8 offset:20992
  v_mfma_f32_16x16x32_bf16 v[156:159], v[20:23], v[36:39], v[156:159]
  ds_read_b128 v[80:83], v10 offset:2048
  v_mfma_f32_16x16x32_bf16 v[192:195], v[24:27], v[36:39], v[192:195]
  ds_read_b128 v[84:87], v10 offset:4096
  s_waitcnt lgkmcnt(14)
  v_mfma_f32_16x16x32_bf16 v[196:199], v[24:27], v[40:43], v[196:199]
  ds_read_b128 v[88:91], v10 offset:6144
  v_mfma_f32_16x16x32_bf16 v[160:163], v[20:23], v[40:43], v[160:163]
  ds_read_b128 v[92:95], v10 offset:8192
  v_mfma_f32_16x16x32_bf16 v[124:127], v[16:19], v[40:43], v[124:127]
  ds_read_b128 v[96:99], v10 offset:10240
  s_waitcnt lgkmcnt(14)
  v_mfma_f32_16x16x32_bf16 v[128:131], v[16:19], v[44:47], v[128:131]
  ds_read_b128 v[100:103], v10 offset:12288
  v_mfma_f32_16x16x32_bf16 v[164:167], v[20:23], v[44:47], v[164:167]
  ds_read_b128 v[104:107], v10 offset:14336
  v_mfma_f32_16x16x32_bf16 v[200:203], v[24:27], v[44:47], v[200:203]
  ds_read_b128 v[108:111], v10 offset:16384
  v_mfma_f32_16x16x32_bf16 v[204:207], v[24:27], v[48:51], v[204:207]
  ds_read_b64 v[224:225], v12 offset:0
  v_mfma_f32_16x16x32_bf16 v[168:171], v[20:23], v[48:51], v[168:171]
  ds_read_b64 v[226:227], v12 offset:128
  v_mfma_f32_16x16x32_bf16 v[132:135], v[16:19], v[48:51], v[132:135]
  ds_read_b64 v[228:229], v12 offset:256
  v_mfma_f32_16x16x32_bf16 v[136:139], v[16:19], v[52:55], v[136:139]
  ds_read_b64 v[230:231], v12 offset:384
  v_mfma_f32_16x16x32_bf16 v[172:175], v[20:23], v[52:55], v[172:175]
  ds_read_b64 v[232:233], v12 offset:512
  v_mfma_f32_16x16x32_bf16 v[208:211], v[24:27], v[52:55], v[208:211]
  ds_read_b64 v[234:235], v12 offset:640
  s_waitcnt lgkmcnt(14)
  v_mfma_f32_16x16x32_bf16 v[212:215], v[24:27], v[56:59], v[212:215]
  ds_read_b64 v[236:237], v12 offset:768
  v_mfma_f32_16x16x32_bf16 v[176:179], v[20:23], v[56:59], v[176:179]
  ds_read_b64 v[238:239], v12 offset:896
  v_mfma_f32_16x16x32_bf16 v[140:143], v[16:19], v[56:59], v[140:143]
  ds_read_b64 v[240:241], v12 offset:1024
  v_mfma_f32_16x16x32_bf16 v[144:147], v[16:19], v[60:63], v[144:147]
  v_mfma_f32_16x16x32_bf16 v[180:183], v[20:23], v[60:63], v[180:183]
  v_mfma_f32_16x16x32_bf16 v[216:219], v[24:27], v[60:63], v[216:219]
  s_waitcnt lgkmcnt(0)
  v_mfma_f32_16x16x32_bf16 v[112:115], v[64:67], v[76:79], v[112:115]
  v_mfma_f32_16x16x32_bf16 v[148:151], v[68:71], v[76:79], v[148:151]
  v_mfma_f32_16x16x32_bf16 v[184:187], v[72:75], v[76:79], v[184:187]
  v_mfma_f32_16x16x32_bf16 v[188:191], v[72:75], v[80:83], v[188:191]
  s_nop 4
  v_mov_b32_dpp v242, v112 row_newbcast:0 row_mask:0xf bank_mask:0xf
  v_mov_b32_dpp v243, v113 row_newbcast:0 row_mask:0xf bank_mask:0xf
  v_mov_b32_dpp v244, v114 row_newbcast:0 row_mask:0xf bank_mask:0xf
  v_mov_b32_dpp v245, v115 row_newbcast:0 row_mask:0xf bank_mask:0xf
  v_mov_b32_dpp v246, v148 row_newbcast:0 row_mask:0xf bank_mask:0xf
  v_mov_b32_dpp v247, v149 row_newbcast:0 row_mask:0xf bank_mask:0xf
  v_mov_b32_dpp v248, v150 row_newbcast:0 row_mask:0xf bank_mask:0xf
  v_mfma_f32_16x16x32_bf16 v[152:155], v[68:71], v[80:83], v[152:155]
  v_mov_b32_dpp v249, v151 row_newbcast:0 row_mask:0xf bank_mask:0xf
  v_mov_b32_dpp v250, v184 row_newbcast:0 row_mask:0xf bank_mask:0xf
  v_mov_b32_dpp v251, v185 row_newbcast:0 row_mask:0xf bank_mask:0xf
  v_mov_b32_dpp v252, v186 row_newbcast:0 row_mask:0xf bank_mask:0xf
  v_mov_b32_dpp v253, v187 row_newbcast:0 row_mask:0xf bank_mask:0xf
  v_pk_fma_f32 v[148:149], v[246:247], v[224:225], v[148:149] op_sel_hi:[1,0,1] neg_lo:[0,1,0] neg_hi:[0,1,0]
  v_pk_fma_f32 v[150:151], v[248:249], v[224:225], v[150:151] op_sel_hi:[1,0,1] neg_lo:[0,1,0] neg_hi:[0,1,0]
  v_mfma_f32_16x16x32_bf16 v[116:119], v[64:67], v[80:83], v[116:119]
  v_pk_fma_f32 v[184:185], v[250:251], v[224:225], v[184:185] op_sel_hi:[1,0,1] neg_lo:[0,1,0] neg_hi:[0,1,0]
  v_pk_fma_f32 v[186:187], v[252:253], v[224:225], v[186:187] op_sel_hi:[1,0,1] neg_lo:[0,1,0] neg_hi:[0,1,0]
  v_pk_mul_f32 v[148:149], v[148:149], v[224:225] op_sel:[0,1] op_sel_hi:[1,1]
  v_pk_mul_f32 v[150:151], v[150:151], v[224:225] op_sel:[0,1] op_sel_hi:[1,1]
  v_pk_mul_f32 v[184:185], v[184:185], v[224:225] op_sel:[0,1] op_sel_hi:[1,1]
  v_pk_mul_f32 v[186:187], v[186:187], v[224:225] op_sel:[0,1] op_sel_hi:[1,1]
  v_cvt_pk_bf16_f32 v16, v148, v149
  v_mfma_f32_16x16x32_bf16 v[120:123], v[64:67], v[84:87], v[120:123]
  v_cvt_pk_bf16_f32 v17, v150, v151
  ds_write_b64 v11, v[16:17] offset:128
  v_cvt_pk_bf16_f32 v18, v184, v185
  v_cvt_pk_bf16_f32 v19, v186, v187
  ds_write_b64 v11, v[18:19] offset:256
  v_pk_fma_f32 v[116:117], v[242:243], v[226:227], v[116:117] op_sel_hi:[1,0,1] neg_lo:[0,1,0] neg_hi:[0,1,0]
  v_pk_fma_f32 v[118:119], v[244:245], v[226:227], v[118:119] op_sel_hi:[1,0,1] neg_lo:[0,1,0] neg_hi:[0,1,0]
  v_mfma_f32_16x16x32_bf16 v[156:159], v[68:71], v[84:87], v[156:159]
  v_pk_fma_f32 v[152:153], v[246:247], v[226:227], v[152:153] op_sel_hi:[1,0,1] neg_lo:[0,1,0] neg_hi:[0,1,0]
  v_pk_fma_f32 v[154:155], v[248:249], v[226:227], v[154:155] op_sel_hi:[1,0,1] neg_lo:[0,1,0] neg_hi:[0,1,0]
  v_pk_fma_f32 v[188:189], v[250:251], v[226:227], v[188:189] op_sel_hi:[1,0,1] neg_lo:[0,1,0] neg_hi:[0,1,0]
  v_pk_fma_f32 v[190:191], v[252:253], v[226:227], v[190:191] op_sel_hi:[1,0,1] neg_lo:[0,1,0] neg_hi:[0,1,0]
  v_pk_mul_f32 v[116:117], v[116:117], v[226:227] op_sel:[0,1] op_sel_hi:[1,1]
  v_pk_mul_f32 v[118:119], v[118:119], v[226:227] op_sel:[0,1] op_sel_hi:[1,1]
  v_pk_mul_f32 v[152:153], v[152:153], v[226:227] op_sel:[0,1] op_sel_hi:[1,1]
  v_mfma_f32_16x16x32_bf16 v[192:195], v[72:75], v[84:87], v[192:195]
  v_pk_mul_f32 v[154:155], v[154:155], v[226:227] op_sel:[0,1] op_sel_hi:[1,1]
  v_pk_mul_f32 v[188:189], v[188:189], v[226:227] op_sel:[0,1] op_sel_hi:[1,1]
  v_pk_mul_f32 v[190:191], v[190:191], v[226:227] op_sel:[0,1] op_sel_hi:[1,1]
  v_cvt_pk_bf16_f32 v22, v116, v117
  v_cvt_pk_bf16_f32 v23, v118, v119
  ds_write_b64 v11, v[22:23] offset:3200
  v_cvt_pk_bf16_f32 v24, v152, v153
  v_mfma_f32_16x16x32_bf16 v[196:199], v[72:75], v[88:91], v[196:199]
  v_cvt_pk_bf16_f32 v25, v154, v155
  ds_write_b64 v11, v[24:25] offset:3328
  v_cvt_pk_bf16_f32 v26, v188, v189
  v_cvt_pk_bf16_f32 v27, v190, v191
  ds_write_b64 v11, v[26:27] offset:3456
  v_pk_fma_f32 v[120:121], v[242:243], v[228:229], v[120:121] op_sel_hi:[1,0,1] neg_lo:[0,1,0] neg_hi:[0,1,0]
  v_pk_fma_f32 v[122:123], v[244:245], v[228:229], v[122:123] op_sel_hi:[1,0,1] neg_lo:[0,1,0] neg_hi:[0,1,0]
  v_mfma_f32_16x16x32_bf16 v[160:163], v[68:71], v[88:91], v[160:163]
  v_pk_fma_f32 v[156:157], v[246:247], v[228:229], v[156:157] op_sel_hi:[1,0,1] neg_lo:[0,1,0] neg_hi:[0,1,0]
  v_pk_fma_f32 v[158:159], v[248:249], v[228:229], v[158:159] op_sel_hi:[1,0,1] neg_lo:[0,1,0] neg_hi:[0,1,0]
  v_pk_fma_f32 v[192:193], v[250:251], v[228:229], v[192:193] op_sel_hi:[1,0,1] neg_lo:[0,1,0] neg_hi:[0,1,0]
  v_pk_fma_f32 v[194:195], v[252:253], v[228:229], v[194:195] op_sel_hi:[1,0,1] neg_lo:[0,1,0] neg_hi:[0,1,0]
  v_pk_mul_f32 v[120:121], v[120:121], v[228:229] op_sel:[0,1] op_sel_hi:[1,1]
  v_pk_mul_f32 v[122:123], v[122:123], v[228:229] op_sel:[0,1] op_sel_hi:[1,1]
  v_pk_mul_f32 v[156:157], v[156:157], v[228:229] op_sel:[0,1] op_sel_hi:[1,1]
  v_mfma_f32_16x16x32_bf16 v[124:127], v[64:67], v[88:91], v[124:127]
  v_pk_mul_f32 v[158:159], v[158:159], v[228:229] op_sel:[0,1] op_sel_hi:[1,1]
  v_pk_mul_f32 v[192:193], v[192:193], v[228:229] op_sel:[0,1] op_sel_hi:[1,1]
  v_pk_mul_f32 v[194:195], v[194:195], v[228:229] op_sel:[0,1] op_sel_hi:[1,1]
  v_cvt_pk_bf16_f32 v28, v120, v121
  v_cvt_pk_bf16_f32 v29, v122, v123
  ds_write_b64 v11, v[28:29] offset:6400
  v_cvt_pk_bf16_f32 v30, v156, v157
  v_mfma_f32_16x16x32_bf16 v[128:131], v[64:67], v[92:95], v[128:131]
  v_cvt_pk_bf16_f32 v31, v158, v159
  ds_write_b64 v11, v[30:31] offset:6528
  v_cvt_pk_bf16_f32 v32, v192, v193
  v_cvt_pk_bf16_f32 v33, v194, v195
  ds_write_b64 v11, v[32:33] offset:6656
  v_pk_fma_f32 v[124:125], v[242:243], v[230:231], v[124:125] op_sel_hi:[1,0,1] neg_lo:[0,1,0] neg_hi:[0,1,0]
  v_pk_fma_f32 v[126:127], v[244:245], v[230:231], v[126:127] op_sel_hi:[1,0,1] neg_lo:[0,1,0] neg_hi:[0,1,0]
  v_mfma_f32_16x16x32_bf16 v[164:167], v[68:71], v[92:95], v[164:167]
  v_pk_fma_f32 v[160:161], v[246:247], v[230:231], v[160:161] op_sel_hi:[1,0,1] neg_lo:[0,1,0] neg_hi:[0,1,0]
  v_pk_fma_f32 v[162:163], v[248:249], v[230:231], v[162:163] op_sel_hi:[1,0,1] neg_lo:[0,1,0] neg_hi:[0,1,0]
  v_pk_fma_f32 v[196:197], v[250:251], v[230:231], v[196:197] op_sel_hi:[1,0,1] neg_lo:[0,1,0] neg_hi:[0,1,0]
  v_pk_fma_f32 v[198:199], v[252:253], v[230:231], v[198:199] op_sel_hi:[1,0,1] neg_lo:[0,1,0] neg_hi:[0,1,0]
  v_pk_mul_f32 v[124:125], v[124:125], v[230:231] op_sel:[0,1] op_sel_hi:[1,1]
  v_pk_mul_f32 v[126:127], v[126:127], v[230:231] op_sel:[0,1] op_sel_hi:[1,1]
  v_pk_mul_f32 v[160:161], v[160:161], v[230:231] op_sel:[0,1] op_sel_hi:[1,1]
  v_mfma_f32_16x16x32_bf16 v[200:203], v[72:75], v[92:95], v[200:203]
  v_pk_mul_f32 v[162:163], v[162:163], v[230:231] op_sel:[0,1] op_sel_hi:[1,1]
  v_pk_mul_f32 v[196:197], v[196:197], v[230:231] op_sel:[0,1] op_sel_hi:[1,1]
  v_pk_mul_f32 v[198:199], v[198:199], v[230:231] op_sel:[0,1] op_sel_hi:[1,1]
  v_cvt_pk_bf16_f32 v34, v124, v125
  v_cvt_pk_bf16_f32 v35, v126, v127
  ds_write_b64 v11, v[34:35] offset:9600
  v_cvt_pk_bf16_f32 v36, v160, v161
  v_mfma_f32_16x16x32_bf16 v[204:207], v[72:75], v[96:99], v[204:207]
  v_cvt_pk_bf16_f32 v37, v162, v163
  ds_write_b64 v11, v[36:37] offset:9728
  v_cvt_pk_bf16_f32 v38, v196, v197
  v_cvt_pk_bf16_f32 v39, v198, v199
  ds_write_b64 v11, v[38:39] offset:9856
  v_pk_fma_f32 v[128:129], v[242:243], v[232:233], v[128:129] op_sel_hi:[1,0,1] neg_lo:[0,1,0] neg_hi:[0,1,0]
  v_pk_fma_f32 v[130:131], v[244:245], v[232:233], v[130:131] op_sel_hi:[1,0,1] neg_lo:[0,1,0] neg_hi:[0,1,0]
  v_mfma_f32_16x16x32_bf16 v[168:171], v[68:71], v[96:99], v[168:171]
  v_pk_fma_f32 v[164:165], v[246:247], v[232:233], v[164:165] op_sel_hi:[1,0,1] neg_lo:[0,1,0] neg_hi:[0,1,0]
  v_pk_fma_f32 v[166:167], v[248:249], v[232:233], v[166:167] op_sel_hi:[1,0,1] neg_lo:[0,1,0] neg_hi:[0,1,0]
  v_pk_fma_f32 v[200:201], v[250:251], v[232:233], v[200:201] op_sel_hi:[1,0,1] neg_lo:[0,1,0] neg_hi:[0,1,0]
  v_pk_fma_f32 v[202:203], v[252:253], v[232:233], v[202:203] op_sel_hi:[1,0,1] neg_lo:[0,1,0] neg_hi:[0,1,0]
  v_pk_mul_f32 v[128:129], v[128:129], v[232:233] op_sel:[0,1] op_sel_hi:[1,1]
  v_pk_mul_f32 v[130:131], v[130:131], v[232:233] op_sel:[0,1] op_sel_hi:[1,1]
  v_pk_mul_f32 v[164:165], v[164:165], v[232:233] op_sel:[0,1] op_sel_hi:[1,1]
  v_mfma_f32_16x16x32_bf16 v[132:135], v[64:67], v[96:99], v[132:135]
  v_pk_mul_f32 v[166:167], v[166:167], v[232:233] op_sel:[0,1] op_sel_hi:[1,1]
  v_pk_mul_f32 v[200:201], v[200:201], v[232:233] op_sel:[0,1] op_sel_hi:[1,1]
  v_pk_mul_f32 v[202:203], v[202:203], v[232:233] op_sel:[0,1] op_sel_hi:[1,1]
  v_cvt_pk_bf16_f32 v40, v128, v129
  v_cvt_pk_bf16_f32 v41, v130, v131
  ds_write_b64 v11, v[40:41] offset:12800
  v_cvt_pk_bf16_f32 v42, v164, v165
  v_mfma_f32_16x16x32_bf16 v[136:139], v[64:67], v[100:103], v[136:139]
  v_cvt_pk_bf16_f32 v43, v166, v167
  ds_write_b64 v11, v[42:43] offset:12928
  v_cvt_pk_bf16_f32 v44, v200, v201
  v_cvt_pk_bf16_f32 v45, v202, v203
  ds_write_b64 v11, v[44:45] offset:13056
  v_pk_fma_f32 v[132:133], v[242:243], v[234:235], v[132:133] op_sel_hi:[1,0,1] neg_lo:[0,1,0] neg_hi:[0,1,0]
  v_pk_fma_f32 v[134:135], v[244:245], v[234:235], v[134:135] op_sel_hi:[1,0,1] neg_lo:[0,1,0] neg_hi:[0,1,0]
  v_mfma_f32_16x16x32_bf16 v[172:175], v[68:71], v[100:103], v[172:175]
  v_pk_fma_f32 v[168:169], v[246:247], v[234:235], v[168:169] op_sel_hi:[1,0,1] neg_lo:[0,1,0] neg_hi:[0,1,0]
  v_pk_fma_f32 v[170:171], v[248:249], v[234:235], v[170:171] op_sel_hi:[1,0,1] neg_lo:[0,1,0] neg_hi:[0,1,0]
  v_pk_fma_f32 v[204:205], v[250:251], v[234:235], v[204:205] op_sel_hi:[1,0,1] neg_lo:[0,1,0] neg_hi:[0,1,0]
  v_pk_fma_f32 v[206:207], v[252:253], v[234:235], v[206:207] op_sel_hi:[1,0,1] neg_lo:[0,1,0] neg_hi:[0,1,0]
  v_pk_mul_f32 v[132:133], v[132:133], v[234:235] op_sel:[0,1] op_sel_hi:[1,1]
  v_pk_mul_f32 v[134:135], v[134:135], v[234:235] op_sel:[0,1] op_sel_hi:[1,1]
  v_pk_mul_f32 v[168:169], v[168:169], v[234:235] op_sel:[0,1] op_sel_hi:[1,1]
  v_mfma_f32_16x16x32_bf16 v[208:211], v[72:75], v[100:103], v[208:211]
  v_pk_mul_f32 v[170:171], v[170:171], v[234:235] op_sel:[0,1] op_sel_hi:[1,1]
  v_pk_mul_f32 v[204:205], v[204:205], v[234:235] op_sel:[0,1] op_sel_hi:[1,1]
  v_pk_mul_f32 v[206:207], v[206:207], v[234:235] op_sel:[0,1] op_sel_hi:[1,1]
  v_cvt_pk_bf16_f32 v46, v132, v133
  v_cvt_pk_bf16_f32 v47, v134, v135
  ds_write_b64 v11, v[46:47] offset:16000
  v_cvt_pk_bf16_f32 v48, v168, v169
  v_mfma_f32_16x16x32_bf16 v[212:215], v[72:75], v[104:107], v[212:215]
  v_cvt_pk_bf16_f32 v49, v170, v171
  ds_write_b64 v11, v[48:49] offset:16128
  v_cvt_pk_bf16_f32 v50, v204, v205
  v_cvt_pk_bf16_f32 v51, v206, v207
  ds_write_b64 v11, v[50:51] offset:16256
  v_pk_fma_f32 v[136:137], v[242:243], v[236:237], v[136:137] op_sel_hi:[1,0,1] neg_lo:[0,1,0] neg_hi:[0,1,0]
  v_pk_fma_f32 v[138:139], v[244:245], v[236:237], v[138:139] op_sel_hi:[1,0,1] neg_lo:[0,1,0] neg_hi:[0,1,0]
  v_mfma_f32_16x16x32_bf16 v[176:179], v[68:71], v[104:107], v[176:179]
  v_pk_fma_f32 v[172:173], v[246:247], v[236:237], v[172:173] op_sel_hi:[1,0,1] neg_lo:[0,1,0] neg_hi:[0,1,0]
  v_pk_fma_f32 v[174:175], v[248:249], v[236:237], v[174:175] op_sel_hi:[1,0,1] neg_lo:[0,1,0] neg_hi:[0,1,0]
  v_pk_fma_f32 v[208:209], v[250:251], v[236:237], v[208:209] op_sel_hi:[1,0,1] neg_lo:[0,1,0] neg_hi:[0,1,0]
  v_pk_fma_f32 v[210:211], v[252:253], v[236:237], v[210:211] op_sel_hi:[1,0,1] neg_lo:[0,1,0] neg_hi:[0,1,0]
  v_pk_mul_f32 v[136:137], v[136:137], v[236:237] op_sel:[0,1] op_sel_hi:[1,1]
  v_pk_mul_f32 v[138:139], v[138:139], v[236:237] op_sel:[0,1] op_sel_hi:[1,1]
  v_pk_mul_f32 v[172:173], v[172:173], v[236:237] op_sel:[0,1] op_sel_hi:[1,1]
  v_mfma_f32_16x16x32_bf16 v[140:143], v[64:67], v[104:107], v[140:143]
  v_pk_mul_f32 v[174:175], v[174:175], v[236:237] op_sel:[0,1] op_sel_hi:[1,1]
  v_pk_mul_f32 v[208:209], v[208:209], v[236:237] op_sel:[0,1] op_sel_hi:[1,1]
  v_pk_mul_f32 v[210:211], v[210:211], v[236:237] op_sel:[0,1] op_sel_hi:[1,1]
  v_cvt_pk_bf16_f32 v52, v136, v137
  v_cvt_pk_bf16_f32 v53, v138, v139
  ds_write_b64 v11, v[52:53] offset:19200
  v_cvt_pk_bf16_f32 v54, v172, v173
  v_mfma_f32_16x16x32_bf16 v[144:147], v[64:67], v[108:111], v[144:147]
  v_cvt_pk_bf16_f32 v55, v174, v175
  ds_write_b64 v11, v[54:55] offset:19328
  v_cvt_pk_bf16_f32 v56, v208, v209
  v_cvt_pk_bf16_f32 v57, v210, v211
  ds_write_b64 v11, v[56:57] offset:19456
  v_pk_fma_f32 v[140:141], v[242:243], v[238:239], v[140:141] op_sel_hi:[1,0,1] neg_lo:[0,1,0] neg_hi:[0,1,0]
  v_pk_fma_f32 v[142:143], v[244:245], v[238:239], v[142:143] op_sel_hi:[1,0,1] neg_lo:[0,1,0] neg_hi:[0,1,0]
  v_mfma_f32_16x16x32_bf16 v[180:183], v[68:71], v[108:111], v[180:183]
  v_pk_fma_f32 v[176:177], v[246:247], v[238:239], v[176:177] op_sel_hi:[1,0,1] neg_lo:[0,1,0] neg_hi:[0,1,0]
  v_pk_fma_f32 v[178:179], v[248:249], v[238:239], v[178:179] op_sel_hi:[1,0,1] neg_lo:[0,1,0] neg_hi:[0,1,0]
  v_pk_fma_f32 v[212:213], v[250:251], v[238:239], v[212:213] op_sel_hi:[1,0,1] neg_lo:[0,1,0] neg_hi:[0,1,0]
  v_pk_fma_f32 v[214:215], v[252:253], v[238:239], v[214:215] op_sel_hi:[1,0,1] neg_lo:[0,1,0] neg_hi:[0,1,0]
  v_pk_mul_f32 v[140:141], v[140:141], v[238:239] op_sel:[0,1] op_sel_hi:[1,1]
  v_pk_mul_f32 v[142:143], v[142:143], v[238:239] op_sel:[0,1] op_sel_hi:[1,1]
  v_pk_mul_f32 v[176:177], v[176:177], v[238:239] op_sel:[0,1] op_sel_hi:[1,1]
  v_mfma_f32_16x16x32_bf16 v[216:219], v[72:75], v[108:111], v[216:219]
  v_pk_mul_f32 v[178:179], v[178:179], v[238:239] op_sel:[0,1] op_sel_hi:[1,1]
  v_pk_mul_f32 v[212:213], v[212:213], v[238:239] op_sel:[0,1] op_sel_hi:[1,1]
  v_pk_mul_f32 v[214:215], v[214:215], v[238:239] op_sel:[0,1] op_sel_hi:[1,1]
  v_cvt_pk_bf16_f32 v58, v140, v141
  v_cvt_pk_bf16_f32 v59, v142, v143
  ds_write_b64 v11, v[58:59] offset:22400
  v_cvt_pk_bf16_f32 v60, v176, v177
  s_barrier
  v_cvt_pk_bf16_f32 v61, v178, v179
  ds_write_b64 v11, v[60:61] offset:22528
  v_cvt_pk_bf16_f32 v62, v212, v213
  v_cvt_pk_bf16_f32 v63, v214, v215
  ds_write_b64 v11, v[62:63] offset:22656
  v_pk_fma_f32 v[144:145], v[242:243], v[240:241], v[144:145] op_sel_hi:[1,0,1] neg_lo:[0,1,0] neg_hi:[0,1,0]
  v_pk_fma_f32 v[146:147], v[244:245], v[240:241], v[146:147] op_sel_hi:[1,0,1] neg_lo:[0,1,0] neg_hi:[0,1,0]
  v_pk_fma_f32 v[180:181], v[246:247], v[240:241], v[180:181] op_sel_hi:[1,0,1] neg_lo:[0,1,0] neg_hi:[0,1,0]
  v_pk_fma_f32 v[182:183], v[248:249], v[240:241], v[182:183] op_sel_hi:[1,0,1] neg_lo:[0,1,0] neg_hi:[0,1,0]
  v_pk_fma_f32 v[216:217], v[250:251], v[240:241], v[216:217] op_sel_hi:[1,0,1] neg_lo:[0,1,0] neg_hi:[0,1,0]
  v_pk_fma_f32 v[218:219], v[252:253], v[240:241], v[218:219] op_sel_hi:[1,0,1] neg_lo:[0,1,0] neg_hi:[0,1,0]
  v_pk_mul_f32 v[144:145], v[144:145], v[240:241] op_sel:[0,1] op_sel_hi:[1,1]
  v_pk_mul_f32 v[146:147], v[146:147], v[240:241] op_sel:[0,1] op_sel_hi:[1,1]
  v_pk_mul_f32 v[180:181], v[180:181], v[240:241] op_sel:[0,1] op_sel_hi:[1,1]
  v_pk_mul_f32 v[182:183], v[182:183], v[240:241] op_sel:[0,1] op_sel_hi:[1,1]
  v_pk_mul_f32 v[216:217], v[216:217], v[240:241] op_sel:[0,1] op_sel_hi:[1,1]
  v_pk_mul_f32 v[218:219], v[218:219], v[240:241] op_sel:[0,1] op_sel_hi:[1,1]
  v_cvt_pk_bf16_f32 v16, v144, v145
  v_cvt_pk_bf16_f32 v17, v146, v147
  ds_write_b64 v11, v[16:17] offset:25600
  v_cvt_pk_bf16_f32 v18, v180, v181
  v_cvt_pk_bf16_f32 v19, v182, v183
  ds_write_b64 v11, v[18:19] offset:25728
  v_cvt_pk_bf16_f32 v20, v216, v217
  v_cvt_pk_bf16_f32 v21, v218, v219
  ds_write_b64 v11, v[20:21] offset:25856
  s_branch attn
C_top1:
  s_nop 7
  s_nop 7
  s_mov_b32 s43, 0
  s_mov_b32 s39, 15
  s_barrier
  ds_read_b64_tr_b16 v[16:17], v8 offset:0
  ds_read_b64_tr_b16 v[18:19], v8 offset:512
  ds_read_b128 v[28:31], v9 offset:0
  ds_read_b64_tr_b16 v[20:21], v8 offset:8192
  ds_read_b64_tr_b16 v[22:23], v8 offset:8704
  ds_read_b64_tr_b16 v[24:25], v8 offset:16384
  ds_read_b64_tr_b16 v[26:27], v8 offset:16896
  ds_read_b128 v[32:35], v9 offset:2048
  ds_read_b128 v[36:39], v9 offset:4096
  ds_read_b128 v[40:43], v9 offset:6144
  ds_read_b128 v[44:47], v9 offset:8192
  ds_read_b128 v[48:51], v9 offset:10240
  ds_read_b128 v[52:55], v9 offset:12288
  ds_read_b128 v[56:59], v9 offset:14336
  ds_read_b128 v[60:63], v9 offset:16384
  s_add_u32 s40, s43, 43008
  s_cmp_eq_u32 s40, 129024
  s_cselect_b32 s40, 0, s40
  s_sub_u32 s42, s40, s43
  s_mov_b32 s43, s40
cl2:
  s_waitcnt lgkmcnt(10)
  v_mfma_f32_16x16x32_bf16 v[148:151], v[20:23], v[28:31], v[148:151]
  ds_read_b64_tr_b16 v[64:65], v8 offset:4096
  s_waitcnt lgkmcnt(9)
  v_mfma_f32_16x16x32_bf16 v[184:187], v[24:27], v[28:31], v[184:187]
  ds_read_b64_tr_b16 v[66:67], v8 offset:4608
  s_waitcnt lgkmcnt(9)
  v_mfma_f32_16x16x32_bf16 v[188:191], v[24:27], v[32:35], v[188:191]
  ds_read_b128 v[76:79], v10 offset:0
  v_mfma_f32_16x16x32_bf16 v[152:155], v[20:23], v[32:35], v[152:155]
  ds_read_b64_tr_b16 v[68:69], v8 offset:12288
  v_mfma_f32_16x16x32_bf16 v[116:119], v[16:19], v[32:35], v[116:119]
  ds_read_b64_tr_b16 v[70:71], v8 offset:12800
  s_waitcnt lgkmcnt(11)
  v_mfma_f32_16x16x32_bf16 v[120:123], v[16:19], v[36:39], v[120:123]
  ds_read_b64_tr_b16 v[72:73], v8 offset:20480
  v_mfma_f32_16x16x32_bf16 v[156:159], v[20:23], v[36:39], v[156:159]
  ds_read_b64_tr_b16 v[74:75], v8 offset:20992
  v_add_u32 v8, s42, v8
  v_mfma_f32_16x16x32_bf16 v[192:195], v[24:27], v[36:39], v[192:195]
  ds_read_b128 v[80:83], v10 offset:2048
  s_waitcnt lgkmcnt(13)
  v_mfma_f32_16x16x32_bf16 v[196:199], v[24:27], v[40:43], v[196:199]
  ds_read_b128 v[84:87], v10 offset:4096
  v_mfma_f32_16x16x32_bf16 v[160:163], v[20:23], v[40:43], v[160:163]
  ds_read_b128 v[88:91], v10 offset:6144
  v_mfma_f32_16x16x32_bf16 v[124:127], v[16:19], v[40:43], v[124:127]
  ds_read_b128 v[92:95], v10 offset:8192
  s_waitcnt lgkmcnt(14)
  v_mfma_f32_16x16x32_bf16 v[128:131], v[16:19], v[44:47], v[128:131]
  ds_read_b128 v[96:99], v10 offset:10240
  v_mfma_f32_16x16x32_bf16 v[164:167], v[20:23], v[44:47], v[164:167]
  ds_read_b128 v[100:103], v10 offset:12288
  v_mfma_f32_16x16x32_bf16 v[200:203], v[24:27], v[44:47], v[200:203]
  ds_read_b128 v[104:107], v10 offset:14336
  v_mfma_f32_16x16x32_bf16 v[204:207], v[24:27], v[48:51], v[204:207]
  ds_read_b128 v[108:111], v10 offset:16384
  v_add_u32 v9, s42, v9
  v_add_u32 v10, s42, v10
  v_mfma_f32_16x16x32_bf16 v[168:171], v[20:23], v[48:51], v[168:171]
  v_mfma_f32_16x16x32_bf16 v[132:135], v[16:19], v[48:51], v[132:135]
  s_waitcnt lgkmcnt(14)
  v_mfma_f32_16x16x32_bf16 v[136:139], v[16:19], v[52:55], v[136:139]
  v_mfma_f32_16x16x32_bf16 v[172:175], v[20:23], v[52:55], v[172:175]
  v_mfma_f32_16x16x32_bf16 v[208:211], v[24:27], v[52:55], v[208:211]
  v_mfma_f32_16x16x32_bf16 v[212:215], v[24:27], v[56:59], v[212:215]
  v_mfma_f32_16x16x32_bf16 v[176:179], v[20:23], v[56:59], v[176:179]
  v_mfma_f32_16x16x32_bf16 v[140:143], v[16:19], v[56:59], v[140:143]
  v_mfma_f32_16x16x32_bf16 v[144:147], v[16:19], v[60:63], v[144:147]
  v_mfma_f32_16x16x32_bf16 v[180:183], v[20:23], v[60:63], v[180:183]
  v_mfma_f32_16x16x32_bf16 v[216:219], v[24:27], v[60:63], v[216:219]
  s_waitcnt lgkmcnt(0)
  s_barrier
  v_mfma_f32_16x16x32_bf16 v[148:151], v[68:71], v[76:79], v[148:151]
  ds_read_b64_tr_b16 v[16:17], v8 offset:0
  s_add_u32 s40, s43, 43008
  v_mfma_f32_16x16x32_bf16 v[184:187], v[72:75], v[76:79], v[184:187]
  ds_read_b64_tr_b16 v[18:19], v8 offset:512
  s_cmp_eq_u32 s40, 129024
  v_mfma_f32_16x16x32_bf16 v[188:191], v[72:75], v[80:83], v[188:191]
  ds_read_b128 v[28:31], v9 offset:0
  s_cselect_b32 s40, 0, s40
  v_mfma_f32_16x16x32_bf16 v[152:155], v[68:71], v[80:83], v[152:155]
  ds_read_b64_tr_b16 v[20:21], v8 offset:8192
  s_sub_u32 s42, s40, s43
  v_mfma_f32_16x16x32_bf16 v[116:119], v[64:67], v[80:83], v[116:119]
  ds_read_b64_tr_b16 v[22:23], v8 offset:8704
  s_mov_b32 s43, s40
  v_mfma_f32_16x16x32_bf16 v[120:123], v[64:67], v[84:87], v[120:123]
  ds_read_b64_tr_b16 v[24:25], v8 offset:16384
  v_mfma_f32_16x16x32_bf16 v[156:159], v[68:71], v[84:87], v[156:159]
  ds_read_b64_tr_b16 v[26:27], v8 offset:16896
  v_mfma_f32_16x16x32_bf16 v[192:195], v[72:75], v[84:87], v[192:195]
  ds_read_b128 v[32:35], v9 offset:2048
  v_mfma_f32_16x16x32_bf16 v[196:199], v[72:75], v[88:91], v[196:199]
  ds_read_b128 v[36:39], v9 offset:4096
  v_mfma_f32_16x16x32_bf16 v[160:163], v[68:71], v[88:91], v[160:163]
  ds_read_b128 v[40:43], v9 offset:6144
  v_mfma_f32_16x16x32_bf16 v[124:127], v[64:67], v[88:91], v[124:127]
  ds_read_b128 v[44:47], v9 offset:8192
  v_mfma_f32_16x16x32_bf16 v[128:131], v[64:67], v[92:95], v[128:131]
  ds_read_b128 v[48:51], v9 offset:10240
  v_mfma_f32_16x16x32_bf16 v[164:167], v[68:71], v[92:95], v[164:167]
  ds_read_b128 v[52:55], v9 offset:12288
  v_mfma_f32_16x16x32_bf16 v[200:203], v[72:75], v[92:95], v[200:203]
  ds_read_b128 v[56:59], v9 offset:14336
  v_mfma_f32_16x16x32_bf16 v[204:207], v[72:75], v[96:99], v[204:207]
  ds_read_b128 v[60:63], v9 offset:16384
  v_mfma_f32_16x16x32_bf16 v[168:171], v[68:71], v[96:99], v[168:171]
  v_mfma_f32_16x16x32_bf16 v[132:135], v[64:67], v[96:99], v[132:135]
  v_mfma_f32_16x16x32_bf16 v[136:139], v[64:67], v[100:103], v[136:139]
  v_mfma_f32_16x16x32_bf16 v[172:175], v[68:71], v[100:103], v[172:175]
  v_mfma_f32_16x16x32_bf16 v[208:211], v[72:75], v[100:103], v[208:211]
  v_mfma_f32_16x16x32_bf16 v[212:215], v[72:75], v[104:107], v[212:215]
  v_mfma_f32_16x16x32_bf16 v[176:179], v[68:71], v[104:107], v[176:179]
  v_mfma_f32_16x16x32_bf16 v[140:143], v[64:67], v[104:107], v[140:143]
  v_mfma_f32_16x16x32_bf16 v[144:147], v[64:67], v[108:111], v[144:147]
  v_mfma_f32_16x16x32_bf16 v[180:183], v[68:71], v[108:111], v[180:183]
  v_mfma_f32_16x16x32_bf16 v[216:219], v[72:75], v[108:111], v[216:219]
  s_sub_u32 s39, s39, 1
  s_cmp_lg_u32 s39, 0
  s_cbranch_scc1 cl2
  s_waitcnt lgkmcnt(10)
  v_mfma_f32_16x16x32_bf16 v[148:151], v[20:23], v[28:31], v[148:151]
  ds_read_b64_tr_b16 v[64:65], v8 offset:4096
  s_waitcnt lgkmcnt(9)
  v_mfma_f32_16x16x32_bf16 v[184:187], v[24:27], v[28:31], v[184:187]
  ds_read_b64_tr_b16 v[66:67], v8 offset:4608
  s_waitcnt lgkmcnt(9)
  v_mfma_f32_16x16x32_bf16 v[188:191], v[24:27], v[32:35], v[188:191]
  ds_read_b128 v[76:79], v10 offset:0
  v_mfma_f32_16x16x32_bf16 v[152:155], v[20:23], v[32:35], v[152:155]
  ds_read_b64_tr_b16 v[68:69], v8 offset:12288
  v_mfma_f32_16x16x32_bf16 v[116:119], v[16:19], v[32:35], v[116:119]
  ds_read_b64_tr_b16 v[70:71], v8 offset:12800
  s_waitcnt lgkmcnt(11)
  v_mfma_f32_16x16x32_bf16 v[120:123], v[16:19], v[36:39], v[120:123]
  ds_read_b64_tr_b16 v[72:73], v8 offset:20480
  v_mfma_f32_16x16x32_bf16 v[156:159], v[20:23], v[36:39], v[156:159]
  ds_read_b64_tr_b16 v[74:75], v8 offset:20992
  v_mfma_f32_16x16x32_bf16 v[192:195], v[24:27], v[36:39], v[192:195]
  ds_read_b128 v[80:83], v10 offset:2048
  s_waitcnt lgkmcnt(13)
  v_mfma_f32_16x16x32_bf16 v[196:199], v[24:27], v[40:43], v[196:199]
  ds_read_b128 v[84:87], v10 offset:4096
  v_mfma_f32_16x16x32_bf16 v[160:163], v[20:23], v[40:43], v[160:163]
  ds_read_b128 v[88:91], v10 offset:6144
  v_mfma_f32_16x16x32_bf16 v[124:127], v[16:19], v[40:43], v[124:127]
  ds_read_b128 v[92:95], v10 offset:8192
  s_waitcnt lgkmcnt(14)
  v_mfma_f32_16x16x32_bf16 v[128:131], v[16:19], v[44:47], v[128:131]
  ds_read_b128 v[96:99], v10 offset:10240
  v_mfma_f32_16x16x32_bf16 v[164:167], v[20:23], v[44:47], v[164:167]
  ds_read_b128 v[100:103], v10 offset:12288
  v_mfma_f32_16x16x32_bf16 v[200:203], v[24:27], v[44:47], v[200:203]
  ds_read_b128 v[104:107], v10 offset:14336
  v_mfma_f32_16x16x32_bf16 v[204:207], v[24:27], v[48:51], v[204:207]
  ds_read_b128 v[108:111], v10 offset:16384
  v_mfma_f32_16x16x32_bf16 v[168:171], v[20:23], v[48:51], v[168:171]
  ds_read_b64 v[224:225], v12 offset:0
  v_mfma_f32_16x16x32_bf16 v[132:135], v[16:19], v[48:51], v[132:135]
  ds_read_b64 v[226:227], v12 offset:128
  s_waitcnt lgkmcnt(14)
  v_mfma_f32_16x16x32_bf16 v[136:139], v[16:19], v[52:55], v[136:139]
  ds_read_b64 v[228:229], v12 offset:256
  v_mfma_f32_16x16x32_bf16 v[172:175], v[20:23], v[52:55], v[172:175]
  ds_read_b64 v[230:231], v12 offset:384
  v_mfma_f32_16x16x32_bf16 v[208:211], v[24:27], v[52:55], v[208:211]
  ds_read_b64 v[232:233], v12 offset:512
  v_mfma_f32_16x16x32_bf16 v[212:215], v[24:27], v[56:59], v[212:215]
  ds_read_b64 v[234:235], v12 offset:640
  v_mfma_f32_16x16x32_bf16 v[176:179], v[20:23], v[56:59], v[176:179]
  ds_read_b64 v[236:237], v12 offset:768
  v_mfma_f32_16x16x32_bf16 v[140:143], v[16:19], v[56:59], v[140:143]
  ds_read_b64 v[238:239], v12 offset:896
  v_mfma_f32_16x16x32_bf16 v[144:147], v[16:19], v[60:63], v[144:147]
  ds_read_b64 v[240:241], v12 offset:1024
  v_mfma_f32_16x16x32_bf16 v[180:183], v[20:23], v[60:63], v[180:183]
  v_mfma_f32_16x16x32_bf16 v[216:219], v[24:27], v[60:63], v[216:219]
  s_waitcnt lgkmcnt(0)
  v_mfma_f32_16x16x32_bf16 v[148:151], v[68:71], v[76:79], v[148:151]
  v_mfma_f32_16x16x32_bf16 v[184:187], v[72:75], v[76:79], v[184:187]
  v_mfma_f32_16x16x32_bf16 v[188:191], v[72:75], v[80:83], v[188:191]
  s_nop 5
  v_mov_b32_dpp v246, v148 row_newbcast:0 row_mask:0xf bank_mask:0xf
  v_mov_b32_dpp v247, v149 row_newbcast:0 row_mask:0xf bank_mask:0xf
  v_mov_b32_dpp v248, v150 row_newbcast:0 row_mask:0xf bank_mask:0xf
  v_mov_b32_dpp v249, v151 row_newbcast:0 row_mask:0xf bank_mask:0xf
  v_mov_b32_dpp v250, v184 row_newbcast:0 row_mask:0xf bank_mask:0xf
  v_mov_b32_dpp v251, v185 row_newbcast:0 row_mask:0xf bank_mask:0xf
  v_mov_b32_dpp v252, v186 row_newbcast:0 row_mask:0xf bank_mask:0xf
  v_mfma_f32_16x16x32_bf16 v[152:155], v[68:71], v[80:83], v[152:155]
  v_mov_b32_dpp v253, v187 row_newbcast:0 row_mask:0xf bank_mask:0xf
  v_pk_fma_f32 v[148:149], v[246:247], v[224:225], v[148:149] op_sel_hi:[1,0,1] neg_lo:[0,1,0] neg_hi:[0,1,0]
  v_pk_fma_f32 v[150:151], v[248:249], v[224:225], v[150:151] op_sel_hi:[1,0,1] neg_lo:[0,1,0] neg_hi:[0,1,0]
  v_pk_fma_f32 v[184:185], v[250:251], v[224:225], v[184:185] op_sel_hi:[1,0,1] neg_lo:[0,1,0] neg_hi:[0,1,0]
  v_pk_fma_f32 v[186:187], v[252:253], v[224:225], v[186:187] op_sel_hi:[1,0,1] neg_lo:[0,1,0] neg_hi:[0,1,0]
  v_pk_mul_f32 v[148:149], v[148:149], v[224:225] op_sel:[0,1] op_sel_hi:[1,1]
  v_pk_mul_f32 v[150:151], v[150:151], v[224:225] op_sel:[0,1] op_sel_hi:[1,1]
  v_mfma_f32_16x16x32_bf16 v[116:119], v[64:67], v[80:83], v[116:119]
  v_pk_mul_f32 v[184:185], v[184:185], v[224:225] op_sel:[0,1] op_sel_hi:[1,1]
  v_pk_mul_f32 v[186:187], v[186:187], v[224:225] op_sel:[0,1] op_sel_hi:[1,1]
  v_cvt_pk_bf16_f32 v16, v148, v149
  v_cvt_pk_bf16_f32 v17, v150, v151
  ds_write_b64 v11, v[16:17] offset:128
  v_cvt_pk_bf16_f32 v18, v184, v185
  v_cvt_pk_bf16_f32 v19, v186, v187
  v_mfma_f32_16x16x32_bf16 v[120:123], v[64:67], v[84:87], v[120:123]
  ds_write_b64 v11, v[18:19] offset:256
  v_pk_fma_f32 v[116:117], v[242:243], v[226:227], v[116:117] op_sel_hi:[1,0,1] neg_lo:[0,1,0] neg_hi:[0,1,0]
  v_pk_fma_f32 v[118:119], v[244:245], v[226:227], v[118:119] op_sel_hi:[1,0,1] neg_lo:[0,1,0] neg_hi:[0,1,0]
  v_pk_fma_f32 v[152:153], v[246:247], v[226:227], v[152:153] op_sel_hi:[1,0,1] neg_lo:[0,1,0] neg_hi:[0,1,0]
  v_pk_fma_f32 v[154:155], v[248:249], v[226:227], v[154:155] op_sel_hi:[1,0,1] neg_lo:[0,1,0] neg_hi:[0,1,0]
  v_pk_fma_f32 v[188:189], v[250:251], v[226:227], v[188:189] op_sel_hi:[1,0,1] neg_lo:[0,1,0] neg_hi:[0,1,0]
  v_pk_fma_f32 v[190:191], v[252:253], v[226:227], v[190:191] op_sel_hi:[1,0,1] neg_lo:[0,1,0] neg_hi:[0,1,0]
  v_mfma_f32_16x16x32_bf16 v[156:159], v[68:71], v[84:87], v[156:159]
  v_pk_mul_f32 v[116:117], v[116:117], v[226:227] op_sel:[0,1] op_sel_hi:[1,1]
  v_pk_mul_f32 v[118:119], v[118:119], v[226:227] op_sel:[0,1] op_sel_hi:[1,1]
  v_pk_mul_f32 v[152:153], v[152:153], v[226:227] op_sel:[0,1] op_sel_hi:[1,1]
  v_pk_mul_f32 v[154:155], v[154:155], v[226:227] op_sel:[0,1] op_sel_hi:[1,1]
  v_pk_mul_f32 v[188:189], v[188:189], v[226:227] op_sel:[0,1] op_sel_hi:[1,1]
  v_pk_mul_f32 v[190:191], v[190:191], v[226:227] op_sel:[0,1] op_sel_hi:[1,1]
  v_cvt_pk_bf16_f32 v22, v116, v117
  v_mfma_f32_16x16x32_bf16 v[192:195], v[72:75], v[84:87], v[192:195]
  v_cvt_pk_bf16_f32 v23, v118, v119
  ds_write_b64 v11, v[22:23] offset:3200
  v_cvt_pk_bf16_f32 v24, v152, v153
  v_cvt_pk_bf16_f32 v25, v154, v155
  ds_write_b64 v11, v[24:25] offset:3328
  v_cvt_pk_bf16_f32 v26, v188, v189
  v_cvt_pk_bf16_f32 v27, v190, v191
  v_mfma_f32_16x16x32_bf16 v[196:199], v[72:75], v[88:91], v[196:199]
  ds_write_b64 v11, v[26:27] offset:3456
  v_pk_fma_f32 v[120:121], v[242:243], v[228:229], v[120:121] op_sel_hi:[1,0,1] neg_lo:[0,1,0] neg_hi:[0,1,0]
  v_pk_fma_f32 v[122:123], v[244:245], v[228:229], v[122:123] op_sel_hi:[1,0,1] neg_lo:[0,1,0] neg_hi:[0,1,0]
  v_pk_fma_f32 v[156:157], v[246:247], v[228:229], v[156:157] op_sel_hi:[1,0,1] neg_lo:[0,1,0] neg_hi:[0,1,0]
  v_pk_fma_f32 v[158:159], v[248:249], v[228:229], v[158:159] op_sel_hi:[1,0,1] neg_lo:[0,1,0] neg_hi:[0,1,0]
  v_pk_fma_f32 v[192:193], v[250:251], v[228:229], v[192:193] op_sel_hi:[1,0,1] neg_lo:[0,1,0] neg_hi:[0,1,0]
  v_pk_fma_f32 v[194:195], v[252:253], v[228:229], v[194:195] op_sel_hi:[1,0,1] neg_lo:[0,1,0] neg_hi:[0,1,0]
  v_mfma_f32_16x16x32_bf16 v[160:163], v[68:71], v[88:91], v[160:163]
  v_pk_mul_f32 v[120:121], v[120:121], v[228:229] op_sel:[0,1] op_sel_hi:[1,1]
  v_pk_mul_f32 v[122:123], v[122:123], v[228:229] op_sel:[0,1] op_sel_hi:[1,1]
  v_pk_mul_f32 v[156:157], v[156:157], v[228:229] op_sel:[0,1] op_sel_hi:[1,1]
  v_pk_mul_f32 v[158:159], v[158:159], v[228:229] op_sel:[0,1] op_sel_hi:[1,1]
  v_pk_mul_f32 v[192:193], v[192:193], v[228:229] op_sel:[0,1] op_sel_hi:[1,1]
  v_pk_mul_f32 v[194:195], v[194:195], v[228:229] op_sel:[0,1] op_sel_hi:[1,1]
  v_cvt_pk_bf16_f32 v28, v120, v121
  v_mfma_f32_16x16x32_bf16 v[124:127], v[64:67], v[88:91], v[124:127]
  v_cvt_pk_bf16_f32 v29, v122, v123
  ds_write_b64 v11, v[28:29] offset:6400
  v_cvt_pk_bf16_f32 v30, v156, v157
  v_cvt_pk_bf16_f32 v31, v158, v159
  ds_write_b64 v11, v[30:31] offset:6528
  v_cvt_pk_bf16_f32 v32, v192, v193
  v_cvt_pk_bf16_f32 v33, v194, v195
  v_mfma_f32_16x16x32_bf16 v[128:131], v[64:67], v[92:95], v[128:131]
  ds_write_b64 v11, v[32:33] offset:6656
  v_pk_fma_f32 v[124:125], v[242:243], v[230:231], v[124:125] op_sel_hi:[1,0,1] neg_lo:[0,1,0] neg_hi:[0,1,0]
  v_pk_fma_f32 v[126:127], v[244:245], v[230:231], v[126:127] op_sel_hi:[1,0,1] neg_lo:[0,1,0] neg_hi:[0,1,0]
  v_pk_fma_f32 v[160:161], v[246:247], v[230:231], v[160:161] op_sel_hi:[1,0,1] neg_lo:[0,1,0] neg_hi:[0,1,0]
  v_pk_fma_f32 v[162:163], v[248:249], v[230:231], v[162:163] op_sel_hi:[1,0,1] neg_lo:[0,1,0] neg_hi:[0,1,0]
  v_pk_fma_f32 v[196:197], v[250:251], v[230:231], v[196:197] op_sel_hi:[1,0,1] neg_lo:[0,1,0] neg_hi:[0,1,0]
  v_pk_fma_f32 v[198:199], v[252:253], v[230:231], v[198:199] op_sel_hi:[1,0,1] neg_lo:[0,1,0] neg_hi:[0,1,0]
  v_mfma_f32_16x16x32_bf16 v[164:167], v[68:71], v[92:95], v[164:167]
  v_pk_mul_f32 v[124:125], v[124:125], v[230:231] op_sel:[0,1] op_sel_hi:[1,1]
  v_pk_mul_f32 v[126:127], v[126:127], v[230:231] op_sel:[0,1] op_sel_hi:[1,1]
  v_pk_mul_f32 v[160:161], v[160:161], v[230:231] op_sel:[0,1] op_sel_hi:[1,1]
  v_pk_mul_f32 v[162:163], v[162:163], v[230:231] op_sel:[0,1] op_sel_hi:[1,1]
  v_pk_mul_f32 v[196:197], v[196:197], v[230:231] op_sel:[0,1] op_sel_hi:[1,1]
  v_pk_mul_f32 v[198:199], v[198:199], v[230:231] op_sel:[0,1] op_sel_hi:[1,1]
  v_cvt_pk_bf16_f32 v34, v124, v125
  v_mfma_f32_16x16x32_bf16 v[200:203], v[72:75], v[92:95], v[200:203]
  v_cvt_pk_bf16_f32 v35, v126, v127
  ds_write_b64 v11, v[34:35] offset:9600
  v_cvt_pk_bf16_f32 v36, v160, v161
  v_cvt_pk_bf16_f32 v37, v162, v163
  ds_write_b64 v11, v[36:37] offset:9728
  v_cvt_pk_bf16_f32 v38, v196, v197
  v_cvt_pk_bf16_f32 v39, v198, v199
  v_mfma_f32_16x16x32_bf16 v[204:207], v[72:75], v[96:99], v[204:207]
  ds_write_b64 v11, v[38:39] offset:9856
  v_pk_fma_f32 v[128:129], v[242:243], v[232:233], v[128:129] op_sel_hi:[1,0,1] neg_lo:[0,1,0] neg_hi:[0,1,0]
  v_pk_fma_f32 v[130:131], v[244:245], v[232:233], v[130:131] op_sel_hi:[1,0,1] neg_lo:[0,1,0] neg_hi:[0,1,0]
  v_pk_fma_f32 v[164:165], v[246:247], v[232:233], v[164:165] op_sel_hi:[1,0,1] neg_lo:[0,1,0] neg_hi:[0,1,0]
  v_pk_fma_f32 v[166:167], v[248:249], v[232:233], v[166:167] op_sel_hi:[1,0,1] neg_lo:[0,1,0] neg_hi:[0,1,0]
  v_pk_fma_f32 v[200:201], v[250:251], v[232:233], v[200:201] op_sel_hi:[1,0,1] neg_lo:[0,1,0] neg_hi:[0,1,0]
  v_pk_fma_f32 v[202:203], v[252:253], v[232:233], v[202:203] op_sel_hi:[1,0,1] neg_lo:[0,1,0] neg_hi:[0,1,0]
  v_mfma_f32_16x16x32_bf16 v[168:171], v[68:71], v[96:99], v[168:171]
  v_pk_mul_f32 v[128:129], v[128:129], v[232:233] op_sel:[0,1] op_sel_hi:[1,1]
  v_pk_mul_f32 v[130:131], v[130:131], v[232:233] op_sel:[0,1] op_sel_hi:[1,1]
  v_pk_mul_f32 v[164:165], v[164:165], v[232:233] op_sel:[0,1] op_sel_hi:[1,1]
  v_pk_mul_f32 v[166:167], v[166:167], v[232:233] op_sel:[0,1] op_sel_hi:[1,1]
  v_pk_mul_f32 v[200:201], v[200:201], v[232:233] op_sel:[0,1] op_sel_hi:[1,1]
  v_pk_mul_f32 v[202:203], v[202:203], v[232:233] op_sel:[0,1] op_sel_hi:[1,1]
  v_cvt_pk_bf16_f32 v40, v128, v129
  v_mfma_f32_16x16x32_bf16 v[132:135], v[64:67], v[96:99], v[132:135]
  v_cvt_pk_bf16_f32 v41, v130, v131
  ds_write_b64 v11, v[40:41] offset:12800
  v_cvt_pk_bf16_f32 v42, v164, v165
  v_cvt_pk_bf16_f32 v43, v166, v167
  ds_write_b64 v11, v[42:43] offset:12928
  v_cvt_pk_bf16_f32 v44, v200, v201
  v_cvt_pk_bf16_f32 v45, v202, v203
  v_mfma_f32_16x16x32_bf16 v[136:139], v[64:67], v[100:103], v[136:139]
  ds_write_b64 v11, v[44:45] offset:13056
  v_pk_fma_f32 v[132:133], v[242:243], v[234:235], v[132:133] op_sel_hi:[1,0,1] neg_lo:[0,1,0] neg_hi:[0,1,0]
  v_pk_fma_f32 v[134:135], v[244:245], v[234:235], v[134:135] op_sel_hi:[1,0,1] neg_lo:[0,1,0] neg_hi:[0,1,0]
  v_pk_fma_f32 v[168:169], v[246:247], v[234:235], v[168:169] op_sel_hi:[1,0,1] neg_lo:[0,1,0] neg_hi:[0,1,0]
  v_pk_fma_f32 v[170:171], v[248:249], v[234:235], v[170:171] op_sel_hi:[1,0,1] neg_lo:[0,1,0] neg_hi:[0,1,0]
  v_pk_fma_f32 v[204:205], v[250:251], v[234:235], v[204:205] op_sel_hi:[1,0,1] neg_lo:[0,1,0] neg_hi:[0,1,0]
  v_pk_fma_f32 v[206:207], v[252:253], v[234:235], v[206:207] op_sel_hi:[1,0,1] neg_lo:[0,1,0] neg_hi:[0,1,0]
  v_mfma_f32_16x16x32_bf16 v[172:175], v[68:71], v[100:103], v[172:175]
  v_pk_mul_f32 v[132:133], v[132:133], v[234:235] op_sel:[0,1] op_sel_hi:[1,1]
  v_pk_mul_f32 v[134:135], v[134:135], v[234:235] op_sel:[0,1] op_sel_hi:[1,1]
  v_pk_mul_f32 v[168:169], v[168:169], v[234:235] op_sel:[0,1] op_sel_hi:[1,1]
  v_pk_mul_f32 v[170:171], v[170:171], v[234:235] op_sel:[0,1] op_sel_hi:[1,1]
  v_pk_mul_f32 v[204:205], v[204:205], v[234:235] op_sel:[0,1] op_sel_hi:[1,1]
  v_pk_mul_f32 v[206:207], v[206:207], v[234:235] op_sel:[0,1] op_sel_hi:[1,1]
  v_cvt_pk_bf16_f32 v46, v132, v133
  v_mfma_f32_16x16x32_bf16 v[208:211], v[72:75], v[100:103], v[208:211]
  v_cvt_pk_bf16_f32 v47, v134, v135
  ds_write_b64 v11, v[46:47] offset:16000
  v_cvt_pk_bf16_f32 v48, v168, v169
  v_cvt_pk_bf16_f32 v49, v170, v171
  ds_write_b64 v11, v[48:49] offset:16128
  v_cvt_pk_bf16_f32 v50, v204, v205
  v_cvt_pk_bf16_f32 v51, v206, v207
  v_mfma_f32_16x16x32_bf16 v[212:215], v[72:75], v[104:107], v[212:215]
  ds_write_b64 v11, v[50:51] offset:16256
  v_pk_fma_f32 v[136:137], v[242:243], v[236:237], v[136:137] op_sel_hi:[1,0,1] neg_lo:[0,1,0] neg_hi:[0,1,0]
  v_pk_fma_f32 v[138:139], v[244:245], v[236:237], v[138:139] op_sel_hi:[1,0,1] neg_lo:[0,1,0] neg_hi:[0,1,0]
  v_pk_fma_f32 v[172:173], v[246:247], v[236:237], v[172:173] op_sel_hi:[1,0,1] neg_lo:[0,1,0] neg_hi:[0,1,0]
  v_pk_fma_f32 v[174:175], v[248:249], v[236:237], v[174:175] op_sel_hi:[1,0,1] neg_lo:[0,1,0] neg_hi:[0,1,0]
  v_pk_fma_f32 v[208:209], v[250:251], v[236:237], v[208:209] op_sel_hi:[1,0,1] neg_lo:[0,1,0] neg_hi:[0,1,0]
  v_pk_fma_f32 v[210:211], v[252:253], v[236:237], v[210:211] op_sel_hi:[1,0,1] neg_lo:[0,1,0] neg_hi:[0,1,0]
  v_mfma_f32_16x16x32_bf16 v[176:179], v[68:71], v[104:107], v[176:179]
  v_pk_mul_f32 v[136:137], v[136:137], v[236:237] op_sel:[0,1] op_sel_hi:[1,1]
  v_pk_mul_f32 v[138:139], v[138:139], v[236:237] op_sel:[0,1] op_sel_hi:[1,1]
  v_pk_mul_f32 v[172:173], v[172:173], v[236:237] op_sel:[0,1] op_sel_hi:[1,1]
  v_pk_mul_f32 v[174:175], v[174:175], v[236:237] op_sel:[0,1] op_sel_hi:[1,1]
  v_pk_mul_f32 v[208:209], v[208:209], v[236:237] op_sel:[0,1] op_sel_hi:[1,1]
  v_pk_mul_f32 v[210:211], v[210:211], v[236:237] op_sel:[0,1] op_sel_hi:[1,1]
  v_cvt_pk_bf16_f32 v52, v136, v137
  v_mfma_f32_16x16x32_bf16 v[140:143], v[64:67], v[104:107], v[140:143]
  v_cvt_pk_bf16_f32 v53, v138, v139
  ds_write_b64 v11, v[52:53] offset:19200
  v_cvt_pk_bf16_f32 v54, v172, v173
  v_cvt_pk_bf16_f32 v55, v174, v175
  ds_write_b64 v11, v[54:55] offset:19328
  v_cvt_pk_bf16_f32 v56, v208, v209
  v_cvt_pk_bf16_f32 v57, v210, v211
  v_mfma_f32_16x16x32_bf16 v[144:147], v[64:67], v[108:111], v[144:147]
  ds_write_b64 v11, v[56:57] offset:19456
  v_pk_fma_f32 v[140:141], v[242:243], v[238:239], v[140:141] op_sel_hi:[1,0,1] neg_lo:[0,1,0] neg_hi:[0,1,0]
  v_pk_fma_f32 v[142:143], v[244:245], v[238:239], v[142:143] op_sel_hi:[1,0,1] neg_lo:[0,1,0] neg_hi:[0,1,0]
  v_pk_fma_f32 v[176:177], v[246:247], v[238:239], v[176:177] op_sel_hi:[1,0,1] neg_lo:[0,1,0] neg_hi:[0,1,0]
  v_pk_fma_f32 v[178:179], v[248:249], v[238:239], v[178:179] op_sel_hi:[1,0,1] neg_lo:[0,1,0] neg_hi:[0,1,0]
  v_pk_fma_f32 v[212:213], v[250:251], v[238:239], v[212:213] op_sel_hi:[1,0,1] neg_lo:[0,1,0] neg_hi:[0,1,0]
  v_pk_fma_f32 v[214:215], v[252:253], v[238:239], v[214:215] op_sel_hi:[1,0,1] neg_lo:[0,1,0] neg_hi:[0,1,0]
  v_mfma_f32_16x16x32_bf16 v[180:183], v[68:71], v[108:111], v[180:183]
  v_pk_mul_f32 v[140:141], v[140:141], v[238:239] op_sel:[0,1] op_sel_hi:[1,1]
  v_pk_mul_f32 v[142:143], v[142:143], v[238:239] op_sel:[0,1] op_sel_hi:[1,1]
  v_pk_mul_f32 v[176:177], v[176:177], v[238:239] op_sel:[0,1] op_sel_hi:[1,1]
  v_pk_mul_f32 v[178:179], v[178:179], v[238:239] op_sel:[0,1] op_sel_hi:[1,1]
  v_pk_mul_f32 v[212:213], v[212:213], v[238:239] op_sel:[0,1] op_sel_hi:[1,1]
  v_pk_mul_f32 v[214:215], v[214:215], v[238:239] op_sel:[0,1] op_sel_hi:[1,1]
  v_cvt_pk_bf16_f32 v58, v140, v141
  v_mfma_f32_16x16x32_bf16 v[216:219], v[72:75], v[108:111], v[216:219]
  v_cvt_pk_bf16_f32 v59, v142, v143
  ds_write_b64 v11, v[58:59] offset:22400
  v_cvt_pk_bf16_f32 v60, v176, v177
  v_cvt_pk_bf16_f32 v61, v178, v179
  ds_write_b64 v11, v[60:61] offset:22528
  v_cvt_pk_bf16_f32 v62, v212, v213
  v_cvt_pk_bf16_f32 v63, v214, v215
  s_barrier
  ds_write_b64 v11, v[62:63] offset:22656
  v_pk_fma_f32 v[144:145], v[242:243], v[240:241], v[144:145] op_sel_hi:[1,0,1] neg_lo:[0,1,0] neg_hi:[0,1,0]
  v_pk_fma_f32 v[146:147], v[244:245], v[240:241], v[146:147] op_sel_hi:[1,0,1] neg_lo:[0,1,0] neg_hi:[0,1,0]
  v_pk_fma_f32 v[180:181], v[246:247], v[240:241], v[180:181] op_sel_hi:[1,0,1] neg_lo:[0,1,0] neg_hi:[0,1,0]
  v_pk_fma_f32 v[182:183], v[248:249], v[240:241], v[182:183] op_sel_hi:[1,0,1] neg_lo:[0,1,0] neg_hi:[0,1,0]
  v_pk_fma_f32 v[216:217], v[250:251], v[240:241], v[216:217] op_sel_hi:[1,0,1] neg_lo:[0,1,0] neg_hi:[0,1,0]
  v_pk_fma_f32 v[218:219], v[252:253], v[240:241], v[218:219] op_sel_hi:[1,0,1] neg_lo:[0,1,0] neg_hi:[0,1,0]
  v_pk_mul_f32 v[144:145], v[144:145], v[240:241] op_sel:[0,1] op_sel_hi:[1,1]
  v_pk_mul_f32 v[146:147], v[146:147], v[240:241] op_sel:[0,1] op_sel_hi:[1,1]
  v_pk_mul_f32 v[180:181], v[180:181], v[240:241] op_sel:[0,1] op_sel_hi:[1,1]
  v_pk_mul_f32 v[182:183], v[182:183], v[240:241] op_sel:[0,1] op_sel_hi:[1,1]
  v_pk_mul_f32 v[216:217], v[216:217], v[240:241] op_sel:[0,1] op_sel_hi:[1,1]
  v_pk_mul_f32 v[218:219], v[218:219], v[240:241] op_sel:[0,1] op_sel_hi:[1,1]
  v_cvt_pk_bf16_f32 v16, v144, v145
  v_cvt_pk_bf16_f32 v17, v146, v147
  ds_write_b64 v11, v[16:17] offset:25600
  v_cvt_pk_bf16_f32 v18, v180, v181
  v_cvt_pk_bf16_f32 v19, v182, v183
  ds_write_b64 v11, v[18:19] offset:25728
  v_cvt_pk_bf16_f32 v20, v216, v217
  v_cvt_pk_bf16_f32 v21, v218, v219
  ds_write_b64 v11, v[20:21] offset:25856
attn:
  s_nop 7
  s_nop 7
  v_mov_b32 v18, 0x3e8293ee
  v_mov_b32 v19, 0xff800000
  s_mov_b32 s20, s82
  s_mov_b32 s21, s83
  s_mov_b32 s22, 8388608
  s_mov_b32 s23, 0x20000
  s_mov_b32 s49, 4096
  s_waitcnt lgkmcnt(0)
  s_barrier
  ds_read_b128 v[32:35], v223 offset:0
  ds_read_b128 v[36:39], v220 offset:0
  ds_read_b128 v[40:43], v221 offset:0
  ds_read_b128 v[80:83], v223 offset:64
  ds_read_b128 v[84:87], v220 offset:64
  ds_read_b128 v[88:91], v221 offset:64
  ds_read_b64_tr_b16 v[44:45], v222 offset:0
  ds_read_b64_tr_b16 v[46:47], v254 offset:0
  ds_read_b64_tr_b16 v[48:49], v222 offset:8
  ds_read_b64_tr_b16 v[50:51], v254 offset:8
  ds_read_b64_tr_b16 v[92:93], v222 offset:64
  ds_read_b64_tr_b16 v[94:95], v254 offset:64
  ds_read_b64_tr_b16 v[96:97], v222 offset:72
  ds_read_b64_tr_b16 v[98:99], v254 offset:72
  s_waitcnt lgkmcnt(11)
  v_mfma_f32_16x16x32_bf16 v[52:55], v[36:39], v[32:35], 0
  v_mfma_f32_16x16x32_bf16 v[56:59], v[40:43], v[32:35], 0
  s_waitcnt lgkmcnt(8)
  v_mfma_f32_16x16x32_bf16 v[100:103], v[84:87], v[80:83], 0
  v_mfma_f32_16x16x32_bf16 v[104:107], v[88:91], v[80:83], 0
  s_nop 3
  v_cndmask_b32 v52, v19, v52, s[86:87]
  s_nop 1
  v_cndmask_b32 v100, v19, v100, s[86:87]
  v_cndmask_b32 v53, v19, v53, s[88:89]
  v_cndmask_b32 v101, v19, v101, s[88:89]
  v_cndmask_b32 v54, v19, v54, s[90:91]
  v_cndmask_b32 v102, v19, v102, s[90:91]
  v_cndmask_b32 v55, v19, v55, s[92:93]
  v_cndmask_b32 v103, v19, v103, s[92:93]
  v_cndmask_b32 v56, v19, v56, s[94:95]
  v_cndmask_b32 v104, v19, v104, s[94:95]
  v_cndmask_b32 v57, v19, v57, s[96:97]
  v_cndmask_b32 v105, v19, v105, s[96:97]
  v_cndmask_b32 v58, v19, v58, s[98:99]
  v_cndmask_b32 v106, v19, v106, s[98:99]
  v_cndmask_b32 v59, v19, v59, s[100:101]
  v_cndmask_b32 v107, v19, v107, s[100:101]
  v_max3_f32 v60, v52, v53, v54
  v_max3_f32 v108, v100, v101, v102
  v_max3_f32 v61, v55, v56, v57
  v_max3_f32 v109, v103, v104, v105
  v_max3_f32 v60, v60, v58, v59
  v_max3_f32 v108, v108, v106, v107
  v_max_f32 v60, v60, v61
  v_max_f32 v108, v108, v109
  v_mov_b32 v61, v60
  v_mov_b32 v109, v108
  s_nop 0
  v_permlane16_swap_b32 v60, v61
  v_permlane16_swap_b32 v108, v109
  v_max_f32 v60, v60, v61
  v_max_f32 v108, v108, v109
  v_mov_b32 v61, v60
  v_mov_b32 v109, v108
  s_nop 0
  v_permlane32_swap_b32 v60, v61
  v_permlane32_swap_b32 v108, v109
  v_max_f32 v60, v60, v61
  v_max_f32 v108, v108, v109
  v_mul_f32 v60, v18, v60
  v_mul_f32 v108, v18, v108
  v_fma_f32 v52, v52, v18, -v60
  v_fma_f32 v100, v100, v18, -v108
  v_fma_f32 v53, v53, v18, -v60
  v_fma_f32 v101, v101, v18, -v108
  v_fma_f32 v54, v54, v18, -v60
  v_fma_f32 v102, v102, v18, -v108
  v_fma_f32 v55, v55, v18, -v60
  v_fma_f32 v103, v103, v18, -v108
  v_fma_f32 v56, v56, v18, -v60
  v_fma_f32 v104, v104, v18, -v108
  v_fma_f32 v57, v57, v18, -v60
  v_fma_f32 v105, v105, v18, -v108
  v_fma_f32 v58, v58, v18, -v60
  v_fma_f32 v106, v106, v18, -v108
  v_fma_f32 v59, v59, v18, -v60
  v_fma_f32 v107, v107, v18, -v108
  v_exp_f32 v52, v52
  v_exp_f32 v100, v100
  v_exp_f32 v53, v53
  v_exp_f32 v101, v101
  v_exp_f32 v54, v54
  v_exp_f32 v102, v102
  v_exp_f32 v55, v55
  v_exp_f32 v103, v103
  v_exp_f32 v56, v56
  v_exp_f32 v104, v104
  v_exp_f32 v57, v57
  v_exp_f32 v105, v105
  v_exp_f32 v58, v58
  v_exp_f32 v106, v106
  v_exp_f32 v59, v59
  v_exp_f32 v107, v107
  v_pk_add_f32 v[60:61], v[52:53], v[54:55]
  v_pk_add_f32 v[108:109], v[100:101], v[102:103]
  v_pk_add_f32 v[62:63], v[56:57], v[58:59]
  v_pk_add_f32 v[110:111], v[104:105], v[106:107]
  v_pk_add_f32 v[60:61], v[60:61], v[62:63]
  v_pk_add_f32 v[108:109], v[108:109], v[110:111]
  v_add_f32 v60, v60, v61
  v_add_f32 v108, v108, v109
  v_mov_b32 v61, v60
  v_mov_b32 v109, v108
  s_nop 0
  v_permlane16_swap_b32 v60, v61
  v_permlane16_swap_b32 v108, v109
  v_add_f32 v60, v60, v61
  v_add_f32 v108, v108, v109
  v_mov_b32 v61, v60
  v_mov_b32 v109, v108
  s_nop 0
  v_permlane32_swap_b32 v60, v61
  v_permlane32_swap_b32 v108, v109
  v_add_f32 v60, v60, v61
  v_add_f32 v108, v108, v109
  v_rcp_f32 v60, v60
  v_rcp_f32 v108, v108
  v_pk_mul_f32 v[52:53], v[52:53], v[60:61] op_sel_hi:[1,0]
  v_pk_mul_f32 v[100:101], v[100:101], v[108:109] op_sel_hi:[1,0]
  v_pk_mul_f32 v[54:55], v[54:55], v[60:61] op_sel_hi:[1,0]
  v_pk_mul_f32 v[102:103], v[102:103], v[108:109] op_sel_hi:[1,0]
  v_pk_mul_f32 v[56:57], v[56:57], v[60:61] op_sel_hi:[1,0]
  v_pk_mul_f32 v[104:105], v[104:105], v[108:109] op_sel_hi:[1,0]
  v_pk_mul_f32 v[58:59], v[58:59], v[60:61] op_sel_hi:[1,0]
  v_pk_mul_f32 v[106:107], v[106:107], v[108:109] op_sel_hi:[1,0]
  v_cvt_pk_bf16_f32 v64, v52, v53
  v_cvt_pk_bf16_f32 v112, v100, v101
  v_cvt_pk_bf16_f32 v65, v54, v55
  v_cvt_pk_bf16_f32 v113, v102, v103
  v_cvt_pk_bf16_f32 v66, v56, v57
  v_cvt_pk_bf16_f32 v114, v104, v105
  v_cvt_pk_bf16_f32 v67, v58, v59
  v_cvt_pk_bf16_f32 v115, v106, v107
  s_waitcnt lgkmcnt(0)
  v_mfma_f32_16x16x32_bf16 v[68:71], v[44:47], v[64:67], 0
  v_mfma_f32_16x16x32_bf16 v[116:119], v[92:95], v[112:115], 0
  v_mfma_f32_16x16x32_bf16 v[72:75], v[48:51], v[64:67], 0
  v_mfma_f32_16x16x32_bf16 v[120:123], v[96:99], v[112:115], 0
  s_nop 4
  v_cvt_pk_bf16_f32 v32, v68, v69
  v_cvt_pk_bf16_f32 v80, v116, v117
  v_cvt_pk_bf16_f32 v33, v70, v71
  v_cvt_pk_bf16_f32 v81, v118, v119
  v_cvt_pk_bf16_f32 v34, v72, v73
  v_cvt_pk_bf16_f32 v82, v120, v121
  v_cvt_pk_bf16_f32 v35, v74, v75
  v_cvt_pk_bf16_f32 v83, v122, v123
  buffer_store_dwordx4 v[32:35], v1, s[20:23], 0 offen sc0 sc1
  buffer_store_dwordx4 v[80:83], v1, s[20:23], s49 offen sc0 sc1
  s_cmp_ge_u32 s4, 4
  s_cbranch_scc1 L_k1done
  s_lshl_b32 s32, s28, 2
  s_add_u32 s32, s32, s4
  s_lshl_b32 s34, s32, 17
  s_lshl_b32 s40, s32, 5
  s_lshl_b32 s52, s32, 8
  v_lshlrev_b32 v13, 1, v4
  v_add_u32 v13, s40, v13
  v_lshlrev_b32 v12, 11, v13
  v_lshl_add_u32 v12, v3, 4, v12
  s_lshl_b32 s32, s29, 7
  v_add_u32 v12, s32, v12
  v_lshlrev_b32 v14, 4, v0
  v_lshlrev_b32 v87, 8, v13
  v_lshl_add_u32 v87, v3, 4, v87
  s_lshl_b32 s32, s29, 19
  v_add_u32 v87, s32, v87
  s_mov_b32 s8, s82
  s_mov_b32 s9, s83
  s_mov_b32 s10, 8388608
  s_mov_b32 s11, 0x20000
  s_cmp_eq_u32 s3, 0
  s_cselect_b32 s16, s64, s84
  s_cselect_b32 s17, s65, s85
  s_cselect_b32 s18, 0, 100663296
  s_add_u32 s16, s16, s18
  s_addc_u32 s17, s17, 0
  s_mov_b32 s18, 4194304
  s_mov_b32 s19, 0x20000
  s_lshl_b32 s18, s18, s3
  s_cmp_eq_u32 s3, 0
  s_cselect_b32 s12, s84, s84
  s_cselect_b32 s13, s85, s85
  s_cselect_b32 s14, 0, 50331648
  s_add_u32 s12, s12, s14
  s_addc_u32 s13, s13, 0
  s_mov_b32 s14, 0
  s_mov_b32 s15, 0x20000
  s_add_u32 s12, s12, 41943040
  s_addc_u32 s13, s13, 0
  s_mov_b32 s14, 524288
  v_lshl_add_u32 v16, v5, 3, v6
  v_lshlrev_b32 v16, 7, v16
  v_lshl_add_u32 v16, v7, 3, v16
  v_lshrrev_b32 v17, 1, v6
  v_lshl_or_b32 v17, v2, 1, v17
  v_lshl_add_u32 v16, v17, 5, v16
  v_add_u32 v16, 131072, v16
  v_xor_b32 v8, 0, v16
  v_xor_b32 v9, 32, v16
  v_xor_b32 v10, 64, v16
  v_xor_b32 v11, 96, v16
  v_lshl_add_u32 v16, v4, 1, v2
  v_lshlrev_b32 v16, 3, v16
  v_add_u32 v16, s52, v16
  s_mul_i32 s32, s29, 16384
  v_add_u32 v112, s32, v16
  v_lshrrev_b32 v17, 5, v0
  v_mul_u32_u24 v17, 131072, v17
  v_add_u32 v113, v16, v17
  s_lshl_b32 s32, s4, 12
  v_lshlrev_b32 v16, 8, v4
  v_lshl_add_u32 v16, v5, 3, v16
  v_add_u32 v16, s32, v16
  v_and_b32 v17, 1, v4
  v_bfe_u32 v18, v4, 2, 1
  v_lshl_or_b32 v17, v18, 1, v17
  v_lshl_add_u32 v114, v17, 5, v16
  s_lshl_b32 s44, s29, 8
  s_lshl_b32 s40, s28, 2
  s_add_u32 s44, s44, s40
  s_add_u32 s44, s44, s4
  s_lshl_b32 s44, s44, 11
  v_lshl_add_u32 v16, v5, 3, v6
  v_lshlrev_b32 v16, 7, v16
  v_lshl_add_u32 v16, v7, 3, v16
  v_lshrrev_b32 v17, 1, v6
  v_lshl_or_b32 v17, v2, 1, v17
  v_lshl_add_u32 v16, v17, 5, v16
  v_xor_b32 v115, 0, v16
  v_add_u32 v115, s32, v115
  s_add_u32 s45, s44, 131072
  s_add_u32 s46, s44, 262144
  s_add_u32 s47, s44, 393216
  v_add_u32 v80, 16384, v113
  v_add_u32 v81, 32768, v113
  v_add_u32 v82, 49152, v113
  v_add_u32 v83, 65536, v113
  v_add_u32 v84, 81920, v113
  v_add_u32 v85, 98304, v113
  v_add_u32 v86, 114688, v113
  s_lshl_b32 s48, 0x303, s7
  s_lshr_b32 s48, s48, 8
  s_mov_b32 s49, s34
  s_add_u32 s50, s34, 65536
  s_add_u32 s41, s34, 131072
  s_and_b32 s40, s4, 1
  s_lshl_b32 s32, s40, 1
  s_add_u32 s32, s32, 0
  s_cmp_eq_u32 s32, 3
  s_addc_u32 s32, s32, 5
  s_lshl_b32 s32, s32, 7
  s_mov_b32 vcc_lo, 0xff000000
  s_mov_b32 vcc_hi, 0
  v_mov_b32 v88, s32
  v_cndmask_b32 v88, 0, v88, vcc
  v_lshl_add_u32 v88, v0, 4, v88
  v_add_u32 v90, 4096, v88
  s_lshl_b32 s32, s40, 1
  s_add_u32 s32, s32, 1
  s_cmp_eq_u32 s32, 3
  s_addc_u32 s32, s32, 5
  s_lshl_b32 s32, s32, 7
  s_mov_b32 vcc_lo, 0xff000000
  s_mov_b32 vcc_hi, 0
  v_mov_b32 v89, s32
  v_cndmask_b32 v89, 0, v89, vcc
  v_lshl_add_u32 v89, v0, 4, v89
  v_add_u32 v89, 2048, v89
  v_add_u32 v91, 4096, v89
  s_lshl_b32 s32, s40, 1
  s_add_u32 s32, s32, 0
  s_cmp_eq_u32 s32, 3
  s_addc_u32 s32, s32, 5
  s_lshl_b32 s32, s32, 7
  s_mov_b32 vcc_lo, 0xff000000
  s_mov_b32 vcc_hi, 0
  v_mov_b32 v92, s32
  v_cndmask_b32 v92, 0, v92, vcc
  v_lshl_add_u32 v92, v0, 4, v92
  s_lshl_b32 s32, s40, 1
  s_add_u32 s32, s32, 1
  s_cmp_eq_u32 s32, 3
  s_addc_u32 s32, s32, 5
  s_lshl_b32 s32, s32, 7
  s_mov_b32 vcc_lo, 0xff000000
  s_mov_b32 vcc_hi, 0
  v_mov_b32 v93, s32
  v_cndmask_b32 v93, 0, v93, vcc
  v_lshl_add_u32 v93, v0, 4, v93
  s_lshl_b32 s32, 0, 1
  s_add_u32 s32, s32, 0
  s_cmp_eq_u32 s32, 3
  s_addc_u32 s32, s32, 5
  s_lshl_b32 s32, s32, 7
  s_mov_b32 vcc_lo, 0xff000000
  s_mov_b32 vcc_hi, 0
  v_mov_b32 v192, s32
  v_cndmask_b32 v192, 0, v192, vcc
  v_lshl_add_u32 v192, v0, 4, v192
  s_lshl_b32 s32, 0, 1
  s_add_u32 s32, s32, 1
  s_cmp_eq_u32 s32, 3
  s_addc_u32 s32, s32, 5
  s_lshl_b32 s32, s32, 7
  s_mov_b32 vcc_lo, 0xff000000
  s_mov_b32 vcc_hi, 0
  v_mov_b32 v193, s32
  v_cndmask_b32 v193, 0, v193, vcc
  v_lshl_add_u32 v193, v0, 4, v193
  v_add_u32 v193, 2048, v193
  s_lshl_b32 s32, 1, 1
  s_add_u32 s32, s32, 0
  s_cmp_eq_u32 s32, 3
  s_addc_u32 s32, s32, 5
  s_lshl_b32 s32, s32, 7
  s_mov_b32 vcc_lo, 0xff000000
  s_mov_b32 vcc_hi, 0
  v_mov_b32 v194, s32
  v_cndmask_b32 v194, 0, v194, vcc
  v_lshl_add_u32 v194, v0, 4, v194
  v_add_u32 v194, 4096, v194
  s_lshl_b32 s32, 1, 1
  s_add_u32 s32, s32, 1
  s_cmp_eq_u32 s32, 3
  s_addc_u32 s32, s32, 5
  s_lshl_b32 s32, s32, 7
  s_mov_b32 vcc_lo, 0xff000000
  s_mov_b32 vcc_hi, 0
  v_mov_b32 v195, s32
  v_cndmask_b32 v195, 0, v195, vcc
  v_lshl_add_u32 v195, v0, 4, v195
  v_add_u32 v195, 6144, v195
  s_lshl_b32 s53, s29, 13
  s_add_u32 s53, s53, s34
  s_add_u32 s24, s84, 109051904
  s_addc_u32 s25, s85, 0
  s_mov_b32 s26, 524288
  s_mov_b32 s27, 0x20000
  v_min_u32 v119, 15, v0
  s_lshl_b32 s32, s28, 4
  v_add_u32 v119, s32, v119
  v_max_i32 v119, 0, v119
  v_lshlrev_b32 v119, 7, v119
  s_lshl_b32 s55, s3, 17
  s_add_u32 s55, s55, 0
  s_waitcnt vmcnt(0)
  s_barrier
  s_cmp_lg_u32 s3, 0
  s_cbranch_scc1 C_r1
  buffer_load_dwordx4 v[96:99], v12, s[16:19], 0 offen offset:0
  buffer_load_dwordx4 v[100:103], v12, s[16:19], 0 offen offset:64
  buffer_load_dwordx4 v[104:107], v12, s[16:19], 0 offen offset:2048
  buffer_load_dwordx4 v[108:111], v12, s[16:19], 0 offen offset:2112
  s_branch C_r2
C_r1:
  buffer_load_dwordx4 v[96:99], v87, s[16:19], 0 offen offset:0 sc1
  buffer_load_dwordx4 v[100:103], v87, s[16:19], 0 offen offset:64 sc1
  buffer_load_dwordx4 v[104:107], v87, s[16:19], 0 offen offset:256 sc1
  buffer_load_dwordx4 v[108:111], v87, s[16:19], 0 offen offset:320 sc1
C_r2:
  s_mov_b32 s39, 0
  s_and_b32 s32, s4, 3
  s_cmp_lg_u32 s32, 0
  s_cbranch_scc1 poll3d
  s_sleep 8
poll3:
  buffer_load_dword v16, v119, s[24:27], s55 offen sc0 sc1
  s_waitcnt vmcnt(0)
  v_cmp_eq_u32 vcc, 0, v16
  s_add_u32 s39, s39, 1
  s_cmp_gt_u32 s39, 1000000
  s_cbranch_scc1 poll3d
  s_cbranch_vccnz poll3
poll3d:
  s_barrier
  s_bitcmp1_b32 s48, 0
  s_cselect_b32 s36, s50, s49
  s_add_u32 s36, s36, 0
  buffer_load_dwordx4 v[120:123], v88, s[8:11], s36 offen sc1
  buffer_load_dwordx4 v[124:127], v89, s[8:11], s36 offen sc1
  buffer_load_dwordx4 v[128:131], v90, s[8:11], s36 offen sc1
  buffer_load_dwordx4 v[132:135], v91, s[8:11], s36 offen sc1
  s_bitcmp1_b32 s48, 1
  s_cselect_b32 s36, s50, s49
  s_add_u32 s36, s36, 8192
  buffer_load_dwordx4 v[136:139], v88, s[8:11], s36 offen sc1
  buffer_load_dwordx4 v[140:143], v89, s[8:11], s36 offen sc1
  buffer_load_dwordx4 v[144:147], v90, s[8:11], s36 offen sc1
  buffer_load_dwordx4 v[148:151], v91, s[8:11], s36 offen sc1
  s_bitcmp1_b32 s48, 2
  s_cselect_b32 s36, s50, s49
  s_add_u32 s36, s36, 16384
  buffer_load_dwordx4 v[152:155], v88, s[8:11], s36 offen sc1
  buffer_load_dwordx4 v[156:159], v89, s[8:11], s36 offen sc1
  buffer_load_dwordx4 v[160:163], v90, s[8:11], s36 offen sc1
  buffer_load_dwordx4 v[164:167], v91, s[8:11], s36 offen sc1
  s_bitcmp1_b32 s48, 3
  s_cselect_b32 s36, s50, s49
  s_add_u32 s36, s36, 24576
  buffer_load_dwordx4 v[168:171], v88, s[8:11], s36 offen sc1
  buffer_load_dwordx4 v[172:175], v89, s[8:11], s36 offen sc1
  s_waitcnt vmcnt(14)
  v_permlane16_swap_b32 v96, v98
  v_permlane16_swap_b32 v97, v99
  v_permlane16_swap_b32 v100, v102
  v_permlane16_swap_b32 v101, v103
  v_permlane16_swap_b32 v104, v106
  v_permlane16_swap_b32 v105, v107
  v_permlane16_swap_b32 v108, v110
  v_permlane16_swap_b32 v109, v111
  v_lshlrev_b32 v48, 16, v96
  v_and_b32 v49, 0xffff0000, v96
  v_lshlrev_b32 v50, 16, v97
  v_and_b32 v51, 0xffff0000, v97
  v_lshlrev_b32 v52, 16, v98
  v_and_b32 v53, 0xffff0000, v98
  v_lshlrev_b32 v54, 16, v99
  v_and_b32 v55, 0xffff0000, v99
  v_lshlrev_b32 v56, 16, v100
  v_and_b32 v57, 0xffff0000, v100
  v_lshlrev_b32 v58, 16, v101
  v_and_b32 v59, 0xffff0000, v101
  v_lshlrev_b32 v60, 16, v102
  v_and_b32 v61, 0xffff0000, v102
  v_lshlrev_b32 v62, 16, v103
  v_and_b32 v63, 0xffff0000, v103
  v_lshlrev_b32 v64, 16, v104
  v_and_b32 v65, 0xffff0000, v104
  v_lshlrev_b32 v66, 16, v105
  v_and_b32 v67, 0xffff0000, v105
  v_lshlrev_b32 v68, 16, v106
  v_and_b32 v69, 0xffff0000, v106
  v_lshlrev_b32 v70, 16, v107
  v_and_b32 v71, 0xffff0000, v107
  v_lshlrev_b32 v72, 16, v108
  v_and_b32 v73, 0xffff0000, v108
  v_lshlrev_b32 v74, 16, v109
  v_and_b32 v75, 0xffff0000, v109
  v_lshlrev_b32 v76, 16, v110
  v_and_b32 v77, 0xffff0000, v110
  v_lshlrev_b32 v78, 16, v111
  v_and_b32 v79, 0xffff0000, v111
  s_mov_b32 s43, 0
  s_mov_b32 s39, 1
  s_barrier
  ds_read_b64_tr_b16 v[16:17], v8 offset:0
  ds_read_b64_tr_b16 v[18:19], v8 offset:512
  ds_read_b64_tr_b16 v[20:21], v9 offset:0
  ds_read_b64_tr_b16 v[22:23], v9 offset:512
  ds_read_b64_tr_b16 v[24:25], v10 offset:0
  ds_read_b64_tr_b16 v[26:27], v10 offset:512
  ds_read_b64_tr_b16 v[28:29], v11 offset:0
  ds_read_b64_tr_b16 v[30:31], v11 offset:512
  s_waitcnt vmcnt(13) lgkmcnt(6)
  v_mfma_f32_16x16x32_bf16 v[48:51], v[16:19], v[120:123], v[48:51]
  ds_read_b64_tr_b16 v[32:33], v8 offset:4096
  s_waitcnt vmcnt(12)
  v_mfma_f32_16x16x32_bf16 v[64:67], v[16:19], v[124:127], v[64:67]
  ds_read_b64_tr_b16 v[34:35], v8 offset:4608
  v_add_u32 v8, 8192, v8
  s_waitcnt lgkmcnt(6)
  v_mfma_f32_16x16x32_bf16 v[68:71], v[20:23], v[124:127], v[68:71]
  ds_read_b64_tr_b16 v[36:37], v9 offset:4096
  buffer_load_dwordx4 v[176:179], v90, s[8:11], s36 offen sc1
  v_mfma_f32_16x16x32_bf16 v[52:55], v[20:23], v[120:123], v[52:55]
  ds_read_b64_tr_b16 v[38:39], v9 offset:4608
  v_add_u32 v9, 8192, v9
  s_waitcnt lgkmcnt(6)
  v_mfma_f32_16x16x32_bf16 v[56:59], v[24:27], v[120:123], v[56:59]
  ds_read_b64_tr_b16 v[40:41], v10 offset:4096
  v_mfma_f32_16x16x32_bf16 v[72:75], v[24:27], v[124:127], v[72:75]
  ds_read_b64_tr_b16 v[42:43], v10 offset:4608
  v_add_u32 v10, 8192, v10
  s_waitcnt lgkmcnt(6)
  v_mfma_f32_16x16x32_bf16 v[76:79], v[28:31], v[124:127], v[76:79]
  ds_read_b64_tr_b16 v[44:45], v11 offset:4096
  buffer_load_dwordx4 v[180:183], v91, s[8:11], s36 offen sc1
  v_mfma_f32_16x16x32_bf16 v[60:63], v[28:31], v[120:123], v[60:63]
  ds_read_b64_tr_b16 v[46:47], v11 offset:4608
  v_add_u32 v11, 8192, v11
  s_waitcnt vmcnt(13) lgkmcnt(6)
  v_mfma_f32_16x16x32_bf16 v[48:51], v[32:35], v[128:131], v[48:51]
  ds_read_b64_tr_b16 v[16:17], v8 offset:0
  s_bitcmp1_b32 s48, 4
  s_cselect_b32 s36, s50, s49
  s_waitcnt vmcnt(12)
  v_mfma_f32_16x16x32_bf16 v[64:67], v[32:35], v[132:135], v[64:67]
  ds_read_b64_tr_b16 v[18:19], v8 offset:512
  s_add_u32 s36, s36, 32768
  s_waitcnt lgkmcnt(6)
  v_mfma_f32_16x16x32_bf16 v[68:71], v[36:39], v[132:135], v[68:71]
  ds_read_b64_tr_b16 v[20:21], v9 offset:0
  v_mfma_f32_16x16x32_bf16 v[52:55], v[36:39], v[128:131], v[52:55]
  ds_read_b64_tr_b16 v[22:23], v9 offset:512
  s_waitcnt lgkmcnt(6)
  v_mfma_f32_16x16x32_bf16 v[56:59], v[40:43], v[128:131], v[56:59]
  ds_read_b64_tr_b16 v[24:25], v10 offset:0
  buffer_load_dwordx4 v[120:123], v88, s[8:11], s36 offen sc1
  v_mfma_f32_16x16x32_bf16 v[72:75], v[40:43], v[132:135], v[72:75]
  ds_read_b64_tr_b16 v[26:27], v10 offset:512
  s_waitcnt lgkmcnt(6)
  v_mfma_f32_16x16x32_bf16 v[76:79], v[44:47], v[132:135], v[76:79]
  ds_read_b64_tr_b16 v[28:29], v11 offset:0
  v_mfma_f32_16x16x32_bf16 v[60:63], v[44:47], v[128:131], v[60:63]
  ds_read_b64_tr_b16 v[30:31], v11 offset:512
  buffer_load_dwordx4 v[124:127], v89, s[8:11], s36 offen sc1
  s_waitcnt vmcnt(13) lgkmcnt(6)
  v_mfma_f32_16x16x32_bf16 v[48:51], v[16:19], v[136:139], v[48:51]
  ds_read_b64_tr_b16 v[32:33], v8 offset:4096
  s_waitcnt vmcnt(12)
  v_mfma_f32_16x16x32_bf16 v[64:67], v[16:19], v[140:143], v[64:67]
  ds_read_b64_tr_b16 v[34:35], v8 offset:4608
  v_add_u32 v8, 8192, v8
  s_waitcnt lgkmcnt(6)
  v_mfma_f32_16x16x32_bf16 v[68:71], v[20:23], v[140:143], v[68:71]
  ds_read_b64_tr_b16 v[36:37], v9 offset:4096
  buffer_load_dwordx4 v[128:131], v90, s[8:11], s36 offen sc1
  v_mfma_f32_16x16x32_bf16 v[52:55], v[20:23], v[136:139], v[52:55]
  ds_read_b64_tr_b16 v[38:39], v9 offset:4608
  v_add_u32 v9, 8192, v9
  s_waitcnt lgkmcnt(6)
  v_mfma_f32_16x16x32_bf16 v[56:59], v[24:27], v[136:139], v[56:59]
  ds_read_b64_tr_b16 v[40:41], v10 offset:4096
  v_mfma_f32_16x16x32_bf16 v[72:75], v[24:27], v[140:143], v[72:75]
  ds_read_b64_tr_b16 v[42:43], v10 offset:4608
  v_add_u32 v10, 8192, v10
  s_waitcnt lgkmcnt(6)
  v_mfma_f32_16x16x32_bf16 v[76:79], v[28:31], v[140:143], v[76:79]
  ds_read_b64_tr_b16 v[44:45], v11 offset:4096
  buffer_load_dwordx4 v[132:135], v91, s[8:11], s36 offen sc1
  v_mfma_f32_16x16x32_bf16 v[60:63], v[28:31], v[136:139], v[60:63]
  ds_read_b64_tr_b16 v[46:47], v11 offset:4608
  v_add_u32 v11, 8192, v11
  s_waitcnt vmcnt(13) lgkmcnt(6)
  v_mfma_f32_16x16x32_bf16 v[48:51], v[32:35], v[144:147], v[48:51]
  ds_read_b64_tr_b16 v[16:17], v8 offset:0
  s_bitcmp1_b32 s48, 5
  s_cselect_b32 s36, s50, s49
  s_waitcnt vmcnt(12)
  v_mfma_f32_16x16x32_bf16 v[64:67], v[32:35], v[148:151], v[64:67]
  ds_read_b64_tr_b16 v[18:19], v8 offset:512
  s_add_u32 s36, s36, 40960
  s_waitcnt lgkmcnt(6)
  v_mfma_f32_16x16x32_bf16 v[68:71], v[36:39], v[148:151], v[68:71]
  ds_read_b64_tr_b16 v[20:21], v9 offset:0
  v_mfma_f32_16x16x32_bf16 v[52:55], v[36:39], v[144:147], v[52:55]
  ds_read_b64_tr_b16 v[22:23], v9 offset:512
  s_waitcnt lgkmcnt(6)
  v_mfma_f32_16x16x32_bf16 v[56:59], v[40:43], v[144:147], v[56:59]
  ds_read_b64_tr_b16 v[24:25], v10 offset:0
  buffer_load_dwordx4 v[136:139], v88, s[8:11], s36 offen sc1
  v_mfma_f32_16x16x32_bf16 v[72:75], v[40:43], v[148:151], v[72:75]
  ds_read_b64_tr_b16 v[26:27], v10 offset:512
  s_waitcnt lgkmcnt(6)
  v_mfma_f32_16x16x32_bf16 v[76:79], v[44:47], v[148:151], v[76:79]
  ds_read_b64_tr_b16 v[28:29], v11 offset:0
  v_mfma_f32_16x16x32_bf16 v[60:63], v[44:47], v[144:147], v[60:63]
  ds_read_b64_tr_b16 v[30:31], v11 offset:512
  buffer_load_dwordx4 v[140:143], v89, s[8:11], s36 offen sc1
  s_waitcnt vmcnt(13) lgkmcnt(6)
  v_mfma_f32_16x16x32_bf16 v[48:51], v[16:19], v[152:155], v[48:51]
  ds_read_b64_tr_b16 v[32:33], v8 offset:4096
  s_waitcnt vmcnt(12)
  v_mfma_f32_16x16x32_bf16 v[64:67], v[16:19], v[156:159], v[64:67]
  ds_read_b64_tr_b16 v[34:35], v8 offset:4608
  v_add_u32 v8, 8192, v8
  s_waitcnt lgkmcnt(6)
  v_mfma_f32_16x16x32_bf16 v[68:71], v[20:23], v[156:159], v[68:71]
  ds_read_b64_tr_b16 v[36:37], v9 offset:4096
  buffer_load_dwordx4 v[144:147], v90, s[8:11], s36 offen sc1
  v_mfma_f32_16x16x32_bf16 v[52:55], v[20:23], v[152:155], v[52:55]
  ds_read_b64_tr_b16 v[38:39], v9 offset:4608
  v_add_u32 v9, 8192, v9
  s_waitcnt lgkmcnt(6)
  v_mfma_f32_16x16x32_bf16 v[56:59], v[24:27], v[152:155], v[56:59]
  ds_read_b64_tr_b16 v[40:41], v10 offset:4096
  v_mfma_f32_16x16x32_bf16 v[72:75], v[24:27], v[156:159], v[72:75]
  ds_read_b64_tr_b16 v[42:43], v10 offset:4608
  v_add_u32 v10, 8192, v10
  s_waitcnt lgkmcnt(6)
  v_mfma_f32_16x16x32_bf16 v[76:79], v[28:31], v[156:159], v[76:79]
  ds_read_b64_tr_b16 v[44:45], v11 offset:4096
  buffer_load_dwordx4 v[148:151], v91, s[8:11], s36 offen sc1
  v_mfma_f32_16x16x32_bf16 v[60:63], v[28:31], v[152:155], v[60:63]
  ds_read_b64_tr_b16 v[46:47], v11 offset:4608
  v_add_u32 v11, 8192, v11
  s_waitcnt vmcnt(13) lgkmcnt(6)
  v_mfma_f32_16x16x32_bf16 v[48:51], v[32:35], v[160:163], v[48:51]
  ds_read_b64_tr_b16 v[16:17], v8 offset:0
  s_bitcmp1_b32 s48, 6
  s_cselect_b32 s36, s50, s49
  s_waitcnt vmcnt(12)
  v_mfma_f32_16x16x32_bf16 v[64:67], v[32:35], v[164:167], v[64:67]
  ds_read_b64_tr_b16 v[18:19], v8 offset:512
  s_add_u32 s36, s36, 49152
  s_waitcnt lgkmcnt(6)
  v_mfma_f32_16x16x32_bf16 v[68:71], v[36:39], v[164:167], v[68:71]
  ds_read_b64_tr_b16 v[20:21], v9 offset:0
  v_mfma_f32_16x16x32_bf16 v[52:55], v[36:39], v[160:163], v[52:55]
  ds_read_b64_tr_b16 v[22:23], v9 offset:512
  s_waitcnt lgkmcnt(6)
  v_mfma_f32_16x16x32_bf16 v[56:59], v[40:43], v[160:163], v[56:59]
  ds_read_b64_tr_b16 v[24:25], v10 offset:0
  buffer_load_dwordx4 v[152:155], v88, s[8:11], s36 offen sc1
  v_mfma_f32_16x16x32_bf16 v[72:75], v[40:43], v[164:167], v[72:75]
  ds_read_b64_tr_b16 v[26:27], v10 offset:512
  s_waitcnt lgkmcnt(6)
  v_mfma_f32_16x16x32_bf16 v[76:79], v[44:47], v[164:167], v[76:79]
  ds_read_b64_tr_b16 v[28:29], v11 offset:0
  v_mfma_f32_16x16x32_bf16 v[60:63], v[44:47], v[160:163], v[60:63]
  ds_read_b64_tr_b16 v[30:31], v11 offset:512
  buffer_load_dwordx4 v[156:159], v89, s[8:11], s36 offen sc1
  s_waitcnt vmcnt(13) lgkmcnt(6)
  v_mfma_f32_16x16x32_bf16 v[48:51], v[16:19], v[168:171], v[48:51]
  ds_read_b64_tr_b16 v[32:33], v8 offset:4096
  s_waitcnt vmcnt(12)
  v_mfma_f32_16x16x32_bf16 v[64:67], v[16:19], v[172:175], v[64:67]
  ds_read_b64_tr_b16 v[34:35], v8 offset:4608
  v_add_u32 v8, 4294912256, v8
  s_waitcnt lgkmcnt(6)
  v_mfma_f32_16x16x32_bf16 v[68:71], v[20:23], v[172:175], v[68:71]
  ds_read_b64_tr_b16 v[36:37], v9 offset:4096
  buffer_load_dwordx4 v[160:163], v90, s[8:11], s36 offen sc1
  v_mfma_f32_16x16x32_bf16 v[52:55], v[20:23], v[168:171], v[52:55]
  ds_read_b64_tr_b16 v[38:39], v9 offset:4608
  v_add_u32 v9, 4294912256, v9
  s_waitcnt lgkmcnt(6)
  v_mfma_f32_16x16x32_bf16 v[56:59], v[24:27], v[168:171], v[56:59]
  ds_read_b64_tr_b16 v[40:41], v10 offset:4096
  v_mfma_f32_16x16x32_bf16 v[72:75], v[24:27], v[172:175], v[72:75]
  ds_read_b64_tr_b16 v[42:43], v10 offset:4608
  v_add_u32 v10, 4294912256, v10
  s_waitcnt lgkmcnt(6)
  v_mfma_f32_16x16x32_bf16 v[76:79], v[28:31], v[172:175], v[76:79]
  ds_read_b64_tr_b16 v[44:45], v11 offset:4096
  buffer_load_dwordx4 v[164:167], v91, s[8:11], s36 offen sc1
  v_mfma_f32_16x16x32_bf16 v[60:63], v[28:31], v[168:171], v[60:63]
  ds_read_b64_tr_b16 v[46:47], v11 offset:4608
  v_add_u32 v11, 4294912256, v11
  s_waitcnt vmcnt(13) lgkmcnt(6)
  v_mfma_f32_16x16x32_bf16 v[48:51], v[32:35], v[176:179], v[48:51]
  ds_read_b64_tr_b16 v[16:17], v8 offset:0
  s_bitcmp1_b32 s48, 7
  s_cselect_b32 s36, s50, s49
  s_waitcnt vmcnt(12)
  v_mfma_f32_16x16x32_bf16 v[64:67], v[32:35], v[180:183], v[64:67]
  ds_read_b64_tr_b16 v[18:19], v8 offset:512
  s_add_u32 s36, s36, 57344
  s_waitcnt lgkmcnt(6)
  v_mfma_f32_16x16x32_bf16 v[68:71], v[36:39], v[180:183], v[68:71]
  ds_read_b64_tr_b16 v[20:21], v9 offset:0
  v_mfma_f32_16x16x32_bf16 v[52:55], v[36:39], v[176:179], v[52:55]
  ds_read_b64_tr_b16 v[22:23], v9 offset:512
  s_waitcnt lgkmcnt(6)
  v_mfma_f32_16x16x32_bf16 v[56:59], v[40:43], v[176:179], v[56:59]
  ds_read_b64_tr_b16 v[24:25], v10 offset:0
  buffer_load_dwordx4 v[168:171], v88, s[8:11], s36 offen sc1
  v_mfma_f32_16x16x32_bf16 v[72:75], v[40:43], v[180:183], v[72:75]
  ds_read_b64_tr_b16 v[26:27], v10 offset:512
  s_waitcnt lgkmcnt(6)
  v_mfma_f32_16x16x32_bf16 v[76:79], v[44:47], v[180:183], v[76:79]
  ds_read_b64_tr_b16 v[28:29], v11 offset:0
  v_mfma_f32_16x16x32_bf16 v[60:63], v[44:47], v[176:179], v[60:63]
  ds_read_b64_tr_b16 v[30:31], v11 offset:512
  buffer_load_dwordx4 v[172:175], v89, s[8:11], s36 offen sc1
  s_waitcnt vmcnt(13) lgkmcnt(6)
  v_mfma_f32_16x16x32_bf16 v[48:51], v[16:19], v[120:123], v[48:51]
  ds_read_b64_tr_b16 v[32:33], v8 offset:4096
  s_waitcnt vmcnt(12)
  v_mfma_f32_16x16x32_bf16 v[64:67], v[16:19], v[124:127], v[64:67]
  ds_read_b64_tr_b16 v[34:35], v8 offset:4608
  v_add_u32 v8, 8192, v8
  s_waitcnt lgkmcnt(6)
  v_mfma_f32_16x16x32_bf16 v[68:71], v[20:23], v[124:127], v[68:71]
  ds_read_b64_tr_b16 v[36:37], v9 offset:4096
  buffer_load_dwordx4 v[176:179], v90, s[8:11], s36 offen sc1
  v_mfma_f32_16x16x32_bf16 v[52:55], v[20:23], v[120:123], v[52:55]
  ds_read_b64_tr_b16 v[38:39], v9 offset:4608
  v_add_u32 v9, 8192, v9
  s_waitcnt lgkmcnt(6)
  v_mfma_f32_16x16x32_bf16 v[56:59], v[24:27], v[120:123], v[56:59]
  ds_read_b64_tr_b16 v[40:41], v10 offset:4096
  v_mfma_f32_16x16x32_bf16 v[72:75], v[24:27], v[124:127], v[72:75]
  ds_read_b64_tr_b16 v[42:43], v10 offset:4608
  v_add_u32 v10, 8192, v10
  s_waitcnt lgkmcnt(6)
  v_mfma_f32_16x16x32_bf16 v[76:79], v[28:31], v[124:127], v[76:79]
  ds_read_b64_tr_b16 v[44:45], v11 offset:4096
  buffer_load_dwordx4 v[180:183], v91, s[8:11], s36 offen sc1
  v_mfma_f32_16x16x32_bf16 v[60:63], v[28:31], v[120:123], v[60:63]
  ds_read_b64_tr_b16 v[46:47], v11 offset:4608
  v_add_u32 v11, 8192, v11
  s_waitcnt vmcnt(13) lgkmcnt(6)
  v_mfma_f32_16x16x32_bf16 v[48:51], v[32:35], v[128:131], v[48:51]
  ds_read_b64_tr_b16 v[16:17], v8 offset:0
  s_mov_b32 s49, s50
  s_add_u32 s50, s50, 65536
  s_waitcnt vmcnt(12)
  v_mfma_f32_16x16x32_bf16 v[64:67], v[32:35], v[132:135], v[64:67]
  ds_read_b64_tr_b16 v[18:19], v8 offset:512
  s_cmp_eq_u32 s50, s41
  s_cselect_b32 s50, s34, s50
  s_waitcnt lgkmcnt(6)
  v_mfma_f32_16x16x32_bf16 v[68:71], v[36:39], v[132:135], v[68:71]
  ds_read_b64_tr_b16 v[20:21], v9 offset:0
  s_bitcmp1_b32 s48, 0
  s_cselect_b32 s36, s50, s49
  v_mfma_f32_16x16x32_bf16 v[52:55], v[36:39], v[128:131], v[52:55]
  ds_read_b64_tr_b16 v[22:23], v9 offset:512
  s_add_u32 s36, s36, 0
  s_waitcnt lgkmcnt(6)
  v_mfma_f32_16x16x32_bf16 v[56:59], v[40:43], v[128:131], v[56:59]
  ds_read_b64_tr_b16 v[24:25], v10 offset:0
  buffer_load_dwordx4 v[120:123], v88, s[8:11], s36 offen sc1
  v_mfma_f32_16x16x32_bf16 v[72:75], v[40:43], v[132:135], v[72:75]
  ds_read_b64_tr_b16 v[26:27], v10 offset:512
  s_waitcnt lgkmcnt(6)
  v_mfma_f32_16x16x32_bf16 v[76:79], v[44:47], v[132:135], v[76:79]
  ds_read_b64_tr_b16 v[28:29], v11 offset:0
  v_mfma_f32_16x16x32_bf16 v[60:63], v[44:47], v[128:131], v[60:63]
  ds_read_b64_tr_b16 v[30:31], v11 offset:512
  buffer_load_dwordx4 v[124:127], v89, s[8:11], s36 offen sc1
  s_waitcnt vmcnt(13) lgkmcnt(6)
  v_mfma_f32_16x16x32_bf16 v[48:51], v[16:19], v[136:139], v[48:51]
  ds_read_b64_tr_b16 v[32:33], v8 offset:4096
  s_waitcnt vmcnt(12)
  v_mfma_f32_16x16x32_bf16 v[64:67], v[16:19], v[140:143], v[64:67]
  ds_read_b64_tr_b16 v[34:35], v8 offset:4608
  v_add_u32 v8, 8192, v8
  s_waitcnt lgkmcnt(6)
  v_mfma_f32_16x16x32_bf16 v[68:71], v[20:23], v[140:143], v[68:71]
  ds_read_b64_tr_b16 v[36:37], v9 offset:4096
  buffer_load_dwordx4 v[128:131], v90, s[8:11], s36 offen sc1
  v_mfma_f32_16x16x32_bf16 v[52:55], v[20:23], v[136:139], v[52:55]
  ds_read_b64_tr_b16 v[38:39], v9 offset:4608
  v_add_u32 v9, 8192, v9
  s_waitcnt lgkmcnt(6)
  v_mfma_f32_16x16x32_bf16 v[56:59], v[24:27], v[136:139], v[56:59]
  ds_read_b64_tr_b16 v[40:41], v10 offset:4096
  v_mfma_f32_16x16x32_bf16 v[72:75], v[24:27], v[140:143], v[72:75]
  ds_read_b64_tr_b16 v[42:43], v10 offset:4608
  v_add_u32 v10, 8192, v10
  s_waitcnt lgkmcnt(6)
  v_mfma_f32_16x16x32_bf16 v[76:79], v[28:31], v[140:143], v[76:79]
  ds_read_b64_tr_b16 v[44:45], v11 offset:4096
  buffer_load_dwordx4 v[132:135], v91, s[8:11], s36 offen sc1
  v_mfma_f32_16x16x32_bf16 v[60:63], v[28:31], v[136:139], v[60:63]
  ds_read_b64_tr_b16 v[46:47], v11 offset:4608
  v_add_u32 v11, 8192, v11
  s_waitcnt vmcnt(13) lgkmcnt(6)
  v_mfma_f32_16x16x32_bf16 v[48:51], v[32:35], v[144:147], v[48:51]
  ds_read_b64_tr_b16 v[16:17], v8 offset:0
  s_bitcmp1_b32 s48, 1
  s_cselect_b32 s36, s50, s49
  s_waitcnt vmcnt(12)
  v_mfma_f32_16x16x32_bf16 v[64:67], v[32:35], v[148:151], v[64:67]
  ds_read_b64_tr_b16 v[18:19], v8 offset:512
  s_add_u32 s36, s36, 8192
  s_waitcnt lgkmcnt(6)
  v_mfma_f32_16x16x32_bf16 v[68:71], v[36:39], v[148:151], v[68:71]
  ds_read_b64_tr_b16 v[20:21], v9 offset:0
  v_mfma_f32_16x16x32_bf16 v[52:55], v[36:39], v[144:147], v[52:55]
  ds_read_b64_tr_b16 v[22:23], v9 offset:512
  s_waitcnt lgkmcnt(6)
  v_mfma_f32_16x16x32_bf16 v[56:59], v[40:43], v[144:147], v[56:59]
  ds_read_b64_tr_b16 v[24:25], v10 offset:0
  buffer_load_dwordx4 v[136:139], v88, s[8:11], s36 offen sc1
  v_mfma_f32_16x16x32_bf16 v[72:75], v[40:43], v[148:151], v[72:75]
  ds_read_b64_tr_b16 v[26:27], v10 offset:512
  s_waitcnt lgkmcnt(6)
  v_mfma_f32_16x16x32_bf16 v[76:79], v[44:47], v[148:151], v[76:79]
  ds_read_b64_tr_b16 v[28:29], v11 offset:0
  v_mfma_f32_16x16x32_bf16 v[60:63], v[44:47], v[144:147], v[60:63]
  ds_read_b64_tr_b16 v[30:31], v11 offset:512
  buffer_load_dwordx4 v[140:143], v89, s[8:11], s36 offen sc1
  s_waitcnt vmcnt(13) lgkmcnt(6)
  v_mfma_f32_16x16x32_bf16 v[48:51], v[16:19], v[152:155], v[48:51]
  ds_read_b64_tr_b16 v[32:33], v8 offset:4096
  s_waitcnt vmcnt(12)
  v_mfma_f32_16x16x32_bf16 v[64:67], v[16:19], v[156:159], v[64:67]
  ds_read_b64_tr_b16 v[34:35], v8 offset:4608
  v_add_u32 v8, 4294850304, v8
  s_waitcnt lgkmcnt(6)
  v_mfma_f32_16x16x32_bf16 v[68:71], v[20:23], v[156:159], v[68:71]
  ds_read_b64_tr_b16 v[36:37], v9 offset:4096
  buffer_load_dwordx4 v[144:147], v90, s[8:11], s36 offen sc1
  v_mfma_f32_16x16x32_bf16 v[52:55], v[20:23], v[152:155], v[52:55]
  ds_read_b64_tr_b16 v[38:39], v9 offset:4608
  v_add_u32 v9, 4294850304, v9
  s_waitcnt lgkmcnt(6)
  v_mfma_f32_16x16x32_bf16 v[56:59], v[24:27], v[152:155], v[56:59]
  ds_read_b64_tr_b16 v[40:41], v10 offset:4096
  v_mfma_f32_16x16x32_bf16 v[72:75], v[24:27], v[156:159], v[72:75]
  ds_read_b64_tr_b16 v[42:43], v10 offset:4608
  v_add_u32 v10, 4294850304, v10
  s_waitcnt lgkmcnt(6)
  v_mfma_f32_16x16x32_bf16 v[76:79], v[28:31], v[156:159], v[76:79]
  ds_read_b64_tr_b16 v[44:45], v11 offset:4096
  buffer_load_dwordx4 v[148:151], v91, s[8:11], s36 offen sc1
  v_mfma_f32_16x16x32_bf16 v[60:63], v[28:31], v[152:155], v[60:63]
  ds_read_b64_tr_b16 v[46:47], v11 offset:4608
  v_add_u32 v11, 4294850304, v11
  s_waitcnt vmcnt(13) lgkmcnt(6)
  v_mfma_f32_16x16x32_bf16 v[48:51], v[32:35], v[160:163], v[48:51]
  ds_read_b64_tr_b16 v[16:17], v8 offset:0
  s_bitcmp1_b32 s48, 2
  s_cselect_b32 s36, s50, s49
  s_waitcnt vmcnt(12)
  v_mfma_f32_16x16x32_bf16 v[64:67], v[32:35], v[164:167], v[64:67]
  ds_read_b64_tr_b16 v[18:19], v8 offset:512
  s_add_u32 s36, s36, 16384
  s_waitcnt lgkmcnt(6)
  v_mfma_f32_16x16x32_bf16 v[68:71], v[36:39], v[164:167], v[68:71]
  ds_read_b64_tr_b16 v[20:21], v9 offset:0
  v_mfma_f32_16x16x32_bf16 v[52:55], v[36:39], v[160:163], v[52:55]
  ds_read_b64_tr_b16 v[22:23], v9 offset:512
  s_waitcnt lgkmcnt(6)
  v_mfma_f32_16x16x32_bf16 v[56:59], v[40:43], v[160:163], v[56:59]
  ds_read_b64_tr_b16 v[24:25], v10 offset:0
  buffer_load_dwordx4 v[152:155], v88, s[8:11], s36 offen sc1
  v_mfma_f32_16x16x32_bf16 v[72:75], v[40:43], v[164:167], v[72:75]
  ds_read_b64_tr_b16 v[26:27], v10 offset:512
  s_waitcnt lgkmcnt(6)
  v_mfma_f32_16x16x32_bf16 v[76:79], v[44:47], v[164:167], v[76:79]
  ds_read_b64_tr_b16 v[28:29], v11 offset:0
  v_mfma_f32_16x16x32_bf16 v[60:63], v[44:47], v[160:163], v[60:63]
  ds_read_b64_tr_b16 v[30:31], v11 offset:512
  buffer_load_dwordx4 v[156:159], v89, s[8:11], s36 offen sc1
  s_waitcnt vmcnt(13) lgkmcnt(6)
  v_mfma_f32_16x16x32_bf16 v[48:51], v[16:19], v[168:171], v[48:51]
  ds_read_b64_tr_b16 v[32:33], v8 offset:4096
  s_waitcnt vmcnt(12)
  v_mfma_f32_16x16x32_bf16 v[64:67], v[16:19], v[172:175], v[64:67]
  ds_read_b64_tr_b16 v[34:35], v8 offset:4608
  v_add_u32 v8, 8192, v8
  s_waitcnt lgkmcnt(6)
  v_mfma_f32_16x16x32_bf16 v[68:71], v[20:23], v[172:175], v[68:71]
  ds_read_b64_tr_b16 v[36:37], v9 offset:4096
  buffer_load_dwordx4 v[160:163], v90, s[8:11], s36 offen sc1
  v_mfma_f32_16x16x32_bf16 v[52:55], v[20:23], v[168:171], v[52:55]
  ds_read_b64_tr_b16 v[38:39], v9 offset:4608
  v_add_u32 v9, 8192, v9
  s_waitcnt lgkmcnt(6)
  v_mfma_f32_16x16x32_bf16 v[56:59], v[24:27], v[168:171], v[56:59]
  ds_read_b64_tr_b16 v[40:41], v10 offset:4096
  v_mfma_f32_16x16x32_bf16 v[72:75], v[24:27], v[172:175], v[72:75]
  ds_read_b64_tr_b16 v[42:43], v10 offset:4608
  v_add_u32 v10, 8192, v10
  s_waitcnt lgkmcnt(6)
  v_mfma_f32_16x16x32_bf16 v[76:79], v[28:31], v[172:175], v[76:79]
  ds_read_b64_tr_b16 v[44:45], v11 offset:4096
  buffer_load_dwordx4 v[164:167], v91, s[8:11], s36 offen sc1
  v_mfma_f32_16x16x32_bf16 v[60:63], v[28:31], v[168:171], v[60:63]
  ds_read_b64_tr_b16 v[46:47], v11 offset:4608
  v_add_u32 v11, 8192, v11
  s_waitcnt vmcnt(13) lgkmcnt(6)
  v_mfma_f32_16x16x32_bf16 v[48:51], v[32:35], v[176:179], v[48:51]
  ds_read_b64_tr_b16 v[16:17], v8 offset:0
  s_bitcmp1_b32 s48, 3
  s_cselect_b32 s36, s50, s49
  s_waitcnt vmcnt(12)
  v_mfma_f32_16x16x32_bf16 v[64:67], v[32:35], v[180:183], v[64:67]
  ds_read_b64_tr_b16 v[18:19], v8 offset:512
  s_add_u32 s36, s36, 24576
  s_waitcnt lgkmcnt(6)
  v_mfma_f32_16x16x32_bf16 v[68:71], v[36:39], v[180:183], v[68:71]
  ds_read_b64_tr_b16 v[20:21], v9 offset:0
  v_mfma_f32_16x16x32_bf16 v[52:55], v[36:39], v[176:179], v[52:55]
  ds_read_b64_tr_b16 v[22:23], v9 offset:512
  s_waitcnt lgkmcnt(6)
  v_mfma_f32_16x16x32_bf16 v[56:59], v[40:43], v[176:179], v[56:59]
  ds_read_b64_tr_b16 v[24:25], v10 offset:0
  buffer_load_dwordx4 v[168:171], v88, s[8:11], s36 offen sc1
  v_mfma_f32_16x16x32_bf16 v[72:75], v[40:43], v[180:183], v[72:75]
  ds_read_b64_tr_b16 v[26:27], v10 offset:512
  s_waitcnt lgkmcnt(6)
  v_mfma_f32_16x16x32_bf16 v[76:79], v[44:47], v[180:183], v[76:79]
  ds_read_b64_tr_b16 v[28:29], v11 offset:0
  v_mfma_f32_16x16x32_bf16 v[60:63], v[44:47], v[176:179], v[60:63]
  ds_read_b64_tr_b16 v[30:31], v11 offset:512
  buffer_load_dwordx4 v[172:175], v89, s[8:11], s36 offen sc1
  s_waitcnt vmcnt(13) lgkmcnt(6)
  v_mfma_f32_16x16x32_bf16 v[48:51], v[16:19], v[120:123], v[48:51]
  ds_read_b64_tr_b16 v[32:33], v8 offset:4096
  s_waitcnt vmcnt(12)
  v_mfma_f32_16x16x32_bf16 v[64:67], v[16:19], v[124:127], v[64:67]
  ds_read_b64_tr_b16 v[34:35], v8 offset:4608
  v_add_u32 v8, 8192, v8
  s_waitcnt lgkmcnt(6)
  v_mfma_f32_16x16x32_bf16 v[68:71], v[20:23], v[124:127], v[68:71]
  ds_read_b64_tr_b16 v[36:37], v9 offset:4096
  buffer_load_dwordx4 v[176:179], v90, s[8:11], s36 offen sc1
  v_mfma_f32_16x16x32_bf16 v[52:55], v[20:23], v[120:123], v[52:55]
  ds_read_b64_tr_b16 v[38:39], v9 offset:4608
  v_add_u32 v9, 8192, v9
  s_waitcnt lgkmcnt(6)
  v_mfma_f32_16x16x32_bf16 v[56:59], v[24:27], v[120:123], v[56:59]
  ds_read_b64_tr_b16 v[40:41], v10 offset:4096
  v_mfma_f32_16x16x32_bf16 v[72:75], v[24:27], v[124:127], v[72:75]
  ds_read_b64_tr_b16 v[42:43], v10 offset:4608
  v_add_u32 v10, 8192, v10
  s_waitcnt lgkmcnt(6)
  v_mfma_f32_16x16x32_bf16 v[76:79], v[28:31], v[124:127], v[76:79]
  ds_read_b64_tr_b16 v[44:45], v11 offset:4096
  buffer_load_dwordx4 v[180:183], v91, s[8:11], s36 offen sc1
  v_mfma_f32_16x16x32_bf16 v[60:63], v[28:31], v[120:123], v[60:63]
  ds_read_b64_tr_b16 v[46:47], v11 offset:4608
  v_add_u32 v11, 8192, v11
  s_waitcnt vmcnt(13) lgkmcnt(6)
  v_mfma_f32_16x16x32_bf16 v[48:51], v[32:35], v[128:131], v[48:51]
  ds_read_b64_tr_b16 v[16:17], v8 offset:0
  s_bitcmp1_b32 s48, 4
  s_cselect_b32 s36, s50, s49
  s_waitcnt vmcnt(12)
  v_mfma_f32_16x16x32_bf16 v[64:67], v[32:35], v[132:135], v[64:67]
  ds_read_b64_tr_b16 v[18:19], v8 offset:512
  s_add_u32 s36, s36, 32768
  s_waitcnt lgkmcnt(6)
  v_mfma_f32_16x16x32_bf16 v[68:71], v[36:39], v[132:135], v[68:71]
  ds_read_b64_tr_b16 v[20:21], v9 offset:0
  v_mfma_f32_16x16x32_bf16 v[52:55], v[36:39], v[128:131], v[52:55]
  ds_read_b64_tr_b16 v[22:23], v9 offset:512
  s_waitcnt lgkmcnt(6)
  v_mfma_f32_16x16x32_bf16 v[56:59], v[40:43], v[128:131], v[56:59]
  ds_read_b64_tr_b16 v[24:25], v10 offset:0
  buffer_load_dwordx4 v[120:123], v88, s[8:11], s36 offen sc1
  v_mfma_f32_16x16x32_bf16 v[72:75], v[40:43], v[132:135], v[72:75]
  ds_read_b64_tr_b16 v[26:27], v10 offset:512
  s_waitcnt lgkmcnt(6)
  v_mfma_f32_16x16x32_bf16 v[76:79], v[44:47], v[132:135], v[76:79]
  ds_read_b64_tr_b16 v[28:29], v11 offset:0
  v_mfma_f32_16x16x32_bf16 v[60:63], v[44:47], v[128:131], v[60:63]
  ds_read_b64_tr_b16 v[30:31], v11 offset:512
  buffer_load_dwordx4 v[124:127], v89, s[8:11], s36 offen sc1
  s_waitcnt vmcnt(13) lgkmcnt(6)
  v_mfma_f32_16x16x32_bf16 v[48:51], v[16:19], v[136:139], v[48:51]
  ds_read_b64_tr_b16 v[32:33], v8 offset:4096
  s_waitcnt vmcnt(12)
  v_mfma_f32_16x16x32_bf16 v[64:67], v[16:19], v[140:143], v[64:67]
  ds_read_b64_tr_b16 v[34:35], v8 offset:4608
  v_add_u32 v8, 8192, v8
  s_waitcnt lgkmcnt(6)
  v_mfma_f32_16x16x32_bf16 v[68:71], v[20:23], v[140:143], v[68:71]
  ds_read_b64_tr_b16 v[36:37], v9 offset:4096
  buffer_load_dwordx4 v[128:131], v90, s[8:11], s36 offen sc1
  v_mfma_f32_16x16x32_bf16 v[52:55], v[20:23], v[136:139], v[52:55]
  ds_read_b64_tr_b16 v[38:39], v9 offset:4608
  v_add_u32 v9, 8192, v9
  s_waitcnt lgkmcnt(6)
  v_mfma_f32_16x16x32_bf16 v[56:59], v[24:27], v[136:139], v[56:59]
  ds_read_b64_tr_b16 v[40:41], v10 offset:4096
  v_mfma_f32_16x16x32_bf16 v[72:75], v[24:27], v[140:143], v[72:75]
  ds_read_b64_tr_b16 v[42:43], v10 offset:4608
  v_add_u32 v10, 8192, v10
  s_waitcnt lgkmcnt(6)
  v_mfma_f32_16x16x32_bf16 v[76:79], v[28:31], v[140:143], v[76:79]
  ds_read_b64_tr_b16 v[44:45], v11 offset:4096
  buffer_load_dwordx4 v[132:135], v91, s[8:11], s36 offen sc1
  v_mfma_f32_16x16x32_bf16 v[60:63], v[28:31], v[136:139], v[60:63]
  ds_read_b64_tr_b16 v[46:47], v11 offset:4608
  v_add_u32 v11, 8192, v11
  s_waitcnt vmcnt(13) lgkmcnt(6)
  v_mfma_f32_16x16x32_bf16 v[48:51], v[32:35], v[144:147], v[48:51]
  ds_read_b64_tr_b16 v[16:17], v8 offset:0
  s_bitcmp1_b32 s48, 5
  s_cselect_b32 s36, s50, s49
  s_waitcnt vmcnt(12)
  v_mfma_f32_16x16x32_bf16 v[64:67], v[32:35], v[148:151], v[64:67]
  ds_read_b64_tr_b16 v[18:19], v8 offset:512
  s_add_u32 s36, s36, 40960
  s_waitcnt lgkmcnt(6)
  v_mfma_f32_16x16x32_bf16 v[68:71], v[36:39], v[148:151], v[68:71]
  ds_read_b64_tr_b16 v[20:21], v9 offset:0
  v_mfma_f32_16x16x32_bf16 v[52:55], v[36:39], v[144:147], v[52:55]
  ds_read_b64_tr_b16 v[22:23], v9 offset:512
  s_waitcnt lgkmcnt(6)
  v_mfma_f32_16x16x32_bf16 v[56:59], v[40:43], v[144:147], v[56:59]
  ds_read_b64_tr_b16 v[24:25], v10 offset:0
  buffer_load_dwordx4 v[136:139], v88, s[8:11], s36 offen sc1
  v_mfma_f32_16x16x32_bf16 v[72:75], v[40:43], v[148:151], v[72:75]
  ds_read_b64_tr_b16 v[26:27], v10 offset:512
  s_waitcnt lgkmcnt(6)
  v_mfma_f32_16x16x32_bf16 v[76:79], v[44:47], v[148:151], v[76:79]
  ds_read_b64_tr_b16 v[28:29], v11 offset:0
  v_mfma_f32_16x16x32_bf16 v[60:63], v[44:47], v[144:147], v[60:63]
  ds_read_b64_tr_b16 v[30:31], v11 offset:512
  buffer_load_dwordx4 v[140:143], v89, s[8:11], s36 offen sc1
  s_waitcnt vmcnt(13) lgkmcnt(6)
  v_mfma_f32_16x16x32_bf16 v[48:51], v[16:19], v[152:155], v[48:51]
  ds_read_b64_tr_b16 v[32:33], v8 offset:4096
  s_waitcnt vmcnt(12)
  v_mfma_f32_16x16x32_bf16 v[64:67], v[16:19], v[156:159], v[64:67]
  ds_read_b64_tr_b16 v[34:35], v8 offset:4608
  v_add_u32 v8, 8192, v8
  s_waitcnt lgkmcnt(6)
  v_mfma_f32_16x16x32_bf16 v[68:71], v[20:23], v[156:159], v[68:71]
  ds_read_b64_tr_b16 v[36:37], v9 offset:4096
  buffer_load_dwordx4 v[144:147], v90, s[8:11], s36 offen sc1
  v_mfma_f32_16x16x32_bf16 v[52:55], v[20:23], v[152:155], v[52:55]
  ds_read_b64_tr_b16 v[38:39], v9 offset:4608
  v_add_u32 v9, 8192, v9
  s_waitcnt lgkmcnt(6)
  v_mfma_f32_16x16x32_bf16 v[56:59], v[24:27], v[152:155], v[56:59]
  ds_read_b64_tr_b16 v[40:41], v10 offset:4096
  v_mfma_f32_16x16x32_bf16 v[72:75], v[24:27], v[156:159], v[72:75]
  ds_read_b64_tr_b16 v[42:43], v10 offset:4608
  v_add_u32 v10, 8192, v10
  s_waitcnt lgkmcnt(6)
  v_mfma_f32_16x16x32_bf16 v[76:79], v[28:31], v[156:159], v[76:79]
  ds_read_b64_tr_b16 v[44:45], v11 offset:4096
  buffer_load_dwordx4 v[148:151], v91, s[8:11], s36 offen sc1
  v_mfma_f32_16x16x32_bf16 v[60:63], v[28:31], v[152:155], v[60:63]
  ds_read_b64_tr_b16 v[46:47], v11 offset:4608
  v_add_u32 v11, 8192, v11
  s_waitcnt vmcnt(13) lgkmcnt(6)
  v_mfma_f32_16x16x32_bf16 v[48:51], v[32:35], v[160:163], v[48:51]
  ds_read_b64_tr_b16 v[16:17], v8 offset:0
  s_bitcmp1_b32 s48, 6
  s_cselect_b32 s36, s50, s49
  s_waitcnt vmcnt(12)
  v_mfma_f32_16x16x32_bf16 v[64:67], v[32:35], v[164:167], v[64:67]
  ds_read_b64_tr_b16 v[18:19], v8 offset:512
  s_add_u32 s36, s36, 49152
  s_waitcnt lgkmcnt(6)
  v_mfma_f32_16x16x32_bf16 v[68:71], v[36:39], v[164:167], v[68:71]
  ds_read_b64_tr_b16 v[20:21], v9 offset:0
  v_mfma_f32_16x16x32_bf16 v[52:55], v[36:39], v[160:163], v[52:55]
  ds_read_b64_tr_b16 v[22:23], v9 offset:512
  s_waitcnt lgkmcnt(6)
  v_mfma_f32_16x16x32_bf16 v[56:59], v[40:43], v[160:163], v[56:59]
  ds_read_b64_tr_b16 v[24:25], v10 offset:0
  buffer_load_dwordx4 v[152:155], v88, s[8:11], s36 offen sc1
  v_mfma_f32_16x16x32_bf16 v[72:75], v[40:43], v[164:167], v[72:75]
  ds_read_b64_tr_b16 v[26:27], v10 offset:512
  s_waitcnt lgkmcnt(6)
  v_mfma_f32_16x16x32_bf16 v[76:79], v[44:47], v[164:167], v[76:79]
  ds_read_b64_tr_b16 v[28:29], v11 offset:0
  v_mfma_f32_16x16x32_bf16 v[60:63], v[44:47], v[160:163], v[60:63]
  ds_read_b64_tr_b16 v[30:31], v11 offset:512
  buffer_load_dwordx4 v[156:159], v89, s[8:11], s36 offen sc1
  s_waitcnt vmcnt(13) lgkmcnt(6)
  v_mfma_f32_16x16x32_bf16 v[48:51], v[16:19], v[168:171], v[48:51]
  ds_read_b64_tr_b16 v[32:33], v8 offset:4096
  s_waitcnt vmcnt(12)
  v_mfma_f32_16x16x32_bf16 v[64:67], v[16:19], v[172:175], v[64:67]
  ds_read_b64_tr_b16 v[34:35], v8 offset:4608
  v_add_u32 v8, 10240, v8
  s_waitcnt lgkmcnt(6)
  v_mfma_f32_16x16x32_bf16 v[68:71], v[20:23], v[172:175], v[68:71]
  ds_read_b64_tr_b16 v[36:37], v9 offset:4096
  buffer_load_dwordx4 v[160:163], v90, s[8:11], s36 offen sc1
  v_mfma_f32_16x16x32_bf16 v[52:55], v[20:23], v[168:171], v[52:55]
  ds_read_b64_tr_b16 v[38:39], v9 offset:4608
  v_add_u32 v9, 10240, v9
  s_waitcnt lgkmcnt(6)
  v_mfma_f32_16x16x32_bf16 v[56:59], v[24:27], v[168:171], v[56:59]
  ds_read_b64_tr_b16 v[40:41], v10 offset:4096
  v_mfma_f32_16x16x32_bf16 v[72:75], v[24:27], v[172:175], v[72:75]
  ds_read_b64_tr_b16 v[42:43], v10 offset:4608
  v_add_u32 v10, 10240, v10
  s_waitcnt lgkmcnt(6)
  v_mfma_f32_16x16x32_bf16 v[76:79], v[28:31], v[172:175], v[76:79]
  ds_read_b64_tr_b16 v[44:45], v11 offset:4096
  buffer_load_dwordx4 v[164:167], v91, s[8:11], s36 offen sc1
  v_mfma_f32_16x16x32_bf16 v[60:63], v[28:31], v[168:171], v[60:63]
  ds_read_b64_tr_b16 v[46:47], v11 offset:4608
  v_add_u32 v11, 10240, v11
  s_waitcnt vmcnt(13) lgkmcnt(6)
  v_mfma_f32_16x16x32_bf16 v[48:51], v[32:35], v[176:179], v[48:51]
  ds_read_b64_tr_b16 v[16:17], v8 offset:0
  s_bitcmp1_b32 s48, 7
  s_cselect_b32 s36, s50, s49
  s_waitcnt vmcnt(12)
  v_mfma_f32_16x16x32_bf16 v[64:67], v[32:35], v[180:183], v[64:67]
  ds_read_b64_tr_b16 v[18:19], v8 offset:512
  s_add_u32 s36, s36, 57344
  s_waitcnt lgkmcnt(6)
  v_mfma_f32_16x16x32_bf16 v[68:71], v[36:39], v[180:183], v[68:71]
  ds_read_b64_tr_b16 v[20:21], v9 offset:0
  v_mfma_f32_16x16x32_bf16 v[52:55], v[36:39], v[176:179], v[52:55]
  ds_read_b64_tr_b16 v[22:23], v9 offset:512
  s_waitcnt lgkmcnt(6)
  v_mfma_f32_16x16x32_bf16 v[56:59], v[40:43], v[176:179], v[56:59]
  ds_read_b64_tr_b16 v[24:25], v10 offset:0
  buffer_load_dwordx4 v[168:171], v88, s[8:11], s36 offen sc1
  v_mfma_f32_16x16x32_bf16 v[72:75], v[40:43], v[180:183], v[72:75]
  ds_read_b64_tr_b16 v[26:27], v10 offset:512
  s_waitcnt lgkmcnt(6)
  v_mfma_f32_16x16x32_bf16 v[76:79], v[44:47], v[180:183], v[76:79]
  ds_read_b64_tr_b16 v[28:29], v11 offset:0
  v_mfma_f32_16x16x32_bf16 v[60:63], v[44:47], v[176:179], v[60:63]
  ds_read_b64_tr_b16 v[30:31], v11 offset:512
  buffer_load_dwordx4 v[172:175], v89, s[8:11], s36 offen sc1
  s_waitcnt vmcnt(13) lgkmcnt(6)
  v_mfma_f32_16x16x32_bf16 v[48:51], v[16:19], v[120:123], v[48:51]
  ds_read_b64_tr_b16 v[32:33], v8 offset:4096
  s_waitcnt vmcnt(12)
  v_mfma_f32_16x16x32_bf16 v[64:67], v[16:19], v[124:127], v[64:67]
  ds_read_b64_tr_b16 v[34:35], v8 offset:4608
  v_add_u32 v8, 8192, v8
  s_waitcnt lgkmcnt(6)
  v_mfma_f32_16x16x32_bf16 v[68:71], v[20:23], v[124:127], v[68:71]
  ds_read_b64_tr_b16 v[36:37], v9 offset:4096
  buffer_load_dwordx4 v[176:179], v90, s[8:11], s36 offen sc1
  v_mfma_f32_16x16x32_bf16 v[52:55], v[20:23], v[120:123], v[52:55]
  ds_read_b64_tr_b16 v[38:39], v9 offset:4608
  v_add_u32 v9, 8192, v9
  s_waitcnt lgkmcnt(6)
  v_mfma_f32_16x16x32_bf16 v[56:59], v[24:27], v[120:123], v[56:59]
  ds_read_b64_tr_b16 v[40:41], v10 offset:4096
  v_mfma_f32_16x16x32_bf16 v[72:75], v[24:27], v[124:127], v[72:75]
  ds_read_b64_tr_b16 v[42:43], v10 offset:4608
  v_add_u32 v10, 8192, v10
  s_waitcnt lgkmcnt(6)
  v_mfma_f32_16x16x32_bf16 v[76:79], v[28:31], v[124:127], v[76:79]
  ds_read_b64_tr_b16 v[44:45], v11 offset:4096
  buffer_load_dwordx4 v[180:183], v91, s[8:11], s36 offen sc1
  v_mfma_f32_16x16x32_bf16 v[60:63], v[28:31], v[120:123], v[60:63]
  ds_read_b64_tr_b16 v[46:47], v11 offset:4608
  v_add_u32 v11, 8192, v11
  s_waitcnt vmcnt(13) lgkmcnt(6)
  v_mfma_f32_16x16x32_bf16 v[48:51], v[32:35], v[128:131], v[48:51]
  ds_read_b64_tr_b16 v[16:17], v8 offset:0
  s_waitcnt vmcnt(12)
  v_mfma_f32_16x16x32_bf16 v[64:67], v[32:35], v[132:135], v[64:67]
  ds_read_b64_tr_b16 v[18:19], v8 offset:512
  s_waitcnt lgkmcnt(6)
  v_mfma_f32_16x16x32_bf16 v[68:71], v[36:39], v[132:135], v[68:71]
  ds_read_b64_tr_b16 v[20:21], v9 offset:0
  v_mfma_f32_16x16x32_bf16 v[52:55], v[36:39], v[128:131], v[52:55]
  ds_read_b64_tr_b16 v[22:23], v9 offset:512
  s_waitcnt lgkmcnt(6)
  v_mfma_f32_16x16x32_bf16 v[56:59], v[40:43], v[128:131], v[56:59]
  ds_read_b64_tr_b16 v[24:25], v10 offset:0
  v_mfma_f32_16x16x32_bf16 v[72:75], v[40:43], v[132:135], v[72:75]
  ds_read_b64_tr_b16 v[26:27], v10 offset:512
  s_waitcnt lgkmcnt(6)
  v_mfma_f32_16x16x32_bf16 v[76:79], v[44:47], v[132:135], v[76:79]
  ds_read_b64_tr_b16 v[28:29], v11 offset:0
  v_mfma_f32_16x16x32_bf16 v[60:63], v[44:47], v[128:131], v[60:63]
  ds_read_b64_tr_b16 v[30:31], v11 offset:512
  s_waitcnt vmcnt(11) lgkmcnt(6)
  v_mfma_f32_16x16x32_bf16 v[48:51], v[16:19], v[136:139], v[48:51]
  ds_read_b64_tr_b16 v[32:33], v8 offset:4096
  s_waitcnt vmcnt(10)
  v_mfma_f32_16x16x32_bf16 v[64:67], v[16:19], v[140:143], v[64:67]
  ds_read_b64_tr_b16 v[34:35], v8 offset:4608
  v_add_u32 v8, 8192, v8
  s_waitcnt lgkmcnt(6)
  v_mfma_f32_16x16x32_bf16 v[68:71], v[20:23], v[140:143], v[68:71]
  ds_read_b64_tr_b16 v[36:37], v9 offset:4096
  v_mfma_f32_16x16x32_bf16 v[52:55], v[20:23], v[136:139], v[52:55]
  ds_read_b64_tr_b16 v[38:39], v9 offset:4608
  v_add_u32 v9, 8192, v9
  s_waitcnt lgkmcnt(6)
  v_mfma_f32_16x16x32_bf16 v[56:59], v[24:27], v[136:139], v[56:59]
  ds_read_b64_tr_b16 v[40:41], v10 offset:4096
  v_mfma_f32_16x16x32_bf16 v[72:75], v[24:27], v[140:143], v[72:75]
  ds_read_b64_tr_b16 v[42:43], v10 offset:4608
  v_add_u32 v10, 8192, v10
  s_waitcnt lgkmcnt(6)
  v_mfma_f32_16x16x32_bf16 v[76:79], v[28:31], v[140:143], v[76:79]
  ds_read_b64_tr_b16 v[44:45], v11 offset:4096
  v_mfma_f32_16x16x32_bf16 v[60:63], v[28:31], v[136:139], v[60:63]
  ds_read_b64_tr_b16 v[46:47], v11 offset:4608
  v_add_u32 v11, 8192, v11
  s_waitcnt vmcnt(9) lgkmcnt(6)
  v_mfma_f32_16x16x32_bf16 v[48:51], v[32:35], v[144:147], v[48:51]
  ds_read_b64_tr_b16 v[16:17], v8 offset:0
  s_waitcnt vmcnt(8)
  v_mfma_f32_16x16x32_bf16 v[64:67], v[32:35], v[148:151], v[64:67]
  ds_read_b64_tr_b16 v[18:19], v8 offset:512
  s_waitcnt lgkmcnt(6)
  v_mfma_f32_16x16x32_bf16 v[68:71], v[36:39], v[148:151], v[68:71]
  ds_read_b64_tr_b16 v[20:21], v9 offset:0
  v_mfma_f32_16x16x32_bf16 v[52:55], v[36:39], v[144:147], v[52:55]
  ds_read_b64_tr_b16 v[22:23], v9 offset:512
  s_waitcnt lgkmcnt(6)
  v_mfma_f32_16x16x32_bf16 v[56:59], v[40:43], v[144:147], v[56:59]
  ds_read_b64_tr_b16 v[24:25], v10 offset:0
  v_mfma_f32_16x16x32_bf16 v[72:75], v[40:43], v[148:151], v[72:75]
  ds_read_b64_tr_b16 v[26:27], v10 offset:512
  s_waitcnt lgkmcnt(6)
  v_mfma_f32_16x16x32_bf16 v[76:79], v[44:47], v[148:151], v[76:79]
  ds_read_b64_tr_b16 v[28:29], v11 offset:0
  v_mfma_f32_16x16x32_bf16 v[60:63], v[44:47], v[144:147], v[60:63]
  ds_read_b64_tr_b16 v[30:31], v11 offset:512
  s_waitcnt vmcnt(7) lgkmcnt(6)
  v_mfma_f32_16x16x32_bf16 v[48:51], v[16:19], v[152:155], v[48:51]
  ds_read_b64_tr_b16 v[32:33], v8 offset:4096
  s_waitcnt vmcnt(6)
  v_mfma_f32_16x16x32_bf16 v[64:67], v[16:19], v[156:159], v[64:67]
  ds_read_b64_tr_b16 v[34:35], v8 offset:4608
  v_add_u32 v8, 8192, v8
  s_waitcnt lgkmcnt(6)
  v_mfma_f32_16x16x32_bf16 v[68:71], v[20:23], v[156:159], v[68:71]
  ds_read_b64_tr_b16 v[36:37], v9 offset:4096
  v_mfma_f32_16x16x32_bf16 v[52:55], v[20:23], v[152:155], v[52:55]
  ds_read_b64_tr_b16 v[38:39], v9 offset:4608
  v_add_u32 v9, 8192, v9
  s_waitcnt lgkmcnt(6)
  v_mfma_f32_16x16x32_bf16 v[56:59], v[24:27], v[152:155], v[56:59]
  ds_read_b64_tr_b16 v[40:41], v10 offset:4096
  v_mfma_f32_16x16x32_bf16 v[72:75], v[24:27], v[156:159], v[72:75]
  ds_read_b64_tr_b16 v[42:43], v10 offset:4608
  v_add_u32 v10, 8192, v10
  s_waitcnt lgkmcnt(6)
  v_mfma_f32_16x16x32_bf16 v[76:79], v[28:31], v[156:159], v[76:79]
  ds_read_b64_tr_b16 v[44:45], v11 offset:4096
  v_mfma_f32_16x16x32_bf16 v[60:63], v[28:31], v[152:155], v[60:63]
  ds_read_b64_tr_b16 v[46:47], v11 offset:4608
  v_add_u32 v11, 8192, v11
  s_waitcnt vmcnt(5) lgkmcnt(6)
  v_mfma_f32_16x16x32_bf16 v[48:51], v[32:35], v[160:163], v[48:51]
  ds_read_b64_tr_b16 v[16:17], v8 offset:0
  s_waitcnt vmcnt(4)
  v_mfma_f32_16x16x32_bf16 v[64:67], v[32:35], v[164:167], v[64:67]
  ds_read_b64_tr_b16 v[18:19], v8 offset:512
  s_waitcnt lgkmcnt(6)
  v_mfma_f32_16x16x32_bf16 v[68:71], v[36:39], v[164:167], v[68:71]
  ds_read_b64_tr_b16 v[20:21], v9 offset:0
  v_mfma_f32_16x16x32_bf16 v[52:55], v[36:39], v[160:163], v[52:55]
  ds_read_b64_tr_b16 v[22:23], v9 offset:512
  s_waitcnt lgkmcnt(6)
  v_mfma_f32_16x16x32_bf16 v[56:59], v[40:43], v[160:163], v[56:59]
  ds_read_b64_tr_b16 v[24:25], v10 offset:0
  v_mfma_f32_16x16x32_bf16 v[72:75], v[40:43], v[164:167], v[72:75]
  ds_read_b64_tr_b16 v[26:27], v10 offset:512
  s_waitcnt lgkmcnt(6)
  v_mfma_f32_16x16x32_bf16 v[76:79], v[44:47], v[164:167], v[76:79]
  ds_read_b64_tr_b16 v[28:29], v11 offset:0
  v_mfma_f32_16x16x32_bf16 v[60:63], v[44:47], v[160:163], v[60:63]
  ds_read_b64_tr_b16 v[30:31], v11 offset:512
  s_waitcnt vmcnt(3) lgkmcnt(6)
  v_mfma_f32_16x16x32_bf16 v[48:51], v[16:19], v[168:171], v[48:51]
  ds_read_b64_tr_b16 v[32:33], v8 offset:4096
  s_waitcnt vmcnt(2)
  v_mfma_f32_16x16x32_bf16 v[64:67], v[16:19], v[172:175], v[64:67]
  ds_read_b64_tr_b16 v[34:35], v8 offset:4608
  s_waitcnt lgkmcnt(6)
  v_mfma_f32_16x16x32_bf16 v[68:71], v[20:23], v[172:175], v[68:71]
  ds_read_b64_tr_b16 v[36:37], v9 offset:4096
  v_mfma_f32_16x16x32_bf16 v[52:55], v[20:23], v[168:171], v[52:55]
  ds_read_b64_tr_b16 v[38:39], v9 offset:4608
  s_waitcnt lgkmcnt(6)
  v_mfma_f32_16x16x32_bf16 v[56:59], v[24:27], v[168:171], v[56:59]
  ds_read_b64_tr_b16 v[40:41], v10 offset:4096
  v_mfma_f32_16x16x32_bf16 v[72:75], v[24:27], v[172:175], v[72:75]
  ds_read_b64_tr_b16 v[42:43], v10 offset:4608
  s_waitcnt lgkmcnt(6)
  v_mfma_f32_16x16x32_bf16 v[76:79], v[28:31], v[172:175], v[76:79]
  ds_read_b64_tr_b16 v[44:45], v11 offset:4096
  v_mfma_f32_16x16x32_bf16 v[60:63], v[28:31], v[168:171], v[60:63]
  ds_read_b64_tr_b16 v[46:47], v11 offset:4608
  s_waitcnt vmcnt(1) lgkmcnt(6)
  v_mfma_f32_16x16x32_bf16 v[48:51], v[32:35], v[176:179], v[48:51]
  s_waitcnt vmcnt(0)
  v_mfma_f32_16x16x32_bf16 v[64:67], v[32:35], v[180:183], v[64:67]
  s_waitcnt lgkmcnt(4)
  v_mfma_f32_16x16x32_bf16 v[68:71], v[36:39], v[180:183], v[68:71]
  v_mfma_f32_16x16x32_bf16 v[52:55], v[36:39], v[176:179], v[52:55]
  s_waitcnt lgkmcnt(2)
  v_mfma_f32_16x16x32_bf16 v[56:59], v[40:43], v[176:179], v[56:59]
  v_mfma_f32_16x16x32_bf16 v[72:75], v[40:43], v[180:183], v[72:75]
  s_waitcnt lgkmcnt(0)
  v_mfma_f32_16x16x32_bf16 v[76:79], v[44:47], v[180:183], v[76:79]
  v_mfma_f32_16x16x32_bf16 v[60:63], v[44:47], v[176:179], v[60:63]
  s_waitcnt lgkmcnt(0)
  s_barrier
  s_add_u32 s20, s82, 8388608
  s_addc_u32 s21, s83, 0
  s_mov_b32 s22, 8388608
  s_mov_b32 s23, 0x20000
  s_add_u32 s24, s82, 16777216
  s_addc_u32 s25, s83, 0
  s_mov_b32 s26, 8388608
  s_mov_b32 s27, 0x20000
  v_pk_add_f32 v[16:17], v[48:49], v[50:51]
  v_pk_mul_f32 v[18:19], v[48:49], v[48:49]
  v_pk_fma_f32 v[18:19], v[50:51], v[50:51], v[18:19]
  v_pk_add_f32 v[16:17], v[16:17], v[52:53]
  v_pk_fma_f32 v[18:19], v[52:53], v[52:53], v[18:19]
  v_pk_add_f32 v[16:17], v[16:17], v[54:55]
  v_pk_fma_f32 v[18:19], v[54:55], v[54:55], v[18:19]
  v_pk_add_f32 v[16:17], v[16:17], v[56:57]
  v_pk_fma_f32 v[18:19], v[56:57], v[56:57], v[18:19]
  v_pk_add_f32 v[16:17], v[16:17], v[58:59]
  v_pk_fma_f32 v[18:19], v[58:59], v[58:59], v[18:19]
  v_pk_add_f32 v[16:17], v[16:17], v[60:61]
  v_pk_fma_f32 v[18:19], v[60:61], v[60:61], v[18:19]
  v_pk_add_f32 v[16:17], v[16:17], v[62:63]
  v_pk_fma_f32 v[18:19], v[62:63], v[62:63], v[18:19]
  v_add_f32 v24, v16, v17
  v_add_f32 v26, v18, v19
  v_pk_add_f32 v[20:21], v[64:65], v[66:67]
  v_pk_mul_f32 v[22:23], v[64:65], v[64:65]
  v_pk_fma_f32 v[22:23], v[66:67], v[66:67], v[22:23]
  v_pk_add_f32 v[20:21], v[20:21], v[68:69]
  v_pk_fma_f32 v[22:23], v[68:69], v[68:69], v[22:23]
  v_pk_add_f32 v[20:21], v[20:21], v[70:71]
  v_pk_fma_f32 v[22:23], v[70:71], v[70:71], v[22:23]
  v_pk_add_f32 v[20:21], v[20:21], v[72:73]
  v_pk_fma_f32 v[22:23], v[72:73], v[72:73], v[22:23]
  v_pk_add_f32 v[20:21], v[20:21], v[74:75]
  v_pk_fma_f32 v[22:23], v[74:75], v[74:75], v[22:23]
  v_pk_add_f32 v[20:21], v[20:21], v[76:77]
  v_pk_fma_f32 v[22:23], v[76:77], v[76:77], v[22:23]
  v_pk_add_f32 v[20:21], v[20:21], v[78:79]
  v_pk_fma_f32 v[22:23], v[78:79], v[78:79], v[22:23]
  v_add_f32 v25, v20, v21
  v_add_f32 v27, v22, v23
  s_nop 0
  v_permlane16_swap_b32 v24, v25
  v_permlane16_swap_b32 v26, v27
  v_add_f32 v28, v24, v25
  v_add_f32 v29, v26, v27
  v_mov_b32 v30, v28
  v_mov_b32 v31, v29
  s_nop 0
  v_permlane32_swap_b32 v28, v30
  v_permlane32_swap_b32 v29, v31
  v_add_f32 v28, v28, v30
  v_add_f32 v29, v29, v31
  v_and_b32 v29, 0x7fffffff, v29
  s_mov_b32 exec_hi, 0
  buffer_store_dwordx2 v[28:29], v112, s[12:15], 0 offen sc0 sc1
  s_mov_b64 exec, -1
  v_cvt_pk_bf16_f32 v96, v48, v49
  v_cvt_pk_bf16_f32 v97, v50, v51
  v_cvt_pk_bf16_f32 v98, v52, v53
  v_cvt_pk_bf16_f32 v99, v54, v55
  v_cvt_pk_bf16_f32 v100, v56, v57
  v_cvt_pk_bf16_f32 v101, v58, v59
  v_cvt_pk_bf16_f32 v102, v60, v61
  v_cvt_pk_bf16_f32 v103, v62, v63
  v_cvt_pk_bf16_f32 v104, v64, v65
  v_cvt_pk_bf16_f32 v105, v66, v67
  v_cvt_pk_bf16_f32 v106, v68, v69
  v_cvt_pk_bf16_f32 v107, v70, v71
  v_cvt_pk_bf16_f32 v108, v72, v73
  v_cvt_pk_bf16_f32 v109, v74, v75
  v_cvt_pk_bf16_f32 v110, v76, v77
  v_cvt_pk_bf16_f32 v111, v78, v79
  v_permlane16_swap_b32 v96, v98
  v_permlane16_swap_b32 v97, v99
  v_permlane16_swap_b32 v100, v102
  v_permlane16_swap_b32 v101, v103
  v_permlane16_swap_b32 v104, v106
  v_permlane16_swap_b32 v105, v107
  v_permlane16_swap_b32 v108, v110
  v_permlane16_swap_b32 v109, v111
  v_xor_b32 v116, 32, v115
  v_xor_b32 v121, 32, v114
  v_xor_b32 v117, 64, v115
  v_xor_b32 v122, 64, v114
  v_xor_b32 v118, 96, v115
  v_xor_b32 v123, 96, v114
  v_mov_b32 v120, v114
  s_mov_b32 s39, 0
k2_poll:
  buffer_load_dwordx2 v[32:33], v113, s[12:15], 0 offen sc0 sc1
  buffer_load_dwordx2 v[34:35], v80, s[12:15], 0 offen sc0 sc1
  buffer_load_dwordx2 v[36:37], v81, s[12:15], 0 offen sc0 sc1
  buffer_load_dwordx2 v[38:39], v82, s[12:15], 0 offen sc0 sc1
  buffer_load_dwordx2 v[40:41], v83, s[12:15], 0 offen sc0 sc1
  buffer_load_dwordx2 v[42:43], v84, s[12:15], 0 offen sc0 sc1
  buffer_load_dwordx2 v[44:45], v85, s[12:15], 0 offen sc0 sc1
  buffer_load_dwordx2 v[46:47], v86, s[12:15], 0 offen sc0 sc1
  s_waitcnt vmcnt(0)
  v_min3_i32 v16, v33, v35, v37
  v_min3_i32 v17, v39, v41, v43
  v_min3_i32 v16, v16, v45, v47
  v_min_i32 v16, v16, v17
  v_cmp_gt_i32 vcc, 0, v16
  s_add_u32 s39, s39, 1
  s_cmp_gt_u32 s39, 1000000
  s_cbranch_scc1 k2_pdone
  s_cbranch_vccnz k2_poll
k2_pdone:
  buffer_store_dwordx4 v[96:99], v192, s[20:23], s53 offen sc0 sc1
  buffer_store_dwordx4 v[100:103], v194, s[20:23], s53 offen sc0 sc1
  buffer_store_dwordx4 v[104:107], v193, s[20:23], s53 offen sc0 sc1
  buffer_store_dwordx4 v[108:111], v195, s[20:23], s53 offen sc0 sc1
  v_pk_add_f32 v[32:33], v[32:33], v[34:35]
  v_pk_add_f32 v[36:37], v[36:37], v[38:39]
  v_pk_add_f32 v[40:41], v[40:41], v[42:43]
  v_pk_add_f32 v[44:45], v[44:45], v[46:47]
  v_pk_add_f32 v[32:33], v[32:33], v[36:37]
  v_pk_add_f32 v[40:41], v[40:41], v[44:45]
  v_pk_add_f32 v[32:33], v[32:33], v[40:41]
  v_mov_b32 v34, v32
  v_mov_b32 v35, v33
  s_nop 0
  v_permlane32_swap_b32 v32, v34
  v_permlane32_swap_b32 v33, v35
  v_add_f32 v32, v32, v34
  v_add_f32 v33, v33, v35
  v_mul_f32 v32, 0x3a800000, v32
  v_mul_f32 v33, 0x3a800000, v33
  v_fma_f32 v33, -v32, v32, v33
  v_max_f32 v33, 0, v33
  v_mov_b32 v36, v33
  v_cvt_pk_bf16_f32 v36, v36, v36
  v_lshlrev_b32 v36, 16, v36
  v_add_f32 v36, 0x3727c5ac, v36
  v_cvt_pk_bf16_f32 v36, v36, v36
  v_lshlrev_b32 v36, 16, v36
  v_sqrt_f32 v36, v36
  s_nop 0
  v_cvt_pk_bf16_f32 v36, v36, v36
  v_lshlrev_b32 v36, 16, v36
  v_rcp_f32 v36, v36
  s_nop 0
  v_mul_f32 v33, v33, v36
  v_mul_f32 v33, v33, v36
  v_cvt_pk_bf16_f32 v33, v33, v33
  v_lshlrev_b32 v33, 16, v33
  v_add_f32 v33, 0x3727c5ac, v33
  v_cvt_pk_bf16_f32 v33, v33, v33
  v_lshlrev_b32 v33, 16, v33
  v_sqrt_f32 v33, v33
  s_nop 0
  v_cvt_pk_bf16_f32 v33, v33, v33
  v_lshlrev_b32 v33, 16, v33
  v_rcp_f32 v33, v33
  s_nop 0
  v_mul_f32 v33, v33, v36
  v_mov_b32 v34, v32
  v_mov_b32 v35, v33
  s_nop 0
  v_permlane16_swap_b32 v32, v34
  v_permlane16_swap_b32 v33, v35
  v_pk_add_f32 v[48:49], v[48:49], v[32:33] op_sel_hi:[1,0] neg_lo:[0,1] neg_hi:[0,1]
  v_pk_add_f32 v[50:51], v[50:51], v[32:33] op_sel_hi:[1,0] neg_lo:[0,1] neg_hi:[0,1]
  v_pk_add_f32 v[52:53], v[52:53], v[32:33] op_sel_hi:[1,0] neg_lo:[0,1] neg_hi:[0,1]
  v_pk_add_f32 v[54:55], v[54:55], v[32:33] op_sel_hi:[1,0] neg_lo:[0,1] neg_hi:[0,1]
  v_pk_add_f32 v[56:57], v[56:57], v[32:33] op_sel_hi:[1,0] neg_lo:[0,1] neg_hi:[0,1]
  v_pk_add_f32 v[58:59], v[58:59], v[32:33] op_sel_hi:[1,0] neg_lo:[0,1] neg_hi:[0,1]
  v_pk_add_f32 v[60:61], v[60:61], v[32:33] op_sel_hi:[1,0] neg_lo:[0,1] neg_hi:[0,1]
  v_pk_add_f32 v[62:63], v[62:63], v[32:33] op_sel_hi:[1,0] neg_lo:[0,1] neg_hi:[0,1]
  v_pk_mul_f32 v[48:49], v[48:49], v[32:33] op_sel:[0,1] op_sel_hi:[1,1]
  v_pk_mul_f32 v[50:51], v[50:51], v[32:33] op_sel:[0,1] op_sel_hi:[1,1]
  v_pk_mul_f32 v[52:53], v[52:53], v[32:33] op_sel:[0,1] op_sel_hi:[1,1]
  v_pk_mul_f32 v[54:55], v[54:55], v[32:33] op_sel:[0,1] op_sel_hi:[1,1]
  v_pk_mul_f32 v[56:57], v[56:57], v[32:33] op_sel:[0,1] op_sel_hi:[1,1]
  v_pk_mul_f32 v[58:59], v[58:59], v[32:33] op_sel:[0,1] op_sel_hi:[1,1]
  v_pk_mul_f32 v[60:61], v[60:61], v[32:33] op_sel:[0,1] op_sel_hi:[1,1]
  v_pk_mul_f32 v[62:63], v[62:63], v[32:33] op_sel:[0,1] op_sel_hi:[1,1]
  v_cvt_pk_bf16_f32 v160, v48, v49
  v_cvt_pk_bf16_f32 v161, v50, v51
  ds_write_b64 v120, v[160:161] offset:0
  v_cvt_pk_bf16_f32 v162, v52, v53
  v_cvt_pk_bf16_f32 v163, v54, v55
  ds_write_b64 v121, v[162:163] offset:0
  v_cvt_pk_bf16_f32 v164, v56, v57
  v_cvt_pk_bf16_f32 v165, v58, v59
  ds_write_b64 v122, v[164:165] offset:0
  v_cvt_pk_bf16_f32 v166, v60, v61
  v_cvt_pk_bf16_f32 v167, v62, v63
  ds_write_b64 v123, v[166:167] offset:0
  v_pk_add_f32 v[64:65], v[64:65], v[34:35] op_sel_hi:[1,0] neg_lo:[0,1] neg_hi:[0,1]
  v_pk_add_f32 v[66:67], v[66:67], v[34:35] op_sel_hi:[1,0] neg_lo:[0,1] neg_hi:[0,1]
  v_pk_add_f32 v[68:69], v[68:69], v[34:35] op_sel_hi:[1,0] neg_lo:[0,1] neg_hi:[0,1]
  v_pk_add_f32 v[70:71], v[70:71], v[34:35] op_sel_hi:[1,0] neg_lo:[0,1] neg_hi:[0,1]
  v_pk_add_f32 v[72:73], v[72:73], v[34:35] op_sel_hi:[1,0] neg_lo:[0,1] neg_hi:[0,1]
  v_pk_add_f32 v[74:75], v[74:75], v[34:35] op_sel_hi:[1,0] neg_lo:[0,1] neg_hi:[0,1]
  v_pk_add_f32 v[76:77], v[76:77], v[34:35] op_sel_hi:[1,0] neg_lo:[0,1] neg_hi:[0,1]
  v_pk_add_f32 v[78:79], v[78:79], v[34:35] op_sel_hi:[1,0] neg_lo:[0,1] neg_hi:[0,1]
  v_pk_mul_f32 v[64:65], v[64:65], v[34:35] op_sel:[0,1] op_sel_hi:[1,1]
  v_pk_mul_f32 v[66:67], v[66:67], v[34:35] op_sel:[0,1] op_sel_hi:[1,1]
  v_pk_mul_f32 v[68:69], v[68:69], v[34:35] op_sel:[0,1] op_sel_hi:[1,1]
  v_pk_mul_f32 v[70:71], v[70:71], v[34:35] op_sel:[0,1] op_sel_hi:[1,1]
  v_pk_mul_f32 v[72:73], v[72:73], v[34:35] op_sel:[0,1] op_sel_hi:[1,1]
  v_pk_mul_f32 v[74:75], v[74:75], v[34:35] op_sel:[0,1] op_sel_hi:[1,1]
  v_pk_mul_f32 v[76:77], v[76:77], v[34:35] op_sel:[0,1] op_sel_hi:[1,1]
  v_pk_mul_f32 v[78:79], v[78:79], v[34:35] op_sel:[0,1] op_sel_hi:[1,1]
  v_cvt_pk_bf16_f32 v168, v64, v65
  v_cvt_pk_bf16_f32 v169, v66, v67
  ds_write_b64 v120, v[168:169] offset:128
  v_cvt_pk_bf16_f32 v170, v68, v69
  v_cvt_pk_bf16_f32 v171, v70, v71
  ds_write_b64 v121, v[170:171] offset:128
  v_cvt_pk_bf16_f32 v172, v72, v73
  v_cvt_pk_bf16_f32 v173, v74, v75
  ds_write_b64 v122, v[172:173] offset:128
  v_cvt_pk_bf16_f32 v174, v76, v77
  v_cvt_pk_bf16_f32 v175, v78, v79
  ds_write_b64 v123, v[174:175] offset:128
  s_waitcnt lgkmcnt(0)
  ds_read_b64_tr_b16 v[176:177], v115
  ds_read_b64_tr_b16 v[178:179], v115 offset:512
  ds_read_b64_tr_b16 v[180:181], v116
  ds_read_b64_tr_b16 v[182:183], v116 offset:512
  ds_read_b64_tr_b16 v[184:185], v117
  ds_read_b64_tr_b16 v[186:187], v117 offset:512
  ds_read_b64_tr_b16 v[188:189], v118
  ds_read_b64_tr_b16 v[190:191], v118 offset:512
  s_waitcnt lgkmcnt(6)
  buffer_store_dwordx4 v[176:179], v92, s[24:27], s44 offen sc0 sc1
  s_waitcnt lgkmcnt(4)
  buffer_store_dwordx4 v[180:183], v93, s[24:27], s45 offen sc0 sc1
  s_waitcnt lgkmcnt(2)
  buffer_store_dwordx4 v[184:187], v92, s[24:27], s46 offen sc0 sc1
  s_waitcnt lgkmcnt(0)
  buffer_store_dwordx4 v[188:191], v93, s[24:27], s47 offen sc0 sc1
  s_cmp_ge_u32 s2, 224
  s_cbranch_scc1 C_k3skip
  s_lshr_b32 s32, s2, 3
  s_mul_i32 s5, s32, 9363
  s_lshr_b32 s5, s5, 16
  s_mul_i32 s6, s5, 7
  s_sub_u32 s6, s32, s6
  s_lshl_b32 s7, s5, 1
  s_add_u32 s7, s7, s6
  s_and_b32 s7, s7, 7
  s_and_b32 s32, s2, 7
  s_lshr_b32 s28, s32, 2
  s_lshl_b32 s28, s28, 2
  s_add_u32 s28, s28, s5
  s_and_b32 s29, s32, 3
  s_mul_i32 s29, s29, 7
  s_add_u32 s29, s29, s6
  s_mov_b32 s30, 7
  s_mov_b32 s31, -1
  s_and_b32 s46, s4, 1
  s_lshr_b32 s41, s4, 1
  s_lshl_b32 s32, s29, 8
  s_lshl_b32 s44, s46, 7
  s_add_u32 s32, s32, s44
  v_lshlrev_b32 v16, 3, v5
  v_add_u32 v16, s32, v16
  s_mov_b32 s16, s74
  s_mov_b32 s17, s75
  s_mov_b32 s18, 7168
  s_mov_b32 s19, 0x20000
  v_mov_b32 v155, v16
  s_add_u32 s20, s82, 25165824
  s_addc_u32 s21, s83, 0
  s_mov_b32 s22, 14680064
  s_mov_b32 s23, 0x20000
  v_lshl_add_u32 v17, v5, 3, v6
  v_lshlrev_b32 v17, 8, v17
  v_lshl_add_u32 v17, v7, 3, v17
  v_lshl_or_b32 v18, v2, 2, v6
  v_lshl_add_u32 v17, v18, 5, v17
  s_lshl_b32 s32, s46, 7
  s_add_u32 s32, s32, 16384
  v_xor_b32 v18, s32, v17
  s_lshl_b32 s32, s41, 13
  v_add_u32 v12, s32, v14
  v_xor_b32 v8, 0, v18
  v_xor_b32 v9, 32, v18
  v_xor_b32 v10, 64, v18
  v_xor_b32 v11, 96, v18
  s_mov_b32 s40, s46
  v_bfe_u32 v19, v4, 2, 1
  v_lshlrev_b32 v17, 11, v19
  v_lshl_add_u32 v17, v3, 8, v17
  v_lshrrev_b32 v18, 3, v4
  v_lshl_add_u32 v17, v18, 6, v17
  v_lshl_add_u32 v152, v7, 4, v17
  v_add_u32 v153, 128, v152
  v_cmp_eq_u32 vcc, 1, v3
  v_lshlrev_b32 v17, 7, v19
  v_add_u32 v18, 640, v17
  v_lshlrev_b32 v17, 8, v19
  v_add_u32 v17, 896, v17
  v_cndmask_b32 v18, 0, v18, vcc
  v_cndmask_b32 v17, 0, v17, vcc
  v_add_u32 v154, v153, v17
  v_add_u32 v153, v153, v18
  s_lshl_b32 s32, s28, 1
  s_add_u32 s32, s32, s41
  s_mul_i32 s32, s32, 224
  s_lshl_b32 s44, s29, 2
  s_add_u32 s32, s32, s44
  s_lshl_b32 s44, s40, 1
  s_add_u32 s32, s32, s44
  s_lshl_b32 s44, s32, 12
  s_add_u32 s45, s44, 458752
  s_add_u32 s46, s44, 4096
  s_add_u32 s47, s45, 4096
  s_lshl_b32 s32, s4, 13
  s_add_u32 s32, s32, 65536
  v_add_u32 v13, s32, v14
  s_waitcnt vmcnt(0)
  s_barrier
  buffer_load_dwordx2 v[144:145], v155, s[16:19], 0 offen offset:0
  buffer_load_dwordx2 v[146:147], v155, s[16:19], 0 offen offset:32
  buffer_load_dwordx2 v[148:149], v155, s[16:19], 0 offen offset:64
  buffer_load_dwordx2 v[150:151], v155, s[16:19], 0 offen offset:96
  s_waitcnt vmcnt(0)
  v_lshlrev_b32 v80, 16, v144
  v_and_b32 v81, 0xffff0000, v144
  v_lshlrev_b32 v82, 16, v145
  v_and_b32 v83, 0xffff0000, v145
  v_mov_b64 v[96:97], v[80:81]
  v_mov_b64 v[98:99], v[82:83]
  v_mov_b64 v[112:113], v[80:81]
  v_mov_b64 v[114:115], v[82:83]
  v_mov_b64 v[128:129], v[80:81]
  v_mov_b64 v[130:131], v[82:83]
  v_lshlrev_b32 v84, 16, v146
  v_and_b32 v85, 0xffff0000, v146
  v_lshlrev_b32 v86, 16, v147
  v_and_b32 v87, 0xffff0000, v147
  v_mov_b64 v[100:101], v[84:85]
  v_mov_b64 v[102:103], v[86:87]
  v_mov_b64 v[116:117], v[84:85]
  v_mov_b64 v[118:119], v[86:87]
  v_mov_b64 v[132:133], v[84:85]
  v_mov_b64 v[134:135], v[86:87]
  v_lshlrev_b32 v88, 16, v148
  v_and_b32 v89, 0xffff0000, v148
  v_lshlrev_b32 v90, 16, v149
  v_and_b32 v91, 0xffff0000, v149
  v_mov_b64 v[104:105], v[88:89]
  v_mov_b64 v[106:107], v[90:91]
  v_mov_b64 v[120:121], v[88:89]
  v_mov_b64 v[122:123], v[90:91]
  v_mov_b64 v[136:137], v[88:89]
  v_mov_b64 v[138:139], v[90:91]
  v_lshlrev_b32 v92, 16, v150
  v_and_b32 v93, 0xffff0000, v150
  v_lshlrev_b32 v94, 16, v151
  v_and_b32 v95, 0xffff0000, v151
  v_mov_b64 v[108:109], v[92:93]
  v_mov_b64 v[110:111], v[94:95]
  v_mov_b64 v[124:125], v[92:93]
  v_mov_b64 v[126:127], v[94:95]
  v_mov_b64 v[140:141], v[92:93]
  v_mov_b64 v[142:143], v[94:95]
  s_barrier
  s_mov_b32 s43, 0
  s_mov_b32 s39, 15
  s_add_u32 s40, s43, 32768
  s_cmp_eq_u32 s40, 163840
  s_cselect_b32 s40, 0, s40
  s_sub_u32 s42, s40, s43
  s_mov_b32 s43, s40
  s_barrier
  ds_read_b64_tr_b16 v[16:17], v8 offset:0
  ds_read_b64_tr_b16 v[18:19], v8 offset:1024
  ds_read_b128 v[32:35], v12 offset:0
  ds_read_b64_tr_b16 v[48:49], v8 offset:8192
  ds_read_b64_tr_b16 v[50:51], v8 offset:9216
  ds_read_b128 v[64:67], v12 offset:1024
  ds_read_b128 v[68:71], v12 offset:3072
  ds_read_b128 v[36:39], v12 offset:2048
  ds_read_b64_tr_b16 v[20:21], v9 offset:0
  ds_read_b64_tr_b16 v[22:23], v9 offset:1024
  ds_read_b64_tr_b16 v[52:53], v9 offset:8192
  ds_read_b64_tr_b16 v[54:55], v9 offset:9216
  ds_read_b64_tr_b16 v[24:25], v10 offset:0
  ds_read_b64_tr_b16 v[26:27], v10 offset:1024
  ds_read_b64_tr_b16 v[56:57], v10 offset:8192
  ds_read_b64_tr_b16 v[58:59], v10 offset:9216
  ds_read_b128 v[40:43], v12 offset:4096
  ds_read_b128 v[72:75], v12 offset:5120
  ds_read_b128 v[76:79], v12 offset:7168
  ds_read_b128 v[44:47], v12 offset:6144
  ds_read_b64_tr_b16 v[28:29], v11 offset:0
  ds_read_b64_tr_b16 v[30:31], v11 offset:1024
  ds_read_b64_tr_b16 v[60:61], v11 offset:8192
  ds_read_b64_tr_b16 v[62:63], v11 offset:9216
  v_add_u32 v8, s42, v8
  v_add_u32 v9, s42, v9
  v_add_u32 v10, s42, v10
  v_add_u32 v11, s42, v11
  v_add_u32 v12, s42, v12
cf4:
  s_barrier
  s_waitcnt lgkmcnt(14)
  v_mfma_f32_16x16x32_bf16 v[80:83], v[16:19], v[32:35], v[80:83]
  ds_read_b64_tr_b16 v[156:157], v8 offset:0
  s_add_u32 s40, s43, 32768
  s_cmp_eq_u32 s40, 163840
  v_mfma_f32_16x16x32_bf16 v[80:83], v[48:51], v[64:67], v[80:83]
  ds_read_b64_tr_b16 v[158:159], v8 offset:1024
  s_cselect_b32 s40, 0, s40
  s_sub_u32 s42, s40, s43
  v_mfma_f32_16x16x32_bf16 v[96:99], v[48:51], v[68:71], v[96:99]
  ds_read_b128 v[172:175], v12 offset:0
  s_mov_b32 s43, s40
  v_mfma_f32_16x16x32_bf16 v[96:99], v[16:19], v[36:39], v[96:99]
  ds_read_b64_tr_b16 v[188:189], v8 offset:8192
  v_mfma_f32_16x16x32_bf16 v[100:103], v[20:23], v[36:39], v[100:103]
  ds_read_b64_tr_b16 v[190:191], v8 offset:9216
  v_add_u32 v8, s42, v8
  s_waitcnt lgkmcnt(14)
  v_mfma_f32_16x16x32_bf16 v[100:103], v[52:55], v[68:71], v[100:103]
  ds_read_b128 v[204:207], v12 offset:1024
  v_mfma_f32_16x16x32_bf16 v[84:87], v[52:55], v[64:67], v[84:87]
  ds_read_b128 v[208:211], v12 offset:3072
  v_mfma_f32_16x16x32_bf16 v[84:87], v[20:23], v[32:35], v[84:87]
  ds_read_b128 v[176:179], v12 offset:2048
  v_mfma_f32_16x16x32_bf16 v[88:91], v[24:27], v[32:35], v[88:91]
  ds_read_b64_tr_b16 v[160:161], v9 offset:0
  s_waitcnt lgkmcnt(14)
  v_mfma_f32_16x16x32_bf16 v[88:91], v[56:59], v[64:67], v[88:91]
  ds_read_b64_tr_b16 v[162:163], v9 offset:1024
  v_mfma_f32_16x16x32_bf16 v[104:107], v[56:59], v[68:71], v[104:107]
  ds_read_b64_tr_b16 v[192:193], v9 offset:8192
  v_mfma_f32_16x16x32_bf16 v[104:107], v[24:27], v[36:39], v[104:107]
  ds_read_b64_tr_b16 v[194:195], v9 offset:9216
  v_add_u32 v9, s42, v9
  v_mfma_f32_16x16x32_bf16 v[120:123], v[24:27], v[40:43], v[120:123]
  ds_read_b64_tr_b16 v[164:165], v10 offset:0
  v_mfma_f32_16x16x32_bf16 v[120:123], v[56:59], v[72:75], v[120:123]
  ds_read_b64_tr_b16 v[166:167], v10 offset:1024
  v_mfma_f32_16x16x32_bf16 v[116:119], v[52:55], v[72:75], v[116:119]
  ds_read_b64_tr_b16 v[196:197], v10 offset:8192
  v_mfma_f32_16x16x32_bf16 v[116:119], v[20:23], v[40:43], v[116:119]
  ds_read_b64_tr_b16 v[198:199], v10 offset:9216
  v_add_u32 v10, s42, v10
  v_mfma_f32_16x16x32_bf16 v[112:115], v[16:19], v[40:43], v[112:115]
  ds_read_b128 v[180:183], v12 offset:4096
  v_mfma_f32_16x16x32_bf16 v[112:115], v[48:51], v[72:75], v[112:115]
  ds_read_b128 v[212:215], v12 offset:5120
  v_mfma_f32_16x16x32_bf16 v[128:131], v[48:51], v[76:79], v[128:131]
  ds_read_b128 v[216:219], v12 offset:7168
  s_waitcnt lgkmcnt(14)
  v_mfma_f32_16x16x32_bf16 v[128:131], v[16:19], v[44:47], v[128:131]
  ds_read_b128 v[184:187], v12 offset:6144
  v_add_u32 v12, s42, v12
  v_mfma_f32_16x16x32_bf16 v[132:135], v[20:23], v[44:47], v[132:135]
  ds_read_b64_tr_b16 v[168:169], v11 offset:0
  v_mfma_f32_16x16x32_bf16 v[132:135], v[52:55], v[76:79], v[132:135]
  ds_read_b64_tr_b16 v[170:171], v11 offset:1024
  v_mfma_f32_16x16x32_bf16 v[136:139], v[56:59], v[76:79], v[136:139]
  ds_read_b64_tr_b16 v[200:201], v11 offset:8192
  v_mfma_f32_16x16x32_bf16 v[136:139], v[24:27], v[44:47], v[136:139]
  ds_read_b64_tr_b16 v[202:203], v11 offset:9216
  v_add_u32 v11, s42, v11
  v_mfma_f32_16x16x32_bf16 v[140:143], v[28:31], v[44:47], v[140:143]
  v_mfma_f32_16x16x32_bf16 v[140:143], v[60:63], v[76:79], v[140:143]
  v_mfma_f32_16x16x32_bf16 v[124:127], v[60:63], v[72:75], v[124:127]
  v_mfma_f32_16x16x32_bf16 v[124:127], v[28:31], v[40:43], v[124:127]
  v_mfma_f32_16x16x32_bf16 v[108:111], v[28:31], v[36:39], v[108:111]
  v_mfma_f32_16x16x32_bf16 v[108:111], v[60:63], v[68:71], v[108:111]
  v_mfma_f32_16x16x32_bf16 v[92:95], v[60:63], v[64:67], v[92:95]
  v_mfma_f32_16x16x32_bf16 v[92:95], v[28:31], v[32:35], v[92:95]
  s_barrier
  s_waitcnt lgkmcnt(14)
  v_mfma_f32_16x16x32_bf16 v[80:83], v[156:159], v[172:175], v[80:83]
  ds_read_b64_tr_b16 v[16:17], v8 offset:0
  s_add_u32 s40, s43, 32768
  s_cmp_eq_u32 s40, 163840
  v_mfma_f32_16x16x32_bf16 v[80:83], v[188:191], v[204:207], v[80:83]
  ds_read_b64_tr_b16 v[18:19], v8 offset:1024
  s_cselect_b32 s40, 0, s40
  s_sub_u32 s42, s40, s43
  v_mfma_f32_16x16x32_bf16 v[96:99], v[188:191], v[208:211], v[96:99]
  ds_read_b128 v[32:35], v12 offset:0
  s_mov_b32 s43, s40
  v_mfma_f32_16x16x32_bf16 v[96:99], v[156:159], v[176:179], v[96:99]
  ds_read_b64_tr_b16 v[48:49], v8 offset:8192
  v_mfma_f32_16x16x32_bf16 v[100:103], v[160:163], v[176:179], v[100:103]
  ds_read_b64_tr_b16 v[50:51], v8 offset:9216
  v_add_u32 v8, s42, v8
  s_waitcnt lgkmcnt(14)
  v_mfma_f32_16x16x32_bf16 v[100:103], v[192:195], v[208:211], v[100:103]
  ds_read_b128 v[64:67], v12 offset:1024
  v_mfma_f32_16x16x32_bf16 v[84:87], v[192:195], v[204:207], v[84:87]
  ds_read_b128 v[68:71], v12 offset:3072
  v_mfma_f32_16x16x32_bf16 v[84:87], v[160:163], v[172:175], v[84:87]
  ds_read_b128 v[36:39], v12 offset:2048
  v_mfma_f32_16x16x32_bf16 v[88:91], v[164:167], v[172:175], v[88:91]
  ds_read_b64_tr_b16 v[20:21], v9 offset:0
  s_waitcnt lgkmcnt(14)
  v_mfma_f32_16x16x32_bf16 v[88:91], v[196:199], v[204:207], v[88:91]
  ds_read_b64_tr_b16 v[22:23], v9 offset:1024
  v_mfma_f32_16x16x32_bf16 v[104:107], v[196:199], v[208:211], v[104:107]
  ds_read_b64_tr_b16 v[52:53], v9 offset:8192
  v_mfma_f32_16x16x32_bf16 v[104:107], v[164:167], v[176:179], v[104:107]
  ds_read_b64_tr_b16 v[54:55], v9 offset:9216
  v_add_u32 v9, s42, v9
  v_mfma_f32_16x16x32_bf16 v[120:123], v[164:167], v[180:183], v[120:123]
  ds_read_b64_tr_b16 v[24:25], v10 offset:0
  v_mfma_f32_16x16x32_bf16 v[120:123], v[196:199], v[212:215], v[120:123]
  ds_read_b64_tr_b16 v[26:27], v10 offset:1024
  v_mfma_f32_16x16x32_bf16 v[116:119], v[192:195], v[212:215], v[116:119]
  ds_read_b64_tr_b16 v[56:57], v10 offset:8192
  v_mfma_f32_16x16x32_bf16 v[116:119], v[160:163], v[180:183], v[116:119]
  ds_read_b64_tr_b16 v[58:59], v10 offset:9216
  v_add_u32 v10, s42, v10
  v_mfma_f32_16x16x32_bf16 v[112:115], v[156:159], v[180:183], v[112:115]
  ds_read_b128 v[40:43], v12 offset:4096
  v_mfma_f32_16x16x32_bf16 v[112:115], v[188:191], v[212:215], v[112:115]
  ds_read_b128 v[72:75], v12 offset:5120
  v_mfma_f32_16x16x32_bf16 v[128:131], v[188:191], v[216:219], v[128:131]
  ds_read_b128 v[76:79], v12 offset:7168
  s_waitcnt lgkmcnt(14)
  v_mfma_f32_16x16x32_bf16 v[128:131], v[156:159], v[184:187], v[128:131]
  ds_read_b128 v[44:47], v12 offset:6144
  v_add_u32 v12, s42, v12
  v_mfma_f32_16x16x32_bf16 v[132:135], v[160:163], v[184:187], v[132:135]
  ds_read_b64_tr_b16 v[28:29], v11 offset:0
  v_mfma_f32_16x16x32_bf16 v[132:135], v[192:195], v[216:219], v[132:135]
  ds_read_b64_tr_b16 v[30:31], v11 offset:1024
  v_mfma_f32_16x16x32_bf16 v[136:139], v[196:199], v[216:219], v[136:139]
  ds_read_b64_tr_b16 v[60:61], v11 offset:8192
  v_mfma_f32_16x16x32_bf16 v[136:139], v[164:167], v[184:187], v[136:139]
  ds_read_b64_tr_b16 v[62:63], v11 offset:9216
  v_add_u32 v11, s42, v11
  v_mfma_f32_16x16x32_bf16 v[140:143], v[168:171], v[184:187], v[140:143]
  v_mfma_f32_16x16x32_bf16 v[140:143], v[200:203], v[216:219], v[140:143]
  v_mfma_f32_16x16x32_bf16 v[124:127], v[200:203], v[212:215], v[124:127]
  v_mfma_f32_16x16x32_bf16 v[124:127], v[168:171], v[180:183], v[124:127]
  v_mfma_f32_16x16x32_bf16 v[108:111], v[168:171], v[176:179], v[108:111]
  v_mfma_f32_16x16x32_bf16 v[108:111], v[200:203], v[208:211], v[108:111]
  v_mfma_f32_16x16x32_bf16 v[92:95], v[200:203], v[204:207], v[92:95]
  v_mfma_f32_16x16x32_bf16 v[92:95], v[168:171], v[172:175], v[92:95]
  s_sub_u32 s39, s39, 1
  s_cmp_lg_u32 s39, 0
  s_cbranch_scc1 cf4
  s_barrier
  s_waitcnt lgkmcnt(14)
  v_mfma_f32_16x16x32_bf16 v[80:83], v[16:19], v[32:35], v[80:83]
  ds_read_b64_tr_b16 v[156:157], v8 offset:0
  s_add_u32 s40, s43, 32768
  s_cmp_eq_u32 s40, 163840
  v_mfma_f32_16x16x32_bf16 v[80:83], v[48:51], v[64:67], v[80:83]
  ds_read_b64_tr_b16 v[158:159], v8 offset:1024
  s_cselect_b32 s40, 0, s40
  s_sub_u32 s42, s40, s43
  v_mfma_f32_16x16x32_bf16 v[96:99], v[48:51], v[68:71], v[96:99]
  ds_read_b128 v[172:175], v12 offset:0
  s_mov_b32 s43, s40
  v_mfma_f32_16x16x32_bf16 v[96:99], v[16:19], v[36:39], v[96:99]
  ds_read_b64_tr_b16 v[188:189], v8 offset:8192
  v_mfma_f32_16x16x32_bf16 v[100:103], v[20:23], v[36:39], v[100:103]
  ds_read_b64_tr_b16 v[190:191], v8 offset:9216
  v_add_u32 v8, s42, v8
  s_waitcnt lgkmcnt(14)
  v_mfma_f32_16x16x32_bf16 v[100:103], v[52:55], v[68:71], v[100:103]
  ds_read_b128 v[204:207], v12 offset:1024
  v_mfma_f32_16x16x32_bf16 v[84:87], v[52:55], v[64:67], v[84:87]
  ds_read_b128 v[208:211], v12 offset:3072
  v_mfma_f32_16x16x32_bf16 v[84:87], v[20:23], v[32:35], v[84:87]
  ds_read_b128 v[176:179], v12 offset:2048
  v_mfma_f32_16x16x32_bf16 v[88:91], v[24:27], v[32:35], v[88:91]
  ds_read_b64_tr_b16 v[160:161], v9 offset:0
  s_waitcnt lgkmcnt(14)
  v_mfma_f32_16x16x32_bf16 v[88:91], v[56:59], v[64:67], v[88:91]
  ds_read_b64_tr_b16 v[162:163], v9 offset:1024
  v_mfma_f32_16x16x32_bf16 v[104:107], v[56:59], v[68:71], v[104:107]
  ds_read_b64_tr_b16 v[192:193], v9 offset:8192
  v_mfma_f32_16x16x32_bf16 v[104:107], v[24:27], v[36:39], v[104:107]
  ds_read_b64_tr_b16 v[194:195], v9 offset:9216
  v_add_u32 v9, s42, v9
  v_mfma_f32_16x16x32_bf16 v[120:123], v[24:27], v[40:43], v[120:123]
  ds_read_b64_tr_b16 v[164:165], v10 offset:0
  v_mfma_f32_16x16x32_bf16 v[120:123], v[56:59], v[72:75], v[120:123]
  ds_read_b64_tr_b16 v[166:167], v10 offset:1024
  v_mfma_f32_16x16x32_bf16 v[116:119], v[52:55], v[72:75], v[116:119]
  ds_read_b64_tr_b16 v[196:197], v10 offset:8192
  v_mfma_f32_16x16x32_bf16 v[116:119], v[20:23], v[40:43], v[116:119]
  ds_read_b64_tr_b16 v[198:199], v10 offset:9216
  v_add_u32 v10, s42, v10
  v_mfma_f32_16x16x32_bf16 v[112:115], v[16:19], v[40:43], v[112:115]
  ds_read_b128 v[180:183], v12 offset:4096
  v_mfma_f32_16x16x32_bf16 v[112:115], v[48:51], v[72:75], v[112:115]
  ds_read_b128 v[212:215], v12 offset:5120
  v_mfma_f32_16x16x32_bf16 v[128:131], v[48:51], v[76:79], v[128:131]
  ds_read_b128 v[216:219], v12 offset:7168
  s_waitcnt lgkmcnt(14)
  v_mfma_f32_16x16x32_bf16 v[128:131], v[16:19], v[44:47], v[128:131]
  ds_read_b128 v[184:187], v12 offset:6144
  v_add_u32 v12, s42, v12
  v_mfma_f32_16x16x32_bf16 v[132:135], v[20:23], v[44:47], v[132:135]
  ds_read_b64_tr_b16 v[168:169], v11 offset:0
  v_mfma_f32_16x16x32_bf16 v[132:135], v[52:55], v[76:79], v[132:135]
  ds_read_b64_tr_b16 v[170:171], v11 offset:1024
  v_mfma_f32_16x16x32_bf16 v[136:139], v[56:59], v[76:79], v[136:139]
  ds_read_b64_tr_b16 v[200:201], v11 offset:8192
  v_mfma_f32_16x16x32_bf16 v[136:139], v[24:27], v[44:47], v[136:139]
  ds_read_b64_tr_b16 v[202:203], v11 offset:9216
  v_add_u32 v11, s42, v11
  v_mfma_f32_16x16x32_bf16 v[140:143], v[28:31], v[44:47], v[140:143]
  v_mfma_f32_16x16x32_bf16 v[140:143], v[60:63], v[76:79], v[140:143]
  v_mfma_f32_16x16x32_bf16 v[124:127], v[60:63], v[72:75], v[124:127]
  v_mfma_f32_16x16x32_bf16 v[124:127], v[28:31], v[40:43], v[124:127]
  v_mfma_f32_16x16x32_bf16 v[108:111], v[28:31], v[36:39], v[108:111]
  v_mfma_f32_16x16x32_bf16 v[108:111], v[60:63], v[68:71], v[108:111]
  v_mfma_f32_16x16x32_bf16 v[92:95], v[60:63], v[64:67], v[92:95]
  v_mfma_f32_16x16x32_bf16 v[92:95], v[28:31], v[32:35], v[92:95]
  s_waitcnt lgkmcnt(14)
  v_mfma_f32_16x16x32_bf16 v[80:83], v[156:159], v[172:175], v[80:83]
  v_mfma_f32_16x16x32_bf16 v[80:83], v[188:191], v[204:207], v[80:83]
  v_mfma_f32_16x16x32_bf16 v[96:99], v[188:191], v[208:211], v[96:99]
  v_mfma_f32_16x16x32_bf16 v[96:99], v[156:159], v[176:179], v[96:99]
  v_mfma_f32_16x16x32_bf16 v[100:103], v[160:163], v[176:179], v[100:103]
  s_waitcnt lgkmcnt(12)
  v_mfma_f32_16x16x32_bf16 v[100:103], v[192:195], v[208:211], v[100:103]
  v_mfma_f32_16x16x32_bf16 v[84:87], v[192:195], v[204:207], v[84:87]
  v_mfma_f32_16x16x32_bf16 v[84:87], v[160:163], v[172:175], v[84:87]
  s_waitcnt lgkmcnt(10)
  v_mfma_f32_16x16x32_bf16 v[88:91], v[164:167], v[172:175], v[88:91]
  s_waitcnt lgkmcnt(8)
  v_mfma_f32_16x16x32_bf16 v[88:91], v[196:199], v[204:207], v[88:91]
  v_mfma_f32_16x16x32_bf16 v[104:107], v[196:199], v[208:211], v[104:107]
  v_mfma_f32_16x16x32_bf16 v[104:107], v[164:167], v[176:179], v[104:107]
  s_waitcnt lgkmcnt(7)
  v_mfma_f32_16x16x32_bf16 v[120:123], v[164:167], v[180:183], v[120:123]
  s_waitcnt lgkmcnt(6)
  v_mfma_f32_16x16x32_bf16 v[120:123], v[196:199], v[212:215], v[120:123]
  v_mfma_f32_16x16x32_bf16 v[116:119], v[192:195], v[212:215], v[116:119]
  v_mfma_f32_16x16x32_bf16 v[116:119], v[160:163], v[180:183], v[116:119]
  v_mfma_f32_16x16x32_bf16 v[112:115], v[156:159], v[180:183], v[112:115]
  v_mfma_f32_16x16x32_bf16 v[112:115], v[188:191], v[212:215], v[112:115]
  s_waitcnt lgkmcnt(5)
  v_mfma_f32_16x16x32_bf16 v[128:131], v[188:191], v[216:219], v[128:131]
  s_waitcnt lgkmcnt(4)
  v_mfma_f32_16x16x32_bf16 v[128:131], v[156:159], v[184:187], v[128:131]
  v_mfma_f32_16x16x32_bf16 v[132:135], v[160:163], v[184:187], v[132:135]
  v_mfma_f32_16x16x32_bf16 v[132:135], v[192:195], v[216:219], v[132:135]
  v_mfma_f32_16x16x32_bf16 v[136:139], v[196:199], v[216:219], v[136:139]
  v_mfma_f32_16x16x32_bf16 v[136:139], v[164:167], v[184:187], v[136:139]
  s_waitcnt lgkmcnt(2)
  v_mfma_f32_16x16x32_bf16 v[140:143], v[168:171], v[184:187], v[140:143]
  s_waitcnt lgkmcnt(0)
  v_mfma_f32_16x16x32_bf16 v[140:143], v[200:203], v[216:219], v[140:143]
  v_mfma_f32_16x16x32_bf16 v[124:127], v[200:203], v[212:215], v[124:127]
  v_mfma_f32_16x16x32_bf16 v[124:127], v[168:171], v[180:183], v[124:127]
  v_mfma_f32_16x16x32_bf16 v[108:111], v[168:171], v[176:179], v[108:111]
  v_mfma_f32_16x16x32_bf16 v[108:111], v[200:203], v[208:211], v[108:111]
  v_mfma_f32_16x16x32_bf16 v[92:95], v[200:203], v[204:207], v[92:95]
  v_mfma_f32_16x16x32_bf16 v[92:95], v[168:171], v[172:175], v[92:95]
  s_waitcnt lgkmcnt(0)
  v_mov_b32 v16, 0xc0135761
  v_mov_b32 v17, 0xbdd2d3e8
  v_pk_mul_f32 v[24:25], v[80:81], v[80:81]
  v_pk_mul_f32 v[26:27], v[82:83], v[82:83]
  v_pk_mul_f32 v[28:29], v[84:85], v[84:85]
  v_pk_mul_f32 v[30:31], v[86:87], v[86:87]
  v_pk_fma_f32 v[24:25], v[24:25], v[16:17], v[16:17] op_sel:[0,1,0] op_sel_hi:[1,1,0]
  v_pk_fma_f32 v[26:27], v[26:27], v[16:17], v[16:17] op_sel:[0,1,0] op_sel_hi:[1,1,0]
  v_pk_fma_f32 v[28:29], v[28:29], v[16:17], v[16:17] op_sel:[0,1,0] op_sel_hi:[1,1,0]
  v_pk_fma_f32 v[30:31], v[30:31], v[16:17], v[16:17] op_sel:[0,1,0] op_sel_hi:[1,1,0]
  v_pk_mul_f32 v[24:25], v[24:25], v[80:81]
  v_pk_mul_f32 v[26:27], v[26:27], v[82:83]
  v_pk_mul_f32 v[28:29], v[28:29], v[84:85]
  v_pk_mul_f32 v[30:31], v[30:31], v[86:87]
  v_exp_f32 v24, v24
  v_exp_f32 v25, v25
  v_exp_f32 v26, v26
  v_exp_f32 v27, v27
  v_exp_f32 v28, v28
  v_exp_f32 v29, v29
  v_exp_f32 v30, v30
  v_exp_f32 v31, v31
  v_pk_add_f32 v[24:25], v[24:25], 1.0 op_sel_hi:[1,0]
  v_pk_add_f32 v[26:27], v[26:27], 1.0 op_sel_hi:[1,0]
  v_pk_add_f32 v[28:29], v[28:29], 1.0 op_sel_hi:[1,0]
  v_pk_add_f32 v[30:31], v[30:31], 1.0 op_sel_hi:[1,0]
  v_rcp_f32 v24, v24
  v_rcp_f32 v25, v25
  v_rcp_f32 v26, v26
  v_rcp_f32 v27, v27
  v_rcp_f32 v28, v28
  v_rcp_f32 v29, v29
  v_rcp_f32 v30, v30
  v_rcp_f32 v31, v31
  v_pk_mul_f32 v[24:25], v[24:25], v[80:81]
  v_pk_mul_f32 v[26:27], v[26:27], v[82:83]
  v_pk_mul_f32 v[28:29], v[28:29], v[84:85]
  v_pk_mul_f32 v[30:31], v[30:31], v[86:87]
  v_cvt_pk_bf16_f32 v164, v24, v25
  v_cvt_pk_bf16_f32 v165, v26, v27
  v_cvt_pk_bf16_f32 v166, v28, v29
  v_cvt_pk_bf16_f32 v167, v30, v31
  s_nop 0
  v_permlane16_swap_b32 v164, v166
  v_permlane16_swap_b32 v165, v167
  buffer_store_dwordx4 v[164:167], v152, s[20:23], s44 offen sc0 sc1
  v_pk_mul_f32 v[40:41], v[88:89], v[88:89]
  v_pk_mul_f32 v[42:43], v[90:91], v[90:91]
  v_pk_mul_f32 v[44:45], v[92:93], v[92:93]
  v_pk_mul_f32 v[46:47], v[94:95], v[94:95]
  v_pk_fma_f32 v[40:41], v[40:41], v[16:17], v[16:17] op_sel:[0,1,0] op_sel_hi:[1,1,0]
  v_pk_fma_f32 v[42:43], v[42:43], v[16:17], v[16:17] op_sel:[0,1,0] op_sel_hi:[1,1,0]
  v_pk_fma_f32 v[44:45], v[44:45], v[16:17], v[16:17] op_sel:[0,1,0] op_sel_hi:[1,1,0]
  v_pk_fma_f32 v[46:47], v[46:47], v[16:17], v[16:17] op_sel:[0,1,0] op_sel_hi:[1,1,0]
  v_pk_mul_f32 v[40:41], v[40:41], v[88:89]
  v_pk_mul_f32 v[42:43], v[42:43], v[90:91]
  v_pk_mul_f32 v[44:45], v[44:45], v[92:93]
  v_pk_mul_f32 v[46:47], v[46:47], v[94:95]
  v_exp_f32 v40, v40
  v_exp_f32 v41, v41
  v_exp_f32 v42, v42
  v_exp_f32 v43, v43
  v_exp_f32 v44, v44
  v_exp_f32 v45, v45
  v_exp_f32 v46, v46
  v_exp_f32 v47, v47
  v_pk_add_f32 v[40:41], v[40:41], 1.0 op_sel_hi:[1,0]
  v_pk_add_f32 v[42:43], v[42:43], 1.0 op_sel_hi:[1,0]
  v_pk_add_f32 v[44:45], v[44:45], 1.0 op_sel_hi:[1,0]
  v_pk_add_f32 v[46:47], v[46:47], 1.0 op_sel_hi:[1,0]
  v_rcp_f32 v40, v40
  v_rcp_f32 v41, v41
  v_rcp_f32 v42, v42
  v_rcp_f32 v43, v43
  v_rcp_f32 v44, v44
  v_rcp_f32 v45, v45
  v_rcp_f32 v46, v46
  v_rcp_f32 v47, v47
  v_pk_mul_f32 v[40:41], v[40:41], v[88:89]
  v_pk_mul_f32 v[42:43], v[42:43], v[90:91]
  v_pk_mul_f32 v[44:45], v[44:45], v[92:93]
  v_pk_mul_f32 v[46:47], v[46:47], v[94:95]
  v_cvt_pk_bf16_f32 v168, v40, v41
  v_cvt_pk_bf16_f32 v169, v42, v43
  v_cvt_pk_bf16_f32 v170, v44, v45
  v_cvt_pk_bf16_f32 v171, v46, v47
  s_nop 0
  v_permlane16_swap_b32 v168, v170
  v_permlane16_swap_b32 v169, v171
  buffer_store_dwordx4 v[168:171], v152, s[20:23], s46 offen sc0 sc1
  v_pk_mul_f32 v[24:25], v[96:97], v[96:97]
  v_pk_mul_f32 v[26:27], v[98:99], v[98:99]
  v_pk_mul_f32 v[28:29], v[100:101], v[100:101]
  v_pk_mul_f32 v[30:31], v[102:103], v[102:103]
  v_pk_fma_f32 v[24:25], v[24:25], v[16:17], v[16:17] op_sel:[0,1,0] op_sel_hi:[1,1,0]
  v_pk_fma_f32 v[26:27], v[26:27], v[16:17], v[16:17] op_sel:[0,1,0] op_sel_hi:[1,1,0]
  v_pk_fma_f32 v[28:29], v[28:29], v[16:17], v[16:17] op_sel:[0,1,0] op_sel_hi:[1,1,0]
  v_pk_fma_f32 v[30:31], v[30:31], v[16:17], v[16:17] op_sel:[0,1,0] op_sel_hi:[1,1,0]
  v_pk_mul_f32 v[24:25], v[24:25], v[96:97]
  v_pk_mul_f32 v[26:27], v[26:27], v[98:99]
  v_pk_mul_f32 v[28:29], v[28:29], v[100:101]
  v_pk_mul_f32 v[30:31], v[30:31], v[102:103]
  v_exp_f32 v24, v24
  v_exp_f32 v25, v25
  v_exp_f32 v26, v26
  v_exp_f32 v27, v27
  v_exp_f32 v28, v28
  v_exp_f32 v29, v29
  v_exp_f32 v30, v30
  v_exp_f32 v31, v31
  v_pk_add_f32 v[24:25], v[24:25], 1.0 op_sel_hi:[1,0]
  v_pk_add_f32 v[26:27], v[26:27], 1.0 op_sel_hi:[1,0]
  v_pk_add_f32 v[28:29], v[28:29], 1.0 op_sel_hi:[1,0]
  v_pk_add_f32 v[30:31], v[30:31], 1.0 op_sel_hi:[1,0]
  v_rcp_f32 v24, v24
  v_rcp_f32 v25, v25
  v_rcp_f32 v26, v26
  v_rcp_f32 v27, v27
  v_rcp_f32 v28, v28
  v_rcp_f32 v29, v29
  v_rcp_f32 v30, v30
  v_rcp_f32 v31, v31
  v_pk_mul_f32 v[24:25], v[24:25], v[96:97]
  v_pk_mul_f32 v[26:27], v[26:27], v[98:99]
  v_pk_mul_f32 v[28:29], v[28:29], v[100:101]
  v_pk_mul_f32 v[30:31], v[30:31], v[102:103]
  v_cvt_pk_bf16_f32 v172, v24, v25
  v_cvt_pk_bf16_f32 v173, v26, v27
  v_cvt_pk_bf16_f32 v174, v28, v29
  v_cvt_pk_bf16_f32 v175, v30, v31
  s_nop 0
  v_permlane16_swap_b32 v172, v174
  v_permlane16_swap_b32 v173, v175
  buffer_store_dwordx4 v[172:175], v153, s[20:23], s44 offen sc0 sc1
  v_pk_mul_f32 v[40:41], v[104:105], v[104:105]
  v_pk_mul_f32 v[42:43], v[106:107], v[106:107]
  v_pk_mul_f32 v[44:45], v[108:109], v[108:109]
  v_pk_mul_f32 v[46:47], v[110:111], v[110:111]
  v_pk_fma_f32 v[40:41], v[40:41], v[16:17], v[16:17] op_sel:[0,1,0] op_sel_hi:[1,1,0]
  v_pk_fma_f32 v[42:43], v[42:43], v[16:17], v[16:17] op_sel:[0,1,0] op_sel_hi:[1,1,0]
  v_pk_fma_f32 v[44:45], v[44:45], v[16:17], v[16:17] op_sel:[0,1,0] op_sel_hi:[1,1,0]
  v_pk_fma_f32 v[46:47], v[46:47], v[16:17], v[16:17] op_sel:[0,1,0] op_sel_hi:[1,1,0]
  v_pk_mul_f32 v[40:41], v[40:41], v[104:105]
  v_pk_mul_f32 v[42:43], v[42:43], v[106:107]
  v_pk_mul_f32 v[44:45], v[44:45], v[108:109]
  v_pk_mul_f32 v[46:47], v[46:47], v[110:111]
  v_exp_f32 v40, v40
  v_exp_f32 v41, v41
  v_exp_f32 v42, v42
  v_exp_f32 v43, v43
  v_exp_f32 v44, v44
  v_exp_f32 v45, v45
  v_exp_f32 v46, v46
  v_exp_f32 v47, v47
  v_pk_add_f32 v[40:41], v[40:41], 1.0 op_sel_hi:[1,0]
  v_pk_add_f32 v[42:43], v[42:43], 1.0 op_sel_hi:[1,0]
  v_pk_add_f32 v[44:45], v[44:45], 1.0 op_sel_hi:[1,0]
  v_pk_add_f32 v[46:47], v[46:47], 1.0 op_sel_hi:[1,0]
  v_rcp_f32 v40, v40
  v_rcp_f32 v41, v41
  v_rcp_f32 v42, v42
  v_rcp_f32 v43, v43
  v_rcp_f32 v44, v44
  v_rcp_f32 v45, v45
  v_rcp_f32 v46, v46
  v_rcp_f32 v47, v47
  v_pk_mul_f32 v[40:41], v[40:41], v[104:105]
  v_pk_mul_f32 v[42:43], v[42:43], v[106:107]
  v_pk_mul_f32 v[44:45], v[44:45], v[108:109]
  v_pk_mul_f32 v[46:47], v[46:47], v[110:111]
  v_cvt_pk_bf16_f32 v176, v40, v41
  v_cvt_pk_bf16_f32 v177, v42, v43
  v_cvt_pk_bf16_f32 v178, v44, v45
  v_cvt_pk_bf16_f32 v179, v46, v47
  s_nop 0
  v_permlane16_swap_b32 v176, v178
  v_permlane16_swap_b32 v177, v179
  buffer_store_dwordx4 v[176:179], v153, s[20:23], s46 offen sc0 sc1
  v_pk_mul_f32 v[24:25], v[112:113], v[112:113]
  v_pk_mul_f32 v[26:27], v[114:115], v[114:115]
  v_pk_mul_f32 v[28:29], v[116:117], v[116:117]
  v_pk_mul_f32 v[30:31], v[118:119], v[118:119]
  v_pk_fma_f32 v[24:25], v[24:25], v[16:17], v[16:17] op_sel:[0,1,0] op_sel_hi:[1,1,0]
  v_pk_fma_f32 v[26:27], v[26:27], v[16:17], v[16:17] op_sel:[0,1,0] op_sel_hi:[1,1,0]
  v_pk_fma_f32 v[28:29], v[28:29], v[16:17], v[16:17] op_sel:[0,1,0] op_sel_hi:[1,1,0]
  v_pk_fma_f32 v[30:31], v[30:31], v[16:17], v[16:17] op_sel:[0,1,0] op_sel_hi:[1,1,0]
  v_pk_mul_f32 v[24:25], v[24:25], v[112:113]
  v_pk_mul_f32 v[26:27], v[26:27], v[114:115]
  v_pk_mul_f32 v[28:29], v[28:29], v[116:117]
  v_pk_mul_f32 v[30:31], v[30:31], v[118:119]
  v_exp_f32 v24, v24
  v_exp_f32 v25, v25
  v_exp_f32 v26, v26
  v_exp_f32 v27, v27
  v_exp_f32 v28, v28
  v_exp_f32 v29, v29
  v_exp_f32 v30, v30
  v_exp_f32 v31, v31
  v_pk_add_f32 v[24:25], v[24:25], 1.0 op_sel_hi:[1,0]
  v_pk_add_f32 v[26:27], v[26:27], 1.0 op_sel_hi:[1,0]
  v_pk_add_f32 v[28:29], v[28:29], 1.0 op_sel_hi:[1,0]
  v_pk_add_f32 v[30:31], v[30:31], 1.0 op_sel_hi:[1,0]
  v_rcp_f32 v24, v24
  v_rcp_f32 v25, v25
  v_rcp_f32 v26, v26
  v_rcp_f32 v27, v27
  v_rcp_f32 v28, v28
  v_rcp_f32 v29, v29
  v_rcp_f32 v30, v30
  v_rcp_f32 v31, v31
  v_pk_mul_f32 v[24:25], v[24:25], v[112:113]
  v_pk_mul_f32 v[26:27], v[26:27], v[114:115]
  v_pk_mul_f32 v[28:29], v[28:29], v[116:117]
  v_pk_mul_f32 v[30:31], v[30:31], v[118:119]
  v_cvt_pk_bf16_f32 v180, v24, v25
  v_cvt_pk_bf16_f32 v181, v26, v27
  v_cvt_pk_bf16_f32 v182, v28, v29
  v_cvt_pk_bf16_f32 v183, v30, v31
  s_nop 0
  v_permlane16_swap_b32 v180, v182
  v_permlane16_swap_b32 v181, v183
  buffer_store_dwordx4 v[180:183], v152, s[20:23], s45 offen sc0 sc1
  v_pk_mul_f32 v[40:41], v[120:121], v[120:121]
  v_pk_mul_f32 v[42:43], v[122:123], v[122:123]
  v_pk_mul_f32 v[44:45], v[124:125], v[124:125]
  v_pk_mul_f32 v[46:47], v[126:127], v[126:127]
  v_pk_fma_f32 v[40:41], v[40:41], v[16:17], v[16:17] op_sel:[0,1,0] op_sel_hi:[1,1,0]
  v_pk_fma_f32 v[42:43], v[42:43], v[16:17], v[16:17] op_sel:[0,1,0] op_sel_hi:[1,1,0]
  v_pk_fma_f32 v[44:45], v[44:45], v[16:17], v[16:17] op_sel:[0,1,0] op_sel_hi:[1,1,0]
  v_pk_fma_f32 v[46:47], v[46:47], v[16:17], v[16:17] op_sel:[0,1,0] op_sel_hi:[1,1,0]
  v_pk_mul_f32 v[40:41], v[40:41], v[120:121]
  v_pk_mul_f32 v[42:43], v[42:43], v[122:123]
  v_pk_mul_f32 v[44:45], v[44:45], v[124:125]
  v_pk_mul_f32 v[46:47], v[46:47], v[126:127]
  v_exp_f32 v40, v40
  v_exp_f32 v41, v41
  v_exp_f32 v42, v42
  v_exp_f32 v43, v43
  v_exp_f32 v44, v44
  v_exp_f32 v45, v45
  v_exp_f32 v46, v46
  v_exp_f32 v47, v47
  v_pk_add_f32 v[40:41], v[40:41], 1.0 op_sel_hi:[1,0]
  v_pk_add_f32 v[42:43], v[42:43], 1.0 op_sel_hi:[1,0]
  v_pk_add_f32 v[44:45], v[44:45], 1.0 op_sel_hi:[1,0]
  v_pk_add_f32 v[46:47], v[46:47], 1.0 op_sel_hi:[1,0]
  v_rcp_f32 v40, v40
  v_rcp_f32 v41, v41
  v_rcp_f32 v42, v42
  v_rcp_f32 v43, v43
  v_rcp_f32 v44, v44
  v_rcp_f32 v45, v45
  v_rcp_f32 v46, v46
  v_rcp_f32 v47, v47
  v_pk_mul_f32 v[40:41], v[40:41], v[120:121]
  v_pk_mul_f32 v[42:43], v[42:43], v[122:123]
  v_pk_mul_f32 v[44:45], v[44:45], v[124:125]
  v_pk_mul_f32 v[46:47], v[46:47], v[126:127]
  v_cvt_pk_bf16_f32 v184, v40, v41
  v_cvt_pk_bf16_f32 v185, v42, v43
  v_cvt_pk_bf16_f32 v186, v44, v45
  v_cvt_pk_bf16_f32 v187, v46, v47
  s_nop 0
  v_permlane16_swap_b32 v184, v186
  v_permlane16_swap_b32 v185, v187
  buffer_store_dwordx4 v[184:187], v152, s[20:23], s47 offen sc0 sc1
  v_pk_mul_f32 v[24:25], v[128:129], v[128:129]
  v_pk_mul_f32 v[26:27], v[130:131], v[130:131]
  v_pk_mul_f32 v[28:29], v[132:133], v[132:133]
  v_pk_mul_f32 v[30:31], v[134:135], v[134:135]
  v_pk_fma_f32 v[24:25], v[24:25], v[16:17], v[16:17] op_sel:[0,1,0] op_sel_hi:[1,1,0]
  v_pk_fma_f32 v[26:27], v[26:27], v[16:17], v[16:17] op_sel:[0,1,0] op_sel_hi:[1,1,0]
  v_pk_fma_f32 v[28:29], v[28:29], v[16:17], v[16:17] op_sel:[0,1,0] op_sel_hi:[1,1,0]
  v_pk_fma_f32 v[30:31], v[30:31], v[16:17], v[16:17] op_sel:[0,1,0] op_sel_hi:[1,1,0]
  v_pk_mul_f32 v[24:25], v[24:25], v[128:129]
  v_pk_mul_f32 v[26:27], v[26:27], v[130:131]
  v_pk_mul_f32 v[28:29], v[28:29], v[132:133]
  v_pk_mul_f32 v[30:31], v[30:31], v[134:135]
  v_exp_f32 v24, v24
  v_exp_f32 v25, v25
  v_exp_f32 v26, v26
  v_exp_f32 v27, v27
  v_exp_f32 v28, v28
  v_exp_f32 v29, v29
  v_exp_f32 v30, v30
  v_exp_f32 v31, v31
  v_pk_add_f32 v[24:25], v[24:25], 1.0 op_sel_hi:[1,0]
  v_pk_add_f32 v[26:27], v[26:27], 1.0 op_sel_hi:[1,0]
  v_pk_add_f32 v[28:29], v[28:29], 1.0 op_sel_hi:[1,0]
  v_pk_add_f32 v[30:31], v[30:31], 1.0 op_sel_hi:[1,0]
  v_rcp_f32 v24, v24
  v_rcp_f32 v25, v25
  v_rcp_f32 v26, v26
  v_rcp_f32 v27, v27
  v_rcp_f32 v28, v28
  v_rcp_f32 v29, v29
  v_rcp_f32 v30, v30
  v_rcp_f32 v31, v31
  v_pk_mul_f32 v[24:25], v[24:25], v[128:129]
  v_pk_mul_f32 v[26:27], v[26:27], v[130:131]
  v_pk_mul_f32 v[28:29], v[28:29], v[132:133]
  v_pk_mul_f32 v[30:31], v[30:31], v[134:135]
  v_cvt_pk_bf16_f32 v188, v24, v25
  v_cvt_pk_bf16_f32 v189, v26, v27
  v_cvt_pk_bf16_f32 v190, v28, v29
  v_cvt_pk_bf16_f32 v191, v30, v31
  s_nop 0
  v_permlane16_swap_b32 v188, v190
  v_permlane16_swap_b32 v189, v191
  buffer_store_dwordx4 v[188:191], v154, s[20:23], s45 offen sc0 sc1
  v_pk_mul_f32 v[40:41], v[136:137], v[136:137]
  v_pk_mul_f32 v[42:43], v[138:139], v[138:139]
  v_pk_mul_f32 v[44:45], v[140:141], v[140:141]
  v_pk_mul_f32 v[46:47], v[142:143], v[142:143]
  v_pk_fma_f32 v[40:41], v[40:41], v[16:17], v[16:17] op_sel:[0,1,0] op_sel_hi:[1,1,0]
  v_pk_fma_f32 v[42:43], v[42:43], v[16:17], v[16:17] op_sel:[0,1,0] op_sel_hi:[1,1,0]
  v_pk_fma_f32 v[44:45], v[44:45], v[16:17], v[16:17] op_sel:[0,1,0] op_sel_hi:[1,1,0]
  v_pk_fma_f32 v[46:47], v[46:47], v[16:17], v[16:17] op_sel:[0,1,0] op_sel_hi:[1,1,0]
  v_pk_mul_f32 v[40:41], v[40:41], v[136:137]
  v_pk_mul_f32 v[42:43], v[42:43], v[138:139]
  v_pk_mul_f32 v[44:45], v[44:45], v[140:141]
  v_pk_mul_f32 v[46:47], v[46:47], v[142:143]
  v_exp_f32 v40, v40
  v_exp_f32 v41, v41
  v_exp_f32 v42, v42
  v_exp_f32 v43, v43
  v_exp_f32 v44, v44
  v_exp_f32 v45, v45
  v_exp_f32 v46, v46
  v_exp_f32 v47, v47
  v_pk_add_f32 v[40:41], v[40:41], 1.0 op_sel_hi:[1,0]
  v_pk_add_f32 v[42:43], v[42:43], 1.0 op_sel_hi:[1,0]
  v_pk_add_f32 v[44:45], v[44:45], 1.0 op_sel_hi:[1,0]
  v_pk_add_f32 v[46:47], v[46:47], 1.0 op_sel_hi:[1,0]
  v_rcp_f32 v40, v40
  v_rcp_f32 v41, v41
  v_rcp_f32 v42, v42
  v_rcp_f32 v43, v43
  v_rcp_f32 v44, v44
  v_rcp_f32 v45, v45
  v_rcp_f32 v46, v46
  v_rcp_f32 v47, v47
  v_pk_mul_f32 v[40:41], v[40:41], v[136:137]
  v_pk_mul_f32 v[42:43], v[42:43], v[138:139]
  v_pk_mul_f32 v[44:45], v[44:45], v[140:141]
  v_pk_mul_f32 v[46:47], v[46:47], v[142:143]
  v_cvt_pk_bf16_f32 v192, v40, v41
  v_cvt_pk_bf16_f32 v193, v42, v43
  v_cvt_pk_bf16_f32 v194, v44, v45
  v_cvt_pk_bf16_f32 v195, v46, v47
  s_nop 0
  v_permlane16_swap_b32 v192, v194
  v_permlane16_swap_b32 v193, v195
  buffer_store_dwordx4 v[192:195], v154, s[20:23], s47 offen sc0 sc1
C_k3skip:
  s_nop 7
  s_nop 7
  s_lshr_b32 s32, s2, 3
  s_lshr_b32 s5, s32, 3
  s_and_b32 s6, s32, 7
  s_lshl_b32 s7, s5, 1
  s_add_u32 s7, s7, s6
  s_and_b32 s7, s7, 7
  s_and_b32 s32, s2, 7
  s_lshr_b32 s28, s32, 2
  s_lshl_b32 s28, s28, 2
  s_add_u32 s28, s28, s5
  s_and_b32 s29, s32, 3
  s_mul_i32 s29, s29, 8
  s_add_u32 s29, s29, s6
  s_mov_b32 s30, 7
  s_mov_b32 s31, -1
  s_lshl_b32 s32, s29, 6
  v_add_u32 v13, s32, v4
  v_lshlrev_b32 v13, 1, v13
  s_lshl_b32 s40, s4, 4
  s_add_u32 s32, s32, s40
  v_add_u32 v16, s32, v5
  v_lshlrev_b32 v12, 11, v16
  v_lshl_add_u32 v12, v4, 4, v12
  s_lshl_b32 s32, s28, 8
  v_add_u32 v12, s32, v12
  v_lshlrev_b32 v186, 8, v16
  v_and_b32 v17, 7, v0
  v_lshl_add_u32 v186, v17, 4, v186
  v_lshrrev_b32 v17, 3, v4
  v_lshl_add_u32 v186, v17, 19, v186
  s_lshl_b32 s32, s28, 20
  v_add_u32 v186, s32, v186
  v_mul_u32_u24 v189, 272, v4
  v_lshl_add_u32 v189, v5, 4, v189
  s_lshl_b32 s32, s4, 6
  s_add_u32 s32, s32, 1024
  v_add_u32 v189, s32, v189
  v_add_u32 v16, s40, v5
  v_mul_u32_u24 v190, 272, v16
  v_lshl_add_u32 v190, v4, 4, v190
  v_add_u32 v190, 1024, v190
  s_lshl_b32 s34, s28, 2
  s_add_u32 s34, s34, s4
  s_mul_i32 s34, s34, 458752
  s_mov_b32 s45, 8192
  s_mov_b32 s46, 16384
  s_mov_b32 s47, 24576
  v_lshrrev_b32 v16, 1, v4
  v_lshlrev_b32 v16, 4, v16
  v_lshl_add_u32 v16, v3, 8, v16
  v_and_b32 v17, 1, v4
  v_lshl_add_u32 v187, v17, 11, v16
  s_and_b32 s32, s4, 1
  s_lshl_b32 s32, s32, 1
  v_add_u32 v17, s32, v17
  v_cmp_eq_u32 vcc, 3, v17
  s_nop 1
  v_addc_co_u32 v17, vcc, 5, v17, vcc
  v_lshlrev_b32 v17, 7, v17
  v_cmp_eq_u32 vcc, 1, v3
  v_add_u32 v188, 128, v187
  s_nop 0
  v_cndmask_b32 v17, 0, v17, vcc
  v_add_u32 v188, v188, v17
  s_lshl_b32 s44, s29, 6
  s_lshl_b32 s32, s28, 2
  s_add_u32 s44, s44, s32
  s_add_u32 s44, s44, s4
  s_lshl_b32 s44, s44, 12
  s_add_u32 s51, s44, 131072
  s_add_u32 s8, s82, 25165824
  s_addc_u32 s9, s83, 0
  s_mov_b32 s10, 14680064
  s_mov_b32 s11, 0x20000
  s_add_u32 s16, s82, 8388608
  s_addc_u32 s17, s83, 0
  s_mov_b32 s18, 8388608
  s_mov_b32 s19, 0x20000
  s_mov_b32 s12, s78
  s_mov_b32 s13, s79
  s_mov_b32 s14, 4096
  s_mov_b32 s15, 0x20000
  v_lshl_add_u32 v16, v5, 3, v6
  v_lshlrev_b32 v16, 7, v16
  v_lshl_add_u32 v16, v7, 3, v16
  v_lshrrev_b32 v17, 1, v6
  v_lshl_or_b32 v17, v2, 1, v17
  v_lshl_add_u32 v16, v17, 5, v16
  v_add_u32 v16, 65536, v16
  v_xor_b32 v8, 0, v16
  v_xor_b32 v9, 32, v16
  v_xor_b32 v10, 64, v16
  v_xor_b32 v11, 96, v16
  s_lshl_b32 s48, 0x303, s7
  s_lshr_b32 s48, s48, 8
  s_mov_b32 s49, s34
  s_add_u32 s50, s34, 65536
  s_add_u32 s41, s34, 458752
  s_and_b32 s40, s4, 1
  s_lshl_b32 s32, s40, 1
  s_add_u32 s32, s32, 0
  s_cmp_eq_u32 s32, 3
  s_addc_u32 s32, s32, 5
  s_lshl_b32 s32, s32, 7
  s_mov_b32 vcc_lo, 0xff000000
  s_mov_b32 vcc_hi, 0
  v_mov_b32 v88, s32
  v_cndmask_b32 v88, 0, v88, vcc
  v_lshl_add_u32 v88, v0, 4, v88
  v_add_u32 v90, 4096, v88
  s_lshl_b32 s32, s40, 1
  s_add_u32 s32, s32, 1
  s_cmp_eq_u32 s32, 3
  s_addc_u32 s32, s32, 5
  s_lshl_b32 s32, s32, 7
  s_mov_b32 vcc_lo, 0xff000000
  s_mov_b32 vcc_hi, 0
  v_mov_b32 v89, s32
  v_cndmask_b32 v89, 0, v89, vcc
  v_lshl_add_u32 v89, v0, 4, v89
  v_add_u32 v89, 2048, v89
  v_add_u32 v91, 4096, v89
  v_lshlrev_b32 v184, 3, v0
  s_lshl_b32 s32, s4, 9
  s_add_u32 s32, s32, 45056
  v_add_u32 v185, s32, v184
  s_add_u32 s24, s84, 109051904
  s_addc_u32 s25, s85, 0
  s_mov_b32 s26, 524288
  s_mov_b32 s27, 0x20000
  v_min_u32 v15, 27, v0
  s_lshl_b32 s32, s28, 5
  v_add_u32 v15, s32, v15
  v_max_i32 v15, 0, v15
  v_lshlrev_b32 v15, 7, v15
  s_lshl_b32 s55, s3, 17
  s_add_u32 s55, s55, 65536
  s_waitcnt vmcnt(0)
  s_barrier
  buffer_load_ushort v112, v13, s[12:15], 0 offen offset:0
  buffer_load_ushort v114, v13, s[12:15], 0 offen offset:32
  buffer_load_ushort v116, v13, s[12:15], 0 offen offset:64
  buffer_load_ushort v118, v13, s[12:15], 0 offen offset:96
  s_cmp_lt_u32 s2, 224
  s_cbranch_scc1 C_nopf
  s_mov_b32 s20, s72
  s_mov_b32 s21, s73
  s_mov_b32 s22, 14680064
  s_mov_b32 s23, 0x20000
  s_and_b32 s32, s2, 3
  s_mul_i32 s32, s32, 14
  s_sub_u32 s40, 3, s32
  s_and_b32 s40, s40, 7
  v_and_b32 v17, 1, v0
  v_lshlrev_b32 v17, 3, v17
  v_add_u32 v17, s40, v17
  v_cmp_gt_u32 vcc, 14, v17
  v_add_u32 v17, s32, v17
  v_lshlrev_b32 v17, 7, v17
  s_sub_u32 s32, s2, 224
  s_lshr_b32 s32, s32, 3
  s_lshl_b32 s32, s32, 2
  s_add_u32 s32, s32, s4
  s_lshl_b32 s32, s32, 5
  v_lshrrev_b32 v18, 1, v0
  v_add_u32 v18, s32, v18
  v_mul_u32_u24 v18, 7168, v18
  v_add_u32 v17, v17, v18
  v_mov_b32 v18, 0x40000000
  v_cndmask_b32 v17, v18, v17, vcc
  s_mov_b32 s32, 0
  buffer_load_dword v18, v17, s[20:23], s32 offen
  s_add_u32 s32, s32, 3670016
  buffer_load_dword v18, v17, s[20:23], s32 offen
  s_add_u32 s32, s32, 3670016
  buffer_load_dword v18, v17, s[20:23], s32 offen
  s_add_u32 s32, s32, 3670016
  buffer_load_dword v18, v17, s[20:23], s32 offen
  s_add_u32 s32, s32, 3670016
  s_cmp_lg_u32 s3, 0
  s_cbranch_scc1 C_nopf
  s_mov_b32 s20, s76
  s_mov_b32 s21, s77
  s_mov_b32 s22, 14680064
  s_mov_b32 s23, 0x20000
  s_sub_u32 s32, s2, 224
  s_lshl_b32 s32, s32, 2
  s_add_u32 s32, s32, s4
  s_lshl_b32 s32, s32, 13
  v_lshlrev_b32 v17, 7, v0
  s_sleep 127
  buffer_load_dword v18, v17, s[20:23], s32 offen
  s_add_u32 s32, s32, 1048576
  buffer_load_dword v18, v17, s[20:23], s32 offen
  s_add_u32 s32, s32, 1048576
  s_waitcnt vmcnt(1)
  buffer_load_dword v18, v17, s[20:23], s32 offen
  s_add_u32 s32, s32, 1048576
  s_waitcnt vmcnt(1)
  buffer_load_dword v18, v17, s[20:23], s32 offen
  s_add_u32 s32, s32, 1048576
  s_waitcnt vmcnt(1)
  buffer_load_dword v18, v17, s[20:23], s32 offen
  s_add_u32 s32, s32, 1048576
  s_waitcnt vmcnt(1)
  buffer_load_dword v18, v17, s[20:23], s32 offen
  s_add_u32 s32, s32, 1048576
  s_waitcnt vmcnt(1)
  buffer_load_dword v18, v17, s[20:23], s32 offen
  s_add_u32 s32, s32, 1048576
  s_waitcnt vmcnt(1)
  buffer_load_dword v18, v17, s[20:23], s32 offen
  s_add_u32 s32, s32, 1048576
  s_waitcnt vmcnt(1)
  buffer_load_dword v18, v17, s[20:23], s32 offen
  s_add_u32 s32, s32, 1048576
  s_waitcnt vmcnt(1)
  buffer_load_dword v18, v17, s[20:23], s32 offen
  s_add_u32 s32, s32, 1048576
  s_waitcnt vmcnt(1)
  buffer_load_dword v18, v17, s[20:23], s32 offen
  s_add_u32 s32, s32, 1048576
  s_waitcnt vmcnt(1)
  buffer_load_dword v18, v17, s[20:23], s32 offen
  s_add_u32 s32, s32, 1048576
  s_waitcnt vmcnt(1)
  buffer_load_dword v18, v17, s[20:23], s32 offen
  s_add_u32 s32, s32, 1048576
  s_waitcnt vmcnt(1)
  buffer_load_dword v18, v17, s[20:23], s32 offen
  s_add_u32 s32, s32, 1048576
  s_waitcnt vmcnt(1)
C_nopf:
  s_mov_b32 s39, 0
  s_and_b32 s32, s4, 3
  s_cmp_lg_u32 s32, 0
  s_cbranch_scc1 poll5d
  s_sleep 8
poll5:
  buffer_load_dword v16, v15, s[24:27], s55 offen sc0 sc1
  s_waitcnt vmcnt(0)
  v_cmp_eq_u32 vcc, 0, v16
  s_add_u32 s39, s39, 1
  s_cmp_gt_u32 s39, 1000000
  s_cbranch_scc1 poll5d
  s_cbranch_vccnz poll5
poll5d:
  s_barrier
  buffer_load_dwordx4 v[96:99], v187, s[16:19], s44 offen sc1
  buffer_load_dwordx4 v[100:103], v188, s[16:19], s44 offen sc1
  buffer_load_dwordx4 v[104:107], v187, s[16:19], s51 offen sc1
  buffer_load_dwordx4 v[108:111], v188, s[16:19], s51 offen sc1
  s_cmp_eq_u32 s3, 0
  s_cselect_b32 s24, s84, s80
  s_cselect_b32 s25, s85, s81
  s_cselect_b32 s26, 100663296, 0
  s_add_u32 s24, s24, s26
  s_addc_u32 s25, s25, 0
  s_mov_b32 s26, 8388608
  s_mov_b32 s27, 0x20000
  s_lshr_b32 s26, s26, s3
  s_add_u32 s12, s84, 93323264
  s_addc_u32 s13, s85, 0
  s_mov_b32 s14, 262144
  s_mov_b32 s15, 0x20000
  s_bitcmp1_b32 s48, 0
  s_cselect_b32 s36, s50, s49
  s_add_u32 s36, s36, 0
  buffer_load_dwordx4 v[120:123], v88, s[8:11], s36 offen sc1
  buffer_load_dwordx4 v[124:127], v89, s[8:11], s36 offen sc1
  buffer_load_dwordx4 v[128:131], v90, s[8:11], s36 offen sc1
  buffer_load_dwordx4 v[132:135], v91, s[8:11], s36 offen sc1
  s_bitcmp1_b32 s48, 1
  s_cselect_b32 s36, s50, s49
  s_add_u32 s36, s36, 8192
  buffer_load_dwordx4 v[136:139], v88, s[8:11], s36 offen sc1
  buffer_load_dwordx4 v[140:143], v89, s[8:11], s36 offen sc1
  buffer_load_dwordx4 v[144:147], v90, s[8:11], s36 offen sc1
  buffer_load_dwordx4 v[148:151], v91, s[8:11], s36 offen sc1
  s_bitcmp1_b32 s48, 2
  s_cselect_b32 s36, s50, s49
  s_add_u32 s36, s36, 16384
  buffer_load_dwordx4 v[152:155], v88, s[8:11], s36 offen sc1
  buffer_load_dwordx4 v[156:159], v89, s[8:11], s36 offen sc1
  buffer_load_dwordx4 v[160:163], v90, s[8:11], s36 offen sc1
  buffer_load_dwordx4 v[164:167], v91, s[8:11], s36 offen sc1
  s_bitcmp1_b32 s48, 3
  s_cselect_b32 s36, s50, s49
  s_add_u32 s36, s36, 24576
  buffer_load_dwordx4 v[168:171], v88, s[8:11], s36 offen sc1
  buffer_load_dwordx4 v[172:175], v89, s[8:11], s36 offen sc1
  s_waitcnt vmcnt(14)
  v_lshlrev_b32 v112, 16, v112
  v_lshlrev_b32 v48, 16, v96
  v_and_b32 v49, 0xffff0000, v96
  v_lshlrev_b32 v50, 16, v97
  v_and_b32 v51, 0xffff0000, v97
  v_lshlrev_b32 v52, 16, v98
  v_and_b32 v53, 0xffff0000, v98
  v_lshlrev_b32 v54, 16, v99
  v_and_b32 v55, 0xffff0000, v99
  v_pk_add_f32 v[48:49], v[48:49], v[112:113] op_sel_hi:[1,0]
  v_pk_add_f32 v[50:51], v[50:51], v[112:113] op_sel_hi:[1,0]
  v_pk_add_f32 v[52:53], v[52:53], v[112:113] op_sel_hi:[1,0]
  v_pk_add_f32 v[54:55], v[54:55], v[112:113] op_sel_hi:[1,0]
  v_lshlrev_b32 v114, 16, v114
  v_lshlrev_b32 v56, 16, v100
  v_and_b32 v57, 0xffff0000, v100
  v_lshlrev_b32 v58, 16, v101
  v_and_b32 v59, 0xffff0000, v101
  v_lshlrev_b32 v60, 16, v102
  v_and_b32 v61, 0xffff0000, v102
  v_lshlrev_b32 v62, 16, v103
  v_and_b32 v63, 0xffff0000, v103
  v_pk_add_f32 v[56:57], v[56:57], v[114:115] op_sel_hi:[1,0]
  v_pk_add_f32 v[58:59], v[58:59], v[114:115] op_sel_hi:[1,0]
  v_pk_add_f32 v[60:61], v[60:61], v[114:115] op_sel_hi:[1,0]
  v_pk_add_f32 v[62:63], v[62:63], v[114:115] op_sel_hi:[1,0]
  v_lshlrev_b32 v116, 16, v116
  v_lshlrev_b32 v64, 16, v104
  v_and_b32 v65, 0xffff0000, v104
  v_lshlrev_b32 v66, 16, v105
  v_and_b32 v67, 0xffff0000, v105
  v_lshlrev_b32 v68, 16, v106
  v_and_b32 v69, 0xffff0000, v106
  v_lshlrev_b32 v70, 16, v107
  v_and_b32 v71, 0xffff0000, v107
  v_pk_add_f32 v[64:65], v[64:65], v[116:117] op_sel_hi:[1,0]
  v_pk_add_f32 v[66:67], v[66:67], v[116:117] op_sel_hi:[1,0]
  v_pk_add_f32 v[68:69], v[68:69], v[116:117] op_sel_hi:[1,0]
  v_pk_add_f32 v[70:71], v[70:71], v[116:117] op_sel_hi:[1,0]
  v_lshlrev_b32 v118, 16, v118
  v_lshlrev_b32 v72, 16, v108
  v_and_b32 v73, 0xffff0000, v108
  v_lshlrev_b32 v74, 16, v109
  v_and_b32 v75, 0xffff0000, v109
  v_lshlrev_b32 v76, 16, v110
  v_and_b32 v77, 0xffff0000, v110
  v_lshlrev_b32 v78, 16, v111
  v_and_b32 v79, 0xffff0000, v111
  v_pk_add_f32 v[72:73], v[72:73], v[118:119] op_sel_hi:[1,0]
  v_pk_add_f32 v[74:75], v[74:75], v[118:119] op_sel_hi:[1,0]
  v_pk_add_f32 v[76:77], v[76:77], v[118:119] op_sel_hi:[1,0]
  v_pk_add_f32 v[78:79], v[78:79], v[118:119] op_sel_hi:[1,0]
  s_mov_b32 s43, 0
  s_mov_b32 s39, 6
  s_barrier
  ds_read_b64_tr_b16 v[16:17], v8 offset:0
  ds_read_b64_tr_b16 v[18:19], v8 offset:512
  ds_read_b64_tr_b16 v[20:21], v9 offset:0
  ds_read_b64_tr_b16 v[22:23], v9 offset:512
  ds_read_b64_tr_b16 v[24:25], v10 offset:0
  ds_read_b64_tr_b16 v[26:27], v10 offset:512
  ds_read_b64_tr_b16 v[28:29], v11 offset:0
  ds_read_b64_tr_b16 v[30:31], v11 offset:512
  s_add_u32 s40, s43, 8192
  s_cmp_eq_u32 s40, 98304
  s_cselect_b32 s40, 0, s40
  s_sub_u32 s42, s40, s43
  s_mov_b32 s43, s40
cd6:
  s_waitcnt vmcnt(13) lgkmcnt(6)
  v_mfma_f32_16x16x32_bf16 v[48:51], v[120:123], v[16:19], v[48:51]
  ds_read_b64_tr_b16 v[32:33], v8 offset:4096
  s_waitcnt vmcnt(12)
  v_mfma_f32_16x16x32_bf16 v[52:55], v[124:127], v[16:19], v[52:55]
  ds_read_b64_tr_b16 v[34:35], v8 offset:4608
  v_add_u32 v8, s42, v8
  s_waitcnt lgkmcnt(6)
  v_mfma_f32_16x16x32_bf16 v[60:63], v[124:127], v[20:23], v[60:63]
  ds_read_b64_tr_b16 v[36:37], v9 offset:4096
  buffer_load_dwordx4 v[176:179], v90, s[8:11], s36 offen sc1
  v_mfma_f32_16x16x32_bf16 v[56:59], v[120:123], v[20:23], v[56:59]
  ds_read_b64_tr_b16 v[38:39], v9 offset:4608
  v_add_u32 v9, s42, v9
  s_waitcnt lgkmcnt(6)
  v_mfma_f32_16x16x32_bf16 v[64:67], v[120:123], v[24:27], v[64:67]
  ds_read_b64_tr_b16 v[40:41], v10 offset:4096
  v_mfma_f32_16x16x32_bf16 v[68:71], v[124:127], v[24:27], v[68:71]
  ds_read_b64_tr_b16 v[42:43], v10 offset:4608
  v_add_u32 v10, s42, v10
  s_waitcnt lgkmcnt(6)
  v_mfma_f32_16x16x32_bf16 v[76:79], v[124:127], v[28:31], v[76:79]
  ds_read_b64_tr_b16 v[44:45], v11 offset:4096
  buffer_load_dwordx4 v[180:183], v91, s[8:11], s36 offen sc1
  v_mfma_f32_16x16x32_bf16 v[72:75], v[120:123], v[28:31], v[72:75]
  ds_read_b64_tr_b16 v[46:47], v11 offset:4608
  v_add_u32 v11, s42, v11
  s_barrier
  s_waitcnt vmcnt(13) lgkmcnt(6)
  v_mfma_f32_16x16x32_bf16 v[48:51], v[128:131], v[32:35], v[48:51]
  ds_read_b64_tr_b16 v[16:17], v8 offset:0
  s_bitcmp1_b32 s48, 4
  s_cselect_b32 s36, s50, s49
  s_waitcnt vmcnt(12)
  v_mfma_f32_16x16x32_bf16 v[52:55], v[132:135], v[32:35], v[52:55]
  ds_read_b64_tr_b16 v[18:19], v8 offset:512
  s_add_u32 s36, s36, 32768
  s_add_u32 s40, s43, 8192
  s_waitcnt lgkmcnt(6)
  v_mfma_f32_16x16x32_bf16 v[60:63], v[132:135], v[36:39], v[60:63]
  ds_read_b64_tr_b16 v[20:21], v9 offset:0
  s_cmp_eq_u32 s40, 98304
  s_cselect_b32 s40, 0, s40
  v_mfma_f32_16x16x32_bf16 v[56:59], v[128:131], v[36:39], v[56:59]
  ds_read_b64_tr_b16 v[22:23], v9 offset:512
  s_sub_u32 s42, s40, s43
  s_mov_b32 s43, s40
  s_waitcnt lgkmcnt(6)
  v_mfma_f32_16x16x32_bf16 v[64:67], v[128:131], v[40:43], v[64:67]
  ds_read_b64_tr_b16 v[24:25], v10 offset:0
  buffer_load_dwordx4 v[120:123], v88, s[8:11], s36 offen sc1
  v_mfma_f32_16x16x32_bf16 v[68:71], v[132:135], v[40:43], v[68:71]
  ds_read_b64_tr_b16 v[26:27], v10 offset:512
  s_waitcnt lgkmcnt(6)
  v_mfma_f32_16x16x32_bf16 v[76:79], v[132:135], v[44:47], v[76:79]
  ds_read_b64_tr_b16 v[28:29], v11 offset:0
  v_mfma_f32_16x16x32_bf16 v[72:75], v[128:131], v[44:47], v[72:75]
  ds_read_b64_tr_b16 v[30:31], v11 offset:512
  buffer_load_dwordx4 v[124:127], v89, s[8:11], s36 offen sc1
  s_waitcnt vmcnt(13) lgkmcnt(6)
  v_mfma_f32_16x16x32_bf16 v[48:51], v[136:139], v[16:19], v[48:51]
  ds_read_b64_tr_b16 v[32:33], v8 offset:4096
  s_waitcnt vmcnt(12)
  v_mfma_f32_16x16x32_bf16 v[52:55], v[140:143], v[16:19], v[52:55]
  ds_read_b64_tr_b16 v[34:35], v8 offset:4608
  v_add_u32 v8, s42, v8
  s_waitcnt lgkmcnt(6)
  v_mfma_f32_16x16x32_bf16 v[60:63], v[140:143], v[20:23], v[60:63]
  ds_read_b64_tr_b16 v[36:37], v9 offset:4096
  buffer_load_dwordx4 v[128:131], v90, s[8:11], s36 offen sc1
  v_mfma_f32_16x16x32_bf16 v[56:59], v[136:139], v[20:23], v[56:59]
  ds_read_b64_tr_b16 v[38:39], v9 offset:4608
  v_add_u32 v9, s42, v9
  s_waitcnt lgkmcnt(6)
  v_mfma_f32_16x16x32_bf16 v[64:67], v[136:139], v[24:27], v[64:67]
  ds_read_b64_tr_b16 v[40:41], v10 offset:4096
  v_mfma_f32_16x16x32_bf16 v[68:71], v[140:143], v[24:27], v[68:71]
  ds_read_b64_tr_b16 v[42:43], v10 offset:4608
  v_add_u32 v10, s42, v10
  s_waitcnt lgkmcnt(6)
  v_mfma_f32_16x16x32_bf16 v[76:79], v[140:143], v[28:31], v[76:79]
  ds_read_b64_tr_b16 v[44:45], v11 offset:4096
  buffer_load_dwordx4 v[132:135], v91, s[8:11], s36 offen sc1
  v_mfma_f32_16x16x32_bf16 v[72:75], v[136:139], v[28:31], v[72:75]
  ds_read_b64_tr_b16 v[46:47], v11 offset:4608
  v_add_u32 v11, s42, v11
  s_barrier
  s_waitcnt vmcnt(13) lgkmcnt(6)
  v_mfma_f32_16x16x32_bf16 v[48:51], v[144:147], v[32:35], v[48:51]
  ds_read_b64_tr_b16 v[16:17], v8 offset:0
  s_bitcmp1_b32 s48, 5
  s_cselect_b32 s36, s50, s49
  s_waitcnt vmcnt(12)
  v_mfma_f32_16x16x32_bf16 v[52:55], v[148:151], v[32:35], v[52:55]
  ds_read_b64_tr_b16 v[18:19], v8 offset:512
  s_add_u32 s36, s36, 40960
  s_add_u32 s40, s43, 8192
  s_waitcnt lgkmcnt(6)
  v_mfma_f32_16x16x32_bf16 v[60:63], v[148:151], v[36:39], v[60:63]
  ds_read_b64_tr_b16 v[20:21], v9 offset:0
  s_cmp_eq_u32 s40, 98304
  s_cselect_b32 s40, 0, s40
  v_mfma_f32_16x16x32_bf16 v[56:59], v[144:147], v[36:39], v[56:59]
  ds_read_b64_tr_b16 v[22:23], v9 offset:512
  s_sub_u32 s42, s40, s43
  s_mov_b32 s43, s40
  s_waitcnt lgkmcnt(6)
  v_mfma_f32_16x16x32_bf16 v[64:67], v[144:147], v[40:43], v[64:67]
  ds_read_b64_tr_b16 v[24:25], v10 offset:0
  buffer_load_dwordx4 v[136:139], v88, s[8:11], s36 offen sc1
  v_mfma_f32_16x16x32_bf16 v[68:71], v[148:151], v[40:43], v[68:71]
  ds_read_b64_tr_b16 v[26:27], v10 offset:512
  s_waitcnt lgkmcnt(6)
  v_mfma_f32_16x16x32_bf16 v[76:79], v[148:151], v[44:47], v[76:79]
  ds_read_b64_tr_b16 v[28:29], v11 offset:0
  v_mfma_f32_16x16x32_bf16 v[72:75], v[144:147], v[44:47], v[72:75]
  ds_read_b64_tr_b16 v[30:31], v11 offset:512
  buffer_load_dwordx4 v[140:143], v89, s[8:11], s36 offen sc1
  s_waitcnt vmcnt(13) lgkmcnt(6)
  v_mfma_f32_16x16x32_bf16 v[48:51], v[152:155], v[16:19], v[48:51]
  ds_read_b64_tr_b16 v[32:33], v8 offset:4096
  s_waitcnt vmcnt(12)
  v_mfma_f32_16x16x32_bf16 v[52:55], v[156:159], v[16:19], v[52:55]
  ds_read_b64_tr_b16 v[34:35], v8 offset:4608
  v_add_u32 v8, s42, v8
  s_waitcnt lgkmcnt(6)
  v_mfma_f32_16x16x32_bf16 v[60:63], v[156:159], v[20:23], v[60:63]
  ds_read_b64_tr_b16 v[36:37], v9 offset:4096
  buffer_load_dwordx4 v[144:147], v90, s[8:11], s36 offen sc1
  v_mfma_f32_16x16x32_bf16 v[56:59], v[152:155], v[20:23], v[56:59]
  ds_read_b64_tr_b16 v[38:39], v9 offset:4608
  v_add_u32 v9, s42, v9
  s_waitcnt lgkmcnt(6)
  v_mfma_f32_16x16x32_bf16 v[64:67], v[152:155], v[24:27], v[64:67]
  ds_read_b64_tr_b16 v[40:41], v10 offset:4096
  v_mfma_f32_16x16x32_bf16 v[68:71], v[156:159], v[24:27], v[68:71]
  ds_read_b64_tr_b16 v[42:43], v10 offset:4608
  v_add_u32 v10, s42, v10
  s_waitcnt lgkmcnt(6)
  v_mfma_f32_16x16x32_bf16 v[76:79], v[156:159], v[28:31], v[76:79]
  ds_read_b64_tr_b16 v[44:45], v11 offset:4096
  buffer_load_dwordx4 v[148:151], v91, s[8:11], s36 offen sc1
  v_mfma_f32_16x16x32_bf16 v[72:75], v[152:155], v[28:31], v[72:75]
  ds_read_b64_tr_b16 v[46:47], v11 offset:4608
  v_add_u32 v11, s42, v11
  s_barrier
  s_waitcnt vmcnt(13) lgkmcnt(6)
  v_mfma_f32_16x16x32_bf16 v[48:51], v[160:163], v[32:35], v[48:51]
  ds_read_b64_tr_b16 v[16:17], v8 offset:0
  s_bitcmp1_b32 s48, 6
  s_cselect_b32 s36, s50, s49
  s_waitcnt vmcnt(12)
  v_mfma_f32_16x16x32_bf16 v[52:55], v[164:167], v[32:35], v[52:55]
  ds_read_b64_tr_b16 v[18:19], v8 offset:512
  s_add_u32 s36, s36, 49152
  s_add_u32 s40, s43, 8192
  s_waitcnt lgkmcnt(6)
  v_mfma_f32_16x16x32_bf16 v[60:63], v[164:167], v[36:39], v[60:63]
  ds_read_b64_tr_b16 v[20:21], v9 offset:0
  s_cmp_eq_u32 s40, 98304
  s_cselect_b32 s40, 0, s40
  v_mfma_f32_16x16x32_bf16 v[56:59], v[160:163], v[36:39], v[56:59]
  ds_read_b64_tr_b16 v[22:23], v9 offset:512
  s_sub_u32 s42, s40, s43
  s_mov_b32 s43, s40
  s_waitcnt lgkmcnt(6)
  v_mfma_f32_16x16x32_bf16 v[64:67], v[160:163], v[40:43], v[64:67]
  ds_read_b64_tr_b16 v[24:25], v10 offset:0
  buffer_load_dwordx4 v[152:155], v88, s[8:11], s36 offen sc1
  v_mfma_f32_16x16x32_bf16 v[68:71], v[164:167], v[40:43], v[68:71]
  ds_read_b64_tr_b16 v[26:27], v10 offset:512
  s_waitcnt lgkmcnt(6)
  v_mfma_f32_16x16x32_bf16 v[76:79], v[164:167], v[44:47], v[76:79]
  ds_read_b64_tr_b16 v[28:29], v11 offset:0
  v_mfma_f32_16x16x32_bf16 v[72:75], v[160:163], v[44:47], v[72:75]
  ds_read_b64_tr_b16 v[30:31], v11 offset:512
  buffer_load_dwordx4 v[156:159], v89, s[8:11], s36 offen sc1
  s_waitcnt vmcnt(13) lgkmcnt(6)
  v_mfma_f32_16x16x32_bf16 v[48:51], v[168:171], v[16:19], v[48:51]
  ds_read_b64_tr_b16 v[32:33], v8 offset:4096
  s_waitcnt vmcnt(12)
  v_mfma_f32_16x16x32_bf16 v[52:55], v[172:175], v[16:19], v[52:55]
  ds_read_b64_tr_b16 v[34:35], v8 offset:4608
  v_add_u32 v8, s42, v8
  s_waitcnt lgkmcnt(6)
  v_mfma_f32_16x16x32_bf16 v[60:63], v[172:175], v[20:23], v[60:63]
  ds_read_b64_tr_b16 v[36:37], v9 offset:4096
  buffer_load_dwordx4 v[160:163], v90, s[8:11], s36 offen sc1
  v_mfma_f32_16x16x32_bf16 v[56:59], v[168:171], v[20:23], v[56:59]
  ds_read_b64_tr_b16 v[38:39], v9 offset:4608
  v_add_u32 v9, s42, v9
  s_waitcnt lgkmcnt(6)
  v_mfma_f32_16x16x32_bf16 v[64:67], v[168:171], v[24:27], v[64:67]
  ds_read_b64_tr_b16 v[40:41], v10 offset:4096
  v_mfma_f32_16x16x32_bf16 v[68:71], v[172:175], v[24:27], v[68:71]
  ds_read_b64_tr_b16 v[42:43], v10 offset:4608
  v_add_u32 v10, s42, v10
  s_waitcnt lgkmcnt(6)
  v_mfma_f32_16x16x32_bf16 v[76:79], v[172:175], v[28:31], v[76:79]
  ds_read_b64_tr_b16 v[44:45], v11 offset:4096
  buffer_load_dwordx4 v[164:167], v91, s[8:11], s36 offen sc1
  v_mfma_f32_16x16x32_bf16 v[72:75], v[168:171], v[28:31], v[72:75]
  ds_read_b64_tr_b16 v[46:47], v11 offset:4608
  v_add_u32 v11, s42, v11
  s_barrier
  s_waitcnt vmcnt(13) lgkmcnt(6)
  v_mfma_f32_16x16x32_bf16 v[48:51], v[176:179], v[32:35], v[48:51]
  ds_read_b64_tr_b16 v[16:17], v8 offset:0
  s_bitcmp1_b32 s48, 7
  s_cselect_b32 s36, s50, s49
  s_waitcnt vmcnt(12)
  v_mfma_f32_16x16x32_bf16 v[52:55], v[180:183], v[32:35], v[52:55]
  ds_read_b64_tr_b16 v[18:19], v8 offset:512
  s_add_u32 s36, s36, 57344
  s_add_u32 s40, s43, 8192
  s_waitcnt lgkmcnt(6)
  v_mfma_f32_16x16x32_bf16 v[60:63], v[180:183], v[36:39], v[60:63]
  ds_read_b64_tr_b16 v[20:21], v9 offset:0
  s_cmp_eq_u32 s40, 98304
  s_cselect_b32 s40, 0, s40
  v_mfma_f32_16x16x32_bf16 v[56:59], v[176:179], v[36:39], v[56:59]
  ds_read_b64_tr_b16 v[22:23], v9 offset:512
  s_sub_u32 s42, s40, s43
  s_mov_b32 s43, s40
  s_waitcnt lgkmcnt(6)
  v_mfma_f32_16x16x32_bf16 v[64:67], v[176:179], v[40:43], v[64:67]
  ds_read_b64_tr_b16 v[24:25], v10 offset:0
  buffer_load_dwordx4 v[168:171], v88, s[8:11], s36 offen sc1
  v_mfma_f32_16x16x32_bf16 v[68:71], v[180:183], v[40:43], v[68:71]
  ds_read_b64_tr_b16 v[26:27], v10 offset:512
  s_waitcnt lgkmcnt(6)
  v_mfma_f32_16x16x32_bf16 v[76:79], v[180:183], v[44:47], v[76:79]
  ds_read_b64_tr_b16 v[28:29], v11 offset:0
  v_mfma_f32_16x16x32_bf16 v[72:75], v[176:179], v[44:47], v[72:75]
  ds_read_b64_tr_b16 v[30:31], v11 offset:512
  buffer_load_dwordx4 v[172:175], v89, s[8:11], s36 offen sc1
  s_waitcnt vmcnt(13) lgkmcnt(6)
  v_mfma_f32_16x16x32_bf16 v[48:51], v[120:123], v[16:19], v[48:51]
  ds_read_b64_tr_b16 v[32:33], v8 offset:4096
  s_waitcnt vmcnt(12)
  v_mfma_f32_16x16x32_bf16 v[52:55], v[124:127], v[16:19], v[52:55]
  ds_read_b64_tr_b16 v[34:35], v8 offset:4608
  v_add_u32 v8, s42, v8
  s_waitcnt lgkmcnt(6)
  v_mfma_f32_16x16x32_bf16 v[60:63], v[124:127], v[20:23], v[60:63]
  ds_read_b64_tr_b16 v[36:37], v9 offset:4096
  buffer_load_dwordx4 v[176:179], v90, s[8:11], s36 offen sc1
  v_mfma_f32_16x16x32_bf16 v[56:59], v[120:123], v[20:23], v[56:59]
  ds_read_b64_tr_b16 v[38:39], v9 offset:4608
  v_add_u32 v9, s42, v9
  s_waitcnt lgkmcnt(6)
  v_mfma_f32_16x16x32_bf16 v[64:67], v[120:123], v[24:27], v[64:67]
  ds_read_b64_tr_b16 v[40:41], v10 offset:4096
  v_mfma_f32_16x16x32_bf16 v[68:71], v[124:127], v[24:27], v[68:71]
  ds_read_b64_tr_b16 v[42:43], v10 offset:4608
  v_add_u32 v10, s42, v10
  s_waitcnt lgkmcnt(6)
  v_mfma_f32_16x16x32_bf16 v[76:79], v[124:127], v[28:31], v[76:79]
  ds_read_b64_tr_b16 v[44:45], v11 offset:4096
  buffer_load_dwordx4 v[180:183], v91, s[8:11], s36 offen sc1
  v_mfma_f32_16x16x32_bf16 v[72:75], v[120:123], v[28:31], v[72:75]
  ds_read_b64_tr_b16 v[46:47], v11 offset:4608
  v_add_u32 v11, s42, v11
  s_barrier
  s_waitcnt vmcnt(13) lgkmcnt(6)
  v_mfma_f32_16x16x32_bf16 v[48:51], v[128:131], v[32:35], v[48:51]
  ds_read_b64_tr_b16 v[16:17], v8 offset:0
  s_mov_b32 s49, s50
  s_add_u32 s50, s50, 65536
  s_waitcnt vmcnt(12)
  v_mfma_f32_16x16x32_bf16 v[52:55], v[132:135], v[32:35], v[52:55]
  ds_read_b64_tr_b16 v[18:19], v8 offset:512
  s_cmp_eq_u32 s50, s41
  s_cselect_b32 s50, s34, s50
  s_waitcnt lgkmcnt(6)
  v_mfma_f32_16x16x32_bf16 v[60:63], v[132:135], v[36:39], v[60:63]
  ds_read_b64_tr_b16 v[20:21], v9 offset:0
  s_bitcmp1_b32 s48, 0
  s_cselect_b32 s36, s50, s49
  v_mfma_f32_16x16x32_bf16 v[56:59], v[128:131], v[36:39], v[56:59]
  ds_read_b64_tr_b16 v[22:23], v9 offset:512
  s_add_u32 s36, s36, 0
  s_add_u32 s40, s43, 8192
  s_waitcnt lgkmcnt(6)
  v_mfma_f32_16x16x32_bf16 v[64:67], v[128:131], v[40:43], v[64:67]
  ds_read_b64_tr_b16 v[24:25], v10 offset:0
  s_cmp_eq_u32 s40, 98304
  s_cselect_b32 s40, 0, s40
  buffer_load_dwordx4 v[120:123], v88, s[8:11], s36 offen sc1
  v_mfma_f32_16x16x32_bf16 v[68:71], v[132:135], v[40:43], v[68:71]
  ds_read_b64_tr_b16 v[26:27], v10 offset:512
  s_sub_u32 s42, s40, s43
  s_mov_b32 s43, s40
  s_waitcnt lgkmcnt(6)
  v_mfma_f32_16x16x32_bf16 v[76:79], v[132:135], v[44:47], v[76:79]
  ds_read_b64_tr_b16 v[28:29], v11 offset:0
  v_mfma_f32_16x16x32_bf16 v[72:75], v[128:131], v[44:47], v[72:75]
  ds_read_b64_tr_b16 v[30:31], v11 offset:512
  buffer_load_dwordx4 v[124:127], v89, s[8:11], s36 offen sc1
  s_waitcnt vmcnt(13) lgkmcnt(6)
  v_mfma_f32_16x16x32_bf16 v[48:51], v[136:139], v[16:19], v[48:51]
  ds_read_b64_tr_b16 v[32:33], v8 offset:4096
  s_waitcnt vmcnt(12)
  v_mfma_f32_16x16x32_bf16 v[52:55], v[140:143], v[16:19], v[52:55]
  ds_read_b64_tr_b16 v[34:35], v8 offset:4608
  v_add_u32 v8, s42, v8
  s_waitcnt lgkmcnt(6)
  v_mfma_f32_16x16x32_bf16 v[60:63], v[140:143], v[20:23], v[60:63]
  ds_read_b64_tr_b16 v[36:37], v9 offset:4096
  buffer_load_dwordx4 v[128:131], v90, s[8:11], s36 offen sc1
  v_mfma_f32_16x16x32_bf16 v[56:59], v[136:139], v[20:23], v[56:59]
  ds_read_b64_tr_b16 v[38:39], v9 offset:4608
  v_add_u32 v9, s42, v9
  s_waitcnt lgkmcnt(6)
  v_mfma_f32_16x16x32_bf16 v[64:67], v[136:139], v[24:27], v[64:67]
  ds_read_b64_tr_b16 v[40:41], v10 offset:4096
  v_mfma_f32_16x16x32_bf16 v[68:71], v[140:143], v[24:27], v[68:71]
  ds_read_b64_tr_b16 v[42:43], v10 offset:4608
  v_add_u32 v10, s42, v10
  s_waitcnt lgkmcnt(6)
  v_mfma_f32_16x16x32_bf16 v[76:79], v[140:143], v[28:31], v[76:79]
  ds_read_b64_tr_b16 v[44:45], v11 offset:4096
  buffer_load_dwordx4 v[132:135], v91, s[8:11], s36 offen sc1
  v_mfma_f32_16x16x32_bf16 v[72:75], v[136:139], v[28:31], v[72:75]
  ds_read_b64_tr_b16 v[46:47], v11 offset:4608
  v_add_u32 v11, s42, v11
  s_barrier
  s_waitcnt vmcnt(13) lgkmcnt(6)
  v_mfma_f32_16x16x32_bf16 v[48:51], v[144:147], v[32:35], v[48:51]
  ds_read_b64_tr_b16 v[16:17], v8 offset:0
  s_bitcmp1_b32 s48, 1
  s_cselect_b32 s36, s50, s49
  s_waitcnt vmcnt(12)
  v_mfma_f32_16x16x32_bf16 v[52:55], v[148:151], v[32:35], v[52:55]
  ds_read_b64_tr_b16 v[18:19], v8 offset:512
  s_add_u32 s36, s36, 8192
  s_add_u32 s40, s43, 8192
  s_waitcnt lgkmcnt(6)
  v_mfma_f32_16x16x32_bf16 v[60:63], v[148:151], v[36:39], v[60:63]
  ds_read_b64_tr_b16 v[20:21], v9 offset:0
  s_cmp_eq_u32 s40, 98304
  s_cselect_b32 s40, 0, s40
  v_mfma_f32_16x16x32_bf16 v[56:59], v[144:147], v[36:39], v[56:59]
  ds_read_b64_tr_b16 v[22:23], v9 offset:512
  s_sub_u32 s42, s40, s43
  s_mov_b32 s43, s40
  s_waitcnt lgkmcnt(6)
  v_mfma_f32_16x16x32_bf16 v[64:67], v[144:147], v[40:43], v[64:67]
  ds_read_b64_tr_b16 v[24:25], v10 offset:0
  buffer_load_dwordx4 v[136:139], v88, s[8:11], s36 offen sc1
  v_mfma_f32_16x16x32_bf16 v[68:71], v[148:151], v[40:43], v[68:71]
  ds_read_b64_tr_b16 v[26:27], v10 offset:512
  s_waitcnt lgkmcnt(6)
  v_mfma_f32_16x16x32_bf16 v[76:79], v[148:151], v[44:47], v[76:79]
  ds_read_b64_tr_b16 v[28:29], v11 offset:0
  v_mfma_f32_16x16x32_bf16 v[72:75], v[144:147], v[44:47], v[72:75]
  ds_read_b64_tr_b16 v[30:31], v11 offset:512
  buffer_load_dwordx4 v[140:143], v89, s[8:11], s36 offen sc1
  s_waitcnt vmcnt(13) lgkmcnt(6)
  v_mfma_f32_16x16x32_bf16 v[48:51], v[152:155], v[16:19], v[48:51]
  ds_read_b64_tr_b16 v[32:33], v8 offset:4096
  s_waitcnt vmcnt(12)
  v_mfma_f32_16x16x32_bf16 v[52:55], v[156:159], v[16:19], v[52:55]
  ds_read_b64_tr_b16 v[34:35], v8 offset:4608
  v_add_u32 v8, s42, v8
  s_waitcnt lgkmcnt(6)
  v_mfma_f32_16x16x32_bf16 v[60:63], v[156:159], v[20:23], v[60:63]
  ds_read_b64_tr_b16 v[36:37], v9 offset:4096
  buffer_load_dwordx4 v[144:147], v90, s[8:11], s36 offen sc1
  v_mfma_f32_16x16x32_bf16 v[56:59], v[152:155], v[20:23], v[56:59]
  ds_read_b64_tr_b16 v[38:39], v9 offset:4608
  v_add_u32 v9, s42, v9
  s_waitcnt lgkmcnt(6)
  v_mfma_f32_16x16x32_bf16 v[64:67], v[152:155], v[24:27], v[64:67]
  ds_read_b64_tr_b16 v[40:41], v10 offset:4096
  v_mfma_f32_16x16x32_bf16 v[68:71], v[156:159], v[24:27], v[68:71]
  ds_read_b64_tr_b16 v[42:43], v10 offset:4608
  v_add_u32 v10, s42, v10
  s_waitcnt lgkmcnt(6)
  v_mfma_f32_16x16x32_bf16 v[76:79], v[156:159], v[28:31], v[76:79]
  ds_read_b64_tr_b16 v[44:45], v11 offset:4096
  buffer_load_dwordx4 v[148:151], v91, s[8:11], s36 offen sc1
  v_mfma_f32_16x16x32_bf16 v[72:75], v[152:155], v[28:31], v[72:75]
  ds_read_b64_tr_b16 v[46:47], v11 offset:4608
  v_add_u32 v11, s42, v11
  s_barrier
  s_waitcnt vmcnt(13) lgkmcnt(6)
  v_mfma_f32_16x16x32_bf16 v[48:51], v[160:163], v[32:35], v[48:51]
  ds_read_b64_tr_b16 v[16:17], v8 offset:0
  s_bitcmp1_b32 s48, 2
  s_cselect_b32 s36, s50, s49
  s_waitcnt vmcnt(12)
  v_mfma_f32_16x16x32_bf16 v[52:55], v[164:167], v[32:35], v[52:55]
  ds_read_b64_tr_b16 v[18:19], v8 offset:512
  s_add_u32 s36, s36, 16384
  s_add_u32 s40, s43, 8192
  s_waitcnt lgkmcnt(6)
  v_mfma_f32_16x16x32_bf16 v[60:63], v[164:167], v[36:39], v[60:63]
  ds_read_b64_tr_b16 v[20:21], v9 offset:0
  s_cmp_eq_u32 s40, 98304
  s_cselect_b32 s40, 0, s40
  v_mfma_f32_16x16x32_bf16 v[56:59], v[160:163], v[36:39], v[56:59]
  ds_read_b64_tr_b16 v[22:23], v9 offset:512
  s_sub_u32 s42, s40, s43
  s_mov_b32 s43, s40
  s_waitcnt lgkmcnt(6)
  v_mfma_f32_16x16x32_bf16 v[64:67], v[160:163], v[40:43], v[64:67]
  ds_read_b64_tr_b16 v[24:25], v10 offset:0
  buffer_load_dwordx4 v[152:155], v88, s[8:11], s36 offen sc1
  v_mfma_f32_16x16x32_bf16 v[68:71], v[164:167], v[40:43], v[68:71]
  ds_read_b64_tr_b16 v[26:27], v10 offset:512
  s_waitcnt lgkmcnt(6)
  v_mfma_f32_16x16x32_bf16 v[76:79], v[164:167], v[44:47], v[76:79]
  ds_read_b64_tr_b16 v[28:29], v11 offset:0
  v_mfma_f32_16x16x32_bf16 v[72:75], v[160:163], v[44:47], v[72:75]
  ds_read_b64_tr_b16 v[30:31], v11 offset:512
  buffer_load_dwordx4 v[156:159], v89, s[8:11], s36 offen sc1
  s_waitcnt vmcnt(13) lgkmcnt(6)
  v_mfma_f32_16x16x32_bf16 v[48:51], v[168:171], v[16:19], v[48:51]
  ds_read_b64_tr_b16 v[32:33], v8 offset:4096
  s_waitcnt vmcnt(12)
  v_mfma_f32_16x16x32_bf16 v[52:55], v[172:175], v[16:19], v[52:55]
  ds_read_b64_tr_b16 v[34:35], v8 offset:4608
  v_add_u32 v8, s42, v8
  s_waitcnt lgkmcnt(6)
  v_mfma_f32_16x16x32_bf16 v[60:63], v[172:175], v[20:23], v[60:63]
  ds_read_b64_tr_b16 v[36:37], v9 offset:4096
  buffer_load_dwordx4 v[160:163], v90, s[8:11], s36 offen sc1
  v_mfma_f32_16x16x32_bf16 v[56:59], v[168:171], v[20:23], v[56:59]
  ds_read_b64_tr_b16 v[38:39], v9 offset:4608
  v_add_u32 v9, s42, v9
  s_waitcnt lgkmcnt(6)
  v_mfma_f32_16x16x32_bf16 v[64:67], v[168:171], v[24:27], v[64:67]
  ds_read_b64_tr_b16 v[40:41], v10 offset:4096
  v_mfma_f32_16x16x32_bf16 v[68:71], v[172:175], v[24:27], v[68:71]
  ds_read_b64_tr_b16 v[42:43], v10 offset:4608
  v_add_u32 v10, s42, v10
  s_waitcnt lgkmcnt(6)
  v_mfma_f32_16x16x32_bf16 v[76:79], v[172:175], v[28:31], v[76:79]
  ds_read_b64_tr_b16 v[44:45], v11 offset:4096
  buffer_load_dwordx4 v[164:167], v91, s[8:11], s36 offen sc1
  v_mfma_f32_16x16x32_bf16 v[72:75], v[168:171], v[28:31], v[72:75]
  ds_read_b64_tr_b16 v[46:47], v11 offset:4608
  v_add_u32 v11, s42, v11
  s_barrier
  s_waitcnt vmcnt(13) lgkmcnt(6)
  v_mfma_f32_16x16x32_bf16 v[48:51], v[176:179], v[32:35], v[48:51]
  ds_read_b64_tr_b16 v[16:17], v8 offset:0
  s_bitcmp1_b32 s48, 3
  s_cselect_b32 s36, s50, s49
  s_waitcnt vmcnt(12)
  v_mfma_f32_16x16x32_bf16 v[52:55], v[180:183], v[32:35], v[52:55]
  ds_read_b64_tr_b16 v[18:19], v8 offset:512
  s_add_u32 s36, s36, 24576
  s_add_u32 s40, s43, 8192
  s_waitcnt lgkmcnt(6)
  v_mfma_f32_16x16x32_bf16 v[60:63], v[180:183], v[36:39], v[60:63]
  ds_read_b64_tr_b16 v[20:21], v9 offset:0
  s_cmp_eq_u32 s40, 98304
  s_cselect_b32 s40, 0, s40
  v_mfma_f32_16x16x32_bf16 v[56:59], v[176:179], v[36:39], v[56:59]
  ds_read_b64_tr_b16 v[22:23], v9 offset:512
  s_sub_u32 s42, s40, s43
  s_mov_b32 s43, s40
  s_waitcnt lgkmcnt(6)
  v_mfma_f32_16x16x32_bf16 v[64:67], v[176:179], v[40:43], v[64:67]
  ds_read_b64_tr_b16 v[24:25], v10 offset:0
  buffer_load_dwordx4 v[168:171], v88, s[8:11], s36 offen sc1
  v_mfma_f32_16x16x32_bf16 v[68:71], v[180:183], v[40:43], v[68:71]
  ds_read_b64_tr_b16 v[26:27], v10 offset:512
  s_waitcnt lgkmcnt(6)
  v_mfma_f32_16x16x32_bf16 v[76:79], v[180:183], v[44:47], v[76:79]
  ds_read_b64_tr_b16 v[28:29], v11 offset:0
  v_mfma_f32_16x16x32_bf16 v[72:75], v[176:179], v[44:47], v[72:75]
  ds_read_b64_tr_b16 v[30:31], v11 offset:512
  buffer_load_dwordx4 v[172:175], v89, s[8:11], s36 offen sc1
  s_sub_u32 s39, s39, 1
  s_cmp_lg_u32 s39, 0
  s_cbranch_scc1 cd6
  s_waitcnt vmcnt(13) lgkmcnt(6)
  v_mfma_f32_16x16x32_bf16 v[48:51], v[120:123], v[16:19], v[48:51]
  ds_read_b64_tr_b16 v[32:33], v8 offset:4096
  s_waitcnt vmcnt(12)
  v_mfma_f32_16x16x32_bf16 v[52:55], v[124:127], v[16:19], v[52:55]
  ds_read_b64_tr_b16 v[34:35], v8 offset:4608
  v_add_u32 v8, s42, v8
  s_waitcnt lgkmcnt(6)
  v_mfma_f32_16x16x32_bf16 v[60:63], v[124:127], v[20:23], v[60:63]
  ds_read_b64_tr_b16 v[36:37], v9 offset:4096
  buffer_load_dwordx4 v[176:179], v90, s[8:11], s36 offen sc1
  v_mfma_f32_16x16x32_bf16 v[56:59], v[120:123], v[20:23], v[56:59]
  ds_read_b64_tr_b16 v[38:39], v9 offset:4608
  v_add_u32 v9, s42, v9
  s_waitcnt lgkmcnt(6)
  v_mfma_f32_16x16x32_bf16 v[64:67], v[120:123], v[24:27], v[64:67]
  ds_read_b64_tr_b16 v[40:41], v10 offset:4096
  v_mfma_f32_16x16x32_bf16 v[68:71], v[124:127], v[24:27], v[68:71]
  ds_read_b64_tr_b16 v[42:43], v10 offset:4608
  v_add_u32 v10, s42, v10
  s_waitcnt lgkmcnt(6)
  v_mfma_f32_16x16x32_bf16 v[76:79], v[124:127], v[28:31], v[76:79]
  ds_read_b64_tr_b16 v[44:45], v11 offset:4096
  buffer_load_dwordx4 v[180:183], v91, s[8:11], s36 offen sc1
  v_mfma_f32_16x16x32_bf16 v[72:75], v[120:123], v[28:31], v[72:75]
  ds_read_b64_tr_b16 v[46:47], v11 offset:4608
  v_add_u32 v11, s42, v11
  s_barrier
  s_waitcnt vmcnt(13) lgkmcnt(6)
  v_mfma_f32_16x16x32_bf16 v[48:51], v[128:131], v[32:35], v[48:51]
  ds_read_b64_tr_b16 v[16:17], v8 offset:0
  s_bitcmp1_b32 s48, 4
  s_cselect_b32 s36, s50, s49
  s_waitcnt vmcnt(12)
  v_mfma_f32_16x16x32_bf16 v[52:55], v[132:135], v[32:35], v[52:55]
  ds_read_b64_tr_b16 v[18:19], v8 offset:512
  s_add_u32 s36, s36, 32768
  s_add_u32 s40, s43, 8192
  s_waitcnt lgkmcnt(6)
  v_mfma_f32_16x16x32_bf16 v[60:63], v[132:135], v[36:39], v[60:63]
  ds_read_b64_tr_b16 v[20:21], v9 offset:0
  s_cmp_eq_u32 s40, 98304
  s_cselect_b32 s40, 0, s40
  v_mfma_f32_16x16x32_bf16 v[56:59], v[128:131], v[36:39], v[56:59]
  ds_read_b64_tr_b16 v[22:23], v9 offset:512
  s_sub_u32 s42, s40, s43
  s_mov_b32 s43, s40
  s_waitcnt lgkmcnt(6)
  v_mfma_f32_16x16x32_bf16 v[64:67], v[128:131], v[40:43], v[64:67]
  ds_read_b64_tr_b16 v[24:25], v10 offset:0
  buffer_load_dwordx4 v[120:123], v88, s[8:11], s36 offen sc1
  v_mfma_f32_16x16x32_bf16 v[68:71], v[132:135], v[40:43], v[68:71]
  ds_read_b64_tr_b16 v[26:27], v10 offset:512
  s_waitcnt lgkmcnt(6)
  v_mfma_f32_16x16x32_bf16 v[76:79], v[132:135], v[44:47], v[76:79]
  ds_read_b64_tr_b16 v[28:29], v11 offset:0
  v_mfma_f32_16x16x32_bf16 v[72:75], v[128:131], v[44:47], v[72:75]
  ds_read_b64_tr_b16 v[30:31], v11 offset:512
  buffer_load_dwordx4 v[124:127], v89, s[8:11], s36 offen sc1
  s_waitcnt vmcnt(13) lgkmcnt(6)
  v_mfma_f32_16x16x32_bf16 v[48:51], v[136:139], v[16:19], v[48:51]
  ds_read_b64_tr_b16 v[32:33], v8 offset:4096
  s_waitcnt vmcnt(12)
  v_mfma_f32_16x16x32_bf16 v[52:55], v[140:143], v[16:19], v[52:55]
  ds_read_b64_tr_b16 v[34:35], v8 offset:4608
  v_add_u32 v8, s42, v8
  s_waitcnt lgkmcnt(6)
  v_mfma_f32_16x16x32_bf16 v[60:63], v[140:143], v[20:23], v[60:63]
  ds_read_b64_tr_b16 v[36:37], v9 offset:4096
  buffer_load_dwordx4 v[128:131], v90, s[8:11], s36 offen sc1
  v_mfma_f32_16x16x32_bf16 v[56:59], v[136:139], v[20:23], v[56:59]
  ds_read_b64_tr_b16 v[38:39], v9 offset:4608
  v_add_u32 v9, s42, v9
  s_waitcnt lgkmcnt(6)
  v_mfma_f32_16x16x32_bf16 v[64:67], v[136:139], v[24:27], v[64:67]
  ds_read_b64_tr_b16 v[40:41], v10 offset:4096
  v_mfma_f32_16x16x32_bf16 v[68:71], v[140:143], v[24:27], v[68:71]
  ds_read_b64_tr_b16 v[42:43], v10 offset:4608
  v_add_u32 v10, s42, v10
  s_waitcnt lgkmcnt(6)
  v_mfma_f32_16x16x32_bf16 v[76:79], v[140:143], v[28:31], v[76:79]
  ds_read_b64_tr_b16 v[44:45], v11 offset:4096
  buffer_load_dwordx4 v[132:135], v91, s[8:11], s36 offen sc1
  v_mfma_f32_16x16x32_bf16 v[72:75], v[136:139], v[28:31], v[72:75]
  ds_read_b64_tr_b16 v[46:47], v11 offset:4608
  v_add_u32 v11, s42, v11
  s_barrier
  s_waitcnt vmcnt(13) lgkmcnt(6)
  v_mfma_f32_16x16x32_bf16 v[48:51], v[144:147], v[32:35], v[48:51]
  ds_read_b64_tr_b16 v[16:17], v8 offset:0
  s_bitcmp1_b32 s48, 5
  s_cselect_b32 s36, s50, s49
  s_waitcnt vmcnt(12)
  v_mfma_f32_16x16x32_bf16 v[52:55], v[148:151], v[32:35], v[52:55]
  ds_read_b64_tr_b16 v[18:19], v8 offset:512
  s_add_u32 s36, s36, 40960
  s_add_u32 s40, s43, 8192
  s_waitcnt lgkmcnt(6)
  v_mfma_f32_16x16x32_bf16 v[60:63], v[148:151], v[36:39], v[60:63]
  ds_read_b64_tr_b16 v[20:21], v9 offset:0
  s_cmp_eq_u32 s40, 98304
  s_cselect_b32 s40, 0, s40
  v_mfma_f32_16x16x32_bf16 v[56:59], v[144:147], v[36:39], v[56:59]
  ds_read_b64_tr_b16 v[22:23], v9 offset:512
  s_sub_u32 s42, s40, s43
  s_mov_b32 s43, s40
  s_waitcnt lgkmcnt(6)
  v_mfma_f32_16x16x32_bf16 v[64:67], v[144:147], v[40:43], v[64:67]
  ds_read_b64_tr_b16 v[24:25], v10 offset:0
  buffer_load_dwordx4 v[136:139], v88, s[8:11], s36 offen sc1
  v_mfma_f32_16x16x32_bf16 v[68:71], v[148:151], v[40:43], v[68:71]
  ds_read_b64_tr_b16 v[26:27], v10 offset:512
  s_waitcnt lgkmcnt(6)
  v_mfma_f32_16x16x32_bf16 v[76:79], v[148:151], v[44:47], v[76:79]
  ds_read_b64_tr_b16 v[28:29], v11 offset:0
  v_mfma_f32_16x16x32_bf16 v[72:75], v[144:147], v[44:47], v[72:75]
  ds_read_b64_tr_b16 v[30:31], v11 offset:512
  buffer_load_dwordx4 v[140:143], v89, s[8:11], s36 offen sc1
  s_waitcnt vmcnt(13) lgkmcnt(6)
  v_mfma_f32_16x16x32_bf16 v[48:51], v[152:155], v[16:19], v[48:51]
  ds_read_b64_tr_b16 v[32:33], v8 offset:4096
  s_waitcnt vmcnt(12)
  v_mfma_f32_16x16x32_bf16 v[52:55], v[156:159], v[16:19], v[52:55]
  ds_read_b64_tr_b16 v[34:35], v8 offset:4608
  v_add_u32 v8, s42, v8
  s_waitcnt lgkmcnt(6)
  v_mfma_f32_16x16x32_bf16 v[60:63], v[156:159], v[20:23], v[60:63]
  ds_read_b64_tr_b16 v[36:37], v9 offset:4096
  buffer_load_dwordx4 v[144:147], v90, s[8:11], s36 offen sc1
  v_mfma_f32_16x16x32_bf16 v[56:59], v[152:155], v[20:23], v[56:59]
  ds_read_b64_tr_b16 v[38:39], v9 offset:4608
  v_add_u32 v9, s42, v9
  s_waitcnt lgkmcnt(6)
  v_mfma_f32_16x16x32_bf16 v[64:67], v[152:155], v[24:27], v[64:67]
  ds_read_b64_tr_b16 v[40:41], v10 offset:4096
  v_mfma_f32_16x16x32_bf16 v[68:71], v[156:159], v[24:27], v[68:71]
  ds_read_b64_tr_b16 v[42:43], v10 offset:4608
  v_add_u32 v10, s42, v10
  s_waitcnt lgkmcnt(6)
  v_mfma_f32_16x16x32_bf16 v[76:79], v[156:159], v[28:31], v[76:79]
  ds_read_b64_tr_b16 v[44:45], v11 offset:4096
  buffer_load_dwordx4 v[148:151], v91, s[8:11], s36 offen sc1
  v_mfma_f32_16x16x32_bf16 v[72:75], v[152:155], v[28:31], v[72:75]
  ds_read_b64_tr_b16 v[46:47], v11 offset:4608
  v_add_u32 v11, s42, v11
  s_barrier
  s_waitcnt vmcnt(13) lgkmcnt(6)
  v_mfma_f32_16x16x32_bf16 v[48:51], v[160:163], v[32:35], v[48:51]
  ds_read_b64_tr_b16 v[16:17], v8 offset:0
  s_bitcmp1_b32 s48, 6
  s_cselect_b32 s36, s50, s49
  s_waitcnt vmcnt(12)
  v_mfma_f32_16x16x32_bf16 v[52:55], v[164:167], v[32:35], v[52:55]
  ds_read_b64_tr_b16 v[18:19], v8 offset:512
  s_add_u32 s36, s36, 49152
  s_add_u32 s40, s43, 8192
  s_waitcnt lgkmcnt(6)
  v_mfma_f32_16x16x32_bf16 v[60:63], v[164:167], v[36:39], v[60:63]
  ds_read_b64_tr_b16 v[20:21], v9 offset:0
  s_cmp_eq_u32 s40, 98304
  s_cselect_b32 s40, 0, s40
  v_mfma_f32_16x16x32_bf16 v[56:59], v[160:163], v[36:39], v[56:59]
  ds_read_b64_tr_b16 v[22:23], v9 offset:512
  s_sub_u32 s42, s40, s43
  s_mov_b32 s43, s40
  s_waitcnt lgkmcnt(6)
  v_mfma_f32_16x16x32_bf16 v[64:67], v[160:163], v[40:43], v[64:67]
  ds_read_b64_tr_b16 v[24:25], v10 offset:0
  buffer_load_dwordx4 v[152:155], v88, s[8:11], s36 offen sc1
  v_mfma_f32_16x16x32_bf16 v[68:71], v[164:167], v[40:43], v[68:71]
  ds_read_b64_tr_b16 v[26:27], v10 offset:512
  s_waitcnt lgkmcnt(6)
  v_mfma_f32_16x16x32_bf16 v[76:79], v[164:167], v[44:47], v[76:79]
  ds_read_b64_tr_b16 v[28:29], v11 offset:0
  v_mfma_f32_16x16x32_bf16 v[72:75], v[160:163], v[44:47], v[72:75]
  ds_read_b64_tr_b16 v[30:31], v11 offset:512
  buffer_load_dwordx4 v[156:159], v89, s[8:11], s36 offen sc1
  s_waitcnt vmcnt(13) lgkmcnt(6)
  v_mfma_f32_16x16x32_bf16 v[48:51], v[168:171], v[16:19], v[48:51]
  ds_read_b64_tr_b16 v[32:33], v8 offset:4096
  s_waitcnt vmcnt(12)
  v_mfma_f32_16x16x32_bf16 v[52:55], v[172:175], v[16:19], v[52:55]
  ds_read_b64_tr_b16 v[34:35], v8 offset:4608
  v_add_u32 v8, s42, v8
  s_waitcnt lgkmcnt(6)
  v_mfma_f32_16x16x32_bf16 v[60:63], v[172:175], v[20:23], v[60:63]
  ds_read_b64_tr_b16 v[36:37], v9 offset:4096
  buffer_load_dwordx4 v[160:163], v90, s[8:11], s36 offen sc1
  v_mfma_f32_16x16x32_bf16 v[56:59], v[168:171], v[20:23], v[56:59]
  ds_read_b64_tr_b16 v[38:39], v9 offset:4608
  v_add_u32 v9, s42, v9
  s_waitcnt lgkmcnt(6)
  v_mfma_f32_16x16x32_bf16 v[64:67], v[168:171], v[24:27], v[64:67]
  ds_read_b64_tr_b16 v[40:41], v10 offset:4096
  v_mfma_f32_16x16x32_bf16 v[68:71], v[172:175], v[24:27], v[68:71]
  ds_read_b64_tr_b16 v[42:43], v10 offset:4608
  v_add_u32 v10, s42, v10
  s_waitcnt lgkmcnt(6)
  v_mfma_f32_16x16x32_bf16 v[76:79], v[172:175], v[28:31], v[76:79]
  ds_read_b64_tr_b16 v[44:45], v11 offset:4096
  buffer_load_dwordx4 v[164:167], v91, s[8:11], s36 offen sc1
  v_mfma_f32_16x16x32_bf16 v[72:75], v[168:171], v[28:31], v[72:75]
  ds_read_b64_tr_b16 v[46:47], v11 offset:4608
  v_add_u32 v11, s42, v11
  s_barrier
  s_waitcnt vmcnt(13) lgkmcnt(6)
  v_mfma_f32_16x16x32_bf16 v[48:51], v[176:179], v[32:35], v[48:51]
  ds_read_b64_tr_b16 v[16:17], v8 offset:0
  s_bitcmp1_b32 s48, 7
  s_cselect_b32 s36, s50, s49
  s_waitcnt vmcnt(12)
  v_mfma_f32_16x16x32_bf16 v[52:55], v[180:183], v[32:35], v[52:55]
  ds_read_b64_tr_b16 v[18:19], v8 offset:512
  s_add_u32 s36, s36, 57344
  s_add_u32 s40, s43, 8192
  s_waitcnt lgkmcnt(6)
  v_mfma_f32_16x16x32_bf16 v[60:63], v[180:183], v[36:39], v[60:63]
  ds_read_b64_tr_b16 v[20:21], v9 offset:0
  s_cmp_eq_u32 s40, 98304
  s_cselect_b32 s40, 0, s40
  v_mfma_f32_16x16x32_bf16 v[56:59], v[176:179], v[36:39], v[56:59]
  ds_read_b64_tr_b16 v[22:23], v9 offset:512
  s_sub_u32 s42, s40, s43
  s_mov_b32 s43, s40
  s_waitcnt lgkmcnt(6)
  v_mfma_f32_16x16x32_bf16 v[64:67], v[176:179], v[40:43], v[64:67]
  ds_read_b64_tr_b16 v[24:25], v10 offset:0
  buffer_load_dwordx4 v[168:171], v88, s[8:11], s36 offen sc1
  v_mfma_f32_16x16x32_bf16 v[68:71], v[180:183], v[40:43], v[68:71]
  ds_read_b64_tr_b16 v[26:27], v10 offset:512
  s_waitcnt lgkmcnt(6)
  v_mfma_f32_16x16x32_bf16 v[76:79], v[180:183], v[44:47], v[76:79]
  ds_read_b64_tr_b16 v[28:29], v11 offset:0
  v_mfma_f32_16x16x32_bf16 v[72:75], v[176:179], v[44:47], v[72:75]
  ds_read_b64_tr_b16 v[30:31], v11 offset:512
  buffer_load_dwordx4 v[172:175], v89, s[8:11], s36 offen sc1
  s_waitcnt vmcnt(13) lgkmcnt(6)
  v_mfma_f32_16x16x32_bf16 v[48:51], v[120:123], v[16:19], v[48:51]
  ds_read_b64_tr_b16 v[32:33], v8 offset:4096
  s_waitcnt vmcnt(12)
  v_mfma_f32_16x16x32_bf16 v[52:55], v[124:127], v[16:19], v[52:55]
  ds_read_b64_tr_b16 v[34:35], v8 offset:4608
  v_add_u32 v8, s42, v8
  s_waitcnt lgkmcnt(6)
  v_mfma_f32_16x16x32_bf16 v[60:63], v[124:127], v[20:23], v[60:63]
  ds_read_b64_tr_b16 v[36:37], v9 offset:4096
  buffer_load_dwordx4 v[176:179], v90, s[8:11], s36 offen sc1
  v_mfma_f32_16x16x32_bf16 v[56:59], v[120:123], v[20:23], v[56:59]
  ds_read_b64_tr_b16 v[38:39], v9 offset:4608
  v_add_u32 v9, s42, v9
  s_waitcnt lgkmcnt(6)
  v_mfma_f32_16x16x32_bf16 v[64:67], v[120:123], v[24:27], v[64:67]
  ds_read_b64_tr_b16 v[40:41], v10 offset:4096
  v_mfma_f32_16x16x32_bf16 v[68:71], v[124:127], v[24:27], v[68:71]
  ds_read_b64_tr_b16 v[42:43], v10 offset:4608
  v_add_u32 v10, s42, v10
  s_waitcnt lgkmcnt(6)
  v_mfma_f32_16x16x32_bf16 v[76:79], v[124:127], v[28:31], v[76:79]
  ds_read_b64_tr_b16 v[44:45], v11 offset:4096
  buffer_load_dwordx4 v[180:183], v91, s[8:11], s36 offen sc1
  v_mfma_f32_16x16x32_bf16 v[72:75], v[120:123], v[28:31], v[72:75]
  ds_read_b64_tr_b16 v[46:47], v11 offset:4608
  v_add_u32 v11, s42, v11
  s_barrier
  s_waitcnt vmcnt(13) lgkmcnt(6)
  v_mfma_f32_16x16x32_bf16 v[48:51], v[128:131], v[32:35], v[48:51]
  ds_read_b64_tr_b16 v[16:17], v8 offset:0
  s_add_u32 s40, s43, 8192
  s_cmp_eq_u32 s40, 98304
  s_waitcnt vmcnt(12)
  v_mfma_f32_16x16x32_bf16 v[52:55], v[132:135], v[32:35], v[52:55]
  ds_read_b64_tr_b16 v[18:19], v8 offset:512
  s_cselect_b32 s40, 0, s40
  s_sub_u32 s42, s40, s43
  s_waitcnt lgkmcnt(6)
  v_mfma_f32_16x16x32_bf16 v[60:63], v[132:135], v[36:39], v[60:63]
  ds_read_b64_tr_b16 v[20:21], v9 offset:0
  s_mov_b32 s43, s40
  v_mfma_f32_16x16x32_bf16 v[56:59], v[128:131], v[36:39], v[56:59]
  ds_read_b64_tr_b16 v[22:23], v9 offset:512
  s_waitcnt lgkmcnt(6)
  v_mfma_f32_16x16x32_bf16 v[64:67], v[128:131], v[40:43], v[64:67]
  ds_read_b64_tr_b16 v[24:25], v10 offset:0
  v_mfma_f32_16x16x32_bf16 v[68:71], v[132:135], v[40:43], v[68:71]
  ds_read_b64_tr_b16 v[26:27], v10 offset:512
  s_waitcnt lgkmcnt(6)
  v_mfma_f32_16x16x32_bf16 v[76:79], v[132:135], v[44:47], v[76:79]
  ds_read_b64_tr_b16 v[28:29], v11 offset:0
  v_mfma_f32_16x16x32_bf16 v[72:75], v[128:131], v[44:47], v[72:75]
  ds_read_b64_tr_b16 v[30:31], v11 offset:512
  s_waitcnt vmcnt(11) lgkmcnt(6)
  v_mfma_f32_16x16x32_bf16 v[48:51], v[136:139], v[16:19], v[48:51]
  ds_read_b64_tr_b16 v[32:33], v8 offset:4096
  s_waitcnt vmcnt(10)
  v_mfma_f32_16x16x32_bf16 v[52:55], v[140:143], v[16:19], v[52:55]
  ds_read_b64_tr_b16 v[34:35], v8 offset:4608
  v_add_u32 v8, s42, v8
  s_waitcnt lgkmcnt(6)
  v_mfma_f32_16x16x32_bf16 v[60:63], v[140:143], v[20:23], v[60:63]
  ds_read_b64_tr_b16 v[36:37], v9 offset:4096
  v_mfma_f32_16x16x32_bf16 v[56:59], v[136:139], v[20:23], v[56:59]
  ds_read_b64_tr_b16 v[38:39], v9 offset:4608
  v_add_u32 v9, s42, v9
  s_waitcnt lgkmcnt(6)
  v_mfma_f32_16x16x32_bf16 v[64:67], v[136:139], v[24:27], v[64:67]
  ds_read_b64_tr_b16 v[40:41], v10 offset:4096
  v_mfma_f32_16x16x32_bf16 v[68:71], v[140:143], v[24:27], v[68:71]
  ds_read_b64_tr_b16 v[42:43], v10 offset:4608
  v_add_u32 v10, s42, v10
  s_waitcnt lgkmcnt(6)
  v_mfma_f32_16x16x32_bf16 v[76:79], v[140:143], v[28:31], v[76:79]
  ds_read_b64_tr_b16 v[44:45], v11 offset:4096
  v_mfma_f32_16x16x32_bf16 v[72:75], v[136:139], v[28:31], v[72:75]
  ds_read_b64_tr_b16 v[46:47], v11 offset:4608
  v_add_u32 v11, s42, v11
  s_barrier
  s_waitcnt vmcnt(9) lgkmcnt(6)
  v_mfma_f32_16x16x32_bf16 v[48:51], v[144:147], v[32:35], v[48:51]
  ds_read_b64_tr_b16 v[16:17], v8 offset:0
  s_add_u32 s40, s43, 8192
  s_cmp_eq_u32 s40, 98304
  s_waitcnt vmcnt(8)
  v_mfma_f32_16x16x32_bf16 v[52:55], v[148:151], v[32:35], v[52:55]
  ds_read_b64_tr_b16 v[18:19], v8 offset:512
  s_cselect_b32 s40, 0, s40
  s_sub_u32 s42, s40, s43
  s_waitcnt lgkmcnt(6)
  v_mfma_f32_16x16x32_bf16 v[60:63], v[148:151], v[36:39], v[60:63]
  ds_read_b64_tr_b16 v[20:21], v9 offset:0
  s_mov_b32 s43, s40
  v_mfma_f32_16x16x32_bf16 v[56:59], v[144:147], v[36:39], v[56:59]
  ds_read_b64_tr_b16 v[22:23], v9 offset:512
  s_waitcnt lgkmcnt(6)
  v_mfma_f32_16x16x32_bf16 v[64:67], v[144:147], v[40:43], v[64:67]
  ds_read_b64_tr_b16 v[24:25], v10 offset:0
  v_mfma_f32_16x16x32_bf16 v[68:71], v[148:151], v[40:43], v[68:71]
  ds_read_b64_tr_b16 v[26:27], v10 offset:512
  s_waitcnt lgkmcnt(6)
  v_mfma_f32_16x16x32_bf16 v[76:79], v[148:151], v[44:47], v[76:79]
  ds_read_b64_tr_b16 v[28:29], v11 offset:0
  v_mfma_f32_16x16x32_bf16 v[72:75], v[144:147], v[44:47], v[72:75]
  ds_read_b64_tr_b16 v[30:31], v11 offset:512
  s_waitcnt vmcnt(7) lgkmcnt(6)
  v_mfma_f32_16x16x32_bf16 v[48:51], v[152:155], v[16:19], v[48:51]
  ds_read_b64_tr_b16 v[32:33], v8 offset:4096
  s_waitcnt vmcnt(6)
  v_mfma_f32_16x16x32_bf16 v[52:55], v[156:159], v[16:19], v[52:55]
  ds_read_b64_tr_b16 v[34:35], v8 offset:4608
  v_add_u32 v8, s42, v8
  s_waitcnt lgkmcnt(6)
  v_mfma_f32_16x16x32_bf16 v[60:63], v[156:159], v[20:23], v[60:63]
  ds_read_b64_tr_b16 v[36:37], v9 offset:4096
  v_mfma_f32_16x16x32_bf16 v[56:59], v[152:155], v[20:23], v[56:59]
  ds_read_b64_tr_b16 v[38:39], v9 offset:4608
  v_add_u32 v9, s42, v9
  s_waitcnt lgkmcnt(6)
  v_mfma_f32_16x16x32_bf16 v[64:67], v[152:155], v[24:27], v[64:67]
  ds_read_b64_tr_b16 v[40:41], v10 offset:4096
  v_mfma_f32_16x16x32_bf16 v[68:71], v[156:159], v[24:27], v[68:71]
  ds_read_b64_tr_b16 v[42:43], v10 offset:4608
  v_add_u32 v10, s42, v10
  s_waitcnt lgkmcnt(6)
  v_mfma_f32_16x16x32_bf16 v[76:79], v[156:159], v[28:31], v[76:79]
  ds_read_b64_tr_b16 v[44:45], v11 offset:4096
  v_mfma_f32_16x16x32_bf16 v[72:75], v[152:155], v[28:31], v[72:75]
  ds_read_b64_tr_b16 v[46:47], v11 offset:4608
  v_add_u32 v11, s42, v11
  s_barrier
  s_waitcnt vmcnt(5) lgkmcnt(6)
  v_mfma_f32_16x16x32_bf16 v[48:51], v[160:163], v[32:35], v[48:51]
  ds_read_b64_tr_b16 v[16:17], v8 offset:0
  s_add_u32 s40, s43, 8192
  s_cmp_eq_u32 s40, 98304
  s_waitcnt vmcnt(4)
  v_mfma_f32_16x16x32_bf16 v[52:55], v[164:167], v[32:35], v[52:55]
  ds_read_b64_tr_b16 v[18:19], v8 offset:512
  s_cselect_b32 s40, 0, s40
  s_sub_u32 s42, s40, s43
  s_waitcnt lgkmcnt(6)
  v_mfma_f32_16x16x32_bf16 v[60:63], v[164:167], v[36:39], v[60:63]
  ds_read_b64_tr_b16 v[20:21], v9 offset:0
  s_mov_b32 s43, s40
  v_mfma_f32_16x16x32_bf16 v[56:59], v[160:163], v[36:39], v[56:59]
  ds_read_b64_tr_b16 v[22:23], v9 offset:512
  s_waitcnt lgkmcnt(6)
  v_mfma_f32_16x16x32_bf16 v[64:67], v[160:163], v[40:43], v[64:67]
  ds_read_b64_tr_b16 v[24:25], v10 offset:0
  v_mfma_f32_16x16x32_bf16 v[68:71], v[164:167], v[40:43], v[68:71]
  ds_read_b64_tr_b16 v[26:27], v10 offset:512
  s_waitcnt lgkmcnt(6)
  v_mfma_f32_16x16x32_bf16 v[76:79], v[164:167], v[44:47], v[76:79]
  ds_read_b64_tr_b16 v[28:29], v11 offset:0
  v_mfma_f32_16x16x32_bf16 v[72:75], v[160:163], v[44:47], v[72:75]
  ds_read_b64_tr_b16 v[30:31], v11 offset:512
  s_waitcnt vmcnt(3) lgkmcnt(6)
  v_mfma_f32_16x16x32_bf16 v[48:51], v[168:171], v[16:19], v[48:51]
  ds_read_b64_tr_b16 v[32:33], v8 offset:4096
  s_waitcnt vmcnt(2)
  v_mfma_f32_16x16x32_bf16 v[52:55], v[172:175], v[16:19], v[52:55]
  ds_read_b64_tr_b16 v[34:35], v8 offset:4608
  s_waitcnt lgkmcnt(6)
  v_mfma_f32_16x16x32_bf16 v[60:63], v[172:175], v[20:23], v[60:63]
  ds_read_b64_tr_b16 v[36:37], v9 offset:4096
  v_mfma_f32_16x16x32_bf16 v[56:59], v[168:171], v[20:23], v[56:59]
  ds_read_b64_tr_b16 v[38:39], v9 offset:4608
  s_waitcnt lgkmcnt(6)
  v_mfma_f32_16x16x32_bf16 v[64:67], v[168:171], v[24:27], v[64:67]
  ds_read_b64_tr_b16 v[40:41], v10 offset:4096
  v_mfma_f32_16x16x32_bf16 v[68:71], v[172:175], v[24:27], v[68:71]
  ds_read_b64_tr_b16 v[42:43], v10 offset:4608
  s_waitcnt lgkmcnt(6)
  v_mfma_f32_16x16x32_bf16 v[76:79], v[172:175], v[28:31], v[76:79]
  ds_read_b64_tr_b16 v[44:45], v11 offset:4096
  v_mfma_f32_16x16x32_bf16 v[72:75], v[168:171], v[28:31], v[72:75]
  ds_read_b64_tr_b16 v[46:47], v11 offset:4608
  s_waitcnt vmcnt(1) lgkmcnt(6)
  v_mfma_f32_16x16x32_bf16 v[48:51], v[176:179], v[32:35], v[48:51]
  s_waitcnt vmcnt(0)
  v_mfma_f32_16x16x32_bf16 v[52:55], v[180:183], v[32:35], v[52:55]
  s_waitcnt lgkmcnt(4)
  v_mfma_f32_16x16x32_bf16 v[60:63], v[180:183], v[36:39], v[60:63]
  v_mfma_f32_16x16x32_bf16 v[56:59], v[176:179], v[36:39], v[56:59]
  s_waitcnt lgkmcnt(2)
  v_mfma_f32_16x16x32_bf16 v[64:67], v[176:179], v[40:43], v[64:67]
  v_mfma_f32_16x16x32_bf16 v[68:71], v[180:183], v[40:43], v[68:71]
  s_waitcnt lgkmcnt(0)
  v_mfma_f32_16x16x32_bf16 v[76:79], v[180:183], v[44:47], v[76:79]
  v_mfma_f32_16x16x32_bf16 v[72:75], v[176:179], v[44:47], v[72:75]
  s_waitcnt lgkmcnt(0)
  s_cmp_eq_u32 s3, 0
  s_cbranch_scc1 C_st
  v_cvt_pk_bf16_f32 v96, v48, v49
  v_cvt_pk_bf16_f32 v97, v50, v51
  v_cvt_pk_bf16_f32 v98, v52, v53
  v_cvt_pk_bf16_f32 v99, v54, v55
  ds_write_b128 v189, v[96:99] offset:0
  v_cvt_pk_bf16_f32 v100, v56, v57
  v_cvt_pk_bf16_f32 v101, v58, v59
  v_cvt_pk_bf16_f32 v102, v60, v61
  v_cvt_pk_bf16_f32 v103, v62, v63
  ds_write_b128 v189, v[100:103] offset:4352
  v_cvt_pk_bf16_f32 v104, v64, v65
  v_cvt_pk_bf16_f32 v105, v66, v67
  v_cvt_pk_bf16_f32 v106, v68, v69
  v_cvt_pk_bf16_f32 v107, v70, v71
  ds_write_b128 v189, v[104:107] offset:8704
  v_cvt_pk_bf16_f32 v108, v72, v73
  v_cvt_pk_bf16_f32 v109, v74, v75
  v_cvt_pk_bf16_f32 v110, v76, v77
  v_cvt_pk_bf16_f32 v111, v78, v79
  ds_write_b128 v189, v[108:111] offset:13056
  s_waitcnt lgkmcnt(0)
  s_barrier
  ds_read_b128 v[96:99], v190 offset:0
  ds_read_b128 v[100:103], v190 offset:1088
  ds_read_b128 v[104:107], v190 offset:2176
  ds_read_b128 v[108:111], v190 offset:3264
  s_waitcnt lgkmcnt(3)
  buffer_store_dwordx4 v[96:99], v12, s[24:27], 0 offen
  s_waitcnt lgkmcnt(2)
  buffer_store_dwordx4 v[100:103], v12, s[24:27], s45 offen
  s_waitcnt lgkmcnt(1)
  buffer_store_dwordx4 v[104:107], v12, s[24:27], s46 offen
  s_waitcnt lgkmcnt(0)
  buffer_store_dwordx4 v[108:111], v12, s[24:27], s47 offen
  s_branch C_end
C_st:
  s_nop 7
  v_pk_add_f32 v[16:17], v[48:49], v[50:51]
  v_pk_mul_f32 v[18:19], v[48:49], v[48:49]
  v_pk_fma_f32 v[18:19], v[50:51], v[50:51], v[18:19]
  v_pk_add_f32 v[16:17], v[16:17], v[52:53]
  v_pk_fma_f32 v[18:19], v[52:53], v[52:53], v[18:19]
  v_pk_add_f32 v[16:17], v[16:17], v[54:55]
  v_pk_fma_f32 v[18:19], v[54:55], v[54:55], v[18:19]
  v_add_f32 v32, v16, v17
  v_add_f32 v36, v18, v19
  v_pk_add_f32 v[20:21], v[56:57], v[58:59]
  v_pk_mul_f32 v[22:23], v[56:57], v[56:57]
  v_pk_fma_f32 v[22:23], v[58:59], v[58:59], v[22:23]
  v_pk_add_f32 v[20:21], v[20:21], v[60:61]
  v_pk_fma_f32 v[22:23], v[60:61], v[60:61], v[22:23]
  v_pk_add_f32 v[20:21], v[20:21], v[62:63]
  v_pk_fma_f32 v[22:23], v[62:63], v[62:63], v[22:23]
  v_add_f32 v33, v20, v21
  v_add_f32 v37, v22, v23
  v_pk_add_f32 v[24:25], v[64:65], v[66:67]
  v_pk_mul_f32 v[26:27], v[64:65], v[64:65]
  v_pk_fma_f32 v[26:27], v[66:67], v[66:67], v[26:27]
  v_pk_add_f32 v[24:25], v[24:25], v[68:69]
  v_pk_fma_f32 v[26:27], v[68:69], v[68:69], v[26:27]
  v_pk_add_f32 v[24:25], v[24:25], v[70:71]
  v_pk_fma_f32 v[26:27], v[70:71], v[70:71], v[26:27]
  v_add_f32 v34, v24, v25
  v_add_f32 v38, v26, v27
  v_pk_add_f32 v[28:29], v[72:73], v[74:75]
  v_pk_mul_f32 v[30:31], v[72:73], v[72:73]
  v_pk_fma_f32 v[30:31], v[74:75], v[74:75], v[30:31]
  v_pk_add_f32 v[28:29], v[28:29], v[76:77]
  v_pk_fma_f32 v[30:31], v[76:77], v[76:77], v[30:31]
  v_pk_add_f32 v[28:29], v[28:29], v[78:79]
  v_pk_fma_f32 v[30:31], v[78:79], v[78:79], v[30:31]
  v_add_f32 v35, v28, v29
  v_add_f32 v39, v30, v31
  v_permlane16_swap_b32 v32, v33
  v_permlane16_swap_b32 v34, v35
  v_permlane16_swap_b32 v36, v37
  v_permlane16_swap_b32 v38, v39
  v_add_f32 v32, v32, v33
  v_add_f32 v34, v34, v35
  v_add_f32 v36, v36, v37
  v_add_f32 v38, v38, v39
  v_permlane32_swap_b32 v32, v34
  s_nop 0
  v_permlane32_swap_b32 v36, v38
  v_add_f32 v40, v32, v34
  v_add_f32 v41, v36, v38
  ds_write_b64 v185, v[40:41]
  s_lshl_b32 s32, s28, 15
  s_lshl_b32 s40, s29, 10
  s_add_u32 s32, s32, s40
  s_add_u32 s32, s32, 512
  v_cvt_pk_bf16_f32 v96, v48, v49
  v_cvt_pk_bf16_f32 v97, v50, v51
  v_cvt_pk_bf16_f32 v98, v52, v53
  v_cvt_pk_bf16_f32 v99, v54, v55
  ds_write_b128 v189, v[96:99] offset:0
  v_cvt_pk_bf16_f32 v100, v56, v57
  v_cvt_pk_bf16_f32 v101, v58, v59
  v_cvt_pk_bf16_f32 v102, v60, v61
  v_cvt_pk_bf16_f32 v103, v62, v63
  ds_write_b128 v189, v[100:103] offset:4352
  v_cvt_pk_bf16_f32 v104, v64, v65
  v_cvt_pk_bf16_f32 v105, v66, v67
  v_cvt_pk_bf16_f32 v106, v68, v69
  v_cvt_pk_bf16_f32 v107, v70, v71
  ds_write_b128 v189, v[104:107] offset:8704
  v_cvt_pk_bf16_f32 v108, v72, v73
  v_cvt_pk_bf16_f32 v109, v74, v75
  v_cvt_pk_bf16_f32 v110, v76, v77
  v_cvt_pk_bf16_f32 v111, v78, v79
  ds_write_b128 v189, v[108:111] offset:13056
  s_waitcnt lgkmcnt(0)
  s_barrier
  s_cmp_lg_u32 s4, 0
  s_cbranch_scc1 C_nost
  ds_read_b64 v[44:45], v185 offset:512
  ds_read_b64 v[46:47], v185 offset:1024
  ds_read_b64 v[18:19], v185 offset:1536
  s_waitcnt lgkmcnt(0)
  v_pk_add_f32 v[40:41], v[40:41], v[44:45]
  v_pk_add_f32 v[46:47], v[46:47], v[18:19]
  v_pk_add_f32 v[40:41], v[40:41], v[46:47]
  buffer_store_dwordx2 v[40:41], v184, s[12:15], s32 offen sc0 sc1
C_nost:
  s_nop 1
  ds_read_b128 v[96:99], v190 offset:0
  ds_read_b128 v[100:103], v190 offset:1088
  ds_read_b128 v[104:107], v190 offset:2176
  ds_read_b128 v[108:111], v190 offset:3264
  s_waitcnt lgkmcnt(3)
  buffer_store_dwordx4 v[96:99], v186, s[24:27], 0 offen offset:0 sc0 sc1
  s_waitcnt lgkmcnt(2)
  buffer_store_dwordx4 v[100:103], v186, s[24:27], 0 offen offset:1024 sc0 sc1
  s_waitcnt lgkmcnt(1)
  buffer_store_dwordx4 v[104:107], v186, s[24:27], 0 offen offset:2048 sc0 sc1
  s_waitcnt lgkmcnt(0)
  buffer_store_dwordx4 v[108:111], v186, s[24:27], 0 offen offset:3072 sc0 sc1
  s_lshr_b32 s32, s2, 3
  s_lshr_b32 s5, s32, 3
  s_and_b32 s6, s32, 7
  s_lshl_b32 s7, s5, 1
  s_add_u32 s7, s7, s6
  s_and_b32 s7, s7, 7
  s_and_b32 s32, s2, 7
  s_lshr_b32 s28, s32, 1
  s_lshl_b32 s28, s28, 2
  s_add_u32 s28, s28, s5
  s_and_b32 s29, s32, 1
  s_mul_i32 s29, s29, 8
  s_add_u32 s29, s29, s6
  s_mov_b32 s30, 7
  s_mov_b32 s31, -1
  v_and_b32 v4, 15, v0
  v_lshrrev_b32 v5, 4, v0
  v_lshrrev_b32 v6, 2, v4
  v_and_b32 v7, 3, v0
  v_lshrrev_b32 v3, 5, v0
  v_and_b32 v2, 1, v5
  v_lshl_or_b32 v3, v2, 1, v3
  v_lshl_add_u32 v21, v5, 3, v6
  v_lshlrev_b32 v21, 7, v21
  v_lshl_add_u32 v21, v7, 3, v21
  v_lshrrev_b32 v22, 1, v6
  v_lshl_or_b32 v22, v2, 1, v22
  v_lshl_add_u32 v21, v22, 5, v21
  v_add_u32 v21, 18432, v21
  v_xor_b32 v8, 0, v21
  s_lshl_b32 s32, s4, 5
  v_xor_b32 v8, s32, v8
  v_lshrrev_b32 v21, 1, v4
  v_xor_b32 v21, v21, v5
  v_lshlrev_b32 v21, 4, v21
  v_lshlrev_b32 v22, 7, v4
  v_add_u32 v9, v21, v22
  v_xor_b32 v10, 64, v9
  v_and_b32 v21, 1, v4
  v_mul_u32_u24 v21, 28800, v21
  v_lshrrev_b32 v22, 1, v4
  v_mul_u32_u24 v22, 400, v22
  v_lshlrev_b32 v23, 3, v5
  v_add3_u32 v11, v21, v22, v23
  s_add_u32 s32, s32, 43008
  v_add_u32 v11, s32, v11
  v_lshlrev_b32 v12, 3, v4
  v_add_u32 v12, 129024, v12
  v_mov_b64 v[112:113], 0
  v_mov_b64 v[114:115], 0
  v_mov_b64 v[116:117], 0
  v_mov_b64 v[118:119], 0
  v_mov_b64 v[120:121], 0
  v_mov_b64 v[122:123], 0
  v_mov_b64 v[124:125], 0
  v_mov_b64 v[126:127], 0
  v_mov_b64 v[128:129], 0
  v_mov_b64 v[130:131], 0
  v_mov_b64 v[132:133], 0
  v_mov_b64 v[134:135], 0
  v_mov_b64 v[136:137], 0
  v_mov_b64 v[138:139], 0
  v_mov_b64 v[140:141], 0
  v_mov_b64 v[142:143], 0
  v_mov_b64 v[144:145], 0
  v_mov_b64 v[146:147], 0
  v_mov_b64 v[148:149], 0
  v_mov_b64 v[150:151], 0
  v_mov_b64 v[152:153], 0
  v_mov_b64 v[154:155], 0
  v_mov_b64 v[156:157], 0
  v_mov_b64 v[158:159], 0
  v_mov_b64 v[160:161], 0
  v_mov_b64 v[162:163], 0
  v_mov_b64 v[164:165], 0
  v_mov_b64 v[166:167], 0
  v_mov_b64 v[168:169], 0
  v_mov_b64 v[170:171], 0
  v_mov_b64 v[172:173], 0
  v_mov_b64 v[174:175], 0
  v_mov_b64 v[176:177], 0
  v_mov_b64 v[178:179], 0
  v_mov_b64 v[180:181], 0
  v_mov_b64 v[182:183], 0
  v_mov_b64 v[184:185], 0
  v_mov_b64 v[186:187], 0
  v_mov_b64 v[188:189], 0
  v_mov_b64 v[190:191], 0
  v_mov_b64 v[192:193], 0
  v_mov_b64 v[194:195], 0
  v_mov_b64 v[196:197], 0
  v_mov_b64 v[198:199], 0
  v_mov_b64 v[200:201], 0
  v_mov_b64 v[202:203], 0
  v_mov_b64 v[204:205], 0
  v_mov_b64 v[206:207], 0
  v_mov_b64 v[208:209], 0
  v_mov_b64 v[210:211], 0
  v_mov_b64 v[212:213], 0
  v_mov_b64 v[214:215], 0
  v_mov_b64 v[216:217], 0
  v_mov_b64 v[218:219], 0
  s_waitcnt vmcnt(0)
  s_barrier
  s_mov_b32 s16, s66
  s_mov_b32 s17, s67
  s_mov_b32 s18, 6291456
  s_mov_b32 s19, 0x20000
  s_lshr_b32 s32, s2, 3
  s_lshl_b32 s32, s32, 1
  s_add_u32 s32, s32, s4
  s_sub_u32 s32, s32, 1
  s_lshl_b32 s32, s32, 6
  v_add_u32 v16, s32, v0
  v_mul_u32_u24 v17, 21846, v16
  v_lshrrev_b32 v17, 16, v17
  v_mul_u32_u24 v18, 3, v17
  v_sub_u32 v18, v16, v18
  v_mul_u32_u24 v17, 6144, v17
  v_lshl_add_u32 v14, v18, 11, v17
  s_and_b32 s32, s2, 1
  s_lshl_b32 s32, s32, 10
  s_add_u32 s32, s32, 384
  s_sub_u32 s40, s4, 1
  s_cmp_lt_u32 s40, 2
  s_cselect_b32 s18, s18, 0
  buffer_load_dword v15, v14, s[16:19], s32 offen
  s_barrier
  s_mov_b32 s3, 1
  s_mov_b32 s51, 9
  s_add_u32 s82, s84, 50331648
  s_addc_u32 s83, s85, 0
  s_branch C_top1
C_end:
  s_endpgm
L_start:
  s_nop 7
  s_nop 7
  s_sub_u32 s57, s4, 4
  v_and_b32 v134, 3, v0
  v_lshlrev_b32 v134, 6, v134
  s_lshr_b32 s32, s2, 3
  s_lshr_b32 s5, s32, 3
  s_and_b32 s6, s32, 7
  s_lshl_b32 s7, s5, 1
  s_add_u32 s7, s7, s6
  s_and_b32 s7, s7, 7
  s_and_b32 s32, s2, 7
  s_lshr_b32 s28, s32, 1
  s_lshl_b32 s28, s28, 2
  s_add_u32 s28, s28, s5
  s_and_b32 s29, s32, 1
  s_mul_i32 s29, s29, 8
  s_add_u32 s29, s29, s6
  s_mov_b32 s30, 7
  s_mov_b32 s31, -1
  s_mov_b32 s41, s57
  s_mul_i32 s32, s41, 16
  s_add_u32 s32, s32, 0
  v_lshrrev_b32 v2, 3, v0
  v_add_u32 v2, s32, v2
  v_bfe_u32 v3, v2, 1, 1
  v_bfe_u32 v4, v2, 3, 1
  v_lshl_or_b32 v3, v4, 1, v3
  v_lshlrev_b32 v3, 1, v3
  v_and_b32 v4, 7, v0
  v_xor_b32 v3, v3, v4
  v_lshlrev_b32 v3, 4, v3
  s_mov_b32 s32, 6144
  v_mul_lo_u32 v2, v2, s32
  v_add_u32 v13, v2, v3
  s_mul_i32 s32, s41, 16
  s_add_u32 s32, s32, 8
  v_lshrrev_b32 v2, 3, v0
  v_add_u32 v2, s32, v2
  v_bfe_u32 v3, v2, 1, 1
  v_bfe_u32 v4, v2, 3, 1
  v_lshl_or_b32 v3, v4, 1, v3
  v_lshlrev_b32 v3, 1, v3
  v_and_b32 v4, 7, v0
  v_xor_b32 v3, v3, v4
  v_lshlrev_b32 v3, 4, v3
  s_mov_b32 s32, 6144
  v_mul_lo_u32 v2, v2, s32
  v_add_u32 v14, v2, v3
  v_subrev_u32 v14, 1024, v14
  v_add_u32 v15, 2048, v13
  v_add_u32 v16, 2048, v14
  v_add_u32 v17, 4096, v13
  v_add_u32 v18, 4096, v14
  s_lshl_b32 s46, s41, 11
  s_add_u32 s46, s46, 18432
  s_add_u32 s47, s46, 8192
  s_add_u32 s48, s46, 16384
  s_lshl_b32 s35, s29, 7
  s_lshl_b32 s40, s28, 7
  s_sub_u32 s40, s40, 16
  s_lshl_b32 s32, s41, 5
  s_add_u32 s32, s32, 16
  v_lshrrev_b32 v2, 3, v0
  v_add_u32 v2, s32, v2
  v_bfe_u32 v3, v2, 1, 3
  v_and_b32 v4, 7, v0
  v_xor_b32 v3, v3, v4
  v_lshlrev_b32 v3, 4, v3
  v_add_u32 v2, s40, v2
  v_max_i32 v2, 0, v2
  v_lshlrev_b32 v2, 11, v2
  v_add_u32 v8, v2, v3
  v_add_u32 v10, 30720, v8
  s_lshl_b32 s32, s41, 5
  s_add_u32 s32, s32, 24
  v_lshrrev_b32 v2, 3, v0
  v_add_u32 v2, s32, v2
  v_bfe_u32 v3, v2, 1, 3
  v_and_b32 v4, 7, v0
  v_xor_b32 v3, v3, v4
  v_lshlrev_b32 v3, 4, v3
  v_add_u32 v2, s40, v2
  v_max_i32 v2, 0, v2
  v_lshlrev_b32 v2, 11, v2
  v_add_u32 v9, v2, v3
  v_subrev_u32 v9, 1024, v9
  v_add_u32 v11, 30720, v9
  s_lshl_b32 s32, s41, 3
  v_lshrrev_b32 v2, 3, v0
  v_add_u32 v2, s32, v2
  v_bfe_u32 v3, v2, 1, 3
  v_and_b32 v4, 7, v0
  v_xor_b32 v3, v3, v4
  v_lshlrev_b32 v3, 4, v3
  v_add_u32 v2, s40, v2
  v_max_i32 v2, 0, v2
  v_lshlrev_b32 v2, 11, v2
  v_add_u32 v12, v2, v3
  s_lshl_b32 s44, s41, 12
  s_add_u32 s44, s44, 2048
  s_lshl_b32 s45, s41, 10
  s_mov_b32 s34, 0
  s_mov_b32 s54, 128
  s_cmp_eq_u32 s41, 0
  s_cselect_b32 s52, 0xffffff00, -1
  s_mov_b32 s53, -1
  v_mov_b32 v20, 0x3f803f80
  v_mov_b32 v21, v20
  v_mov_b32 v22, v20
  v_mov_b32 v23, v20
  v_lshlrev_b32 v24, 4, v0
  v_add_u32 v25, 86016, v24
  s_mov_b64 exec, 0xff
  ds_write_b128 v24, v[20:23]
  ds_write_b128 v24, v[20:23] offset:43008
  ds_write_b128 v25, v[20:23]
  s_mov_b64 exec, -1
  s_lshl_b32 s32, s41, 6
  v_add_u32 v26, s32, v0
  v_min_u32 v26, 143, v26
  v_add_u32 v27, s40, v26
  v_max_i32 v27, 0, v27
  v_lshrrev_b32 v2, 6, v27
  v_and_b32 v27, 63, v27
  v_lshlrev_b32 v27, 3, v27
  v_lshl_add_u32 v27, v2, 10, v27
  v_add_u32 v27, 512, v27
  v_lshlrev_b32 v26, 3, v26
  v_add_u32 v26, 129024, v26
  s_lshl_b32 s32, s2, 3
  s_lshl_b32 s40, s57, 1
  s_add_u32 s32, s32, s40
  v_lshrrev_b32 v72, 5, v0
  v_add_u32 v72, s32, v72
  v_lshlrev_b32 v46, 11, v72
  v_and_b32 v2, 31, v0
  v_lshl_add_u32 v46, v2, 4, v46
  v_lshrrev_b32 v2, 6, v72
  v_and_b32 v72, 63, v72
  v_lshlrev_b32 v72, 3, v72
  v_lshl_add_u32 v72, v2, 10, v72
  v_add_u32 v72, 42992128, v72
  s_cmp_eq_u32 s57, 0
  s_cselect_b32 s58, 0, -1
  v_mov_b32 v64, s58
  v_mov_b32 v65, s58
  v_mov_b32 v66, s58
  v_mov_b32 v67, s58
  v_lshrrev_b32 v2, 3, v0
  v_lshlrev_b32 v2, 15, v2
  v_and_b32 v3, 7, v0
  v_lshl_add_u32 v2, v3, 4, v2
  v_lshrrev_b32 v4, 4, v0
  v_and_b32 v3, 15, v0
  v_lshlrev_b32 v3, 4, v3
  v_lshl_add_u32 v3, v4, 8, v3
  s_cselect_b64 vcc, -1, 0
  s_lshl_b32 s58, s2, 7
  s_add_u32 s58, s58, 109051904
  s_lshl_b32 s59, s2, 10
  s_add_u32 s59, s59, 41943040
  s_cmp_eq_u32 s57, 0
  s_cselect_b32 s58, s58, s59
  s_add_u32 s59, s59, 50331648
  s_cmp_eq_u32 s57, 2
  s_cselect_b32 s58, s59, s58
  s_lshr_b32 s59, s2, 2
  s_mul_i32 s59, s59, 50331648
  s_and_b32 s32, s2, 3
  s_lshl_b32 s32, s32, 10
  s_add_u32 s59, s59, s32
  s_add_u32 s59, s59, 42205184
  s_cmp_lt_u32 s2, 8
  s_cselect_b32 s59, s59, 134217728
  s_cmp_eq_u32 s57, 3
  s_cselect_b32 s58, s59, s58
  v_cndmask_b32 v47, v3, v2, vcc
  s_and_b32 s59, s2, 3
  s_lshl_b32 s59, s59, 6
  v_mov_b32 v73, s59
  v_mov_b32 v74, 1
  s_lshl_b32 s56, s3, 10
  s_mul_i32 s32, s28, 16
  s_add_u32 s56, s56, s32
  s_add_u32 s56, s56, s29
  s_add_u32 s56, s56, 0
  s_lshl_b32 s56, s56, 7
  s_mov_b32 s38, 0
  s_waitcnt lgkmcnt(0)
  s_mov_b32 s8, s64
  s_mov_b32 s9, s65
  s_mov_b32 s10, 4194304
  s_mov_b32 s11, 0x20000
  s_mov_b32 s12, s66
  s_mov_b32 s13, s67
  s_mov_b32 s14, 6291456
  s_mov_b32 s15, 0x20000
  s_branch L_first
L_top:
  s_nop 7
  s_nop 7
  s_lshl_b32 s56, s3, 10
  s_mul_i32 s32, s28, 16
  s_add_u32 s56, s56, s32
  s_add_u32 s56, s56, s29
  s_add_u32 s56, s56, 0
  s_lshl_b32 s56, s56, 7
  s_mov_b32 s24, s72
  s_mov_b32 s25, s73
  s_mov_b32 s26, 14680064
  s_mov_b32 s27, 0x20000
  s_cmp_ge_u32 s57, 2
  s_cbranch_scc1 L_k1B
  s_mov_b32 s30, 7
  s_mov_b32 s31, -1
  s_mov_b32 s38, 0
  s_add_u32 s30, s30, 1
  s_and_b32 s30, s30, 7
  s_cselect_b32 s32, 0, 1
  s_add_u32 s31, s31, s32
  s_sub_u32 s32, s30, s7
  s_and_b32 s32, s32, 7
  s_cmp_lt_u32 s32, 2
  s_cselect_b32 s32, 1, 0
  s_add_u32 s32, s32, s31
  s_cmp_ge_u32 s32, 2
  s_cselect_b32 s32, 0, s32
  s_lshl_b32 s33, s32, 3
  s_add_u32 s33, s33, s30
  s_mul_i32 s36, s33, s54
  s_add_u32 s36, s36, s34
  s_add_u32 m0, s38, s45
  s_mov_b64 exec, s[52:53]
  buffer_load_dwordx4 v12, s[8:11], s36 offen offset:0 sc1 lds
  s_mov_b64 exec, -1
  s_add_u32 m0, s38, s44
  s_nop 0
  buffer_load_dwordx4 v8, s[8:11], s36 offen offset:0 sc1 lds
  buffer_load_dwordx4 v9, s[8:11], s36 offen offset:1024 sc1 lds
  buffer_load_dwordx4 v10, s[8:11], s36 offen offset:2048 sc1 lds
  buffer_load_dwordx4 v11, s[8:11], s36 offen offset:3072 sc1 lds
  s_add_u32 s38, s38, 43008
  s_cmp_eq_u32 s38, 129024
  s_cselect_b32 s38, 0, s38
  s_add_u32 s30, s30, 1
  s_and_b32 s30, s30, 7
  s_cselect_b32 s32, 0, 1
  s_add_u32 s31, s31, s32
  s_sub_u32 s32, s30, s7
  s_and_b32 s32, s32, 7
  s_cmp_lt_u32 s32, 2
  s_cselect_b32 s32, 1, 0
  s_add_u32 s32, s32, s31
  s_cmp_ge_u32 s32, 2
  s_cselect_b32 s32, 0, s32
  s_lshl_b32 s33, s32, 3
  s_add_u32 s33, s33, s30
  s_mul_i32 s36, s33, s54
  s_add_u32 s36, s36, s34
  s_add_u32 m0, s38, s45
  s_mov_b64 exec, s[52:53]
  buffer_load_dwordx4 v12, s[8:11], s36 offen offset:0 sc1 lds
  s_mov_b64 exec, -1
  s_add_u32 m0, s38, s44
  s_nop 0
  buffer_load_dwordx4 v8, s[8:11], s36 offen offset:0 sc1 lds
  buffer_load_dwordx4 v9, s[8:11], s36 offen offset:1024 sc1 lds
  buffer_load_dwordx4 v10, s[8:11], s36 offen offset:2048 sc1 lds
  buffer_load_dwordx4 v11, s[8:11], s36 offen offset:3072 sc1 lds
  s_add_u32 s38, s38, 43008
  s_cmp_eq_u32 s38, 129024
  s_cselect_b32 s38, 0, s38
  s_waitcnt vmcnt(5)
  s_barrier
  s_add_u32 s30, s30, 1
  s_and_b32 s30, s30, 7
  s_cselect_b32 s32, 0, 1
  s_add_u32 s31, s31, s32
  s_sub_u32 s32, s30, s7
  s_and_b32 s32, s32, 7
  s_cmp_lt_u32 s32, 2
  s_cselect_b32 s32, 1, 0
  s_add_u32 s32, s32, s31
  s_cmp_ge_u32 s32, 2
  s_cselect_b32 s32, 0, s32
  s_lshl_b32 s33, s32, 3
  s_add_u32 s33, s33, s30
  s_mul_i32 s36, s33, s54
  s_add_u32 s36, s36, s34
  s_mul_i32 s37, s33, 393216
  s_add_u32 s37, s37, s35
  s_add_u32 m0, s38, s45
  s_mov_b64 exec, s[52:53]
  buffer_load_dwordx4 v12, s[8:11], s36 offen offset:0 sc1 lds
  s_mov_b64 exec, -1
  s_add_u32 m0, s38, s44
  s_nop 0
  buffer_load_dwordx4 v8, s[8:11], s36 offen offset:0 sc1 lds
  buffer_load_dwordx4 v9, s[8:11], s36 offen offset:1024 sc1 lds
  buffer_load_dwordx4 v10, s[8:11], s36 offen offset:2048 sc1 lds
  buffer_load_dwordx4 v11, s[8:11], s36 offen offset:3072 sc1 lds
  s_add_u32 m0, s38, s46
  s_nop 0
  buffer_load_dwordx4 v13, s[12:15], s37 offen offset:0  lds
  buffer_load_dwordx4 v14, s[12:15], s37 offen offset:1024  lds
  s_add_u32 m0, s38, s47
  s_nop 0
  buffer_load_dwordx4 v15, s[12:15], s37 offen offset:0  lds
  buffer_load_dwordx4 v16, s[12:15], s37 offen offset:1024  lds
  s_add_u32 m0, s38, s48
  s_nop 0
  buffer_load_dwordx4 v17, s[12:15], s37 offen offset:0  lds
  buffer_load_dwordx4 v18, s[12:15], s37 offen offset:1024  lds
  s_add_u32 s38, s38, 43008
  s_cmp_eq_u32 s38, 129024
  s_cselect_b32 s38, 0, s38
L_jA:
  s_nop 1
  s_waitcnt vmcnt(11)
  s_barrier
  s_add_u32 s30, s30, 1
  s_and_b32 s30, s30, 7
  s_cselect_b32 s32, 0, 1
  s_add_u32 s31, s31, s32
  s_sub_u32 s32, s30, s7
  s_and_b32 s32, s32, 7
  s_cmp_lt_u32 s32, 2
  s_cselect_b32 s32, 1, 0
  s_add_u32 s32, s32, s31
  s_cmp_ge_u32 s32, 2
  s_cselect_b32 s32, 0, s32
  s_lshl_b32 s33, s32, 3
  s_add_u32 s33, s33, s30
  s_mul_i32 s36, s33, s54
  s_add_u32 s36, s36, s34
  s_mul_i32 s37, s33, 393216
  s_add_u32 s37, s37, s35
  s_add_u32 m0, s38, s45
  s_mov_b64 exec, s[52:53]
  buffer_load_dwordx4 v12, s[8:11], s36 offen offset:0 sc1 lds
  s_mov_b64 exec, -1
  s_add_u32 m0, s38, s44
  s_nop 0
  buffer_load_dwordx4 v8, s[8:11], s36 offen offset:0 sc1 lds
  buffer_load_dwordx4 v9, s[8:11], s36 offen offset:1024 sc1 lds
  buffer_load_dwordx4 v10, s[8:11], s36 offen offset:2048 sc1 lds
  buffer_load_dwordx4 v11, s[8:11], s36 offen offset:3072 sc1 lds
  s_add_u32 m0, s38, s46
  s_nop 0
  buffer_load_dwordx4 v13, s[12:15], s37 offen offset:0  lds
  buffer_load_dwordx4 v14, s[12:15], s37 offen offset:1024  lds
  s_add_u32 m0, s38, s47
  s_nop 0
  buffer_load_dwordx4 v15, s[12:15], s37 offen offset:0  lds
  buffer_load_dwordx4 v16, s[12:15], s37 offen offset:1024  lds
  s_add_u32 m0, s38, s48
  s_nop 0
  buffer_load_dwordx4 v17, s[12:15], s37 offen offset:0  lds
  buffer_load_dwordx4 v18, s[12:15], s37 offen offset:1024  lds
  s_add_u32 s38, s38, 43008
  s_cmp_eq_u32 s38, 129024
  s_cselect_b32 s38, 0, s38
  s_waitcnt vmcnt(11)
  s_barrier
  s_add_u32 s30, s30, 1
  s_and_b32 s30, s30, 7
  s_cselect_b32 s32, 0, 1
  s_add_u32 s31, s31, s32
  s_sub_u32 s32, s30, s7
  s_and_b32 s32, s32, 7
  s_cmp_lt_u32 s32, 2
  s_cselect_b32 s32, 1, 0
  s_add_u32 s32, s32, s31
  s_cmp_ge_u32 s32, 2
  s_cselect_b32 s32, 0, s32
  s_lshl_b32 s33, s32, 3
  s_add_u32 s33, s33, s30
  s_mul_i32 s36, s33, s54
  s_add_u32 s36, s36, s34
  s_mul_i32 s37, s33, 393216
  s_add_u32 s37, s37, s35
  s_add_u32 m0, s38, s45
  s_mov_b64 exec, s[52:53]
  buffer_load_dwordx4 v12, s[8:11], s36 offen offset:0 sc1 lds
  s_mov_b64 exec, -1
  s_add_u32 m0, s38, s44
  s_nop 0
  buffer_load_dwordx4 v8, s[8:11], s36 offen offset:0 sc1 lds
  buffer_load_dwordx4 v9, s[8:11], s36 offen offset:1024 sc1 lds
  buffer_load_dwordx4 v10, s[8:11], s36 offen offset:2048 sc1 lds
  buffer_load_dwordx4 v11, s[8:11], s36 offen offset:3072 sc1 lds
  s_add_u32 m0, s38, s46
  s_nop 0
  buffer_load_dwordx4 v13, s[12:15], s37 offen offset:0  lds
  buffer_load_dwordx4 v14, s[12:15], s37 offen offset:1024  lds
  s_add_u32 m0, s38, s47
  s_nop 0
  buffer_load_dwordx4 v15, s[12:15], s37 offen offset:0  lds
  buffer_load_dwordx4 v16, s[12:15], s37 offen offset:1024  lds
  s_add_u32 m0, s38, s48
  s_nop 0
  buffer_load_dwordx4 v17, s[12:15], s37 offen offset:0  lds
  buffer_load_dwordx4 v18, s[12:15], s37 offen offset:1024  lds
  s_add_u32 s38, s38, 43008
  s_cmp_eq_u32 s38, 129024
  s_cselect_b32 s38, 0, s38
  s_cmp_lg_u32 s3, 0
  s_cbranch_scc1 e7
  s_cmp_lg_u32 s57, 0
  s_cbranch_scc1 g8
  s_mov_b64 exec, 1
  global_atomic_add v73, v74, s[62:63] sc1
  s_mov_b64 exec, -1
g8:
e7:
  s_nop 1
  s_mov_b32 s39, 9
ll9:
  s_waitcnt vmcnt(11)
  s_barrier
  s_add_u32 s30, s30, 1
  s_and_b32 s30, s30, 7
  s_cselect_b32 s32, 0, 1
  s_add_u32 s31, s31, s32
  s_sub_u32 s32, s30, s7
  s_and_b32 s32, s32, 7
  s_cmp_lt_u32 s32, 2
  s_cselect_b32 s32, 1, 0
  s_add_u32 s32, s32, s31
  s_cmp_ge_u32 s32, 2
  s_cselect_b32 s32, 0, s32
  s_lshl_b32 s33, s32, 3
  s_add_u32 s33, s33, s30
  s_mul_i32 s36, s33, s54
  s_add_u32 s36, s36, s34
  s_mul_i32 s37, s33, 393216
  s_add_u32 s37, s37, s35
  s_add_u32 m0, s38, s45
  s_mov_b64 exec, s[52:53]
  buffer_load_dwordx4 v12, s[8:11], s36 offen offset:0 sc1 lds
  s_mov_b64 exec, -1
  s_add_u32 m0, s38, s44
  s_nop 0
  buffer_load_dwordx4 v8, s[8:11], s36 offen offset:0 sc1 lds
  buffer_load_dwordx4 v9, s[8:11], s36 offen offset:1024 sc1 lds
  buffer_load_dwordx4 v10, s[8:11], s36 offen offset:2048 sc1 lds
  buffer_load_dwordx4 v11, s[8:11], s36 offen offset:3072 sc1 lds
  s_add_u32 m0, s38, s46
  s_nop 0
  buffer_load_dwordx4 v13, s[12:15], s37 offen offset:0  lds
  buffer_load_dwordx4 v14, s[12:15], s37 offen offset:1024  lds
  s_add_u32 m0, s38, s47
  s_nop 0
  buffer_load_dwordx4 v15, s[12:15], s37 offen offset:0  lds
  buffer_load_dwordx4 v16, s[12:15], s37 offen offset:1024  lds
  s_add_u32 m0, s38, s48
  s_nop 0
  buffer_load_dwordx4 v17, s[12:15], s37 offen offset:0  lds
  buffer_load_dwordx4 v18, s[12:15], s37 offen offset:1024  lds
  s_add_u32 s38, s38, 43008
  s_cmp_eq_u32 s38, 129024
  s_cselect_b32 s38, 0, s38
  s_sub_u32 s39, s39, 1
  s_cmp_lg_u32 s39, 0
  s_cbranch_scc1 ll9
  s_waitcnt vmcnt(11)
  s_barrier
  s_add_u32 s30, s30, 1
  s_and_b32 s30, s30, 7
  s_cselect_b32 s32, 0, 1
  s_add_u32 s31, s31, s32
  s_sub_u32 s32, s30, s7
  s_and_b32 s32, s32, 7
  s_cmp_lt_u32 s32, 2
  s_cselect_b32 s32, 1, 0
  s_add_u32 s32, s32, s31
  s_cmp_ge_u32 s32, 2
  s_cselect_b32 s32, 0, s32
  s_lshl_b32 s33, s32, 3
  s_add_u32 s33, s33, s30
  s_mul_i32 s36, s33, s54
  s_add_u32 s36, s36, s34
  s_mul_i32 s37, s33, 393216
  s_add_u32 s37, s37, s35
  s_add_u32 m0, s38, s45
  s_mov_b64 exec, s[52:53]
  buffer_load_dwordx4 v12, s[8:11], s36 offen offset:0 sc1 lds
  s_mov_b64 exec, -1
  s_add_u32 m0, s38, s44
  s_nop 0
  buffer_load_dwordx4 v8, s[8:11], s36 offen offset:0 sc1 lds
  buffer_load_dwordx4 v9, s[8:11], s36 offen offset:1024 sc1 lds
  buffer_load_dwordx4 v10, s[8:11], s36 offen offset:2048 sc1 lds
  buffer_load_dwordx4 v11, s[8:11], s36 offen offset:3072 sc1 lds
  s_add_u32 m0, s38, s46
  s_nop 0
  buffer_load_dwordx4 v13, s[12:15], s37 offen offset:0  lds
  buffer_load_dwordx4 v14, s[12:15], s37 offen offset:1024  lds
  s_add_u32 m0, s38, s47
  s_nop 0
  buffer_load_dwordx4 v15, s[12:15], s37 offen offset:0  lds
  buffer_load_dwordx4 v16, s[12:15], s37 offen offset:1024  lds
  s_add_u32 m0, s38, s48
  s_nop 0
  buffer_load_dwordx4 v17, s[12:15], s37 offen offset:0  lds
  buffer_load_dwordx4 v18, s[12:15], s37 offen offset:1024  lds
  s_add_u32 s38, s38, 43008
  s_cmp_eq_u32 s38, 129024
  s_cselect_b32 s38, 0, s38
  global_load_dword v29, v134, s[62:63] sc0 sc1
  s_waitcnt vmcnt(11)
  s_barrier
  s_add_u32 s30, s30, 1
  s_and_b32 s30, s30, 7
  s_cselect_b32 s32, 0, 1
  s_add_u32 s31, s31, s32
  s_sub_u32 s32, s30, s7
  s_and_b32 s32, s32, 7
  s_cmp_lt_u32 s32, 2
  s_cselect_b32 s32, 1, 0
  s_add_u32 s32, s32, s31
  s_cmp_ge_u32 s32, 2
  s_cselect_b32 s32, 0, s32
  s_lshl_b32 s33, s32, 3
  s_add_u32 s33, s33, s30
  s_mul_i32 s36, s33, s54
  s_add_u32 s36, s36, s34
  s_mul_i32 s37, s33, 393216
  s_add_u32 s37, s37, s35
  s_add_u32 m0, s38, s45
  s_mov_b64 exec, s[52:53]
  buffer_load_dwordx4 v12, s[8:11], s36 offen offset:0 sc1 lds
  s_mov_b64 exec, -1
  s_add_u32 m0, s38, s44
  s_nop 0
  buffer_load_dwordx4 v8, s[8:11], s36 offen offset:0 sc1 lds
  buffer_load_dwordx4 v9, s[8:11], s36 offen offset:1024 sc1 lds
  buffer_load_dwordx4 v10, s[8:11], s36 offen offset:2048 sc1 lds
  buffer_load_dwordx4 v11, s[8:11], s36 offen offset:3072 sc1 lds
  s_add_u32 m0, s38, s46
  s_nop 0
  buffer_load_dwordx4 v13, s[12:15], s37 offen offset:0  lds
  buffer_load_dwordx4 v14, s[12:15], s37 offen offset:1024  lds
  s_add_u32 m0, s38, s47
  s_nop 0
  buffer_load_dwordx4 v15, s[12:15], s37 offen offset:0  lds
  buffer_load_dwordx4 v16, s[12:15], s37 offen offset:1024  lds
  s_add_u32 m0, s38, s48
  s_nop 0
  buffer_load_dwordx4 v17, s[12:15], s37 offen offset:0  lds
  buffer_load_dwordx4 v18, s[12:15], s37 offen offset:1024  lds
  s_add_u32 s38, s38, 43008
  s_cmp_eq_u32 s38, 129024
  s_cselect_b32 s38, 0, s38
  s_cmp_lg_u32 s3, 0
  s_cbranch_scc1 st10g
  s_waitcnt vmcnt(11)
  s_mov_b32 s61, 0
st10p:
  v_cmp_gt_u32 vcc, 64, v29
  s_add_u32 s61, s61, 1
  s_cmp_gt_u32 s61, 1000000
  s_cbranch_scc1 st10g
  s_cbranch_vccz st10g
  global_load_dword v29, v134, s[62:63] sc0 sc1
  s_waitcnt vmcnt(0)
  s_branch st10p
st10g:
  buffer_load_dwordx2 v[30:31], v27, s[20:23], 0 offen sc1
  s_mov_b32 s32, 32768
  buffer_load_dwordx2 v[32:33], v27, s[20:23], s32 offen sc1
  s_mov_b32 s32, 65536
  buffer_load_dwordx2 v[34:35], v27, s[20:23], s32 offen sc1
  s_mov_b32 s32, 98304
  buffer_load_dwordx2 v[36:37], v27, s[20:23], s32 offen sc1
  s_mov_b32 s32, 131072
  buffer_load_dwordx2 v[38:39], v27, s[20:23], s32 offen sc1
  s_mov_b32 s32, 163840
  buffer_load_dwordx2 v[40:41], v27, s[20:23], s32 offen sc1
  s_mov_b32 s32, 196608
  buffer_load_dwordx2 v[42:43], v27, s[20:23], s32 offen sc1
  s_mov_b32 s32, 229376
  buffer_load_dwordx2 v[44:45], v27, s[20:23], s32 offen sc1
  s_waitcnt vmcnt(19)
  s_barrier
  s_branch L_k1t
L_k1B:
  s_nop 7
  s_nop 7
  s_mov_b32 s30, 7
  s_mov_b32 s31, -1
  s_mov_b32 s38, 0
  s_add_u32 s30, s30, 1
  s_and_b32 s30, s30, 7
  s_cselect_b32 s32, 0, 1
  s_add_u32 s31, s31, s32
  s_sub_u32 s32, s30, s7
  s_and_b32 s32, s32, 7
  s_cmp_lt_u32 s32, 2
  s_cselect_b32 s32, 1, 0
  s_add_u32 s32, s32, s31
  s_cmp_ge_u32 s32, 2
  s_cselect_b32 s32, 0, s32
  s_lshl_b32 s33, s32, 3
  s_add_u32 s33, s33, s30
  s_mul_i32 s36, s33, s54
  s_add_u32 s36, s36, s34
  s_add_u32 m0, s38, s44
  s_nop 0
  buffer_load_dwordx4 v8, s[8:11], s36 offen offset:0 sc1 lds
  buffer_load_dwordx4 v9, s[8:11], s36 offen offset:1024 sc1 lds
  buffer_load_dwordx4 v10, s[8:11], s36 offen offset:2048 sc1 lds
  buffer_load_dwordx4 v11, s[8:11], s36 offen offset:3072 sc1 lds
  s_add_u32 s38, s38, 43008
  s_cmp_eq_u32 s38, 129024
  s_cselect_b32 s38, 0, s38
  s_add_u32 s30, s30, 1
  s_and_b32 s30, s30, 7
  s_cselect_b32 s32, 0, 1
  s_add_u32 s31, s31, s32
  s_sub_u32 s32, s30, s7
  s_and_b32 s32, s32, 7
  s_cmp_lt_u32 s32, 2
  s_cselect_b32 s32, 1, 0
  s_add_u32 s32, s32, s31
  s_cmp_ge_u32 s32, 2
  s_cselect_b32 s32, 0, s32
  s_lshl_b32 s33, s32, 3
  s_add_u32 s33, s33, s30
  s_mul_i32 s36, s33, s54
  s_add_u32 s36, s36, s34
  s_add_u32 m0, s38, s44
  s_nop 0
  buffer_load_dwordx4 v8, s[8:11], s36 offen offset:0 sc1 lds
  buffer_load_dwordx4 v9, s[8:11], s36 offen offset:1024 sc1 lds
  buffer_load_dwordx4 v10, s[8:11], s36 offen offset:2048 sc1 lds
  buffer_load_dwordx4 v11, s[8:11], s36 offen offset:3072 sc1 lds
  s_add_u32 s38, s38, 43008
  s_cmp_eq_u32 s38, 129024
  s_cselect_b32 s38, 0, s38
  s_waitcnt vmcnt(4)
  s_barrier
  s_add_u32 s30, s30, 1
  s_and_b32 s30, s30, 7
  s_cselect_b32 s32, 0, 1
  s_add_u32 s31, s31, s32
  s_sub_u32 s32, s30, s7
  s_and_b32 s32, s32, 7
  s_cmp_lt_u32 s32, 2
  s_cselect_b32 s32, 1, 0
  s_add_u32 s32, s32, s31
  s_cmp_ge_u32 s32, 2
  s_cselect_b32 s32, 0, s32
  s_lshl_b32 s33, s32, 3
  s_add_u32 s33, s33, s30
  s_mul_i32 s36, s33, s54
  s_add_u32 s36, s36, s34
  s_mul_i32 s37, s33, 393216
  s_add_u32 s37, s37, s35
  s_add_u32 m0, s38, s44
  s_nop 0
  buffer_load_dwordx4 v8, s[8:11], s36 offen offset:0 sc1 lds
  buffer_load_dwordx4 v9, s[8:11], s36 offen offset:1024 sc1 lds
  buffer_load_dwordx4 v10, s[8:11], s36 offen offset:2048 sc1 lds
  buffer_load_dwordx4 v11, s[8:11], s36 offen offset:3072 sc1 lds
  s_add_u32 m0, s38, s46
  s_nop 0
  buffer_load_dwordx4 v13, s[12:15], s37 offen offset:0  lds
  buffer_load_dwordx4 v14, s[12:15], s37 offen offset:1024  lds
  s_add_u32 m0, s38, s47
  s_nop 0
  buffer_load_dwordx4 v15, s[12:15], s37 offen offset:0  lds
  buffer_load_dwordx4 v16, s[12:15], s37 offen offset:1024  lds
  s_add_u32 m0, s38, s48
  s_nop 0
  buffer_load_dwordx4 v17, s[12:15], s37 offen offset:0  lds
  buffer_load_dwordx4 v18, s[12:15], s37 offen offset:1024  lds
  s_add_u32 s38, s38, 43008
  s_cmp_eq_u32 s38, 129024
  s_cselect_b32 s38, 0, s38
L_jB:
  s_nop 1
  s_waitcnt vmcnt(10)
  s_barrier
  s_add_u32 s30, s30, 1
  s_and_b32 s30, s30, 7
  s_cselect_b32 s32, 0, 1
  s_add_u32 s31, s31, s32
  s_sub_u32 s32, s30, s7
  s_and_b32 s32, s32, 7
  s_cmp_lt_u32 s32, 2
  s_cselect_b32 s32, 1, 0
  s_add_u32 s32, s32, s31
  s_cmp_ge_u32 s32, 2
  s_cselect_b32 s32, 0, s32
  s_lshl_b32 s33, s32, 3
  s_add_u32 s33, s33, s30
  s_mul_i32 s36, s33, s54
  s_add_u32 s36, s36, s34
  s_mul_i32 s37, s33, 393216
  s_add_u32 s37, s37, s35
  s_add_u32 m0, s38, s44
  s_nop 0
  buffer_load_dwordx4 v8, s[8:11], s36 offen offset:0 sc1 lds
  buffer_load_dwordx4 v9, s[8:11], s36 offen offset:1024 sc1 lds
  buffer_load_dwordx4 v10, s[8:11], s36 offen offset:2048 sc1 lds
  buffer_load_dwordx4 v11, s[8:11], s36 offen offset:3072 sc1 lds
  s_add_u32 m0, s38, s46
  s_nop 0
  buffer_load_dwordx4 v13, s[12:15], s37 offen offset:0  lds
  buffer_load_dwordx4 v14, s[12:15], s37 offen offset:1024  lds
  s_add_u32 m0, s38, s47
  s_nop 0
  buffer_load_dwordx4 v15, s[12:15], s37 offen offset:0  lds
  buffer_load_dwordx4 v16, s[12:15], s37 offen offset:1024  lds
  s_add_u32 m0, s38, s48
  s_nop 0
  buffer_load_dwordx4 v17, s[12:15], s37 offen offset:0  lds
  buffer_load_dwordx4 v18, s[12:15], s37 offen offset:1024  lds
  s_add_u32 s38, s38, 43008
  s_cmp_eq_u32 s38, 129024
  s_cselect_b32 s38, 0, s38
  s_waitcnt vmcnt(10)
  s_barrier
  s_add_u32 s30, s30, 1
  s_and_b32 s30, s30, 7
  s_cselect_b32 s32, 0, 1
  s_add_u32 s31, s31, s32
  s_sub_u32 s32, s30, s7
  s_and_b32 s32, s32, 7
  s_cmp_lt_u32 s32, 2
  s_cselect_b32 s32, 1, 0
  s_add_u32 s32, s32, s31
  s_cmp_ge_u32 s32, 2
  s_cselect_b32 s32, 0, s32
  s_lshl_b32 s33, s32, 3
  s_add_u32 s33, s33, s30
  s_mul_i32 s36, s33, s54
  s_add_u32 s36, s36, s34
  s_mul_i32 s37, s33, 393216
  s_add_u32 s37, s37, s35
  s_add_u32 m0, s38, s44
  s_nop 0
  buffer_load_dwordx4 v8, s[8:11], s36 offen offset:0 sc1 lds
  buffer_load_dwordx4 v9, s[8:11], s36 offen offset:1024 sc1 lds
  buffer_load_dwordx4 v10, s[8:11], s36 offen offset:2048 sc1 lds
  buffer_load_dwordx4 v11, s[8:11], s36 offen offset:3072 sc1 lds
  s_add_u32 m0, s38, s46
  s_nop 0
  buffer_load_dwordx4 v13, s[12:15], s37 offen offset:0  lds
  buffer_load_dwordx4 v14, s[12:15], s37 offen offset:1024  lds
  s_add_u32 m0, s38, s47
  s_nop 0
  buffer_load_dwordx4 v15, s[12:15], s37 offen offset:0  lds
  buffer_load_dwordx4 v16, s[12:15], s37 offen offset:1024  lds
  s_add_u32 m0, s38, s48
  s_nop 0
  buffer_load_dwordx4 v17, s[12:15], s37 offen offset:0  lds
  buffer_load_dwordx4 v18, s[12:15], s37 offen offset:1024  lds
  s_add_u32 s38, s38, 43008
  s_cmp_eq_u32 s38, 129024
  s_cselect_b32 s38, 0, s38
  s_cmp_lg_u32 s3, 0
  s_cbranch_scc1 e11
  s_cmp_lg_u32 s57, 0
  s_cbranch_scc1 g12
  s_mov_b64 exec, 1
  global_atomic_add v73, v74, s[62:63] sc1
  s_mov_b64 exec, -1
g12:
e11:
  s_nop 1
  s_mov_b32 s39, 9
ll13:
  s_waitcnt vmcnt(10)
  s_barrier
  s_add_u32 s30, s30, 1
  s_and_b32 s30, s30, 7
  s_cselect_b32 s32, 0, 1
  s_add_u32 s31, s31, s32
  s_sub_u32 s32, s30, s7
  s_and_b32 s32, s32, 7
  s_cmp_lt_u32 s32, 2
  s_cselect_b32 s32, 1, 0
  s_add_u32 s32, s32, s31
  s_cmp_ge_u32 s32, 2
  s_cselect_b32 s32, 0, s32
  s_lshl_b32 s33, s32, 3
  s_add_u32 s33, s33, s30
  s_mul_i32 s36, s33, s54
  s_add_u32 s36, s36, s34
  s_mul_i32 s37, s33, 393216
  s_add_u32 s37, s37, s35
  s_add_u32 m0, s38, s44
  s_nop 0
  buffer_load_dwordx4 v8, s[8:11], s36 offen offset:0 sc1 lds
  buffer_load_dwordx4 v9, s[8:11], s36 offen offset:1024 sc1 lds
  buffer_load_dwordx4 v10, s[8:11], s36 offen offset:2048 sc1 lds
  buffer_load_dwordx4 v11, s[8:11], s36 offen offset:3072 sc1 lds
  s_add_u32 m0, s38, s46
  s_nop 0
  buffer_load_dwordx4 v13, s[12:15], s37 offen offset:0  lds
  buffer_load_dwordx4 v14, s[12:15], s37 offen offset:1024  lds
  s_add_u32 m0, s38, s47
  s_nop 0
  buffer_load_dwordx4 v15, s[12:15], s37 offen offset:0  lds
  buffer_load_dwordx4 v16, s[12:15], s37 offen offset:1024  lds
  s_add_u32 m0, s38, s48
  s_nop 0
  buffer_load_dwordx4 v17, s[12:15], s37 offen offset:0  lds
  buffer_load_dwordx4 v18, s[12:15], s37 offen offset:1024  lds
  s_add_u32 s38, s38, 43008
  s_cmp_eq_u32 s38, 129024
  s_cselect_b32 s38, 0, s38
  s_sub_u32 s39, s39, 1
  s_cmp_lg_u32 s39, 0
  s_cbranch_scc1 ll13
  s_waitcnt vmcnt(10)
  s_barrier
  s_add_u32 s30, s30, 1
  s_and_b32 s30, s30, 7
  s_cselect_b32 s32, 0, 1
  s_add_u32 s31, s31, s32
  s_sub_u32 s32, s30, s7
  s_and_b32 s32, s32, 7
  s_cmp_lt_u32 s32, 2
  s_cselect_b32 s32, 1, 0
  s_add_u32 s32, s32, s31
  s_cmp_ge_u32 s32, 2
  s_cselect_b32 s32, 0, s32
  s_lshl_b32 s33, s32, 3
  s_add_u32 s33, s33, s30
  s_mul_i32 s36, s33, s54
  s_add_u32 s36, s36, s34
  s_mul_i32 s37, s33, 393216
  s_add_u32 s37, s37, s35
  s_add_u32 m0, s38, s44
  s_nop 0
  buffer_load_dwordx4 v8, s[8:11], s36 offen offset:0 sc1 lds
  buffer_load_dwordx4 v9, s[8:11], s36 offen offset:1024 sc1 lds
  buffer_load_dwordx4 v10, s[8:11], s36 offen offset:2048 sc1 lds
  buffer_load_dwordx4 v11, s[8:11], s36 offen offset:3072 sc1 lds
  s_add_u32 m0, s38, s46
  s_nop 0
  buffer_load_dwordx4 v13, s[12:15], s37 offen offset:0  lds
  buffer_load_dwordx4 v14, s[12:15], s37 offen offset:1024  lds
  s_add_u32 m0, s38, s47
  s_nop 0
  buffer_load_dwordx4 v15, s[12:15], s37 offen offset:0  lds
  buffer_load_dwordx4 v16, s[12:15], s37 offen offset:1024  lds
  s_add_u32 m0, s38, s48
  s_nop 0
  buffer_load_dwordx4 v17, s[12:15], s37 offen offset:0  lds
  buffer_load_dwordx4 v18, s[12:15], s37 offen offset:1024  lds
  s_add_u32 s38, s38, 43008
  s_cmp_eq_u32 s38, 129024
  s_cselect_b32 s38, 0, s38
  global_load_dword v29, v134, s[62:63] sc0 sc1
  s_waitcnt vmcnt(10)
  s_barrier
  s_add_u32 s30, s30, 1
  s_and_b32 s30, s30, 7
  s_cselect_b32 s32, 0, 1
  s_add_u32 s31, s31, s32
  s_sub_u32 s32, s30, s7
  s_and_b32 s32, s32, 7
  s_cmp_lt_u32 s32, 2
  s_cselect_b32 s32, 1, 0
  s_add_u32 s32, s32, s31
  s_cmp_ge_u32 s32, 2
  s_cselect_b32 s32, 0, s32
  s_lshl_b32 s33, s32, 3
  s_add_u32 s33, s33, s30
  s_mul_i32 s36, s33, s54
  s_add_u32 s36, s36, s34
  s_mul_i32 s37, s33, 393216
  s_add_u32 s37, s37, s35
  s_add_u32 m0, s38, s44
  s_nop 0
  buffer_load_dwordx4 v8, s[8:11], s36 offen offset:0 sc1 lds
  buffer_load_dwordx4 v9, s[8:11], s36 offen offset:1024 sc1 lds
  buffer_load_dwordx4 v10, s[8:11], s36 offen offset:2048 sc1 lds
  buffer_load_dwordx4 v11, s[8:11], s36 offen offset:3072 sc1 lds
  s_add_u32 m0, s38, s46
  s_nop 0
  buffer_load_dwordx4 v13, s[12:15], s37 offen offset:0  lds
  buffer_load_dwordx4 v14, s[12:15], s37 offen offset:1024  lds
  s_add_u32 m0, s38, s47
  s_nop 0
  buffer_load_dwordx4 v15, s[12:15], s37 offen offset:0  lds
  buffer_load_dwordx4 v16, s[12:15], s37 offen offset:1024  lds
  s_add_u32 m0, s38, s48
  s_nop 0
  buffer_load_dwordx4 v17, s[12:15], s37 offen offset:0  lds
  buffer_load_dwordx4 v18, s[12:15], s37 offen offset:1024  lds
  s_add_u32 s38, s38, 43008
  s_cmp_eq_u32 s38, 129024
  s_cselect_b32 s38, 0, s38
  s_cmp_lg_u32 s3, 0
  s_cbranch_scc1 st14g
  s_waitcnt vmcnt(10)
  s_mov_b32 s61, 0
st14p:
  v_cmp_gt_u32 vcc, 64, v29
  s_add_u32 s61, s61, 1
  s_cmp_gt_u32 s61, 1000000
  s_cbranch_scc1 st14g
  s_cbranch_vccz st14g
  global_load_dword v29, v134, s[62:63] sc0 sc1
  s_waitcnt vmcnt(0)
  s_branch st14p
st14g:
  buffer_load_dwordx2 v[30:31], v27, s[20:23], 0 offen sc1
  s_mov_b32 s32, 32768
  buffer_load_dwordx2 v[32:33], v27, s[20:23], s32 offen sc1
  s_mov_b32 s32, 65536
  buffer_load_dwordx2 v[34:35], v27, s[20:23], s32 offen sc1
  s_mov_b32 s32, 98304
  buffer_load_dwordx2 v[36:37], v27, s[20:23], s32 offen sc1
  s_mov_b32 s32, 131072
  buffer_load_dwordx2 v[38:39], v27, s[20:23], s32 offen sc1
  s_mov_b32 s32, 163840
  buffer_load_dwordx2 v[40:41], v27, s[20:23], s32 offen sc1
  s_mov_b32 s32, 196608
  buffer_load_dwordx2 v[42:43], v27, s[20:23], s32 offen sc1
  s_mov_b32 s32, 229376
  buffer_load_dwordx2 v[44:45], v27, s[20:23], s32 offen sc1
  s_waitcnt vmcnt(18)
  s_barrier
  s_branch L_k1t
L_first:
  s_nop 7
  s_nop 7
  s_cmp_ge_u32 s57, 2
  s_cbranch_scc1 L_firstB
  s_add_u32 s30, s30, 1
  s_and_b32 s30, s30, 7
  s_cselect_b32 s32, 0, 1
  s_add_u32 s31, s31, s32
  s_sub_u32 s32, s30, s7
  s_and_b32 s32, s32, 7
  s_cmp_lt_u32 s32, 2
  s_cselect_b32 s32, 1, 0
  s_add_u32 s32, s32, s31
  s_cmp_ge_u32 s32, 2
  s_cselect_b32 s32, 0, s32
  s_lshl_b32 s33, s32, 3
  s_add_u32 s33, s33, s30
  s_mul_i32 s36, s33, s54
  s_add_u32 s36, s36, s34
  s_mul_i32 s37, s33, 393216
  s_add_u32 s37, s37, s35
  s_add_u32 m0, s38, s45
  s_mov_b64 exec, s[52:53]
  buffer_load_dwordx4 v12, s[8:11], s36 offen offset:0 sc1 lds
  s_mov_b64 exec, -1
  s_add_u32 m0, s38, s44
  s_nop 0
  buffer_load_dwordx4 v8, s[8:11], s36 offen offset:0 sc1 lds
  buffer_load_dwordx4 v9, s[8:11], s36 offen offset:1024 sc1 lds
  buffer_load_dwordx4 v10, s[8:11], s36 offen offset:2048 sc1 lds
  buffer_load_dwordx4 v11, s[8:11], s36 offen offset:3072 sc1 lds
  s_add_u32 m0, s38, s46
  s_nop 0
  buffer_load_dwordx4 v13, s[12:15], s37 offen offset:0  lds
  buffer_load_dwordx4 v14, s[12:15], s37 offen offset:1024  lds
  s_add_u32 m0, s38, s47
  s_nop 0
  buffer_load_dwordx4 v15, s[12:15], s37 offen offset:0  lds
  buffer_load_dwordx4 v16, s[12:15], s37 offen offset:1024  lds
  s_add_u32 m0, s38, s48
  s_nop 0
  buffer_load_dwordx4 v17, s[12:15], s37 offen offset:0  lds
  buffer_load_dwordx4 v18, s[12:15], s37 offen offset:1024  lds
  s_add_u32 s38, s38, 43008
  s_cmp_eq_u32 s38, 129024
  s_cselect_b32 s38, 0, s38
  s_mov_b32 s16, s84
  s_mov_b32 s17, s85
  s_mov_b32 s18, 117440512
  s_mov_b32 s19, 0x20000
  s_add_u32 s20, s84, 42991616
  s_addc_u32 s21, s85, 0
  s_mov_b32 s22, 32768
  s_mov_b32 s23, 0x20000
  s_mov_b32 s82, s84
  s_mov_b32 s83, s85
  s_add_u32 s30, s30, 1
  s_and_b32 s30, s30, 7
  s_cselect_b32 s32, 0, 1
  s_add_u32 s31, s31, s32
  s_sub_u32 s32, s30, s7
  s_and_b32 s32, s32, 7
  s_cmp_lt_u32 s32, 2
  s_cselect_b32 s32, 1, 0
  s_add_u32 s32, s32, s31
  s_cmp_ge_u32 s32, 2
  s_cselect_b32 s32, 0, s32
  s_lshl_b32 s33, s32, 3
  s_add_u32 s33, s33, s30
  s_mul_i32 s36, s33, s54
  s_add_u32 s36, s36, s34
  s_mul_i32 s37, s33, 393216
  s_add_u32 s37, s37, s35
  s_add_u32 m0, s38, s45
  s_mov_b64 exec, s[52:53]
  buffer_load_dwordx4 v12, s[8:11], s36 offen offset:0 sc1 lds
  s_mov_b64 exec, -1
  s_add_u32 m0, s38, s44
  s_nop 0
  buffer_load_dwordx4 v8, s[8:11], s36 offen offset:0 sc1 lds
  buffer_load_dwordx4 v9, s[8:11], s36 offen offset:1024 sc1 lds
  buffer_load_dwordx4 v10, s[8:11], s36 offen offset:2048 sc1 lds
  buffer_load_dwordx4 v11, s[8:11], s36 offen offset:3072 sc1 lds
  s_add_u32 m0, s38, s46
  s_nop 0
  buffer_load_dwordx4 v13, s[12:15], s37 offen offset:0  lds
  buffer_load_dwordx4 v14, s[12:15], s37 offen offset:1024  lds
  s_add_u32 m0, s38, s47
  s_nop 0
  buffer_load_dwordx4 v15, s[12:15], s37 offen offset:0  lds
  buffer_load_dwordx4 v16, s[12:15], s37 offen offset:1024  lds
  s_add_u32 m0, s38, s48
  s_nop 0
  buffer_load_dwordx4 v17, s[12:15], s37 offen offset:0  lds
  buffer_load_dwordx4 v18, s[12:15], s37 offen offset:1024  lds
  s_add_u32 s38, s38, 43008
  s_cmp_eq_u32 s38, 129024
  s_cselect_b32 s38, 0, s38
  buffer_load_dwordx4 v[48:51], v46, s[8:11], 0 offen offset:0
  buffer_load_dwordx4 v[52:55], v46, s[8:11], 0 offen offset:512
  buffer_load_dwordx4 v[56:59], v46, s[8:11], 0 offen offset:1024
  buffer_load_dwordx4 v[60:63], v46, s[8:11], 0 offen offset:1536
  buffer_store_dwordx4 v[64:67], v47, s[16:19], s58 offen sc0 sc1
  s_barrier
  s_waitcnt vmcnt(16)
  s_barrier
  s_add_u32 s30, s30, 1
  s_and_b32 s30, s30, 7
  s_cselect_b32 s32, 0, 1
  s_add_u32 s31, s31, s32
  s_sub_u32 s32, s30, s7
  s_and_b32 s32, s32, 7
  s_cmp_lt_u32 s32, 2
  s_cselect_b32 s32, 1, 0
  s_add_u32 s32, s32, s31
  s_cmp_ge_u32 s32, 2
  s_cselect_b32 s32, 0, s32
  s_lshl_b32 s33, s32, 3
  s_add_u32 s33, s33, s30
  s_mul_i32 s36, s33, s54
  s_add_u32 s36, s36, s34
  s_mul_i32 s37, s33, 393216
  s_add_u32 s37, s37, s35
  s_add_u32 m0, s38, s45
  s_mov_b64 exec, s[52:53]
  buffer_load_dwordx4 v12, s[8:11], s36 offen offset:0 sc1 lds
  s_mov_b64 exec, -1
  s_add_u32 m0, s38, s44
  s_nop 0
  buffer_load_dwordx4 v8, s[8:11], s36 offen offset:0 sc1 lds
  buffer_load_dwordx4 v9, s[8:11], s36 offen offset:1024 sc1 lds
  buffer_load_dwordx4 v10, s[8:11], s36 offen offset:2048 sc1 lds
  buffer_load_dwordx4 v11, s[8:11], s36 offen offset:3072 sc1 lds
  s_add_u32 m0, s38, s46
  s_nop 0
  buffer_load_dwordx4 v13, s[12:15], s37 offen offset:0  lds
  buffer_load_dwordx4 v14, s[12:15], s37 offen offset:1024  lds
  s_add_u32 m0, s38, s47
  s_nop 0
  buffer_load_dwordx4 v15, s[12:15], s37 offen offset:0  lds
  buffer_load_dwordx4 v16, s[12:15], s37 offen offset:1024  lds
  s_add_u32 m0, s38, s48
  s_nop 0
  buffer_load_dwordx4 v17, s[12:15], s37 offen offset:0  lds
  buffer_load_dwordx4 v18, s[12:15], s37 offen offset:1024  lds
  s_add_u32 s38, s38, 43008
  s_cmp_eq_u32 s38, 129024
  s_cselect_b32 s38, 0, s38
  v_mov_b32 v68, 0
  v_mov_b32 v69, 0
  v_mov_b32 v70, 0x3f803f80
  s_waitcnt vmcnt(12)
  v_dot2c_f32_bf16 v68, v70, v48
  v_dot2c_f32_bf16 v69, v48, v48
  v_dot2c_f32_bf16 v68, v70, v49
  v_dot2c_f32_bf16 v69, v49, v49
  v_dot2c_f32_bf16 v68, v70, v50
  v_dot2c_f32_bf16 v69, v50, v50
  v_dot2c_f32_bf16 v68, v70, v51
  v_dot2c_f32_bf16 v69, v51, v51
  v_dot2c_f32_bf16 v68, v70, v52
  v_dot2c_f32_bf16 v69, v52, v52
  v_dot2c_f32_bf16 v68, v70, v53
  v_dot2c_f32_bf16 v69, v53, v53
  v_dot2c_f32_bf16 v68, v70, v54
  v_dot2c_f32_bf16 v69, v54, v54
  v_dot2c_f32_bf16 v68, v70, v55
  v_dot2c_f32_bf16 v69, v55, v55
  v_dot2c_f32_bf16 v68, v70, v56
  v_dot2c_f32_bf16 v69, v56, v56
  v_dot2c_f32_bf16 v68, v70, v57
  v_dot2c_f32_bf16 v69, v57, v57
  v_dot2c_f32_bf16 v68, v70, v58
  v_dot2c_f32_bf16 v69, v58, v58
  v_dot2c_f32_bf16 v68, v70, v59
  v_dot2c_f32_bf16 v69, v59, v59
  v_dot2c_f32_bf16 v68, v70, v60
  v_dot2c_f32_bf16 v69, v60, v60
  v_dot2c_f32_bf16 v68, v70, v61
  v_dot2c_f32_bf16 v69, v61, v61
  v_dot2c_f32_bf16 v68, v70, v62
  v_dot2c_f32_bf16 v69, v62, v62
  v_dot2c_f32_bf16 v68, v70, v63
  v_dot2c_f32_bf16 v69, v63, v63
  s_nop 1
  v_add_f32_dpp v68, v68, v68 quad_perm:[1,0,3,2] row_mask:0xf bank_mask:0xf
  v_add_f32_dpp v69, v69, v69 quad_perm:[1,0,3,2] row_mask:0xf bank_mask:0xf
  s_nop 0
  v_add_f32_dpp v68, v68, v68 quad_perm:[2,3,0,1] row_mask:0xf bank_mask:0xf
  v_add_f32_dpp v69, v69, v69 quad_perm:[2,3,0,1] row_mask:0xf bank_mask:0xf
  s_nop 0
  v_add_f32_dpp v68, v68, v68 row_half_mirror row_mask:0xf bank_mask:0xf
  v_add_f32_dpp v69, v69, v69 row_half_mirror row_mask:0xf bank_mask:0xf
  s_nop 0
  v_add_f32_dpp v68, v68, v68 row_mirror row_mask:0xf bank_mask:0xf
  v_add_f32_dpp v69, v69, v69 row_mirror row_mask:0xf bank_mask:0xf
  v_mov_b32 v70, v68
  v_mov_b32 v71, v69
  s_nop 0
  v_permlane16_swap_b32 v68, v70
  v_permlane16_swap_b32 v69, v71
  v_add_f32 v68, v68, v70
  v_add_f32 v69, v69, v71
  s_mov_b32 exec_lo, 1
  s_mov_b32 exec_hi, 1
  buffer_store_dwordx2 v[68:69], v72, s[16:19], 0 offen sc0 sc1
  s_mov_b64 exec, -1
  s_mov_b32 s60, 0
  s_branch L_jA
L_firstB:
  s_nop 7
  s_nop 7
  s_add_u32 s30, s30, 1
  s_and_b32 s30, s30, 7
  s_cselect_b32 s32, 0, 1
  s_add_u32 s31, s31, s32
  s_sub_u32 s32, s30, s7
  s_and_b32 s32, s32, 7
  s_cmp_lt_u32 s32, 2
  s_cselect_b32 s32, 1, 0
  s_add_u32 s32, s32, s31
  s_cmp_ge_u32 s32, 2
  s_cselect_b32 s32, 0, s32
  s_lshl_b32 s33, s32, 3
  s_add_u32 s33, s33, s30
  s_mul_i32 s36, s33, s54
  s_add_u32 s36, s36, s34
  s_mul_i32 s37, s33, 393216
  s_add_u32 s37, s37, s35
  s_add_u32 m0, s38, s44
  s_nop 0
  buffer_load_dwordx4 v8, s[8:11], s36 offen offset:0 sc1 lds
  buffer_load_dwordx4 v9, s[8:11], s36 offen offset:1024 sc1 lds
  buffer_load_dwordx4 v10, s[8:11], s36 offen offset:2048 sc1 lds
  buffer_load_dwordx4 v11, s[8:11], s36 offen offset:3072 sc1 lds
  s_add_u32 m0, s38, s46
  s_nop 0
  buffer_load_dwordx4 v13, s[12:15], s37 offen offset:0  lds
  buffer_load_dwordx4 v14, s[12:15], s37 offen offset:1024  lds
  s_add_u32 m0, s38, s47
  s_nop 0
  buffer_load_dwordx4 v15, s[12:15], s37 offen offset:0  lds
  buffer_load_dwordx4 v16, s[12:15], s37 offen offset:1024  lds
  s_add_u32 m0, s38, s48
  s_nop 0
  buffer_load_dwordx4 v17, s[12:15], s37 offen offset:0  lds
  buffer_load_dwordx4 v18, s[12:15], s37 offen offset:1024  lds
  s_add_u32 s38, s38, 43008
  s_cmp_eq_u32 s38, 129024
  s_cselect_b32 s38, 0, s38
  s_mov_b32 s16, s84
  s_mov_b32 s17, s85
  s_mov_b32 s18, 117440512
  s_mov_b32 s19, 0x20000
  s_add_u32 s20, s84, 42991616
  s_addc_u32 s21, s85, 0
  s_mov_b32 s22, 32768
  s_mov_b32 s23, 0x20000
  s_mov_b32 s82, s84
  s_mov_b32 s83, s85
  s_add_u32 s30, s30, 1
  s_and_b32 s30, s30, 7
  s_cselect_b32 s32, 0, 1
  s_add_u32 s31, s31, s32
  s_sub_u32 s32, s30, s7
  s_and_b32 s32, s32, 7
  s_cmp_lt_u32 s32, 2
  s_cselect_b32 s32, 1, 0
  s_add_u32 s32, s32, s31
  s_cmp_ge_u32 s32, 2
  s_cselect_b32 s32, 0, s32
  s_lshl_b32 s33, s32, 3
  s_add_u32 s33, s33, s30
  s_mul_i32 s36, s33, s54
  s_add_u32 s36, s36, s34
  s_mul_i32 s37, s33, 393216
  s_add_u32 s37, s37, s35
  s_add_u32 m0, s38, s44
  s_nop 0
  buffer_load_dwordx4 v8, s[8:11], s36 offen offset:0 sc1 lds
  buffer_load_dwordx4 v9, s[8:11], s36 offen offset:1024 sc1 lds
  buffer_load_dwordx4 v10, s[8:11], s36 offen offset:2048 sc1 lds
  buffer_load_dwordx4 v11, s[8:11], s36 offen offset:3072 sc1 lds
  s_add_u32 m0, s38, s46
  s_nop 0
  buffer_load_dwordx4 v13, s[12:15], s37 offen offset:0  lds
  buffer_load_dwordx4 v14, s[12:15], s37 offen offset:1024  lds
  s_add_u32 m0, s38, s47
  s_nop 0
  buffer_load_dwordx4 v15, s[12:15], s37 offen offset:0  lds
  buffer_load_dwordx4 v16, s[12:15], s37 offen offset:1024  lds
  s_add_u32 m0, s38, s48
  s_nop 0
  buffer_load_dwordx4 v17, s[12:15], s37 offen offset:0  lds
  buffer_load_dwordx4 v18, s[12:15], s37 offen offset:1024  lds
  s_add_u32 s38, s38, 43008
  s_cmp_eq_u32 s38, 129024
  s_cselect_b32 s38, 0, s38
  buffer_load_dwordx4 v[48:51], v46, s[8:11], 0 offen offset:0
  buffer_load_dwordx4 v[52:55], v46, s[8:11], 0 offen offset:512
  buffer_load_dwordx4 v[56:59], v46, s[8:11], 0 offen offset:1024
  buffer_load_dwordx4 v[60:63], v46, s[8:11], 0 offen offset:1536
  buffer_store_dwordx4 v[64:67], v47, s[16:19], s58 offen sc0 sc1
  s_barrier
  s_waitcnt vmcnt(15)
  s_barrier
  s_add_u32 s30, s30, 1
  s_and_b32 s30, s30, 7
  s_cselect_b32 s32, 0, 1
  s_add_u32 s31, s31, s32
  s_sub_u32 s32, s30, s7
  s_and_b32 s32, s32, 7
  s_cmp_lt_u32 s32, 2
  s_cselect_b32 s32, 1, 0
  s_add_u32 s32, s32, s31
  s_cmp_ge_u32 s32, 2
  s_cselect_b32 s32, 0, s32
  s_lshl_b32 s33, s32, 3
  s_add_u32 s33, s33, s30
  s_mul_i32 s36, s33, s54
  s_add_u32 s36, s36, s34
  s_mul_i32 s37, s33, 393216
  s_add_u32 s37, s37, s35
  s_add_u32 m0, s38, s44
  s_nop 0
  buffer_load_dwordx4 v8, s[8:11], s36 offen offset:0 sc1 lds
  buffer_load_dwordx4 v9, s[8:11], s36 offen offset:1024 sc1 lds
  buffer_load_dwordx4 v10, s[8:11], s36 offen offset:2048 sc1 lds
  buffer_load_dwordx4 v11, s[8:11], s36 offen offset:3072 sc1 lds
  s_add_u32 m0, s38, s46
  s_nop 0
  buffer_load_dwordx4 v13, s[12:15], s37 offen offset:0  lds
  buffer_load_dwordx4 v14, s[12:15], s37 offen offset:1024  lds
  s_add_u32 m0, s38, s47
  s_nop 0
  buffer_load_dwordx4 v15, s[12:15], s37 offen offset:0  lds
  buffer_load_dwordx4 v16, s[12:15], s37 offen offset:1024  lds
  s_add_u32 m0, s38, s48
  s_nop 0
  buffer_load_dwordx4 v17, s[12:15], s37 offen offset:0  lds
  buffer_load_dwordx4 v18, s[12:15], s37 offen offset:1024  lds
  s_add_u32 s38, s38, 43008
  s_cmp_eq_u32 s38, 129024
  s_cselect_b32 s38, 0, s38
  v_mov_b32 v68, 0
  v_mov_b32 v69, 0
  v_mov_b32 v70, 0x3f803f80
  s_waitcnt vmcnt(11)
  v_dot2c_f32_bf16 v68, v70, v48
  v_dot2c_f32_bf16 v69, v48, v48
  v_dot2c_f32_bf16 v68, v70, v49
  v_dot2c_f32_bf16 v69, v49, v49
  v_dot2c_f32_bf16 v68, v70, v50
  v_dot2c_f32_bf16 v69, v50, v50
  v_dot2c_f32_bf16 v68, v70, v51
  v_dot2c_f32_bf16 v69, v51, v51
  v_dot2c_f32_bf16 v68, v70, v52
  v_dot2c_f32_bf16 v69, v52, v52
  v_dot2c_f32_bf16 v68, v70, v53
  v_dot2c_f32_bf16 v69, v53, v53
  v_dot2c_f32_bf16 v68, v70, v54
  v_dot2c_f32_bf16 v69, v54, v54
  v_dot2c_f32_bf16 v68, v70, v55
  v_dot2c_f32_bf16 v69, v55, v55
  v_dot2c_f32_bf16 v68, v70, v56
  v_dot2c_f32_bf16 v69, v56, v56
  v_dot2c_f32_bf16 v68, v70, v57
  v_dot2c_f32_bf16 v69, v57, v57
  v_dot2c_f32_bf16 v68, v70, v58
  v_dot2c_f32_bf16 v69, v58, v58
  v_dot2c_f32_bf16 v68, v70, v59
  v_dot2c_f32_bf16 v69, v59, v59
  v_dot2c_f32_bf16 v68, v70, v60
  v_dot2c_f32_bf16 v69, v60, v60
  v_dot2c_f32_bf16 v68, v70, v61
  v_dot2c_f32_bf16 v69, v61, v61
  v_dot2c_f32_bf16 v68, v70, v62
  v_dot2c_f32_bf16 v69, v62, v62
  v_dot2c_f32_bf16 v68, v70, v63
  v_dot2c_f32_bf16 v69, v63, v63
  s_nop 1
  v_add_f32_dpp v68, v68, v68 quad_perm:[1,0,3,2] row_mask:0xf bank_mask:0xf
  v_add_f32_dpp v69, v69, v69 quad_perm:[1,0,3,2] row_mask:0xf bank_mask:0xf
  s_nop 0
  v_add_f32_dpp v68, v68, v68 quad_perm:[2,3,0,1] row_mask:0xf bank_mask:0xf
  v_add_f32_dpp v69, v69, v69 quad_perm:[2,3,0,1] row_mask:0xf bank_mask:0xf
  s_nop 0
  v_add_f32_dpp v68, v68, v68 row_half_mirror row_mask:0xf bank_mask:0xf
  v_add_f32_dpp v69, v69, v69 row_half_mirror row_mask:0xf bank_mask:0xf
  s_nop 0
  v_add_f32_dpp v68, v68, v68 row_mirror row_mask:0xf bank_mask:0xf
  v_add_f32_dpp v69, v69, v69 row_mirror row_mask:0xf bank_mask:0xf
  v_mov_b32 v70, v68
  v_mov_b32 v71, v69
  s_nop 0
  v_permlane16_swap_b32 v68, v70
  v_permlane16_swap_b32 v69, v71
  v_add_f32 v68, v68, v70
  v_add_f32 v69, v69, v71
  s_mov_b32 exec_lo, 1
  s_mov_b32 exec_hi, 1
  buffer_store_dwordx2 v[68:69], v72, s[16:19], 0 offen sc0 sc1
  s_mov_b64 exec, -1
  s_mov_b32 s60, 0
  s_branch L_jB
L_k1t:
  s_nop 7
  s_nop 7
  s_waitcnt vmcnt(0)
  v_pk_add_f32 v[30:31], v[30:31], v[32:33]
  v_pk_add_f32 v[34:35], v[34:35], v[36:37]
  v_pk_add_f32 v[38:39], v[38:39], v[40:41]
  v_pk_add_f32 v[42:43], v[42:43], v[44:45]
  v_pk_add_f32 v[30:31], v[30:31], v[34:35]
  v_pk_add_f32 v[38:39], v[38:39], v[42:43]
  v_pk_add_f32 v[30:31], v[30:31], v[38:39]
  v_mul_f32 v30, 0x3a800000, v30
  v_mul_f32 v31, 0x3a800000, v31
  v_fma_f32 v31, -v30, v30, v31
  v_max_f32 v31, 0, v31
  v_mov_b32 v32, v31
  v_cvt_pk_bf16_f32 v32, v32, v32
  v_lshlrev_b32 v32, 16, v32
  v_add_f32 v32, 0x3727c5ac, v32
  v_cvt_pk_bf16_f32 v32, v32, v32
  v_lshlrev_b32 v32, 16, v32
  v_sqrt_f32 v32, v32
  s_nop 0
  v_cvt_pk_bf16_f32 v32, v32, v32
  v_lshlrev_b32 v32, 16, v32
  v_rcp_f32 v32, v32
  v_cvt_pk_bf16_f32 v30, v30, v30
  v_lshlrev_b32 v30, 16, v30
  v_mov_b32 v31, v32
  ds_write_b64 v26, v[30:31]
  s_waitcnt lgkmcnt(0)
  s_mov_b32 s41, s57
  s_mul_i32 s32, s41, 16
  s_add_u32 s32, s32, 0
  v_lshrrev_b32 v2, 3, v0
  v_add_u32 v2, s32, v2
  v_bfe_u32 v3, v2, 1, 1
  v_bfe_u32 v4, v2, 3, 1
  v_lshl_or_b32 v3, v4, 1, v3
  v_lshlrev_b32 v3, 1, v3
  v_and_b32 v4, 7, v0
  v_xor_b32 v3, v3, v4
  v_lshlrev_b32 v3, 4, v3
  s_mov_b32 s32, 2048
  v_mul_lo_u32 v2, v2, s32
  v_add_u32 v130, v2, v3
  s_mul_i32 s32, s41, 16
  s_add_u32 s32, s32, 8
  v_lshrrev_b32 v2, 3, v0
  v_add_u32 v2, s32, v2
  v_bfe_u32 v3, v2, 1, 1
  v_bfe_u32 v4, v2, 3, 1
  v_lshl_or_b32 v3, v4, 1, v3
  v_lshlrev_b32 v3, 1, v3
  v_and_b32 v4, 7, v0
  v_xor_b32 v3, v3, v4
  v_lshlrev_b32 v3, 4, v3
  s_mov_b32 s32, 2048
  v_mul_lo_u32 v2, v2, s32
  v_add_u32 v131, v2, v3
  v_subrev_u32 v131, 1024, v131
  s_mov_b32 s12, s68
  s_mov_b32 s13, s69
  s_mov_b32 s14, 2097152
  s_mov_b32 s15, 0x20000
  s_mov_b32 s30, 7
  s_mov_b32 s31, -1
  s_lshl_b32 s52, s57, 11
  s_lshl_b32 s53, 0x303, s7
  s_lshr_b32 s53, s53, 8
  s_add_u32 s30, s30, 1
  s_and_b32 s30, s30, 7
  s_cselect_b32 s32, 0, 1
  s_add_u32 s31, s31, s32
  s_sub_u32 s32, s30, s7
  s_and_b32 s32, s32, 7
  s_cmp_lt_u32 s32, 2
  s_cselect_b32 s32, 1, 0
  s_add_u32 s32, s32, s31
  s_cmp_ge_u32 s32, 2
  s_cselect_b32 s32, 0, s32
  s_lshl_b32 s33, s32, 3
  s_add_u32 s33, s33, s30
  s_lshl_b32 s37, s33, 17
  s_add_u32 s37, s37, s35
  s_add_u32 m0, s52, 131072
  s_nop 0
  buffer_load_dwordx4 v130, s[12:15], s37 offen lds
  buffer_load_dwordx4 v131, s[12:15], s37 offen offset:1024 lds
  s_add_u32 s30, s30, 1
  s_and_b32 s30, s30, 7
  s_cselect_b32 s32, 0, 1
  s_add_u32 s31, s31, s32
  s_sub_u32 s32, s30, s7
  s_and_b32 s32, s32, 7
  s_cmp_lt_u32 s32, 2
  s_cselect_b32 s32, 1, 0
  s_add_u32 s32, s32, s31
  s_cmp_ge_u32 s32, 2
  s_cselect_b32 s32, 0, s32
  s_lshl_b32 s33, s32, 3
  s_add_u32 s33, s33, s30
  s_lshl_b32 s37, s33, 17
  s_add_u32 s37, s37, s35
  s_add_u32 m0, s52, 139264
  s_nop 0
  buffer_load_dwordx4 v130, s[12:15], s37 offen lds
  buffer_load_dwordx4 v131, s[12:15], s37 offen offset:1024 lds
  s_add_u32 s30, s30, 1
  s_and_b32 s30, s30, 7
  s_cselect_b32 s32, 0, 1
  s_add_u32 s31, s31, s32
  s_sub_u32 s32, s30, s7
  s_and_b32 s32, s32, 7
  s_cmp_lt_u32 s32, 2
  s_cselect_b32 s32, 1, 0
  s_add_u32 s32, s32, s31
  s_cmp_ge_u32 s32, 2
  s_cselect_b32 s32, 0, s32
  s_lshl_b32 s33, s32, 3
  s_add_u32 s33, s33, s30
  s_lshl_b32 s37, s33, 17
  s_add_u32 s37, s37, s35
  s_add_u32 m0, s52, 147456
  s_nop 0
  buffer_load_dwordx4 v130, s[12:15], s37 offen lds
  buffer_load_dwordx4 v131, s[12:15], s37 offen offset:1024 lds
  s_add_u32 s30, s30, 1
  s_and_b32 s30, s30, 7
  s_cselect_b32 s32, 0, 1
  s_add_u32 s31, s31, s32
  s_sub_u32 s32, s30, s7
  s_and_b32 s32, s32, 7
  s_cmp_lt_u32 s32, 2
  s_cselect_b32 s32, 1, 0
  s_add_u32 s32, s32, s31
  s_cmp_ge_u32 s32, 2
  s_cselect_b32 s32, 0, s32
  s_lshl_b32 s33, s32, 3
  s_add_u32 s33, s33, s30
  s_lshl_b32 s37, s33, 17
  s_add_u32 s37, s37, s35
  s_add_u32 m0, s52, 155648
  s_nop 0
  buffer_load_dwordx4 v130, s[12:15], s37 offen lds
  buffer_load_dwordx4 v131, s[12:15], s37 offen offset:1024 lds
  s_waitcnt vmcnt(8)
  s_barrier
  s_add_u32 s30, s30, 1
  s_and_b32 s30, s30, 7
  s_cselect_b32 s32, 0, 1
  s_add_u32 s31, s31, s32
  s_sub_u32 s32, s30, s7
  s_and_b32 s32, s32, 7
  s_cmp_lt_u32 s32, 2
  s_cselect_b32 s32, 1, 0
  s_add_u32 s32, s32, s31
  s_cmp_ge_u32 s32, 2
  s_cselect_b32 s32, 0, s32
  s_lshl_b32 s33, s32, 3
  s_add_u32 s33, s33, s30
  s_lshl_b32 s37, s33, 17
  s_add_u32 s37, s37, s35
  s_add_u32 m0, s52, 100608
  s_nop 0
  buffer_load_dwordx4 v130, s[12:15], s37 offen lds
  buffer_load_dwordx4 v131, s[12:15], s37 offen offset:1024 lds
  s_add_u32 s30, s30, 1
  s_and_b32 s30, s30, 7
  s_cselect_b32 s32, 0, 1
  s_add_u32 s31, s31, s32
  s_sub_u32 s32, s30, s7
  s_and_b32 s32, s32, 7
  s_cmp_lt_u32 s32, 2
  s_cselect_b32 s32, 1, 0
  s_add_u32 s32, s32, s31
  s_cmp_ge_u32 s32, 2
  s_cselect_b32 s32, 0, s32
  s_lshl_b32 s33, s32, 3
  s_add_u32 s33, s33, s30
  s_lshl_b32 s37, s33, 17
  s_add_u32 s37, s37, s35
  s_add_u32 m0, s52, 108800
  s_nop 0
  buffer_load_dwordx4 v130, s[12:15], s37 offen lds
  buffer_load_dwordx4 v131, s[12:15], s37 offen offset:1024 lds
  s_add_u32 s30, s30, 1
  s_and_b32 s30, s30, 7
  s_cselect_b32 s32, 0, 1
  s_add_u32 s31, s31, s32
  s_sub_u32 s32, s30, s7
  s_and_b32 s32, s32, 7
  s_cmp_lt_u32 s32, 2
  s_cselect_b32 s32, 1, 0
  s_add_u32 s32, s32, s31
  s_cmp_ge_u32 s32, 2
  s_cselect_b32 s32, 0, s32
  s_lshl_b32 s33, s32, 3
  s_add_u32 s33, s33, s30
  s_lshl_b32 s37, s33, 17
  s_add_u32 s37, s37, s35
  s_add_u32 m0, s52, 116992
  s_nop 0
  buffer_load_dwordx4 v130, s[12:15], s37 offen lds
  buffer_load_dwordx4 v131, s[12:15], s37 offen offset:1024 lds
  s_cmp_lg_u32 s3, 0
  s_cbranch_scc1 e15
  v_and_b32 v4, 15, v0
  v_lshrrev_b32 v5, 4, v0
  v_lshrrev_b32 v6, 2, v4
  v_and_b32 v7, 3, v0
  v_lshrrev_b32 v3, 5, v0
  v_and_b32 v2, 1, v5
  v_lshl_or_b32 v3, v2, 1, v3
  s_lshr_b32 s40, s4, 1
  s_and_b32 s41, s4, 1
  s_mul_i32 s32, s41, 28800
  s_add_u32 s32, s32, 43008
  s_lshl_b32 s49, s40, 4
  v_add_u32 v76, s49, v4
  v_lshlrev_b32 v77, 4, v5
  v_add_u32 v77, s32, v77
  v_mul_u32_u24 v78, 400, v76
  v_add_u32 v220, v78, v77
  v_add_u32 v223, 3200, v220
  v_add_u32 v220, 128, v220
  v_add_u32 v76, 16, v76
  v_min_u32 v76, 71, v76
  v_mul_u32_u24 v78, 400, v76
  v_add3_u32 v221, v78, v77, 64
  v_add_u32 v221, 64, v221
  v_lshl_add_u32 v76, v5, 2, v6
  v_add_u32 v76, s49, v76
  v_lshlrev_b32 v77, 4, v7
  v_add_u32 v77, s32, v77
  v_add_u32 v77, 256, v77
  v_mul_u32_u24 v78, 400, v76
  v_add_u32 v222, v78, v77
  v_add_u32 v76, 16, v76
  v_min_u32 v76, 71, v76
  v_mul_u32_u24 v78, 400, v76
  v_add_u32 v254, v78, v77
  s_lshl_b32 s50, s28, 2
  s_add_u32 s50, s50, s40
  s_lshl_b32 s50, s50, 17
  s_lshl_b32 s51, s29, 13
  s_add_u32 s50, s50, s51
  s_lshl_b32 s51, s41, 11
  s_add_u32 s50, s50, s51
  s_and_b32 s51, s40, 1
  s_lshl_b32 s32, s51, 1
  s_add_u32 s32, s32, s41
  s_cmp_eq_u32 s32, 3
  s_addc_u32 s32, s32, 5
  s_lshl_b32 s32, s32, 7
  s_mov_b32 vcc_lo, 0xff000000
  s_mov_b32 vcc_hi, 0
  v_mov_b32 v1, s32
  v_cndmask_b32 v1, 0, v1, vcc
  v_lshl_add_u32 v1, v0, 4, v1
  v_add_u32 v1, s50, v1
  v_lshlrev_b32 v76, 2, v5
  v_sub_u32 v76, v76, v4
  s_or_b32 s51, s28, s40
  s_cmp_eq_u32 s51, 0
  s_cselect_b32 s51, 0, -1
  v_add_u32 v77, -1, v76
  v_cmp_gt_u32 s[86:87], 8, v77
  v_add_u32 v77, 0, v76
  v_cmp_gt_u32 s[88:89], 8, v77
  v_add_u32 v77, 1, v76
  v_cmp_gt_u32 s[90:91], 8, v77
  v_add_u32 v77, 2, v76
  v_cmp_gt_u32 s[92:93], 8, v77
  v_add_u32 v77, 15, v76
  v_cmp_gt_u32 s[94:95], 8, v77
  v_add_u32 v77, 16, v76
  v_cmp_gt_u32 s[96:97], 8, v77
  v_add_u32 v77, 17, v76
  v_cmp_gt_u32 s[98:99], 8, v77
  v_add_u32 v77, 18, v76
  v_cmp_gt_u32 s[100:101], 8, v77
  s_and_b32 s86, s86, s51
  s_and_b32 s88, s88, s51
  s_and_b32 s90, s90, s51
  s_and_b32 s92, s92, s51
e15:
  s_nop 1
  s_waitcnt lgkmcnt(0)
  s_barrier
  s_add_u32 s30, s30, 1
  s_and_b32 s30, s30, 7
  s_cselect_b32 s32, 0, 1
  s_add_u32 s31, s31, s32
  s_sub_u32 s32, s30, s7
  s_and_b32 s32, s32, 7
  s_cmp_lt_u32 s32, 2
  s_cselect_b32 s32, 1, 0
  s_add_u32 s32, s32, s31
  s_cmp_ge_u32 s32, 2
  s_cselect_b32 s32, 0, s32
  s_lshl_b32 s33, s32, 3
  s_add_u32 s33, s33, s30
  s_lshl_b32 s37, s33, 17
  s_add_u32 s37, s37, s35
  s_add_u32 m0, s52, 0
  s_nop 0
  buffer_load_dwordx4 v130, s[12:15], s37 offen lds
  buffer_load_dwordx4 v131, s[12:15], s37 offen offset:1024 lds
  s_add_u32 s30, s30, 1
  s_and_b32 s30, s30, 7
  s_cselect_b32 s32, 0, 1
  s_add_u32 s31, s31, s32
  s_sub_u32 s32, s30, s7
  s_and_b32 s32, s32, 7
  s_cmp_lt_u32 s32, 2
  s_cselect_b32 s32, 1, 0
  s_add_u32 s32, s32, s31
  s_cmp_ge_u32 s32, 2
  s_cselect_b32 s32, 0, s32
  s_lshl_b32 s33, s32, 3
  s_add_u32 s33, s33, s30
  s_lshl_b32 s37, s33, 17
  s_add_u32 s37, s37, s35
  s_add_u32 m0, s52, 8192
  s_nop 0
  buffer_load_dwordx4 v130, s[12:15], s37 offen lds
  buffer_load_dwordx4 v131, s[12:15], s37 offen offset:1024 lds
  s_add_u32 s30, s30, 1
  s_and_b32 s30, s30, 7
  s_cselect_b32 s32, 0, 1
  s_add_u32 s31, s31, s32
  s_sub_u32 s32, s30, s7
  s_and_b32 s32, s32, 7
  s_cmp_lt_u32 s32, 2
  s_cselect_b32 s32, 1, 0
  s_add_u32 s32, s32, s31
  s_cmp_ge_u32 s32, 2
  s_cselect_b32 s32, 0, s32
  s_lshl_b32 s33, s32, 3
  s_add_u32 s33, s33, s30
  s_lshl_b32 s37, s33, 17
  s_add_u32 s37, s37, s35
  s_add_u32 m0, s52, 16384
  s_nop 0
  buffer_load_dwordx4 v130, s[12:15], s37 offen lds
  buffer_load_dwordx4 v131, s[12:15], s37 offen offset:1024 lds
  s_add_u32 s30, s30, 1
  s_and_b32 s30, s30, 7
  s_cselect_b32 s32, 0, 1
  s_add_u32 s31, s31, s32
  s_sub_u32 s32, s30, s7
  s_and_b32 s32, s32, 7
  s_cmp_lt_u32 s32, 2
  s_cselect_b32 s32, 1, 0
  s_add_u32 s32, s32, s31
  s_cmp_ge_u32 s32, 2
  s_cselect_b32 s32, 0, s32
  s_lshl_b32 s33, s32, 3
  s_add_u32 s33, s33, s30
  s_lshl_b32 s37, s33, 17
  s_add_u32 s37, s37, s35
  s_add_u32 m0, s52, 24576
  s_nop 0
  buffer_load_dwordx4 v130, s[12:15], s37 offen lds
  buffer_load_dwordx4 v131, s[12:15], s37 offen offset:1024 lds
  s_add_u32 s30, s30, 1
  s_and_b32 s30, s30, 7
  s_cselect_b32 s32, 0, 1
  s_add_u32 s31, s31, s32
  s_sub_u32 s32, s30, s7
  s_and_b32 s32, s32, 7
  s_cmp_lt_u32 s32, 2
  s_cselect_b32 s32, 1, 0
  s_add_u32 s32, s32, s31
  s_cmp_ge_u32 s32, 2
  s_cselect_b32 s32, 0, s32
  s_lshl_b32 s33, s32, 3
  s_add_u32 s33, s33, s30
  s_lshl_b32 s37, s33, 17
  s_add_u32 s37, s37, s35
  s_add_u32 m0, s52, 32768
  s_nop 0
  buffer_load_dwordx4 v130, s[12:15], s37 offen lds
  buffer_load_dwordx4 v131, s[12:15], s37 offen offset:1024 lds
  s_branch attn
L_k1done:
  s_nop 7
  s_nop 7
  s_add_u32 s24, s84, 109051904
  s_addc_u32 s25, s85, 0
  s_mov_b32 s26, 524288
  s_mov_b32 s27, 0x20000
  v_mov_b32 v136, 0
  v_mov_b32 v137, 1
  s_cmp_eq_u32 s57, 0
  s_cselect_b32 s26, s26, 0
  s_waitcnt vmcnt(0)
  s_barrier
  s_mov_b64 exec, 1
  buffer_store_dword v137, v136, s[24:27], s56 offen sc0 sc1
  s_mov_b64 exec, -1
  s_add_u32 s30, s30, 1
  s_and_b32 s30, s30, 7
  s_cselect_b32 s32, 0, 1
  s_add_u32 s31, s31, s32
  s_sub_u32 s32, s30, s7
  s_and_b32 s32, s32, 7
  s_cmp_lt_u32 s32, 2
  s_cselect_b32 s32, 1, 0
  s_add_u32 s32, s32, s31
  s_cmp_ge_u32 s32, 2
  s_cselect_b32 s32, 0, s32
  s_lshl_b32 s33, s32, 3
  s_add_u32 s33, s33, s30
  s_lshl_b32 s37, s33, 17
  s_add_u32 s37, s37, s35
  s_add_u32 m0, s52, 43008
  s_nop 0
  buffer_load_dwordx4 v130, s[12:15], s37 offen lds
  buffer_load_dwordx4 v131, s[12:15], s37 offen offset:1024 lds
  s_add_u32 s30, s30, 1
  s_and_b32 s30, s30, 7
  s_cselect_b32 s32, 0, 1
  s_add_u32 s31, s31, s32
  s_sub_u32 s32, s30, s7
  s_and_b32 s32, s32, 7
  s_cmp_lt_u32 s32, 2
  s_cselect_b32 s32, 1, 0
  s_add_u32 s32, s32, s31
  s_cmp_ge_u32 s32, 2
  s_cselect_b32 s32, 0, s32
  s_lshl_b32 s33, s32, 3
  s_add_u32 s33, s33, s30
  s_lshl_b32 s37, s33, 17
  s_add_u32 s37, s37, s35
  s_add_u32 m0, s52, 51200
  s_nop 0
  buffer_load_dwordx4 v130, s[12:15], s37 offen lds
  buffer_load_dwordx4 v131, s[12:15], s37 offen offset:1024 lds
  s_add_u32 s30, s30, 1
  s_and_b32 s30, s30, 7
  s_cselect_b32 s32, 0, 1
  s_add_u32 s31, s31, s32
  s_sub_u32 s32, s30, s7
  s_and_b32 s32, s32, 7
  s_cmp_lt_u32 s32, 2
  s_cselect_b32 s32, 1, 0
  s_add_u32 s32, s32, s31
  s_cmp_ge_u32 s32, 2
  s_cselect_b32 s32, 0, s32
  s_lshl_b32 s33, s32, 3
  s_add_u32 s33, s33, s30
  s_lshl_b32 s37, s33, 17
  s_add_u32 s37, s37, s35
  s_add_u32 m0, s52, 59392
  s_nop 0
  buffer_load_dwordx4 v130, s[12:15], s37 offen lds
  buffer_load_dwordx4 v131, s[12:15], s37 offen offset:1024 lds
  s_add_u32 s30, s30, 1
  s_and_b32 s30, s30, 7
  s_cselect_b32 s32, 0, 1
  s_add_u32 s31, s31, s32
  s_sub_u32 s32, s30, s7
  s_and_b32 s32, s32, 7
  s_cmp_lt_u32 s32, 2
  s_cselect_b32 s32, 1, 0
  s_add_u32 s32, s32, s31
  s_cmp_ge_u32 s32, 2
  s_cselect_b32 s32, 0, s32
  s_lshl_b32 s33, s32, 3
  s_add_u32 s33, s33, s30
  s_lshl_b32 s37, s33, 17
  s_add_u32 s37, s37, s35
  s_add_u32 m0, s52, 67584
  s_nop 0
  buffer_load_dwordx4 v130, s[12:15], s37 offen lds
  buffer_load_dwordx4 v131, s[12:15], s37 offen offset:1024 lds
  s_lshl_b32 s56, s3, 10
  s_mul_i32 s32, s29, 16
  s_add_u32 s56, s56, s32
  s_add_u32 s56, s56, s28
  s_add_u32 s56, s56, 256
  s_lshl_b32 s56, s56, 7
  s_barrier
  s_waitcnt vmcnt(0)
  s_barrier
  s_cmp_ge_u32 s2, 224
  s_cbranch_scc1 L_k3skip
  s_lshr_b32 s32, s2, 3
  s_mul_i32 s5, s32, 9363
  s_lshr_b32 s5, s5, 16
  s_mul_i32 s6, s5, 7
  s_sub_u32 s6, s32, s6
  s_lshl_b32 s7, s5, 1
  s_add_u32 s7, s7, s6
  s_and_b32 s7, s7, 7
  s_and_b32 s32, s2, 7
  s_lshr_b32 s28, s32, 2
  s_lshl_b32 s28, s28, 2
  s_add_u32 s28, s28, s5
  s_and_b32 s29, s32, 3
  s_mul_i32 s29, s29, 7
  s_add_u32 s29, s29, s6
  s_mov_b32 s30, 7
  s_mov_b32 s31, -1
  s_lshl_b32 s44, s57, 12
  s_add_u32 s45, s44, 16384
  v_lshrrev_b32 v2, 4, v0
  v_lshlrev_b32 v3, 1, v2
  v_and_b32 v4, 15, v0
  v_xor_b32 v3, v3, v4
  v_lshlrev_b32 v3, 4, v3
  s_lshl_b32 s32, s57, 4
  v_add_u32 v2, s32, v2
  s_mov_b32 s32, 7168
  v_mul_lo_u32 v2, v2, s32
  v_add_u32 v9, v2, v3
  v_xor_b32 v3, 128, v3
  v_add_u32 v11, v2, v3
  v_add_u32 v10, 27648, v9
  v_add_u32 v12, 82944, v11
  v_add_u32 v11, 55296, v11
  s_lshl_b32 s34, s28, 2
  s_add_u32 s34, s34, s57
  s_lshl_b32 s34, s34, 18
  s_lshl_b32 s35, s29, 8
  s_lshl_b32 s32, 0, 1
  s_add_u32 s32, s32, 0
  s_cmp_eq_u32 s32, 3
  s_addc_u32 s32, s32, 5
  s_lshl_b32 s32, s32, 7
  s_mov_b32 vcc_lo, 0xff000000
  s_mov_b32 vcc_hi, 0
  v_mov_b32 v20, s32
  v_cndmask_b32 v20, 0, v20, vcc
  v_lshl_add_u32 v20, v0, 4, v20
  s_lshl_b32 s32, 1, 1
  s_add_u32 s32, s32, 0
  s_cmp_eq_u32 s32, 3
  s_addc_u32 s32, s32, 5
  s_lshl_b32 s32, s32, 7
  s_mov_b32 vcc_lo, 0xff000000
  s_mov_b32 vcc_hi, 0
  v_mov_b32 v21, s32
  v_cndmask_b32 v21, 0, v21, vcc
  v_lshl_add_u32 v21, v0, 4, v21
  v_add_u32 v21, 1024, v21
  s_lshl_b32 s32, 0, 1
  s_add_u32 s32, s32, 1
  s_cmp_eq_u32 s32, 3
  s_addc_u32 s32, s32, 5
  s_lshl_b32 s32, s32, 7
  s_mov_b32 vcc_lo, 0xff000000
  s_mov_b32 vcc_hi, 0
  v_mov_b32 v22, s32
  v_cndmask_b32 v22, 0, v22, vcc
  v_lshl_add_u32 v22, v0, 4, v22
  v_add_u32 v22, 129024, v22
  s_lshl_b32 s32, 1, 1
  s_add_u32 s32, s32, 1
  s_cmp_eq_u32 s32, 3
  s_addc_u32 s32, s32, 5
  s_lshl_b32 s32, s32, 7
  s_mov_b32 vcc_lo, 0xff000000
  s_mov_b32 vcc_hi, 0
  v_mov_b32 v23, s32
  v_cndmask_b32 v23, 0, v23, vcc
  v_lshl_add_u32 v23, v0, 4, v23
  v_add_u32 v23, 130048, v23
  s_add_u32 s8, s82, 16777216
  s_addc_u32 s9, s83, 0
  s_mov_b32 s10, 8388608
  s_mov_b32 s11, 0x20000
  s_mov_b32 s12, s72
  s_mov_b32 s13, s73
  s_mov_b32 s14, 14680064
  s_mov_b32 s15, 0x20000
  s_add_u32 s16, s84, 109051904
  s_addc_u32 s17, s85, 0
  s_mov_b32 s18, 524288
  s_mov_b32 s19, 0x20000
  v_min_u32 v14, 31, v0
  s_lshl_b32 s32, s28, 5
  v_add_u32 v14, s32, v14
  v_max_i32 v14, 0, v14
  v_lshlrev_b32 v14, 7, v14
  s_lshl_b32 s55, s3, 17
  s_add_u32 s55, s55, 32768
  s_lshr_b32 s32, s2, 3
  s_add_u32 s32, s32, 0
  s_lshl_b32 s32, s32, 2
  s_add_u32 s32, s32, s57
  s_lshl_b32 s32, s32, 6
  v_add_u32 v2, s32, v0
  v_mul_u32_u24 v3, 74899, v2
  v_lshrrev_b32 v3, 20, v3
  v_mul_u32_u24 v4, 14, v3
  v_sub_u32 v4, v2, v4
  v_add_u32 v3, 192, v3
  v_mul_u32_u24 v3, 7168, v3
  v_lshl_add_u32 v3, v4, 7, v3
  s_and_b32 s32, s2, 3
  s_mul_i32 s32, s32, 1792
  s_lshl_b32 s40, s3, 30
  s_add_u32 s32, s32, s40
  v_add_u32 v16, s32, v3
  s_barrier
  s_barrier
  s_mov_b64 exec, 1
  buffer_store_dword v137, v136, s[24:27], s56 offen sc0 sc1
  s_mov_b64 exec, -1
  s_mov_b32 s30, 7
  s_mov_b32 s31, -1
  s_mov_b32 s38, 0
  s_add_u32 s30, s30, 1
  s_and_b32 s30, s30, 7
  s_cselect_b32 s32, 0, 1
  s_add_u32 s31, s31, s32
  s_sub_u32 s32, s30, s7
  s_and_b32 s32, s32, 7
  s_cmp_lt_u32 s32, 2
  s_cselect_b32 s32, 1, 0
  s_add_u32 s32, s32, s31
  s_cmp_ge_u32 s32, 4
  s_cselect_b32 s32, 0, s32
  s_lshl_b32 s33, s32, 3
  s_add_u32 s33, s33, s30
  s_mul_i32 s37, s33, 458752
  s_add_u32 s37, s37, s35
  s_add_u32 m0, s38, s45
  s_nop 0
  buffer_load_dwordx4 v9, s[12:15], s37 offen offset:0  lds
  buffer_load_dwordx4 v10, s[12:15], s37 offen offset:1024  lds
  buffer_load_dwordx4 v11, s[12:15], s37 offen offset:2048  lds
  buffer_load_dwordx4 v12, s[12:15], s37 offen offset:3072  lds
  s_add_u32 s38, s38, 32768
  s_cmp_eq_u32 s38, 163840
  s_cselect_b32 s38, 0, s38
  s_add_u32 s30, s30, 1
  s_and_b32 s30, s30, 7
  s_cselect_b32 s32, 0, 1
  s_add_u32 s31, s31, s32
  s_sub_u32 s32, s30, s7
  s_and_b32 s32, s32, 7
  s_cmp_lt_u32 s32, 2
  s_cselect_b32 s32, 1, 0
  s_add_u32 s32, s32, s31
  s_cmp_ge_u32 s32, 4
  s_cselect_b32 s32, 0, s32
  s_lshl_b32 s33, s32, 3
  s_add_u32 s33, s33, s30
  s_mul_i32 s37, s33, 458752
  s_add_u32 s37, s37, s35
  s_add_u32 m0, s38, s45
  s_nop 0
  buffer_load_dwordx4 v9, s[12:15], s37 offen offset:0  lds
  buffer_load_dwordx4 v10, s[12:15], s37 offen offset:1024  lds
  buffer_load_dwordx4 v11, s[12:15], s37 offen offset:2048  lds
  buffer_load_dwordx4 v12, s[12:15], s37 offen offset:3072  lds
  s_add_u32 s38, s38, 32768
  s_cmp_eq_u32 s38, 163840
  s_cselect_b32 s38, 0, s38
  s_add_u32 s30, s30, 1
  s_and_b32 s30, s30, 7
  s_cselect_b32 s32, 0, 1
  s_add_u32 s31, s31, s32
  s_sub_u32 s32, s30, s7
  s_and_b32 s32, s32, 7
  s_cmp_lt_u32 s32, 2
  s_cselect_b32 s32, 1, 0
  s_add_u32 s32, s32, s31
  s_cmp_ge_u32 s32, 4
  s_cselect_b32 s32, 0, s32
  s_lshl_b32 s33, s32, 3
  s_add_u32 s33, s33, s30
  s_mul_i32 s37, s33, 458752
  s_add_u32 s37, s37, s35
  s_add_u32 m0, s38, s45
  s_nop 0
  buffer_load_dwordx4 v9, s[12:15], s37 offen offset:0  lds
  buffer_load_dwordx4 v10, s[12:15], s37 offen offset:1024  lds
  buffer_load_dwordx4 v11, s[12:15], s37 offen offset:2048  lds
  buffer_load_dwordx4 v12, s[12:15], s37 offen offset:3072  lds
  s_add_u32 s38, s38, 32768
  s_cmp_eq_u32 s38, 163840
  s_cselect_b32 s38, 0, s38
  buffer_load_dword v135, v16, s[12:15], 0 offen
  s_lshl_b32 s56, s3, 10
  s_mul_i32 s32, s28, 32
  s_add_u32 s56, s56, s32
  s_add_u32 s56, s56, s29
  s_add_u32 s56, s56, 512
  s_lshl_b32 s56, s56, 7
  s_mov_b32 s39, 0
  s_and_b32 s32, s4, 3
  s_cmp_lg_u32 s32, 0
  s_cbranch_scc1 poll16d
  s_sleep 8
poll16:
  buffer_load_dword v15, v14, s[16:19], s55 offen sc0 sc1
  s_waitcnt vmcnt(0)
  v_cmp_eq_u32 vcc, 0, v15
  s_add_u32 s39, s39, 1
  s_cmp_gt_u32 s39, 1000000
  s_cbranch_scc1 poll16d
  s_cbranch_vccnz poll16
poll16d:
  s_barrier
  s_mov_b32 s30, 7
  s_mov_b32 s31, -1
  s_mov_b32 s38, 0
  s_add_u32 s30, s30, 1
  s_and_b32 s30, s30, 7
  s_cselect_b32 s32, 0, 1
  s_add_u32 s31, s31, s32
  s_sub_u32 s32, s30, s7
  s_and_b32 s32, s32, 7
  s_cmp_lt_u32 s32, 2
  s_cselect_b32 s32, 1, 0
  s_add_u32 s32, s32, s31
  s_cmp_ge_u32 s32, 4
  s_cselect_b32 s32, 0, s32
  s_lshl_b32 s33, s32, 3
  s_add_u32 s33, s33, s30
  s_mul_i32 s36, s33, 4096
  s_add_u32 s36, s36, s34
  s_add_u32 m0, s38, s44
  s_nop 0
  buffer_load_dwordx4 v20, s[8:11], s36 offen offset:0 sc1 lds
  buffer_load_dwordx4 v21, s[8:11], s36 offen offset:1024 sc1 lds
  buffer_load_dwordx4 v22, s[8:11], s36 offen offset:2048 sc1 lds
  buffer_load_dwordx4 v23, s[8:11], s36 offen offset:3072 sc1 lds
  s_add_u32 s38, s38, 32768
  s_cmp_eq_u32 s38, 163840
  s_cselect_b32 s38, 0, s38
  s_add_u32 s30, s30, 1
  s_and_b32 s30, s30, 7
  s_cselect_b32 s32, 0, 1
  s_add_u32 s31, s31, s32
  s_sub_u32 s32, s30, s7
  s_and_b32 s32, s32, 7
  s_cmp_lt_u32 s32, 2
  s_cselect_b32 s32, 1, 0
  s_add_u32 s32, s32, s31
  s_cmp_ge_u32 s32, 4
  s_cselect_b32 s32, 0, s32
  s_lshl_b32 s33, s32, 3
  s_add_u32 s33, s33, s30
  s_mul_i32 s36, s33, 4096
  s_add_u32 s36, s36, s34
  s_add_u32 m0, s38, s44
  s_nop 0
  buffer_load_dwordx4 v20, s[8:11], s36 offen offset:0 sc1 lds
  buffer_load_dwordx4 v21, s[8:11], s36 offen offset:1024 sc1 lds
  buffer_load_dwordx4 v22, s[8:11], s36 offen offset:2048 sc1 lds
  buffer_load_dwordx4 v23, s[8:11], s36 offen offset:3072 sc1 lds
  s_add_u32 s38, s38, 32768
  s_cmp_eq_u32 s38, 163840
  s_cselect_b32 s38, 0, s38
  s_add_u32 s30, s30, 1
  s_and_b32 s30, s30, 7
  s_cselect_b32 s32, 0, 1
  s_add_u32 s31, s31, s32
  s_sub_u32 s32, s30, s7
  s_and_b32 s32, s32, 7
  s_cmp_lt_u32 s32, 2
  s_cselect_b32 s32, 1, 0
  s_add_u32 s32, s32, s31
  s_cmp_ge_u32 s32, 4
  s_cselect_b32 s32, 0, s32
  s_lshl_b32 s33, s32, 3
  s_add_u32 s33, s33, s30
  s_mul_i32 s36, s33, 4096
  s_add_u32 s36, s36, s34
  s_add_u32 m0, s38, s44
  s_nop 0
  buffer_load_dwordx4 v20, s[8:11], s36 offen offset:0 sc1 lds
  buffer_load_dwordx4 v21, s[8:11], s36 offen offset:1024 sc1 lds
  buffer_load_dwordx4 v22, s[8:11], s36 offen offset:2048 sc1 lds
  buffer_load_dwordx4 v23, s[8:11], s36 offen offset:3072 sc1 lds
  s_add_u32 s38, s38, 32768
  s_cmp_eq_u32 s38, 163840
  s_cselect_b32 s38, 0, s38
  s_waitcnt vmcnt(8)
  s_barrier
  s_add_u32 s30, s30, 1
  s_and_b32 s30, s30, 7
  s_cselect_b32 s32, 0, 1
  s_add_u32 s31, s31, s32
  s_sub_u32 s32, s30, s7
  s_and_b32 s32, s32, 7
  s_cmp_lt_u32 s32, 2
  s_cselect_b32 s32, 1, 0
  s_add_u32 s32, s32, s31
  s_cmp_ge_u32 s32, 4
  s_cselect_b32 s32, 0, s32
  s_lshl_b32 s33, s32, 3
  s_add_u32 s33, s33, s30
  s_mul_i32 s36, s33, 4096
  s_add_u32 s36, s36, s34
  s_mul_i32 s37, s33, 458752
  s_add_u32 s37, s37, s35
  s_add_u32 m0, s38, s44
  s_nop 0
  buffer_load_dwordx4 v20, s[8:11], s36 offen offset:0 sc1 lds
  buffer_load_dwordx4 v21, s[8:11], s36 offen offset:1024 sc1 lds
  buffer_load_dwordx4 v22, s[8:11], s36 offen offset:2048 sc1 lds
  buffer_load_dwordx4 v23, s[8:11], s36 offen offset:3072 sc1 lds
  s_add_u32 m0, s38, s45
  s_nop 0
  buffer_load_dwordx4 v9, s[12:15], s37 offen offset:0  lds
  buffer_load_dwordx4 v10, s[12:15], s37 offen offset:1024  lds
  buffer_load_dwordx4 v11, s[12:15], s37 offen offset:2048  lds
  buffer_load_dwordx4 v12, s[12:15], s37 offen offset:3072  lds
  s_add_u32 s38, s38, 32768
  s_cmp_eq_u32 s38, 163840
  s_cselect_b32 s38, 0, s38
  s_waitcnt vmcnt(12)
  s_barrier
  s_add_u32 s30, s30, 1
  s_and_b32 s30, s30, 7
  s_cselect_b32 s32, 0, 1
  s_add_u32 s31, s31, s32
  s_sub_u32 s32, s30, s7
  s_and_b32 s32, s32, 7
  s_cmp_lt_u32 s32, 2
  s_cselect_b32 s32, 1, 0
  s_add_u32 s32, s32, s31
  s_cmp_ge_u32 s32, 4
  s_cselect_b32 s32, 0, s32
  s_lshl_b32 s33, s32, 3
  s_add_u32 s33, s33, s30
  s_mul_i32 s36, s33, 4096
  s_add_u32 s36, s36, s34
  s_mul_i32 s37, s33, 458752
  s_add_u32 s37, s37, s35
  s_add_u32 m0, s38, s44
  s_nop 0
  buffer_load_dwordx4 v20, s[8:11], s36 offen offset:0 sc1 lds
  buffer_load_dwordx4 v21, s[8:11], s36 offen offset:1024 sc1 lds
  buffer_load_dwordx4 v22, s[8:11], s36 offen offset:2048 sc1 lds
  buffer_load_dwordx4 v23, s[8:11], s36 offen offset:3072 sc1 lds
  s_add_u32 m0, s38, s45
  s_nop 0
  buffer_load_dwordx4 v9, s[12:15], s37 offen offset:0  lds
  buffer_load_dwordx4 v10, s[12:15], s37 offen offset:1024  lds
  buffer_load_dwordx4 v11, s[12:15], s37 offen offset:2048  lds
  buffer_load_dwordx4 v12, s[12:15], s37 offen offset:3072  lds
  s_add_u32 s38, s38, 32768
  s_cmp_eq_u32 s38, 163840
  s_cselect_b32 s38, 0, s38
  s_mov_b32 s39, 27
ll17:
  s_waitcnt vmcnt(16)
  s_barrier
  s_add_u32 s30, s30, 1
  s_and_b32 s30, s30, 7
  s_cselect_b32 s32, 0, 1
  s_add_u32 s31, s31, s32
  s_sub_u32 s32, s30, s7
  s_and_b32 s32, s32, 7
  s_cmp_lt_u32 s32, 2
  s_cselect_b32 s32, 1, 0
  s_add_u32 s32, s32, s31
  s_cmp_ge_u32 s32, 4
  s_cselect_b32 s32, 0, s32
  s_lshl_b32 s33, s32, 3
  s_add_u32 s33, s33, s30
  s_mul_i32 s36, s33, 4096
  s_add_u32 s36, s36, s34
  s_mul_i32 s37, s33, 458752
  s_add_u32 s37, s37, s35
  s_add_u32 m0, s38, s44
  s_nop 0
  buffer_load_dwordx4 v20, s[8:11], s36 offen offset:0 sc1 lds
  buffer_load_dwordx4 v21, s[8:11], s36 offen offset:1024 sc1 lds
  buffer_load_dwordx4 v22, s[8:11], s36 offen offset:2048 sc1 lds
  buffer_load_dwordx4 v23, s[8:11], s36 offen offset:3072 sc1 lds
  s_add_u32 m0, s38, s45
  s_nop 0
  buffer_load_dwordx4 v9, s[12:15], s37 offen offset:0  lds
  buffer_load_dwordx4 v10, s[12:15], s37 offen offset:1024  lds
  buffer_load_dwordx4 v11, s[12:15], s37 offen offset:2048  lds
  buffer_load_dwordx4 v12, s[12:15], s37 offen offset:3072  lds
  s_add_u32 s38, s38, 32768
  s_cmp_eq_u32 s38, 163840
  s_cselect_b32 s38, 0, s38
  s_sub_u32 s39, s39, 1
  s_cmp_lg_u32 s39, 0
  s_cbranch_scc1 ll17
  s_waitcnt vmcnt(16)
  s_barrier
  s_waitcnt vmcnt(8)
  s_barrier
  s_waitcnt vmcnt(0)
  s_barrier
  s_lshr_b32 s32, s2, 3
  s_lshr_b32 s5, s32, 3
  s_and_b32 s6, s32, 7
  s_lshl_b32 s7, s5, 1
  s_add_u32 s7, s7, s6
  s_and_b32 s7, s7, 7
  s_and_b32 s32, s2, 7
  s_lshr_b32 s28, s32, 2
  s_lshl_b32 s28, s28, 2
  s_add_u32 s28, s28, s5
  s_and_b32 s29, s32, 3
  s_mul_i32 s29, s29, 8
  s_add_u32 s29, s29, s6
  s_mov_b32 s30, 7
  s_mov_b32 s31, -1
  s_mov_b32 s41, s57
  s_lshl_b32 s45, s41, 11
  s_mul_i32 s32, s41, 16
  s_add_u32 s32, s32, 0
  v_lshrrev_b32 v2, 3, v0
  v_add_u32 v2, s32, v2
  v_bfe_u32 v3, v2, 1, 1
  v_bfe_u32 v4, v2, 3, 1
  v_lshl_or_b32 v3, v4, 1, v3
  v_lshlrev_b32 v3, 1, v3
  v_and_b32 v4, 7, v0
  v_xor_b32 v3, v3, v4
  v_lshlrev_b32 v3, 4, v3
  s_mov_b32 s32, 4096
  v_mul_lo_u32 v2, v2, s32
  v_add_u32 v9, v2, v3
  s_mul_i32 s32, s41, 16
  s_add_u32 s32, s32, 8
  v_lshrrev_b32 v2, 3, v0
  v_add_u32 v2, s32, v2
  v_bfe_u32 v3, v2, 1, 1
  v_bfe_u32 v4, v2, 3, 1
  v_lshl_or_b32 v3, v4, 1, v3
  v_lshlrev_b32 v3, 1, v3
  v_and_b32 v4, 7, v0
  v_xor_b32 v3, v3, v4
  v_lshlrev_b32 v3, 4, v3
  s_mov_b32 s32, 4096
  v_mul_lo_u32 v2, v2, s32
  v_add_u32 v10, v2, v3
  v_subrev_u32 v10, 1024, v10
  s_lshl_b32 s35, s29, 7
  s_mov_b32 s12, s76
  s_mov_b32 s13, s77
  s_mov_b32 s14, 14680064
  s_mov_b32 s15, 0x20000
  s_branch L_k4
L_k3skip:
  s_nop 7
  s_nop 7
  s_lshr_b32 s32, s2, 3
  s_lshr_b32 s5, s32, 3
  s_and_b32 s6, s32, 7
  s_lshl_b32 s7, s5, 1
  s_add_u32 s7, s7, s6
  s_and_b32 s7, s7, 7
  s_and_b32 s32, s2, 7
  s_lshr_b32 s28, s32, 2
  s_lshl_b32 s28, s28, 2
  s_add_u32 s28, s28, s5
  s_and_b32 s29, s32, 3
  s_mul_i32 s29, s29, 8
  s_add_u32 s29, s29, s6
  s_mov_b32 s30, 7
  s_mov_b32 s31, -1
  s_mov_b32 s41, s57
  s_lshl_b32 s45, s41, 11
  s_mul_i32 s32, s41, 16
  s_add_u32 s32, s32, 0
  v_lshrrev_b32 v2, 3, v0
  v_add_u32 v2, s32, v2
  v_bfe_u32 v3, v2, 1, 1
  v_bfe_u32 v4, v2, 3, 1
  v_lshl_or_b32 v3, v4, 1, v3
  v_lshlrev_b32 v3, 1, v3
  v_and_b32 v4, 7, v0
  v_xor_b32 v3, v3, v4
  v_lshlrev_b32 v3, 4, v3
  s_mov_b32 s32, 4096
  v_mul_lo_u32 v2, v2, s32
  v_add_u32 v9, v2, v3
  s_mul_i32 s32, s41, 16
  s_add_u32 s32, s32, 8
  v_lshrrev_b32 v2, 3, v0
  v_add_u32 v2, s32, v2
  v_bfe_u32 v3, v2, 1, 1
  v_bfe_u32 v4, v2, 3, 1
  v_lshl_or_b32 v3, v4, 1, v3
  v_lshlrev_b32 v3, 1, v3
  v_and_b32 v4, 7, v0
  v_xor_b32 v3, v3, v4
  v_lshlrev_b32 v3, 4, v3
  s_mov_b32 s32, 4096
  v_mul_lo_u32 v2, v2, s32
  v_add_u32 v10, v2, v3
  v_subrev_u32 v10, 1024, v10
  s_lshl_b32 s35, s29, 7
  s_mov_b32 s12, s76
  s_mov_b32 s13, s77
  s_mov_b32 s14, 14680064
  s_mov_b32 s15, 0x20000
  s_barrier
L_k4:
  s_nop 7
  s_nop 7
  s_mov_b32 s30, 7
  s_mov_b32 s31, -1
  s_mov_b32 s38, 65536
  s_add_u32 s30, s30, 1
  s_and_b32 s30, s30, 7
  s_cselect_b32 s32, 0, 1
  s_add_u32 s31, s31, s32
  s_sub_u32 s32, s30, s7
  s_and_b32 s32, s32, 7
  s_cmp_lt_u32 s32, 2
  s_cselect_b32 s32, 1, 0
  s_add_u32 s32, s32, s31
  s_cmp_ge_u32 s32, 7
  s_cselect_b32 s32, 0, s32
  s_lshl_b32 s33, s32, 3
  s_add_u32 s33, s33, s30
  s_mul_i32 s37, s33, 262144
  s_add_u32 s37, s37, s35
  s_add_u32 m0, s38, s45
  s_nop 0
  buffer_load_dwordx4 v9, s[12:15], s37 offen offset:0  lds
  buffer_load_dwordx4 v10, s[12:15], s37 offen offset:1024  lds
  s_add_u32 s38, s38, 8192
  s_cmp_eq_u32 s38, 163840
  s_cselect_b32 s38, 65536, s38
  s_add_u32 s30, s30, 1
  s_and_b32 s30, s30, 7
  s_cselect_b32 s32, 0, 1
  s_add_u32 s31, s31, s32
  s_sub_u32 s32, s30, s7
  s_and_b32 s32, s32, 7
  s_cmp_lt_u32 s32, 2
  s_cselect_b32 s32, 1, 0
  s_add_u32 s32, s32, s31
  s_cmp_ge_u32 s32, 7
  s_cselect_b32 s32, 0, s32
  s_lshl_b32 s33, s32, 3
  s_add_u32 s33, s33, s30
  s_mul_i32 s37, s33, 262144
  s_add_u32 s37, s37, s35
  s_add_u32 m0, s38, s45
  s_nop 0
  buffer_load_dwordx4 v9, s[12:15], s37 offen offset:0  lds
  buffer_load_dwordx4 v10, s[12:15], s37 offen offset:1024  lds
  s_add_u32 s38, s38, 8192
  s_cmp_eq_u32 s38, 163840
  s_cselect_b32 s38, 65536, s38
  s_add_u32 s30, s30, 1
  s_and_b32 s30, s30, 7
  s_cselect_b32 s32, 0, 1
  s_add_u32 s31, s31, s32
  s_sub_u32 s32, s30, s7
  s_and_b32 s32, s32, 7
  s_cmp_lt_u32 s32, 2
  s_cselect_b32 s32, 1, 0
  s_add_u32 s32, s32, s31
  s_cmp_ge_u32 s32, 7
  s_cselect_b32 s32, 0, s32
  s_lshl_b32 s33, s32, 3
  s_add_u32 s33, s33, s30
  s_mul_i32 s37, s33, 262144
  s_add_u32 s37, s37, s35
  s_add_u32 m0, s38, s45
  s_nop 0
  buffer_load_dwordx4 v9, s[12:15], s37 offen offset:0  lds
  buffer_load_dwordx4 v10, s[12:15], s37 offen offset:1024  lds
  s_add_u32 s38, s38, 8192
  s_cmp_eq_u32 s38, 163840
  s_cselect_b32 s38, 65536, s38
  s_add_u32 s30, s30, 1
  s_and_b32 s30, s30, 7
  s_cselect_b32 s32, 0, 1
  s_add_u32 s31, s31, s32
  s_sub_u32 s32, s30, s7
  s_and_b32 s32, s32, 7
  s_cmp_lt_u32 s32, 2
  s_cselect_b32 s32, 1, 0
  s_add_u32 s32, s32, s31
  s_cmp_ge_u32 s32, 7
  s_cselect_b32 s32, 0, s32
  s_lshl_b32 s33, s32, 3
  s_add_u32 s33, s33, s30
  s_mul_i32 s37, s33, 262144
  s_add_u32 s37, s37, s35
  s_add_u32 m0, s38, s45
  s_nop 0
  buffer_load_dwordx4 v9, s[12:15], s37 offen offset:0  lds
  buffer_load_dwordx4 v10, s[12:15], s37 offen offset:1024  lds
  s_add_u32 s38, s38, 8192
  s_cmp_eq_u32 s38, 163840
  s_cselect_b32 s38, 65536, s38
  s_add_u32 s30, s30, 1
  s_and_b32 s30, s30, 7
  s_cselect_b32 s32, 0, 1
  s_add_u32 s31, s31, s32
  s_sub_u32 s32, s30, s7
  s_and_b32 s32, s32, 7
  s_cmp_lt_u32 s32, 2
  s_cselect_b32 s32, 1, 0
  s_add_u32 s32, s32, s31
  s_cmp_ge_u32 s32, 7
  s_cselect_b32 s32, 0, s32
  s_lshl_b32 s33, s32, 3
  s_add_u32 s33, s33, s30
  s_mul_i32 s37, s33, 262144
  s_add_u32 s37, s37, s35
  s_add_u32 m0, s38, s45
  s_nop 0
  buffer_load_dwordx4 v9, s[12:15], s37 offen offset:0  lds
  buffer_load_dwordx4 v10, s[12:15], s37 offen offset:1024  lds
  s_add_u32 s38, s38, 8192
  s_cmp_eq_u32 s38, 163840
  s_cselect_b32 s38, 65536, s38
  s_add_u32 s30, s30, 1
  s_and_b32 s30, s30, 7
  s_cselect_b32 s32, 0, 1
  s_add_u32 s31, s31, s32
  s_sub_u32 s32, s30, s7
  s_and_b32 s32, s32, 7
  s_cmp_lt_u32 s32, 2
  s_cselect_b32 s32, 1, 0
  s_add_u32 s32, s32, s31
  s_cmp_ge_u32 s32, 7
  s_cselect_b32 s32, 0, s32
  s_lshl_b32 s33, s32, 3
  s_add_u32 s33, s33, s30
  s_mul_i32 s37, s33, 262144
  s_add_u32 s37, s37, s35
  s_add_u32 m0, s38, s45
  s_nop 0
  buffer_load_dwordx4 v9, s[12:15], s37 offen offset:0  lds
  buffer_load_dwordx4 v10, s[12:15], s37 offen offset:1024  lds
  s_add_u32 s38, s38, 8192
  s_cmp_eq_u32 s38, 163840
  s_cselect_b32 s38, 65536, s38
L_k4b:
  s_barrier
  s_mov_b64 exec, 1
  buffer_store_dword v137, v136, s[24:27], s56 offen sc0 sc1
  s_mov_b64 exec, -1
  s_add_u32 s30, s30, 1
  s_and_b32 s30, s30, 7
  s_cselect_b32 s32, 0, 1
  s_add_u32 s31, s31, s32
  s_sub_u32 s32, s30, s7
  s_and_b32 s32, s32, 7
  s_cmp_lt_u32 s32, 2
  s_cselect_b32 s32, 1, 0
  s_add_u32 s32, s32, s31
  s_cmp_ge_u32 s32, 7
  s_cselect_b32 s32, 0, s32
  s_lshl_b32 s33, s32, 3
  s_add_u32 s33, s33, s30
  s_mul_i32 s37, s33, 262144
  s_add_u32 s37, s37, s35
  s_add_u32 m0, s38, s45
  s_nop 0
  buffer_load_dwordx4 v9, s[12:15], s37 offen offset:0  lds
  buffer_load_dwordx4 v10, s[12:15], s37 offen offset:1024  lds
  s_add_u32 s38, s38, 8192
  s_cmp_eq_u32 s38, 163840
  s_cselect_b32 s38, 65536, s38
  s_add_u32 s30, s30, 1
  s_and_b32 s30, s30, 7
  s_cselect_b32 s32, 0, 1
  s_add_u32 s31, s31, s32
  s_sub_u32 s32, s30, s7
  s_and_b32 s32, s32, 7
  s_cmp_lt_u32 s32, 2
  s_cselect_b32 s32, 1, 0
  s_add_u32 s32, s32, s31
  s_cmp_ge_u32 s32, 7
  s_cselect_b32 s32, 0, s32
  s_lshl_b32 s33, s32, 3
  s_add_u32 s33, s33, s30
  s_mul_i32 s37, s33, 262144
  s_add_u32 s37, s37, s35
  s_add_u32 m0, s38, s45
  s_nop 0
  buffer_load_dwordx4 v9, s[12:15], s37 offen offset:0  lds
  buffer_load_dwordx4 v10, s[12:15], s37 offen offset:1024  lds
  s_add_u32 s38, s38, 8192
  s_cmp_eq_u32 s38, 163840
  s_cselect_b32 s38, 65536, s38
  s_add_u32 s30, s30, 1
  s_and_b32 s30, s30, 7
  s_cselect_b32 s32, 0, 1
  s_add_u32 s31, s31, s32
  s_sub_u32 s32, s30, s7
  s_and_b32 s32, s32, 7
  s_cmp_lt_u32 s32, 2
  s_cselect_b32 s32, 1, 0
  s_add_u32 s32, s32, s31
  s_cmp_ge_u32 s32, 7
  s_cselect_b32 s32, 0, s32
  s_lshl_b32 s33, s32, 3
  s_add_u32 s33, s33, s30
  s_mul_i32 s37, s33, 262144
  s_add_u32 s37, s37, s35
  s_add_u32 m0, s38, s45
  s_nop 0
  buffer_load_dwordx4 v9, s[12:15], s37 offen offset:0  lds
  buffer_load_dwordx4 v10, s[12:15], s37 offen offset:1024  lds
  s_add_u32 s38, s38, 8192
  s_cmp_eq_u32 s38, 163840
  s_cselect_b32 s38, 65536, s38
  s_add_u32 s30, s30, 1
  s_and_b32 s30, s30, 7
  s_cselect_b32 s32, 0, 1
  s_add_u32 s31, s31, s32
  s_sub_u32 s32, s30, s7
  s_and_b32 s32, s32, 7
  s_cmp_lt_u32 s32, 2
  s_cselect_b32 s32, 1, 0
  s_add_u32 s32, s32, s31
  s_cmp_ge_u32 s32, 7
  s_cselect_b32 s32, 0, s32
  s_lshl_b32 s33, s32, 3
  s_add_u32 s33, s33, s30
  s_mul_i32 s37, s33, 262144
  s_add_u32 s37, s37, s35
  s_add_u32 m0, s38, s45
  s_nop 0
  buffer_load_dwordx4 v9, s[12:15], s37 offen offset:0  lds
  buffer_load_dwordx4 v10, s[12:15], s37 offen offset:1024  lds
  s_add_u32 s38, s38, 8192
  s_cmp_eq_u32 s38, 163840
  s_cselect_b32 s38, 65536, s38
  s_add_u32 s30, s30, 1
  s_and_b32 s30, s30, 7
  s_cselect_b32 s32, 0, 1
  s_add_u32 s31, s31, s32
  s_sub_u32 s32, s30, s7
  s_and_b32 s32, s32, 7
  s_cmp_lt_u32 s32, 2
  s_cselect_b32 s32, 1, 0
  s_add_u32 s32, s32, s31
  s_cmp_ge_u32 s32, 7
  s_cselect_b32 s32, 0, s32
  s_lshl_b32 s33, s32, 3
  s_add_u32 s33, s33, s30
  s_mul_i32 s37, s33, 262144
  s_add_u32 s37, s37, s35
  s_add_u32 m0, s38, s45
  s_nop 0
  buffer_load_dwordx4 v9, s[12:15], s37 offen offset:0  lds
  buffer_load_dwordx4 v10, s[12:15], s37 offen offset:1024  lds
  s_add_u32 s38, s38, 8192
  s_cmp_eq_u32 s38, 163840
  s_cselect_b32 s38, 65536, s38
  s_add_u32 s30, s30, 1
  s_and_b32 s30, s30, 7
  s_cselect_b32 s32, 0, 1
  s_add_u32 s31, s31, s32
  s_sub_u32 s32, s30, s7
  s_and_b32 s32, s32, 7
  s_cmp_lt_u32 s32, 2
  s_cselect_b32 s32, 1, 0
  s_add_u32 s32, s32, s31
  s_cmp_ge_u32 s32, 7
  s_cselect_b32 s32, 0, s32
  s_lshl_b32 s33, s32, 3
  s_add_u32 s33, s33, s30
  s_mul_i32 s37, s33, 262144
  s_add_u32 s37, s37, s35
  s_add_u32 m0, s38, s45
  s_nop 0
  buffer_load_dwordx4 v9, s[12:15], s37 offen offset:0  lds
  buffer_load_dwordx4 v10, s[12:15], s37 offen offset:1024  lds
  s_add_u32 s38, s38, 8192
  s_cmp_eq_u32 s38, 163840
  s_cselect_b32 s38, 65536, s38
  s_lshl_b32 s56, s3, 10
  s_mul_i32 s32, s29, 8
  s_add_u32 s56, s56, s32
  s_add_u32 s56, s56, s28
  s_add_u32 s56, s56, 768
  s_lshl_b32 s56, s56, 7
  s_barrier
  s_waitcnt vmcnt(22)
  s_barrier
  s_waitcnt vmcnt(20)
  s_barrier
  s_mov_b32 s39, 44
ll18:
  s_waitcnt vmcnt(18)
  s_barrier
  s_add_u32 s30, s30, 1
  s_and_b32 s30, s30, 7
  s_cselect_b32 s32, 0, 1
  s_add_u32 s31, s31, s32
  s_sub_u32 s32, s30, s7
  s_and_b32 s32, s32, 7
  s_cmp_lt_u32 s32, 2
  s_cselect_b32 s32, 1, 0
  s_add_u32 s32, s32, s31
  s_cmp_ge_u32 s32, 7
  s_cselect_b32 s32, 0, s32
  s_lshl_b32 s33, s32, 3
  s_add_u32 s33, s33, s30
  s_mul_i32 s37, s33, 262144
  s_add_u32 s37, s37, s35
  s_add_u32 m0, s38, s45
  s_nop 0
  buffer_load_dwordx4 v9, s[12:15], s37 offen offset:0  lds
  buffer_load_dwordx4 v10, s[12:15], s37 offen offset:1024  lds
  s_add_u32 s38, s38, 8192
  s_cmp_eq_u32 s38, 163840
  s_cselect_b32 s38, 65536, s38
  s_sub_u32 s39, s39, 1
  s_cmp_lg_u32 s39, 0
  s_cbranch_scc1 ll18
  s_waitcnt vmcnt(18)
  s_barrier
  s_waitcnt vmcnt(16)
  s_barrier
  s_waitcnt vmcnt(14)
  s_barrier
  s_waitcnt vmcnt(12)
  s_barrier
  s_waitcnt vmcnt(10)
  s_barrier
  s_waitcnt vmcnt(8)
  s_barrier
  s_waitcnt vmcnt(6)
  s_barrier
  s_waitcnt vmcnt(4)
  s_barrier
  s_waitcnt vmcnt(2)
  s_barrier
  s_waitcnt vmcnt(0)
  s_barrier
  s_cmp_lg_u32 s3, 0
  s_cbranch_scc1 L_end
  s_lshr_b32 s32, s2, 3
  s_lshr_b32 s5, s32, 3
  s_and_b32 s6, s32, 7
  s_lshl_b32 s7, s5, 1
  s_add_u32 s7, s7, s6
  s_and_b32 s7, s7, 7
  s_and_b32 s32, s2, 7
  s_lshr_b32 s28, s32, 1
  s_lshl_b32 s28, s28, 2
  s_add_u32 s28, s28, s5
  s_and_b32 s29, s32, 1
  s_mul_i32 s29, s29, 8
  s_add_u32 s29, s29, s6
  s_mov_b32 s30, 7
  s_mov_b32 s31, -1
  s_mov_b32 s41, s57
  s_mul_i32 s32, s41, 16
  s_add_u32 s32, s32, 0
  v_lshrrev_b32 v2, 3, v0
  v_add_u32 v2, s32, v2
  v_bfe_u32 v3, v2, 1, 1
  v_bfe_u32 v4, v2, 3, 1
  v_lshl_or_b32 v3, v4, 1, v3
  v_lshlrev_b32 v3, 1, v3
  v_and_b32 v4, 7, v0
  v_xor_b32 v3, v3, v4
  v_lshlrev_b32 v3, 4, v3
  s_mov_b32 s32, 6144
  v_mul_lo_u32 v2, v2, s32
  v_add_u32 v13, v2, v3
  s_mul_i32 s32, s41, 16
  s_add_u32 s32, s32, 8
  v_lshrrev_b32 v2, 3, v0
  v_add_u32 v2, s32, v2
  v_bfe_u32 v3, v2, 1, 1
  v_bfe_u32 v4, v2, 3, 1
  v_lshl_or_b32 v3, v4, 1, v3
  v_lshlrev_b32 v3, 1, v3
  v_and_b32 v4, 7, v0
  v_xor_b32 v3, v3, v4
  v_lshlrev_b32 v3, 4, v3
  s_mov_b32 s32, 6144
  v_mul_lo_u32 v2, v2, s32
  v_add_u32 v14, v2, v3
  v_subrev_u32 v14, 1024, v14
  v_add_u32 v15, 2048, v13
  v_add_u32 v16, 2048, v14
  v_add_u32 v17, 4096, v13
  v_add_u32 v18, 4096, v14
  s_lshl_b32 s46, s41, 11
  s_add_u32 s46, s46, 18432
  s_add_u32 s47, s46, 8192
  s_add_u32 s48, s46, 16384
  s_lshl_b32 s35, s29, 7
  s_mov_b32 s12, s66
  s_mov_b32 s13, s67
  s_mov_b32 s14, 6291456
  s_mov_b32 s15, 0x20000
  s_mov_b32 s30, 7
  s_mov_b32 s31, -1
  s_mov_b32 s38, 0
  s_add_u32 s30, s30, 1
  s_and_b32 s30, s30, 7
  s_cselect_b32 s32, 0, 1
  s_add_u32 s31, s31, s32
  s_sub_u32 s32, s30, s7
  s_and_b32 s32, s32, 7
  s_cmp_lt_u32 s32, 2
  s_cselect_b32 s32, 1, 0
  s_add_u32 s32, s32, s31
  s_cmp_ge_u32 s32, 2
  s_cselect_b32 s32, 0, s32
  s_lshl_b32 s33, s32, 3
  s_add_u32 s33, s33, s30
  s_mul_i32 s37, s33, 393216
  s_add_u32 s37, s37, s35
  s_add_u32 m0, s38, s46
  s_nop 0
  buffer_load_dwordx4 v13, s[12:15], s37 offen offset:0  lds
  buffer_load_dwordx4 v14, s[12:15], s37 offen offset:1024  lds
  s_add_u32 m0, s38, s47
  s_nop 0
  buffer_load_dwordx4 v15, s[12:15], s37 offen offset:0  lds
  buffer_load_dwordx4 v16, s[12:15], s37 offen offset:1024  lds
  s_add_u32 m0, s38, s48
  s_nop 0
  buffer_load_dwordx4 v17, s[12:15], s37 offen offset:0  lds
  buffer_load_dwordx4 v18, s[12:15], s37 offen offset:1024  lds
  s_add_u32 s38, s38, 43008
  s_cmp_eq_u32 s38, 129024
  s_cselect_b32 s38, 0, s38
  s_add_u32 s30, s30, 1
  s_and_b32 s30, s30, 7
  s_cselect_b32 s32, 0, 1
  s_add_u32 s31, s31, s32
  s_sub_u32 s32, s30, s7
  s_and_b32 s32, s32, 7
  s_cmp_lt_u32 s32, 2
  s_cselect_b32 s32, 1, 0
  s_add_u32 s32, s32, s31
  s_cmp_ge_u32 s32, 2
  s_cselect_b32 s32, 0, s32
  s_lshl_b32 s33, s32, 3
  s_add_u32 s33, s33, s30
  s_mul_i32 s37, s33, 393216
  s_add_u32 s37, s37, s35
  s_add_u32 m0, s38, s46
  s_nop 0
  buffer_load_dwordx4 v13, s[12:15], s37 offen offset:0  lds
  buffer_load_dwordx4 v14, s[12:15], s37 offen offset:1024  lds
  s_add_u32 m0, s38, s47
  s_nop 0
  buffer_load_dwordx4 v15, s[12:15], s37 offen offset:0  lds
  buffer_load_dwordx4 v16, s[12:15], s37 offen offset:1024  lds
  s_add_u32 m0, s38, s48
  s_nop 0
  buffer_load_dwordx4 v17, s[12:15], s37 offen offset:0  lds
  buffer_load_dwordx4 v18, s[12:15], s37 offen offset:1024  lds
  s_add_u32 s38, s38, 43008
  s_cmp_eq_u32 s38, 129024
  s_cselect_b32 s38, 0, s38
  s_lshl_b32 s40, s28, 7
  s_sub_u32 s40, s40, 16
  s_lshl_b32 s32, s41, 5
  s_add_u32 s32, s32, 16
  v_lshrrev_b32 v2, 3, v0
  v_add_u32 v2, s32, v2
  v_bfe_u32 v3, v2, 1, 3
  v_and_b32 v4, 7, v0
  v_xor_b32 v3, v3, v4
  v_lshlrev_b32 v3, 4, v3
  v_add_u32 v2, s40, v2
  v_max_i32 v2, 0, v2
  v_lshlrev_b32 v2, 8, v2
  v_add_u32 v8, v2, v3
  v_add_u32 v10, 2048, v8
  s_lshl_b32 s32, s41, 5
  s_add_u32 s32, s32, 24
  v_lshrrev_b32 v2, 3, v0
  v_add_u32 v2, s32, v2
  v_bfe_u32 v3, v2, 1, 3
  v_and_b32 v4, 7, v0
  v_xor_b32 v3, v3, v4
  v_lshlrev_b32 v3, 4, v3
  v_add_u32 v2, s40, v2
  v_max_i32 v2, 0, v2
  v_lshlrev_b32 v2, 8, v2
  v_add_u32 v9, v2, v3
  v_subrev_u32 v9, 1024, v9
  v_add_u32 v11, 2048, v9
  s_lshl_b32 s32, s41, 3
  v_lshrrev_b32 v2, 3, v0
  v_add_u32 v2, s32, v2
  v_bfe_u32 v3, v2, 1, 3
  v_and_b32 v4, 7, v0
  v_xor_b32 v3, v3, v4
  v_lshlrev_b32 v3, 4, v3
  v_add_u32 v2, s40, v2
  v_max_i32 v2, 0, v2
  v_lshlrev_b32 v2, 8, v2
  v_add_u32 v12, v2, v3
  s_lshl_b32 s44, s41, 12
  s_add_u32 s44, s44, 2048
  s_lshl_b32 s45, s41, 10
  s_mov_b32 s34, 0
  s_mov_b32 s54, 524288
  s_cmp_eq_u32 s41, 0
  s_cselect_b32 s52, 0xffffff00, -1
  s_mov_b32 s53, -1
  v_mov_b32 v20, 0x3f803f80
  v_mov_b32 v21, v20
  v_mov_b32 v22, v20
  v_mov_b32 v23, v20
  v_lshlrev_b32 v24, 4, v0
  v_add_u32 v25, 86016, v24
  s_mov_b64 exec, 0xff
  ds_write_b128 v24, v[20:23]
  ds_write_b128 v24, v[20:23] offset:43008
  ds_write_b128 v25, v[20:23]
  s_mov_b64 exec, -1
  s_lshl_b32 s32, s41, 6
  v_add_u32 v26, s32, v0
  v_min_u32 v26, 143, v26
  v_add_u32 v27, s40, v26
  v_max_i32 v27, 0, v27
  v_lshrrev_b32 v2, 6, v27
  v_and_b32 v27, 63, v27
  v_lshlrev_b32 v27, 3, v27
  v_lshl_add_u32 v27, v2, 10, v27
  v_add_u32 v27, 512, v27
  v_lshlrev_b32 v26, 3, v26
  v_add_u32 v26, 129024, v26
  s_add_u32 s8, s84, 100663296
  s_addc_u32 s9, s85, 0
  s_mov_b32 s10, 8388608
  s_mov_b32 s11, 0x20000
  s_add_u32 s20, s84, 93323264
  s_addc_u32 s21, s85, 0
  s_mov_b32 s22, 262144
  s_mov_b32 s23, 0x20000
  s_waitcnt lgkmcnt(0)
  s_add_u32 s16, s84, 109051904
  s_addc_u32 s17, s85, 0
  s_mov_b32 s18, 524288
  s_mov_b32 s19, 0x20000
  v_min_u32 v28, 23, v0
  s_lshl_b32 s32, s28, 4
  s_sub_u32 s32, s32, 8
  v_add_u32 v28, s32, v28
  v_max_i32 v28, 0, v28
  v_lshlrev_b32 v28, 7, v28
  s_lshl_b32 s55, s3, 17
  s_add_u32 s55, s55, 98304
  s_barrier
  s_barrier
  s_mov_b64 exec, 1
  buffer_store_dword v137, v136, s[24:27], s56 offen sc0 sc1
  s_mov_b64 exec, -1
  s_mov_b32 s39, 0
  s_and_b32 s32, s4, 3
  s_cmp_lg_u32 s32, 0
  s_cbranch_scc1 poll19d
  s_sleep 8
poll19:
  buffer_load_dword v29, v28, s[16:19], s55 offen sc0 sc1
  s_waitcnt vmcnt(0)
  v_cmp_eq_u32 vcc, 0, v29
  s_add_u32 s39, s39, 1
  s_cmp_gt_u32 s39, 1000000
  s_cbranch_scc1 poll19d
  s_cbranch_vccnz poll19
poll19d:
  s_barrier
  s_mov_b32 s3, 1
  s_add_u32 s82, s84, 50331648
  s_addc_u32 s83, s85, 0
  s_branch L_top
L_end:
mega_end:
  s_endpgm
.section .rodata,"a"
.p2align 6
.amdhsa_kernel interleave_layers__sliding_local_dilated__mixer_token_mlp__prompt_kernel
  .amdhsa_next_free_vgpr 256
  .amdhsa_next_free_sgpr 102
  .amdhsa_accum_offset 256
  .amdhsa_group_segment_fixed_size 0
  .amdhsa_kernarg_size 88
  .amdhsa_user_sgpr_count 2
  .amdhsa_user_sgpr_kernarg_segment_ptr 1
  .amdhsa_system_sgpr_workgroup_id_x 1
.end_amdhsa_kernel
```
